```python
import torch

def _softmax(x, axis=-1):
    return torch.softmax(x, dim=axis)
def _gelu(x):
    return torch.nn.functional.gelu(x, approximate="tanh")
def _silu(x):
    return torch.nn.functional.silu(x)
def _sigmoid(x):
    return torch.sigmoid(x)
def _layernorm(x, axis=-1, eps=1e-5):
    m = x.mean(dim=axis, keepdim=True)
    v = x.var(dim=axis, keepdim=True, unbiased=False)
    return (x - m) / torch.sqrt(v + eps)
def _scatter_add(tgt, idx, src, axis=0):
    return tgt.clone().index_add_(axis, idx, src)
def _segment_sum(src, seg, n):
    out = torch.zeros((n,) + src.shape[1:], dtype=src.dtype)
    return out.index_add_(0, seg, src)
def _pad(x, pw):
    flat = tuple(v for pair in reversed(pw) for v in pair)
    return torch.nn.functional.pad(x, flat)

kernel_name = 'sequential_preLN__compressed_kv_cla__dense_activation_silu__prompt'

def setup_inputs():

    _w = (lambda a: (lambda t: t.to(torch.bfloat16) if t.is_floating_point() else t)(torch.as_tensor(a)))
    def _A_setup():
        B, H, Sq, Sk, D, M = 1, 16, 2048, 2048, 256, 448
        Dc = 4 * D
        return {
            "x": _w((lambda *s: torch.randn(*s, dtype=torch.bfloat16) * 0.05)(B, Sq, M)),
            "c_kv": _w((lambda *s: torch.randn(*s, dtype=torch.bfloat16) * 0.4)(B, Sk, Dc)),
            "w_q": _w((lambda *s: torch.randn(*s, dtype=torch.bfloat16) * 1.6)(M, H, D) * (M ** -0.5)),
            "w_uk": _w((lambda *s: torch.randn(*s, dtype=torch.bfloat16) * 1.6)(Dc, H, D) * (Dc ** -0.5)),
            "w_uv": _w((lambda *s: torch.randn(*s, dtype=torch.bfloat16) * 0.4)(Dc, H, D) * (Dc ** -0.5)),
            "w_o": _w((lambda *s: torch.randn(*s, dtype=torch.bfloat16) * 0.4)(H, D, M) * ((H * D) ** -0.5)),
        }
    _A_in = _A_setup()

    def _B_setup():
        B, S, D, F = 1, 2048, 448, 1792
        return {
            "x": _w((lambda *s: torch.randn(*s, dtype=torch.bfloat16) * 0.05)(B, S, D)),
            "w1": _w((lambda *s: torch.randn(*s, dtype=torch.bfloat16) * 0.8)(D, F) * (D ** -0.5)),
            "w2": _w((lambda *s: torch.randn(*s, dtype=torch.bfloat16) * 0.1)(F, D) * (F ** -0.5)),
        }
    _B_in = _B_setup()

    return {
        "A_x": _A_in["x"],
        "A_c_kv": _A_in["c_kv"],
        "A_w_q": _A_in["w_q"],
        "A_w_uk": _A_in["w_uk"],
        "A_w_uv": _A_in["w_uv"],
        "A_w_o": _A_in["w_o"],
        "B_x": _B_in["x"],
        "B_w1": _B_in["w1"],
        "B_w2": _B_in["w2"],
    }

def reference(A_x, A_c_kv, A_w_q, A_w_uk, A_w_uv, A_w_o, B_x, B_w1, B_w2):
    def _A_ref(x, c_kv, w_q, w_uk, w_uv, w_o):
        B, Sq, M = x.shape[0], x.shape[1], x.shape[2]
        Sk = c_kv.shape[1]
        H, D = w_q.shape[1], w_q.shape[2]
        q = torch.einsum("bqm,mhd->bhqd", x, w_q)
        k = torch.einsum("bkc,chd->bhkd", c_kv, w_uk)
        v = torch.einsum("bkc,chd->bhkd", c_kv, w_uv)
        scores = torch.einsum("bhqd,bhkd->bhqk", q, k) * (D ** -0.5)
        off = Sk - Sq
        qi = torch.arange(Sq)[:, None]
        kj = torch.arange(Sk)[None, :]
        cmask = kj <= (qi + off)
        scores = torch.where(cmask[None, None], scores, -1e9)
        p = _softmax(scores, axis=-1)
        ctx = torch.einsum("bhqk,bhkd->bhqd", p, v)
        return torch.einsum("bhqd,hdm->bqm", ctx, w_o)

    def _B_ref(x, w1, w2):
        h = torch.einsum("bsd,df->bsf", x, w1)
        h = _silu(h)
        out = torch.einsum("bsf,fd->bsd", h, w2)
        return out

    x = A_x
    h = x + _A_ref(_layernorm(x, axis=-1), A_c_kv, A_w_q, A_w_uk, A_w_uv, A_w_o)
    h2 = h + _B_ref(_layernorm(h, axis=-1), B_w1, B_w2)
    return h2
```

```asm
; @launch kernel=mega_kernel grid=(256,1,1) block=(256,1,1) lds=163840
.amdgcn_target "amdgcn-amd-amdhsa--gfx950"
.text
.globl mega_kernel
.p2align 8
.type mega_kernel,@function
mega_kernel:
s_cmp_ge_u32 s2, 256
s_cbranch_scc0 MEGA_GO
s_endpgm
MEGA_GO:
s_load_dwordx16 s[36:51], s[0:1], 0
s_load_dwordx2 s[52:53], s[0:1], 64
s_load_dwordx4 s[92:95], s[0:1], 80
v_lshrrev_b32 v1, 6, v0
v_and_b32 v2, 63, v0
v_readfirstlane_b32 s3, v1
s_and_b32 s4, s2, 7
s_lshr_b32 s5, s2, 3
s_and_b32 s6, s5, 7
s_lshr_b32 s5, s5, 3
s_lshr_b32 s7, s5, 1
s_and_b32 s5, s5, 1
s_lshl_b32 s4, s4, 1
s_add_u32 s4, s4, s5
v_lshrrev_b32 v3, 3, v2
v_lshlrev_b32 v3, 11, v3
v_and_b32 v4, 7, v2
v_bfe_u32 v8, v2, 4, 2
v_xor_b32 v4, v4, v8
v_lshl_add_u32 v3, v4, 4, v3
s_lshl_b32 s56, s6, 19
s_lshl_b32 s57, s3, 17
s_add_u32 s56, s56, s57
v_add_u32 v8, s56, v3
v_xor_b32 v9, 64, v8
v_lshrrev_b32 v3, 5, v2
v_and_b32 v4, 31, v2
s_and_b32 s57, s3, 1
v_xor_b32 v4, s57, v4
v_lshlrev_b32 v5, 2, v3
v_xor_b32 v4, v4, v5
v_lshlrev_b32 v4, 4, v4
v_lshl_add_u32 v4, v3, 13, v4
s_lshl_b32 s56, s4, 9
s_lshl_b32 s57, s3, 16
s_add_u32 s56, s56, s57
v_add_u32 v12, s56, v4
v_xor_b32 v13, 128, v12
v_add_u32 v13, 15360, v13
v_add_u32 v14, 30720, v12
v_add_u32 v15, 30720, v13
s_lshl_b32 s64, s3, 12
s_mov_b32 s65, 0
s_mov_b32 s66, 0
s_waitcnt lgkmcnt(0)
s_mov_b32 s54, s94
s_mov_b32 s55, s95
s_mov_b32 s8, s38
s_and_b32 s9, s39, 0xffff
s_mov_b32 s10, 0x400000
s_mov_b32 s11, 0x00020000
s_cmp_eq_u32 s7, 0
s_cselect_b32 s12, s42, s44
s_cselect_b32 s13, s43, s45
s_and_b32 s13, s13, 0xffff
s_mov_b32 s14, 0x800000
s_mov_b32 s15, 0x00020000
s_lshl_b32 s63, s3, 13
s_add_u32 m0, s64, 65536
s_nop 0
s_nop 0
buffer_load_dwordx4 v12, s[12:15], s66 offen lds
buffer_load_dwordx4 v13, s[12:15], s66 offen offset:1024 lds
buffer_load_dwordx4 v14, s[12:15], s66 offen offset:2048 lds
buffer_load_dwordx4 v15, s[12:15], s66 offen offset:3072 lds
s_add_u32 s66, s66, 262144
s_add_u32 m0, s63, 0
s_add_u32 s62, s65, 0
buffer_load_dwordx4 v8, s[8:11], s62 offen lds
s_add_u32 s62, s65, 15360
buffer_load_dwordx4 v8, s[8:11], s62 offen offset:1024 lds
s_add_u32 s62, s65, 30720
buffer_load_dwordx4 v9, s[8:11], s62 offen offset:2048 lds
s_add_u32 s62, s65, 46080
buffer_load_dwordx4 v9, s[8:11], s62 offen offset:3072 lds
s_add_u32 m0, s63, 4096
s_add_u32 s62, s65, 65536
buffer_load_dwordx4 v8, s[8:11], s62 offen lds
s_add_u32 s62, s65, 80896
buffer_load_dwordx4 v8, s[8:11], s62 offen offset:1024 lds
s_add_u32 s62, s65, 96256
buffer_load_dwordx4 v9, s[8:11], s62 offen offset:2048 lds
s_add_u32 s62, s65, 111616
buffer_load_dwordx4 v9, s[8:11], s62 offen offset:3072 lds
s_add_u32 s65, s65, 128
s_add_u32 m0, s64, 81920
s_nop 0
s_nop 0
buffer_load_dwordx4 v12, s[12:15], s66 offen lds
buffer_load_dwordx4 v13, s[12:15], s66 offen offset:1024 lds
buffer_load_dwordx4 v14, s[12:15], s66 offen offset:2048 lds
buffer_load_dwordx4 v15, s[12:15], s66 offen offset:3072 lds
s_add_u32 s66, s66, 262144
v_bfe_u32 v240, v2, 3, 1
v_lshlrev_b32 v240, 11, v240
v_and_b32 v241, 7, v2
v_lshl_add_u32 v240, v241, 7, v240
s_lshl_b32 s56, s2, 14
s_lshl_b32 s57, s3, 12
s_add_u32 s56, s56, s57
v_add_u32 v241, s56, v240
s_cmp_lt_u32 s2, 128
s_cselect_b32 s98, s42, s44
s_cselect_b32 s99, s43, s45
s_and_b32 s56, s2, 127
s_lshl_b32 s56, s56, 13
s_lshl_b32 s57, s3, 11
s_add_u32 s56, s56, s57
v_and_b32 v242, 15, v2
v_lshlrev_b32 v242, 7, v242
v_add_u32 v242, s56, v242
buffer_load_dword v244, v241, s[8:11], 0 offen
v_add_u32 v242, 0x100000, v242
global_load_dword v245, v242, s[98:99]
s_getpc_b64 s[56:57]
PCREF:
s_lshr_b32 s58, s2, 3
s_lshl_b32 s58, s58, 2
s_add_u32 s58, s58, s3
s_mul_i32 s58, s58, 1280
v_min_u32 v249, 9, v2
v_lshlrev_b32 v249, 7, v249
v_add_u32 v249, s58, v249
v_min_u32 v249, (MEGA_END - PCREF), v249
global_load_dword v250, v249, s[56:57]
s_add_u32 s88, s54, 0x4a00000
s_addc_u32 s89, s55, 0
s_and_b32 s89, s89, 0xffff
s_mov_b32 s90, 0x2000
s_mov_b32 s91, 0x00020000
v_mov_b32 v29, 0
v_mov_b32 v30, 1
s_cmp_lg_u32 s2, 0
s_cbranch_scc1 NOZERO
v_lshlrev_b32 v3, 5, v0
v_mov_b32 v32, 0
v_mov_b32 v33, 0
v_mov_b32 v34, 0
v_mov_b32 v35, 0
buffer_store_dwordx4 v[32:35], v3, s[88:91], 0 offen sc1
buffer_store_dwordx4 v[32:35], v3, s[88:91], 0 offen offset:16 sc1
NOZERO:
s_add_u32 s16, s54, 0x0
s_addc_u32 s17, s55, 0
s_and_b32 s17, s17, 0xffff
s_mov_b32 s18, 0x2000000
s_mov_b32 s19, 0x00020000
s_mov_b32 s20, s36
s_and_b32 s21, s37, 0xffff
s_mov_b32 s22, 0x1c0000
s_mov_b32 s23, 0x00020000
s_add_u32 s24, s54, 0x2000000
s_addc_u32 s25, s55, 0
s_and_b32 s25, s25, 0xffff
s_mov_b32 s26, 0x1c0000
s_mov_b32 s27, 0x00020000
v_and_b32 v3, 31, v2
v_lshrrev_b32 v4, 5, v2
s_lshl_b32 s56, s2, 3
s_lshl_b32 s57, s3, 1
s_add_u32 s56, s56, s57
v_add_u32 v4, s56, v4
v_mul_u32_u24 v25, 896, v4
v_lshl_add_u32 v25, v3, 5, v25
v_and_b32 v5, 7, v4
v_lshlrev_b32 v26, 8, v3
v_lshl_add_u32 v26, v5, 4, v26
v_add_u32 v26, 0x24000, v26
s_mul_i32 s56, s3, 112
v_add_u32 v251, s56, v2
v_lshlrev_b32 v252, 4, v251
v_add_u32 v252, 0x24000, v252
v_lshrrev_b32 v253, 3, v251
v_lshlrev_b32 v253, 9, v253
v_and_b32 v251, 7, v251
v_lshl_add_u32 v253, v251, 4, v253
s_lshr_b32 s56, s2, 2
s_mul_i32 s56, s56, 28672
s_and_b32 s57, s2, 3
s_lshl_b32 s57, s57, 7
s_add_u32 s56, s56, s57
v_add_u32 v253, s56, v253
v_mov_b32 v5, 0x7ffffff0
v_cmp_gt_u32 vcc, 56, v2
s_nop 1
v_cndmask_b32 v253, v5, v253, vcc
v_cmp_gt_u32 vcc, 28, v3
v_mov_b32 v5, 0x7ffffff0
s_nop 0
v_cndmask_b32 v25, v5, v25, vcc
v_cndmask_b32 v7, 0, 1.0, vcc
s_and_b32 s67, s3, 1
s_lshr_b32 s68, s3, 1
v_and_b32 v3, 15, v2
v_lshrrev_b32 v4, 4, v2
v_lshrrev_b32 v5, 3, v3
v_and_b32 v6, 7, v3
v_lshl_add_u32 v6, v5, 4, v6
v_lshlrev_b32 v5, 2, v5
v_bfe_u32 v16, v3, 1, 2
v_or_b32 v5, v5, v16
v_xor_b32 v5, v4, v5
v_lshlrev_b32 v16, 7, v6
v_lshl_add_u32 v16, v5, 4, v16
s_lshl_b32 s56, s67, 14
v_add_u32 v16, s56, v16
v_xor_b32 v10, 64, v16
v_lshlrev_b32 v6, 4, v6
v_lshrrev_b32 v5, 1, v4
v_lshl_add_u32 v6, v5, 10, v6
v_and_b32 v5, 1, v4
v_lshl_add_u32 v6, v5, 9, v6
v_lshrrev_b32 v60, 2, v3
v_lshl_add_u32 v61, v4, 3, v60
v_lshlrev_b32 v61, 9, v61
v_and_b32 v62, 1, v3
v_lshl_add_u32 v61, v62, 3, v61
s_lshl_b32 s56, s68, 8
s_add_u32 s56, s56, 65536
v_add_u32 v61, s56, v61
v_lshl_or_b32 v60, v60, 2, v5
v_and_b32 v62, 2, v3
v_xor_b32 v60, v60, v62
v_xor_b32 v62, 0, v60
v_lshl_add_u32 v17, v62, 4, v61
v_xor_b32 v62, 1, v60
v_lshl_add_u32 v18, v62, 4, v61
v_xor_b32 v62, 4, v60
v_lshl_add_u32 v19, v62, 4, v61
v_xor_b32 v62, 5, v60
v_lshl_add_u32 v20, v62, 4, v61
v_xor_b32 v62, 8, v60
v_lshl_add_u32 v21, v62, 4, v61
v_xor_b32 v62, 9, v60
v_lshl_add_u32 v22, v62, 4, v61
v_xor_b32 v62, 12, v60
v_lshl_add_u32 v23, v62, 4, v61
v_xor_b32 v62, 13, v60
v_lshl_add_u32 v24, v62, 4, v61
v_lshlrev_b32 v5, 4, v2
s_and_b32 s56, s2, 7
s_lshr_b32 s57, s2, 7
s_lshl_b32 s56, s56, 1
s_add_u32 s85, s56, s57
s_lshl_b32 s60, s85, 9
s_lshl_b32 s56, s3, 7
s_add_u32 s60, s60, s56
s_lshl_b32 s86, s3, 12
s_add_u32 s86, s86, 114688
s_mov_b32 s28, s40
s_and_b32 s29, s41, 0xffff
s_mov_b32 s30, 0x380000
s_mov_b32 s31, 0x00020000
v_lshrrev_b32 v60, 3, v2
v_mul_u32_u24 v27, 8192, v60
v_bfe_u32 v60, v2, 4, 1
v_lshlrev_b32 v60, 2, v60
v_and_b32 v61, 7, v2
v_xor_b32 v60, v60, v61
v_lshl_add_u32 v27, v60, 4, v27
v_add_u32 v28, 64512, v27
v_lshrrev_b32 v60, 5, v2
v_bfe_u32 v61, v2, 2, 2
v_lshl_add_u32 v60, v60, 2, v61
v_lshlrev_b32 v60, 7, v60
v_bfe_u32 v61, v2, 3, 1
v_lshl_add_u32 v60, v61, 6, v60
v_bfe_u32 v61, v2, 4, 1
v_lshl_add_u32 v60, v61, 5, v60
v_and_b32 v61, 3, v2
v_lshl_add_u32 v60, v61, 3, v60
v_add_u32 v3, s86, v60
v_xor_b32 v4, 64, v3
s_lshl_b32 s69, s2, 2
s_add_u32 s69, s69, s3
s_lshl_b32 s70, s69, 12
v_and_b32 v246, 15, v2
v_lshlrev_b32 v246, 7, v246
v_add_u32 v247, s70, v246
s_lshl_b32 s70, s69, 11
v_add_u32 v246, s70, v246
s_mov_b32 s32, s46
s_and_b32 s33, s47, 0xffff
s_mov_b32 s34, 0x380000
s_mov_b32 s35, 0x00020000
s_mov_b32 s76, s50
s_and_b32 s77, s51, 0xffff
s_mov_b32 s78, 0x188000
s_mov_b32 s79, 0x00020000
s_mov_b32 s80, s52
s_and_b32 s81, s53, 0xffff
s_mov_b32 s82, 0x188000
s_mov_b32 s83, 0x00020000
s_lshr_b32 s56, s2, 3
s_and_b32 s5, s56, 15
s_lshl_b32 s57, s5, 1
s_add_u32 s58, s57, s3
s_sub_u32 s59, 60, s57
s_add_u32 s59, s59, s3
s_cmp_lt_u32 s3, 2
s_cselect_b32 s58, s58, s59
s_mul_i32 s69, s58, 28672
s_cmp_eq_u32 s7, 1
s_cbranch_scc1 PA_V
s_waitcnt vmcnt(7)
s_barrier
ds_read_b128 v[64:67], v16
ds_read_b64_tr_b16 v[96:97], v17
ds_read_b64_tr_b16 v[98:99], v17 offset:2048
ds_read_b128 v[68:71], v16 offset:1024
ds_read_b64_tr_b16 v[100:101], v18
ds_read_b64_tr_b16 v[102:103], v18 offset:2048
ds_read_b128 v[72:75], v16 offset:4096
ds_read_b64_tr_b16 v[104:105], v19
ds_read_b64_tr_b16 v[106:107], v19 offset:2048
ds_read_b128 v[76:79], v16 offset:5120
ds_read_b64_tr_b16 v[108:109], v20
ds_read_b64_tr_b16 v[110:111], v20 offset:2048
ds_read_b128 v[80:83], v16 offset:8192
ds_read_b64_tr_b16 v[112:113], v21
ds_read_b64_tr_b16 v[114:115], v21 offset:2048
ds_read_b128 v[84:87], v16 offset:9216
ds_read_b64_tr_b16 v[116:117], v22
ds_read_b64_tr_b16 v[118:119], v22 offset:2048
ds_read_b128 v[88:91], v16 offset:12288
ds_read_b64_tr_b16 v[120:121], v23
ds_read_b64_tr_b16 v[122:123], v23 offset:2048
ds_read_b128 v[92:95], v16 offset:13312
ds_read_b64_tr_b16 v[124:125], v24
ds_read_b64_tr_b16 v[126:127], v24 offset:2048
s_waitcnt lgkmcnt(0)
v_mfma_f32_16x16x32_bf16 a[0:3], v[96:99], v[64:67], 0
s_add_u32 m0, s64, 98304
s_nop 0
buffer_load_dwordx4 v12, s[12:15], s66 offen lds
v_mfma_f32_16x16x32_bf16 a[4:7], v[100:103], v[64:67], 0
buffer_load_dwordx4 v13, s[12:15], s66 offen offset:1024 lds
buffer_load_dwordx4 v14, s[12:15], s66 offen offset:2048 lds
buffer_load_dwordx4 v15, s[12:15], s66 offen offset:3072 lds
v_mfma_f32_16x16x32_bf16 a[8:11], v[104:107], v[64:67], 0
s_add_u32 s66, s66, 262144
s_add_u32 m0, s63, 32768
s_add_u32 s62, s65, 0
v_mfma_f32_16x16x32_bf16 a[12:15], v[108:111], v[64:67], 0
buffer_load_dwordx4 v8, s[8:11], s62 offen lds
s_add_u32 s62, s65, 15360
v_mfma_f32_16x16x32_bf16 a[16:19], v[112:115], v[64:67], 0
buffer_load_dwordx4 v8, s[8:11], s62 offen offset:1024 lds
s_add_u32 s62, s65, 30720
buffer_load_dwordx4 v9, s[8:11], s62 offen offset:2048 lds
v_mfma_f32_16x16x32_bf16 a[20:23], v[116:119], v[64:67], 0
s_add_u32 s62, s65, 46080
buffer_load_dwordx4 v9, s[8:11], s62 offen offset:3072 lds
s_add_u32 m0, s63, 36864
v_mfma_f32_16x16x32_bf16 a[24:27], v[120:123], v[64:67], 0
s_add_u32 s62, s65, 65536
buffer_load_dwordx4 v8, s[8:11], s62 offen lds
s_add_u32 s62, s65, 80896
v_mfma_f32_16x16x32_bf16 a[28:31], v[124:127], v[64:67], 0
buffer_load_dwordx4 v8, s[8:11], s62 offen offset:1024 lds
s_add_u32 s62, s65, 96256
v_mfma_f32_16x16x32_bf16 a[32:35], v[96:99], v[68:71], 0
buffer_load_dwordx4 v9, s[8:11], s62 offen offset:2048 lds
s_add_u32 s62, s65, 111616
buffer_load_dwordx4 v9, s[8:11], s62 offen offset:3072 lds
v_mfma_f32_16x16x32_bf16 a[36:39], v[100:103], v[68:71], 0
s_add_u32 s65, s65, 128
s_add_u32 m0, s64, 114688
s_nop 0
v_mfma_f32_16x16x32_bf16 a[40:43], v[104:107], v[68:71], 0
buffer_load_dwordx4 v12, s[12:15], s66 offen lds
buffer_load_dwordx4 v13, s[12:15], s66 offen offset:1024 lds
buffer_load_dwordx4 v14, s[12:15], s66 offen offset:2048 lds
v_mfma_f32_16x16x32_bf16 a[44:47], v[108:111], v[68:71], 0
buffer_load_dwordx4 v15, s[12:15], s66 offen offset:3072 lds
s_add_u32 s66, s66, 262144
v_mfma_f32_16x16x32_bf16 a[48:51], v[112:115], v[68:71], 0
s_waitcnt vmcnt(19)
s_barrier
v_mfma_f32_16x16x32_bf16 a[52:55], v[116:119], v[68:71], 0
ds_read_b128 v[128:131], v10
v_mfma_f32_16x16x32_bf16 a[56:59], v[120:123], v[68:71], 0
ds_read_b64_tr_b16 v[160:161], v17 offset:16384
s_add_u32 m0, s64, 65536
v_mfma_f32_16x16x32_bf16 a[60:63], v[124:127], v[68:71], 0
v_mfma_f32_16x16x32_bf16 a[64:67], v[96:99], v[72:75], 0
ds_read_b64_tr_b16 v[162:163], v17 offset:18432
v_mfma_f32_16x16x32_bf16 a[68:71], v[100:103], v[72:75], 0
v_mfma_f32_16x16x32_bf16 a[72:75], v[104:107], v[72:75], 0
ds_read_b128 v[132:135], v10 offset:1024
v_mfma_f32_16x16x32_bf16 a[76:79], v[108:111], v[72:75], 0
s_nop 0
v_mfma_f32_16x16x32_bf16 a[80:83], v[112:115], v[72:75], 0
ds_read_b64_tr_b16 v[164:165], v18 offset:16384
v_mfma_f32_16x16x32_bf16 a[84:87], v[116:119], v[72:75], 0
ds_read_b64_tr_b16 v[166:167], v18 offset:18432
v_mfma_f32_16x16x32_bf16 a[88:91], v[120:123], v[72:75], 0
v_mfma_f32_16x16x32_bf16 a[92:95], v[124:127], v[72:75], 0
ds_read_b128 v[136:139], v10 offset:4096
v_mfma_f32_16x16x32_bf16 a[96:99], v[96:99], v[76:79], 0
buffer_load_dwordx4 v12, s[12:15], s66 offen lds
v_mfma_f32_16x16x32_bf16 a[100:103], v[100:103], v[76:79], 0
ds_read_b64_tr_b16 v[168:169], v19 offset:16384
v_mfma_f32_16x16x32_bf16 a[104:107], v[104:107], v[76:79], 0
v_mfma_f32_16x16x32_bf16 a[108:111], v[108:111], v[76:79], 0
ds_read_b64_tr_b16 v[170:171], v19 offset:18432
v_mfma_f32_16x16x32_bf16 a[112:115], v[112:115], v[76:79], 0
ds_read_b128 v[140:143], v10 offset:5120
v_mfma_f32_16x16x32_bf16 a[116:119], v[116:119], v[76:79], 0
buffer_load_dwordx4 v13, s[12:15], s66 offen offset:1024 lds
v_mfma_f32_16x16x32_bf16 a[120:123], v[120:123], v[76:79], 0
ds_read_b64_tr_b16 v[172:173], v20 offset:16384
v_mfma_f32_16x16x32_bf16 a[124:127], v[124:127], v[76:79], 0
v_mfma_f32_16x16x32_bf16 a[128:131], v[96:99], v[80:83], 0
ds_read_b64_tr_b16 v[174:175], v20 offset:18432
v_mfma_f32_16x16x32_bf16 a[132:135], v[100:103], v[80:83], 0
v_mfma_f32_16x16x32_bf16 a[136:139], v[104:107], v[80:83], 0
ds_read_b128 v[144:147], v10 offset:8192
buffer_load_dwordx4 v14, s[12:15], s66 offen offset:2048 lds
v_mfma_f32_16x16x32_bf16 a[140:143], v[108:111], v[80:83], 0
ds_read_b64_tr_b16 v[176:177], v21 offset:16384
v_mfma_f32_16x16x32_bf16 a[144:147], v[112:115], v[80:83], 0
v_mfma_f32_16x16x32_bf16 a[148:151], v[116:119], v[80:83], 0
ds_read_b64_tr_b16 v[178:179], v21 offset:18432
v_mfma_f32_16x16x32_bf16 a[152:155], v[120:123], v[80:83], 0
v_mfma_f32_16x16x32_bf16 a[156:159], v[124:127], v[80:83], 0
ds_read_b128 v[148:151], v10 offset:9216
buffer_load_dwordx4 v15, s[12:15], s66 offen offset:3072 lds
v_mfma_f32_16x16x32_bf16 a[160:163], v[96:99], v[84:87], 0
v_mfma_f32_16x16x32_bf16 a[164:167], v[100:103], v[84:87], 0
ds_read_b64_tr_b16 v[180:181], v22 offset:16384
v_mfma_f32_16x16x32_bf16 a[168:171], v[104:107], v[84:87], 0
ds_read_b64_tr_b16 v[182:183], v22 offset:18432
v_mfma_f32_16x16x32_bf16 a[172:175], v[108:111], v[84:87], 0
v_mfma_f32_16x16x32_bf16 a[176:179], v[112:115], v[84:87], 0
ds_read_b128 v[152:155], v10 offset:12288
s_add_u32 s66, s66, 262144
v_mfma_f32_16x16x32_bf16 a[180:183], v[116:119], v[84:87], 0
v_mfma_f32_16x16x32_bf16 a[184:187], v[120:123], v[84:87], 0
ds_read_b64_tr_b16 v[184:185], v23 offset:16384
v_mfma_f32_16x16x32_bf16 a[188:191], v[124:127], v[84:87], 0
v_mfma_f32_16x16x32_bf16 a[192:195], v[96:99], v[88:91], 0
ds_read_b64_tr_b16 v[186:187], v23 offset:18432
v_mfma_f32_16x16x32_bf16 a[196:199], v[100:103], v[88:91], 0
ds_read_b128 v[156:159], v10 offset:13312
v_mfma_f32_16x16x32_bf16 a[200:203], v[104:107], v[88:91], 0
v_add_u32 v242, 0x100000, v242
global_load_dword v245, v242, s[98:99]
v_mfma_f32_16x16x32_bf16 a[204:207], v[108:111], v[88:91], 0
ds_read_b64_tr_b16 v[188:189], v24 offset:16384
v_mfma_f32_16x16x32_bf16 a[208:211], v[112:115], v[88:91], 0
v_mfma_f32_16x16x32_bf16 a[212:215], v[116:119], v[88:91], 0
ds_read_b64_tr_b16 v[190:191], v24 offset:18432
v_mfma_f32_16x16x32_bf16 a[216:219], v[120:123], v[88:91], 0
v_mfma_f32_16x16x32_bf16 a[220:223], v[124:127], v[88:91], 0
v_mfma_f32_16x16x32_bf16 a[224:227], v[96:99], v[92:95], 0
v_mfma_f32_16x16x32_bf16 a[228:231], v[100:103], v[92:95], 0
v_mfma_f32_16x16x32_bf16 a[232:235], v[104:107], v[92:95], 0
v_mfma_f32_16x16x32_bf16 a[236:239], v[108:111], v[92:95], 0
v_mfma_f32_16x16x32_bf16 a[240:243], v[112:115], v[92:95], 0
v_mfma_f32_16x16x32_bf16 a[244:247], v[116:119], v[92:95], 0
v_mfma_f32_16x16x32_bf16 a[248:251], v[120:123], v[92:95], 0
v_mfma_f32_16x16x32_bf16 a[252:255], v[124:127], v[92:95], 0
s_waitcnt lgkmcnt(0)
v_mfma_f32_16x16x32_bf16 a[0:3], v[160:163], v[128:131], a[0:3]
s_waitcnt vmcnt(9)
s_barrier
v_mfma_f32_16x16x32_bf16 a[4:7], v[164:167], v[128:131], a[4:7]
ds_read_b128 v[64:67], v16 offset:32768
v_mfma_f32_16x16x32_bf16 a[8:11], v[168:171], v[128:131], a[8:11]
s_add_u32 m0, s63, 0
v_mfma_f32_16x16x32_bf16 a[12:15], v[172:175], v[128:131], a[12:15]
ds_read_b64_tr_b16 v[96:97], v17 offset:32768
s_add_u32 s62, s65, 0
v_mfma_f32_16x16x32_bf16 a[16:19], v[176:179], v[128:131], a[16:19]
v_mfma_f32_16x16x32_bf16 a[20:23], v[180:183], v[128:131], a[20:23]
ds_read_b64_tr_b16 v[98:99], v17 offset:34816
buffer_load_dwordx4 v8, s[8:11], s62 offen lds
v_mfma_f32_16x16x32_bf16 a[24:27], v[184:187], v[128:131], a[24:27]
v_mfma_f32_16x16x32_bf16 a[28:31], v[188:191], v[128:131], a[28:31]
ds_read_b128 v[68:71], v16 offset:33792
s_add_u32 s62, s65, 15360
v_mfma_f32_16x16x32_bf16 a[32:35], v[160:163], v[132:135], a[32:35]
v_mfma_f32_16x16x32_bf16 a[36:39], v[164:167], v[132:135], a[36:39]
buffer_load_dwordx4 v8, s[8:11], s62 offen offset:1024 lds
v_mfma_f32_16x16x32_bf16 a[40:43], v[168:171], v[132:135], a[40:43]
ds_read_b64_tr_b16 v[100:101], v18 offset:32768
v_mfma_f32_16x16x32_bf16 a[44:47], v[172:175], v[132:135], a[44:47]
s_add_u32 s62, s65, 30720
v_mfma_f32_16x16x32_bf16 a[48:51], v[176:179], v[132:135], a[48:51]
ds_read_b64_tr_b16 v[102:103], v18 offset:34816
buffer_load_dwordx4 v9, s[8:11], s62 offen offset:2048 lds
v_mfma_f32_16x16x32_bf16 a[52:55], v[180:183], v[132:135], a[52:55]
v_mfma_f32_16x16x32_bf16 a[56:59], v[184:187], v[132:135], a[56:59]
ds_read_b128 v[72:75], v16 offset:36864
s_add_u32 s62, s65, 46080
v_mfma_f32_16x16x32_bf16 a[60:63], v[188:191], v[132:135], a[60:63]
v_mfma_f32_16x16x32_bf16 a[64:67], v[160:163], v[136:139], a[64:67]
ds_read_b64_tr_b16 v[104:105], v19 offset:32768
buffer_load_dwordx4 v9, s[8:11], s62 offen offset:3072 lds
v_mfma_f32_16x16x32_bf16 a[68:71], v[164:167], v[136:139], a[68:71]
v_mfma_f32_16x16x32_bf16 a[72:75], v[168:171], v[136:139], a[72:75]
s_add_u32 m0, s63, 4096
v_mfma_f32_16x16x32_bf16 a[76:79], v[172:175], v[136:139], a[76:79]
ds_read_b64_tr_b16 v[106:107], v19 offset:34816
v_mfma_f32_16x16x32_bf16 a[80:83], v[176:179], v[136:139], a[80:83]
s_add_u32 s62, s65, 65536
v_mfma_f32_16x16x32_bf16 a[84:87], v[180:183], v[136:139], a[84:87]
ds_read_b128 v[76:79], v16 offset:37888
buffer_load_dwordx4 v8, s[8:11], s62 offen lds
v_mfma_f32_16x16x32_bf16 a[88:91], v[184:187], v[136:139], a[88:91]
v_mfma_f32_16x16x32_bf16 a[92:95], v[188:191], v[136:139], a[92:95]
ds_read_b64_tr_b16 v[108:109], v20 offset:32768
s_add_u32 s62, s65, 80896
v_mfma_f32_16x16x32_bf16 a[96:99], v[160:163], v[140:143], a[96:99]
v_mfma_f32_16x16x32_bf16 a[100:103], v[164:167], v[140:143], a[100:103]
ds_read_b64_tr_b16 v[110:111], v20 offset:34816
buffer_load_dwordx4 v8, s[8:11], s62 offen offset:1024 lds
v_mfma_f32_16x16x32_bf16 a[104:107], v[168:171], v[140:143], a[104:107]
v_mfma_f32_16x16x32_bf16 a[108:111], v[172:175], v[140:143], a[108:111]
s_add_u32 s62, s65, 96256
v_mfma_f32_16x16x32_bf16 a[112:115], v[176:179], v[140:143], a[112:115]
ds_read_b128 v[80:83], v16 offset:40960
v_mfma_f32_16x16x32_bf16 a[116:119], v[180:183], v[140:143], a[116:119]
buffer_load_dwordx4 v9, s[8:11], s62 offen offset:2048 lds
v_mfma_f32_16x16x32_bf16 a[120:123], v[184:187], v[140:143], a[120:123]
ds_read_b64_tr_b16 v[112:113], v21 offset:32768
s_add_u32 s62, s65, 111616
v_mfma_f32_16x16x32_bf16 a[124:127], v[188:191], v[140:143], a[124:127]
v_mfma_f32_16x16x32_bf16 a[128:131], v[160:163], v[144:147], a[128:131]
ds_read_b64_tr_b16 v[114:115], v21 offset:34816
buffer_load_dwordx4 v9, s[8:11], s62 offen offset:3072 lds
v_mfma_f32_16x16x32_bf16 a[132:135], v[164:167], v[144:147], a[132:135]
v_mfma_f32_16x16x32_bf16 a[136:139], v[168:171], v[144:147], a[136:139]
ds_read_b128 v[84:87], v16 offset:41984
s_add_u32 s65, s65, 128
v_mfma_f32_16x16x32_bf16 a[140:143], v[172:175], v[144:147], a[140:143]
v_mfma_f32_16x16x32_bf16 a[144:147], v[176:179], v[144:147], a[144:147]
s_add_u32 m0, s64, 81920
v_mfma_f32_16x16x32_bf16 a[148:151], v[180:183], v[144:147], a[148:151]
ds_read_b64_tr_b16 v[116:117], v22 offset:32768
v_mfma_f32_16x16x32_bf16 a[152:155], v[184:187], v[144:147], a[152:155]
s_nop 0
v_mfma_f32_16x16x32_bf16 a[156:159], v[188:191], v[144:147], a[156:159]
ds_read_b64_tr_b16 v[118:119], v22 offset:34816
buffer_load_dwordx4 v12, s[12:15], s66 offen lds
v_mfma_f32_16x16x32_bf16 a[160:163], v[160:163], v[148:151], a[160:163]
v_mfma_f32_16x16x32_bf16 a[164:167], v[164:167], v[148:151], a[164:167]
ds_read_b128 v[88:91], v16 offset:45056
buffer_load_dwordx4 v13, s[12:15], s66 offen offset:1024 lds
v_mfma_f32_16x16x32_bf16 a[168:171], v[168:171], v[148:151], a[168:171]
v_mfma_f32_16x16x32_bf16 a[172:175], v[172:175], v[148:151], a[172:175]
ds_read_b64_tr_b16 v[120:121], v23 offset:32768
buffer_load_dwordx4 v14, s[12:15], s66 offen offset:2048 lds
v_mfma_f32_16x16x32_bf16 a[176:179], v[176:179], v[148:151], a[176:179]
v_mfma_f32_16x16x32_bf16 a[180:183], v[180:183], v[148:151], a[180:183]
buffer_load_dwordx4 v15, s[12:15], s66 offen offset:3072 lds
v_mfma_f32_16x16x32_bf16 a[184:187], v[184:187], v[148:151], a[184:187]
ds_read_b64_tr_b16 v[122:123], v23 offset:34816
v_mfma_f32_16x16x32_bf16 a[188:191], v[188:191], v[148:151], a[188:191]
s_add_u32 s66, s66, 262144
v_mfma_f32_16x16x32_bf16 a[192:195], v[160:163], v[152:155], a[192:195]
ds_read_b128 v[92:95], v16 offset:46080
v_mfma_f32_16x16x32_bf16 a[196:199], v[164:167], v[152:155], a[196:199]
v_mfma_f32_16x16x32_bf16 a[200:203], v[168:171], v[152:155], a[200:203]
ds_read_b64_tr_b16 v[124:125], v24 offset:32768
v_mfma_f32_16x16x32_bf16 a[204:207], v[172:175], v[152:155], a[204:207]
v_mfma_f32_16x16x32_bf16 a[208:211], v[176:179], v[152:155], a[208:211]
ds_read_b64_tr_b16 v[126:127], v24 offset:34816
v_mfma_f32_16x16x32_bf16 a[212:215], v[180:183], v[152:155], a[212:215]
v_mfma_f32_16x16x32_bf16 a[216:219], v[184:187], v[152:155], a[216:219]
v_mfma_f32_16x16x32_bf16 a[220:223], v[188:191], v[152:155], a[220:223]
v_mfma_f32_16x16x32_bf16 a[224:227], v[160:163], v[156:159], a[224:227]
v_mfma_f32_16x16x32_bf16 a[228:231], v[164:167], v[156:159], a[228:231]
v_mfma_f32_16x16x32_bf16 a[232:235], v[168:171], v[156:159], a[232:235]
v_mfma_f32_16x16x32_bf16 a[236:239], v[172:175], v[156:159], a[236:239]
v_mfma_f32_16x16x32_bf16 a[240:243], v[176:179], v[156:159], a[240:243]
v_mfma_f32_16x16x32_bf16 a[244:247], v[180:183], v[156:159], a[244:247]
v_mfma_f32_16x16x32_bf16 a[248:251], v[184:187], v[156:159], a[248:251]
v_mfma_f32_16x16x32_bf16 a[252:255], v[188:191], v[156:159], a[252:255]
s_waitcnt lgkmcnt(0)
v_mfma_f32_16x16x32_bf16 a[0:3], v[96:99], v[64:67], a[0:3]
s_waitcnt vmcnt(17)
s_barrier
v_mfma_f32_16x16x32_bf16 a[4:7], v[100:103], v[64:67], a[4:7]
ds_read_b128 v[128:131], v10 offset:32768
v_mfma_f32_16x16x32_bf16 a[8:11], v[104:107], v[64:67], a[8:11]
s_add_u32 m0, s64, 98304
v_mfma_f32_16x16x32_bf16 a[12:15], v[108:111], v[64:67], a[12:15]
ds_read_b64_tr_b16 v[160:161], v17 offset:49152
v_mfma_f32_16x16x32_bf16 a[16:19], v[112:115], v[64:67], a[16:19]
v_mfma_f32_16x16x32_bf16 a[20:23], v[116:119], v[64:67], a[20:23]
ds_read_b64_tr_b16 v[162:163], v17 offset:51200
v_mfma_f32_16x16x32_bf16 a[24:27], v[120:123], v[64:67], a[24:27]
v_mfma_f32_16x16x32_bf16 a[28:31], v[124:127], v[64:67], a[28:31]
ds_read_b128 v[132:135], v10 offset:33792
v_mfma_f32_16x16x32_bf16 a[32:35], v[96:99], v[68:71], a[32:35]
s_nop 0
v_mfma_f32_16x16x32_bf16 a[36:39], v[100:103], v[68:71], a[36:39]
v_mfma_f32_16x16x32_bf16 a[40:43], v[104:107], v[68:71], a[40:43]
ds_read_b64_tr_b16 v[164:165], v18 offset:49152
v_mfma_f32_16x16x32_bf16 a[44:47], v[108:111], v[68:71], a[44:47]
v_mfma_f32_16x16x32_bf16 a[48:51], v[112:115], v[68:71], a[48:51]
ds_read_b64_tr_b16 v[166:167], v18 offset:51200
v_mfma_f32_16x16x32_bf16 a[52:55], v[116:119], v[68:71], a[52:55]
v_mfma_f32_16x16x32_bf16 a[56:59], v[120:123], v[68:71], a[56:59]
ds_read_b128 v[136:139], v10 offset:36864
v_mfma_f32_16x16x32_bf16 a[60:63], v[124:127], v[68:71], a[60:63]
buffer_load_dwordx4 v12, s[12:15], s66 offen lds
v_mfma_f32_16x16x32_bf16 a[64:67], v[96:99], v[72:75], a[64:67]
ds_read_b64_tr_b16 v[168:169], v19 offset:49152
v_mfma_f32_16x16x32_bf16 a[68:71], v[100:103], v[72:75], a[68:71]
v_mfma_f32_16x16x32_bf16 a[72:75], v[104:107], v[72:75], a[72:75]
v_mfma_f32_16x16x32_bf16 a[76:79], v[108:111], v[72:75], a[76:79]
ds_read_b64_tr_b16 v[170:171], v19 offset:51200
v_mfma_f32_16x16x32_bf16 a[80:83], v[112:115], v[72:75], a[80:83]
v_mfma_f32_16x16x32_bf16 a[84:87], v[116:119], v[72:75], a[84:87]
ds_read_b128 v[140:143], v10 offset:37888
v_mfma_f32_16x16x32_bf16 a[88:91], v[120:123], v[72:75], a[88:91]
buffer_load_dwordx4 v13, s[12:15], s66 offen offset:1024 lds
v_mfma_f32_16x16x32_bf16 a[92:95], v[124:127], v[72:75], a[92:95]
ds_read_b64_tr_b16 v[172:173], v20 offset:49152
v_mfma_f32_16x16x32_bf16 a[96:99], v[96:99], v[76:79], a[96:99]
v_mfma_f32_16x16x32_bf16 a[100:103], v[100:103], v[76:79], a[100:103]
ds_read_b64_tr_b16 v[174:175], v20 offset:51200
v_mfma_f32_16x16x32_bf16 a[104:107], v[104:107], v[76:79], a[104:107]
v_mfma_f32_16x16x32_bf16 a[108:111], v[108:111], v[76:79], a[108:111]
v_mfma_f32_16x16x32_bf16 a[112:115], v[112:115], v[76:79], a[112:115]
ds_read_b128 v[144:147], v10 offset:40960
buffer_load_dwordx4 v14, s[12:15], s66 offen offset:2048 lds
v_mfma_f32_16x16x32_bf16 a[116:119], v[116:119], v[76:79], a[116:119]
v_mfma_f32_16x16x32_bf16 a[120:123], v[120:123], v[76:79], a[120:123]
ds_read_b64_tr_b16 v[176:177], v21 offset:49152
v_mfma_f32_16x16x32_bf16 a[124:127], v[124:127], v[76:79], a[124:127]
v_mfma_f32_16x16x32_bf16 a[128:131], v[96:99], v[80:83], a[128:131]
ds_read_b64_tr_b16 v[178:179], v21 offset:51200
v_mfma_f32_16x16x32_bf16 a[132:135], v[100:103], v[80:83], a[132:135]
v_mfma_f32_16x16x32_bf16 a[136:139], v[104:107], v[80:83], a[136:139]
ds_read_b128 v[148:151], v10 offset:41984
v_mfma_f32_16x16x32_bf16 a[140:143], v[108:111], v[80:83], a[140:143]
buffer_load_dwordx4 v15, s[12:15], s66 offen offset:3072 lds
v_mfma_f32_16x16x32_bf16 a[144:147], v[112:115], v[80:83], a[144:147]
v_mfma_f32_16x16x32_bf16 a[148:151], v[116:119], v[80:83], a[148:151]
ds_read_b64_tr_b16 v[180:181], v22 offset:49152
v_mfma_f32_16x16x32_bf16 a[152:155], v[120:123], v[80:83], a[152:155]
v_mfma_f32_16x16x32_bf16 a[156:159], v[124:127], v[80:83], a[156:159]
ds_read_b64_tr_b16 v[182:183], v22 offset:51200
v_mfma_f32_16x16x32_bf16 a[160:163], v[96:99], v[84:87], a[160:163]
v_mfma_f32_16x16x32_bf16 a[164:167], v[100:103], v[84:87], a[164:167]
ds_read_b128 v[152:155], v10 offset:45056
v_mfma_f32_16x16x32_bf16 a[168:171], v[104:107], v[84:87], a[168:171]
s_add_u32 s66, s66, 262144
v_mfma_f32_16x16x32_bf16 a[172:175], v[108:111], v[84:87], a[172:175]
ds_read_b64_tr_b16 v[184:185], v23 offset:49152
v_mfma_f32_16x16x32_bf16 a[176:179], v[112:115], v[84:87], a[176:179]
v_mfma_f32_16x16x32_bf16 a[180:183], v[116:119], v[84:87], a[180:183]
v_mfma_f32_16x16x32_bf16 a[184:187], v[120:123], v[84:87], a[184:187]
ds_read_b64_tr_b16 v[186:187], v23 offset:51200
v_mfma_f32_16x16x32_bf16 a[188:191], v[124:127], v[84:87], a[188:191]
v_mfma_f32_16x16x32_bf16 a[192:195], v[96:99], v[88:91], a[192:195]
ds_read_b128 v[156:159], v10 offset:46080
v_mfma_f32_16x16x32_bf16 a[196:199], v[100:103], v[88:91], a[196:199]
v_mfma_f32_16x16x32_bf16 a[200:203], v[104:107], v[88:91], a[200:203]
ds_read_b64_tr_b16 v[188:189], v24 offset:49152
v_mfma_f32_16x16x32_bf16 a[204:207], v[108:111], v[88:91], a[204:207]
buffer_load_dwordx4 v[32:35], v25, s[20:23], 0 offen
buffer_load_dwordx4 v[36:39], v25, s[20:23], 0 offen offset:16
v_mfma_f32_16x16x32_bf16 a[208:211], v[112:115], v[88:91], a[208:211]
ds_read_b64_tr_b16 v[190:191], v24 offset:51200
buffer_load_dword v248, v247, s[28:31], 0 offen
v_mfma_f32_16x16x32_bf16 a[212:215], v[116:119], v[88:91], a[212:215]
v_mfma_f32_16x16x32_bf16 a[216:219], v[120:123], v[88:91], a[216:219]
v_mfma_f32_16x16x32_bf16 a[220:223], v[124:127], v[88:91], a[220:223]
v_mfma_f32_16x16x32_bf16 a[224:227], v[96:99], v[92:95], a[224:227]
v_mfma_f32_16x16x32_bf16 a[228:231], v[100:103], v[92:95], a[228:231]
v_mfma_f32_16x16x32_bf16 a[232:235], v[104:107], v[92:95], a[232:235]
v_mfma_f32_16x16x32_bf16 a[236:239], v[108:111], v[92:95], a[236:239]
v_mfma_f32_16x16x32_bf16 a[240:243], v[112:115], v[92:95], a[240:243]
v_mfma_f32_16x16x32_bf16 a[244:247], v[116:119], v[92:95], a[244:247]
v_mfma_f32_16x16x32_bf16 a[248:251], v[120:123], v[92:95], a[248:251]
v_mfma_f32_16x16x32_bf16 a[252:255], v[124:127], v[92:95], a[252:255]
s_waitcnt lgkmcnt(0)
v_mfma_f32_16x16x32_bf16 a[0:3], v[160:163], v[128:131], a[0:3]
s_waitcnt vmcnt(11)
s_barrier
v_mfma_f32_16x16x32_bf16 a[4:7], v[164:167], v[128:131], a[4:7]
ds_read_b128 v[64:67], v16
v_mfma_f32_16x16x32_bf16 a[8:11], v[168:171], v[128:131], a[8:11]
s_add_u32 m0, s63, 32768
v_mfma_f32_16x16x32_bf16 a[12:15], v[172:175], v[128:131], a[12:15]
ds_read_b64_tr_b16 v[96:97], v17
s_add_u32 s62, s65, 0
v_mfma_f32_16x16x32_bf16 a[16:19], v[176:179], v[128:131], a[16:19]
v_mfma_f32_16x16x32_bf16 a[20:23], v[180:183], v[128:131], a[20:23]
ds_read_b64_tr_b16 v[98:99], v17 offset:2048
buffer_load_dwordx4 v8, s[8:11], s62 offen lds
v_mfma_f32_16x16x32_bf16 a[24:27], v[184:187], v[128:131], a[24:27]
v_mfma_f32_16x16x32_bf16 a[28:31], v[188:191], v[128:131], a[28:31]
ds_read_b128 v[68:71], v16 offset:1024
s_add_u32 s62, s65, 15360
v_mfma_f32_16x16x32_bf16 a[32:35], v[160:163], v[132:135], a[32:35]
v_mfma_f32_16x16x32_bf16 a[36:39], v[164:167], v[132:135], a[36:39]
buffer_load_dwordx4 v8, s[8:11], s62 offen offset:1024 lds
v_mfma_f32_16x16x32_bf16 a[40:43], v[168:171], v[132:135], a[40:43]
ds_read_b64_tr_b16 v[100:101], v18
v_mfma_f32_16x16x32_bf16 a[44:47], v[172:175], v[132:135], a[44:47]
s_add_u32 s62, s65, 30720
v_mfma_f32_16x16x32_bf16 a[48:51], v[176:179], v[132:135], a[48:51]
ds_read_b64_tr_b16 v[102:103], v18 offset:2048
buffer_load_dwordx4 v9, s[8:11], s62 offen offset:2048 lds
v_mfma_f32_16x16x32_bf16 a[52:55], v[180:183], v[132:135], a[52:55]
v_mfma_f32_16x16x32_bf16 a[56:59], v[184:187], v[132:135], a[56:59]
ds_read_b128 v[72:75], v16 offset:4096
s_add_u32 s62, s65, 46080
v_mfma_f32_16x16x32_bf16 a[60:63], v[188:191], v[132:135], a[60:63]
v_mfma_f32_16x16x32_bf16 a[64:67], v[160:163], v[136:139], a[64:67]
ds_read_b64_tr_b16 v[104:105], v19
buffer_load_dwordx4 v9, s[8:11], s62 offen offset:3072 lds
v_mfma_f32_16x16x32_bf16 a[68:71], v[164:167], v[136:139], a[68:71]
v_mfma_f32_16x16x32_bf16 a[72:75], v[168:171], v[136:139], a[72:75]
s_add_u32 m0, s63, 36864
v_mfma_f32_16x16x32_bf16 a[76:79], v[172:175], v[136:139], a[76:79]
ds_read_b64_tr_b16 v[106:107], v19 offset:2048
v_mfma_f32_16x16x32_bf16 a[80:83], v[176:179], v[136:139], a[80:83]
s_add_u32 s62, s65, 65536
v_mfma_f32_16x16x32_bf16 a[84:87], v[180:183], v[136:139], a[84:87]
ds_read_b128 v[76:79], v16 offset:5120
buffer_load_dwordx4 v8, s[8:11], s62 offen lds
v_mfma_f32_16x16x32_bf16 a[88:91], v[184:187], v[136:139], a[88:91]
v_mfma_f32_16x16x32_bf16 a[92:95], v[188:191], v[136:139], a[92:95]
ds_read_b64_tr_b16 v[108:109], v20
s_add_u32 s62, s65, 80896
v_mfma_f32_16x16x32_bf16 a[96:99], v[160:163], v[140:143], a[96:99]
v_mfma_f32_16x16x32_bf16 a[100:103], v[164:167], v[140:143], a[100:103]
ds_read_b64_tr_b16 v[110:111], v20 offset:2048
buffer_load_dwordx4 v8, s[8:11], s62 offen offset:1024 lds
v_mfma_f32_16x16x32_bf16 a[104:107], v[168:171], v[140:143], a[104:107]
v_mfma_f32_16x16x32_bf16 a[108:111], v[172:175], v[140:143], a[108:111]
s_add_u32 s62, s65, 96256
v_mfma_f32_16x16x32_bf16 a[112:115], v[176:179], v[140:143], a[112:115]
ds_read_b128 v[80:83], v16 offset:8192
v_mfma_f32_16x16x32_bf16 a[116:119], v[180:183], v[140:143], a[116:119]
buffer_load_dwordx4 v9, s[8:11], s62 offen offset:2048 lds
v_mfma_f32_16x16x32_bf16 a[120:123], v[184:187], v[140:143], a[120:123]
ds_read_b64_tr_b16 v[112:113], v21
s_add_u32 s62, s65, 111616
v_mfma_f32_16x16x32_bf16 a[124:127], v[188:191], v[140:143], a[124:127]
v_mfma_f32_16x16x32_bf16 a[128:131], v[160:163], v[144:147], a[128:131]
ds_read_b64_tr_b16 v[114:115], v21 offset:2048
buffer_load_dwordx4 v9, s[8:11], s62 offen offset:3072 lds
v_mfma_f32_16x16x32_bf16 a[132:135], v[164:167], v[144:147], a[132:135]
v_mfma_f32_16x16x32_bf16 a[136:139], v[168:171], v[144:147], a[136:139]
ds_read_b128 v[84:87], v16 offset:9216
s_add_u32 s65, s65, 128
v_mfma_f32_16x16x32_bf16 a[140:143], v[172:175], v[144:147], a[140:143]
v_mfma_f32_16x16x32_bf16 a[144:147], v[176:179], v[144:147], a[144:147]
s_add_u32 m0, s64, 114688
v_mfma_f32_16x16x32_bf16 a[148:151], v[180:183], v[144:147], a[148:151]
ds_read_b64_tr_b16 v[116:117], v22
v_mfma_f32_16x16x32_bf16 a[152:155], v[184:187], v[144:147], a[152:155]
s_nop 0
v_mfma_f32_16x16x32_bf16 a[156:159], v[188:191], v[144:147], a[156:159]
ds_read_b64_tr_b16 v[118:119], v22 offset:2048
buffer_load_dwordx4 v12, s[12:15], s66 offen lds
v_mfma_f32_16x16x32_bf16 a[160:163], v[160:163], v[148:151], a[160:163]
v_mfma_f32_16x16x32_bf16 a[164:167], v[164:167], v[148:151], a[164:167]
ds_read_b128 v[88:91], v16 offset:12288
buffer_load_dwordx4 v13, s[12:15], s66 offen offset:1024 lds
v_mfma_f32_16x16x32_bf16 a[168:171], v[168:171], v[148:151], a[168:171]
v_mfma_f32_16x16x32_bf16 a[172:175], v[172:175], v[148:151], a[172:175]
ds_read_b64_tr_b16 v[120:121], v23
buffer_load_dwordx4 v14, s[12:15], s66 offen offset:2048 lds
v_mfma_f32_16x16x32_bf16 a[176:179], v[176:179], v[148:151], a[176:179]
v_mfma_f32_16x16x32_bf16 a[180:183], v[180:183], v[148:151], a[180:183]
buffer_load_dwordx4 v15, s[12:15], s66 offen offset:3072 lds
v_mfma_f32_16x16x32_bf16 a[184:187], v[184:187], v[148:151], a[184:187]
ds_read_b64_tr_b16 v[122:123], v23 offset:2048
v_mfma_f32_16x16x32_bf16 a[188:191], v[188:191], v[148:151], a[188:191]
s_add_u32 s66, s66, 262144
v_mfma_f32_16x16x32_bf16 a[192:195], v[160:163], v[152:155], a[192:195]
ds_read_b128 v[92:95], v16 offset:13312
v_mfma_f32_16x16x32_bf16 a[196:199], v[164:167], v[152:155], a[196:199]
v_mfma_f32_16x16x32_bf16 a[200:203], v[168:171], v[152:155], a[200:203]
ds_read_b64_tr_b16 v[124:125], v24
v_add_u32 v242, 0x100000, v242
global_load_dword v245, v242, s[98:99]
v_mfma_f32_16x16x32_bf16 a[204:207], v[172:175], v[152:155], a[204:207]
v_mfma_f32_16x16x32_bf16 a[208:211], v[176:179], v[152:155], a[208:211]
ds_read_b64_tr_b16 v[126:127], v24 offset:2048
v_mfma_f32_16x16x32_bf16 a[212:215], v[180:183], v[152:155], a[212:215]
v_mfma_f32_16x16x32_bf16 a[216:219], v[184:187], v[152:155], a[216:219]
v_mfma_f32_16x16x32_bf16 a[220:223], v[188:191], v[152:155], a[220:223]
v_mfma_f32_16x16x32_bf16 a[224:227], v[160:163], v[156:159], a[224:227]
v_mfma_f32_16x16x32_bf16 a[228:231], v[164:167], v[156:159], a[228:231]
v_mfma_f32_16x16x32_bf16 a[232:235], v[168:171], v[156:159], a[232:235]
v_mfma_f32_16x16x32_bf16 a[236:239], v[172:175], v[156:159], a[236:239]
v_mfma_f32_16x16x32_bf16 a[240:243], v[176:179], v[156:159], a[240:243]
v_mfma_f32_16x16x32_bf16 a[244:247], v[180:183], v[156:159], a[244:247]
v_mfma_f32_16x16x32_bf16 a[248:251], v[184:187], v[156:159], a[248:251]
v_mfma_f32_16x16x32_bf16 a[252:255], v[188:191], v[156:159], a[252:255]
s_waitcnt lgkmcnt(0)
v_mfma_f32_16x16x32_bf16 a[0:3], v[96:99], v[64:67], a[0:3]
s_waitcnt vmcnt(20)
s_barrier
v_mfma_f32_16x16x32_bf16 a[4:7], v[100:103], v[64:67], a[4:7]
ds_read_b128 v[128:131], v10
v_mfma_f32_16x16x32_bf16 a[8:11], v[104:107], v[64:67], a[8:11]
s_add_u32 m0, s64, 65536
v_mfma_f32_16x16x32_bf16 a[12:15], v[108:111], v[64:67], a[12:15]
ds_read_b64_tr_b16 v[160:161], v17 offset:16384
v_mfma_f32_16x16x32_bf16 a[16:19], v[112:115], v[64:67], a[16:19]
v_mfma_f32_16x16x32_bf16 a[20:23], v[116:119], v[64:67], a[20:23]
ds_read_b64_tr_b16 v[162:163], v17 offset:18432
v_mfma_f32_16x16x32_bf16 a[24:27], v[120:123], v[64:67], a[24:27]
v_mfma_f32_16x16x32_bf16 a[28:31], v[124:127], v[64:67], a[28:31]
ds_read_b128 v[132:135], v10 offset:1024
v_mfma_f32_16x16x32_bf16 a[32:35], v[96:99], v[68:71], a[32:35]
s_nop 0
v_mfma_f32_16x16x32_bf16 a[36:39], v[100:103], v[68:71], a[36:39]
v_mfma_f32_16x16x32_bf16 a[40:43], v[104:107], v[68:71], a[40:43]
ds_read_b64_tr_b16 v[164:165], v18 offset:16384
v_mfma_f32_16x16x32_bf16 a[44:47], v[108:111], v[68:71], a[44:47]
v_mfma_f32_16x16x32_bf16 a[48:51], v[112:115], v[68:71], a[48:51]
ds_read_b64_tr_b16 v[166:167], v18 offset:18432
v_mfma_f32_16x16x32_bf16 a[52:55], v[116:119], v[68:71], a[52:55]
v_mfma_f32_16x16x32_bf16 a[56:59], v[120:123], v[68:71], a[56:59]
ds_read_b128 v[136:139], v10 offset:4096
v_mfma_f32_16x16x32_bf16 a[60:63], v[124:127], v[68:71], a[60:63]
buffer_load_dwordx4 v12, s[12:15], s66 offen lds
v_mfma_f32_16x16x32_bf16 a[64:67], v[96:99], v[72:75], a[64:67]
ds_read_b64_tr_b16 v[168:169], v19 offset:16384
v_mfma_f32_16x16x32_bf16 a[68:71], v[100:103], v[72:75], a[68:71]
v_mfma_f32_16x16x32_bf16 a[72:75], v[104:107], v[72:75], a[72:75]
v_mfma_f32_16x16x32_bf16 a[76:79], v[108:111], v[72:75], a[76:79]
ds_read_b64_tr_b16 v[170:171], v19 offset:18432
v_mfma_f32_16x16x32_bf16 a[80:83], v[112:115], v[72:75], a[80:83]
v_mfma_f32_16x16x32_bf16 a[84:87], v[116:119], v[72:75], a[84:87]
ds_read_b128 v[140:143], v10 offset:5120
v_mfma_f32_16x16x32_bf16 a[88:91], v[120:123], v[72:75], a[88:91]
buffer_load_dwordx4 v13, s[12:15], s66 offen offset:1024 lds
v_mfma_f32_16x16x32_bf16 a[92:95], v[124:127], v[72:75], a[92:95]
ds_read_b64_tr_b16 v[172:173], v20 offset:16384
v_mfma_f32_16x16x32_bf16 a[96:99], v[96:99], v[76:79], a[96:99]
v_mfma_f32_16x16x32_bf16 a[100:103], v[100:103], v[76:79], a[100:103]
ds_read_b64_tr_b16 v[174:175], v20 offset:18432
v_mfma_f32_16x16x32_bf16 a[104:107], v[104:107], v[76:79], a[104:107]
v_mfma_f32_16x16x32_bf16 a[108:111], v[108:111], v[76:79], a[108:111]
v_mfma_f32_16x16x32_bf16 a[112:115], v[112:115], v[76:79], a[112:115]
ds_read_b128 v[144:147], v10 offset:8192
buffer_load_dwordx4 v14, s[12:15], s66 offen offset:2048 lds
v_mfma_f32_16x16x32_bf16 a[116:119], v[116:119], v[76:79], a[116:119]
v_mfma_f32_16x16x32_bf16 a[120:123], v[120:123], v[76:79], a[120:123]
ds_read_b64_tr_b16 v[176:177], v21 offset:16384
v_mfma_f32_16x16x32_bf16 a[124:127], v[124:127], v[76:79], a[124:127]
v_mfma_f32_16x16x32_bf16 a[128:131], v[96:99], v[80:83], a[128:131]
ds_read_b64_tr_b16 v[178:179], v21 offset:18432
v_mfma_f32_16x16x32_bf16 a[132:135], v[100:103], v[80:83], a[132:135]
v_mfma_f32_16x16x32_bf16 a[136:139], v[104:107], v[80:83], a[136:139]
ds_read_b128 v[148:151], v10 offset:9216
v_mfma_f32_16x16x32_bf16 a[140:143], v[108:111], v[80:83], a[140:143]
buffer_load_dwordx4 v15, s[12:15], s66 offen offset:3072 lds
v_mfma_f32_16x16x32_bf16 a[144:147], v[112:115], v[80:83], a[144:147]
v_mfma_f32_16x16x32_bf16 a[148:151], v[116:119], v[80:83], a[148:151]
ds_read_b64_tr_b16 v[180:181], v22 offset:16384
v_mfma_f32_16x16x32_bf16 a[152:155], v[120:123], v[80:83], a[152:155]
v_mfma_f32_16x16x32_bf16 a[156:159], v[124:127], v[80:83], a[156:159]
ds_read_b64_tr_b16 v[182:183], v22 offset:18432
v_mfma_f32_16x16x32_bf16 a[160:163], v[96:99], v[84:87], a[160:163]
v_mfma_f32_16x16x32_bf16 a[164:167], v[100:103], v[84:87], a[164:167]
ds_read_b128 v[152:155], v10 offset:12288
v_mfma_f32_16x16x32_bf16 a[168:171], v[104:107], v[84:87], a[168:171]
s_add_u32 s66, s66, 262144
v_mfma_f32_16x16x32_bf16 a[172:175], v[108:111], v[84:87], a[172:175]
ds_read_b64_tr_b16 v[184:185], v23 offset:16384
v_mfma_f32_16x16x32_bf16 a[176:179], v[112:115], v[84:87], a[176:179]
v_mfma_f32_16x16x32_bf16 a[180:183], v[116:119], v[84:87], a[180:183]
v_mfma_f32_16x16x32_bf16 a[184:187], v[120:123], v[84:87], a[184:187]
ds_read_b64_tr_b16 v[186:187], v23 offset:18432
v_mfma_f32_16x16x32_bf16 a[188:191], v[124:127], v[84:87], a[188:191]
v_mfma_f32_16x16x32_bf16 a[192:195], v[96:99], v[88:91], a[192:195]
ds_read_b128 v[156:159], v10 offset:13312
v_mfma_f32_16x16x32_bf16 a[196:199], v[100:103], v[88:91], a[196:199]
v_mfma_f32_16x16x32_bf16 a[200:203], v[104:107], v[88:91], a[200:203]
ds_read_b64_tr_b16 v[188:189], v24 offset:16384
v_mfma_f32_16x16x32_bf16 a[204:207], v[108:111], v[88:91], a[204:207]
v_mfma_f32_16x16x32_bf16 a[208:211], v[112:115], v[88:91], a[208:211]
ds_read_b64_tr_b16 v[190:191], v24 offset:18432
buffer_load_dword v248, v247, s[28:31], 0 offen offset:2048
v_mfma_f32_16x16x32_bf16 a[212:215], v[116:119], v[88:91], a[212:215]
v_mfma_f32_16x16x32_bf16 a[216:219], v[120:123], v[88:91], a[216:219]
v_mfma_f32_16x16x32_bf16 a[220:223], v[124:127], v[88:91], a[220:223]
v_mfma_f32_16x16x32_bf16 a[224:227], v[96:99], v[92:95], a[224:227]
v_mfma_f32_16x16x32_bf16 a[228:231], v[100:103], v[92:95], a[228:231]
v_mfma_f32_16x16x32_bf16 a[232:235], v[104:107], v[92:95], a[232:235]
v_mfma_f32_16x16x32_bf16 a[236:239], v[108:111], v[92:95], a[236:239]
v_mfma_f32_16x16x32_bf16 a[240:243], v[112:115], v[92:95], a[240:243]
v_mfma_f32_16x16x32_bf16 a[244:247], v[116:119], v[92:95], a[244:247]
v_mfma_f32_16x16x32_bf16 a[248:251], v[120:123], v[92:95], a[248:251]
v_mfma_f32_16x16x32_bf16 a[252:255], v[124:127], v[92:95], a[252:255]
s_waitcnt lgkmcnt(0)
v_mfma_f32_16x16x32_bf16 a[0:3], v[160:163], v[128:131], a[0:3]
s_waitcnt vmcnt(10)
s_barrier
s_or_b32 s56, s2, s3
s_cbranch_scc1 RDBG_1
s_mov_b64 exec, 1
global_store_dword v29, v30, s[92:93] sc1
s_mov_b64 exec, -1
RDBG_1:
v_mfma_f32_16x16x32_bf16 a[4:7], v[164:167], v[128:131], a[4:7]
ds_read_b128 v[64:67], v16 offset:32768
s_waitcnt vmcnt(19)
v_mfma_f32_16x16x32_bf16 a[8:11], v[168:171], v[128:131], a[8:11]
s_add_u32 m0, s63, 0
v_lshlrev_b32 v40, 16, v32
v_mfma_f32_16x16x32_bf16 a[12:15], v[172:175], v[128:131], a[12:15]
ds_read_b64_tr_b16 v[96:97], v17 offset:32768
s_add_u32 s62, s65, 0
v_mfma_f32_16x16x32_bf16 a[16:19], v[176:179], v[128:131], a[16:19]
v_and_b32 v41, 0xffff0000, v32
v_lshlrev_b32 v42, 16, v33
v_mfma_f32_16x16x32_bf16 a[20:23], v[180:183], v[128:131], a[20:23]
ds_read_b64_tr_b16 v[98:99], v17 offset:34816
buffer_load_dwordx4 v8, s[8:11], s62 offen lds
v_mfma_f32_16x16x32_bf16 a[24:27], v[184:187], v[128:131], a[24:27]
v_and_b32 v43, 0xffff0000, v33
v_lshlrev_b32 v44, 16, v34
v_mfma_f32_16x16x32_bf16 a[28:31], v[188:191], v[128:131], a[28:31]
ds_read_b128 v[68:71], v16 offset:33792
s_add_u32 s62, s65, 15360
v_mfma_f32_16x16x32_bf16 a[32:35], v[160:163], v[132:135], a[32:35]
v_and_b32 v45, 0xffff0000, v34
v_lshlrev_b32 v46, 16, v35
v_mfma_f32_16x16x32_bf16 a[36:39], v[164:167], v[132:135], a[36:39]
buffer_load_dwordx4 v8, s[8:11], s62 offen offset:1024 lds
v_and_b32 v47, 0xffff0000, v35
v_mfma_f32_16x16x32_bf16 a[40:43], v[168:171], v[132:135], a[40:43]
ds_read_b64_tr_b16 v[100:101], v18 offset:32768
v_lshlrev_b32 v48, 16, v36
v_mfma_f32_16x16x32_bf16 a[44:47], v[172:175], v[132:135], a[44:47]
s_add_u32 s62, s65, 30720
v_and_b32 v49, 0xffff0000, v36
v_mfma_f32_16x16x32_bf16 a[48:51], v[176:179], v[132:135], a[48:51]
ds_read_b64_tr_b16 v[102:103], v18 offset:34816
buffer_load_dwordx4 v9, s[8:11], s62 offen offset:2048 lds
v_mfma_f32_16x16x32_bf16 a[52:55], v[180:183], v[132:135], a[52:55]
v_lshlrev_b32 v50, 16, v37
v_and_b32 v51, 0xffff0000, v37
v_mfma_f32_16x16x32_bf16 a[56:59], v[184:187], v[132:135], a[56:59]
ds_read_b128 v[72:75], v16 offset:36864
s_add_u32 s62, s65, 46080
v_mfma_f32_16x16x32_bf16 a[60:63], v[188:191], v[132:135], a[60:63]
v_lshlrev_b32 v52, 16, v38
v_and_b32 v53, 0xffff0000, v38
v_mfma_f32_16x16x32_bf16 a[64:67], v[160:163], v[136:139], a[64:67]
ds_read_b64_tr_b16 v[104:105], v19 offset:32768
buffer_load_dwordx4 v9, s[8:11], s62 offen offset:3072 lds
v_mfma_f32_16x16x32_bf16 a[68:71], v[164:167], v[136:139], a[68:71]
v_lshlrev_b32 v54, 16, v39
v_and_b32 v55, 0xffff0000, v39
v_mfma_f32_16x16x32_bf16 a[72:75], v[168:171], v[136:139], a[72:75]
s_add_u32 m0, s63, 4096
v_add_f32 v56, v40, v41
v_mfma_f32_16x16x32_bf16 a[76:79], v[172:175], v[136:139], a[76:79]
ds_read_b64_tr_b16 v[106:107], v19 offset:34816
v_add_f32 v56, v56, v42
v_mfma_f32_16x16x32_bf16 a[80:83], v[176:179], v[136:139], a[80:83]
s_add_u32 s62, s65, 65536
v_add_f32 v56, v56, v43
v_mfma_f32_16x16x32_bf16 a[84:87], v[180:183], v[136:139], a[84:87]
ds_read_b128 v[76:79], v16 offset:37888
buffer_load_dwordx4 v8, s[8:11], s62 offen lds
v_mfma_f32_16x16x32_bf16 a[88:91], v[184:187], v[136:139], a[88:91]
v_add_f32 v56, v56, v44
v_add_f32 v56, v56, v45
v_mfma_f32_16x16x32_bf16 a[92:95], v[188:191], v[136:139], a[92:95]
ds_read_b64_tr_b16 v[108:109], v20 offset:32768
s_add_u32 s62, s65, 80896
v_mfma_f32_16x16x32_bf16 a[96:99], v[160:163], v[140:143], a[96:99]
v_add_f32 v56, v56, v46
v_add_f32 v56, v56, v47
v_mfma_f32_16x16x32_bf16 a[100:103], v[164:167], v[140:143], a[100:103]
ds_read_b64_tr_b16 v[110:111], v20 offset:34816
buffer_load_dwordx4 v8, s[8:11], s62 offen offset:1024 lds
v_mfma_f32_16x16x32_bf16 a[104:107], v[168:171], v[140:143], a[104:107]
v_add_f32 v56, v56, v48
v_add_f32 v56, v56, v49
v_mfma_f32_16x16x32_bf16 a[108:111], v[172:175], v[140:143], a[108:111]
s_add_u32 s62, s65, 96256
v_add_f32 v56, v56, v50
v_mfma_f32_16x16x32_bf16 a[112:115], v[176:179], v[140:143], a[112:115]
ds_read_b128 v[80:83], v16 offset:40960
v_add_f32 v56, v56, v51
v_mfma_f32_16x16x32_bf16 a[116:119], v[180:183], v[140:143], a[116:119]
buffer_load_dwordx4 v9, s[8:11], s62 offen offset:2048 lds
v_add_f32 v56, v56, v52
v_mfma_f32_16x16x32_bf16 a[120:123], v[184:187], v[140:143], a[120:123]
ds_read_b64_tr_b16 v[112:113], v21 offset:32768
s_add_u32 s62, s65, 111616
v_mfma_f32_16x16x32_bf16 a[124:127], v[188:191], v[140:143], a[124:127]
v_add_f32 v56, v56, v53
v_add_f32 v56, v56, v54
v_mfma_f32_16x16x32_bf16 a[128:131], v[160:163], v[144:147], a[128:131]
ds_read_b64_tr_b16 v[114:115], v21 offset:34816
buffer_load_dwordx4 v9, s[8:11], s62 offen offset:3072 lds
v_mfma_f32_16x16x32_bf16 a[132:135], v[164:167], v[144:147], a[132:135]
v_add_f32 v56, v56, v55
s_nop 1
v_mfma_f32_16x16x32_bf16 a[136:139], v[168:171], v[144:147], a[136:139]
ds_read_b128 v[84:87], v16 offset:41984
s_add_u32 s65, s65, 128
v_mfma_f32_16x16x32_bf16 a[140:143], v[172:175], v[144:147], a[140:143]
v_add_f32_dpp v56, v56, v56 quad_perm:[1,0,3,2] row_mask:0xf bank_mask:0xf
s_nop 1
v_mfma_f32_16x16x32_bf16 a[144:147], v[176:179], v[144:147], a[144:147]
s_add_u32 m0, s64, 81920
v_add_f32_dpp v56, v56, v56 quad_perm:[2,3,0,1] row_mask:0xf bank_mask:0xf
v_mfma_f32_16x16x32_bf16 a[148:151], v[180:183], v[144:147], a[148:151]
ds_read_b64_tr_b16 v[116:117], v22 offset:32768
s_nop 1
v_mfma_f32_16x16x32_bf16 a[152:155], v[184:187], v[144:147], a[152:155]
s_nop 0
v_add_f32_dpp v56, v56, v56 row_half_mirror row_mask:0xf bank_mask:0xf
v_mfma_f32_16x16x32_bf16 a[156:159], v[188:191], v[144:147], a[156:159]
ds_read_b64_tr_b16 v[118:119], v22 offset:34816
buffer_load_dwordx4 v12, s[12:15], s66 offen lds
v_mfma_f32_16x16x32_bf16 a[160:163], v[160:163], v[148:151], a[160:163]
s_nop 1
v_add_f32_dpp v56, v56, v56 row_mirror row_mask:0xf bank_mask:0xf
v_mfma_f32_16x16x32_bf16 a[164:167], v[164:167], v[148:151], a[164:167]
ds_read_b128 v[88:91], v16 offset:45056
buffer_load_dwordx4 v13, s[12:15], s66 offen offset:1024 lds
v_mfma_f32_16x16x32_bf16 a[168:171], v[168:171], v[148:151], a[168:171]
v_mov_b32 v57, v56
s_nop 1
v_mfma_f32_16x16x32_bf16 a[172:175], v[172:175], v[148:151], a[172:175]
ds_read_b64_tr_b16 v[120:121], v23 offset:32768
buffer_load_dwordx4 v14, s[12:15], s66 offen offset:2048 lds
v_mfma_f32_16x16x32_bf16 a[176:179], v[176:179], v[148:151], a[176:179]
v_permlane16_swap_b32 v56, v57
v_add_f32 v56, v56, v57
v_mfma_f32_16x16x32_bf16 a[180:183], v[180:183], v[148:151], a[180:183]
buffer_load_dwordx4 v15, s[12:15], s66 offen offset:3072 lds
v_mul_f32 v56, 0x3b124925, v56
v_mfma_f32_16x16x32_bf16 a[184:187], v[184:187], v[148:151], a[184:187]
ds_read_b64_tr_b16 v[122:123], v23 offset:34816
v_mov_b32 v58, 0
v_mfma_f32_16x16x32_bf16 a[188:191], v[188:191], v[148:151], a[188:191]
s_add_u32 s66, s66, 262144
v_sub_f32 v57, v40, v56
v_mfma_f32_16x16x32_bf16 a[192:195], v[160:163], v[152:155], a[192:195]
ds_read_b128 v[92:95], v16 offset:46080
v_fmac_f32 v58, v57, v57
v_mfma_f32_16x16x32_bf16 a[196:199], v[164:167], v[152:155], a[196:199]
v_sub_f32 v57, v41, v56
v_fmac_f32 v58, v57, v57
v_mfma_f32_16x16x32_bf16 a[200:203], v[168:171], v[152:155], a[200:203]
ds_read_b64_tr_b16 v[124:125], v24 offset:32768
v_sub_f32 v57, v42, v56
v_mfma_f32_16x16x32_bf16 a[204:207], v[172:175], v[152:155], a[204:207]
v_fmac_f32 v58, v57, v57
v_sub_f32 v57, v43, v56
v_mfma_f32_16x16x32_bf16 a[208:211], v[176:179], v[152:155], a[208:211]
ds_read_b64_tr_b16 v[126:127], v24 offset:34816
v_fmac_f32 v58, v57, v57
v_mfma_f32_16x16x32_bf16 a[212:215], v[180:183], v[152:155], a[212:215]
v_sub_f32 v57, v44, v56
v_fmac_f32 v58, v57, v57
v_mfma_f32_16x16x32_bf16 a[216:219], v[184:187], v[152:155], a[216:219]
v_sub_f32 v57, v45, v56
v_fmac_f32 v58, v57, v57
v_mfma_f32_16x16x32_bf16 a[220:223], v[188:191], v[152:155], a[220:223]
v_sub_f32 v57, v46, v56
v_fmac_f32 v58, v57, v57
v_mfma_f32_16x16x32_bf16 a[224:227], v[160:163], v[156:159], a[224:227]
v_sub_f32 v57, v47, v56
v_fmac_f32 v58, v57, v57
v_mfma_f32_16x16x32_bf16 a[228:231], v[164:167], v[156:159], a[228:231]
v_sub_f32 v57, v48, v56
v_fmac_f32 v58, v57, v57
v_mfma_f32_16x16x32_bf16 a[232:235], v[168:171], v[156:159], a[232:235]
v_sub_f32 v57, v49, v56
v_fmac_f32 v58, v57, v57
v_mfma_f32_16x16x32_bf16 a[236:239], v[172:175], v[156:159], a[236:239]
v_sub_f32 v57, v50, v56
v_fmac_f32 v58, v57, v57
v_mfma_f32_16x16x32_bf16 a[240:243], v[176:179], v[156:159], a[240:243]
v_sub_f32 v57, v51, v56
v_fmac_f32 v58, v57, v57
v_mfma_f32_16x16x32_bf16 a[244:247], v[180:183], v[156:159], a[244:247]
v_sub_f32 v57, v52, v56
v_fmac_f32 v58, v57, v57
v_mfma_f32_16x16x32_bf16 a[248:251], v[184:187], v[156:159], a[248:251]
v_sub_f32 v57, v53, v56
v_fmac_f32 v58, v57, v57
v_mfma_f32_16x16x32_bf16 a[252:255], v[188:191], v[156:159], a[252:255]
v_sub_f32 v57, v54, v56
v_fmac_f32 v58, v57, v57
s_waitcnt lgkmcnt(0)
v_mfma_f32_16x16x32_bf16 a[0:3], v[96:99], v[64:67], a[0:3]
s_waitcnt vmcnt(18)
s_barrier
v_mfma_f32_16x16x32_bf16 a[4:7], v[100:103], v[64:67], a[4:7]
ds_read_b128 v[128:131], v10 offset:32768
v_sub_f32 v57, v55, v56
v_mfma_f32_16x16x32_bf16 a[8:11], v[104:107], v[64:67], a[8:11]
s_add_u32 m0, s64, 98304
v_fmac_f32 v58, v57, v57
v_mfma_f32_16x16x32_bf16 a[12:15], v[108:111], v[64:67], a[12:15]
ds_read_b64_tr_b16 v[160:161], v17 offset:49152
v_mul_f32 v58, v58, v7
v_mfma_f32_16x16x32_bf16 a[16:19], v[112:115], v[64:67], a[16:19]
s_nop 1
v_add_f32_dpp v58, v58, v58 quad_perm:[1,0,3,2] row_mask:0xf bank_mask:0xf
v_mfma_f32_16x16x32_bf16 a[20:23], v[116:119], v[64:67], a[20:23]
ds_read_b64_tr_b16 v[162:163], v17 offset:51200
s_nop 1
v_mfma_f32_16x16x32_bf16 a[24:27], v[120:123], v[64:67], a[24:27]
v_add_f32_dpp v58, v58, v58 quad_perm:[2,3,0,1] row_mask:0xf bank_mask:0xf
s_nop 1
v_mfma_f32_16x16x32_bf16 a[28:31], v[124:127], v[64:67], a[28:31]
ds_read_b128 v[132:135], v10 offset:33792
v_add_f32_dpp v58, v58, v58 row_half_mirror row_mask:0xf bank_mask:0xf
v_mfma_f32_16x16x32_bf16 a[32:35], v[96:99], v[68:71], a[32:35]
s_nop 0
s_nop 1
v_mfma_f32_16x16x32_bf16 a[36:39], v[100:103], v[68:71], a[36:39]
v_add_f32_dpp v58, v58, v58 row_mirror row_mask:0xf bank_mask:0xf
v_mov_b32 v57, v58
v_mfma_f32_16x16x32_bf16 a[40:43], v[104:107], v[68:71], a[40:43]
ds_read_b64_tr_b16 v[164:165], v18 offset:49152
s_nop 1
v_mfma_f32_16x16x32_bf16 a[44:47], v[108:111], v[68:71], a[44:47]
v_permlane16_swap_b32 v58, v57
v_add_f32 v58, v58, v57
v_mfma_f32_16x16x32_bf16 a[48:51], v[112:115], v[68:71], a[48:51]
ds_read_b64_tr_b16 v[166:167], v18 offset:51200
v_mul_f32 v58, 0x3b124925, v58
v_mfma_f32_16x16x32_bf16 a[52:55], v[116:119], v[68:71], a[52:55]
v_cvt_pk_bf16_f32 v56, v56, v56
v_lshlrev_b32 v56, 16, v56
v_mfma_f32_16x16x32_bf16 a[56:59], v[120:123], v[68:71], a[56:59]
ds_read_b128 v[136:139], v10 offset:36864
v_cvt_pk_bf16_f32 v58, v58, v58
v_mfma_f32_16x16x32_bf16 a[60:63], v[124:127], v[68:71], a[60:63]
buffer_load_dwordx4 v12, s[12:15], s66 offen lds
v_lshlrev_b32 v58, 16, v58
v_mfma_f32_16x16x32_bf16 a[64:67], v[96:99], v[72:75], a[64:67]
ds_read_b64_tr_b16 v[168:169], v19 offset:49152
v_add_f32 v58, 0x3727c5ac, v58
v_mfma_f32_16x16x32_bf16 a[68:71], v[100:103], v[72:75], a[68:71]
v_cvt_pk_bf16_f32 v58, v58, v58
v_lshlrev_b32 v58, 16, v58
v_mfma_f32_16x16x32_bf16 a[72:75], v[104:107], v[72:75], a[72:75]
v_sqrt_f32 v58, v58
v_mfma_f32_16x16x32_bf16 a[76:79], v[108:111], v[72:75], a[76:79]
ds_read_b64_tr_b16 v[170:171], v19 offset:51200
s_nop 0
v_mfma_f32_16x16x32_bf16 a[80:83], v[112:115], v[72:75], a[80:83]
v_cvt_pk_bf16_f32 v58, v58, v58
v_lshlrev_b32 v58, 16, v58
v_mfma_f32_16x16x32_bf16 a[84:87], v[116:119], v[72:75], a[84:87]
ds_read_b128 v[140:143], v10 offset:37888
v_rcp_f32 v58, v58
v_mfma_f32_16x16x32_bf16 a[88:91], v[120:123], v[72:75], a[88:91]
buffer_load_dwordx4 v13, s[12:15], s66 offen offset:1024 lds
v_sub_f32 v40, v40, v56
v_mfma_f32_16x16x32_bf16 a[92:95], v[124:127], v[72:75], a[92:95]
ds_read_b64_tr_b16 v[172:173], v20 offset:49152
v_sub_f32 v41, v41, v56
v_mfma_f32_16x16x32_bf16 a[96:99], v[96:99], v[76:79], a[96:99]
v_sub_f32 v42, v42, v56
v_sub_f32 v43, v43, v56
v_mfma_f32_16x16x32_bf16 a[100:103], v[100:103], v[76:79], a[100:103]
ds_read_b64_tr_b16 v[174:175], v20 offset:51200
v_sub_f32 v44, v44, v56
v_mfma_f32_16x16x32_bf16 a[104:107], v[104:107], v[76:79], a[104:107]
v_sub_f32 v45, v45, v56
v_sub_f32 v46, v46, v56
v_mfma_f32_16x16x32_bf16 a[108:111], v[108:111], v[76:79], a[108:111]
v_sub_f32 v47, v47, v56
v_sub_f32 v48, v48, v56
v_mfma_f32_16x16x32_bf16 a[112:115], v[112:115], v[76:79], a[112:115]
ds_read_b128 v[144:147], v10 offset:40960
buffer_load_dwordx4 v14, s[12:15], s66 offen offset:2048 lds
v_mfma_f32_16x16x32_bf16 a[116:119], v[116:119], v[76:79], a[116:119]
v_sub_f32 v49, v49, v56
v_sub_f32 v50, v50, v56
v_mfma_f32_16x16x32_bf16 a[120:123], v[120:123], v[76:79], a[120:123]
ds_read_b64_tr_b16 v[176:177], v21 offset:49152
v_sub_f32 v51, v51, v56
v_mfma_f32_16x16x32_bf16 a[124:127], v[124:127], v[76:79], a[124:127]
v_sub_f32 v52, v52, v56
v_sub_f32 v53, v53, v56
v_mfma_f32_16x16x32_bf16 a[128:131], v[96:99], v[80:83], a[128:131]
ds_read_b64_tr_b16 v[178:179], v21 offset:51200
v_sub_f32 v54, v54, v56
v_mfma_f32_16x16x32_bf16 a[132:135], v[100:103], v[80:83], a[132:135]
v_sub_f32 v55, v55, v56
v_cvt_pk_bf16_f32 v32, v40, v41
v_mfma_f32_16x16x32_bf16 a[136:139], v[104:107], v[80:83], a[136:139]
ds_read_b128 v[148:151], v10 offset:41984
v_cvt_pk_bf16_f32 v33, v42, v43
v_mfma_f32_16x16x32_bf16 a[140:143], v[108:111], v[80:83], a[140:143]
buffer_load_dwordx4 v15, s[12:15], s66 offen offset:3072 lds
v_cvt_pk_bf16_f32 v34, v44, v45
v_mfma_f32_16x16x32_bf16 a[144:147], v[112:115], v[80:83], a[144:147]
v_cvt_pk_bf16_f32 v35, v46, v47
v_cvt_pk_bf16_f32 v36, v48, v49
v_mfma_f32_16x16x32_bf16 a[148:151], v[116:119], v[80:83], a[148:151]
ds_read_b64_tr_b16 v[180:181], v22 offset:49152
v_cvt_pk_bf16_f32 v37, v50, v51
v_mfma_f32_16x16x32_bf16 a[152:155], v[120:123], v[80:83], a[152:155]
v_cvt_pk_bf16_f32 v38, v52, v53
v_cvt_pk_bf16_f32 v39, v54, v55
v_mfma_f32_16x16x32_bf16 a[156:159], v[124:127], v[80:83], a[156:159]
ds_read_b64_tr_b16 v[182:183], v22 offset:51200
v_lshlrev_b32 v40, 16, v32
v_mfma_f32_16x16x32_bf16 a[160:163], v[96:99], v[84:87], a[160:163]
v_and_b32 v41, 0xffff0000, v32
v_lshlrev_b32 v42, 16, v33
v_mfma_f32_16x16x32_bf16 a[164:167], v[100:103], v[84:87], a[164:167]
ds_read_b128 v[152:155], v10 offset:45056
v_and_b32 v43, 0xffff0000, v33
v_mfma_f32_16x16x32_bf16 a[168:171], v[104:107], v[84:87], a[168:171]
s_add_u32 s66, s66, 262144
v_lshlrev_b32 v44, 16, v34
v_mfma_f32_16x16x32_bf16 a[172:175], v[108:111], v[84:87], a[172:175]
ds_read_b64_tr_b16 v[184:185], v23 offset:49152
v_and_b32 v45, 0xffff0000, v34
v_mfma_f32_16x16x32_bf16 a[176:179], v[112:115], v[84:87], a[176:179]
v_lshlrev_b32 v46, 16, v35
v_and_b32 v47, 0xffff0000, v35
v_mfma_f32_16x16x32_bf16 a[180:183], v[116:119], v[84:87], a[180:183]
v_lshlrev_b32 v48, 16, v36
v_and_b32 v49, 0xffff0000, v36
v_mfma_f32_16x16x32_bf16 a[184:187], v[120:123], v[84:87], a[184:187]
ds_read_b64_tr_b16 v[186:187], v23 offset:51200
v_lshlrev_b32 v50, 16, v37
v_mfma_f32_16x16x32_bf16 a[188:191], v[124:127], v[84:87], a[188:191]
v_and_b32 v51, 0xffff0000, v37
v_lshlrev_b32 v52, 16, v38
v_mfma_f32_16x16x32_bf16 a[192:195], v[96:99], v[88:91], a[192:195]
ds_read_b128 v[156:159], v10 offset:46080
v_and_b32 v53, 0xffff0000, v38
v_mfma_f32_16x16x32_bf16 a[196:199], v[100:103], v[88:91], a[196:199]
v_lshlrev_b32 v54, 16, v39
v_and_b32 v55, 0xffff0000, v39
v_mfma_f32_16x16x32_bf16 a[200:203], v[104:107], v[88:91], a[200:203]
ds_read_b64_tr_b16 v[188:189], v24 offset:49152
v_add_u32 v242, 0x100000, v242
global_load_dword v245, v242, s[98:99]
v_mfma_f32_16x16x32_bf16 a[204:207], v[108:111], v[88:91], a[204:207]
v_mul_f32 v40, v40, v58
v_mul_f32 v41, v41, v58
v_mfma_f32_16x16x32_bf16 a[208:211], v[112:115], v[88:91], a[208:211]
ds_read_b64_tr_b16 v[190:191], v24 offset:51200
v_mul_f32 v42, v42, v58
v_mfma_f32_16x16x32_bf16 a[212:215], v[116:119], v[88:91], a[212:215]
v_mul_f32 v43, v43, v58
v_mul_f32 v44, v44, v58
v_mfma_f32_16x16x32_bf16 a[216:219], v[120:123], v[88:91], a[216:219]
v_mul_f32 v45, v45, v58
v_mul_f32 v46, v46, v58
v_mfma_f32_16x16x32_bf16 a[220:223], v[124:127], v[88:91], a[220:223]
v_mul_f32 v47, v47, v58
v_mul_f32 v48, v48, v58
v_mfma_f32_16x16x32_bf16 a[224:227], v[96:99], v[92:95], a[224:227]
v_mul_f32 v49, v49, v58
v_mul_f32 v50, v50, v58
v_mfma_f32_16x16x32_bf16 a[228:231], v[100:103], v[92:95], a[228:231]
v_mul_f32 v51, v51, v58
v_mul_f32 v52, v52, v58
v_mfma_f32_16x16x32_bf16 a[232:235], v[104:107], v[92:95], a[232:235]
v_mul_f32 v53, v53, v58
v_mul_f32 v54, v54, v58
v_mfma_f32_16x16x32_bf16 a[236:239], v[108:111], v[92:95], a[236:239]
v_mul_f32 v55, v55, v58
v_cvt_pk_bf16_f32 v32, v40, v41
v_mfma_f32_16x16x32_bf16 a[240:243], v[112:115], v[92:95], a[240:243]
v_cvt_pk_bf16_f32 v33, v42, v43
v_cvt_pk_bf16_f32 v36, v44, v45
v_mfma_f32_16x16x32_bf16 a[244:247], v[116:119], v[92:95], a[244:247]
v_cvt_pk_bf16_f32 v37, v46, v47
v_cvt_pk_bf16_f32 v34, v48, v49
v_mfma_f32_16x16x32_bf16 a[248:251], v[120:123], v[92:95], a[248:251]
v_cvt_pk_bf16_f32 v35, v50, v51
v_cvt_pk_bf16_f32 v38, v52, v53
v_mfma_f32_16x16x32_bf16 a[252:255], v[124:127], v[92:95], a[252:255]
v_cvt_pk_bf16_f32 v39, v54, v55
ds_write_b128 v26, v[32:35]
s_waitcnt lgkmcnt(0)
v_mfma_f32_16x16x32_bf16 a[0:3], v[160:163], v[128:131], a[0:3]
s_waitcnt vmcnt(9)
s_barrier
v_mfma_f32_16x16x32_bf16 a[4:7], v[164:167], v[128:131], a[4:7]
ds_read_b128 v[64:67], v16
ds_write_b128 v26, v[36:39] offset:128
v_mfma_f32_16x16x32_bf16 a[8:11], v[168:171], v[128:131], a[8:11]
s_add_u32 m0, s63, 32768
v_mfma_f32_16x16x32_bf16 a[12:15], v[172:175], v[128:131], a[12:15]
ds_read_b64_tr_b16 v[96:97], v17
s_add_u32 s62, s65, 0
v_mfma_f32_16x16x32_bf16 a[16:19], v[176:179], v[128:131], a[16:19]
v_mfma_f32_16x16x32_bf16 a[20:23], v[180:183], v[128:131], a[20:23]
ds_read_b64_tr_b16 v[98:99], v17 offset:2048
buffer_load_dwordx4 v8, s[8:11], s62 offen lds
v_mfma_f32_16x16x32_bf16 a[24:27], v[184:187], v[128:131], a[24:27]
v_mfma_f32_16x16x32_bf16 a[28:31], v[188:191], v[128:131], a[28:31]
ds_read_b128 v[68:71], v16 offset:1024
s_add_u32 s62, s65, 15360
v_mfma_f32_16x16x32_bf16 a[32:35], v[160:163], v[132:135], a[32:35]
v_mfma_f32_16x16x32_bf16 a[36:39], v[164:167], v[132:135], a[36:39]
buffer_load_dwordx4 v8, s[8:11], s62 offen offset:1024 lds
v_mfma_f32_16x16x32_bf16 a[40:43], v[168:171], v[132:135], a[40:43]
ds_read_b64_tr_b16 v[100:101], v18
v_mfma_f32_16x16x32_bf16 a[44:47], v[172:175], v[132:135], a[44:47]
s_add_u32 s62, s65, 30720
v_mfma_f32_16x16x32_bf16 a[48:51], v[176:179], v[132:135], a[48:51]
ds_read_b64_tr_b16 v[102:103], v18 offset:2048
buffer_load_dwordx4 v9, s[8:11], s62 offen offset:2048 lds
v_mfma_f32_16x16x32_bf16 a[52:55], v[180:183], v[132:135], a[52:55]
v_mfma_f32_16x16x32_bf16 a[56:59], v[184:187], v[132:135], a[56:59]
ds_read_b128 v[72:75], v16 offset:4096
s_add_u32 s62, s65, 46080
v_mfma_f32_16x16x32_bf16 a[60:63], v[188:191], v[132:135], a[60:63]
v_mfma_f32_16x16x32_bf16 a[64:67], v[160:163], v[136:139], a[64:67]
ds_read_b64_tr_b16 v[104:105], v19
buffer_load_dwordx4 v9, s[8:11], s62 offen offset:3072 lds
v_mfma_f32_16x16x32_bf16 a[68:71], v[164:167], v[136:139], a[68:71]
v_mfma_f32_16x16x32_bf16 a[72:75], v[168:171], v[136:139], a[72:75]
s_add_u32 m0, s63, 36864
v_mfma_f32_16x16x32_bf16 a[76:79], v[172:175], v[136:139], a[76:79]
ds_read_b64_tr_b16 v[106:107], v19 offset:2048
v_mfma_f32_16x16x32_bf16 a[80:83], v[176:179], v[136:139], a[80:83]
s_add_u32 s62, s65, 65536
v_mfma_f32_16x16x32_bf16 a[84:87], v[180:183], v[136:139], a[84:87]
ds_read_b128 v[76:79], v16 offset:5120
buffer_load_dwordx4 v8, s[8:11], s62 offen lds
v_mfma_f32_16x16x32_bf16 a[88:91], v[184:187], v[136:139], a[88:91]
v_mfma_f32_16x16x32_bf16 a[92:95], v[188:191], v[136:139], a[92:95]
ds_read_b64_tr_b16 v[108:109], v20
s_add_u32 s62, s65, 80896
v_mfma_f32_16x16x32_bf16 a[96:99], v[160:163], v[140:143], a[96:99]
v_mfma_f32_16x16x32_bf16 a[100:103], v[164:167], v[140:143], a[100:103]
ds_read_b64_tr_b16 v[110:111], v20 offset:2048
buffer_load_dwordx4 v8, s[8:11], s62 offen offset:1024 lds
v_mfma_f32_16x16x32_bf16 a[104:107], v[168:171], v[140:143], a[104:107]
v_mfma_f32_16x16x32_bf16 a[108:111], v[172:175], v[140:143], a[108:111]
s_add_u32 s62, s65, 96256
v_mfma_f32_16x16x32_bf16 a[112:115], v[176:179], v[140:143], a[112:115]
ds_read_b128 v[80:83], v16 offset:8192
v_mfma_f32_16x16x32_bf16 a[116:119], v[180:183], v[140:143], a[116:119]
buffer_load_dwordx4 v9, s[8:11], s62 offen offset:2048 lds
v_mfma_f32_16x16x32_bf16 a[120:123], v[184:187], v[140:143], a[120:123]
ds_read_b64_tr_b16 v[112:113], v21
s_add_u32 s62, s65, 111616
v_mfma_f32_16x16x32_bf16 a[124:127], v[188:191], v[140:143], a[124:127]
v_mfma_f32_16x16x32_bf16 a[128:131], v[160:163], v[144:147], a[128:131]
ds_read_b64_tr_b16 v[114:115], v21 offset:2048
buffer_load_dwordx4 v9, s[8:11], s62 offen offset:3072 lds
v_mfma_f32_16x16x32_bf16 a[132:135], v[164:167], v[144:147], a[132:135]
v_mfma_f32_16x16x32_bf16 a[136:139], v[168:171], v[144:147], a[136:139]
ds_read_b128 v[84:87], v16 offset:9216
s_add_u32 s65, s65, 128
v_mfma_f32_16x16x32_bf16 a[140:143], v[172:175], v[144:147], a[140:143]
v_mfma_f32_16x16x32_bf16 a[144:147], v[176:179], v[144:147], a[144:147]
s_add_u32 m0, s64, 114688
v_mfma_f32_16x16x32_bf16 a[148:151], v[180:183], v[144:147], a[148:151]
ds_read_b64_tr_b16 v[116:117], v22
v_mfma_f32_16x16x32_bf16 a[152:155], v[184:187], v[144:147], a[152:155]
s_nop 0
v_mfma_f32_16x16x32_bf16 a[156:159], v[188:191], v[144:147], a[156:159]
ds_read_b64_tr_b16 v[118:119], v22 offset:2048
buffer_load_dwordx4 v12, s[12:15], s66 offen lds
v_mfma_f32_16x16x32_bf16 a[160:163], v[160:163], v[148:151], a[160:163]
v_mfma_f32_16x16x32_bf16 a[164:167], v[164:167], v[148:151], a[164:167]
ds_read_b128 v[88:91], v16 offset:12288
buffer_load_dwordx4 v13, s[12:15], s66 offen offset:1024 lds
v_mfma_f32_16x16x32_bf16 a[168:171], v[168:171], v[148:151], a[168:171]
v_mfma_f32_16x16x32_bf16 a[172:175], v[172:175], v[148:151], a[172:175]
ds_read_b64_tr_b16 v[120:121], v23
buffer_load_dwordx4 v14, s[12:15], s66 offen offset:2048 lds
v_mfma_f32_16x16x32_bf16 a[176:179], v[176:179], v[148:151], a[176:179]
v_mfma_f32_16x16x32_bf16 a[180:183], v[180:183], v[148:151], a[180:183]
buffer_load_dwordx4 v15, s[12:15], s66 offen offset:3072 lds
v_mfma_f32_16x16x32_bf16 a[184:187], v[184:187], v[148:151], a[184:187]
ds_read_b64_tr_b16 v[122:123], v23 offset:2048
v_mfma_f32_16x16x32_bf16 a[188:191], v[188:191], v[148:151], a[188:191]
s_add_u32 s66, s66, 262144
v_mfma_f32_16x16x32_bf16 a[192:195], v[160:163], v[152:155], a[192:195]
ds_read_b128 v[92:95], v16 offset:13312
v_mfma_f32_16x16x32_bf16 a[196:199], v[164:167], v[152:155], a[196:199]
v_mfma_f32_16x16x32_bf16 a[200:203], v[168:171], v[152:155], a[200:203]
ds_read_b64_tr_b16 v[124:125], v24
buffer_load_dword v244, v241, s[8:11], 0 offen offset:1024
v_mfma_f32_16x16x32_bf16 a[204:207], v[172:175], v[152:155], a[204:207]
v_mfma_f32_16x16x32_bf16 a[208:211], v[176:179], v[152:155], a[208:211]
ds_read_b64_tr_b16 v[126:127], v24 offset:2048
v_mfma_f32_16x16x32_bf16 a[212:215], v[180:183], v[152:155], a[212:215]
v_mfma_f32_16x16x32_bf16 a[216:219], v[184:187], v[152:155], a[216:219]
v_mfma_f32_16x16x32_bf16 a[220:223], v[188:191], v[152:155], a[220:223]
v_mfma_f32_16x16x32_bf16 a[224:227], v[160:163], v[156:159], a[224:227]
v_mfma_f32_16x16x32_bf16 a[228:231], v[164:167], v[156:159], a[228:231]
v_mfma_f32_16x16x32_bf16 a[232:235], v[168:171], v[156:159], a[232:235]
v_mfma_f32_16x16x32_bf16 a[236:239], v[172:175], v[156:159], a[236:239]
v_mfma_f32_16x16x32_bf16 a[240:243], v[176:179], v[156:159], a[240:243]
v_mfma_f32_16x16x32_bf16 a[244:247], v[180:183], v[156:159], a[244:247]
v_mfma_f32_16x16x32_bf16 a[248:251], v[184:187], v[156:159], a[248:251]
v_mfma_f32_16x16x32_bf16 a[252:255], v[188:191], v[156:159], a[252:255]
s_waitcnt lgkmcnt(0)
v_mfma_f32_16x16x32_bf16 a[0:3], v[96:99], v[64:67], a[0:3]
s_waitcnt vmcnt(18)
s_barrier
v_mfma_f32_16x16x32_bf16 a[4:7], v[100:103], v[64:67], a[4:7]
ds_read_b128 v[128:131], v10
v_mfma_f32_16x16x32_bf16 a[8:11], v[104:107], v[64:67], a[8:11]
s_add_u32 m0, s64, 65536
v_mfma_f32_16x16x32_bf16 a[12:15], v[108:111], v[64:67], a[12:15]
ds_read_b64_tr_b16 v[160:161], v17 offset:16384
v_mfma_f32_16x16x32_bf16 a[16:19], v[112:115], v[64:67], a[16:19]
v_mfma_f32_16x16x32_bf16 a[20:23], v[116:119], v[64:67], a[20:23]
ds_read_b64_tr_b16 v[162:163], v17 offset:18432
v_mfma_f32_16x16x32_bf16 a[24:27], v[120:123], v[64:67], a[24:27]
v_mfma_f32_16x16x32_bf16 a[28:31], v[124:127], v[64:67], a[28:31]
ds_read_b128 v[132:135], v10 offset:1024
v_mfma_f32_16x16x32_bf16 a[32:35], v[96:99], v[68:71], a[32:35]
s_nop 0
v_mfma_f32_16x16x32_bf16 a[36:39], v[100:103], v[68:71], a[36:39]
v_mfma_f32_16x16x32_bf16 a[40:43], v[104:107], v[68:71], a[40:43]
ds_read_b64_tr_b16 v[164:165], v18 offset:16384
v_mfma_f32_16x16x32_bf16 a[44:47], v[108:111], v[68:71], a[44:47]
v_mfma_f32_16x16x32_bf16 a[48:51], v[112:115], v[68:71], a[48:51]
ds_read_b64_tr_b16 v[166:167], v18 offset:18432
v_mfma_f32_16x16x32_bf16 a[52:55], v[116:119], v[68:71], a[52:55]
v_mfma_f32_16x16x32_bf16 a[56:59], v[120:123], v[68:71], a[56:59]
ds_read_b128 v[136:139], v10 offset:4096
v_mfma_f32_16x16x32_bf16 a[60:63], v[124:127], v[68:71], a[60:63]
buffer_load_dwordx4 v12, s[12:15], s66 offen lds
v_mfma_f32_16x16x32_bf16 a[64:67], v[96:99], v[72:75], a[64:67]
ds_read_b64_tr_b16 v[168:169], v19 offset:16384
v_mfma_f32_16x16x32_bf16 a[68:71], v[100:103], v[72:75], a[68:71]
v_mfma_f32_16x16x32_bf16 a[72:75], v[104:107], v[72:75], a[72:75]
v_mfma_f32_16x16x32_bf16 a[76:79], v[108:111], v[72:75], a[76:79]
ds_read_b64_tr_b16 v[170:171], v19 offset:18432
v_mfma_f32_16x16x32_bf16 a[80:83], v[112:115], v[72:75], a[80:83]
v_mfma_f32_16x16x32_bf16 a[84:87], v[116:119], v[72:75], a[84:87]
ds_read_b128 v[140:143], v10 offset:5120
v_mfma_f32_16x16x32_bf16 a[88:91], v[120:123], v[72:75], a[88:91]
buffer_load_dwordx4 v13, s[12:15], s66 offen offset:1024 lds
v_mfma_f32_16x16x32_bf16 a[92:95], v[124:127], v[72:75], a[92:95]
ds_read_b64_tr_b16 v[172:173], v20 offset:16384
v_mfma_f32_16x16x32_bf16 a[96:99], v[96:99], v[76:79], a[96:99]
v_mfma_f32_16x16x32_bf16 a[100:103], v[100:103], v[76:79], a[100:103]
ds_read_b64_tr_b16 v[174:175], v20 offset:18432
v_mfma_f32_16x16x32_bf16 a[104:107], v[104:107], v[76:79], a[104:107]
v_mfma_f32_16x16x32_bf16 a[108:111], v[108:111], v[76:79], a[108:111]
v_mfma_f32_16x16x32_bf16 a[112:115], v[112:115], v[76:79], a[112:115]
ds_read_b128 v[144:147], v10 offset:8192
buffer_load_dwordx4 v14, s[12:15], s66 offen offset:2048 lds
v_mfma_f32_16x16x32_bf16 a[116:119], v[116:119], v[76:79], a[116:119]
v_mfma_f32_16x16x32_bf16 a[120:123], v[120:123], v[76:79], a[120:123]
ds_read_b64_tr_b16 v[176:177], v21 offset:16384
v_mfma_f32_16x16x32_bf16 a[124:127], v[124:127], v[76:79], a[124:127]
v_mfma_f32_16x16x32_bf16 a[128:131], v[96:99], v[80:83], a[128:131]
ds_read_b64_tr_b16 v[178:179], v21 offset:18432
v_mfma_f32_16x16x32_bf16 a[132:135], v[100:103], v[80:83], a[132:135]
v_mfma_f32_16x16x32_bf16 a[136:139], v[104:107], v[80:83], a[136:139]
ds_read_b128 v[148:151], v10 offset:9216
v_mfma_f32_16x16x32_bf16 a[140:143], v[108:111], v[80:83], a[140:143]
buffer_load_dwordx4 v15, s[12:15], s66 offen offset:3072 lds
v_mfma_f32_16x16x32_bf16 a[144:147], v[112:115], v[80:83], a[144:147]
v_mfma_f32_16x16x32_bf16 a[148:151], v[116:119], v[80:83], a[148:151]
ds_read_b64_tr_b16 v[180:181], v22 offset:16384
v_mfma_f32_16x16x32_bf16 a[152:155], v[120:123], v[80:83], a[152:155]
v_mfma_f32_16x16x32_bf16 a[156:159], v[124:127], v[80:83], a[156:159]
ds_read_b64_tr_b16 v[182:183], v22 offset:18432
v_mfma_f32_16x16x32_bf16 a[160:163], v[96:99], v[84:87], a[160:163]
v_mfma_f32_16x16x32_bf16 a[164:167], v[100:103], v[84:87], a[164:167]
ds_read_b128 v[152:155], v10 offset:12288
v_mfma_f32_16x16x32_bf16 a[168:171], v[104:107], v[84:87], a[168:171]
s_add_u32 s66, s66, 262144
v_mfma_f32_16x16x32_bf16 a[172:175], v[108:111], v[84:87], a[172:175]
ds_read_b64_tr_b16 v[184:185], v23 offset:16384
v_mfma_f32_16x16x32_bf16 a[176:179], v[112:115], v[84:87], a[176:179]
v_mfma_f32_16x16x32_bf16 a[180:183], v[116:119], v[84:87], a[180:183]
v_mfma_f32_16x16x32_bf16 a[184:187], v[120:123], v[84:87], a[184:187]
ds_read_b64_tr_b16 v[186:187], v23 offset:18432
v_mfma_f32_16x16x32_bf16 a[188:191], v[124:127], v[84:87], a[188:191]
v_mfma_f32_16x16x32_bf16 a[192:195], v[96:99], v[88:91], a[192:195]
ds_read_b128 v[156:159], v10 offset:13312
v_mfma_f32_16x16x32_bf16 a[196:199], v[100:103], v[88:91], a[196:199]
v_mfma_f32_16x16x32_bf16 a[200:203], v[104:107], v[88:91], a[200:203]
ds_read_b64_tr_b16 v[188:189], v24 offset:16384
v_mfma_f32_16x16x32_bf16 a[204:207], v[108:111], v[88:91], a[204:207]
v_mfma_f32_16x16x32_bf16 a[208:211], v[112:115], v[88:91], a[208:211]
ds_read_b64_tr_b16 v[190:191], v24 offset:18432
v_mfma_f32_16x16x32_bf16 a[212:215], v[116:119], v[88:91], a[212:215]
v_mfma_f32_16x16x32_bf16 a[216:219], v[120:123], v[88:91], a[216:219]
v_mfma_f32_16x16x32_bf16 a[220:223], v[124:127], v[88:91], a[220:223]
v_mfma_f32_16x16x32_bf16 a[224:227], v[96:99], v[92:95], a[224:227]
v_mfma_f32_16x16x32_bf16 a[228:231], v[100:103], v[92:95], a[228:231]
v_mfma_f32_16x16x32_bf16 a[232:235], v[104:107], v[92:95], a[232:235]
v_mfma_f32_16x16x32_bf16 a[236:239], v[108:111], v[92:95], a[236:239]
v_mfma_f32_16x16x32_bf16 a[240:243], v[112:115], v[92:95], a[240:243]
v_mfma_f32_16x16x32_bf16 a[244:247], v[116:119], v[92:95], a[244:247]
v_mfma_f32_16x16x32_bf16 a[248:251], v[120:123], v[92:95], a[248:251]
v_mfma_f32_16x16x32_bf16 a[252:255], v[124:127], v[92:95], a[252:255]
s_waitcnt lgkmcnt(0)
v_mfma_f32_16x16x32_bf16 a[0:3], v[160:163], v[128:131], a[0:3]
s_waitcnt vmcnt(9)
s_barrier
v_mfma_f32_16x16x32_bf16 a[4:7], v[164:167], v[128:131], a[4:7]
ds_read_b128 v[64:67], v16 offset:32768
v_mfma_f32_16x16x32_bf16 a[8:11], v[168:171], v[128:131], a[8:11]
s_add_u32 m0, s63, 0
v_mfma_f32_16x16x32_bf16 a[12:15], v[172:175], v[128:131], a[12:15]
ds_read_b64_tr_b16 v[96:97], v17 offset:32768
s_add_u32 s62, s65, 0
v_mfma_f32_16x16x32_bf16 a[16:19], v[176:179], v[128:131], a[16:19]
v_mfma_f32_16x16x32_bf16 a[20:23], v[180:183], v[128:131], a[20:23]
ds_read_b64_tr_b16 v[98:99], v17 offset:34816
buffer_load_dwordx4 v8, s[8:11], s62 offen lds
v_mfma_f32_16x16x32_bf16 a[24:27], v[184:187], v[128:131], a[24:27]
v_mfma_f32_16x16x32_bf16 a[28:31], v[188:191], v[128:131], a[28:31]
ds_read_b128 v[68:71], v16 offset:33792
s_add_u32 s62, s65, 15360
v_mfma_f32_16x16x32_bf16 a[32:35], v[160:163], v[132:135], a[32:35]
v_mfma_f32_16x16x32_bf16 a[36:39], v[164:167], v[132:135], a[36:39]
buffer_load_dwordx4 v8, s[8:11], s62 offen offset:1024 lds
v_mfma_f32_16x16x32_bf16 a[40:43], v[168:171], v[132:135], a[40:43]
ds_read_b64_tr_b16 v[100:101], v18 offset:32768
v_mfma_f32_16x16x32_bf16 a[44:47], v[172:175], v[132:135], a[44:47]
s_add_u32 s62, s65, 30720
v_mfma_f32_16x16x32_bf16 a[48:51], v[176:179], v[132:135], a[48:51]
ds_read_b64_tr_b16 v[102:103], v18 offset:34816
buffer_load_dwordx4 v9, s[8:11], s62 offen offset:2048 lds
v_mfma_f32_16x16x32_bf16 a[52:55], v[180:183], v[132:135], a[52:55]
v_mfma_f32_16x16x32_bf16 a[56:59], v[184:187], v[132:135], a[56:59]
ds_read_b128 v[72:75], v16 offset:36864
s_add_u32 s62, s65, 46080
v_mfma_f32_16x16x32_bf16 a[60:63], v[188:191], v[132:135], a[60:63]
v_mfma_f32_16x16x32_bf16 a[64:67], v[160:163], v[136:139], a[64:67]
ds_read_b64_tr_b16 v[104:105], v19 offset:32768
buffer_load_dwordx4 v9, s[8:11], s62 offen offset:3072 lds
v_mfma_f32_16x16x32_bf16 a[68:71], v[164:167], v[136:139], a[68:71]
v_mfma_f32_16x16x32_bf16 a[72:75], v[168:171], v[136:139], a[72:75]
s_add_u32 m0, s63, 4096
v_mfma_f32_16x16x32_bf16 a[76:79], v[172:175], v[136:139], a[76:79]
ds_read_b64_tr_b16 v[106:107], v19 offset:34816
v_mfma_f32_16x16x32_bf16 a[80:83], v[176:179], v[136:139], a[80:83]
s_add_u32 s62, s65, 65536
ds_read_b128 v[32:35], v252
ds_read_b128 v[36:39], v252 offset:896
v_mfma_f32_16x16x32_bf16 a[84:87], v[180:183], v[136:139], a[84:87]
ds_read_b128 v[76:79], v16 offset:37888
buffer_load_dwordx4 v8, s[8:11], s62 offen lds
v_mfma_f32_16x16x32_bf16 a[88:91], v[184:187], v[136:139], a[88:91]
v_mfma_f32_16x16x32_bf16 a[92:95], v[188:191], v[136:139], a[92:95]
ds_read_b64_tr_b16 v[108:109], v20 offset:32768
s_add_u32 s62, s65, 80896
v_mfma_f32_16x16x32_bf16 a[96:99], v[160:163], v[140:143], a[96:99]
v_mfma_f32_16x16x32_bf16 a[100:103], v[164:167], v[140:143], a[100:103]
ds_read_b64_tr_b16 v[110:111], v20 offset:34816
buffer_load_dwordx4 v8, s[8:11], s62 offen offset:1024 lds
v_mfma_f32_16x16x32_bf16 a[104:107], v[168:171], v[140:143], a[104:107]
v_mfma_f32_16x16x32_bf16 a[108:111], v[172:175], v[140:143], a[108:111]
s_add_u32 s62, s65, 96256
v_mfma_f32_16x16x32_bf16 a[112:115], v[176:179], v[140:143], a[112:115]
ds_read_b128 v[80:83], v16 offset:40960
v_mfma_f32_16x16x32_bf16 a[116:119], v[180:183], v[140:143], a[116:119]
buffer_load_dwordx4 v9, s[8:11], s62 offen offset:2048 lds
v_mfma_f32_16x16x32_bf16 a[120:123], v[184:187], v[140:143], a[120:123]
ds_read_b64_tr_b16 v[112:113], v21 offset:32768
s_add_u32 s62, s65, 111616
v_mfma_f32_16x16x32_bf16 a[124:127], v[188:191], v[140:143], a[124:127]
v_mfma_f32_16x16x32_bf16 a[128:131], v[160:163], v[144:147], a[128:131]
ds_read_b64_tr_b16 v[114:115], v21 offset:34816
buffer_load_dwordx4 v9, s[8:11], s62 offen offset:3072 lds
v_mfma_f32_16x16x32_bf16 a[132:135], v[164:167], v[144:147], a[132:135]
v_mfma_f32_16x16x32_bf16 a[136:139], v[168:171], v[144:147], a[136:139]
ds_read_b128 v[84:87], v16 offset:41984
s_add_u32 s65, s65, 128
v_mfma_f32_16x16x32_bf16 a[140:143], v[172:175], v[144:147], a[140:143]
v_mfma_f32_16x16x32_bf16 a[144:147], v[176:179], v[144:147], a[144:147]
s_add_u32 m0, s64, 81920
v_mfma_f32_16x16x32_bf16 a[148:151], v[180:183], v[144:147], a[148:151]
ds_read_b64_tr_b16 v[116:117], v22 offset:32768
v_mfma_f32_16x16x32_bf16 a[152:155], v[184:187], v[144:147], a[152:155]
s_nop 0
v_mfma_f32_16x16x32_bf16 a[156:159], v[188:191], v[144:147], a[156:159]
ds_read_b64_tr_b16 v[118:119], v22 offset:34816
buffer_load_dwordx4 v12, s[12:15], s66 offen lds
v_mfma_f32_16x16x32_bf16 a[160:163], v[160:163], v[148:151], a[160:163]
v_mfma_f32_16x16x32_bf16 a[164:167], v[164:167], v[148:151], a[164:167]
ds_read_b128 v[88:91], v16 offset:45056
buffer_load_dwordx4 v13, s[12:15], s66 offen offset:1024 lds
v_mfma_f32_16x16x32_bf16 a[168:171], v[168:171], v[148:151], a[168:171]
v_mfma_f32_16x16x32_bf16 a[172:175], v[172:175], v[148:151], a[172:175]
ds_read_b64_tr_b16 v[120:121], v23 offset:32768
buffer_load_dwordx4 v14, s[12:15], s66 offen offset:2048 lds
v_mfma_f32_16x16x32_bf16 a[176:179], v[176:179], v[148:151], a[176:179]
v_mfma_f32_16x16x32_bf16 a[180:183], v[180:183], v[148:151], a[180:183]
buffer_load_dwordx4 v15, s[12:15], s66 offen offset:3072 lds
v_mfma_f32_16x16x32_bf16 a[184:187], v[184:187], v[148:151], a[184:187]
ds_read_b64_tr_b16 v[122:123], v23 offset:34816
v_mfma_f32_16x16x32_bf16 a[188:191], v[188:191], v[148:151], a[188:191]
s_add_u32 s66, s66, 262144
v_mfma_f32_16x16x32_bf16 a[192:195], v[160:163], v[152:155], a[192:195]
ds_read_b128 v[92:95], v16 offset:46080
v_mfma_f32_16x16x32_bf16 a[196:199], v[164:167], v[152:155], a[196:199]
v_mfma_f32_16x16x32_bf16 a[200:203], v[168:171], v[152:155], a[200:203]
ds_read_b64_tr_b16 v[124:125], v24 offset:32768
v_add_u32 v242, 0x100000, v242
global_load_dword v245, v242, s[98:99]
v_mfma_f32_16x16x32_bf16 a[204:207], v[172:175], v[152:155], a[204:207]
v_mfma_f32_16x16x32_bf16 a[208:211], v[176:179], v[152:155], a[208:211]
ds_read_b64_tr_b16 v[126:127], v24 offset:34816
v_mfma_f32_16x16x32_bf16 a[212:215], v[180:183], v[152:155], a[212:215]
v_mfma_f32_16x16x32_bf16 a[216:219], v[184:187], v[152:155], a[216:219]
v_mfma_f32_16x16x32_bf16 a[220:223], v[188:191], v[152:155], a[220:223]
v_mfma_f32_16x16x32_bf16 a[224:227], v[160:163], v[156:159], a[224:227]
v_mfma_f32_16x16x32_bf16 a[228:231], v[164:167], v[156:159], a[228:231]
v_mfma_f32_16x16x32_bf16 a[232:235], v[168:171], v[156:159], a[232:235]
v_mfma_f32_16x16x32_bf16 a[236:239], v[172:175], v[156:159], a[236:239]
v_mfma_f32_16x16x32_bf16 a[240:243], v[176:179], v[156:159], a[240:243]
v_mfma_f32_16x16x32_bf16 a[244:247], v[180:183], v[156:159], a[244:247]
v_mfma_f32_16x16x32_bf16 a[248:251], v[184:187], v[156:159], a[248:251]
v_mfma_f32_16x16x32_bf16 a[252:255], v[188:191], v[156:159], a[252:255]
s_waitcnt lgkmcnt(0)
v_mfma_f32_16x16x32_bf16 a[0:3], v[96:99], v[64:67], a[0:3]
s_waitcnt vmcnt(18)
s_barrier
v_mfma_f32_16x16x32_bf16 a[4:7], v[100:103], v[64:67], a[4:7]
ds_read_b128 v[128:131], v10 offset:32768
v_mfma_f32_16x16x32_bf16 a[8:11], v[104:107], v[64:67], a[8:11]
s_add_u32 m0, s64, 98304
v_mfma_f32_16x16x32_bf16 a[12:15], v[108:111], v[64:67], a[12:15]
ds_read_b64_tr_b16 v[160:161], v17 offset:49152
v_mfma_f32_16x16x32_bf16 a[16:19], v[112:115], v[64:67], a[16:19]
v_mfma_f32_16x16x32_bf16 a[20:23], v[116:119], v[64:67], a[20:23]
ds_read_b64_tr_b16 v[162:163], v17 offset:51200
v_mfma_f32_16x16x32_bf16 a[24:27], v[120:123], v[64:67], a[24:27]
v_mfma_f32_16x16x32_bf16 a[28:31], v[124:127], v[64:67], a[28:31]
ds_read_b128 v[132:135], v10 offset:33792
v_mfma_f32_16x16x32_bf16 a[32:35], v[96:99], v[68:71], a[32:35]
s_nop 0
v_mfma_f32_16x16x32_bf16 a[36:39], v[100:103], v[68:71], a[36:39]
v_mfma_f32_16x16x32_bf16 a[40:43], v[104:107], v[68:71], a[40:43]
ds_read_b64_tr_b16 v[164:165], v18 offset:49152
v_mfma_f32_16x16x32_bf16 a[44:47], v[108:111], v[68:71], a[44:47]
v_mfma_f32_16x16x32_bf16 a[48:51], v[112:115], v[68:71], a[48:51]
ds_read_b64_tr_b16 v[166:167], v18 offset:51200
v_mfma_f32_16x16x32_bf16 a[52:55], v[116:119], v[68:71], a[52:55]
v_mfma_f32_16x16x32_bf16 a[56:59], v[120:123], v[68:71], a[56:59]
ds_read_b128 v[136:139], v10 offset:36864
v_mfma_f32_16x16x32_bf16 a[60:63], v[124:127], v[68:71], a[60:63]
buffer_load_dwordx4 v12, s[12:15], s66 offen lds
v_mfma_f32_16x16x32_bf16 a[64:67], v[96:99], v[72:75], a[64:67]
ds_read_b64_tr_b16 v[168:169], v19 offset:49152
v_mfma_f32_16x16x32_bf16 a[68:71], v[100:103], v[72:75], a[68:71]
v_mfma_f32_16x16x32_bf16 a[72:75], v[104:107], v[72:75], a[72:75]
v_mfma_f32_16x16x32_bf16 a[76:79], v[108:111], v[72:75], a[76:79]
ds_read_b64_tr_b16 v[170:171], v19 offset:51200
v_mfma_f32_16x16x32_bf16 a[80:83], v[112:115], v[72:75], a[80:83]
buffer_store_dwordx4 v[32:35], v253, s[24:27], 0 offen sc1
buffer_store_dwordx4 v[36:39], v253, s[24:27], 0 offen offset:3584 sc1
v_mfma_f32_16x16x32_bf16 a[84:87], v[116:119], v[72:75], a[84:87]
ds_read_b128 v[140:143], v10 offset:37888
v_mfma_f32_16x16x32_bf16 a[88:91], v[120:123], v[72:75], a[88:91]
buffer_load_dwordx4 v13, s[12:15], s66 offen offset:1024 lds
v_mfma_f32_16x16x32_bf16 a[92:95], v[124:127], v[72:75], a[92:95]
ds_read_b64_tr_b16 v[172:173], v20 offset:49152
v_mfma_f32_16x16x32_bf16 a[96:99], v[96:99], v[76:79], a[96:99]
v_mfma_f32_16x16x32_bf16 a[100:103], v[100:103], v[76:79], a[100:103]
ds_read_b64_tr_b16 v[174:175], v20 offset:51200
v_mfma_f32_16x16x32_bf16 a[104:107], v[104:107], v[76:79], a[104:107]
v_mfma_f32_16x16x32_bf16 a[108:111], v[108:111], v[76:79], a[108:111]
v_mfma_f32_16x16x32_bf16 a[112:115], v[112:115], v[76:79], a[112:115]
ds_read_b128 v[144:147], v10 offset:40960
buffer_load_dwordx4 v14, s[12:15], s66 offen offset:2048 lds
v_mfma_f32_16x16x32_bf16 a[116:119], v[116:119], v[76:79], a[116:119]
v_mfma_f32_16x16x32_bf16 a[120:123], v[120:123], v[76:79], a[120:123]
ds_read_b64_tr_b16 v[176:177], v21 offset:49152
v_mfma_f32_16x16x32_bf16 a[124:127], v[124:127], v[76:79], a[124:127]
v_mfma_f32_16x16x32_bf16 a[128:131], v[96:99], v[80:83], a[128:131]
ds_read_b64_tr_b16 v[178:179], v21 offset:51200
v_mfma_f32_16x16x32_bf16 a[132:135], v[100:103], v[80:83], a[132:135]
v_mfma_f32_16x16x32_bf16 a[136:139], v[104:107], v[80:83], a[136:139]
ds_read_b128 v[148:151], v10 offset:41984
v_mfma_f32_16x16x32_bf16 a[140:143], v[108:111], v[80:83], a[140:143]
buffer_load_dwordx4 v15, s[12:15], s66 offen offset:3072 lds
v_mfma_f32_16x16x32_bf16 a[144:147], v[112:115], v[80:83], a[144:147]
v_mfma_f32_16x16x32_bf16 a[148:151], v[116:119], v[80:83], a[148:151]
ds_read_b64_tr_b16 v[180:181], v22 offset:49152
v_mfma_f32_16x16x32_bf16 a[152:155], v[120:123], v[80:83], a[152:155]
v_mfma_f32_16x16x32_bf16 a[156:159], v[124:127], v[80:83], a[156:159]
ds_read_b64_tr_b16 v[182:183], v22 offset:51200
v_mfma_f32_16x16x32_bf16 a[160:163], v[96:99], v[84:87], a[160:163]
v_mfma_f32_16x16x32_bf16 a[164:167], v[100:103], v[84:87], a[164:167]
ds_read_b128 v[152:155], v10 offset:45056
v_mfma_f32_16x16x32_bf16 a[168:171], v[104:107], v[84:87], a[168:171]
s_add_u32 s66, s66, 262144
v_mfma_f32_16x16x32_bf16 a[172:175], v[108:111], v[84:87], a[172:175]
ds_read_b64_tr_b16 v[184:185], v23 offset:49152
v_mfma_f32_16x16x32_bf16 a[176:179], v[112:115], v[84:87], a[176:179]
v_mfma_f32_16x16x32_bf16 a[180:183], v[116:119], v[84:87], a[180:183]
v_mfma_f32_16x16x32_bf16 a[184:187], v[120:123], v[84:87], a[184:187]
ds_read_b64_tr_b16 v[186:187], v23 offset:51200
v_mfma_f32_16x16x32_bf16 a[188:191], v[124:127], v[84:87], a[188:191]
v_mfma_f32_16x16x32_bf16 a[192:195], v[96:99], v[88:91], a[192:195]
ds_read_b128 v[156:159], v10 offset:46080
v_mfma_f32_16x16x32_bf16 a[196:199], v[100:103], v[88:91], a[196:199]
v_mfma_f32_16x16x32_bf16 a[200:203], v[104:107], v[88:91], a[200:203]
ds_read_b64_tr_b16 v[188:189], v24 offset:49152
v_mfma_f32_16x16x32_bf16 a[204:207], v[108:111], v[88:91], a[204:207]
v_mfma_f32_16x16x32_bf16 a[208:211], v[112:115], v[88:91], a[208:211]
ds_read_b64_tr_b16 v[190:191], v24 offset:51200
v_mfma_f32_16x16x32_bf16 a[212:215], v[116:119], v[88:91], a[212:215]
v_mfma_f32_16x16x32_bf16 a[216:219], v[120:123], v[88:91], a[216:219]
v_mfma_f32_16x16x32_bf16 a[220:223], v[124:127], v[88:91], a[220:223]
v_mfma_f32_16x16x32_bf16 a[224:227], v[96:99], v[92:95], a[224:227]
v_mfma_f32_16x16x32_bf16 a[228:231], v[100:103], v[92:95], a[228:231]
v_mfma_f32_16x16x32_bf16 a[232:235], v[104:107], v[92:95], a[232:235]
v_mfma_f32_16x16x32_bf16 a[236:239], v[108:111], v[92:95], a[236:239]
v_mfma_f32_16x16x32_bf16 a[240:243], v[112:115], v[92:95], a[240:243]
v_mfma_f32_16x16x32_bf16 a[244:247], v[116:119], v[92:95], a[244:247]
v_mfma_f32_16x16x32_bf16 a[248:251], v[120:123], v[92:95], a[248:251]
v_mfma_f32_16x16x32_bf16 a[252:255], v[124:127], v[92:95], a[252:255]
s_waitcnt lgkmcnt(0)
v_mfma_f32_16x16x32_bf16 a[0:3], v[160:163], v[128:131], a[0:3]
s_waitcnt vmcnt(11)
s_barrier
v_mfma_f32_16x16x32_bf16 a[4:7], v[164:167], v[128:131], a[4:7]
ds_read_b128 v[64:67], v16
v_mfma_f32_16x16x32_bf16 a[8:11], v[168:171], v[128:131], a[8:11]
s_add_u32 m0, s63, 32768
v_mfma_f32_16x16x32_bf16 a[12:15], v[172:175], v[128:131], a[12:15]
ds_read_b64_tr_b16 v[96:97], v17
s_add_u32 s62, s65, 0
v_mfma_f32_16x16x32_bf16 a[16:19], v[176:179], v[128:131], a[16:19]
v_mfma_f32_16x16x32_bf16 a[20:23], v[180:183], v[128:131], a[20:23]
ds_read_b64_tr_b16 v[98:99], v17 offset:2048
buffer_load_dwordx4 v8, s[8:11], s62 offen lds
v_mfma_f32_16x16x32_bf16 a[24:27], v[184:187], v[128:131], a[24:27]
v_mfma_f32_16x16x32_bf16 a[28:31], v[188:191], v[128:131], a[28:31]
ds_read_b128 v[68:71], v16 offset:1024
s_add_u32 s62, s65, 15360
v_mfma_f32_16x16x32_bf16 a[32:35], v[160:163], v[132:135], a[32:35]
v_mfma_f32_16x16x32_bf16 a[36:39], v[164:167], v[132:135], a[36:39]
buffer_load_dwordx4 v8, s[8:11], s62 offen offset:1024 lds
v_mfma_f32_16x16x32_bf16 a[40:43], v[168:171], v[132:135], a[40:43]
ds_read_b64_tr_b16 v[100:101], v18
v_mfma_f32_16x16x32_bf16 a[44:47], v[172:175], v[132:135], a[44:47]
s_add_u32 s62, s65, 30720
v_mfma_f32_16x16x32_bf16 a[48:51], v[176:179], v[132:135], a[48:51]
ds_read_b64_tr_b16 v[102:103], v18 offset:2048
buffer_load_dwordx4 v9, s[8:11], s62 offen offset:2048 lds
v_mfma_f32_16x16x32_bf16 a[52:55], v[180:183], v[132:135], a[52:55]
v_mfma_f32_16x16x32_bf16 a[56:59], v[184:187], v[132:135], a[56:59]
ds_read_b128 v[72:75], v16 offset:4096
s_add_u32 s62, s65, 46080
v_mfma_f32_16x16x32_bf16 a[60:63], v[188:191], v[132:135], a[60:63]
v_mfma_f32_16x16x32_bf16 a[64:67], v[160:163], v[136:139], a[64:67]
ds_read_b64_tr_b16 v[104:105], v19
buffer_load_dwordx4 v9, s[8:11], s62 offen offset:3072 lds
v_mfma_f32_16x16x32_bf16 a[68:71], v[164:167], v[136:139], a[68:71]
v_mfma_f32_16x16x32_bf16 a[72:75], v[168:171], v[136:139], a[72:75]
s_add_u32 m0, s63, 36864
v_mfma_f32_16x16x32_bf16 a[76:79], v[172:175], v[136:139], a[76:79]
ds_read_b64_tr_b16 v[106:107], v19 offset:2048
v_mfma_f32_16x16x32_bf16 a[80:83], v[176:179], v[136:139], a[80:83]
s_add_u32 s62, s65, 65536
v_mfma_f32_16x16x32_bf16 a[84:87], v[180:183], v[136:139], a[84:87]
ds_read_b128 v[76:79], v16 offset:5120
buffer_load_dwordx4 v8, s[8:11], s62 offen lds
v_mfma_f32_16x16x32_bf16 a[88:91], v[184:187], v[136:139], a[88:91]
v_mfma_f32_16x16x32_bf16 a[92:95], v[188:191], v[136:139], a[92:95]
ds_read_b64_tr_b16 v[108:109], v20
s_add_u32 s62, s65, 80896
v_mfma_f32_16x16x32_bf16 a[96:99], v[160:163], v[140:143], a[96:99]
v_mfma_f32_16x16x32_bf16 a[100:103], v[164:167], v[140:143], a[100:103]
ds_read_b64_tr_b16 v[110:111], v20 offset:2048
buffer_load_dwordx4 v8, s[8:11], s62 offen offset:1024 lds
v_mfma_f32_16x16x32_bf16 a[104:107], v[168:171], v[140:143], a[104:107]
v_mfma_f32_16x16x32_bf16 a[108:111], v[172:175], v[140:143], a[108:111]
s_add_u32 s62, s65, 96256
v_mfma_f32_16x16x32_bf16 a[112:115], v[176:179], v[140:143], a[112:115]
ds_read_b128 v[80:83], v16 offset:8192
v_mfma_f32_16x16x32_bf16 a[116:119], v[180:183], v[140:143], a[116:119]
buffer_load_dwordx4 v9, s[8:11], s62 offen offset:2048 lds
v_mfma_f32_16x16x32_bf16 a[120:123], v[184:187], v[140:143], a[120:123]
ds_read_b64_tr_b16 v[112:113], v21
s_add_u32 s62, s65, 111616
v_mfma_f32_16x16x32_bf16 a[124:127], v[188:191], v[140:143], a[124:127]
v_mfma_f32_16x16x32_bf16 a[128:131], v[160:163], v[144:147], a[128:131]
ds_read_b64_tr_b16 v[114:115], v21 offset:2048
buffer_load_dwordx4 v9, s[8:11], s62 offen offset:3072 lds
v_mfma_f32_16x16x32_bf16 a[132:135], v[164:167], v[144:147], a[132:135]
v_mfma_f32_16x16x32_bf16 a[136:139], v[168:171], v[144:147], a[136:139]
ds_read_b128 v[84:87], v16 offset:9216
s_add_u32 s65, s65, 128
v_mfma_f32_16x16x32_bf16 a[140:143], v[172:175], v[144:147], a[140:143]
v_mfma_f32_16x16x32_bf16 a[144:147], v[176:179], v[144:147], a[144:147]
s_add_u32 m0, s64, 114688
v_mfma_f32_16x16x32_bf16 a[148:151], v[180:183], v[144:147], a[148:151]
ds_read_b64_tr_b16 v[116:117], v22
v_mfma_f32_16x16x32_bf16 a[152:155], v[184:187], v[144:147], a[152:155]
s_nop 0
v_mfma_f32_16x16x32_bf16 a[156:159], v[188:191], v[144:147], a[156:159]
ds_read_b64_tr_b16 v[118:119], v22 offset:2048
buffer_load_dwordx4 v12, s[12:15], s66 offen lds
v_mfma_f32_16x16x32_bf16 a[160:163], v[160:163], v[148:151], a[160:163]
v_mfma_f32_16x16x32_bf16 a[164:167], v[164:167], v[148:151], a[164:167]
ds_read_b128 v[88:91], v16 offset:12288
buffer_load_dwordx4 v13, s[12:15], s66 offen offset:1024 lds
v_mfma_f32_16x16x32_bf16 a[168:171], v[168:171], v[148:151], a[168:171]
v_mfma_f32_16x16x32_bf16 a[172:175], v[172:175], v[148:151], a[172:175]
ds_read_b64_tr_b16 v[120:121], v23
buffer_load_dwordx4 v14, s[12:15], s66 offen offset:2048 lds
v_mfma_f32_16x16x32_bf16 a[176:179], v[176:179], v[148:151], a[176:179]
v_mfma_f32_16x16x32_bf16 a[180:183], v[180:183], v[148:151], a[180:183]
buffer_load_dwordx4 v15, s[12:15], s66 offen offset:3072 lds
v_mfma_f32_16x16x32_bf16 a[184:187], v[184:187], v[148:151], a[184:187]
ds_read_b64_tr_b16 v[122:123], v23 offset:2048
v_mfma_f32_16x16x32_bf16 a[188:191], v[188:191], v[148:151], a[188:191]
s_add_u32 s66, s66, 262144
v_mfma_f32_16x16x32_bf16 a[192:195], v[160:163], v[152:155], a[192:195]
ds_read_b128 v[92:95], v16 offset:13312
v_mfma_f32_16x16x32_bf16 a[196:199], v[164:167], v[152:155], a[196:199]
v_mfma_f32_16x16x32_bf16 a[200:203], v[168:171], v[152:155], a[200:203]
ds_read_b64_tr_b16 v[124:125], v24
v_mfma_f32_16x16x32_bf16 a[204:207], v[172:175], v[152:155], a[204:207]
v_mfma_f32_16x16x32_bf16 a[208:211], v[176:179], v[152:155], a[208:211]
ds_read_b64_tr_b16 v[126:127], v24 offset:2048
v_mfma_f32_16x16x32_bf16 a[212:215], v[180:183], v[152:155], a[212:215]
v_mfma_f32_16x16x32_bf16 a[216:219], v[184:187], v[152:155], a[216:219]
v_mfma_f32_16x16x32_bf16 a[220:223], v[188:191], v[152:155], a[220:223]
v_mfma_f32_16x16x32_bf16 a[224:227], v[160:163], v[156:159], a[224:227]
v_mfma_f32_16x16x32_bf16 a[228:231], v[164:167], v[156:159], a[228:231]
v_mfma_f32_16x16x32_bf16 a[232:235], v[168:171], v[156:159], a[232:235]
v_mfma_f32_16x16x32_bf16 a[236:239], v[172:175], v[156:159], a[236:239]
v_mfma_f32_16x16x32_bf16 a[240:243], v[176:179], v[156:159], a[240:243]
v_mfma_f32_16x16x32_bf16 a[244:247], v[180:183], v[156:159], a[244:247]
v_mfma_f32_16x16x32_bf16 a[248:251], v[184:187], v[156:159], a[248:251]
v_mfma_f32_16x16x32_bf16 a[252:255], v[188:191], v[156:159], a[252:255]
s_waitcnt lgkmcnt(0)
v_mfma_f32_16x16x32_bf16 a[0:3], v[96:99], v[64:67], a[0:3]
s_waitcnt vmcnt(19)
s_barrier
v_mfma_f32_16x16x32_bf16 a[4:7], v[100:103], v[64:67], a[4:7]
ds_read_b128 v[128:131], v10
v_mfma_f32_16x16x32_bf16 a[8:11], v[104:107], v[64:67], a[8:11]
s_add_u32 m0, s64, 65536
v_mfma_f32_16x16x32_bf16 a[12:15], v[108:111], v[64:67], a[12:15]
ds_read_b64_tr_b16 v[160:161], v17 offset:16384
v_mfma_f32_16x16x32_bf16 a[16:19], v[112:115], v[64:67], a[16:19]
v_mfma_f32_16x16x32_bf16 a[20:23], v[116:119], v[64:67], a[20:23]
ds_read_b64_tr_b16 v[162:163], v17 offset:18432
v_mfma_f32_16x16x32_bf16 a[24:27], v[120:123], v[64:67], a[24:27]
v_mfma_f32_16x16x32_bf16 a[28:31], v[124:127], v[64:67], a[28:31]
ds_read_b128 v[132:135], v10 offset:1024
v_mfma_f32_16x16x32_bf16 a[32:35], v[96:99], v[68:71], a[32:35]
s_nop 0
v_mfma_f32_16x16x32_bf16 a[36:39], v[100:103], v[68:71], a[36:39]
v_mfma_f32_16x16x32_bf16 a[40:43], v[104:107], v[68:71], a[40:43]
ds_read_b64_tr_b16 v[164:165], v18 offset:16384
v_mfma_f32_16x16x32_bf16 a[44:47], v[108:111], v[68:71], a[44:47]
v_mfma_f32_16x16x32_bf16 a[48:51], v[112:115], v[68:71], a[48:51]
ds_read_b64_tr_b16 v[166:167], v18 offset:18432
v_mfma_f32_16x16x32_bf16 a[52:55], v[116:119], v[68:71], a[52:55]
v_mfma_f32_16x16x32_bf16 a[56:59], v[120:123], v[68:71], a[56:59]
ds_read_b128 v[136:139], v10 offset:4096
v_mfma_f32_16x16x32_bf16 a[60:63], v[124:127], v[68:71], a[60:63]
buffer_load_dwordx4 v12, s[12:15], s66 offen lds
v_mfma_f32_16x16x32_bf16 a[64:67], v[96:99], v[72:75], a[64:67]
ds_read_b64_tr_b16 v[168:169], v19 offset:16384
v_mfma_f32_16x16x32_bf16 a[68:71], v[100:103], v[72:75], a[68:71]
v_mfma_f32_16x16x32_bf16 a[72:75], v[104:107], v[72:75], a[72:75]
v_mfma_f32_16x16x32_bf16 a[76:79], v[108:111], v[72:75], a[76:79]
ds_read_b64_tr_b16 v[170:171], v19 offset:18432
v_mfma_f32_16x16x32_bf16 a[80:83], v[112:115], v[72:75], a[80:83]
v_mfma_f32_16x16x32_bf16 a[84:87], v[116:119], v[72:75], a[84:87]
ds_read_b128 v[140:143], v10 offset:5120
v_mfma_f32_16x16x32_bf16 a[88:91], v[120:123], v[72:75], a[88:91]
buffer_load_dwordx4 v13, s[12:15], s66 offen offset:1024 lds
v_mfma_f32_16x16x32_bf16 a[92:95], v[124:127], v[72:75], a[92:95]
ds_read_b64_tr_b16 v[172:173], v20 offset:16384
v_mfma_f32_16x16x32_bf16 a[96:99], v[96:99], v[76:79], a[96:99]
v_mfma_f32_16x16x32_bf16 a[100:103], v[100:103], v[76:79], a[100:103]
ds_read_b64_tr_b16 v[174:175], v20 offset:18432
v_mfma_f32_16x16x32_bf16 a[104:107], v[104:107], v[76:79], a[104:107]
v_mfma_f32_16x16x32_bf16 a[108:111], v[108:111], v[76:79], a[108:111]
v_mfma_f32_16x16x32_bf16 a[112:115], v[112:115], v[76:79], a[112:115]
ds_read_b128 v[144:147], v10 offset:8192
buffer_load_dwordx4 v14, s[12:15], s66 offen offset:2048 lds
v_mfma_f32_16x16x32_bf16 a[116:119], v[116:119], v[76:79], a[116:119]
v_mfma_f32_16x16x32_bf16 a[120:123], v[120:123], v[76:79], a[120:123]
ds_read_b64_tr_b16 v[176:177], v21 offset:16384
v_mfma_f32_16x16x32_bf16 a[124:127], v[124:127], v[76:79], a[124:127]
v_mfma_f32_16x16x32_bf16 a[128:131], v[96:99], v[80:83], a[128:131]
ds_read_b64_tr_b16 v[178:179], v21 offset:18432
v_mfma_f32_16x16x32_bf16 a[132:135], v[100:103], v[80:83], a[132:135]
v_mfma_f32_16x16x32_bf16 a[136:139], v[104:107], v[80:83], a[136:139]
ds_read_b128 v[148:151], v10 offset:9216
v_mfma_f32_16x16x32_bf16 a[140:143], v[108:111], v[80:83], a[140:143]
buffer_load_dwordx4 v15, s[12:15], s66 offen offset:3072 lds
v_mfma_f32_16x16x32_bf16 a[144:147], v[112:115], v[80:83], a[144:147]
v_mfma_f32_16x16x32_bf16 a[148:151], v[116:119], v[80:83], a[148:151]
ds_read_b64_tr_b16 v[180:181], v22 offset:16384
v_mfma_f32_16x16x32_bf16 a[152:155], v[120:123], v[80:83], a[152:155]
v_mfma_f32_16x16x32_bf16 a[156:159], v[124:127], v[80:83], a[156:159]
ds_read_b64_tr_b16 v[182:183], v22 offset:18432
v_mfma_f32_16x16x32_bf16 a[160:163], v[96:99], v[84:87], a[160:163]
v_mfma_f32_16x16x32_bf16 a[164:167], v[100:103], v[84:87], a[164:167]
ds_read_b128 v[152:155], v10 offset:12288
v_mfma_f32_16x16x32_bf16 a[168:171], v[104:107], v[84:87], a[168:171]
s_add_u32 s66, s66, 262144
v_mfma_f32_16x16x32_bf16 a[172:175], v[108:111], v[84:87], a[172:175]
ds_read_b64_tr_b16 v[184:185], v23 offset:16384
v_mfma_f32_16x16x32_bf16 a[176:179], v[112:115], v[84:87], a[176:179]
v_mfma_f32_16x16x32_bf16 a[180:183], v[116:119], v[84:87], a[180:183]
v_mfma_f32_16x16x32_bf16 a[184:187], v[120:123], v[84:87], a[184:187]
ds_read_b64_tr_b16 v[186:187], v23 offset:18432
v_mfma_f32_16x16x32_bf16 a[188:191], v[124:127], v[84:87], a[188:191]
v_mfma_f32_16x16x32_bf16 a[192:195], v[96:99], v[88:91], a[192:195]
ds_read_b128 v[156:159], v10 offset:13312
v_mfma_f32_16x16x32_bf16 a[196:199], v[100:103], v[88:91], a[196:199]
v_mfma_f32_16x16x32_bf16 a[200:203], v[104:107], v[88:91], a[200:203]
ds_read_b64_tr_b16 v[188:189], v24 offset:16384
global_load_dword v59, v29, s[92:93] sc1
v_mfma_f32_16x16x32_bf16 a[204:207], v[108:111], v[88:91], a[204:207]
v_mfma_f32_16x16x32_bf16 a[208:211], v[112:115], v[88:91], a[208:211]
ds_read_b64_tr_b16 v[190:191], v24 offset:18432
v_mfma_f32_16x16x32_bf16 a[212:215], v[116:119], v[88:91], a[212:215]
v_mfma_f32_16x16x32_bf16 a[216:219], v[120:123], v[88:91], a[216:219]
v_mfma_f32_16x16x32_bf16 a[220:223], v[124:127], v[88:91], a[220:223]
v_mfma_f32_16x16x32_bf16 a[224:227], v[96:99], v[92:95], a[224:227]
v_mfma_f32_16x16x32_bf16 a[228:231], v[100:103], v[92:95], a[228:231]
v_mfma_f32_16x16x32_bf16 a[232:235], v[104:107], v[92:95], a[232:235]
v_mfma_f32_16x16x32_bf16 a[236:239], v[108:111], v[92:95], a[236:239]
v_mfma_f32_16x16x32_bf16 a[240:243], v[112:115], v[92:95], a[240:243]
v_mfma_f32_16x16x32_bf16 a[244:247], v[116:119], v[92:95], a[244:247]
v_mfma_f32_16x16x32_bf16 a[248:251], v[120:123], v[92:95], a[248:251]
v_mfma_f32_16x16x32_bf16 a[252:255], v[124:127], v[92:95], a[252:255]
s_waitcnt lgkmcnt(0)
v_mfma_f32_16x16x32_bf16 a[0:3], v[160:163], v[128:131], a[0:3]
s_waitcnt vmcnt(9)
s_barrier
v_mfma_f32_16x16x32_bf16 a[4:7], v[164:167], v[128:131], a[4:7]
ds_read_b128 v[64:67], v16 offset:32768
v_mfma_f32_16x16x32_bf16 a[8:11], v[168:171], v[128:131], a[8:11]
s_add_u32 m0, s63, 0
v_mfma_f32_16x16x32_bf16 a[12:15], v[172:175], v[128:131], a[12:15]
ds_read_b64_tr_b16 v[96:97], v17 offset:32768
s_add_u32 s62, s65, 0
v_mfma_f32_16x16x32_bf16 a[16:19], v[176:179], v[128:131], a[16:19]
v_mfma_f32_16x16x32_bf16 a[20:23], v[180:183], v[128:131], a[20:23]
ds_read_b64_tr_b16 v[98:99], v17 offset:34816
buffer_load_dwordx4 v8, s[8:11], s62 offen lds
v_mfma_f32_16x16x32_bf16 a[24:27], v[184:187], v[128:131], a[24:27]
v_mfma_f32_16x16x32_bf16 a[28:31], v[188:191], v[128:131], a[28:31]
ds_read_b128 v[68:71], v16 offset:33792
s_add_u32 s62, s65, 15360
v_mfma_f32_16x16x32_bf16 a[32:35], v[160:163], v[132:135], a[32:35]
v_mfma_f32_16x16x32_bf16 a[36:39], v[164:167], v[132:135], a[36:39]
buffer_load_dwordx4 v8, s[8:11], s62 offen offset:1024 lds
v_mfma_f32_16x16x32_bf16 a[40:43], v[168:171], v[132:135], a[40:43]
ds_read_b64_tr_b16 v[100:101], v18 offset:32768
v_mfma_f32_16x16x32_bf16 a[44:47], v[172:175], v[132:135], a[44:47]
s_add_u32 s62, s65, 30720
v_mfma_f32_16x16x32_bf16 a[48:51], v[176:179], v[132:135], a[48:51]
ds_read_b64_tr_b16 v[102:103], v18 offset:34816
buffer_load_dwordx4 v9, s[8:11], s62 offen offset:2048 lds
v_mfma_f32_16x16x32_bf16 a[52:55], v[180:183], v[132:135], a[52:55]
v_mfma_f32_16x16x32_bf16 a[56:59], v[184:187], v[132:135], a[56:59]
ds_read_b128 v[72:75], v16 offset:36864
s_add_u32 s62, s65, 46080
v_mfma_f32_16x16x32_bf16 a[60:63], v[188:191], v[132:135], a[60:63]
v_mfma_f32_16x16x32_bf16 a[64:67], v[160:163], v[136:139], a[64:67]
ds_read_b64_tr_b16 v[104:105], v19 offset:32768
buffer_load_dwordx4 v9, s[8:11], s62 offen offset:3072 lds
v_mfma_f32_16x16x32_bf16 a[68:71], v[164:167], v[136:139], a[68:71]
v_mfma_f32_16x16x32_bf16 a[72:75], v[168:171], v[136:139], a[72:75]
s_add_u32 m0, s63, 4096
v_mfma_f32_16x16x32_bf16 a[76:79], v[172:175], v[136:139], a[76:79]
ds_read_b64_tr_b16 v[106:107], v19 offset:34816
v_mfma_f32_16x16x32_bf16 a[80:83], v[176:179], v[136:139], a[80:83]
s_add_u32 s62, s65, 65536
v_mfma_f32_16x16x32_bf16 a[84:87], v[180:183], v[136:139], a[84:87]
ds_read_b128 v[76:79], v16 offset:37888
buffer_load_dwordx4 v8, s[8:11], s62 offen lds
v_mfma_f32_16x16x32_bf16 a[88:91], v[184:187], v[136:139], a[88:91]
v_mfma_f32_16x16x32_bf16 a[92:95], v[188:191], v[136:139], a[92:95]
ds_read_b64_tr_b16 v[108:109], v20 offset:32768
s_add_u32 s62, s65, 80896
v_mfma_f32_16x16x32_bf16 a[96:99], v[160:163], v[140:143], a[96:99]
v_mfma_f32_16x16x32_bf16 a[100:103], v[164:167], v[140:143], a[100:103]
ds_read_b64_tr_b16 v[110:111], v20 offset:34816
buffer_load_dwordx4 v8, s[8:11], s62 offen offset:1024 lds
v_mfma_f32_16x16x32_bf16 a[104:107], v[168:171], v[140:143], a[104:107]
v_mfma_f32_16x16x32_bf16 a[108:111], v[172:175], v[140:143], a[108:111]
s_add_u32 s62, s65, 96256
v_mfma_f32_16x16x32_bf16 a[112:115], v[176:179], v[140:143], a[112:115]
ds_read_b128 v[80:83], v16 offset:40960
v_mfma_f32_16x16x32_bf16 a[116:119], v[180:183], v[140:143], a[116:119]
buffer_load_dwordx4 v9, s[8:11], s62 offen offset:2048 lds
v_mfma_f32_16x16x32_bf16 a[120:123], v[184:187], v[140:143], a[120:123]
ds_read_b64_tr_b16 v[112:113], v21 offset:32768
s_add_u32 s62, s65, 111616
v_mfma_f32_16x16x32_bf16 a[124:127], v[188:191], v[140:143], a[124:127]
v_mfma_f32_16x16x32_bf16 a[128:131], v[160:163], v[144:147], a[128:131]
ds_read_b64_tr_b16 v[114:115], v21 offset:34816
buffer_load_dwordx4 v9, s[8:11], s62 offen offset:3072 lds
v_mfma_f32_16x16x32_bf16 a[132:135], v[164:167], v[144:147], a[132:135]
v_mfma_f32_16x16x32_bf16 a[136:139], v[168:171], v[144:147], a[136:139]
ds_read_b128 v[84:87], v16 offset:41984
s_add_u32 s65, s65, 128
v_mfma_f32_16x16x32_bf16 a[140:143], v[172:175], v[144:147], a[140:143]
v_mfma_f32_16x16x32_bf16 a[144:147], v[176:179], v[144:147], a[144:147]
s_add_u32 m0, s64, 81920
v_mfma_f32_16x16x32_bf16 a[148:151], v[180:183], v[144:147], a[148:151]
ds_read_b64_tr_b16 v[116:117], v22 offset:32768
v_mfma_f32_16x16x32_bf16 a[152:155], v[184:187], v[144:147], a[152:155]
s_nop 0
v_mfma_f32_16x16x32_bf16 a[156:159], v[188:191], v[144:147], a[156:159]
ds_read_b64_tr_b16 v[118:119], v22 offset:34816
buffer_load_dwordx4 v12, s[12:15], s66 offen lds
v_mfma_f32_16x16x32_bf16 a[160:163], v[160:163], v[148:151], a[160:163]
v_mfma_f32_16x16x32_bf16 a[164:167], v[164:167], v[148:151], a[164:167]
ds_read_b128 v[88:91], v16 offset:45056
buffer_load_dwordx4 v13, s[12:15], s66 offen offset:1024 lds
v_mfma_f32_16x16x32_bf16 a[168:171], v[168:171], v[148:151], a[168:171]
v_mfma_f32_16x16x32_bf16 a[172:175], v[172:175], v[148:151], a[172:175]
ds_read_b64_tr_b16 v[120:121], v23 offset:32768
buffer_load_dwordx4 v14, s[12:15], s66 offen offset:2048 lds
v_mfma_f32_16x16x32_bf16 a[176:179], v[176:179], v[148:151], a[176:179]
v_mfma_f32_16x16x32_bf16 a[180:183], v[180:183], v[148:151], a[180:183]
buffer_load_dwordx4 v15, s[12:15], s66 offen offset:3072 lds
v_mfma_f32_16x16x32_bf16 a[184:187], v[184:187], v[148:151], a[184:187]
ds_read_b64_tr_b16 v[122:123], v23 offset:34816
v_mfma_f32_16x16x32_bf16 a[188:191], v[188:191], v[148:151], a[188:191]
s_add_u32 s66, s66, 262144
v_mfma_f32_16x16x32_bf16 a[192:195], v[160:163], v[152:155], a[192:195]
ds_read_b128 v[92:95], v16 offset:46080
v_mfma_f32_16x16x32_bf16 a[196:199], v[164:167], v[152:155], a[196:199]
v_mfma_f32_16x16x32_bf16 a[200:203], v[168:171], v[152:155], a[200:203]
ds_read_b64_tr_b16 v[124:125], v24 offset:32768
v_add_u32 v242, 0x100000, v242
global_load_dword v245, v242, s[98:99]
v_mfma_f32_16x16x32_bf16 a[204:207], v[172:175], v[152:155], a[204:207]
v_mfma_f32_16x16x32_bf16 a[208:211], v[176:179], v[152:155], a[208:211]
ds_read_b64_tr_b16 v[126:127], v24 offset:34816
v_mfma_f32_16x16x32_bf16 a[212:215], v[180:183], v[152:155], a[212:215]
v_mfma_f32_16x16x32_bf16 a[216:219], v[184:187], v[152:155], a[216:219]
v_mfma_f32_16x16x32_bf16 a[220:223], v[188:191], v[152:155], a[220:223]
v_mfma_f32_16x16x32_bf16 a[224:227], v[160:163], v[156:159], a[224:227]
v_mfma_f32_16x16x32_bf16 a[228:231], v[164:167], v[156:159], a[228:231]
v_mfma_f32_16x16x32_bf16 a[232:235], v[168:171], v[156:159], a[232:235]
v_mfma_f32_16x16x32_bf16 a[236:239], v[172:175], v[156:159], a[236:239]
v_mfma_f32_16x16x32_bf16 a[240:243], v[176:179], v[156:159], a[240:243]
v_mfma_f32_16x16x32_bf16 a[244:247], v[180:183], v[156:159], a[244:247]
v_mfma_f32_16x16x32_bf16 a[248:251], v[184:187], v[156:159], a[248:251]
v_mfma_f32_16x16x32_bf16 a[252:255], v[188:191], v[156:159], a[252:255]
s_waitcnt lgkmcnt(0)
v_mfma_f32_16x16x32_bf16 a[0:3], v[96:99], v[64:67], a[0:3]
s_waitcnt vmcnt(18)
s_barrier
v_mfma_f32_16x16x32_bf16 a[4:7], v[100:103], v[64:67], a[4:7]
ds_read_b128 v[128:131], v10 offset:32768
v_mfma_f32_16x16x32_bf16 a[8:11], v[104:107], v[64:67], a[8:11]
s_add_u32 m0, s64, 98304
v_mfma_f32_16x16x32_bf16 a[12:15], v[108:111], v[64:67], a[12:15]
ds_read_b64_tr_b16 v[160:161], v17 offset:49152
v_mfma_f32_16x16x32_bf16 a[16:19], v[112:115], v[64:67], a[16:19]
v_mfma_f32_16x16x32_bf16 a[20:23], v[116:119], v[64:67], a[20:23]
ds_read_b64_tr_b16 v[162:163], v17 offset:51200
v_mfma_f32_16x16x32_bf16 a[24:27], v[120:123], v[64:67], a[24:27]
v_mfma_f32_16x16x32_bf16 a[28:31], v[124:127], v[64:67], a[28:31]
ds_read_b128 v[132:135], v10 offset:33792
v_mfma_f32_16x16x32_bf16 a[32:35], v[96:99], v[68:71], a[32:35]
s_nop 0
v_mfma_f32_16x16x32_bf16 a[36:39], v[100:103], v[68:71], a[36:39]
v_mfma_f32_16x16x32_bf16 a[40:43], v[104:107], v[68:71], a[40:43]
ds_read_b64_tr_b16 v[164:165], v18 offset:49152
v_mfma_f32_16x16x32_bf16 a[44:47], v[108:111], v[68:71], a[44:47]
v_mfma_f32_16x16x32_bf16 a[48:51], v[112:115], v[68:71], a[48:51]
ds_read_b64_tr_b16 v[166:167], v18 offset:51200
v_mfma_f32_16x16x32_bf16 a[52:55], v[116:119], v[68:71], a[52:55]
v_mfma_f32_16x16x32_bf16 a[56:59], v[120:123], v[68:71], a[56:59]
ds_read_b128 v[136:139], v10 offset:36864
v_mfma_f32_16x16x32_bf16 a[60:63], v[124:127], v[68:71], a[60:63]
buffer_load_dwordx4 v12, s[12:15], s66 offen lds
v_mfma_f32_16x16x32_bf16 a[64:67], v[96:99], v[72:75], a[64:67]
ds_read_b64_tr_b16 v[168:169], v19 offset:49152
v_mfma_f32_16x16x32_bf16 a[68:71], v[100:103], v[72:75], a[68:71]
v_mfma_f32_16x16x32_bf16 a[72:75], v[104:107], v[72:75], a[72:75]
v_mfma_f32_16x16x32_bf16 a[76:79], v[108:111], v[72:75], a[76:79]
ds_read_b64_tr_b16 v[170:171], v19 offset:51200
v_mfma_f32_16x16x32_bf16 a[80:83], v[112:115], v[72:75], a[80:83]
v_mfma_f32_16x16x32_bf16 a[84:87], v[116:119], v[72:75], a[84:87]
ds_read_b128 v[140:143], v10 offset:37888
v_mfma_f32_16x16x32_bf16 a[88:91], v[120:123], v[72:75], a[88:91]
buffer_load_dwordx4 v13, s[12:15], s66 offen offset:1024 lds
v_mfma_f32_16x16x32_bf16 a[92:95], v[124:127], v[72:75], a[92:95]
ds_read_b64_tr_b16 v[172:173], v20 offset:49152
v_mfma_f32_16x16x32_bf16 a[96:99], v[96:99], v[76:79], a[96:99]
v_mfma_f32_16x16x32_bf16 a[100:103], v[100:103], v[76:79], a[100:103]
ds_read_b64_tr_b16 v[174:175], v20 offset:51200
v_mfma_f32_16x16x32_bf16 a[104:107], v[104:107], v[76:79], a[104:107]
v_mfma_f32_16x16x32_bf16 a[108:111], v[108:111], v[76:79], a[108:111]
v_mfma_f32_16x16x32_bf16 a[112:115], v[112:115], v[76:79], a[112:115]
ds_read_b128 v[144:147], v10 offset:40960
buffer_load_dwordx4 v14, s[12:15], s66 offen offset:2048 lds
v_mfma_f32_16x16x32_bf16 a[116:119], v[116:119], v[76:79], a[116:119]
v_mfma_f32_16x16x32_bf16 a[120:123], v[120:123], v[76:79], a[120:123]
ds_read_b64_tr_b16 v[176:177], v21 offset:49152
v_mfma_f32_16x16x32_bf16 a[124:127], v[124:127], v[76:79], a[124:127]
v_mfma_f32_16x16x32_bf16 a[128:131], v[96:99], v[80:83], a[128:131]
ds_read_b64_tr_b16 v[178:179], v21 offset:51200
v_mfma_f32_16x16x32_bf16 a[132:135], v[100:103], v[80:83], a[132:135]
v_mfma_f32_16x16x32_bf16 a[136:139], v[104:107], v[80:83], a[136:139]
ds_read_b128 v[148:151], v10 offset:41984
v_mfma_f32_16x16x32_bf16 a[140:143], v[108:111], v[80:83], a[140:143]
buffer_load_dwordx4 v15, s[12:15], s66 offen offset:3072 lds
v_mfma_f32_16x16x32_bf16 a[144:147], v[112:115], v[80:83], a[144:147]
v_mfma_f32_16x16x32_bf16 a[148:151], v[116:119], v[80:83], a[148:151]
ds_read_b64_tr_b16 v[180:181], v22 offset:49152
v_mfma_f32_16x16x32_bf16 a[152:155], v[120:123], v[80:83], a[152:155]
v_mfma_f32_16x16x32_bf16 a[156:159], v[124:127], v[80:83], a[156:159]
ds_read_b64_tr_b16 v[182:183], v22 offset:51200
v_mfma_f32_16x16x32_bf16 a[160:163], v[96:99], v[84:87], a[160:163]
v_mfma_f32_16x16x32_bf16 a[164:167], v[100:103], v[84:87], a[164:167]
ds_read_b128 v[152:155], v10 offset:45056
v_mfma_f32_16x16x32_bf16 a[168:171], v[104:107], v[84:87], a[168:171]
s_add_u32 s66, s66, 262144
v_mfma_f32_16x16x32_bf16 a[172:175], v[108:111], v[84:87], a[172:175]
ds_read_b64_tr_b16 v[184:185], v23 offset:49152
v_mfma_f32_16x16x32_bf16 a[176:179], v[112:115], v[84:87], a[176:179]
v_mfma_f32_16x16x32_bf16 a[180:183], v[116:119], v[84:87], a[180:183]
v_mfma_f32_16x16x32_bf16 a[184:187], v[120:123], v[84:87], a[184:187]
ds_read_b64_tr_b16 v[186:187], v23 offset:51200
v_mfma_f32_16x16x32_bf16 a[188:191], v[124:127], v[84:87], a[188:191]
v_mfma_f32_16x16x32_bf16 a[192:195], v[96:99], v[88:91], a[192:195]
ds_read_b128 v[156:159], v10 offset:46080
v_mfma_f32_16x16x32_bf16 a[196:199], v[100:103], v[88:91], a[196:199]
v_mfma_f32_16x16x32_bf16 a[200:203], v[104:107], v[88:91], a[200:203]
ds_read_b64_tr_b16 v[188:189], v24 offset:49152
v_mfma_f32_16x16x32_bf16 a[204:207], v[108:111], v[88:91], a[204:207]
v_mfma_f32_16x16x32_bf16 a[208:211], v[112:115], v[88:91], a[208:211]
ds_read_b64_tr_b16 v[190:191], v24 offset:51200
v_mfma_f32_16x16x32_bf16 a[212:215], v[116:119], v[88:91], a[212:215]
v_mfma_f32_16x16x32_bf16 a[216:219], v[120:123], v[88:91], a[216:219]
v_mfma_f32_16x16x32_bf16 a[220:223], v[124:127], v[88:91], a[220:223]
v_mfma_f32_16x16x32_bf16 a[224:227], v[96:99], v[92:95], a[224:227]
v_mfma_f32_16x16x32_bf16 a[228:231], v[100:103], v[92:95], a[228:231]
v_mfma_f32_16x16x32_bf16 a[232:235], v[104:107], v[92:95], a[232:235]
v_mfma_f32_16x16x32_bf16 a[236:239], v[108:111], v[92:95], a[236:239]
v_mfma_f32_16x16x32_bf16 a[240:243], v[112:115], v[92:95], a[240:243]
v_mfma_f32_16x16x32_bf16 a[244:247], v[116:119], v[92:95], a[244:247]
v_mfma_f32_16x16x32_bf16 a[248:251], v[120:123], v[92:95], a[248:251]
v_mfma_f32_16x16x32_bf16 a[252:255], v[124:127], v[92:95], a[252:255]
s_waitcnt lgkmcnt(0)
v_mfma_f32_16x16x32_bf16 a[0:3], v[160:163], v[128:131], a[0:3]
s_waitcnt vmcnt(9)
s_barrier
v_mfma_f32_16x16x32_bf16 a[4:7], v[164:167], v[128:131], a[4:7]
ds_read_b128 v[64:67], v16
v_mfma_f32_16x16x32_bf16 a[8:11], v[168:171], v[128:131], a[8:11]
s_add_u32 m0, s63, 32768
v_mfma_f32_16x16x32_bf16 a[12:15], v[172:175], v[128:131], a[12:15]
ds_read_b64_tr_b16 v[96:97], v17
s_add_u32 s62, s65, 0
v_mfma_f32_16x16x32_bf16 a[16:19], v[176:179], v[128:131], a[16:19]
v_mfma_f32_16x16x32_bf16 a[20:23], v[180:183], v[128:131], a[20:23]
ds_read_b64_tr_b16 v[98:99], v17 offset:2048
buffer_load_dwordx4 v8, s[8:11], s62 offen lds
v_mfma_f32_16x16x32_bf16 a[24:27], v[184:187], v[128:131], a[24:27]
v_mfma_f32_16x16x32_bf16 a[28:31], v[188:191], v[128:131], a[28:31]
ds_read_b128 v[68:71], v16 offset:1024
s_add_u32 s62, s65, 15360
v_mfma_f32_16x16x32_bf16 a[32:35], v[160:163], v[132:135], a[32:35]
v_mfma_f32_16x16x32_bf16 a[36:39], v[164:167], v[132:135], a[36:39]
buffer_load_dwordx4 v8, s[8:11], s62 offen offset:1024 lds
v_mfma_f32_16x16x32_bf16 a[40:43], v[168:171], v[132:135], a[40:43]
ds_read_b64_tr_b16 v[100:101], v18
v_mfma_f32_16x16x32_bf16 a[44:47], v[172:175], v[132:135], a[44:47]
s_add_u32 s62, s65, 30720
v_mfma_f32_16x16x32_bf16 a[48:51], v[176:179], v[132:135], a[48:51]
ds_read_b64_tr_b16 v[102:103], v18 offset:2048
buffer_load_dwordx4 v9, s[8:11], s62 offen offset:2048 lds
v_mfma_f32_16x16x32_bf16 a[52:55], v[180:183], v[132:135], a[52:55]
v_mfma_f32_16x16x32_bf16 a[56:59], v[184:187], v[132:135], a[56:59]
ds_read_b128 v[72:75], v16 offset:4096
s_add_u32 s62, s65, 46080
v_mfma_f32_16x16x32_bf16 a[60:63], v[188:191], v[132:135], a[60:63]
v_mfma_f32_16x16x32_bf16 a[64:67], v[160:163], v[136:139], a[64:67]
ds_read_b64_tr_b16 v[104:105], v19
buffer_load_dwordx4 v9, s[8:11], s62 offen offset:3072 lds
v_mfma_f32_16x16x32_bf16 a[68:71], v[164:167], v[136:139], a[68:71]
v_mfma_f32_16x16x32_bf16 a[72:75], v[168:171], v[136:139], a[72:75]
s_add_u32 m0, s63, 36864
v_mfma_f32_16x16x32_bf16 a[76:79], v[172:175], v[136:139], a[76:79]
ds_read_b64_tr_b16 v[106:107], v19 offset:2048
v_mfma_f32_16x16x32_bf16 a[80:83], v[176:179], v[136:139], a[80:83]
s_add_u32 s62, s65, 65536
v_mfma_f32_16x16x32_bf16 a[84:87], v[180:183], v[136:139], a[84:87]
ds_read_b128 v[76:79], v16 offset:5120
buffer_load_dwordx4 v8, s[8:11], s62 offen lds
v_mfma_f32_16x16x32_bf16 a[88:91], v[184:187], v[136:139], a[88:91]
v_mfma_f32_16x16x32_bf16 a[92:95], v[188:191], v[136:139], a[92:95]
ds_read_b64_tr_b16 v[108:109], v20
s_add_u32 s62, s65, 80896
v_mfma_f32_16x16x32_bf16 a[96:99], v[160:163], v[140:143], a[96:99]
v_mfma_f32_16x16x32_bf16 a[100:103], v[164:167], v[140:143], a[100:103]
ds_read_b64_tr_b16 v[110:111], v20 offset:2048
buffer_load_dwordx4 v8, s[8:11], s62 offen offset:1024 lds
v_mfma_f32_16x16x32_bf16 a[104:107], v[168:171], v[140:143], a[104:107]
v_mfma_f32_16x16x32_bf16 a[108:111], v[172:175], v[140:143], a[108:111]
s_add_u32 s62, s65, 96256
v_mfma_f32_16x16x32_bf16 a[112:115], v[176:179], v[140:143], a[112:115]
ds_read_b128 v[80:83], v16 offset:8192
v_mfma_f32_16x16x32_bf16 a[116:119], v[180:183], v[140:143], a[116:119]
buffer_load_dwordx4 v9, s[8:11], s62 offen offset:2048 lds
v_mfma_f32_16x16x32_bf16 a[120:123], v[184:187], v[140:143], a[120:123]
ds_read_b64_tr_b16 v[112:113], v21
s_add_u32 s62, s65, 111616
v_mfma_f32_16x16x32_bf16 a[124:127], v[188:191], v[140:143], a[124:127]
v_mfma_f32_16x16x32_bf16 a[128:131], v[160:163], v[144:147], a[128:131]
ds_read_b64_tr_b16 v[114:115], v21 offset:2048
buffer_load_dwordx4 v9, s[8:11], s62 offen offset:3072 lds
v_mfma_f32_16x16x32_bf16 a[132:135], v[164:167], v[144:147], a[132:135]
v_mfma_f32_16x16x32_bf16 a[136:139], v[168:171], v[144:147], a[136:139]
ds_read_b128 v[84:87], v16 offset:9216
s_add_u32 s65, s65, 128
v_mfma_f32_16x16x32_bf16 a[140:143], v[172:175], v[144:147], a[140:143]
v_mfma_f32_16x16x32_bf16 a[144:147], v[176:179], v[144:147], a[144:147]
s_add_u32 m0, s64, 114688
v_mfma_f32_16x16x32_bf16 a[148:151], v[180:183], v[144:147], a[148:151]
ds_read_b64_tr_b16 v[116:117], v22
v_mfma_f32_16x16x32_bf16 a[152:155], v[184:187], v[144:147], a[152:155]
s_nop 0
v_mfma_f32_16x16x32_bf16 a[156:159], v[188:191], v[144:147], a[156:159]
ds_read_b64_tr_b16 v[118:119], v22 offset:2048
buffer_load_dwordx4 v12, s[12:15], s66 offen lds
v_mfma_f32_16x16x32_bf16 a[160:163], v[160:163], v[148:151], a[160:163]
v_mfma_f32_16x16x32_bf16 a[164:167], v[164:167], v[148:151], a[164:167]
ds_read_b128 v[88:91], v16 offset:12288
buffer_load_dwordx4 v13, s[12:15], s66 offen offset:1024 lds
v_mfma_f32_16x16x32_bf16 a[168:171], v[168:171], v[148:151], a[168:171]
v_mfma_f32_16x16x32_bf16 a[172:175], v[172:175], v[148:151], a[172:175]
ds_read_b64_tr_b16 v[120:121], v23
buffer_load_dwordx4 v14, s[12:15], s66 offen offset:2048 lds
v_mfma_f32_16x16x32_bf16 a[176:179], v[176:179], v[148:151], a[176:179]
v_mfma_f32_16x16x32_bf16 a[180:183], v[180:183], v[148:151], a[180:183]
buffer_load_dwordx4 v15, s[12:15], s66 offen offset:3072 lds
v_mfma_f32_16x16x32_bf16 a[184:187], v[184:187], v[148:151], a[184:187]
ds_read_b64_tr_b16 v[122:123], v23 offset:2048
v_mfma_f32_16x16x32_bf16 a[188:191], v[188:191], v[148:151], a[188:191]
s_add_u32 s66, s66, 262144
v_mfma_f32_16x16x32_bf16 a[192:195], v[160:163], v[152:155], a[192:195]
ds_read_b128 v[92:95], v16 offset:13312
v_mfma_f32_16x16x32_bf16 a[196:199], v[164:167], v[152:155], a[196:199]
v_mfma_f32_16x16x32_bf16 a[200:203], v[168:171], v[152:155], a[200:203]
ds_read_b64_tr_b16 v[124:125], v24
s_waitcnt vmcnt(29)
s_mov_b32 s87, 0
DBG_2:
v_cmp_ne_u32 vcc, 1, v59
s_cbranch_vccz DBG_2_OK
s_sleep 1
global_load_dword v59, v29, s[92:93] sc1
s_waitcnt vmcnt(0)
s_add_u32 s87, s87, 1
s_cmp_lt_u32 s87, 65536
s_cbranch_scc1 DBG_2
DBG_2_OK:
v_mfma_f32_16x16x32_bf16 a[204:207], v[172:175], v[152:155], a[204:207]
v_mfma_f32_16x16x32_bf16 a[208:211], v[176:179], v[152:155], a[208:211]
ds_read_b64_tr_b16 v[126:127], v24 offset:2048
v_mfma_f32_16x16x32_bf16 a[212:215], v[180:183], v[152:155], a[212:215]
v_mfma_f32_16x16x32_bf16 a[216:219], v[184:187], v[152:155], a[216:219]
v_mfma_f32_16x16x32_bf16 a[220:223], v[188:191], v[152:155], a[220:223]
v_mfma_f32_16x16x32_bf16 a[224:227], v[160:163], v[156:159], a[224:227]
v_mfma_f32_16x16x32_bf16 a[228:231], v[164:167], v[156:159], a[228:231]
v_mfma_f32_16x16x32_bf16 a[232:235], v[168:171], v[156:159], a[232:235]
v_mfma_f32_16x16x32_bf16 a[236:239], v[172:175], v[156:159], a[236:239]
v_mfma_f32_16x16x32_bf16 a[240:243], v[176:179], v[156:159], a[240:243]
v_mfma_f32_16x16x32_bf16 a[244:247], v[180:183], v[156:159], a[244:247]
v_mfma_f32_16x16x32_bf16 a[248:251], v[184:187], v[156:159], a[248:251]
v_mfma_f32_16x16x32_bf16 a[252:255], v[188:191], v[156:159], a[252:255]
s_waitcnt lgkmcnt(0)
v_mfma_f32_16x16x32_bf16 a[0:3], v[96:99], v[64:67], a[0:3]
s_waitcnt vmcnt(17)
s_barrier
s_lshl_b32 s56, s2, 2
s_cmp_lg_u32 s3, 0
s_cbranch_scc1 SETF_3
s_mov_b64 exec, 1
buffer_store_dword v30, v29, s[88:91], s56 offen sc1
s_mov_b64 exec, -1
SETF_3:
v_mfma_f32_16x16x32_bf16 a[4:7], v[100:103], v[64:67], a[4:7]
ds_read_b128 v[128:131], v10
v_mfma_f32_16x16x32_bf16 a[8:11], v[104:107], v[64:67], a[8:11]
s_add_u32 m0, s64, 65536
v_mfma_f32_16x16x32_bf16 a[12:15], v[108:111], v[64:67], a[12:15]
ds_read_b64_tr_b16 v[160:161], v17 offset:16384
v_mfma_f32_16x16x32_bf16 a[16:19], v[112:115], v[64:67], a[16:19]
v_mfma_f32_16x16x32_bf16 a[20:23], v[116:119], v[64:67], a[20:23]
ds_read_b64_tr_b16 v[162:163], v17 offset:18432
v_mfma_f32_16x16x32_bf16 a[24:27], v[120:123], v[64:67], a[24:27]
v_mfma_f32_16x16x32_bf16 a[28:31], v[124:127], v[64:67], a[28:31]
ds_read_b128 v[132:135], v10 offset:1024
v_mfma_f32_16x16x32_bf16 a[32:35], v[96:99], v[68:71], a[32:35]
s_nop 0
v_mfma_f32_16x16x32_bf16 a[36:39], v[100:103], v[68:71], a[36:39]
v_mfma_f32_16x16x32_bf16 a[40:43], v[104:107], v[68:71], a[40:43]
ds_read_b64_tr_b16 v[164:165], v18 offset:16384
v_mfma_f32_16x16x32_bf16 a[44:47], v[108:111], v[68:71], a[44:47]
v_mfma_f32_16x16x32_bf16 a[48:51], v[112:115], v[68:71], a[48:51]
ds_read_b64_tr_b16 v[166:167], v18 offset:18432
v_mfma_f32_16x16x32_bf16 a[52:55], v[116:119], v[68:71], a[52:55]
v_mfma_f32_16x16x32_bf16 a[56:59], v[120:123], v[68:71], a[56:59]
ds_read_b128 v[136:139], v10 offset:4096
v_mfma_f32_16x16x32_bf16 a[60:63], v[124:127], v[68:71], a[60:63]
buffer_load_dwordx4 v12, s[12:15], s66 offen lds
v_mfma_f32_16x16x32_bf16 a[64:67], v[96:99], v[72:75], a[64:67]
ds_read_b64_tr_b16 v[168:169], v19 offset:16384
v_mfma_f32_16x16x32_bf16 a[68:71], v[100:103], v[72:75], a[68:71]
v_mfma_f32_16x16x32_bf16 a[72:75], v[104:107], v[72:75], a[72:75]
v_mfma_f32_16x16x32_bf16 a[76:79], v[108:111], v[72:75], a[76:79]
ds_read_b64_tr_b16 v[170:171], v19 offset:18432
v_mfma_f32_16x16x32_bf16 a[80:83], v[112:115], v[72:75], a[80:83]
v_mfma_f32_16x16x32_bf16 a[84:87], v[116:119], v[72:75], a[84:87]
ds_read_b128 v[140:143], v10 offset:5120
v_mfma_f32_16x16x32_bf16 a[88:91], v[120:123], v[72:75], a[88:91]
buffer_load_dwordx4 v13, s[12:15], s66 offen offset:1024 lds
v_mfma_f32_16x16x32_bf16 a[92:95], v[124:127], v[72:75], a[92:95]
ds_read_b64_tr_b16 v[172:173], v20 offset:16384
v_mfma_f32_16x16x32_bf16 a[96:99], v[96:99], v[76:79], a[96:99]
v_mfma_f32_16x16x32_bf16 a[100:103], v[100:103], v[76:79], a[100:103]
ds_read_b64_tr_b16 v[174:175], v20 offset:18432
v_mfma_f32_16x16x32_bf16 a[104:107], v[104:107], v[76:79], a[104:107]
v_mfma_f32_16x16x32_bf16 a[108:111], v[108:111], v[76:79], a[108:111]
v_mfma_f32_16x16x32_bf16 a[112:115], v[112:115], v[76:79], a[112:115]
ds_read_b128 v[144:147], v10 offset:8192
buffer_load_dwordx4 v14, s[12:15], s66 offen offset:2048 lds
v_mfma_f32_16x16x32_bf16 a[116:119], v[116:119], v[76:79], a[116:119]
v_mfma_f32_16x16x32_bf16 a[120:123], v[120:123], v[76:79], a[120:123]
ds_read_b64_tr_b16 v[176:177], v21 offset:16384
v_mfma_f32_16x16x32_bf16 a[124:127], v[124:127], v[76:79], a[124:127]
v_mfma_f32_16x16x32_bf16 a[128:131], v[96:99], v[80:83], a[128:131]
ds_read_b64_tr_b16 v[178:179], v21 offset:18432
v_mfma_f32_16x16x32_bf16 a[132:135], v[100:103], v[80:83], a[132:135]
v_mfma_f32_16x16x32_bf16 a[136:139], v[104:107], v[80:83], a[136:139]
ds_read_b128 v[148:151], v10 offset:9216
v_mfma_f32_16x16x32_bf16 a[140:143], v[108:111], v[80:83], a[140:143]
buffer_load_dwordx4 v15, s[12:15], s66 offen offset:3072 lds
v_mfma_f32_16x16x32_bf16 a[144:147], v[112:115], v[80:83], a[144:147]
v_mfma_f32_16x16x32_bf16 a[148:151], v[116:119], v[80:83], a[148:151]
ds_read_b64_tr_b16 v[180:181], v22 offset:16384
v_mfma_f32_16x16x32_bf16 a[152:155], v[120:123], v[80:83], a[152:155]
v_mfma_f32_16x16x32_bf16 a[156:159], v[124:127], v[80:83], a[156:159]
ds_read_b64_tr_b16 v[182:183], v22 offset:18432
v_mfma_f32_16x16x32_bf16 a[160:163], v[96:99], v[84:87], a[160:163]
v_mfma_f32_16x16x32_bf16 a[164:167], v[100:103], v[84:87], a[164:167]
ds_read_b128 v[152:155], v10 offset:12288
v_mfma_f32_16x16x32_bf16 a[168:171], v[104:107], v[84:87], a[168:171]
s_add_u32 s66, s66, 262144
v_mfma_f32_16x16x32_bf16 a[172:175], v[108:111], v[84:87], a[172:175]
ds_read_b64_tr_b16 v[184:185], v23 offset:16384
v_mfma_f32_16x16x32_bf16 a[176:179], v[112:115], v[84:87], a[176:179]
v_mfma_f32_16x16x32_bf16 a[180:183], v[116:119], v[84:87], a[180:183]
v_mfma_f32_16x16x32_bf16 a[184:187], v[120:123], v[84:87], a[184:187]
ds_read_b64_tr_b16 v[186:187], v23 offset:18432
v_mfma_f32_16x16x32_bf16 a[188:191], v[124:127], v[84:87], a[188:191]
v_mfma_f32_16x16x32_bf16 a[192:195], v[96:99], v[88:91], a[192:195]
ds_read_b128 v[156:159], v10 offset:13312
v_mfma_f32_16x16x32_bf16 a[196:199], v[100:103], v[88:91], a[196:199]
v_mfma_f32_16x16x32_bf16 a[200:203], v[104:107], v[88:91], a[200:203]
ds_read_b64_tr_b16 v[188:189], v24 offset:16384
v_mfma_f32_16x16x32_bf16 a[204:207], v[108:111], v[88:91], a[204:207]
v_mfma_f32_16x16x32_bf16 a[208:211], v[112:115], v[88:91], a[208:211]
ds_read_b64_tr_b16 v[190:191], v24 offset:18432
v_mfma_f32_16x16x32_bf16 a[212:215], v[116:119], v[88:91], a[212:215]
v_mfma_f32_16x16x32_bf16 a[216:219], v[120:123], v[88:91], a[216:219]
v_mfma_f32_16x16x32_bf16 a[220:223], v[124:127], v[88:91], a[220:223]
v_mfma_f32_16x16x32_bf16 a[224:227], v[96:99], v[92:95], a[224:227]
v_mfma_f32_16x16x32_bf16 a[228:231], v[100:103], v[92:95], a[228:231]
v_mfma_f32_16x16x32_bf16 a[232:235], v[104:107], v[92:95], a[232:235]
v_mfma_f32_16x16x32_bf16 a[236:239], v[108:111], v[92:95], a[236:239]
v_mfma_f32_16x16x32_bf16 a[240:243], v[112:115], v[92:95], a[240:243]
v_mfma_f32_16x16x32_bf16 a[244:247], v[116:119], v[92:95], a[244:247]
v_mfma_f32_16x16x32_bf16 a[248:251], v[120:123], v[92:95], a[248:251]
v_mfma_f32_16x16x32_bf16 a[252:255], v[124:127], v[92:95], a[252:255]
s_waitcnt lgkmcnt(0)
v_mfma_f32_16x16x32_bf16 a[0:3], v[160:163], v[128:131], a[0:3]
s_waitcnt vmcnt(8)
s_barrier
v_mfma_f32_16x16x32_bf16 a[4:7], v[164:167], v[128:131], a[4:7]
ds_read_b128 v[64:67], v16 offset:32768
v_mfma_f32_16x16x32_bf16 a[8:11], v[168:171], v[128:131], a[8:11]
s_add_u32 m0, s63, 0
v_mfma_f32_16x16x32_bf16 a[12:15], v[172:175], v[128:131], a[12:15]
ds_read_b64_tr_b16 v[96:97], v17 offset:32768
s_add_u32 s62, s65, 0
v_mfma_f32_16x16x32_bf16 a[16:19], v[176:179], v[128:131], a[16:19]
v_mfma_f32_16x16x32_bf16 a[20:23], v[180:183], v[128:131], a[20:23]
ds_read_b64_tr_b16 v[98:99], v17 offset:34816
buffer_load_dwordx4 v8, s[8:11], s62 offen lds
v_mfma_f32_16x16x32_bf16 a[24:27], v[184:187], v[128:131], a[24:27]
v_mfma_f32_16x16x32_bf16 a[28:31], v[188:191], v[128:131], a[28:31]
ds_read_b128 v[68:71], v16 offset:33792
s_add_u32 s62, s65, 15360
v_mfma_f32_16x16x32_bf16 a[32:35], v[160:163], v[132:135], a[32:35]
v_mfma_f32_16x16x32_bf16 a[36:39], v[164:167], v[132:135], a[36:39]
buffer_load_dwordx4 v8, s[8:11], s62 offen offset:1024 lds
v_mfma_f32_16x16x32_bf16 a[40:43], v[168:171], v[132:135], a[40:43]
ds_read_b64_tr_b16 v[100:101], v18 offset:32768
v_mfma_f32_16x16x32_bf16 a[44:47], v[172:175], v[132:135], a[44:47]
s_add_u32 s62, s65, 30720
v_mfma_f32_16x16x32_bf16 a[48:51], v[176:179], v[132:135], a[48:51]
ds_read_b64_tr_b16 v[102:103], v18 offset:34816
buffer_load_dwordx4 v9, s[8:11], s62 offen offset:2048 lds
v_mfma_f32_16x16x32_bf16 a[52:55], v[180:183], v[132:135], a[52:55]
v_mfma_f32_16x16x32_bf16 a[56:59], v[184:187], v[132:135], a[56:59]
ds_read_b128 v[72:75], v16 offset:36864
s_add_u32 s62, s65, 46080
v_mfma_f32_16x16x32_bf16 a[60:63], v[188:191], v[132:135], a[60:63]
v_mfma_f32_16x16x32_bf16 a[64:67], v[160:163], v[136:139], a[64:67]
ds_read_b64_tr_b16 v[104:105], v19 offset:32768
buffer_load_dwordx4 v9, s[8:11], s62 offen offset:3072 lds
v_mfma_f32_16x16x32_bf16 a[68:71], v[164:167], v[136:139], a[68:71]
v_mfma_f32_16x16x32_bf16 a[72:75], v[168:171], v[136:139], a[72:75]
s_add_u32 m0, s63, 4096
v_mfma_f32_16x16x32_bf16 a[76:79], v[172:175], v[136:139], a[76:79]
ds_read_b64_tr_b16 v[106:107], v19 offset:34816
v_mfma_f32_16x16x32_bf16 a[80:83], v[176:179], v[136:139], a[80:83]
s_add_u32 s62, s65, 65536
v_mfma_f32_16x16x32_bf16 a[84:87], v[180:183], v[136:139], a[84:87]
ds_read_b128 v[76:79], v16 offset:37888
buffer_load_dwordx4 v8, s[8:11], s62 offen lds
v_mfma_f32_16x16x32_bf16 a[88:91], v[184:187], v[136:139], a[88:91]
v_mfma_f32_16x16x32_bf16 a[92:95], v[188:191], v[136:139], a[92:95]
ds_read_b64_tr_b16 v[108:109], v20 offset:32768
s_add_u32 s62, s65, 80896
v_mfma_f32_16x16x32_bf16 a[96:99], v[160:163], v[140:143], a[96:99]
v_mfma_f32_16x16x32_bf16 a[100:103], v[164:167], v[140:143], a[100:103]
ds_read_b64_tr_b16 v[110:111], v20 offset:34816
buffer_load_dwordx4 v8, s[8:11], s62 offen offset:1024 lds
v_mfma_f32_16x16x32_bf16 a[104:107], v[168:171], v[140:143], a[104:107]
v_mfma_f32_16x16x32_bf16 a[108:111], v[172:175], v[140:143], a[108:111]
s_add_u32 s62, s65, 96256
v_mfma_f32_16x16x32_bf16 a[112:115], v[176:179], v[140:143], a[112:115]
ds_read_b128 v[80:83], v16 offset:40960
v_mfma_f32_16x16x32_bf16 a[116:119], v[180:183], v[140:143], a[116:119]
buffer_load_dwordx4 v9, s[8:11], s62 offen offset:2048 lds
v_mfma_f32_16x16x32_bf16 a[120:123], v[184:187], v[140:143], a[120:123]
ds_read_b64_tr_b16 v[112:113], v21 offset:32768
s_add_u32 s62, s65, 111616
v_mfma_f32_16x16x32_bf16 a[124:127], v[188:191], v[140:143], a[124:127]
v_mfma_f32_16x16x32_bf16 a[128:131], v[160:163], v[144:147], a[128:131]
ds_read_b64_tr_b16 v[114:115], v21 offset:34816
buffer_load_dwordx4 v9, s[8:11], s62 offen offset:3072 lds
v_mfma_f32_16x16x32_bf16 a[132:135], v[164:167], v[144:147], a[132:135]
v_mfma_f32_16x16x32_bf16 a[136:139], v[168:171], v[144:147], a[136:139]
ds_read_b128 v[84:87], v16 offset:41984
s_add_u32 s65, s65, 128
v_mfma_f32_16x16x32_bf16 a[140:143], v[172:175], v[144:147], a[140:143]
v_mfma_f32_16x16x32_bf16 a[144:147], v[176:179], v[144:147], a[144:147]
s_add_u32 m0, s64, 81920
v_mfma_f32_16x16x32_bf16 a[148:151], v[180:183], v[144:147], a[148:151]
ds_read_b64_tr_b16 v[116:117], v22 offset:32768
v_mfma_f32_16x16x32_bf16 a[152:155], v[184:187], v[144:147], a[152:155]
s_nop 0
v_mfma_f32_16x16x32_bf16 a[156:159], v[188:191], v[144:147], a[156:159]
ds_read_b64_tr_b16 v[118:119], v22 offset:34816
buffer_load_dwordx4 v12, s[12:15], s66 offen lds
v_mfma_f32_16x16x32_bf16 a[160:163], v[160:163], v[148:151], a[160:163]
v_mfma_f32_16x16x32_bf16 a[164:167], v[164:167], v[148:151], a[164:167]
ds_read_b128 v[88:91], v16 offset:45056
buffer_load_dwordx4 v13, s[12:15], s66 offen offset:1024 lds
v_mfma_f32_16x16x32_bf16 a[168:171], v[168:171], v[148:151], a[168:171]
v_mfma_f32_16x16x32_bf16 a[172:175], v[172:175], v[148:151], a[172:175]
ds_read_b64_tr_b16 v[120:121], v23 offset:32768
buffer_load_dwordx4 v14, s[12:15], s66 offen offset:2048 lds
v_mfma_f32_16x16x32_bf16 a[176:179], v[176:179], v[148:151], a[176:179]
v_mfma_f32_16x16x32_bf16 a[180:183], v[180:183], v[148:151], a[180:183]
buffer_load_dwordx4 v15, s[12:15], s66 offen offset:3072 lds
v_mfma_f32_16x16x32_bf16 a[184:187], v[184:187], v[148:151], a[184:187]
ds_read_b64_tr_b16 v[122:123], v23 offset:34816
v_mfma_f32_16x16x32_bf16 a[188:191], v[188:191], v[148:151], a[188:191]
s_add_u32 s66, s66, 262144
v_mfma_f32_16x16x32_bf16 a[192:195], v[160:163], v[152:155], a[192:195]
ds_read_b128 v[92:95], v16 offset:46080
v_mfma_f32_16x16x32_bf16 a[196:199], v[164:167], v[152:155], a[196:199]
v_mfma_f32_16x16x32_bf16 a[200:203], v[168:171], v[152:155], a[200:203]
ds_read_b64_tr_b16 v[124:125], v24 offset:32768
v_add_u32 v242, 0x100000, v242
global_load_dword v245, v242, s[98:99]
v_mfma_f32_16x16x32_bf16 a[204:207], v[172:175], v[152:155], a[204:207]
v_mfma_f32_16x16x32_bf16 a[208:211], v[176:179], v[152:155], a[208:211]
ds_read_b64_tr_b16 v[126:127], v24 offset:34816
v_mfma_f32_16x16x32_bf16 a[212:215], v[180:183], v[152:155], a[212:215]
v_mfma_f32_16x16x32_bf16 a[216:219], v[184:187], v[152:155], a[216:219]
v_mfma_f32_16x16x32_bf16 a[220:223], v[188:191], v[152:155], a[220:223]
v_mfma_f32_16x16x32_bf16 a[224:227], v[160:163], v[156:159], a[224:227]
v_mfma_f32_16x16x32_bf16 a[228:231], v[164:167], v[156:159], a[228:231]
v_mfma_f32_16x16x32_bf16 a[232:235], v[168:171], v[156:159], a[232:235]
v_mfma_f32_16x16x32_bf16 a[236:239], v[172:175], v[156:159], a[236:239]
v_mfma_f32_16x16x32_bf16 a[240:243], v[176:179], v[156:159], a[240:243]
v_mfma_f32_16x16x32_bf16 a[244:247], v[180:183], v[156:159], a[244:247]
v_mfma_f32_16x16x32_bf16 a[248:251], v[184:187], v[156:159], a[248:251]
v_mfma_f32_16x16x32_bf16 a[252:255], v[188:191], v[156:159], a[252:255]
s_waitcnt lgkmcnt(0)
v_mfma_f32_16x16x32_bf16 a[0:3], v[96:99], v[64:67], a[0:3]
s_waitcnt vmcnt(17)
s_barrier
v_mfma_f32_16x16x32_bf16 a[4:7], v[100:103], v[64:67], a[4:7]
ds_read_b128 v[128:131], v10 offset:32768
v_mfma_f32_16x16x32_bf16 a[8:11], v[104:107], v[64:67], a[8:11]
s_add_u32 m0, s64, 98304
v_mfma_f32_16x16x32_bf16 a[12:15], v[108:111], v[64:67], a[12:15]
ds_read_b64_tr_b16 v[160:161], v17 offset:49152
v_mfma_f32_16x16x32_bf16 a[16:19], v[112:115], v[64:67], a[16:19]
v_mfma_f32_16x16x32_bf16 a[20:23], v[116:119], v[64:67], a[20:23]
ds_read_b64_tr_b16 v[162:163], v17 offset:51200
v_mfma_f32_16x16x32_bf16 a[24:27], v[120:123], v[64:67], a[24:27]
v_mfma_f32_16x16x32_bf16 a[28:31], v[124:127], v[64:67], a[28:31]
ds_read_b128 v[132:135], v10 offset:33792
v_mfma_f32_16x16x32_bf16 a[32:35], v[96:99], v[68:71], a[32:35]
s_nop 0
v_mfma_f32_16x16x32_bf16 a[36:39], v[100:103], v[68:71], a[36:39]
v_mfma_f32_16x16x32_bf16 a[40:43], v[104:107], v[68:71], a[40:43]
ds_read_b64_tr_b16 v[164:165], v18 offset:49152
v_mfma_f32_16x16x32_bf16 a[44:47], v[108:111], v[68:71], a[44:47]
v_mfma_f32_16x16x32_bf16 a[48:51], v[112:115], v[68:71], a[48:51]
ds_read_b64_tr_b16 v[166:167], v18 offset:51200
v_mfma_f32_16x16x32_bf16 a[52:55], v[116:119], v[68:71], a[52:55]
v_mfma_f32_16x16x32_bf16 a[56:59], v[120:123], v[68:71], a[56:59]
ds_read_b128 v[136:139], v10 offset:36864
v_mfma_f32_16x16x32_bf16 a[60:63], v[124:127], v[68:71], a[60:63]
buffer_load_dwordx4 v12, s[12:15], s66 offen lds
v_mfma_f32_16x16x32_bf16 a[64:67], v[96:99], v[72:75], a[64:67]
ds_read_b64_tr_b16 v[168:169], v19 offset:49152
v_mfma_f32_16x16x32_bf16 a[68:71], v[100:103], v[72:75], a[68:71]
v_mfma_f32_16x16x32_bf16 a[72:75], v[104:107], v[72:75], a[72:75]
v_mfma_f32_16x16x32_bf16 a[76:79], v[108:111], v[72:75], a[76:79]
ds_read_b64_tr_b16 v[170:171], v19 offset:51200
v_mfma_f32_16x16x32_bf16 a[80:83], v[112:115], v[72:75], a[80:83]
v_mfma_f32_16x16x32_bf16 a[84:87], v[116:119], v[72:75], a[84:87]
ds_read_b128 v[140:143], v10 offset:37888
v_mfma_f32_16x16x32_bf16 a[88:91], v[120:123], v[72:75], a[88:91]
buffer_load_dwordx4 v13, s[12:15], s66 offen offset:1024 lds
v_mfma_f32_16x16x32_bf16 a[92:95], v[124:127], v[72:75], a[92:95]
ds_read_b64_tr_b16 v[172:173], v20 offset:49152
v_mfma_f32_16x16x32_bf16 a[96:99], v[96:99], v[76:79], a[96:99]
v_mfma_f32_16x16x32_bf16 a[100:103], v[100:103], v[76:79], a[100:103]
ds_read_b64_tr_b16 v[174:175], v20 offset:51200
v_mfma_f32_16x16x32_bf16 a[104:107], v[104:107], v[76:79], a[104:107]
v_mfma_f32_16x16x32_bf16 a[108:111], v[108:111], v[76:79], a[108:111]
v_mfma_f32_16x16x32_bf16 a[112:115], v[112:115], v[76:79], a[112:115]
ds_read_b128 v[144:147], v10 offset:40960
buffer_load_dwordx4 v14, s[12:15], s66 offen offset:2048 lds
v_mfma_f32_16x16x32_bf16 a[116:119], v[116:119], v[76:79], a[116:119]
v_mfma_f32_16x16x32_bf16 a[120:123], v[120:123], v[76:79], a[120:123]
ds_read_b64_tr_b16 v[176:177], v21 offset:49152
v_mfma_f32_16x16x32_bf16 a[124:127], v[124:127], v[76:79], a[124:127]
v_mfma_f32_16x16x32_bf16 a[128:131], v[96:99], v[80:83], a[128:131]
ds_read_b64_tr_b16 v[178:179], v21 offset:51200
v_mfma_f32_16x16x32_bf16 a[132:135], v[100:103], v[80:83], a[132:135]
v_mfma_f32_16x16x32_bf16 a[136:139], v[104:107], v[80:83], a[136:139]
ds_read_b128 v[148:151], v10 offset:41984
v_mfma_f32_16x16x32_bf16 a[140:143], v[108:111], v[80:83], a[140:143]
buffer_load_dwordx4 v15, s[12:15], s66 offen offset:3072 lds
v_mfma_f32_16x16x32_bf16 a[144:147], v[112:115], v[80:83], a[144:147]
v_mfma_f32_16x16x32_bf16 a[148:151], v[116:119], v[80:83], a[148:151]
ds_read_b64_tr_b16 v[180:181], v22 offset:49152
v_mfma_f32_16x16x32_bf16 a[152:155], v[120:123], v[80:83], a[152:155]
v_mfma_f32_16x16x32_bf16 a[156:159], v[124:127], v[80:83], a[156:159]
ds_read_b64_tr_b16 v[182:183], v22 offset:51200
v_mfma_f32_16x16x32_bf16 a[160:163], v[96:99], v[84:87], a[160:163]
v_mfma_f32_16x16x32_bf16 a[164:167], v[100:103], v[84:87], a[164:167]
ds_read_b128 v[152:155], v10 offset:45056
v_mfma_f32_16x16x32_bf16 a[168:171], v[104:107], v[84:87], a[168:171]
s_add_u32 s66, s66, 262144
v_mfma_f32_16x16x32_bf16 a[172:175], v[108:111], v[84:87], a[172:175]
ds_read_b64_tr_b16 v[184:185], v23 offset:49152
v_mfma_f32_16x16x32_bf16 a[176:179], v[112:115], v[84:87], a[176:179]
v_mfma_f32_16x16x32_bf16 a[180:183], v[116:119], v[84:87], a[180:183]
v_mfma_f32_16x16x32_bf16 a[184:187], v[120:123], v[84:87], a[184:187]
ds_read_b64_tr_b16 v[186:187], v23 offset:51200
v_mfma_f32_16x16x32_bf16 a[188:191], v[124:127], v[84:87], a[188:191]
v_mfma_f32_16x16x32_bf16 a[192:195], v[96:99], v[88:91], a[192:195]
ds_read_b128 v[156:159], v10 offset:46080
v_mfma_f32_16x16x32_bf16 a[196:199], v[100:103], v[88:91], a[196:199]
v_mfma_f32_16x16x32_bf16 a[200:203], v[104:107], v[88:91], a[200:203]
ds_read_b64_tr_b16 v[188:189], v24 offset:49152
v_mfma_f32_16x16x32_bf16 a[204:207], v[108:111], v[88:91], a[204:207]
v_mfma_f32_16x16x32_bf16 a[208:211], v[112:115], v[88:91], a[208:211]
ds_read_b64_tr_b16 v[190:191], v24 offset:51200
v_mfma_f32_16x16x32_bf16 a[212:215], v[116:119], v[88:91], a[212:215]
v_mfma_f32_16x16x32_bf16 a[216:219], v[120:123], v[88:91], a[216:219]
v_mfma_f32_16x16x32_bf16 a[220:223], v[124:127], v[88:91], a[220:223]
v_mfma_f32_16x16x32_bf16 a[224:227], v[96:99], v[92:95], a[224:227]
v_mfma_f32_16x16x32_bf16 a[228:231], v[100:103], v[92:95], a[228:231]
v_mfma_f32_16x16x32_bf16 a[232:235], v[104:107], v[92:95], a[232:235]
v_mfma_f32_16x16x32_bf16 a[236:239], v[108:111], v[92:95], a[236:239]
v_mfma_f32_16x16x32_bf16 a[240:243], v[112:115], v[92:95], a[240:243]
v_mfma_f32_16x16x32_bf16 a[244:247], v[116:119], v[92:95], a[244:247]
v_mfma_f32_16x16x32_bf16 a[248:251], v[120:123], v[92:95], a[248:251]
v_mfma_f32_16x16x32_bf16 a[252:255], v[124:127], v[92:95], a[252:255]
s_waitcnt lgkmcnt(0)
v_mfma_f32_16x16x32_bf16 a[0:3], v[160:163], v[128:131], a[0:3]
s_waitcnt vmcnt(9)
s_barrier
v_mfma_f32_16x16x32_bf16 a[4:7], v[164:167], v[128:131], a[4:7]
ds_read_b128 v[64:67], v16
v_mfma_f32_16x16x32_bf16 a[8:11], v[168:171], v[128:131], a[8:11]
s_add_u32 m0, s63, 32768
v_mfma_f32_16x16x32_bf16 a[12:15], v[172:175], v[128:131], a[12:15]
ds_read_b64_tr_b16 v[96:97], v17
s_add_u32 s62, s65, 0
v_mfma_f32_16x16x32_bf16 a[16:19], v[176:179], v[128:131], a[16:19]
v_mfma_f32_16x16x32_bf16 a[20:23], v[180:183], v[128:131], a[20:23]
ds_read_b64_tr_b16 v[98:99], v17 offset:2048
buffer_load_dwordx4 v8, s[8:11], s62 offen lds
v_mfma_f32_16x16x32_bf16 a[24:27], v[184:187], v[128:131], a[24:27]
v_mfma_f32_16x16x32_bf16 a[28:31], v[188:191], v[128:131], a[28:31]
ds_read_b128 v[68:71], v16 offset:1024
s_add_u32 s62, s65, 15360
v_mfma_f32_16x16x32_bf16 a[32:35], v[160:163], v[132:135], a[32:35]
v_mfma_f32_16x16x32_bf16 a[36:39], v[164:167], v[132:135], a[36:39]
buffer_load_dwordx4 v8, s[8:11], s62 offen offset:1024 lds
v_mfma_f32_16x16x32_bf16 a[40:43], v[168:171], v[132:135], a[40:43]
ds_read_b64_tr_b16 v[100:101], v18
v_mfma_f32_16x16x32_bf16 a[44:47], v[172:175], v[132:135], a[44:47]
s_add_u32 s62, s65, 30720
v_mfma_f32_16x16x32_bf16 a[48:51], v[176:179], v[132:135], a[48:51]
ds_read_b64_tr_b16 v[102:103], v18 offset:2048
buffer_load_dwordx4 v9, s[8:11], s62 offen offset:2048 lds
v_mfma_f32_16x16x32_bf16 a[52:55], v[180:183], v[132:135], a[52:55]
v_mfma_f32_16x16x32_bf16 a[56:59], v[184:187], v[132:135], a[56:59]
ds_read_b128 v[72:75], v16 offset:4096
s_add_u32 s62, s65, 46080
v_mfma_f32_16x16x32_bf16 a[60:63], v[188:191], v[132:135], a[60:63]
v_mfma_f32_16x16x32_bf16 a[64:67], v[160:163], v[136:139], a[64:67]
ds_read_b64_tr_b16 v[104:105], v19
buffer_load_dwordx4 v9, s[8:11], s62 offen offset:3072 lds
v_mfma_f32_16x16x32_bf16 a[68:71], v[164:167], v[136:139], a[68:71]
v_mfma_f32_16x16x32_bf16 a[72:75], v[168:171], v[136:139], a[72:75]
s_add_u32 m0, s63, 36864
v_mfma_f32_16x16x32_bf16 a[76:79], v[172:175], v[136:139], a[76:79]
ds_read_b64_tr_b16 v[106:107], v19 offset:2048
v_mfma_f32_16x16x32_bf16 a[80:83], v[176:179], v[136:139], a[80:83]
s_add_u32 s62, s65, 65536
v_mfma_f32_16x16x32_bf16 a[84:87], v[180:183], v[136:139], a[84:87]
ds_read_b128 v[76:79], v16 offset:5120
buffer_load_dwordx4 v8, s[8:11], s62 offen lds
v_mfma_f32_16x16x32_bf16 a[88:91], v[184:187], v[136:139], a[88:91]
v_mfma_f32_16x16x32_bf16 a[92:95], v[188:191], v[136:139], a[92:95]
ds_read_b64_tr_b16 v[108:109], v20
s_add_u32 s62, s65, 80896
v_mfma_f32_16x16x32_bf16 a[96:99], v[160:163], v[140:143], a[96:99]
v_mfma_f32_16x16x32_bf16 a[100:103], v[164:167], v[140:143], a[100:103]
ds_read_b64_tr_b16 v[110:111], v20 offset:2048
buffer_load_dwordx4 v8, s[8:11], s62 offen offset:1024 lds
v_mfma_f32_16x16x32_bf16 a[104:107], v[168:171], v[140:143], a[104:107]
v_mfma_f32_16x16x32_bf16 a[108:111], v[172:175], v[140:143], a[108:111]
s_add_u32 s62, s65, 96256
v_mfma_f32_16x16x32_bf16 a[112:115], v[176:179], v[140:143], a[112:115]
ds_read_b128 v[80:83], v16 offset:8192
v_mfma_f32_16x16x32_bf16 a[116:119], v[180:183], v[140:143], a[116:119]
buffer_load_dwordx4 v9, s[8:11], s62 offen offset:2048 lds
v_mfma_f32_16x16x32_bf16 a[120:123], v[184:187], v[140:143], a[120:123]
ds_read_b64_tr_b16 v[112:113], v21
s_add_u32 s62, s65, 111616
v_mfma_f32_16x16x32_bf16 a[124:127], v[188:191], v[140:143], a[124:127]
v_mfma_f32_16x16x32_bf16 a[128:131], v[160:163], v[144:147], a[128:131]
ds_read_b64_tr_b16 v[114:115], v21 offset:2048
buffer_load_dwordx4 v9, s[8:11], s62 offen offset:3072 lds
v_mfma_f32_16x16x32_bf16 a[132:135], v[164:167], v[144:147], a[132:135]
v_mfma_f32_16x16x32_bf16 a[136:139], v[168:171], v[144:147], a[136:139]
ds_read_b128 v[84:87], v16 offset:9216
s_add_u32 s65, s65, 128
v_mfma_f32_16x16x32_bf16 a[140:143], v[172:175], v[144:147], a[140:143]
v_mfma_f32_16x16x32_bf16 a[144:147], v[176:179], v[144:147], a[144:147]
s_add_u32 m0, s64, 114688
v_mfma_f32_16x16x32_bf16 a[148:151], v[180:183], v[144:147], a[148:151]
ds_read_b64_tr_b16 v[116:117], v22
v_mfma_f32_16x16x32_bf16 a[152:155], v[184:187], v[144:147], a[152:155]
s_nop 0
v_mfma_f32_16x16x32_bf16 a[156:159], v[188:191], v[144:147], a[156:159]
ds_read_b64_tr_b16 v[118:119], v22 offset:2048
buffer_load_dwordx4 v12, s[12:15], s66 offen lds
v_mfma_f32_16x16x32_bf16 a[160:163], v[160:163], v[148:151], a[160:163]
v_mfma_f32_16x16x32_bf16 a[164:167], v[164:167], v[148:151], a[164:167]
ds_read_b128 v[88:91], v16 offset:12288
buffer_load_dwordx4 v13, s[12:15], s66 offen offset:1024 lds
v_mfma_f32_16x16x32_bf16 a[168:171], v[168:171], v[148:151], a[168:171]
v_mfma_f32_16x16x32_bf16 a[172:175], v[172:175], v[148:151], a[172:175]
ds_read_b64_tr_b16 v[120:121], v23
buffer_load_dwordx4 v14, s[12:15], s66 offen offset:2048 lds
v_mfma_f32_16x16x32_bf16 a[176:179], v[176:179], v[148:151], a[176:179]
v_mfma_f32_16x16x32_bf16 a[180:183], v[180:183], v[148:151], a[180:183]
buffer_load_dwordx4 v15, s[12:15], s66 offen offset:3072 lds
v_mfma_f32_16x16x32_bf16 a[184:187], v[184:187], v[148:151], a[184:187]
ds_read_b64_tr_b16 v[122:123], v23 offset:2048
v_mfma_f32_16x16x32_bf16 a[188:191], v[188:191], v[148:151], a[188:191]
s_add_u32 s66, s66, 262144
v_mfma_f32_16x16x32_bf16 a[192:195], v[160:163], v[152:155], a[192:195]
ds_read_b128 v[92:95], v16 offset:13312
v_mfma_f32_16x16x32_bf16 a[196:199], v[164:167], v[152:155], a[196:199]
v_mfma_f32_16x16x32_bf16 a[200:203], v[168:171], v[152:155], a[200:203]
ds_read_b64_tr_b16 v[124:125], v24
v_mfma_f32_16x16x32_bf16 a[204:207], v[172:175], v[152:155], a[204:207]
v_mfma_f32_16x16x32_bf16 a[208:211], v[176:179], v[152:155], a[208:211]
ds_read_b64_tr_b16 v[126:127], v24 offset:2048
buffer_load_dword v248, v247, s[32:35], 0 offen
v_mfma_f32_16x16x32_bf16 a[212:215], v[180:183], v[152:155], a[212:215]
v_mfma_f32_16x16x32_bf16 a[216:219], v[184:187], v[152:155], a[216:219]
v_mfma_f32_16x16x32_bf16 a[220:223], v[188:191], v[152:155], a[220:223]
v_mfma_f32_16x16x32_bf16 a[224:227], v[160:163], v[156:159], a[224:227]
v_mfma_f32_16x16x32_bf16 a[228:231], v[164:167], v[156:159], a[228:231]
v_mfma_f32_16x16x32_bf16 a[232:235], v[168:171], v[156:159], a[232:235]
v_mfma_f32_16x16x32_bf16 a[236:239], v[172:175], v[156:159], a[236:239]
v_mfma_f32_16x16x32_bf16 a[240:243], v[176:179], v[156:159], a[240:243]
v_mfma_f32_16x16x32_bf16 a[244:247], v[180:183], v[156:159], a[244:247]
v_mfma_f32_16x16x32_bf16 a[248:251], v[184:187], v[156:159], a[248:251]
v_mfma_f32_16x16x32_bf16 a[252:255], v[188:191], v[156:159], a[252:255]
s_waitcnt lgkmcnt(0)
v_mfma_f32_16x16x32_bf16 a[0:3], v[96:99], v[64:67], a[0:3]
s_waitcnt vmcnt(18)
s_barrier
v_mfma_f32_16x16x32_bf16 a[4:7], v[100:103], v[64:67], a[4:7]
ds_read_b128 v[128:131], v10
v_mfma_f32_16x16x32_bf16 a[8:11], v[104:107], v[64:67], a[8:11]
s_add_u32 m0, s64, 65536
v_mfma_f32_16x16x32_bf16 a[12:15], v[108:111], v[64:67], a[12:15]
ds_read_b64_tr_b16 v[160:161], v17 offset:16384
v_mfma_f32_16x16x32_bf16 a[16:19], v[112:115], v[64:67], a[16:19]
v_mfma_f32_16x16x32_bf16 a[20:23], v[116:119], v[64:67], a[20:23]
ds_read_b64_tr_b16 v[162:163], v17 offset:18432
v_mfma_f32_16x16x32_bf16 a[24:27], v[120:123], v[64:67], a[24:27]
v_mfma_f32_16x16x32_bf16 a[28:31], v[124:127], v[64:67], a[28:31]
ds_read_b128 v[132:135], v10 offset:1024
v_mfma_f32_16x16x32_bf16 a[32:35], v[96:99], v[68:71], a[32:35]
s_nop 0
v_mfma_f32_16x16x32_bf16 a[36:39], v[100:103], v[68:71], a[36:39]
v_mfma_f32_16x16x32_bf16 a[40:43], v[104:107], v[68:71], a[40:43]
ds_read_b64_tr_b16 v[164:165], v18 offset:16384
v_mfma_f32_16x16x32_bf16 a[44:47], v[108:111], v[68:71], a[44:47]
v_mfma_f32_16x16x32_bf16 a[48:51], v[112:115], v[68:71], a[48:51]
ds_read_b64_tr_b16 v[166:167], v18 offset:18432
v_mfma_f32_16x16x32_bf16 a[52:55], v[116:119], v[68:71], a[52:55]
v_mfma_f32_16x16x32_bf16 a[56:59], v[120:123], v[68:71], a[56:59]
ds_read_b128 v[136:139], v10 offset:4096
v_mfma_f32_16x16x32_bf16 a[60:63], v[124:127], v[68:71], a[60:63]
buffer_load_dwordx4 v12, s[12:15], s66 offen lds
v_mfma_f32_16x16x32_bf16 a[64:67], v[96:99], v[72:75], a[64:67]
ds_read_b64_tr_b16 v[168:169], v19 offset:16384
v_mfma_f32_16x16x32_bf16 a[68:71], v[100:103], v[72:75], a[68:71]
v_mfma_f32_16x16x32_bf16 a[72:75], v[104:107], v[72:75], a[72:75]
v_mfma_f32_16x16x32_bf16 a[76:79], v[108:111], v[72:75], a[76:79]
ds_read_b64_tr_b16 v[170:171], v19 offset:18432
v_mfma_f32_16x16x32_bf16 a[80:83], v[112:115], v[72:75], a[80:83]
v_mfma_f32_16x16x32_bf16 a[84:87], v[116:119], v[72:75], a[84:87]
ds_read_b128 v[140:143], v10 offset:5120
v_mfma_f32_16x16x32_bf16 a[88:91], v[120:123], v[72:75], a[88:91]
buffer_load_dwordx4 v13, s[12:15], s66 offen offset:1024 lds
v_mfma_f32_16x16x32_bf16 a[92:95], v[124:127], v[72:75], a[92:95]
ds_read_b64_tr_b16 v[172:173], v20 offset:16384
v_mfma_f32_16x16x32_bf16 a[96:99], v[96:99], v[76:79], a[96:99]
v_mfma_f32_16x16x32_bf16 a[100:103], v[100:103], v[76:79], a[100:103]
ds_read_b64_tr_b16 v[174:175], v20 offset:18432
v_mfma_f32_16x16x32_bf16 a[104:107], v[104:107], v[76:79], a[104:107]
v_mfma_f32_16x16x32_bf16 a[108:111], v[108:111], v[76:79], a[108:111]
v_mfma_f32_16x16x32_bf16 a[112:115], v[112:115], v[76:79], a[112:115]
ds_read_b128 v[144:147], v10 offset:8192
buffer_load_dwordx4 v14, s[12:15], s66 offen offset:2048 lds
v_mfma_f32_16x16x32_bf16 a[116:119], v[116:119], v[76:79], a[116:119]
v_mfma_f32_16x16x32_bf16 a[120:123], v[120:123], v[76:79], a[120:123]
ds_read_b64_tr_b16 v[176:177], v21 offset:16384
v_mfma_f32_16x16x32_bf16 a[124:127], v[124:127], v[76:79], a[124:127]
v_mfma_f32_16x16x32_bf16 a[128:131], v[96:99], v[80:83], a[128:131]
ds_read_b64_tr_b16 v[178:179], v21 offset:18432
v_mfma_f32_16x16x32_bf16 a[132:135], v[100:103], v[80:83], a[132:135]
v_mfma_f32_16x16x32_bf16 a[136:139], v[104:107], v[80:83], a[136:139]
ds_read_b128 v[148:151], v10 offset:9216
v_mfma_f32_16x16x32_bf16 a[140:143], v[108:111], v[80:83], a[140:143]
buffer_load_dwordx4 v15, s[12:15], s66 offen offset:3072 lds
v_mfma_f32_16x16x32_bf16 a[144:147], v[112:115], v[80:83], a[144:147]
v_mfma_f32_16x16x32_bf16 a[148:151], v[116:119], v[80:83], a[148:151]
ds_read_b64_tr_b16 v[180:181], v22 offset:16384
v_mfma_f32_16x16x32_bf16 a[152:155], v[120:123], v[80:83], a[152:155]
v_mfma_f32_16x16x32_bf16 a[156:159], v[124:127], v[80:83], a[156:159]
ds_read_b64_tr_b16 v[182:183], v22 offset:18432
v_mfma_f32_16x16x32_bf16 a[160:163], v[96:99], v[84:87], a[160:163]
v_mfma_f32_16x16x32_bf16 a[164:167], v[100:103], v[84:87], a[164:167]
ds_read_b128 v[152:155], v10 offset:12288
v_mfma_f32_16x16x32_bf16 a[168:171], v[104:107], v[84:87], a[168:171]
s_add_u32 s66, s66, 262144
v_mfma_f32_16x16x32_bf16 a[172:175], v[108:111], v[84:87], a[172:175]
ds_read_b64_tr_b16 v[184:185], v23 offset:16384
v_mfma_f32_16x16x32_bf16 a[176:179], v[112:115], v[84:87], a[176:179]
v_mfma_f32_16x16x32_bf16 a[180:183], v[116:119], v[84:87], a[180:183]
v_mfma_f32_16x16x32_bf16 a[184:187], v[120:123], v[84:87], a[184:187]
ds_read_b64_tr_b16 v[186:187], v23 offset:18432
v_mfma_f32_16x16x32_bf16 a[188:191], v[124:127], v[84:87], a[188:191]
v_mfma_f32_16x16x32_bf16 a[192:195], v[96:99], v[88:91], a[192:195]
ds_read_b128 v[156:159], v10 offset:13312
v_mfma_f32_16x16x32_bf16 a[196:199], v[100:103], v[88:91], a[196:199]
v_mfma_f32_16x16x32_bf16 a[200:203], v[104:107], v[88:91], a[200:203]
ds_read_b64_tr_b16 v[188:189], v24 offset:16384
v_mfma_f32_16x16x32_bf16 a[204:207], v[108:111], v[88:91], a[204:207]
v_mfma_f32_16x16x32_bf16 a[208:211], v[112:115], v[88:91], a[208:211]
ds_read_b64_tr_b16 v[190:191], v24 offset:18432
v_mfma_f32_16x16x32_bf16 a[212:215], v[116:119], v[88:91], a[212:215]
v_mfma_f32_16x16x32_bf16 a[216:219], v[120:123], v[88:91], a[216:219]
v_mfma_f32_16x16x32_bf16 a[220:223], v[124:127], v[88:91], a[220:223]
v_mfma_f32_16x16x32_bf16 a[224:227], v[96:99], v[92:95], a[224:227]
v_mfma_f32_16x16x32_bf16 a[228:231], v[100:103], v[92:95], a[228:231]
v_mfma_f32_16x16x32_bf16 a[232:235], v[104:107], v[92:95], a[232:235]
v_mfma_f32_16x16x32_bf16 a[236:239], v[108:111], v[92:95], a[236:239]
v_mfma_f32_16x16x32_bf16 a[240:243], v[112:115], v[92:95], a[240:243]
v_mfma_f32_16x16x32_bf16 a[244:247], v[116:119], v[92:95], a[244:247]
v_mfma_f32_16x16x32_bf16 a[248:251], v[120:123], v[92:95], a[248:251]
v_mfma_f32_16x16x32_bf16 a[252:255], v[124:127], v[92:95], a[252:255]
s_waitcnt lgkmcnt(0)
v_mfma_f32_16x16x32_bf16 a[0:3], v[160:163], v[128:131], a[0:3]
s_waitcnt vmcnt(9)
s_barrier
v_mfma_f32_16x16x32_bf16 a[4:7], v[164:167], v[128:131], a[4:7]
ds_read_b128 v[64:67], v16 offset:32768
v_mfma_f32_16x16x32_bf16 a[8:11], v[168:171], v[128:131], a[8:11]
s_add_u32 m0, s63, 0
v_mfma_f32_16x16x32_bf16 a[12:15], v[172:175], v[128:131], a[12:15]
ds_read_b64_tr_b16 v[96:97], v17 offset:32768
s_add_u32 s62, s65, 0
v_mfma_f32_16x16x32_bf16 a[16:19], v[176:179], v[128:131], a[16:19]
v_mfma_f32_16x16x32_bf16 a[20:23], v[180:183], v[128:131], a[20:23]
ds_read_b64_tr_b16 v[98:99], v17 offset:34816
buffer_load_dwordx4 v8, s[8:11], s62 offen lds
v_mfma_f32_16x16x32_bf16 a[24:27], v[184:187], v[128:131], a[24:27]
v_mfma_f32_16x16x32_bf16 a[28:31], v[188:191], v[128:131], a[28:31]
ds_read_b128 v[68:71], v16 offset:33792
s_add_u32 s62, s65, 15360
v_mfma_f32_16x16x32_bf16 a[32:35], v[160:163], v[132:135], a[32:35]
v_mfma_f32_16x16x32_bf16 a[36:39], v[164:167], v[132:135], a[36:39]
buffer_load_dwordx4 v8, s[8:11], s62 offen offset:1024 lds
v_mfma_f32_16x16x32_bf16 a[40:43], v[168:171], v[132:135], a[40:43]
ds_read_b64_tr_b16 v[100:101], v18 offset:32768
v_mfma_f32_16x16x32_bf16 a[44:47], v[172:175], v[132:135], a[44:47]
s_add_u32 s62, s65, 30720
v_mfma_f32_16x16x32_bf16 a[48:51], v[176:179], v[132:135], a[48:51]
ds_read_b64_tr_b16 v[102:103], v18 offset:34816
buffer_load_dwordx4 v9, s[8:11], s62 offen offset:2048 lds
v_mfma_f32_16x16x32_bf16 a[52:55], v[180:183], v[132:135], a[52:55]
v_mfma_f32_16x16x32_bf16 a[56:59], v[184:187], v[132:135], a[56:59]
ds_read_b128 v[72:75], v16 offset:36864
s_add_u32 s62, s65, 46080
v_mfma_f32_16x16x32_bf16 a[60:63], v[188:191], v[132:135], a[60:63]
v_mfma_f32_16x16x32_bf16 a[64:67], v[160:163], v[136:139], a[64:67]
ds_read_b64_tr_b16 v[104:105], v19 offset:32768
buffer_load_dwordx4 v9, s[8:11], s62 offen offset:3072 lds
v_mfma_f32_16x16x32_bf16 a[68:71], v[164:167], v[136:139], a[68:71]
v_mfma_f32_16x16x32_bf16 a[72:75], v[168:171], v[136:139], a[72:75]
s_add_u32 m0, s63, 4096
v_mfma_f32_16x16x32_bf16 a[76:79], v[172:175], v[136:139], a[76:79]
ds_read_b64_tr_b16 v[106:107], v19 offset:34816
v_mfma_f32_16x16x32_bf16 a[80:83], v[176:179], v[136:139], a[80:83]
s_add_u32 s62, s65, 65536
v_mfma_f32_16x16x32_bf16 a[84:87], v[180:183], v[136:139], a[84:87]
ds_read_b128 v[76:79], v16 offset:37888
buffer_load_dwordx4 v8, s[8:11], s62 offen lds
v_mfma_f32_16x16x32_bf16 a[88:91], v[184:187], v[136:139], a[88:91]
v_mfma_f32_16x16x32_bf16 a[92:95], v[188:191], v[136:139], a[92:95]
ds_read_b64_tr_b16 v[108:109], v20 offset:32768
s_add_u32 s62, s65, 80896
v_mfma_f32_16x16x32_bf16 a[96:99], v[160:163], v[140:143], a[96:99]
v_mfma_f32_16x16x32_bf16 a[100:103], v[164:167], v[140:143], a[100:103]
ds_read_b64_tr_b16 v[110:111], v20 offset:34816
buffer_load_dwordx4 v8, s[8:11], s62 offen offset:1024 lds
v_mfma_f32_16x16x32_bf16 a[104:107], v[168:171], v[140:143], a[104:107]
v_mfma_f32_16x16x32_bf16 a[108:111], v[172:175], v[140:143], a[108:111]
s_add_u32 s62, s65, 96256
v_mfma_f32_16x16x32_bf16 a[112:115], v[176:179], v[140:143], a[112:115]
ds_read_b128 v[80:83], v16 offset:40960
v_mfma_f32_16x16x32_bf16 a[116:119], v[180:183], v[140:143], a[116:119]
buffer_load_dwordx4 v9, s[8:11], s62 offen offset:2048 lds
v_mfma_f32_16x16x32_bf16 a[120:123], v[184:187], v[140:143], a[120:123]
ds_read_b64_tr_b16 v[112:113], v21 offset:32768
s_add_u32 s62, s65, 111616
v_mfma_f32_16x16x32_bf16 a[124:127], v[188:191], v[140:143], a[124:127]
v_mfma_f32_16x16x32_bf16 a[128:131], v[160:163], v[144:147], a[128:131]
ds_read_b64_tr_b16 v[114:115], v21 offset:34816
buffer_load_dwordx4 v9, s[8:11], s62 offen offset:3072 lds
v_mfma_f32_16x16x32_bf16 a[132:135], v[164:167], v[144:147], a[132:135]
v_mfma_f32_16x16x32_bf16 a[136:139], v[168:171], v[144:147], a[136:139]
ds_read_b128 v[84:87], v16 offset:41984
s_add_u32 s65, s65, 128
v_mfma_f32_16x16x32_bf16 a[140:143], v[172:175], v[144:147], a[140:143]
v_mfma_f32_16x16x32_bf16 a[144:147], v[176:179], v[144:147], a[144:147]
s_add_u32 m0, s64, 81920
v_mfma_f32_16x16x32_bf16 a[148:151], v[180:183], v[144:147], a[148:151]
ds_read_b64_tr_b16 v[116:117], v22 offset:32768
v_mfma_f32_16x16x32_bf16 a[152:155], v[184:187], v[144:147], a[152:155]
s_nop 0
v_mfma_f32_16x16x32_bf16 a[156:159], v[188:191], v[144:147], a[156:159]
ds_read_b64_tr_b16 v[118:119], v22 offset:34816
buffer_load_dwordx4 v12, s[12:15], s66 offen lds
v_mfma_f32_16x16x32_bf16 a[160:163], v[160:163], v[148:151], a[160:163]
v_mfma_f32_16x16x32_bf16 a[164:167], v[164:167], v[148:151], a[164:167]
ds_read_b128 v[88:91], v16 offset:45056
buffer_load_dwordx4 v13, s[12:15], s66 offen offset:1024 lds
v_mfma_f32_16x16x32_bf16 a[168:171], v[168:171], v[148:151], a[168:171]
v_mfma_f32_16x16x32_bf16 a[172:175], v[172:175], v[148:151], a[172:175]
ds_read_b64_tr_b16 v[120:121], v23 offset:32768
buffer_load_dwordx4 v14, s[12:15], s66 offen offset:2048 lds
v_mfma_f32_16x16x32_bf16 a[176:179], v[176:179], v[148:151], a[176:179]
v_mfma_f32_16x16x32_bf16 a[180:183], v[180:183], v[148:151], a[180:183]
buffer_load_dwordx4 v15, s[12:15], s66 offen offset:3072 lds
v_mfma_f32_16x16x32_bf16 a[184:187], v[184:187], v[148:151], a[184:187]
ds_read_b64_tr_b16 v[122:123], v23 offset:34816
v_mfma_f32_16x16x32_bf16 a[188:191], v[188:191], v[148:151], a[188:191]
s_add_u32 s66, s66, 262144
v_mfma_f32_16x16x32_bf16 a[192:195], v[160:163], v[152:155], a[192:195]
ds_read_b128 v[92:95], v16 offset:46080
v_mfma_f32_16x16x32_bf16 a[196:199], v[164:167], v[152:155], a[196:199]
v_mfma_f32_16x16x32_bf16 a[200:203], v[168:171], v[152:155], a[200:203]
ds_read_b64_tr_b16 v[124:125], v24 offset:32768
v_mfma_f32_16x16x32_bf16 a[204:207], v[172:175], v[152:155], a[204:207]
v_mfma_f32_16x16x32_bf16 a[208:211], v[176:179], v[152:155], a[208:211]
ds_read_b64_tr_b16 v[126:127], v24 offset:34816
buffer_load_dword v248, v247, s[32:35], 0 offen offset:2048
v_mfma_f32_16x16x32_bf16 a[212:215], v[180:183], v[152:155], a[212:215]
v_mfma_f32_16x16x32_bf16 a[216:219], v[184:187], v[152:155], a[216:219]
v_mfma_f32_16x16x32_bf16 a[220:223], v[188:191], v[152:155], a[220:223]
v_mfma_f32_16x16x32_bf16 a[224:227], v[160:163], v[156:159], a[224:227]
v_mfma_f32_16x16x32_bf16 a[228:231], v[164:167], v[156:159], a[228:231]
v_mfma_f32_16x16x32_bf16 a[232:235], v[168:171], v[156:159], a[232:235]
v_mfma_f32_16x16x32_bf16 a[236:239], v[172:175], v[156:159], a[236:239]
v_mfma_f32_16x16x32_bf16 a[240:243], v[176:179], v[156:159], a[240:243]
v_mfma_f32_16x16x32_bf16 a[244:247], v[180:183], v[156:159], a[244:247]
v_mfma_f32_16x16x32_bf16 a[248:251], v[184:187], v[156:159], a[248:251]
v_mfma_f32_16x16x32_bf16 a[252:255], v[188:191], v[156:159], a[252:255]
s_waitcnt lgkmcnt(0)
v_mfma_f32_16x16x32_bf16 a[0:3], v[96:99], v[64:67], a[0:3]
s_waitcnt vmcnt(18)
s_barrier
v_mfma_f32_16x16x32_bf16 a[4:7], v[100:103], v[64:67], a[4:7]
ds_read_b128 v[128:131], v10 offset:32768
v_mfma_f32_16x16x32_bf16 a[8:11], v[104:107], v[64:67], a[8:11]
s_add_u32 m0, s64, 98304
v_mfma_f32_16x16x32_bf16 a[12:15], v[108:111], v[64:67], a[12:15]
ds_read_b64_tr_b16 v[160:161], v17 offset:49152
v_mfma_f32_16x16x32_bf16 a[16:19], v[112:115], v[64:67], a[16:19]
v_mfma_f32_16x16x32_bf16 a[20:23], v[116:119], v[64:67], a[20:23]
ds_read_b64_tr_b16 v[162:163], v17 offset:51200
v_mfma_f32_16x16x32_bf16 a[24:27], v[120:123], v[64:67], a[24:27]
v_mfma_f32_16x16x32_bf16 a[28:31], v[124:127], v[64:67], a[28:31]
ds_read_b128 v[132:135], v10 offset:33792
v_mfma_f32_16x16x32_bf16 a[32:35], v[96:99], v[68:71], a[32:35]
s_nop 0
v_mfma_f32_16x16x32_bf16 a[36:39], v[100:103], v[68:71], a[36:39]
v_mfma_f32_16x16x32_bf16 a[40:43], v[104:107], v[68:71], a[40:43]
ds_read_b64_tr_b16 v[164:165], v18 offset:49152
v_mfma_f32_16x16x32_bf16 a[44:47], v[108:111], v[68:71], a[44:47]
v_mfma_f32_16x16x32_bf16 a[48:51], v[112:115], v[68:71], a[48:51]
ds_read_b64_tr_b16 v[166:167], v18 offset:51200
v_mfma_f32_16x16x32_bf16 a[52:55], v[116:119], v[68:71], a[52:55]
v_mfma_f32_16x16x32_bf16 a[56:59], v[120:123], v[68:71], a[56:59]
ds_read_b128 v[136:139], v10 offset:36864
v_mfma_f32_16x16x32_bf16 a[60:63], v[124:127], v[68:71], a[60:63]
buffer_load_dwordx4 v12, s[12:15], s66 offen lds
v_mfma_f32_16x16x32_bf16 a[64:67], v[96:99], v[72:75], a[64:67]
ds_read_b64_tr_b16 v[168:169], v19 offset:49152
v_mfma_f32_16x16x32_bf16 a[68:71], v[100:103], v[72:75], a[68:71]
v_mfma_f32_16x16x32_bf16 a[72:75], v[104:107], v[72:75], a[72:75]
v_mfma_f32_16x16x32_bf16 a[76:79], v[108:111], v[72:75], a[76:79]
ds_read_b64_tr_b16 v[170:171], v19 offset:51200
v_mfma_f32_16x16x32_bf16 a[80:83], v[112:115], v[72:75], a[80:83]
v_mfma_f32_16x16x32_bf16 a[84:87], v[116:119], v[72:75], a[84:87]
ds_read_b128 v[140:143], v10 offset:37888
v_mfma_f32_16x16x32_bf16 a[88:91], v[120:123], v[72:75], a[88:91]
buffer_load_dwordx4 v13, s[12:15], s66 offen offset:1024 lds
v_mfma_f32_16x16x32_bf16 a[92:95], v[124:127], v[72:75], a[92:95]
ds_read_b64_tr_b16 v[172:173], v20 offset:49152
v_mfma_f32_16x16x32_bf16 a[96:99], v[96:99], v[76:79], a[96:99]
v_mfma_f32_16x16x32_bf16 a[100:103], v[100:103], v[76:79], a[100:103]
ds_read_b64_tr_b16 v[174:175], v20 offset:51200
v_mfma_f32_16x16x32_bf16 a[104:107], v[104:107], v[76:79], a[104:107]
v_mfma_f32_16x16x32_bf16 a[108:111], v[108:111], v[76:79], a[108:111]
v_mfma_f32_16x16x32_bf16 a[112:115], v[112:115], v[76:79], a[112:115]
ds_read_b128 v[144:147], v10 offset:40960
buffer_load_dwordx4 v14, s[12:15], s66 offen offset:2048 lds
v_mfma_f32_16x16x32_bf16 a[116:119], v[116:119], v[76:79], a[116:119]
v_mfma_f32_16x16x32_bf16 a[120:123], v[120:123], v[76:79], a[120:123]
ds_read_b64_tr_b16 v[176:177], v21 offset:49152
v_mfma_f32_16x16x32_bf16 a[124:127], v[124:127], v[76:79], a[124:127]
v_mfma_f32_16x16x32_bf16 a[128:131], v[96:99], v[80:83], a[128:131]
ds_read_b64_tr_b16 v[178:179], v21 offset:51200
v_mfma_f32_16x16x32_bf16 a[132:135], v[100:103], v[80:83], a[132:135]
v_mfma_f32_16x16x32_bf16 a[136:139], v[104:107], v[80:83], a[136:139]
ds_read_b128 v[148:151], v10 offset:41984
v_mfma_f32_16x16x32_bf16 a[140:143], v[108:111], v[80:83], a[140:143]
buffer_load_dwordx4 v15, s[12:15], s66 offen offset:3072 lds
v_mfma_f32_16x16x32_bf16 a[144:147], v[112:115], v[80:83], a[144:147]
v_mfma_f32_16x16x32_bf16 a[148:151], v[116:119], v[80:83], a[148:151]
ds_read_b64_tr_b16 v[180:181], v22 offset:49152
v_mfma_f32_16x16x32_bf16 a[152:155], v[120:123], v[80:83], a[152:155]
v_mfma_f32_16x16x32_bf16 a[156:159], v[124:127], v[80:83], a[156:159]
ds_read_b64_tr_b16 v[182:183], v22 offset:51200
v_mfma_f32_16x16x32_bf16 a[160:163], v[96:99], v[84:87], a[160:163]
v_mfma_f32_16x16x32_bf16 a[164:167], v[100:103], v[84:87], a[164:167]
ds_read_b128 v[152:155], v10 offset:45056
v_mfma_f32_16x16x32_bf16 a[168:171], v[104:107], v[84:87], a[168:171]
s_add_u32 s66, s66, 262144
v_mfma_f32_16x16x32_bf16 a[172:175], v[108:111], v[84:87], a[172:175]
ds_read_b64_tr_b16 v[184:185], v23 offset:49152
v_mfma_f32_16x16x32_bf16 a[176:179], v[112:115], v[84:87], a[176:179]
v_mfma_f32_16x16x32_bf16 a[180:183], v[116:119], v[84:87], a[180:183]
v_mfma_f32_16x16x32_bf16 a[184:187], v[120:123], v[84:87], a[184:187]
ds_read_b64_tr_b16 v[186:187], v23 offset:51200
v_mfma_f32_16x16x32_bf16 a[188:191], v[124:127], v[84:87], a[188:191]
v_mfma_f32_16x16x32_bf16 a[192:195], v[96:99], v[88:91], a[192:195]
ds_read_b128 v[156:159], v10 offset:46080
v_mfma_f32_16x16x32_bf16 a[196:199], v[100:103], v[88:91], a[196:199]
v_mfma_f32_16x16x32_bf16 a[200:203], v[104:107], v[88:91], a[200:203]
ds_read_b64_tr_b16 v[188:189], v24 offset:49152
v_mfma_f32_16x16x32_bf16 a[204:207], v[108:111], v[88:91], a[204:207]
v_mfma_f32_16x16x32_bf16 a[208:211], v[112:115], v[88:91], a[208:211]
ds_read_b64_tr_b16 v[190:191], v24 offset:51200
v_mfma_f32_16x16x32_bf16 a[212:215], v[116:119], v[88:91], a[212:215]
v_mfma_f32_16x16x32_bf16 a[216:219], v[120:123], v[88:91], a[216:219]
v_mfma_f32_16x16x32_bf16 a[220:223], v[124:127], v[88:91], a[220:223]
v_mfma_f32_16x16x32_bf16 a[224:227], v[96:99], v[92:95], a[224:227]
v_mfma_f32_16x16x32_bf16 a[228:231], v[100:103], v[92:95], a[228:231]
v_mfma_f32_16x16x32_bf16 a[232:235], v[104:107], v[92:95], a[232:235]
v_mfma_f32_16x16x32_bf16 a[236:239], v[108:111], v[92:95], a[236:239]
v_mfma_f32_16x16x32_bf16 a[240:243], v[112:115], v[92:95], a[240:243]
v_mfma_f32_16x16x32_bf16 a[244:247], v[116:119], v[92:95], a[244:247]
v_mfma_f32_16x16x32_bf16 a[248:251], v[120:123], v[92:95], a[248:251]
v_mfma_f32_16x16x32_bf16 a[252:255], v[124:127], v[92:95], a[252:255]
s_waitcnt lgkmcnt(0)
v_mfma_f32_16x16x32_bf16 a[0:3], v[160:163], v[128:131], a[0:3]
s_waitcnt vmcnt(9)
s_barrier
v_mfma_f32_16x16x32_bf16 a[4:7], v[164:167], v[128:131], a[4:7]
ds_read_b128 v[64:67], v16
v_mfma_f32_16x16x32_bf16 a[8:11], v[168:171], v[128:131], a[8:11]
s_add_u32 m0, s63, 32768
v_mfma_f32_16x16x32_bf16 a[12:15], v[172:175], v[128:131], a[12:15]
ds_read_b64_tr_b16 v[96:97], v17
s_add_u32 s62, s65, 0
v_mfma_f32_16x16x32_bf16 a[16:19], v[176:179], v[128:131], a[16:19]
v_mfma_f32_16x16x32_bf16 a[20:23], v[180:183], v[128:131], a[20:23]
ds_read_b64_tr_b16 v[98:99], v17 offset:2048
buffer_load_dwordx4 v8, s[8:11], s62 offen lds
v_mfma_f32_16x16x32_bf16 a[24:27], v[184:187], v[128:131], a[24:27]
v_mfma_f32_16x16x32_bf16 a[28:31], v[188:191], v[128:131], a[28:31]
ds_read_b128 v[68:71], v16 offset:1024
s_add_u32 s62, s65, 15360
v_mfma_f32_16x16x32_bf16 a[32:35], v[160:163], v[132:135], a[32:35]
v_mfma_f32_16x16x32_bf16 a[36:39], v[164:167], v[132:135], a[36:39]
buffer_load_dwordx4 v8, s[8:11], s62 offen offset:1024 lds
v_mfma_f32_16x16x32_bf16 a[40:43], v[168:171], v[132:135], a[40:43]
ds_read_b64_tr_b16 v[100:101], v18
v_mfma_f32_16x16x32_bf16 a[44:47], v[172:175], v[132:135], a[44:47]
s_add_u32 s62, s65, 30720
v_mfma_f32_16x16x32_bf16 a[48:51], v[176:179], v[132:135], a[48:51]
ds_read_b64_tr_b16 v[102:103], v18 offset:2048
buffer_load_dwordx4 v9, s[8:11], s62 offen offset:2048 lds
v_mfma_f32_16x16x32_bf16 a[52:55], v[180:183], v[132:135], a[52:55]
v_mfma_f32_16x16x32_bf16 a[56:59], v[184:187], v[132:135], a[56:59]
ds_read_b128 v[72:75], v16 offset:4096
s_add_u32 s62, s65, 46080
v_mfma_f32_16x16x32_bf16 a[60:63], v[188:191], v[132:135], a[60:63]
v_mfma_f32_16x16x32_bf16 a[64:67], v[160:163], v[136:139], a[64:67]
ds_read_b64_tr_b16 v[104:105], v19
buffer_load_dwordx4 v9, s[8:11], s62 offen offset:3072 lds
v_mfma_f32_16x16x32_bf16 a[68:71], v[164:167], v[136:139], a[68:71]
v_mfma_f32_16x16x32_bf16 a[72:75], v[168:171], v[136:139], a[72:75]
s_add_u32 m0, s63, 36864
v_mfma_f32_16x16x32_bf16 a[76:79], v[172:175], v[136:139], a[76:79]
ds_read_b64_tr_b16 v[106:107], v19 offset:2048
v_mfma_f32_16x16x32_bf16 a[80:83], v[176:179], v[136:139], a[80:83]
s_add_u32 s62, s65, 65536
v_mfma_f32_16x16x32_bf16 a[84:87], v[180:183], v[136:139], a[84:87]
ds_read_b128 v[76:79], v16 offset:5120
buffer_load_dwordx4 v8, s[8:11], s62 offen lds
v_mfma_f32_16x16x32_bf16 a[88:91], v[184:187], v[136:139], a[88:91]
v_mfma_f32_16x16x32_bf16 a[92:95], v[188:191], v[136:139], a[92:95]
ds_read_b64_tr_b16 v[108:109], v20
s_add_u32 s62, s65, 80896
v_mfma_f32_16x16x32_bf16 a[96:99], v[160:163], v[140:143], a[96:99]
v_mfma_f32_16x16x32_bf16 a[100:103], v[164:167], v[140:143], a[100:103]
ds_read_b64_tr_b16 v[110:111], v20 offset:2048
buffer_load_dwordx4 v8, s[8:11], s62 offen offset:1024 lds
v_mfma_f32_16x16x32_bf16 a[104:107], v[168:171], v[140:143], a[104:107]
v_mfma_f32_16x16x32_bf16 a[108:111], v[172:175], v[140:143], a[108:111]
s_add_u32 s62, s65, 96256
v_mfma_f32_16x16x32_bf16 a[112:115], v[176:179], v[140:143], a[112:115]
ds_read_b128 v[80:83], v16 offset:8192
v_mfma_f32_16x16x32_bf16 a[116:119], v[180:183], v[140:143], a[116:119]
buffer_load_dwordx4 v9, s[8:11], s62 offen offset:2048 lds
v_mfma_f32_16x16x32_bf16 a[120:123], v[184:187], v[140:143], a[120:123]
ds_read_b64_tr_b16 v[112:113], v21
s_add_u32 s62, s65, 111616
v_mfma_f32_16x16x32_bf16 a[124:127], v[188:191], v[140:143], a[124:127]
v_mfma_f32_16x16x32_bf16 a[128:131], v[160:163], v[144:147], a[128:131]
ds_read_b64_tr_b16 v[114:115], v21 offset:2048
buffer_load_dwordx4 v9, s[8:11], s62 offen offset:3072 lds
v_mfma_f32_16x16x32_bf16 a[132:135], v[164:167], v[144:147], a[132:135]
v_mfma_f32_16x16x32_bf16 a[136:139], v[168:171], v[144:147], a[136:139]
ds_read_b128 v[84:87], v16 offset:9216
s_add_u32 s65, s65, 128
v_mfma_f32_16x16x32_bf16 a[140:143], v[172:175], v[144:147], a[140:143]
v_mfma_f32_16x16x32_bf16 a[144:147], v[176:179], v[144:147], a[144:147]
s_add_u32 m0, s64, 114688
v_mfma_f32_16x16x32_bf16 a[148:151], v[180:183], v[144:147], a[148:151]
ds_read_b64_tr_b16 v[116:117], v22
v_mfma_f32_16x16x32_bf16 a[152:155], v[184:187], v[144:147], a[152:155]
s_nop 0
v_mfma_f32_16x16x32_bf16 a[156:159], v[188:191], v[144:147], a[156:159]
ds_read_b64_tr_b16 v[118:119], v22 offset:2048
buffer_load_dwordx4 v12, s[12:15], s66 offen lds
v_mfma_f32_16x16x32_bf16 a[160:163], v[160:163], v[148:151], a[160:163]
v_mfma_f32_16x16x32_bf16 a[164:167], v[164:167], v[148:151], a[164:167]
ds_read_b128 v[88:91], v16 offset:12288
buffer_load_dwordx4 v13, s[12:15], s66 offen offset:1024 lds
v_mfma_f32_16x16x32_bf16 a[168:171], v[168:171], v[148:151], a[168:171]
v_mfma_f32_16x16x32_bf16 a[172:175], v[172:175], v[148:151], a[172:175]
ds_read_b64_tr_b16 v[120:121], v23
buffer_load_dwordx4 v14, s[12:15], s66 offen offset:2048 lds
v_mfma_f32_16x16x32_bf16 a[176:179], v[176:179], v[148:151], a[176:179]
v_mfma_f32_16x16x32_bf16 a[180:183], v[180:183], v[148:151], a[180:183]
buffer_load_dwordx4 v15, s[12:15], s66 offen offset:3072 lds
v_mfma_f32_16x16x32_bf16 a[184:187], v[184:187], v[148:151], a[184:187]
ds_read_b64_tr_b16 v[122:123], v23 offset:2048
v_mfma_f32_16x16x32_bf16 a[188:191], v[188:191], v[148:151], a[188:191]
s_add_u32 s66, s66, 262144
v_mfma_f32_16x16x32_bf16 a[192:195], v[160:163], v[152:155], a[192:195]
ds_read_b128 v[92:95], v16 offset:13312
v_mfma_f32_16x16x32_bf16 a[196:199], v[164:167], v[152:155], a[196:199]
v_mfma_f32_16x16x32_bf16 a[200:203], v[168:171], v[152:155], a[200:203]
ds_read_b64_tr_b16 v[124:125], v24
v_mfma_f32_16x16x32_bf16 a[204:207], v[172:175], v[152:155], a[204:207]
v_mfma_f32_16x16x32_bf16 a[208:211], v[176:179], v[152:155], a[208:211]
ds_read_b64_tr_b16 v[126:127], v24 offset:2048
buffer_load_dword v248, v246, s[76:79], 0 offen
v_mfma_f32_16x16x32_bf16 a[212:215], v[180:183], v[152:155], a[212:215]
v_mfma_f32_16x16x32_bf16 a[216:219], v[184:187], v[152:155], a[216:219]
v_mfma_f32_16x16x32_bf16 a[220:223], v[188:191], v[152:155], a[220:223]
v_mfma_f32_16x16x32_bf16 a[224:227], v[160:163], v[156:159], a[224:227]
v_mfma_f32_16x16x32_bf16 a[228:231], v[164:167], v[156:159], a[228:231]
v_mfma_f32_16x16x32_bf16 a[232:235], v[168:171], v[156:159], a[232:235]
v_mfma_f32_16x16x32_bf16 a[236:239], v[172:175], v[156:159], a[236:239]
v_mfma_f32_16x16x32_bf16 a[240:243], v[176:179], v[156:159], a[240:243]
v_mfma_f32_16x16x32_bf16 a[244:247], v[180:183], v[156:159], a[244:247]
v_mfma_f32_16x16x32_bf16 a[248:251], v[184:187], v[156:159], a[248:251]
v_mfma_f32_16x16x32_bf16 a[252:255], v[188:191], v[156:159], a[252:255]
s_waitcnt lgkmcnt(0)
v_mfma_f32_16x16x32_bf16 a[0:3], v[96:99], v[64:67], a[0:3]
s_waitcnt vmcnt(18)
s_barrier
v_mfma_f32_16x16x32_bf16 a[4:7], v[100:103], v[64:67], a[4:7]
ds_read_b128 v[128:131], v10
v_mfma_f32_16x16x32_bf16 a[8:11], v[104:107], v[64:67], a[8:11]
s_add_u32 m0, s64, 65536
v_mfma_f32_16x16x32_bf16 a[12:15], v[108:111], v[64:67], a[12:15]
ds_read_b64_tr_b16 v[160:161], v17 offset:16384
v_mfma_f32_16x16x32_bf16 a[16:19], v[112:115], v[64:67], a[16:19]
v_mfma_f32_16x16x32_bf16 a[20:23], v[116:119], v[64:67], a[20:23]
ds_read_b64_tr_b16 v[162:163], v17 offset:18432
v_mfma_f32_16x16x32_bf16 a[24:27], v[120:123], v[64:67], a[24:27]
v_mfma_f32_16x16x32_bf16 a[28:31], v[124:127], v[64:67], a[28:31]
ds_read_b128 v[132:135], v10 offset:1024
v_mfma_f32_16x16x32_bf16 a[32:35], v[96:99], v[68:71], a[32:35]
s_nop 0
v_mfma_f32_16x16x32_bf16 a[36:39], v[100:103], v[68:71], a[36:39]
v_mfma_f32_16x16x32_bf16 a[40:43], v[104:107], v[68:71], a[40:43]
ds_read_b64_tr_b16 v[164:165], v18 offset:16384
v_mfma_f32_16x16x32_bf16 a[44:47], v[108:111], v[68:71], a[44:47]
v_mfma_f32_16x16x32_bf16 a[48:51], v[112:115], v[68:71], a[48:51]
ds_read_b64_tr_b16 v[166:167], v18 offset:18432
v_mfma_f32_16x16x32_bf16 a[52:55], v[116:119], v[68:71], a[52:55]
v_mfma_f32_16x16x32_bf16 a[56:59], v[120:123], v[68:71], a[56:59]
ds_read_b128 v[136:139], v10 offset:4096
v_mfma_f32_16x16x32_bf16 a[60:63], v[124:127], v[68:71], a[60:63]
buffer_load_dwordx4 v12, s[12:15], s66 offen lds
v_mfma_f32_16x16x32_bf16 a[64:67], v[96:99], v[72:75], a[64:67]
ds_read_b64_tr_b16 v[168:169], v19 offset:16384
v_mfma_f32_16x16x32_bf16 a[68:71], v[100:103], v[72:75], a[68:71]
v_mfma_f32_16x16x32_bf16 a[72:75], v[104:107], v[72:75], a[72:75]
v_mfma_f32_16x16x32_bf16 a[76:79], v[108:111], v[72:75], a[76:79]
ds_read_b64_tr_b16 v[170:171], v19 offset:18432
v_mfma_f32_16x16x32_bf16 a[80:83], v[112:115], v[72:75], a[80:83]
v_mfma_f32_16x16x32_bf16 a[84:87], v[116:119], v[72:75], a[84:87]
ds_read_b128 v[140:143], v10 offset:5120
v_mfma_f32_16x16x32_bf16 a[88:91], v[120:123], v[72:75], a[88:91]
buffer_load_dwordx4 v13, s[12:15], s66 offen offset:1024 lds
v_mfma_f32_16x16x32_bf16 a[92:95], v[124:127], v[72:75], a[92:95]
ds_read_b64_tr_b16 v[172:173], v20 offset:16384
v_mfma_f32_16x16x32_bf16 a[96:99], v[96:99], v[76:79], a[96:99]
v_mfma_f32_16x16x32_bf16 a[100:103], v[100:103], v[76:79], a[100:103]
ds_read_b64_tr_b16 v[174:175], v20 offset:18432
v_mfma_f32_16x16x32_bf16 a[104:107], v[104:107], v[76:79], a[104:107]
v_mfma_f32_16x16x32_bf16 a[108:111], v[108:111], v[76:79], a[108:111]
v_mfma_f32_16x16x32_bf16 a[112:115], v[112:115], v[76:79], a[112:115]
ds_read_b128 v[144:147], v10 offset:8192
buffer_load_dwordx4 v14, s[12:15], s66 offen offset:2048 lds
v_mfma_f32_16x16x32_bf16 a[116:119], v[116:119], v[76:79], a[116:119]
v_mfma_f32_16x16x32_bf16 a[120:123], v[120:123], v[76:79], a[120:123]
ds_read_b64_tr_b16 v[176:177], v21 offset:16384
v_mfma_f32_16x16x32_bf16 a[124:127], v[124:127], v[76:79], a[124:127]
v_mfma_f32_16x16x32_bf16 a[128:131], v[96:99], v[80:83], a[128:131]
ds_read_b64_tr_b16 v[178:179], v21 offset:18432
v_mfma_f32_16x16x32_bf16 a[132:135], v[100:103], v[80:83], a[132:135]
v_mfma_f32_16x16x32_bf16 a[136:139], v[104:107], v[80:83], a[136:139]
ds_read_b128 v[148:151], v10 offset:9216
v_mfma_f32_16x16x32_bf16 a[140:143], v[108:111], v[80:83], a[140:143]
buffer_load_dwordx4 v15, s[12:15], s66 offen offset:3072 lds
v_mfma_f32_16x16x32_bf16 a[144:147], v[112:115], v[80:83], a[144:147]
v_mfma_f32_16x16x32_bf16 a[148:151], v[116:119], v[80:83], a[148:151]
ds_read_b64_tr_b16 v[180:181], v22 offset:16384
v_mfma_f32_16x16x32_bf16 a[152:155], v[120:123], v[80:83], a[152:155]
v_mfma_f32_16x16x32_bf16 a[156:159], v[124:127], v[80:83], a[156:159]
ds_read_b64_tr_b16 v[182:183], v22 offset:18432
v_mfma_f32_16x16x32_bf16 a[160:163], v[96:99], v[84:87], a[160:163]
v_mfma_f32_16x16x32_bf16 a[164:167], v[100:103], v[84:87], a[164:167]
ds_read_b128 v[152:155], v10 offset:12288
v_mfma_f32_16x16x32_bf16 a[168:171], v[104:107], v[84:87], a[168:171]
s_add_u32 s66, s66, 262144
v_mfma_f32_16x16x32_bf16 a[172:175], v[108:111], v[84:87], a[172:175]
ds_read_b64_tr_b16 v[184:185], v23 offset:16384
v_mfma_f32_16x16x32_bf16 a[176:179], v[112:115], v[84:87], a[176:179]
v_mfma_f32_16x16x32_bf16 a[180:183], v[116:119], v[84:87], a[180:183]
v_mfma_f32_16x16x32_bf16 a[184:187], v[120:123], v[84:87], a[184:187]
ds_read_b64_tr_b16 v[186:187], v23 offset:18432
v_mfma_f32_16x16x32_bf16 a[188:191], v[124:127], v[84:87], a[188:191]
v_mfma_f32_16x16x32_bf16 a[192:195], v[96:99], v[88:91], a[192:195]
ds_read_b128 v[156:159], v10 offset:13312
v_mfma_f32_16x16x32_bf16 a[196:199], v[100:103], v[88:91], a[196:199]
v_mfma_f32_16x16x32_bf16 a[200:203], v[104:107], v[88:91], a[200:203]
ds_read_b64_tr_b16 v[188:189], v24 offset:16384
buffer_load_dwordx4 v[56:59], v5, s[88:91], 0 offen sc1
v_mfma_f32_16x16x32_bf16 a[204:207], v[108:111], v[88:91], a[204:207]
v_mfma_f32_16x16x32_bf16 a[208:211], v[112:115], v[88:91], a[208:211]
ds_read_b64_tr_b16 v[190:191], v24 offset:18432
v_mfma_f32_16x16x32_bf16 a[212:215], v[116:119], v[88:91], a[212:215]
v_mfma_f32_16x16x32_bf16 a[216:219], v[120:123], v[88:91], a[216:219]
v_mfma_f32_16x16x32_bf16 a[220:223], v[124:127], v[88:91], a[220:223]
v_mfma_f32_16x16x32_bf16 a[224:227], v[96:99], v[92:95], a[224:227]
v_mfma_f32_16x16x32_bf16 a[228:231], v[100:103], v[92:95], a[228:231]
v_mfma_f32_16x16x32_bf16 a[232:235], v[104:107], v[92:95], a[232:235]
v_mfma_f32_16x16x32_bf16 a[236:239], v[108:111], v[92:95], a[236:239]
v_mfma_f32_16x16x32_bf16 a[240:243], v[112:115], v[92:95], a[240:243]
v_mfma_f32_16x16x32_bf16 a[244:247], v[116:119], v[92:95], a[244:247]
v_mfma_f32_16x16x32_bf16 a[248:251], v[120:123], v[92:95], a[248:251]
v_mfma_f32_16x16x32_bf16 a[252:255], v[124:127], v[92:95], a[252:255]
s_waitcnt lgkmcnt(0)
v_mfma_f32_16x16x32_bf16 a[0:3], v[160:163], v[128:131], a[0:3]
s_waitcnt vmcnt(10)
s_barrier
v_mfma_f32_16x16x32_bf16 a[4:7], v[164:167], v[128:131], a[4:7]
ds_read_b128 v[64:67], v16 offset:32768
v_mfma_f32_16x16x32_bf16 a[8:11], v[168:171], v[128:131], a[8:11]
s_add_u32 m0, s63, 0
v_mfma_f32_16x16x32_bf16 a[12:15], v[172:175], v[128:131], a[12:15]
ds_read_b64_tr_b16 v[96:97], v17 offset:32768
s_add_u32 s62, s65, 0
v_mfma_f32_16x16x32_bf16 a[16:19], v[176:179], v[128:131], a[16:19]
v_mfma_f32_16x16x32_bf16 a[20:23], v[180:183], v[128:131], a[20:23]
ds_read_b64_tr_b16 v[98:99], v17 offset:34816
buffer_load_dwordx4 v8, s[8:11], s62 offen lds
v_mfma_f32_16x16x32_bf16 a[24:27], v[184:187], v[128:131], a[24:27]
v_mfma_f32_16x16x32_bf16 a[28:31], v[188:191], v[128:131], a[28:31]
ds_read_b128 v[68:71], v16 offset:33792
s_add_u32 s62, s65, 15360
v_mfma_f32_16x16x32_bf16 a[32:35], v[160:163], v[132:135], a[32:35]
v_mfma_f32_16x16x32_bf16 a[36:39], v[164:167], v[132:135], a[36:39]
buffer_load_dwordx4 v8, s[8:11], s62 offen offset:1024 lds
v_mfma_f32_16x16x32_bf16 a[40:43], v[168:171], v[132:135], a[40:43]
ds_read_b64_tr_b16 v[100:101], v18 offset:32768
v_mfma_f32_16x16x32_bf16 a[44:47], v[172:175], v[132:135], a[44:47]
s_add_u32 s62, s65, 30720
v_mfma_f32_16x16x32_bf16 a[48:51], v[176:179], v[132:135], a[48:51]
ds_read_b64_tr_b16 v[102:103], v18 offset:34816
buffer_load_dwordx4 v9, s[8:11], s62 offen offset:2048 lds
v_mfma_f32_16x16x32_bf16 a[52:55], v[180:183], v[132:135], a[52:55]
v_mfma_f32_16x16x32_bf16 a[56:59], v[184:187], v[132:135], a[56:59]
ds_read_b128 v[72:75], v16 offset:36864
s_add_u32 s62, s65, 46080
v_mfma_f32_16x16x32_bf16 a[60:63], v[188:191], v[132:135], a[60:63]
v_mfma_f32_16x16x32_bf16 a[64:67], v[160:163], v[136:139], a[64:67]
ds_read_b64_tr_b16 v[104:105], v19 offset:32768
buffer_load_dwordx4 v9, s[8:11], s62 offen offset:3072 lds
v_mfma_f32_16x16x32_bf16 a[68:71], v[164:167], v[136:139], a[68:71]
v_mfma_f32_16x16x32_bf16 a[72:75], v[168:171], v[136:139], a[72:75]
s_add_u32 m0, s63, 4096
v_mfma_f32_16x16x32_bf16 a[76:79], v[172:175], v[136:139], a[76:79]
ds_read_b64_tr_b16 v[106:107], v19 offset:34816
v_mfma_f32_16x16x32_bf16 a[80:83], v[176:179], v[136:139], a[80:83]
s_add_u32 s62, s65, 65536
v_mfma_f32_16x16x32_bf16 a[84:87], v[180:183], v[136:139], a[84:87]
ds_read_b128 v[76:79], v16 offset:37888
buffer_load_dwordx4 v8, s[8:11], s62 offen lds
v_mfma_f32_16x16x32_bf16 a[88:91], v[184:187], v[136:139], a[88:91]
v_mfma_f32_16x16x32_bf16 a[92:95], v[188:191], v[136:139], a[92:95]
ds_read_b64_tr_b16 v[108:109], v20 offset:32768
s_add_u32 s62, s65, 80896
v_mfma_f32_16x16x32_bf16 a[96:99], v[160:163], v[140:143], a[96:99]
v_mfma_f32_16x16x32_bf16 a[100:103], v[164:167], v[140:143], a[100:103]
ds_read_b64_tr_b16 v[110:111], v20 offset:34816
buffer_load_dwordx4 v8, s[8:11], s62 offen offset:1024 lds
v_mfma_f32_16x16x32_bf16 a[104:107], v[168:171], v[140:143], a[104:107]
v_mfma_f32_16x16x32_bf16 a[108:111], v[172:175], v[140:143], a[108:111]
s_add_u32 s62, s65, 96256
v_mfma_f32_16x16x32_bf16 a[112:115], v[176:179], v[140:143], a[112:115]
ds_read_b128 v[80:83], v16 offset:40960
v_mfma_f32_16x16x32_bf16 a[116:119], v[180:183], v[140:143], a[116:119]
buffer_load_dwordx4 v9, s[8:11], s62 offen offset:2048 lds
v_mfma_f32_16x16x32_bf16 a[120:123], v[184:187], v[140:143], a[120:123]
ds_read_b64_tr_b16 v[112:113], v21 offset:32768
s_add_u32 s62, s65, 111616
v_mfma_f32_16x16x32_bf16 a[124:127], v[188:191], v[140:143], a[124:127]
v_mfma_f32_16x16x32_bf16 a[128:131], v[160:163], v[144:147], a[128:131]
ds_read_b64_tr_b16 v[114:115], v21 offset:34816
buffer_load_dwordx4 v9, s[8:11], s62 offen offset:3072 lds
v_mfma_f32_16x16x32_bf16 a[132:135], v[164:167], v[144:147], a[132:135]
v_mfma_f32_16x16x32_bf16 a[136:139], v[168:171], v[144:147], a[136:139]
ds_read_b128 v[84:87], v16 offset:41984
s_add_u32 s65, s65, 128
v_mfma_f32_16x16x32_bf16 a[140:143], v[172:175], v[144:147], a[140:143]
v_mfma_f32_16x16x32_bf16 a[144:147], v[176:179], v[144:147], a[144:147]
s_add_u32 m0, s64, 81920
v_mfma_f32_16x16x32_bf16 a[148:151], v[180:183], v[144:147], a[148:151]
ds_read_b64_tr_b16 v[116:117], v22 offset:32768
v_mfma_f32_16x16x32_bf16 a[152:155], v[184:187], v[144:147], a[152:155]
s_nop 0
v_mfma_f32_16x16x32_bf16 a[156:159], v[188:191], v[144:147], a[156:159]
ds_read_b64_tr_b16 v[118:119], v22 offset:34816
buffer_load_dwordx4 v12, s[12:15], s66 offen lds
v_mfma_f32_16x16x32_bf16 a[160:163], v[160:163], v[148:151], a[160:163]
v_mfma_f32_16x16x32_bf16 a[164:167], v[164:167], v[148:151], a[164:167]
ds_read_b128 v[88:91], v16 offset:45056
buffer_load_dwordx4 v13, s[12:15], s66 offen offset:1024 lds
v_mfma_f32_16x16x32_bf16 a[168:171], v[168:171], v[148:151], a[168:171]
v_mfma_f32_16x16x32_bf16 a[172:175], v[172:175], v[148:151], a[172:175]
ds_read_b64_tr_b16 v[120:121], v23 offset:32768
buffer_load_dwordx4 v14, s[12:15], s66 offen offset:2048 lds
v_mfma_f32_16x16x32_bf16 a[176:179], v[176:179], v[148:151], a[176:179]
v_mfma_f32_16x16x32_bf16 a[180:183], v[180:183], v[148:151], a[180:183]
buffer_load_dwordx4 v15, s[12:15], s66 offen offset:3072 lds
v_mfma_f32_16x16x32_bf16 a[184:187], v[184:187], v[148:151], a[184:187]
ds_read_b64_tr_b16 v[122:123], v23 offset:34816
v_mfma_f32_16x16x32_bf16 a[188:191], v[188:191], v[148:151], a[188:191]
s_add_u32 s66, s66, 262144
v_mfma_f32_16x16x32_bf16 a[192:195], v[160:163], v[152:155], a[192:195]
ds_read_b128 v[92:95], v16 offset:46080
v_mfma_f32_16x16x32_bf16 a[196:199], v[164:167], v[152:155], a[196:199]
v_mfma_f32_16x16x32_bf16 a[200:203], v[168:171], v[152:155], a[200:203]
ds_read_b64_tr_b16 v[124:125], v24 offset:32768
v_mfma_f32_16x16x32_bf16 a[204:207], v[172:175], v[152:155], a[204:207]
v_mfma_f32_16x16x32_bf16 a[208:211], v[176:179], v[152:155], a[208:211]
ds_read_b64_tr_b16 v[126:127], v24 offset:34816
buffer_load_dword v248, v246, s[80:83], 0 offen
v_mfma_f32_16x16x32_bf16 a[212:215], v[180:183], v[152:155], a[212:215]
v_mfma_f32_16x16x32_bf16 a[216:219], v[184:187], v[152:155], a[216:219]
v_mfma_f32_16x16x32_bf16 a[220:223], v[188:191], v[152:155], a[220:223]
v_mfma_f32_16x16x32_bf16 a[224:227], v[160:163], v[156:159], a[224:227]
v_mfma_f32_16x16x32_bf16 a[228:231], v[164:167], v[156:159], a[228:231]
v_mfma_f32_16x16x32_bf16 a[232:235], v[168:171], v[156:159], a[232:235]
v_mfma_f32_16x16x32_bf16 a[236:239], v[172:175], v[156:159], a[236:239]
v_mfma_f32_16x16x32_bf16 a[240:243], v[176:179], v[156:159], a[240:243]
v_mfma_f32_16x16x32_bf16 a[244:247], v[180:183], v[156:159], a[244:247]
v_mfma_f32_16x16x32_bf16 a[248:251], v[184:187], v[156:159], a[248:251]
v_mfma_f32_16x16x32_bf16 a[252:255], v[188:191], v[156:159], a[252:255]
s_waitcnt lgkmcnt(0)
v_mfma_f32_16x16x32_bf16 a[0:3], v[96:99], v[64:67], a[0:3]
s_waitcnt vmcnt(19)
s_barrier
v_mfma_f32_16x16x32_bf16 a[4:7], v[100:103], v[64:67], a[4:7]
ds_read_b128 v[128:131], v10 offset:32768
v_mfma_f32_16x16x32_bf16 a[8:11], v[104:107], v[64:67], a[8:11]
s_add_u32 m0, s64, 98304
v_mfma_f32_16x16x32_bf16 a[12:15], v[108:111], v[64:67], a[12:15]
ds_read_b64_tr_b16 v[160:161], v17 offset:49152
v_mfma_f32_16x16x32_bf16 a[16:19], v[112:115], v[64:67], a[16:19]
v_mfma_f32_16x16x32_bf16 a[20:23], v[116:119], v[64:67], a[20:23]
ds_read_b64_tr_b16 v[162:163], v17 offset:51200
v_mfma_f32_16x16x32_bf16 a[24:27], v[120:123], v[64:67], a[24:27]
v_mfma_f32_16x16x32_bf16 a[28:31], v[124:127], v[64:67], a[28:31]
ds_read_b128 v[132:135], v10 offset:33792
v_mfma_f32_16x16x32_bf16 a[32:35], v[96:99], v[68:71], a[32:35]
s_nop 0
v_mfma_f32_16x16x32_bf16 a[36:39], v[100:103], v[68:71], a[36:39]
v_mfma_f32_16x16x32_bf16 a[40:43], v[104:107], v[68:71], a[40:43]
ds_read_b64_tr_b16 v[164:165], v18 offset:49152
v_mfma_f32_16x16x32_bf16 a[44:47], v[108:111], v[68:71], a[44:47]
v_mfma_f32_16x16x32_bf16 a[48:51], v[112:115], v[68:71], a[48:51]
ds_read_b64_tr_b16 v[166:167], v18 offset:51200
v_mfma_f32_16x16x32_bf16 a[52:55], v[116:119], v[68:71], a[52:55]
v_mfma_f32_16x16x32_bf16 a[56:59], v[120:123], v[68:71], a[56:59]
ds_read_b128 v[136:139], v10 offset:36864
v_mfma_f32_16x16x32_bf16 a[60:63], v[124:127], v[68:71], a[60:63]
buffer_load_dwordx4 v12, s[12:15], s66 offen lds
v_mfma_f32_16x16x32_bf16 a[64:67], v[96:99], v[72:75], a[64:67]
ds_read_b64_tr_b16 v[168:169], v19 offset:49152
v_mfma_f32_16x16x32_bf16 a[68:71], v[100:103], v[72:75], a[68:71]
v_mfma_f32_16x16x32_bf16 a[72:75], v[104:107], v[72:75], a[72:75]
v_mfma_f32_16x16x32_bf16 a[76:79], v[108:111], v[72:75], a[76:79]
ds_read_b64_tr_b16 v[170:171], v19 offset:51200
v_mfma_f32_16x16x32_bf16 a[80:83], v[112:115], v[72:75], a[80:83]
v_mfma_f32_16x16x32_bf16 a[84:87], v[116:119], v[72:75], a[84:87]
ds_read_b128 v[140:143], v10 offset:37888
v_mfma_f32_16x16x32_bf16 a[88:91], v[120:123], v[72:75], a[88:91]
buffer_load_dwordx4 v13, s[12:15], s66 offen offset:1024 lds
v_mfma_f32_16x16x32_bf16 a[92:95], v[124:127], v[72:75], a[92:95]
ds_read_b64_tr_b16 v[172:173], v20 offset:49152
v_mfma_f32_16x16x32_bf16 a[96:99], v[96:99], v[76:79], a[96:99]
v_mfma_f32_16x16x32_bf16 a[100:103], v[100:103], v[76:79], a[100:103]
ds_read_b64_tr_b16 v[174:175], v20 offset:51200
v_mfma_f32_16x16x32_bf16 a[104:107], v[104:107], v[76:79], a[104:107]
v_mfma_f32_16x16x32_bf16 a[108:111], v[108:111], v[76:79], a[108:111]
v_mfma_f32_16x16x32_bf16 a[112:115], v[112:115], v[76:79], a[112:115]
ds_read_b128 v[144:147], v10 offset:40960
buffer_load_dwordx4 v14, s[12:15], s66 offen offset:2048 lds
v_mfma_f32_16x16x32_bf16 a[116:119], v[116:119], v[76:79], a[116:119]
v_mfma_f32_16x16x32_bf16 a[120:123], v[120:123], v[76:79], a[120:123]
ds_read_b64_tr_b16 v[176:177], v21 offset:49152
v_mfma_f32_16x16x32_bf16 a[124:127], v[124:127], v[76:79], a[124:127]
v_mfma_f32_16x16x32_bf16 a[128:131], v[96:99], v[80:83], a[128:131]
ds_read_b64_tr_b16 v[178:179], v21 offset:51200
v_mfma_f32_16x16x32_bf16 a[132:135], v[100:103], v[80:83], a[132:135]
v_mfma_f32_16x16x32_bf16 a[136:139], v[104:107], v[80:83], a[136:139]
ds_read_b128 v[148:151], v10 offset:41984
v_mfma_f32_16x16x32_bf16 a[140:143], v[108:111], v[80:83], a[140:143]
buffer_load_dwordx4 v15, s[12:15], s66 offen offset:3072 lds
v_mfma_f32_16x16x32_bf16 a[144:147], v[112:115], v[80:83], a[144:147]
v_mfma_f32_16x16x32_bf16 a[148:151], v[116:119], v[80:83], a[148:151]
ds_read_b64_tr_b16 v[180:181], v22 offset:49152
v_mfma_f32_16x16x32_bf16 a[152:155], v[120:123], v[80:83], a[152:155]
v_mfma_f32_16x16x32_bf16 a[156:159], v[124:127], v[80:83], a[156:159]
ds_read_b64_tr_b16 v[182:183], v22 offset:51200
v_mfma_f32_16x16x32_bf16 a[160:163], v[96:99], v[84:87], a[160:163]
v_mfma_f32_16x16x32_bf16 a[164:167], v[100:103], v[84:87], a[164:167]
ds_read_b128 v[152:155], v10 offset:45056
v_mfma_f32_16x16x32_bf16 a[168:171], v[104:107], v[84:87], a[168:171]
s_add_u32 s66, s66, 262144
v_mfma_f32_16x16x32_bf16 a[172:175], v[108:111], v[84:87], a[172:175]
ds_read_b64_tr_b16 v[184:185], v23 offset:49152
v_mfma_f32_16x16x32_bf16 a[176:179], v[112:115], v[84:87], a[176:179]
v_mfma_f32_16x16x32_bf16 a[180:183], v[116:119], v[84:87], a[180:183]
v_mfma_f32_16x16x32_bf16 a[184:187], v[120:123], v[84:87], a[184:187]
ds_read_b64_tr_b16 v[186:187], v23 offset:51200
v_mfma_f32_16x16x32_bf16 a[188:191], v[124:127], v[84:87], a[188:191]
v_mfma_f32_16x16x32_bf16 a[192:195], v[96:99], v[88:91], a[192:195]
ds_read_b128 v[156:159], v10 offset:46080
v_mfma_f32_16x16x32_bf16 a[196:199], v[100:103], v[88:91], a[196:199]
v_mfma_f32_16x16x32_bf16 a[200:203], v[104:107], v[88:91], a[200:203]
ds_read_b64_tr_b16 v[188:189], v24 offset:49152
s_waitcnt vmcnt(17)
s_mov_b32 s87, 0
PSA_4:
v_and_b32 v56, v56, v57
v_and_b32 v58, v58, v59
v_and_b32 v56, v56, v58
v_cmp_ne_u32 vcc, 1, v56
s_cbranch_vccz PSA_4_OK
s_sleep 1
buffer_load_dwordx4 v[56:59], v5, s[88:91], 0 offen sc1
s_waitcnt vmcnt(0)
s_add_u32 s87, s87, 1
s_cmp_lt_u32 s87, 65536
s_cbranch_scc1 PSA_4
PSA_4_OK:
v_mfma_f32_16x16x32_bf16 a[204:207], v[108:111], v[88:91], a[204:207]
v_mfma_f32_16x16x32_bf16 a[208:211], v[112:115], v[88:91], a[208:211]
ds_read_b64_tr_b16 v[190:191], v24 offset:51200
v_mfma_f32_16x16x32_bf16 a[212:215], v[116:119], v[88:91], a[212:215]
v_mfma_f32_16x16x32_bf16 a[216:219], v[120:123], v[88:91], a[216:219]
v_mfma_f32_16x16x32_bf16 a[220:223], v[124:127], v[88:91], a[220:223]
v_mfma_f32_16x16x32_bf16 a[224:227], v[96:99], v[92:95], a[224:227]
v_mfma_f32_16x16x32_bf16 a[228:231], v[100:103], v[92:95], a[228:231]
v_mfma_f32_16x16x32_bf16 a[232:235], v[104:107], v[92:95], a[232:235]
v_mfma_f32_16x16x32_bf16 a[236:239], v[108:111], v[92:95], a[236:239]
v_mfma_f32_16x16x32_bf16 a[240:243], v[112:115], v[92:95], a[240:243]
v_mfma_f32_16x16x32_bf16 a[244:247], v[116:119], v[92:95], a[244:247]
v_mfma_f32_16x16x32_bf16 a[248:251], v[120:123], v[92:95], a[248:251]
v_mfma_f32_16x16x32_bf16 a[252:255], v[124:127], v[92:95], a[252:255]
s_waitcnt lgkmcnt(0)
v_mfma_f32_16x16x32_bf16 a[0:3], v[160:163], v[128:131], a[0:3]
s_waitcnt vmcnt(9)
s_barrier
v_mfma_f32_16x16x32_bf16 a[4:7], v[164:167], v[128:131], a[4:7]
ds_read_b128 v[64:67], v16
v_mfma_f32_16x16x32_bf16 a[8:11], v[168:171], v[128:131], a[8:11]
s_add_u32 m0, s63, 32768
v_mfma_f32_16x16x32_bf16 a[12:15], v[172:175], v[128:131], a[12:15]
ds_read_b64_tr_b16 v[96:97], v17
s_add_u32 s62, s65, 0
v_mfma_f32_16x16x32_bf16 a[16:19], v[176:179], v[128:131], a[16:19]
v_mfma_f32_16x16x32_bf16 a[20:23], v[180:183], v[128:131], a[20:23]
ds_read_b64_tr_b16 v[98:99], v17 offset:2048
buffer_load_dwordx4 v8, s[8:11], s62 offen lds
v_mfma_f32_16x16x32_bf16 a[24:27], v[184:187], v[128:131], a[24:27]
v_mfma_f32_16x16x32_bf16 a[28:31], v[188:191], v[128:131], a[28:31]
ds_read_b128 v[68:71], v16 offset:1024
s_add_u32 s62, s65, 15360
v_mfma_f32_16x16x32_bf16 a[32:35], v[160:163], v[132:135], a[32:35]
v_mfma_f32_16x16x32_bf16 a[36:39], v[164:167], v[132:135], a[36:39]
buffer_load_dwordx4 v8, s[8:11], s62 offen offset:1024 lds
v_mfma_f32_16x16x32_bf16 a[40:43], v[168:171], v[132:135], a[40:43]
ds_read_b64_tr_b16 v[100:101], v18
v_mfma_f32_16x16x32_bf16 a[44:47], v[172:175], v[132:135], a[44:47]
s_add_u32 s62, s65, 30720
v_mfma_f32_16x16x32_bf16 a[48:51], v[176:179], v[132:135], a[48:51]
ds_read_b64_tr_b16 v[102:103], v18 offset:2048
buffer_load_dwordx4 v9, s[8:11], s62 offen offset:2048 lds
v_mfma_f32_16x16x32_bf16 a[52:55], v[180:183], v[132:135], a[52:55]
v_mfma_f32_16x16x32_bf16 a[56:59], v[184:187], v[132:135], a[56:59]
ds_read_b128 v[72:75], v16 offset:4096
s_add_u32 s62, s65, 46080
v_mfma_f32_16x16x32_bf16 a[60:63], v[188:191], v[132:135], a[60:63]
v_mfma_f32_16x16x32_bf16 a[64:67], v[160:163], v[136:139], a[64:67]
ds_read_b64_tr_b16 v[104:105], v19
buffer_load_dwordx4 v9, s[8:11], s62 offen offset:3072 lds
v_mfma_f32_16x16x32_bf16 a[68:71], v[164:167], v[136:139], a[68:71]
v_mfma_f32_16x16x32_bf16 a[72:75], v[168:171], v[136:139], a[72:75]
s_add_u32 m0, s63, 36864
v_mfma_f32_16x16x32_bf16 a[76:79], v[172:175], v[136:139], a[76:79]
ds_read_b64_tr_b16 v[106:107], v19 offset:2048
v_mfma_f32_16x16x32_bf16 a[80:83], v[176:179], v[136:139], a[80:83]
s_add_u32 s62, s65, 65536
v_mfma_f32_16x16x32_bf16 a[84:87], v[180:183], v[136:139], a[84:87]
ds_read_b128 v[76:79], v16 offset:5120
buffer_load_dwordx4 v8, s[8:11], s62 offen lds
v_mfma_f32_16x16x32_bf16 a[88:91], v[184:187], v[136:139], a[88:91]
v_mfma_f32_16x16x32_bf16 a[92:95], v[188:191], v[136:139], a[92:95]
ds_read_b64_tr_b16 v[108:109], v20
s_add_u32 s62, s65, 80896
v_mfma_f32_16x16x32_bf16 a[96:99], v[160:163], v[140:143], a[96:99]
v_mfma_f32_16x16x32_bf16 a[100:103], v[164:167], v[140:143], a[100:103]
ds_read_b64_tr_b16 v[110:111], v20 offset:2048
buffer_load_dwordx4 v8, s[8:11], s62 offen offset:1024 lds
v_mfma_f32_16x16x32_bf16 a[104:107], v[168:171], v[140:143], a[104:107]
v_mfma_f32_16x16x32_bf16 a[108:111], v[172:175], v[140:143], a[108:111]
s_add_u32 s62, s65, 96256
v_mfma_f32_16x16x32_bf16 a[112:115], v[176:179], v[140:143], a[112:115]
ds_read_b128 v[80:83], v16 offset:8192
v_mfma_f32_16x16x32_bf16 a[116:119], v[180:183], v[140:143], a[116:119]
buffer_load_dwordx4 v9, s[8:11], s62 offen offset:2048 lds
v_mfma_f32_16x16x32_bf16 a[120:123], v[184:187], v[140:143], a[120:123]
ds_read_b64_tr_b16 v[112:113], v21
s_add_u32 s62, s65, 111616
v_mfma_f32_16x16x32_bf16 a[124:127], v[188:191], v[140:143], a[124:127]
v_mfma_f32_16x16x32_bf16 a[128:131], v[160:163], v[144:147], a[128:131]
ds_read_b64_tr_b16 v[114:115], v21 offset:2048
buffer_load_dwordx4 v9, s[8:11], s62 offen offset:3072 lds
v_mfma_f32_16x16x32_bf16 a[132:135], v[164:167], v[144:147], a[132:135]
v_mfma_f32_16x16x32_bf16 a[136:139], v[168:171], v[144:147], a[136:139]
ds_read_b128 v[84:87], v16 offset:9216
s_add_u32 s65, s65, 128
v_mfma_f32_16x16x32_bf16 a[140:143], v[172:175], v[144:147], a[140:143]
v_mfma_f32_16x16x32_bf16 a[144:147], v[176:179], v[144:147], a[144:147]
s_add_u32 m0, s64, 114688
v_mfma_f32_16x16x32_bf16 a[148:151], v[180:183], v[144:147], a[148:151]
ds_read_b64_tr_b16 v[116:117], v22
v_mfma_f32_16x16x32_bf16 a[152:155], v[184:187], v[144:147], a[152:155]
s_nop 0
v_mfma_f32_16x16x32_bf16 a[156:159], v[188:191], v[144:147], a[156:159]
ds_read_b64_tr_b16 v[118:119], v22 offset:2048
buffer_load_dwordx4 v12, s[12:15], s66 offen lds
v_mfma_f32_16x16x32_bf16 a[160:163], v[160:163], v[148:151], a[160:163]
v_mfma_f32_16x16x32_bf16 a[164:167], v[164:167], v[148:151], a[164:167]
ds_read_b128 v[88:91], v16 offset:12288
buffer_load_dwordx4 v13, s[12:15], s66 offen offset:1024 lds
v_mfma_f32_16x16x32_bf16 a[168:171], v[168:171], v[148:151], a[168:171]
v_mfma_f32_16x16x32_bf16 a[172:175], v[172:175], v[148:151], a[172:175]
ds_read_b64_tr_b16 v[120:121], v23
buffer_load_dwordx4 v14, s[12:15], s66 offen offset:2048 lds
v_mfma_f32_16x16x32_bf16 a[176:179], v[176:179], v[148:151], a[176:179]
v_mfma_f32_16x16x32_bf16 a[180:183], v[180:183], v[148:151], a[180:183]
buffer_load_dwordx4 v15, s[12:15], s66 offen offset:3072 lds
v_mfma_f32_16x16x32_bf16 a[184:187], v[184:187], v[148:151], a[184:187]
ds_read_b64_tr_b16 v[122:123], v23 offset:2048
v_mfma_f32_16x16x32_bf16 a[188:191], v[188:191], v[148:151], a[188:191]
s_add_u32 s66, s66, 262144
v_mfma_f32_16x16x32_bf16 a[192:195], v[160:163], v[152:155], a[192:195]
ds_read_b128 v[92:95], v16 offset:13312
v_mfma_f32_16x16x32_bf16 a[196:199], v[164:167], v[152:155], a[196:199]
v_mfma_f32_16x16x32_bf16 a[200:203], v[168:171], v[152:155], a[200:203]
ds_read_b64_tr_b16 v[124:125], v24
v_mfma_f32_16x16x32_bf16 a[204:207], v[172:175], v[152:155], a[204:207]
v_mfma_f32_16x16x32_bf16 a[208:211], v[176:179], v[152:155], a[208:211]
ds_read_b64_tr_b16 v[126:127], v24 offset:2048
v_mfma_f32_16x16x32_bf16 a[212:215], v[180:183], v[152:155], a[212:215]
v_mfma_f32_16x16x32_bf16 a[216:219], v[184:187], v[152:155], a[216:219]
v_mfma_f32_16x16x32_bf16 a[220:223], v[188:191], v[152:155], a[220:223]
v_mfma_f32_16x16x32_bf16 a[224:227], v[160:163], v[156:159], a[224:227]
v_mfma_f32_16x16x32_bf16 a[228:231], v[164:167], v[156:159], a[228:231]
v_mfma_f32_16x16x32_bf16 a[232:235], v[168:171], v[156:159], a[232:235]
v_mfma_f32_16x16x32_bf16 a[236:239], v[172:175], v[156:159], a[236:239]
v_mfma_f32_16x16x32_bf16 a[240:243], v[176:179], v[156:159], a[240:243]
v_mfma_f32_16x16x32_bf16 a[244:247], v[180:183], v[156:159], a[244:247]
v_mfma_f32_16x16x32_bf16 a[248:251], v[184:187], v[156:159], a[248:251]
v_mfma_f32_16x16x32_bf16 a[252:255], v[188:191], v[156:159], a[252:255]
s_waitcnt lgkmcnt(0)
v_mfma_f32_16x16x32_bf16 a[0:3], v[96:99], v[64:67], a[0:3]
s_waitcnt vmcnt(17)
s_barrier
v_mfma_f32_16x16x32_bf16 a[4:7], v[100:103], v[64:67], a[4:7]
ds_read_b128 v[128:131], v10
v_mfma_f32_16x16x32_bf16 a[8:11], v[104:107], v[64:67], a[8:11]
s_add_u32 m0, s64, 65536
v_mfma_f32_16x16x32_bf16 a[12:15], v[108:111], v[64:67], a[12:15]
ds_read_b64_tr_b16 v[160:161], v17 offset:16384
v_mfma_f32_16x16x32_bf16 a[16:19], v[112:115], v[64:67], a[16:19]
v_mfma_f32_16x16x32_bf16 a[20:23], v[116:119], v[64:67], a[20:23]
ds_read_b64_tr_b16 v[162:163], v17 offset:18432
v_mfma_f32_16x16x32_bf16 a[24:27], v[120:123], v[64:67], a[24:27]
s_add_u32 s56, s69, 0
v_mfma_f32_16x16x32_bf16 a[28:31], v[124:127], v[64:67], a[28:31]
ds_read_b128 v[132:135], v10 offset:1024
v_mfma_f32_16x16x32_bf16 a[32:35], v[96:99], v[68:71], a[32:35]
v_mfma_f32_16x16x32_bf16 a[36:39], v[100:103], v[68:71], a[36:39]
v_mfma_f32_16x16x32_bf16 a[40:43], v[104:107], v[68:71], a[40:43]
ds_read_b64_tr_b16 v[164:165], v18 offset:16384
v_mfma_f32_16x16x32_bf16 a[44:47], v[108:111], v[68:71], a[44:47]
buffer_load_dwordx4 v5, s[24:27], s56 offen sc1 lds
v_mfma_f32_16x16x32_bf16 a[48:51], v[112:115], v[68:71], a[48:51]
ds_read_b64_tr_b16 v[166:167], v18 offset:18432
v_mfma_f32_16x16x32_bf16 a[52:55], v[116:119], v[68:71], a[52:55]
v_mfma_f32_16x16x32_bf16 a[56:59], v[120:123], v[68:71], a[56:59]
ds_read_b128 v[136:139], v10 offset:4096
v_mfma_f32_16x16x32_bf16 a[60:63], v[124:127], v[68:71], a[60:63]
v_mfma_f32_16x16x32_bf16 a[64:67], v[96:99], v[72:75], a[64:67]
ds_read_b64_tr_b16 v[168:169], v19 offset:16384
buffer_load_dwordx4 v5, s[24:27], s56 offen offset:1024 sc1 lds
v_mfma_f32_16x16x32_bf16 a[68:71], v[100:103], v[72:75], a[68:71]
v_mfma_f32_16x16x32_bf16 a[72:75], v[104:107], v[72:75], a[72:75]
v_mfma_f32_16x16x32_bf16 a[76:79], v[108:111], v[72:75], a[76:79]
ds_read_b64_tr_b16 v[170:171], v19 offset:18432
v_mfma_f32_16x16x32_bf16 a[80:83], v[112:115], v[72:75], a[80:83]
v_mfma_f32_16x16x32_bf16 a[84:87], v[116:119], v[72:75], a[84:87]
ds_read_b128 v[140:143], v10 offset:5120
buffer_load_dwordx4 v5, s[24:27], s56 offen offset:2048 sc1 lds
v_mfma_f32_16x16x32_bf16 a[88:91], v[120:123], v[72:75], a[88:91]
v_mfma_f32_16x16x32_bf16 a[92:95], v[124:127], v[72:75], a[92:95]
ds_read_b64_tr_b16 v[172:173], v20 offset:16384
v_mfma_f32_16x16x32_bf16 a[96:99], v[96:99], v[76:79], a[96:99]
v_mfma_f32_16x16x32_bf16 a[100:103], v[100:103], v[76:79], a[100:103]
ds_read_b64_tr_b16 v[174:175], v20 offset:18432
v_mfma_f32_16x16x32_bf16 a[104:107], v[104:107], v[76:79], a[104:107]
buffer_load_dwordx4 v5, s[24:27], s56 offen offset:3072 sc1 lds
v_mfma_f32_16x16x32_bf16 a[108:111], v[108:111], v[76:79], a[108:111]
v_mfma_f32_16x16x32_bf16 a[112:115], v[112:115], v[76:79], a[112:115]
ds_read_b128 v[144:147], v10 offset:8192
v_mfma_f32_16x16x32_bf16 a[116:119], v[116:119], v[76:79], a[116:119]
v_mfma_f32_16x16x32_bf16 a[120:123], v[120:123], v[76:79], a[120:123]
ds_read_b64_tr_b16 v[176:177], v21 offset:16384
v_mfma_f32_16x16x32_bf16 a[124:127], v[124:127], v[76:79], a[124:127]
v_mfma_f32_16x16x32_bf16 a[128:131], v[96:99], v[80:83], a[128:131]
ds_read_b64_tr_b16 v[178:179], v21 offset:18432
v_mfma_f32_16x16x32_bf16 a[132:135], v[100:103], v[80:83], a[132:135]
v_mfma_f32_16x16x32_bf16 a[136:139], v[104:107], v[80:83], a[136:139]
ds_read_b128 v[148:151], v10 offset:9216
s_add_u32 m0, s86, 16384
v_mfma_f32_16x16x32_bf16 a[140:143], v[108:111], v[80:83], a[140:143]
v_mfma_f32_16x16x32_bf16 a[144:147], v[112:115], v[80:83], a[144:147]
s_nop 0
v_mfma_f32_16x16x32_bf16 a[148:151], v[116:119], v[80:83], a[148:151]
ds_read_b64_tr_b16 v[180:181], v22 offset:16384
v_mfma_f32_16x16x32_bf16 a[152:155], v[120:123], v[80:83], a[152:155]
v_mfma_f32_16x16x32_bf16 a[156:159], v[124:127], v[80:83], a[156:159]
ds_read_b64_tr_b16 v[182:183], v22 offset:18432
buffer_load_dwordx4 v27, s[28:31], s60 offen lds
v_mfma_f32_16x16x32_bf16 a[160:163], v[96:99], v[84:87], a[160:163]
v_mfma_f32_16x16x32_bf16 a[164:167], v[100:103], v[84:87], a[164:167]
ds_read_b128 v[152:155], v10 offset:12288
v_mfma_f32_16x16x32_bf16 a[168:171], v[104:107], v[84:87], a[168:171]
buffer_load_dwordx4 v28, s[28:31], s60 offen offset:1024 lds
v_mfma_f32_16x16x32_bf16 a[172:175], v[108:111], v[84:87], a[172:175]
ds_read_b64_tr_b16 v[184:185], v23 offset:16384
v_mfma_f32_16x16x32_bf16 a[176:179], v[112:115], v[84:87], a[176:179]
s_add_u32 s60, s60, 131072
v_mfma_f32_16x16x32_bf16 a[180:183], v[116:119], v[84:87], a[180:183]
v_mfma_f32_16x16x32_bf16 a[184:187], v[120:123], v[84:87], a[184:187]
ds_read_b64_tr_b16 v[186:187], v23 offset:18432
v_mfma_f32_16x16x32_bf16 a[188:191], v[124:127], v[84:87], a[188:191]
s_add_u32 m0, s86, 18432
v_mfma_f32_16x16x32_bf16 a[192:195], v[96:99], v[88:91], a[192:195]
ds_read_b128 v[156:159], v10 offset:13312
v_mfma_f32_16x16x32_bf16 a[196:199], v[100:103], v[88:91], a[196:199]
v_mfma_f32_16x16x32_bf16 a[200:203], v[104:107], v[88:91], a[200:203]
ds_read_b64_tr_b16 v[188:189], v24 offset:16384
s_nop 0
v_mfma_f32_16x16x32_bf16 a[204:207], v[108:111], v[88:91], a[204:207]
v_mfma_f32_16x16x32_bf16 a[208:211], v[112:115], v[88:91], a[208:211]
ds_read_b64_tr_b16 v[190:191], v24 offset:18432
buffer_load_dwordx4 v27, s[28:31], s60 offen lds
v_mfma_f32_16x16x32_bf16 a[212:215], v[116:119], v[88:91], a[212:215]
v_mfma_f32_16x16x32_bf16 a[216:219], v[120:123], v[88:91], a[216:219]
v_mfma_f32_16x16x32_bf16 a[220:223], v[124:127], v[88:91], a[220:223]
buffer_load_dwordx4 v28, s[28:31], s60 offen offset:1024 lds
v_mfma_f32_16x16x32_bf16 a[224:227], v[96:99], v[92:95], a[224:227]
v_mfma_f32_16x16x32_bf16 a[228:231], v[100:103], v[92:95], a[228:231]
v_mfma_f32_16x16x32_bf16 a[232:235], v[104:107], v[92:95], a[232:235]
s_add_u32 s60, s60, 131072
v_mfma_f32_16x16x32_bf16 a[236:239], v[108:111], v[92:95], a[236:239]
v_mfma_f32_16x16x32_bf16 a[240:243], v[112:115], v[92:95], a[240:243]
v_mfma_f32_16x16x32_bf16 a[244:247], v[116:119], v[92:95], a[244:247]
v_mfma_f32_16x16x32_bf16 a[248:251], v[120:123], v[92:95], a[248:251]
v_mfma_f32_16x16x32_bf16 a[252:255], v[124:127], v[92:95], a[252:255]
s_waitcnt lgkmcnt(0)
v_mfma_f32_16x16x32_bf16 a[0:3], v[160:163], v[128:131], a[0:3]
s_waitcnt vmcnt(12)
s_barrier
v_mfma_f32_16x16x32_bf16 a[4:7], v[164:167], v[128:131], a[4:7]
ds_read_b128 v[64:67], v16 offset:32768
v_mfma_f32_16x16x32_bf16 a[8:11], v[168:171], v[128:131], a[8:11]
s_add_u32 m0, s64, 81920
v_mfma_f32_16x16x32_bf16 a[12:15], v[172:175], v[128:131], a[12:15]
ds_read_b64_tr_b16 v[96:97], v17 offset:32768
s_add_u32 s56, s69, 4096
v_mfma_f32_16x16x32_bf16 a[16:19], v[176:179], v[128:131], a[16:19]
v_mfma_f32_16x16x32_bf16 a[20:23], v[180:183], v[128:131], a[20:23]
ds_read_b64_tr_b16 v[98:99], v17 offset:34816
buffer_load_dwordx4 v5, s[24:27], s56 offen sc1 lds
v_mfma_f32_16x16x32_bf16 a[24:27], v[184:187], v[128:131], a[24:27]
buffer_load_dwordx4 v5, s[24:27], s56 offen offset:1024 sc1 lds
v_mfma_f32_16x16x32_bf16 a[28:31], v[188:191], v[128:131], a[28:31]
ds_read_b128 v[68:71], v16 offset:33792
v_mfma_f32_16x16x32_bf16 a[32:35], v[160:163], v[132:135], a[32:35]
buffer_load_dwordx4 v5, s[24:27], s56 offen offset:2048 sc1 lds
v_mfma_f32_16x16x32_bf16 a[36:39], v[164:167], v[132:135], a[36:39]
v_mfma_f32_16x16x32_bf16 a[40:43], v[168:171], v[132:135], a[40:43]
ds_read_b64_tr_b16 v[100:101], v18 offset:32768
buffer_load_dwordx4 v5, s[24:27], s56 offen offset:3072 sc1 lds
v_mfma_f32_16x16x32_bf16 a[44:47], v[172:175], v[132:135], a[44:47]
s_add_u32 m0, s64, 0
v_mfma_f32_16x16x32_bf16 a[48:51], v[176:179], v[132:135], a[48:51]
ds_read_b64_tr_b16 v[102:103], v18 offset:34816
v_mfma_f32_16x16x32_bf16 a[52:55], v[180:183], v[132:135], a[52:55]
s_add_u32 s56, s69, 8192
v_mfma_f32_16x16x32_bf16 a[56:59], v[184:187], v[132:135], a[56:59]
ds_read_b128 v[72:75], v16 offset:36864
buffer_load_dwordx4 v5, s[24:27], s56 offen sc1 lds
v_mfma_f32_16x16x32_bf16 a[60:63], v[188:191], v[132:135], a[60:63]
v_mfma_f32_16x16x32_bf16 a[64:67], v[160:163], v[136:139], a[64:67]
ds_read_b64_tr_b16 v[104:105], v19 offset:32768
buffer_load_dwordx4 v5, s[24:27], s56 offen offset:1024 sc1 lds
v_mfma_f32_16x16x32_bf16 a[68:71], v[164:167], v[136:139], a[68:71]
v_mfma_f32_16x16x32_bf16 a[72:75], v[168:171], v[136:139], a[72:75]
buffer_load_dwordx4 v5, s[24:27], s56 offen offset:2048 sc1 lds
v_mfma_f32_16x16x32_bf16 a[76:79], v[172:175], v[136:139], a[76:79]
ds_read_b64_tr_b16 v[106:107], v19 offset:34816
buffer_load_dwordx4 v5, s[24:27], s56 offen offset:3072 sc1 lds
v_mfma_f32_16x16x32_bf16 a[80:83], v[176:179], v[136:139], a[80:83]
v_mfma_f32_16x16x32_bf16 a[84:87], v[180:183], v[136:139], a[84:87]
ds_read_b128 v[76:79], v16 offset:37888
s_add_u32 m0, s64, 16384
v_mfma_f32_16x16x32_bf16 a[88:91], v[184:187], v[136:139], a[88:91]
s_add_u32 s56, s69, 12288
v_mfma_f32_16x16x32_bf16 a[92:95], v[188:191], v[136:139], a[92:95]
ds_read_b64_tr_b16 v[108:109], v20 offset:32768
v_mfma_f32_16x16x32_bf16 a[96:99], v[160:163], v[140:143], a[96:99]
buffer_load_dwordx4 v5, s[24:27], s56 offen sc1 lds
v_mfma_f32_16x16x32_bf16 a[100:103], v[164:167], v[140:143], a[100:103]
ds_read_b64_tr_b16 v[110:111], v20 offset:34816
v_mfma_f32_16x16x32_bf16 a[104:107], v[168:171], v[140:143], a[104:107]
buffer_load_dwordx4 v5, s[24:27], s56 offen offset:1024 sc1 lds
v_mfma_f32_16x16x32_bf16 a[108:111], v[172:175], v[140:143], a[108:111]
buffer_load_dwordx4 v5, s[24:27], s56 offen offset:2048 sc1 lds
v_mfma_f32_16x16x32_bf16 a[112:115], v[176:179], v[140:143], a[112:115]
ds_read_b128 v[80:83], v16 offset:40960
v_mfma_f32_16x16x32_bf16 a[116:119], v[180:183], v[140:143], a[116:119]
buffer_load_dwordx4 v5, s[24:27], s56 offen offset:3072 sc1 lds
v_mfma_f32_16x16x32_bf16 a[120:123], v[184:187], v[140:143], a[120:123]
ds_read_b64_tr_b16 v[112:113], v21 offset:32768
v_mfma_f32_16x16x32_bf16 a[124:127], v[188:191], v[140:143], a[124:127]
v_mfma_f32_16x16x32_bf16 a[128:131], v[160:163], v[144:147], a[128:131]
ds_read_b64_tr_b16 v[114:115], v21 offset:34816
v_mfma_f32_16x16x32_bf16 a[132:135], v[164:167], v[144:147], a[132:135]
v_mfma_f32_16x16x32_bf16 a[136:139], v[168:171], v[144:147], a[136:139]
ds_read_b128 v[84:87], v16 offset:41984
s_add_u32 m0, s86, 32768
v_mfma_f32_16x16x32_bf16 a[140:143], v[172:175], v[144:147], a[140:143]
v_mfma_f32_16x16x32_bf16 a[144:147], v[176:179], v[144:147], a[144:147]
s_nop 0
v_mfma_f32_16x16x32_bf16 a[148:151], v[180:183], v[144:147], a[148:151]
ds_read_b64_tr_b16 v[116:117], v22 offset:32768
v_mfma_f32_16x16x32_bf16 a[152:155], v[184:187], v[144:147], a[152:155]
v_mfma_f32_16x16x32_bf16 a[156:159], v[188:191], v[144:147], a[156:159]
ds_read_b64_tr_b16 v[118:119], v22 offset:34816
buffer_load_dwordx4 v27, s[28:31], s60 offen lds
v_mfma_f32_16x16x32_bf16 a[160:163], v[160:163], v[148:151], a[160:163]
v_mfma_f32_16x16x32_bf16 a[164:167], v[164:167], v[148:151], a[164:167]
ds_read_b128 v[88:91], v16 offset:45056
v_mfma_f32_16x16x32_bf16 a[168:171], v[168:171], v[148:151], a[168:171]
buffer_load_dwordx4 v28, s[28:31], s60 offen offset:1024 lds
v_mfma_f32_16x16x32_bf16 a[172:175], v[172:175], v[148:151], a[172:175]
ds_read_b64_tr_b16 v[120:121], v23 offset:32768
v_mfma_f32_16x16x32_bf16 a[176:179], v[176:179], v[148:151], a[176:179]
s_add_u32 s60, s60, 131072
v_mfma_f32_16x16x32_bf16 a[180:183], v[180:183], v[148:151], a[180:183]
v_mfma_f32_16x16x32_bf16 a[184:187], v[184:187], v[148:151], a[184:187]
ds_read_b64_tr_b16 v[122:123], v23 offset:34816
v_mfma_f32_16x16x32_bf16 a[188:191], v[188:191], v[148:151], a[188:191]
s_add_u32 m0, s86, 34816
v_mfma_f32_16x16x32_bf16 a[192:195], v[160:163], v[152:155], a[192:195]
ds_read_b128 v[92:95], v16 offset:46080
v_mfma_f32_16x16x32_bf16 a[196:199], v[164:167], v[152:155], a[196:199]
v_mfma_f32_16x16x32_bf16 a[200:203], v[168:171], v[152:155], a[200:203]
ds_read_b64_tr_b16 v[124:125], v24 offset:32768
s_nop 0
v_mfma_f32_16x16x32_bf16 a[204:207], v[172:175], v[152:155], a[204:207]
v_mfma_f32_16x16x32_bf16 a[208:211], v[176:179], v[152:155], a[208:211]
ds_read_b64_tr_b16 v[126:127], v24 offset:34816
buffer_load_dwordx4 v27, s[28:31], s60 offen lds
v_mfma_f32_16x16x32_bf16 a[212:215], v[180:183], v[152:155], a[212:215]
v_mfma_f32_16x16x32_bf16 a[216:219], v[184:187], v[152:155], a[216:219]
v_mfma_f32_16x16x32_bf16 a[220:223], v[188:191], v[152:155], a[220:223]
buffer_load_dwordx4 v28, s[28:31], s60 offen offset:1024 lds
v_mfma_f32_16x16x32_bf16 a[224:227], v[160:163], v[156:159], a[224:227]
v_mfma_f32_16x16x32_bf16 a[228:231], v[164:167], v[156:159], a[228:231]
v_mfma_f32_16x16x32_bf16 a[232:235], v[168:171], v[156:159], a[232:235]
s_add_u32 s60, s60, 131072
v_mfma_f32_16x16x32_bf16 a[236:239], v[172:175], v[156:159], a[236:239]
v_mfma_f32_16x16x32_bf16 a[240:243], v[176:179], v[156:159], a[240:243]
v_mfma_f32_16x16x32_bf16 a[244:247], v[180:183], v[156:159], a[244:247]
v_mfma_f32_16x16x32_bf16 a[248:251], v[184:187], v[156:159], a[248:251]
v_mfma_f32_16x16x32_bf16 a[252:255], v[188:191], v[156:159], a[252:255]
s_waitcnt lgkmcnt(0)
v_mfma_f32_16x16x32_bf16 a[0:3], v[96:99], v[64:67], a[0:3]
s_waitcnt vmcnt(24)
s_barrier
v_mfma_f32_16x16x32_bf16 a[4:7], v[100:103], v[64:67], a[4:7]
ds_read_b128 v[128:131], v10 offset:32768
v_mfma_f32_16x16x32_bf16 a[8:11], v[104:107], v[64:67], a[8:11]
s_add_u32 m0, s64, 98304
v_mfma_f32_16x16x32_bf16 a[12:15], v[108:111], v[64:67], a[12:15]
ds_read_b64_tr_b16 v[160:161], v17 offset:49152
v_mfma_f32_16x16x32_bf16 a[16:19], v[112:115], v[64:67], a[16:19]
v_mfma_f32_16x16x32_bf16 a[20:23], v[116:119], v[64:67], a[20:23]
ds_read_b64_tr_b16 v[162:163], v17 offset:51200
v_mfma_f32_16x16x32_bf16 a[24:27], v[120:123], v[64:67], a[24:27]
s_add_u32 s56, s69, 16384
v_mfma_f32_16x16x32_bf16 a[28:31], v[124:127], v[64:67], a[28:31]
ds_read_b128 v[132:135], v10 offset:33792
v_mfma_f32_16x16x32_bf16 a[32:35], v[96:99], v[68:71], a[32:35]
v_mfma_f32_16x16x32_bf16 a[36:39], v[100:103], v[68:71], a[36:39]
v_mfma_f32_16x16x32_bf16 a[40:43], v[104:107], v[68:71], a[40:43]
ds_read_b64_tr_b16 v[164:165], v18 offset:49152
v_mfma_f32_16x16x32_bf16 a[44:47], v[108:111], v[68:71], a[44:47]
buffer_load_dwordx4 v5, s[24:27], s56 offen sc1 lds
v_mfma_f32_16x16x32_bf16 a[48:51], v[112:115], v[68:71], a[48:51]
ds_read_b64_tr_b16 v[166:167], v18 offset:51200
v_mfma_f32_16x16x32_bf16 a[52:55], v[116:119], v[68:71], a[52:55]
v_mfma_f32_16x16x32_bf16 a[56:59], v[120:123], v[68:71], a[56:59]
ds_read_b128 v[136:139], v10 offset:36864
v_mfma_f32_16x16x32_bf16 a[60:63], v[124:127], v[68:71], a[60:63]
v_mfma_f32_16x16x32_bf16 a[64:67], v[96:99], v[72:75], a[64:67]
ds_read_b64_tr_b16 v[168:169], v19 offset:49152
buffer_load_dwordx4 v5, s[24:27], s56 offen offset:1024 sc1 lds
v_mfma_f32_16x16x32_bf16 a[68:71], v[100:103], v[72:75], a[68:71]
v_mfma_f32_16x16x32_bf16 a[72:75], v[104:107], v[72:75], a[72:75]
v_mfma_f32_16x16x32_bf16 a[76:79], v[108:111], v[72:75], a[76:79]
ds_read_b64_tr_b16 v[170:171], v19 offset:51200
v_mfma_f32_16x16x32_bf16 a[80:83], v[112:115], v[72:75], a[80:83]
v_mfma_f32_16x16x32_bf16 a[84:87], v[116:119], v[72:75], a[84:87]
ds_read_b128 v[140:143], v10 offset:37888
buffer_load_dwordx4 v5, s[24:27], s56 offen offset:2048 sc1 lds
v_mfma_f32_16x16x32_bf16 a[88:91], v[120:123], v[72:75], a[88:91]
v_mfma_f32_16x16x32_bf16 a[92:95], v[124:127], v[72:75], a[92:95]
ds_read_b64_tr_b16 v[172:173], v20 offset:49152
v_mfma_f32_16x16x32_bf16 a[96:99], v[96:99], v[76:79], a[96:99]
v_mfma_f32_16x16x32_bf16 a[100:103], v[100:103], v[76:79], a[100:103]
ds_read_b64_tr_b16 v[174:175], v20 offset:51200
v_mfma_f32_16x16x32_bf16 a[104:107], v[104:107], v[76:79], a[104:107]
buffer_load_dwordx4 v5, s[24:27], s56 offen offset:3072 sc1 lds
v_mfma_f32_16x16x32_bf16 a[108:111], v[108:111], v[76:79], a[108:111]
v_mfma_f32_16x16x32_bf16 a[112:115], v[112:115], v[76:79], a[112:115]
ds_read_b128 v[144:147], v10 offset:40960
v_mfma_f32_16x16x32_bf16 a[116:119], v[116:119], v[76:79], a[116:119]
v_mfma_f32_16x16x32_bf16 a[120:123], v[120:123], v[76:79], a[120:123]
ds_read_b64_tr_b16 v[176:177], v21 offset:49152
v_mfma_f32_16x16x32_bf16 a[124:127], v[124:127], v[76:79], a[124:127]
v_mfma_f32_16x16x32_bf16 a[128:131], v[96:99], v[80:83], a[128:131]
ds_read_b64_tr_b16 v[178:179], v21 offset:51200
v_mfma_f32_16x16x32_bf16 a[132:135], v[100:103], v[80:83], a[132:135]
v_mfma_f32_16x16x32_bf16 a[136:139], v[104:107], v[80:83], a[136:139]
ds_read_b128 v[148:151], v10 offset:41984
v_mfma_f32_16x16x32_bf16 a[140:143], v[108:111], v[80:83], a[140:143]
v_mfma_f32_16x16x32_bf16 a[144:147], v[112:115], v[80:83], a[144:147]
v_mfma_f32_16x16x32_bf16 a[148:151], v[116:119], v[80:83], a[148:151]
ds_read_b64_tr_b16 v[180:181], v22 offset:49152
v_mfma_f32_16x16x32_bf16 a[152:155], v[120:123], v[80:83], a[152:155]
v_mfma_f32_16x16x32_bf16 a[156:159], v[124:127], v[80:83], a[156:159]
ds_read_b64_tr_b16 v[182:183], v22 offset:51200
v_mfma_f32_16x16x32_bf16 a[160:163], v[96:99], v[84:87], a[160:163]
v_mfma_f32_16x16x32_bf16 a[164:167], v[100:103], v[84:87], a[164:167]
ds_read_b128 v[152:155], v10 offset:45056
v_mfma_f32_16x16x32_bf16 a[168:171], v[104:107], v[84:87], a[168:171]
v_mfma_f32_16x16x32_bf16 a[172:175], v[108:111], v[84:87], a[172:175]
ds_read_b64_tr_b16 v[184:185], v23 offset:49152
v_mfma_f32_16x16x32_bf16 a[176:179], v[112:115], v[84:87], a[176:179]
v_mfma_f32_16x16x32_bf16 a[180:183], v[116:119], v[84:87], a[180:183]
v_mfma_f32_16x16x32_bf16 a[184:187], v[120:123], v[84:87], a[184:187]
ds_read_b64_tr_b16 v[186:187], v23 offset:51200
v_mfma_f32_16x16x32_bf16 a[188:191], v[124:127], v[84:87], a[188:191]
v_mfma_f32_16x16x32_bf16 a[192:195], v[96:99], v[88:91], a[192:195]
ds_read_b128 v[156:159], v10 offset:46080
v_mfma_f32_16x16x32_bf16 a[196:199], v[100:103], v[88:91], a[196:199]
v_mfma_f32_16x16x32_bf16 a[200:203], v[104:107], v[88:91], a[200:203]
ds_read_b64_tr_b16 v[188:189], v24 offset:49152
v_mfma_f32_16x16x32_bf16 a[204:207], v[108:111], v[88:91], a[204:207]
v_mfma_f32_16x16x32_bf16 a[208:211], v[112:115], v[88:91], a[208:211]
ds_read_b64_tr_b16 v[190:191], v24 offset:51200
v_mfma_f32_16x16x32_bf16 a[212:215], v[116:119], v[88:91], a[212:215]
v_mfma_f32_16x16x32_bf16 a[216:219], v[120:123], v[88:91], a[216:219]
v_mfma_f32_16x16x32_bf16 a[220:223], v[124:127], v[88:91], a[220:223]
v_mfma_f32_16x16x32_bf16 a[224:227], v[96:99], v[92:95], a[224:227]
v_mfma_f32_16x16x32_bf16 a[228:231], v[100:103], v[92:95], a[228:231]
v_mfma_f32_16x16x32_bf16 a[232:235], v[104:107], v[92:95], a[232:235]
v_mfma_f32_16x16x32_bf16 a[236:239], v[108:111], v[92:95], a[236:239]
v_mfma_f32_16x16x32_bf16 a[240:243], v[112:115], v[92:95], a[240:243]
v_mfma_f32_16x16x32_bf16 a[244:247], v[116:119], v[92:95], a[244:247]
v_mfma_f32_16x16x32_bf16 a[248:251], v[120:123], v[92:95], a[248:251]
v_mfma_f32_16x16x32_bf16 a[252:255], v[124:127], v[92:95], a[252:255]
s_waitcnt lgkmcnt(0)
v_mfma_f32_16x16x32_bf16 a[0:3], v[160:163], v[128:131], a[0:3]
s_barrier
v_mfma_f32_16x16x32_bf16 a[4:7], v[164:167], v[128:131], a[4:7]
v_mfma_f32_16x16x32_bf16 a[8:11], v[168:171], v[128:131], a[8:11]
s_add_u32 m0, s64, 32768
v_mfma_f32_16x16x32_bf16 a[12:15], v[172:175], v[128:131], a[12:15]
v_mfma_f32_16x16x32_bf16 a[16:19], v[176:179], v[128:131], a[16:19]
s_add_u32 s56, s69, 20480
v_mfma_f32_16x16x32_bf16 a[20:23], v[180:183], v[128:131], a[20:23]
v_mfma_f32_16x16x32_bf16 a[24:27], v[184:187], v[128:131], a[24:27]
buffer_load_dwordx4 v5, s[24:27], s56 offen sc1 lds
v_mfma_f32_16x16x32_bf16 a[28:31], v[188:191], v[128:131], a[28:31]
v_mfma_f32_16x16x32_bf16 a[32:35], v[160:163], v[132:135], a[32:35]
v_mfma_f32_16x16x32_bf16 a[36:39], v[164:167], v[132:135], a[36:39]
buffer_load_dwordx4 v5, s[24:27], s56 offen offset:1024 sc1 lds
v_mfma_f32_16x16x32_bf16 a[40:43], v[168:171], v[132:135], a[40:43]
v_mfma_f32_16x16x32_bf16 a[44:47], v[172:175], v[132:135], a[44:47]
buffer_load_dwordx4 v5, s[24:27], s56 offen offset:2048 sc1 lds
v_mfma_f32_16x16x32_bf16 a[48:51], v[176:179], v[132:135], a[48:51]
v_mfma_f32_16x16x32_bf16 a[52:55], v[180:183], v[132:135], a[52:55]
v_mfma_f32_16x16x32_bf16 a[56:59], v[184:187], v[132:135], a[56:59]
buffer_load_dwordx4 v5, s[24:27], s56 offen offset:3072 sc1 lds
v_mfma_f32_16x16x32_bf16 a[60:63], v[188:191], v[132:135], a[60:63]
v_mfma_f32_16x16x32_bf16 a[64:67], v[160:163], v[136:139], a[64:67]
s_add_u32 m0, s64, 49152
v_mfma_f32_16x16x32_bf16 a[68:71], v[164:167], v[136:139], a[68:71]
v_mfma_f32_16x16x32_bf16 a[72:75], v[168:171], v[136:139], a[72:75]
s_add_u32 s56, s69, 24576
v_mfma_f32_16x16x32_bf16 a[76:79], v[172:175], v[136:139], a[76:79]
v_mfma_f32_16x16x32_bf16 a[80:83], v[176:179], v[136:139], a[80:83]
v_mfma_f32_16x16x32_bf16 a[84:87], v[180:183], v[136:139], a[84:87]
buffer_load_dwordx4 v5, s[24:27], s56 offen sc1 lds
v_mfma_f32_16x16x32_bf16 a[88:91], v[184:187], v[136:139], a[88:91]
v_mfma_f32_16x16x32_bf16 a[92:95], v[188:191], v[136:139], a[92:95]
buffer_load_dwordx4 v5, s[24:27], s56 offen offset:1024 sc1 lds
v_mfma_f32_16x16x32_bf16 a[96:99], v[160:163], v[140:143], a[96:99]
v_mfma_f32_16x16x32_bf16 a[100:103], v[164:167], v[140:143], a[100:103]
v_mfma_f32_16x16x32_bf16 a[104:107], v[168:171], v[140:143], a[104:107]
buffer_load_dwordx4 v5, s[24:27], s56 offen offset:2048 sc1 lds
v_mfma_f32_16x16x32_bf16 a[108:111], v[172:175], v[140:143], a[108:111]
v_mfma_f32_16x16x32_bf16 a[112:115], v[176:179], v[140:143], a[112:115]
buffer_load_dwordx4 v5, s[24:27], s56 offen offset:3072 sc1 lds
v_mfma_f32_16x16x32_bf16 a[116:119], v[180:183], v[140:143], a[116:119]
v_mfma_f32_16x16x32_bf16 a[120:123], v[184:187], v[140:143], a[120:123]
v_mfma_f32_16x16x32_bf16 a[124:127], v[188:191], v[140:143], a[124:127]
v_mfma_f32_16x16x32_bf16 a[128:131], v[160:163], v[144:147], a[128:131]
v_mfma_f32_16x16x32_bf16 a[132:135], v[164:167], v[144:147], a[132:135]
v_mfma_f32_16x16x32_bf16 a[136:139], v[168:171], v[144:147], a[136:139]
s_add_u32 m0, s86, 0
v_mfma_f32_16x16x32_bf16 a[140:143], v[172:175], v[144:147], a[140:143]
v_mfma_f32_16x16x32_bf16 a[144:147], v[176:179], v[144:147], a[144:147]
s_nop 0
v_mfma_f32_16x16x32_bf16 a[148:151], v[180:183], v[144:147], a[148:151]
v_mfma_f32_16x16x32_bf16 a[152:155], v[184:187], v[144:147], a[152:155]
v_mfma_f32_16x16x32_bf16 a[156:159], v[188:191], v[144:147], a[156:159]
buffer_load_dwordx4 v27, s[28:31], s60 offen lds
v_mfma_f32_16x16x32_bf16 a[160:163], v[160:163], v[148:151], a[160:163]
v_mfma_f32_16x16x32_bf16 a[164:167], v[164:167], v[148:151], a[164:167]
v_mfma_f32_16x16x32_bf16 a[168:171], v[168:171], v[148:151], a[168:171]
buffer_load_dwordx4 v28, s[28:31], s60 offen offset:1024 lds
v_mfma_f32_16x16x32_bf16 a[172:175], v[172:175], v[148:151], a[172:175]
v_mfma_f32_16x16x32_bf16 a[176:179], v[176:179], v[148:151], a[176:179]
s_add_u32 s60, s60, 131072
v_mfma_f32_16x16x32_bf16 a[180:183], v[180:183], v[148:151], a[180:183]
v_mfma_f32_16x16x32_bf16 a[184:187], v[184:187], v[148:151], a[184:187]
v_mfma_f32_16x16x32_bf16 a[188:191], v[188:191], v[148:151], a[188:191]
s_add_u32 m0, s86, 2048
v_mfma_f32_16x16x32_bf16 a[192:195], v[160:163], v[152:155], a[192:195]
v_mfma_f32_16x16x32_bf16 a[196:199], v[164:167], v[152:155], a[196:199]
v_mfma_f32_16x16x32_bf16 a[200:203], v[168:171], v[152:155], a[200:203]
s_nop 0
v_mfma_f32_16x16x32_bf16 a[204:207], v[172:175], v[152:155], a[204:207]
v_mfma_f32_16x16x32_bf16 a[208:211], v[176:179], v[152:155], a[208:211]
buffer_load_dwordx4 v27, s[28:31], s60 offen lds
v_mfma_f32_16x16x32_bf16 a[212:215], v[180:183], v[152:155], a[212:215]
v_mfma_f32_16x16x32_bf16 a[216:219], v[184:187], v[152:155], a[216:219]
v_mfma_f32_16x16x32_bf16 a[220:223], v[188:191], v[152:155], a[220:223]
buffer_load_dwordx4 v28, s[28:31], s60 offen offset:1024 lds
v_mfma_f32_16x16x32_bf16 a[224:227], v[160:163], v[156:159], a[224:227]
v_mfma_f32_16x16x32_bf16 a[228:231], v[164:167], v[156:159], a[228:231]
v_mfma_f32_16x16x32_bf16 a[232:235], v[168:171], v[156:159], a[232:235]
s_add_u32 s60, s60, 131072
v_mfma_f32_16x16x32_bf16 a[236:239], v[172:175], v[156:159], a[236:239]
v_mfma_f32_16x16x32_bf16 a[240:243], v[176:179], v[156:159], a[240:243]
v_mfma_f32_16x16x32_bf16 a[244:247], v[180:183], v[156:159], a[244:247]
v_mfma_f32_16x16x32_bf16 a[248:251], v[184:187], v[156:159], a[248:251]
v_mfma_f32_16x16x32_bf16 a[252:255], v[188:191], v[156:159], a[252:255]
s_lshl_b32 s70, s4, 21
s_lshl_b32 s71, s6, 18
s_add_u32 s70, s70, s71
s_lshl_b32 s71, s67, 17
s_add_u32 s70, s70, s71
s_lshl_b32 s71, s68, 13
s_add_u32 s70, s70, s71
s_add_u32 s72, s70, 0
s_nop 0
s_add_u32 s73, s70, 4096
s_add_u32 s74, s70, 32768
s_add_u32 s75, s70, 36864
s_add_u32 s76, s70, 65536
s_add_u32 s77, s70, 69632
s_add_u32 s78, s70, 98304
s_add_u32 s79, s70, 102400
v_add_u32 v7, 0x10000, v5
v_add_u32 v8, 0x20000, v5
s_waitcnt vmcnt(20)
s_barrier
ds_read_b128 v[64:67], v7
ds_read_b128 v[68:71], v7 offset:4096
ds_read_b128 v[72:75], v7 offset:8192
ds_read_b128 v[76:79], v7 offset:12288
ds_read_b64_tr_b16 v[224:225], v3 offset:16384
ds_read_b64_tr_b16 v[226:227], v3 offset:17408
ds_read_b64_tr_b16 v[228:229], v4 offset:16384
ds_read_b64_tr_b16 v[230:231], v4 offset:17408
s_waitcnt lgkmcnt(0)
v_mfma_f32_32x32x16_bf16 v[96:111], v[224:227], v[64:67], 0
s_waitcnt vmcnt(32)
ds_read_b64_tr_b16 v[232:233], v3 offset:18432
v_accvgpr_read_b32 v32, a0
v_accvgpr_read_b32 v33, a1
v_accvgpr_read_b32 v34, a2
v_accvgpr_read_b32 v35, a3
v_accvgpr_read_b32 v36, a4
v_accvgpr_read_b32 v37, a5
v_accvgpr_read_b32 v38, a6
v_mfma_f32_32x32x16_bf16 v[160:175], v[228:231], v[64:67], 0
ds_read_b64_tr_b16 v[234:235], v3 offset:19456
ds_read_b64_tr_b16 v[236:237], v4 offset:18432
v_accvgpr_read_b32 v39, a7
v_cvt_pk_bf16_f32 v40, v32, v33
v_cvt_pk_bf16_f32 v41, v34, v35
v_cvt_pk_bf16_f32 v42, v36, v37
v_cvt_pk_bf16_f32 v43, v38, v39
buffer_store_dwordx4 v[40:43], v6, s[16:19], s72 offen sc1
v_accvgpr_read_b32 v48, a8
v_mfma_f32_32x32x16_bf16 v[112:127], v[224:227], v[68:71], 0
ds_read_b64_tr_b16 v[238:239], v4 offset:19456
ds_read_b128 v[80:83], v7 offset:1024
v_accvgpr_read_b32 v49, a9
v_accvgpr_read_b32 v50, a10
v_accvgpr_read_b32 v51, a11
v_accvgpr_read_b32 v52, a12
v_accvgpr_read_b32 v53, a13
v_accvgpr_read_b32 v54, a14
v_accvgpr_read_b32 v55, a15
v_mfma_f32_32x32x16_bf16 v[176:191], v[228:231], v[68:71], 0
ds_read_b128 v[84:87], v7 offset:5120
ds_read_b128 v[88:91], v7 offset:9216
v_cvt_pk_bf16_f32 v56, v48, v49
v_cvt_pk_bf16_f32 v57, v50, v51
v_cvt_pk_bf16_f32 v58, v52, v53
v_cvt_pk_bf16_f32 v59, v54, v55
buffer_store_dwordx4 v[56:59], v6, s[16:19], s72 offen offset:2048 sc1
v_accvgpr_read_b32 v32, a16
v_accvgpr_read_b32 v33, a17
v_mfma_f32_32x32x16_bf16 v[128:143], v[224:227], v[72:75], 0
ds_read_b128 v[92:95], v7 offset:13312
s_add_u32 m0, s86, 16384
v_accvgpr_read_b32 v34, a18
v_accvgpr_read_b32 v35, a19
v_accvgpr_read_b32 v36, a20
v_accvgpr_read_b32 v37, a21
v_accvgpr_read_b32 v38, a22
v_accvgpr_read_b32 v39, a23
v_cvt_pk_bf16_f32 v40, v32, v33
v_mfma_f32_32x32x16_bf16 v[192:207], v[228:231], v[72:75], 0
s_nop 0
s_nop 0
buffer_load_dwordx4 v27, s[28:31], s60 offen lds
v_cvt_pk_bf16_f32 v41, v34, v35
v_cvt_pk_bf16_f32 v42, v36, v37
v_cvt_pk_bf16_f32 v43, v38, v39
buffer_store_dwordx4 v[40:43], v6, s[16:19], s73 offen sc1
v_accvgpr_read_b32 v48, a24
v_accvgpr_read_b32 v49, a25
v_accvgpr_read_b32 v50, a26
v_mfma_f32_32x32x16_bf16 v[144:159], v[224:227], v[76:79], 0
buffer_load_dwordx4 v28, s[28:31], s60 offen offset:1024 lds
s_add_u32 s60, s60, 131072
v_accvgpr_read_b32 v51, a27
v_accvgpr_read_b32 v52, a28
v_accvgpr_read_b32 v53, a29
v_accvgpr_read_b32 v54, a30
v_accvgpr_read_b32 v55, a31
v_cvt_pk_bf16_f32 v56, v48, v49
v_cvt_pk_bf16_f32 v57, v50, v51
v_mfma_f32_32x32x16_bf16 v[208:223], v[228:231], v[76:79], 0
v_cvt_pk_bf16_f32 v58, v52, v53
v_cvt_pk_bf16_f32 v59, v54, v55
buffer_store_dwordx4 v[56:59], v6, s[16:19], s73 offen offset:2048 sc1
v_accvgpr_read_b32 v32, a32
v_accvgpr_read_b32 v33, a33
v_accvgpr_read_b32 v34, a34
v_accvgpr_read_b32 v35, a35
v_accvgpr_read_b32 v36, a36
v_accvgpr_read_b32 v37, a37
s_waitcnt lgkmcnt(0)
v_mfma_f32_32x32x16_bf16 v[96:111], v[232:235], v[80:83], v[96:111]
s_waitcnt vmcnt(24)
ds_read_b64_tr_b16 v[224:225], v3 offset:32768
v_accvgpr_read_b32 v38, a38
v_accvgpr_read_b32 v39, a39
v_cvt_pk_bf16_f32 v40, v32, v33
v_cvt_pk_bf16_f32 v41, v34, v35
v_cvt_pk_bf16_f32 v42, v36, v37
v_cvt_pk_bf16_f32 v43, v38, v39
buffer_store_dwordx4 v[40:43], v6, s[16:19], s72 offen offset:128 sc1
v_mfma_f32_32x32x16_bf16 v[160:175], v[236:239], v[80:83], v[160:175]
ds_read_b64_tr_b16 v[226:227], v3 offset:33792
ds_read_b64_tr_b16 v[228:229], v4 offset:32768
v_accvgpr_read_b32 v48, a40
v_accvgpr_read_b32 v49, a41
v_accvgpr_read_b32 v50, a42
v_accvgpr_read_b32 v51, a43
v_accvgpr_read_b32 v52, a44
v_accvgpr_read_b32 v53, a45
v_accvgpr_read_b32 v54, a46
v_mfma_f32_32x32x16_bf16 v[112:127], v[232:235], v[84:87], v[112:127]
ds_read_b64_tr_b16 v[230:231], v4 offset:33792
ds_read_b128 v[64:67], v7 offset:2048
v_accvgpr_read_b32 v55, a47
v_cvt_pk_bf16_f32 v56, v48, v49
v_cvt_pk_bf16_f32 v57, v50, v51
v_cvt_pk_bf16_f32 v58, v52, v53
v_cvt_pk_bf16_f32 v59, v54, v55
buffer_store_dwordx4 v[56:59], v6, s[16:19], s72 offen offset:2176 sc1
v_accvgpr_read_b32 v32, a48
v_mfma_f32_32x32x16_bf16 v[176:191], v[236:239], v[84:87], v[176:191]
ds_read_b128 v[68:71], v7 offset:6144
ds_read_b128 v[72:75], v7 offset:10240
v_accvgpr_read_b32 v33, a49
v_accvgpr_read_b32 v34, a50
v_accvgpr_read_b32 v35, a51
v_accvgpr_read_b32 v36, a52
v_accvgpr_read_b32 v37, a53
v_accvgpr_read_b32 v38, a54
v_accvgpr_read_b32 v39, a55
v_mfma_f32_32x32x16_bf16 v[128:143], v[232:235], v[88:91], v[128:143]
ds_read_b128 v[76:79], v7 offset:14336
s_add_u32 m0, s86, 18432
v_cvt_pk_bf16_f32 v40, v32, v33
v_cvt_pk_bf16_f32 v41, v34, v35
v_cvt_pk_bf16_f32 v42, v36, v37
v_cvt_pk_bf16_f32 v43, v38, v39
buffer_store_dwordx4 v[40:43], v6, s[16:19], s73 offen offset:128 sc1
v_accvgpr_read_b32 v48, a56
v_accvgpr_read_b32 v49, a57
v_mfma_f32_32x32x16_bf16 v[192:207], v[236:239], v[88:91], v[192:207]
s_nop 0
s_nop 0
buffer_load_dwordx4 v27, s[28:31], s60 offen lds
v_accvgpr_read_b32 v50, a58
v_accvgpr_read_b32 v51, a59
v_accvgpr_read_b32 v52, a60
v_accvgpr_read_b32 v53, a61
v_accvgpr_read_b32 v54, a62
v_accvgpr_read_b32 v55, a63
v_cvt_pk_bf16_f32 v56, v48, v49
v_mfma_f32_32x32x16_bf16 v[144:159], v[232:235], v[92:95], v[144:159]
buffer_load_dwordx4 v28, s[28:31], s60 offen offset:1024 lds
s_add_u32 s60, s60, 131072
v_cvt_pk_bf16_f32 v57, v50, v51
v_cvt_pk_bf16_f32 v58, v52, v53
v_cvt_pk_bf16_f32 v59, v54, v55
buffer_store_dwordx4 v[56:59], v6, s[16:19], s73 offen offset:2176 sc1
v_accvgpr_read_b32 v32, a64
v_accvgpr_read_b32 v33, a65
v_accvgpr_read_b32 v34, a66
v_mfma_f32_32x32x16_bf16 v[208:223], v[236:239], v[92:95], v[208:223]
v_accvgpr_read_b32 v35, a67
v_accvgpr_read_b32 v36, a68
v_accvgpr_read_b32 v37, a69
v_accvgpr_read_b32 v38, a70
v_accvgpr_read_b32 v39, a71
v_cvt_pk_bf16_f32 v40, v32, v33
v_cvt_pk_bf16_f32 v41, v34, v35
v_cvt_pk_bf16_f32 v42, v36, v37
v_cvt_pk_bf16_f32 v43, v38, v39
s_waitcnt lgkmcnt(0)
v_mfma_f32_32x32x16_bf16 v[96:111], v[224:227], v[64:67], v[96:111]
s_waitcnt vmcnt(28)
ds_read_b64_tr_b16 v[232:233], v3 offset:34816
buffer_store_dwordx4 v[40:43], v6, s[16:19], s74 offen sc1
v_accvgpr_read_b32 v48, a72
v_accvgpr_read_b32 v49, a73
v_accvgpr_read_b32 v50, a74
v_accvgpr_read_b32 v51, a75
v_accvgpr_read_b32 v52, a76
v_accvgpr_read_b32 v53, a77
v_mfma_f32_32x32x16_bf16 v[160:175], v[228:231], v[64:67], v[160:175]
ds_read_b64_tr_b16 v[234:235], v3 offset:35840
ds_read_b64_tr_b16 v[236:237], v4 offset:34816
v_accvgpr_read_b32 v54, a78
v_accvgpr_read_b32 v55, a79
v_cvt_pk_bf16_f32 v56, v48, v49
v_cvt_pk_bf16_f32 v57, v50, v51
v_cvt_pk_bf16_f32 v58, v52, v53
v_cvt_pk_bf16_f32 v59, v54, v55
buffer_store_dwordx4 v[56:59], v6, s[16:19], s74 offen offset:2048 sc1
v_mfma_f32_32x32x16_bf16 v[112:127], v[224:227], v[68:71], v[112:127]
ds_read_b64_tr_b16 v[238:239], v4 offset:35840
ds_read_b128 v[80:83], v7 offset:3072
v_accvgpr_read_b32 v32, a80
v_accvgpr_read_b32 v33, a81
v_accvgpr_read_b32 v34, a82
v_accvgpr_read_b32 v35, a83
v_accvgpr_read_b32 v36, a84
v_accvgpr_read_b32 v37, a85
v_accvgpr_read_b32 v38, a86
v_mfma_f32_32x32x16_bf16 v[176:191], v[228:231], v[68:71], v[176:191]
ds_read_b128 v[84:87], v7 offset:7168
ds_read_b128 v[88:91], v7 offset:11264
v_accvgpr_read_b32 v39, a87
v_cvt_pk_bf16_f32 v40, v32, v33
v_cvt_pk_bf16_f32 v41, v34, v35
v_cvt_pk_bf16_f32 v42, v36, v37
v_cvt_pk_bf16_f32 v43, v38, v39
buffer_store_dwordx4 v[40:43], v6, s[16:19], s75 offen sc1
v_accvgpr_read_b32 v48, a88
v_mfma_f32_32x32x16_bf16 v[128:143], v[224:227], v[72:75], v[128:143]
ds_read_b128 v[92:95], v7 offset:15360
s_add_u32 m0, s86, 32768
v_accvgpr_read_b32 v49, a89
v_accvgpr_read_b32 v50, a90
v_accvgpr_read_b32 v51, a91
v_accvgpr_read_b32 v52, a92
v_accvgpr_read_b32 v53, a93
v_accvgpr_read_b32 v54, a94
v_accvgpr_read_b32 v55, a95
v_mfma_f32_32x32x16_bf16 v[192:207], v[228:231], v[72:75], v[192:207]
s_nop 0
s_nop 0
buffer_load_dwordx4 v27, s[28:31], s60 offen lds
v_cvt_pk_bf16_f32 v56, v48, v49
v_cvt_pk_bf16_f32 v57, v50, v51
v_cvt_pk_bf16_f32 v58, v52, v53
v_cvt_pk_bf16_f32 v59, v54, v55
buffer_store_dwordx4 v[56:59], v6, s[16:19], s75 offen offset:2048 sc1
v_accvgpr_read_b32 v32, a96
v_accvgpr_read_b32 v33, a97
v_mfma_f32_32x32x16_bf16 v[144:159], v[224:227], v[76:79], v[144:159]
buffer_load_dwordx4 v28, s[28:31], s60 offen offset:1024 lds
s_add_u32 s60, s60, 131072
v_accvgpr_read_b32 v34, a98
v_accvgpr_read_b32 v35, a99
v_accvgpr_read_b32 v36, a100
v_accvgpr_read_b32 v37, a101
v_accvgpr_read_b32 v38, a102
v_accvgpr_read_b32 v39, a103
v_cvt_pk_bf16_f32 v40, v32, v33
v_mfma_f32_32x32x16_bf16 v[208:223], v[228:231], v[76:79], v[208:223]
v_cvt_pk_bf16_f32 v41, v34, v35
v_cvt_pk_bf16_f32 v42, v36, v37
v_cvt_pk_bf16_f32 v43, v38, v39
buffer_store_dwordx4 v[40:43], v6, s[16:19], s74 offen offset:128 sc1
v_accvgpr_read_b32 v48, a104
v_accvgpr_read_b32 v49, a105
v_accvgpr_read_b32 v50, a106
v_accvgpr_read_b32 v51, a107
v_accvgpr_read_b32 v52, a108
s_waitcnt lgkmcnt(0)
v_mfma_f32_32x32x16_bf16 v[96:111], v[232:235], v[80:83], v[96:111]
s_waitcnt vmcnt(21)
ds_read_b64_tr_b16 v[224:225], v3
v_accvgpr_read_b32 v53, a109
v_accvgpr_read_b32 v54, a110
v_accvgpr_read_b32 v55, a111
v_cvt_pk_bf16_f32 v56, v48, v49
v_cvt_pk_bf16_f32 v57, v50, v51
v_cvt_pk_bf16_f32 v58, v52, v53
v_cvt_pk_bf16_f32 v59, v54, v55
v_mfma_f32_32x32x16_bf16 v[160:175], v[236:239], v[80:83], v[160:175]
ds_read_b64_tr_b16 v[226:227], v3 offset:1024
ds_read_b64_tr_b16 v[228:229], v4
buffer_store_dwordx4 v[56:59], v6, s[16:19], s74 offen offset:2176 sc1
v_accvgpr_read_b32 v32, a112
v_accvgpr_read_b32 v33, a113
v_accvgpr_read_b32 v34, a114
v_accvgpr_read_b32 v35, a115
v_accvgpr_read_b32 v36, a116
v_accvgpr_read_b32 v37, a117
v_mfma_f32_32x32x16_bf16 v[112:127], v[232:235], v[84:87], v[112:127]
ds_read_b64_tr_b16 v[230:231], v4 offset:1024
ds_read_b128 v[64:67], v7 offset:16384
v_accvgpr_read_b32 v38, a118
v_accvgpr_read_b32 v39, a119
v_cvt_pk_bf16_f32 v40, v32, v33
v_cvt_pk_bf16_f32 v41, v34, v35
v_cvt_pk_bf16_f32 v42, v36, v37
v_cvt_pk_bf16_f32 v43, v38, v39
buffer_store_dwordx4 v[40:43], v6, s[16:19], s75 offen offset:128 sc1
v_mfma_f32_32x32x16_bf16 v[176:191], v[236:239], v[84:87], v[176:191]
ds_read_b128 v[68:71], v7 offset:20480
ds_read_b128 v[72:75], v7 offset:24576
v_accvgpr_read_b32 v48, a120
v_accvgpr_read_b32 v49, a121
v_accvgpr_read_b32 v50, a122
v_accvgpr_read_b32 v51, a123
v_accvgpr_read_b32 v52, a124
v_accvgpr_read_b32 v53, a125
v_accvgpr_read_b32 v54, a126
v_mfma_f32_32x32x16_bf16 v[128:143], v[232:235], v[88:91], v[128:143]
ds_read_b128 v[76:79], v7 offset:28672
s_add_u32 m0, s86, 34816
v_accvgpr_read_b32 v55, a127
v_cvt_pk_bf16_f32 v56, v48, v49
v_cvt_pk_bf16_f32 v57, v50, v51
v_cvt_pk_bf16_f32 v58, v52, v53
v_cvt_pk_bf16_f32 v59, v54, v55
buffer_store_dwordx4 v[56:59], v6, s[16:19], s75 offen offset:2176 sc1
v_accvgpr_read_b32 v32, a128
v_mfma_f32_32x32x16_bf16 v[192:207], v[236:239], v[88:91], v[192:207]
s_nop 0
s_nop 0
buffer_load_dwordx4 v27, s[28:31], s60 offen lds
v_accvgpr_read_b32 v33, a129
v_accvgpr_read_b32 v34, a130
v_accvgpr_read_b32 v35, a131
v_accvgpr_read_b32 v36, a132
v_accvgpr_read_b32 v37, a133
v_accvgpr_read_b32 v38, a134
v_accvgpr_read_b32 v39, a135
v_mfma_f32_32x32x16_bf16 v[144:159], v[232:235], v[92:95], v[144:159]
buffer_load_dwordx4 v28, s[28:31], s60 offen offset:1024 lds
s_add_u32 s60, s60, 131072
v_cvt_pk_bf16_f32 v40, v32, v33
v_cvt_pk_bf16_f32 v41, v34, v35
v_cvt_pk_bf16_f32 v42, v36, v37
v_cvt_pk_bf16_f32 v43, v38, v39
buffer_store_dwordx4 v[40:43], v6, s[16:19], s76 offen sc1
v_accvgpr_read_b32 v48, a136
v_accvgpr_read_b32 v49, a137
v_mfma_f32_32x32x16_bf16 v[208:223], v[236:239], v[92:95], v[208:223]
v_accvgpr_read_b32 v50, a138
v_accvgpr_read_b32 v51, a139
v_accvgpr_read_b32 v52, a140
v_accvgpr_read_b32 v53, a141
v_accvgpr_read_b32 v54, a142
v_accvgpr_read_b32 v55, a143
v_cvt_pk_bf16_f32 v56, v48, v49
v_cvt_pk_bf16_f32 v57, v50, v51
v_cvt_pk_bf16_f32 v58, v52, v53
s_waitcnt lgkmcnt(0)
v_mfma_f32_32x32x16_bf16 v[96:111], v[224:227], v[64:67], v[96:111]
s_waitcnt vmcnt(25)
ds_read_b64_tr_b16 v[232:233], v3 offset:2048
v_cvt_pk_bf16_f32 v59, v54, v55
buffer_store_dwordx4 v[56:59], v6, s[16:19], s76 offen offset:2048 sc1
v_accvgpr_read_b32 v32, a144
v_accvgpr_read_b32 v33, a145
v_accvgpr_read_b32 v34, a146
v_accvgpr_read_b32 v35, a147
v_accvgpr_read_b32 v36, a148
v_mfma_f32_32x32x16_bf16 v[160:175], v[228:231], v[64:67], v[160:175]
ds_read_b64_tr_b16 v[234:235], v3 offset:3072
ds_read_b64_tr_b16 v[236:237], v4 offset:2048
v_accvgpr_read_b32 v37, a149
v_accvgpr_read_b32 v38, a150
v_accvgpr_read_b32 v39, a151
v_cvt_pk_bf16_f32 v40, v32, v33
v_cvt_pk_bf16_f32 v41, v34, v35
v_cvt_pk_bf16_f32 v42, v36, v37
v_cvt_pk_bf16_f32 v43, v38, v39
v_mfma_f32_32x32x16_bf16 v[112:127], v[224:227], v[68:71], v[112:127]
ds_read_b64_tr_b16 v[238:239], v4 offset:3072
ds_read_b128 v[80:83], v7 offset:17408
buffer_store_dwordx4 v[40:43], v6, s[16:19], s77 offen sc1
v_accvgpr_read_b32 v48, a152
v_accvgpr_read_b32 v49, a153
v_accvgpr_read_b32 v50, a154
v_accvgpr_read_b32 v51, a155
v_accvgpr_read_b32 v52, a156
v_accvgpr_read_b32 v53, a157
v_mfma_f32_32x32x16_bf16 v[176:191], v[228:231], v[68:71], v[176:191]
ds_read_b128 v[84:87], v7 offset:21504
ds_read_b128 v[88:91], v7 offset:25600
v_accvgpr_read_b32 v54, a158
v_accvgpr_read_b32 v55, a159
v_cvt_pk_bf16_f32 v56, v48, v49
v_cvt_pk_bf16_f32 v57, v50, v51
v_cvt_pk_bf16_f32 v58, v52, v53
v_cvt_pk_bf16_f32 v59, v54, v55
buffer_store_dwordx4 v[56:59], v6, s[16:19], s77 offen offset:2048 sc1
v_mfma_f32_32x32x16_bf16 v[128:143], v[224:227], v[72:75], v[128:143]
ds_read_b128 v[92:95], v7 offset:29696
s_add_u32 m0, s86, 0
v_accvgpr_read_b32 v32, a160
v_accvgpr_read_b32 v33, a161
v_accvgpr_read_b32 v34, a162
v_accvgpr_read_b32 v35, a163
v_accvgpr_read_b32 v36, a164
v_accvgpr_read_b32 v37, a165
v_accvgpr_read_b32 v38, a166
v_mfma_f32_32x32x16_bf16 v[192:207], v[228:231], v[72:75], v[192:207]
s_nop 0
buffer_load_dwordx4 v27, s[28:31], s60 offen lds
v_accvgpr_read_b32 v39, a167
v_cvt_pk_bf16_f32 v40, v32, v33
v_cvt_pk_bf16_f32 v41, v34, v35
v_cvt_pk_bf16_f32 v42, v36, v37
v_cvt_pk_bf16_f32 v43, v38, v39
buffer_store_dwordx4 v[40:43], v6, s[16:19], s76 offen offset:128 sc1
v_accvgpr_read_b32 v48, a168
v_mfma_f32_32x32x16_bf16 v[144:159], v[224:227], v[76:79], v[144:159]
buffer_load_dwordx4 v28, s[28:31], s60 offen offset:1024 lds
s_add_u32 s60, s60, 131072
v_accvgpr_read_b32 v49, a169
v_accvgpr_read_b32 v50, a170
v_accvgpr_read_b32 v51, a171
v_accvgpr_read_b32 v52, a172
v_accvgpr_read_b32 v53, a173
v_accvgpr_read_b32 v54, a174
v_accvgpr_read_b32 v55, a175
v_mfma_f32_32x32x16_bf16 v[208:223], v[228:231], v[76:79], v[208:223]
v_cvt_pk_bf16_f32 v56, v48, v49
v_cvt_pk_bf16_f32 v57, v50, v51
v_cvt_pk_bf16_f32 v58, v52, v53
v_cvt_pk_bf16_f32 v59, v54, v55
buffer_store_dwordx4 v[56:59], v6, s[16:19], s76 offen offset:2176 sc1
v_accvgpr_read_b32 v32, a176
v_accvgpr_read_b32 v33, a177
v_accvgpr_read_b32 v34, a178
v_accvgpr_read_b32 v35, a179
s_waitcnt lgkmcnt(0)
v_mfma_f32_32x32x16_bf16 v[96:111], v[232:235], v[80:83], v[96:111]
s_waitcnt vmcnt(27)
ds_read_b64_tr_b16 v[224:225], v3 offset:16384
v_accvgpr_read_b32 v36, a180
v_accvgpr_read_b32 v37, a181
v_accvgpr_read_b32 v38, a182
v_accvgpr_read_b32 v39, a183
v_cvt_pk_bf16_f32 v40, v32, v33
v_cvt_pk_bf16_f32 v41, v34, v35
v_cvt_pk_bf16_f32 v42, v36, v37
v_mfma_f32_32x32x16_bf16 v[160:175], v[236:239], v[80:83], v[160:175]
ds_read_b64_tr_b16 v[226:227], v3 offset:17408
ds_read_b64_tr_b16 v[228:229], v4 offset:16384
v_cvt_pk_bf16_f32 v43, v38, v39
buffer_store_dwordx4 v[40:43], v6, s[16:19], s77 offen offset:128 sc1
v_accvgpr_read_b32 v48, a184
v_accvgpr_read_b32 v49, a185
v_accvgpr_read_b32 v50, a186
v_accvgpr_read_b32 v51, a187
v_accvgpr_read_b32 v52, a188
v_mfma_f32_32x32x16_bf16 v[112:127], v[232:235], v[84:87], v[112:127]
ds_read_b64_tr_b16 v[230:231], v4 offset:17408
ds_read_b128 v[64:67], v7 offset:18432
v_accvgpr_read_b32 v53, a189
v_accvgpr_read_b32 v54, a190
v_accvgpr_read_b32 v55, a191
v_cvt_pk_bf16_f32 v56, v48, v49
v_cvt_pk_bf16_f32 v57, v50, v51
v_cvt_pk_bf16_f32 v58, v52, v53
v_cvt_pk_bf16_f32 v59, v54, v55
v_mfma_f32_32x32x16_bf16 v[176:191], v[236:239], v[84:87], v[176:191]
ds_read_b128 v[68:71], v7 offset:22528
ds_read_b128 v[72:75], v7 offset:26624
buffer_store_dwordx4 v[56:59], v6, s[16:19], s77 offen offset:2176 sc1
v_accvgpr_read_b32 v32, a192
v_accvgpr_read_b32 v33, a193
v_accvgpr_read_b32 v34, a194
v_accvgpr_read_b32 v35, a195
v_accvgpr_read_b32 v36, a196
v_accvgpr_read_b32 v37, a197
v_mfma_f32_32x32x16_bf16 v[128:143], v[232:235], v[88:91], v[128:143]
ds_read_b128 v[76:79], v7 offset:30720
s_add_u32 m0, s86, 2048
v_accvgpr_read_b32 v38, a198
v_accvgpr_read_b32 v39, a199
v_cvt_pk_bf16_f32 v40, v32, v33
v_cvt_pk_bf16_f32 v41, v34, v35
v_cvt_pk_bf16_f32 v42, v36, v37
v_cvt_pk_bf16_f32 v43, v38, v39
buffer_store_dwordx4 v[40:43], v6, s[16:19], s78 offen sc1
v_mfma_f32_32x32x16_bf16 v[192:207], v[236:239], v[88:91], v[192:207]
s_nop 0
s_nop 0
buffer_load_dwordx4 v27, s[28:31], s60 offen lds
v_accvgpr_read_b32 v48, a200
v_accvgpr_read_b32 v49, a201
v_accvgpr_read_b32 v50, a202
v_accvgpr_read_b32 v51, a203
v_accvgpr_read_b32 v52, a204
v_accvgpr_read_b32 v53, a205
v_accvgpr_read_b32 v54, a206
v_mfma_f32_32x32x16_bf16 v[144:159], v[232:235], v[92:95], v[144:159]
buffer_load_dwordx4 v28, s[28:31], s60 offen offset:1024 lds
s_add_u32 s60, s60, 131072
v_accvgpr_read_b32 v55, a207
v_cvt_pk_bf16_f32 v56, v48, v49
v_cvt_pk_bf16_f32 v57, v50, v51
v_cvt_pk_bf16_f32 v58, v52, v53
v_cvt_pk_bf16_f32 v59, v54, v55
buffer_store_dwordx4 v[56:59], v6, s[16:19], s78 offen offset:2048 sc1
v_accvgpr_read_b32 v32, a208
v_mfma_f32_32x32x16_bf16 v[208:223], v[236:239], v[92:95], v[208:223]
v_accvgpr_read_b32 v33, a209
v_accvgpr_read_b32 v34, a210
v_accvgpr_read_b32 v35, a211
v_accvgpr_read_b32 v36, a212
v_accvgpr_read_b32 v37, a213
v_accvgpr_read_b32 v38, a214
v_accvgpr_read_b32 v39, a215
v_cvt_pk_bf16_f32 v40, v32, v33
v_cvt_pk_bf16_f32 v41, v34, v35
s_waitcnt lgkmcnt(0)
v_mfma_f32_32x32x16_bf16 v[96:111], v[224:227], v[64:67], v[96:111]
s_waitcnt vmcnt(27)
ds_read_b64_tr_b16 v[232:233], v3 offset:18432
v_cvt_pk_bf16_f32 v42, v36, v37
v_cvt_pk_bf16_f32 v43, v38, v39
buffer_store_dwordx4 v[40:43], v6, s[16:19], s79 offen sc1
v_accvgpr_read_b32 v48, a216
v_accvgpr_read_b32 v49, a217
v_accvgpr_read_b32 v50, a218
v_accvgpr_read_b32 v51, a219
v_mfma_f32_32x32x16_bf16 v[160:175], v[228:231], v[64:67], v[160:175]
ds_read_b64_tr_b16 v[234:235], v3 offset:19456
ds_read_b64_tr_b16 v[236:237], v4 offset:18432
v_accvgpr_read_b32 v52, a220
v_accvgpr_read_b32 v53, a221
v_accvgpr_read_b32 v54, a222
v_accvgpr_read_b32 v55, a223
v_cvt_pk_bf16_f32 v56, v48, v49
v_cvt_pk_bf16_f32 v57, v50, v51
v_cvt_pk_bf16_f32 v58, v52, v53
v_mfma_f32_32x32x16_bf16 v[112:127], v[224:227], v[68:71], v[112:127]
ds_read_b64_tr_b16 v[238:239], v4 offset:19456
ds_read_b128 v[80:83], v7 offset:19456
v_cvt_pk_bf16_f32 v59, v54, v55
buffer_store_dwordx4 v[56:59], v6, s[16:19], s79 offen offset:2048 sc1
v_accvgpr_read_b32 v32, a224
v_accvgpr_read_b32 v33, a225
v_accvgpr_read_b32 v34, a226
v_accvgpr_read_b32 v35, a227
v_accvgpr_read_b32 v36, a228
v_mfma_f32_32x32x16_bf16 v[176:191], v[228:231], v[68:71], v[176:191]
ds_read_b128 v[84:87], v7 offset:23552
ds_read_b128 v[88:91], v7 offset:27648
v_accvgpr_read_b32 v37, a229
v_accvgpr_read_b32 v38, a230
v_accvgpr_read_b32 v39, a231
v_cvt_pk_bf16_f32 v40, v32, v33
v_cvt_pk_bf16_f32 v41, v34, v35
v_cvt_pk_bf16_f32 v42, v36, v37
v_cvt_pk_bf16_f32 v43, v38, v39
v_mfma_f32_32x32x16_bf16 v[128:143], v[224:227], v[72:75], v[128:143]
ds_read_b128 v[92:95], v7 offset:31744
s_add_u32 m0, s86, 16384
buffer_store_dwordx4 v[40:43], v6, s[16:19], s78 offen offset:128 sc1
v_accvgpr_read_b32 v48, a232
v_accvgpr_read_b32 v49, a233
v_accvgpr_read_b32 v50, a234
v_accvgpr_read_b32 v51, a235
v_accvgpr_read_b32 v52, a236
v_accvgpr_read_b32 v53, a237
v_mfma_f32_32x32x16_bf16 v[192:207], v[228:231], v[72:75], v[192:207]
s_nop 0
s_nop 0
buffer_load_dwordx4 v27, s[28:31], s60 offen lds
v_accvgpr_read_b32 v54, a238
v_accvgpr_read_b32 v55, a239
v_cvt_pk_bf16_f32 v56, v48, v49
v_cvt_pk_bf16_f32 v57, v50, v51
v_cvt_pk_bf16_f32 v58, v52, v53
v_cvt_pk_bf16_f32 v59, v54, v55
buffer_store_dwordx4 v[56:59], v6, s[16:19], s78 offen offset:2176 sc1
v_mfma_f32_32x32x16_bf16 v[144:159], v[224:227], v[76:79], v[144:159]
buffer_load_dwordx4 v28, s[28:31], s60 offen offset:1024 lds
s_add_u32 s60, s60, 131072
v_accvgpr_read_b32 v32, a240
v_accvgpr_read_b32 v33, a241
v_accvgpr_read_b32 v34, a242
v_accvgpr_read_b32 v35, a243
v_accvgpr_read_b32 v36, a244
v_accvgpr_read_b32 v37, a245
v_accvgpr_read_b32 v38, a246
v_mfma_f32_32x32x16_bf16 v[208:223], v[228:231], v[76:79], v[208:223]
v_accvgpr_read_b32 v39, a247
v_cvt_pk_bf16_f32 v40, v32, v33
v_cvt_pk_bf16_f32 v41, v34, v35
v_cvt_pk_bf16_f32 v42, v36, v37
v_cvt_pk_bf16_f32 v43, v38, v39
buffer_store_dwordx4 v[40:43], v6, s[16:19], s79 offen offset:128 sc1
v_accvgpr_read_b32 v48, a248
v_accvgpr_read_b32 v49, a249
v_accvgpr_read_b32 v50, a250
s_waitcnt lgkmcnt(0)
v_mfma_f32_32x32x16_bf16 v[96:111], v[232:235], v[80:83], v[96:111]
s_waitcnt vmcnt(27)
ds_read_b64_tr_b16 v[224:225], v3 offset:32768
v_accvgpr_read_b32 v51, a251
v_accvgpr_read_b32 v52, a252
v_accvgpr_read_b32 v53, a253
v_accvgpr_read_b32 v54, a254
v_accvgpr_read_b32 v55, a255
v_cvt_pk_bf16_f32 v56, v48, v49
v_cvt_pk_bf16_f32 v57, v50, v51
v_mfma_f32_32x32x16_bf16 v[160:175], v[236:239], v[80:83], v[160:175]
ds_read_b64_tr_b16 v[226:227], v3 offset:33792
ds_read_b64_tr_b16 v[228:229], v4 offset:32768
v_cvt_pk_bf16_f32 v58, v52, v53
v_cvt_pk_bf16_f32 v59, v54, v55
buffer_store_dwordx4 v[56:59], v6, s[16:19], s79 offen offset:2176 sc1
v_mfma_f32_32x32x16_bf16 v[112:127], v[232:235], v[84:87], v[112:127]
ds_read_b64_tr_b16 v[230:231], v4 offset:33792
ds_read_b128 v[64:67], v5
v_mfma_f32_32x32x16_bf16 v[176:191], v[236:239], v[84:87], v[176:191]
ds_read_b128 v[68:71], v5 offset:4096
ds_read_b128 v[72:75], v5 offset:8192
v_mfma_f32_32x32x16_bf16 v[128:143], v[232:235], v[88:91], v[128:143]
ds_read_b128 v[76:79], v5 offset:12288
s_add_u32 m0, s86, 18432
v_mfma_f32_32x32x16_bf16 v[192:207], v[236:239], v[88:91], v[192:207]
s_nop 0
buffer_load_dwordx4 v27, s[28:31], s60 offen lds
v_mfma_f32_32x32x16_bf16 v[144:159], v[232:235], v[92:95], v[144:159]
buffer_load_dwordx4 v28, s[28:31], s60 offen offset:1024 lds
s_add_u32 s60, s60, 131072
v_mfma_f32_32x32x16_bf16 v[208:223], v[236:239], v[92:95], v[208:223]
s_waitcnt lgkmcnt(0)
v_mfma_f32_32x32x16_bf16 v[96:111], v[224:227], v[64:67], v[96:111]
s_waitcnt vmcnt(24)
ds_read_b64_tr_b16 v[232:233], v3 offset:34816
v_mfma_f32_32x32x16_bf16 v[160:175], v[228:231], v[64:67], v[160:175]
ds_read_b64_tr_b16 v[234:235], v3 offset:35840
ds_read_b64_tr_b16 v[236:237], v4 offset:34816
v_mfma_f32_32x32x16_bf16 v[112:127], v[224:227], v[68:71], v[112:127]
ds_read_b64_tr_b16 v[238:239], v4 offset:35840
ds_read_b128 v[80:83], v5 offset:1024
v_mfma_f32_32x32x16_bf16 v[176:191], v[228:231], v[68:71], v[176:191]
ds_read_b128 v[84:87], v5 offset:5120
ds_read_b128 v[88:91], v5 offset:9216
v_mfma_f32_32x32x16_bf16 v[128:143], v[224:227], v[72:75], v[128:143]
ds_read_b128 v[92:95], v5 offset:13312
s_add_u32 m0, s86, 32768
v_mfma_f32_32x32x16_bf16 v[192:207], v[228:231], v[72:75], v[192:207]
s_nop 0
buffer_load_dwordx4 v27, s[28:31], s60 offen lds
v_mfma_f32_32x32x16_bf16 v[144:159], v[224:227], v[76:79], v[144:159]
buffer_load_dwordx4 v28, s[28:31], s60 offen offset:1024 lds
s_add_u32 s60, s60, 131072
v_mfma_f32_32x32x16_bf16 v[208:223], v[228:231], v[76:79], v[208:223]
s_waitcnt lgkmcnt(0)
v_mfma_f32_32x32x16_bf16 v[96:111], v[232:235], v[80:83], v[96:111]
s_waitcnt vmcnt(19)
ds_read_b64_tr_b16 v[224:225], v3
v_mfma_f32_32x32x16_bf16 v[160:175], v[236:239], v[80:83], v[160:175]
ds_read_b64_tr_b16 v[226:227], v3 offset:1024
ds_read_b64_tr_b16 v[228:229], v4
v_mfma_f32_32x32x16_bf16 v[112:127], v[232:235], v[84:87], v[112:127]
ds_read_b64_tr_b16 v[230:231], v4 offset:1024
ds_read_b128 v[64:67], v5 offset:2048
v_mfma_f32_32x32x16_bf16 v[176:191], v[236:239], v[84:87], v[176:191]
ds_read_b128 v[68:71], v5 offset:6144
ds_read_b128 v[72:75], v5 offset:10240
v_mfma_f32_32x32x16_bf16 v[128:143], v[232:235], v[88:91], v[128:143]
ds_read_b128 v[76:79], v5 offset:14336
s_add_u32 m0, s86, 34816
v_mfma_f32_32x32x16_bf16 v[192:207], v[236:239], v[88:91], v[192:207]
s_nop 0
buffer_load_dwordx4 v27, s[28:31], s60 offen lds
v_mfma_f32_32x32x16_bf16 v[144:159], v[232:235], v[92:95], v[144:159]
buffer_load_dwordx4 v28, s[28:31], s60 offen offset:1024 lds
s_add_u32 s60, s60, 131072
v_mfma_f32_32x32x16_bf16 v[208:223], v[236:239], v[92:95], v[208:223]
s_waitcnt lgkmcnt(0)
v_mfma_f32_32x32x16_bf16 v[96:111], v[224:227], v[64:67], v[96:111]
s_waitcnt vmcnt(15)
ds_read_b64_tr_b16 v[232:233], v3 offset:2048
v_mfma_f32_32x32x16_bf16 v[160:175], v[228:231], v[64:67], v[160:175]
ds_read_b64_tr_b16 v[234:235], v3 offset:3072
ds_read_b64_tr_b16 v[236:237], v4 offset:2048
v_mfma_f32_32x32x16_bf16 v[112:127], v[224:227], v[68:71], v[112:127]
ds_read_b64_tr_b16 v[238:239], v4 offset:3072
ds_read_b128 v[80:83], v5 offset:3072
v_mfma_f32_32x32x16_bf16 v[176:191], v[228:231], v[68:71], v[176:191]
ds_read_b128 v[84:87], v5 offset:7168
ds_read_b128 v[88:91], v5 offset:11264
v_mfma_f32_32x32x16_bf16 v[128:143], v[224:227], v[72:75], v[128:143]
ds_read_b128 v[92:95], v5 offset:15360
s_add_u32 m0, s86, 0
v_mfma_f32_32x32x16_bf16 v[192:207], v[228:231], v[72:75], v[192:207]
s_nop 0
buffer_load_dwordx4 v27, s[28:31], s60 offen lds
v_mfma_f32_32x32x16_bf16 v[144:159], v[224:227], v[76:79], v[144:159]
buffer_load_dwordx4 v28, s[28:31], s60 offen offset:1024 lds
s_add_u32 s60, s60, 131072
v_mfma_f32_32x32x16_bf16 v[208:223], v[228:231], v[76:79], v[208:223]
s_waitcnt lgkmcnt(0)
s_waitcnt vmcnt(8)
s_barrier
s_lshl_b32 s56, s4, 6
s_lshl_b32 s57, s7, 5
s_add_u32 s56, s56, s57
s_lshl_b32 s57, s6, 2
s_add_u32 s56, s56, s57
s_add_u32 s56, s56, 2048
s_cmp_lg_u32 s3, 0
s_cbranch_scc1 SETF_5
s_mov_b64 exec, 1
buffer_store_dword v30, v29, s[88:91], s56 offen sc1
s_mov_b64 exec, -1
SETF_5:
v_mfma_f32_32x32x16_bf16 v[96:111], v[232:235], v[80:83], v[96:111]
s_waitcnt vmcnt(10)
ds_read_b64_tr_b16 v[224:225], v3 offset:16384
v_mfma_f32_32x32x16_bf16 v[160:175], v[236:239], v[80:83], v[160:175]
ds_read_b64_tr_b16 v[226:227], v3 offset:17408
ds_read_b64_tr_b16 v[228:229], v4 offset:16384
v_mfma_f32_32x32x16_bf16 v[112:127], v[232:235], v[84:87], v[112:127]
ds_read_b64_tr_b16 v[230:231], v4 offset:17408
ds_read_b128 v[64:67], v5 offset:16384
v_mfma_f32_32x32x16_bf16 v[176:191], v[236:239], v[84:87], v[176:191]
ds_read_b128 v[68:71], v5 offset:20480
ds_read_b128 v[72:75], v5 offset:24576
v_mfma_f32_32x32x16_bf16 v[128:143], v[232:235], v[88:91], v[128:143]
ds_read_b128 v[76:79], v5 offset:28672
s_add_u32 m0, s86, 2048
v_mfma_f32_32x32x16_bf16 v[192:207], v[236:239], v[88:91], v[192:207]
s_nop 0
buffer_load_dwordx4 v27, s[28:31], s60 offen lds
v_mfma_f32_32x32x16_bf16 v[144:159], v[232:235], v[92:95], v[144:159]
buffer_load_dwordx4 v28, s[28:31], s60 offen offset:1024 lds
s_add_u32 s60, s60, 131072
v_mfma_f32_32x32x16_bf16 v[208:223], v[236:239], v[92:95], v[208:223]
s_waitcnt lgkmcnt(0)
v_mfma_f32_32x32x16_bf16 v[96:111], v[224:227], v[64:67], v[96:111]
s_waitcnt vmcnt(8)
ds_read_b64_tr_b16 v[232:233], v3 offset:18432
v_mfma_f32_32x32x16_bf16 v[160:175], v[228:231], v[64:67], v[160:175]
ds_read_b64_tr_b16 v[234:235], v3 offset:19456
ds_read_b64_tr_b16 v[236:237], v4 offset:18432
v_mfma_f32_32x32x16_bf16 v[112:127], v[224:227], v[68:71], v[112:127]
ds_read_b64_tr_b16 v[238:239], v4 offset:19456
ds_read_b128 v[80:83], v5 offset:17408
v_mfma_f32_32x32x16_bf16 v[176:191], v[228:231], v[68:71], v[176:191]
ds_read_b128 v[84:87], v5 offset:21504
ds_read_b128 v[88:91], v5 offset:25600
v_mfma_f32_32x32x16_bf16 v[128:143], v[224:227], v[72:75], v[128:143]
ds_read_b128 v[92:95], v5 offset:29696
s_add_u32 m0, s86, 16384
v_mfma_f32_32x32x16_bf16 v[192:207], v[228:231], v[72:75], v[192:207]
s_nop 0
buffer_load_dwordx4 v27, s[28:31], s60 offen lds
v_mfma_f32_32x32x16_bf16 v[144:159], v[224:227], v[76:79], v[144:159]
buffer_load_dwordx4 v28, s[28:31], s60 offen offset:1024 lds
s_add_u32 s60, s60, 131072
v_mfma_f32_32x32x16_bf16 v[208:223], v[228:231], v[76:79], v[208:223]
s_waitcnt lgkmcnt(0)
v_mfma_f32_32x32x16_bf16 v[96:111], v[232:235], v[80:83], v[96:111]
s_waitcnt vmcnt(8)
ds_read_b64_tr_b16 v[224:225], v3 offset:32768
v_mfma_f32_32x32x16_bf16 v[160:175], v[236:239], v[80:83], v[160:175]
ds_read_b64_tr_b16 v[226:227], v3 offset:33792
ds_read_b64_tr_b16 v[228:229], v4 offset:32768
v_mfma_f32_32x32x16_bf16 v[112:127], v[232:235], v[84:87], v[112:127]
ds_read_b64_tr_b16 v[230:231], v4 offset:33792
ds_read_b128 v[64:67], v5 offset:18432
v_mfma_f32_32x32x16_bf16 v[176:191], v[236:239], v[84:87], v[176:191]
ds_read_b128 v[68:71], v5 offset:22528
ds_read_b128 v[72:75], v5 offset:26624
v_mfma_f32_32x32x16_bf16 v[128:143], v[232:235], v[88:91], v[128:143]
ds_read_b128 v[76:79], v5 offset:30720
s_add_u32 m0, s86, 18432
v_mfma_f32_32x32x16_bf16 v[192:207], v[236:239], v[88:91], v[192:207]
s_nop 0
buffer_load_dwordx4 v27, s[28:31], s60 offen lds
v_mfma_f32_32x32x16_bf16 v[144:159], v[232:235], v[92:95], v[144:159]
buffer_load_dwordx4 v28, s[28:31], s60 offen offset:1024 lds
s_add_u32 s60, s60, 131072
v_mfma_f32_32x32x16_bf16 v[208:223], v[236:239], v[92:95], v[208:223]
s_waitcnt lgkmcnt(0)
v_mfma_f32_32x32x16_bf16 v[96:111], v[224:227], v[64:67], v[96:111]
s_waitcnt vmcnt(8)
ds_read_b64_tr_b16 v[232:233], v3 offset:34816
v_mfma_f32_32x32x16_bf16 v[160:175], v[228:231], v[64:67], v[160:175]
ds_read_b64_tr_b16 v[234:235], v3 offset:35840
ds_read_b64_tr_b16 v[236:237], v4 offset:34816
v_mfma_f32_32x32x16_bf16 v[112:127], v[224:227], v[68:71], v[112:127]
ds_read_b64_tr_b16 v[238:239], v4 offset:35840
ds_read_b128 v[80:83], v5 offset:19456
v_mfma_f32_32x32x16_bf16 v[176:191], v[228:231], v[68:71], v[176:191]
ds_read_b128 v[84:87], v5 offset:23552
ds_read_b128 v[88:91], v5 offset:27648
v_mfma_f32_32x32x16_bf16 v[128:143], v[224:227], v[72:75], v[128:143]
ds_read_b128 v[92:95], v5 offset:31744
s_add_u32 m0, s86, 32768
v_mfma_f32_32x32x16_bf16 v[192:207], v[228:231], v[72:75], v[192:207]
s_nop 0
buffer_load_dwordx4 v27, s[28:31], s60 offen lds
v_mfma_f32_32x32x16_bf16 v[144:159], v[224:227], v[76:79], v[144:159]
buffer_load_dwordx4 v28, s[28:31], s60 offen offset:1024 lds
s_add_u32 s60, s60, 131072
v_mfma_f32_32x32x16_bf16 v[208:223], v[228:231], v[76:79], v[208:223]
s_waitcnt lgkmcnt(0)
v_mfma_f32_32x32x16_bf16 v[96:111], v[232:235], v[80:83], v[96:111]
s_waitcnt vmcnt(8)
s_barrier
ds_read_b64_tr_b16 v[224:225], v3
v_mfma_f32_32x32x16_bf16 v[160:175], v[236:239], v[80:83], v[160:175]
ds_read_b64_tr_b16 v[226:227], v3 offset:1024
ds_read_b64_tr_b16 v[228:229], v4
v_mfma_f32_32x32x16_bf16 v[112:127], v[232:235], v[84:87], v[112:127]
ds_read_b64_tr_b16 v[230:231], v4 offset:1024
ds_read_b128 v[64:67], v7 offset:32768
v_mfma_f32_32x32x16_bf16 v[176:191], v[236:239], v[84:87], v[176:191]
ds_read_b128 v[68:71], v7 offset:36864
ds_read_b128 v[72:75], v7 offset:40960
v_mfma_f32_32x32x16_bf16 v[128:143], v[232:235], v[88:91], v[128:143]
ds_read_b128 v[76:79], v7 offset:45056
s_add_u32 m0, s86, 34816
v_mfma_f32_32x32x16_bf16 v[192:207], v[236:239], v[88:91], v[192:207]
s_nop 0
buffer_load_dwordx4 v27, s[28:31], s60 offen lds
v_mfma_f32_32x32x16_bf16 v[144:159], v[232:235], v[92:95], v[144:159]
buffer_load_dwordx4 v28, s[28:31], s60 offen offset:1024 lds
s_add_u32 s60, s60, 131072
v_mfma_f32_32x32x16_bf16 v[208:223], v[236:239], v[92:95], v[208:223]
s_waitcnt lgkmcnt(0)
v_mfma_f32_32x32x16_bf16 v[96:111], v[224:227], v[64:67], v[96:111]
s_waitcnt vmcnt(8)
ds_read_b64_tr_b16 v[232:233], v3 offset:2048
v_mfma_f32_32x32x16_bf16 v[160:175], v[228:231], v[64:67], v[160:175]
ds_read_b64_tr_b16 v[234:235], v3 offset:3072
ds_read_b64_tr_b16 v[236:237], v4 offset:2048
v_mfma_f32_32x32x16_bf16 v[112:127], v[224:227], v[68:71], v[112:127]
ds_read_b64_tr_b16 v[238:239], v4 offset:3072
ds_read_b128 v[80:83], v7 offset:33792
v_mfma_f32_32x32x16_bf16 v[176:191], v[228:231], v[68:71], v[176:191]
ds_read_b128 v[84:87], v7 offset:37888
ds_read_b128 v[88:91], v7 offset:41984
v_mfma_f32_32x32x16_bf16 v[128:143], v[224:227], v[72:75], v[128:143]
ds_read_b128 v[92:95], v7 offset:46080
s_add_u32 m0, s86, 0
v_mfma_f32_32x32x16_bf16 v[192:207], v[228:231], v[72:75], v[192:207]
s_nop 0
buffer_load_dwordx4 v27, s[28:31], s60 offen lds
v_mfma_f32_32x32x16_bf16 v[144:159], v[224:227], v[76:79], v[144:159]
buffer_load_dwordx4 v28, s[28:31], s60 offen offset:1024 lds
s_add_u32 s60, s60, 131072
v_mfma_f32_32x32x16_bf16 v[208:223], v[228:231], v[76:79], v[208:223]
s_waitcnt lgkmcnt(0)
v_mfma_f32_32x32x16_bf16 v[96:111], v[232:235], v[80:83], v[96:111]
s_waitcnt vmcnt(8)
ds_read_b64_tr_b16 v[224:225], v3 offset:16384
v_mfma_f32_32x32x16_bf16 v[160:175], v[236:239], v[80:83], v[160:175]
ds_read_b64_tr_b16 v[226:227], v3 offset:17408
ds_read_b64_tr_b16 v[228:229], v4 offset:16384
v_mfma_f32_32x32x16_bf16 v[112:127], v[232:235], v[84:87], v[112:127]
ds_read_b64_tr_b16 v[230:231], v4 offset:17408
ds_read_b128 v[64:67], v7 offset:34816
v_mfma_f32_32x32x16_bf16 v[176:191], v[236:239], v[84:87], v[176:191]
ds_read_b128 v[68:71], v7 offset:38912
ds_read_b128 v[72:75], v7 offset:43008
v_mfma_f32_32x32x16_bf16 v[128:143], v[232:235], v[88:91], v[128:143]
ds_read_b128 v[76:79], v7 offset:47104
s_add_u32 m0, s86, 2048
v_mfma_f32_32x32x16_bf16 v[192:207], v[236:239], v[88:91], v[192:207]
s_nop 0
buffer_load_dwordx4 v27, s[28:31], s60 offen lds
v_mfma_f32_32x32x16_bf16 v[144:159], v[232:235], v[92:95], v[144:159]
buffer_load_dwordx4 v28, s[28:31], s60 offen offset:1024 lds
s_add_u32 s60, s60, 131072
v_mfma_f32_32x32x16_bf16 v[208:223], v[236:239], v[92:95], v[208:223]
s_waitcnt lgkmcnt(0)
v_mfma_f32_32x32x16_bf16 v[96:111], v[224:227], v[64:67], v[96:111]
s_waitcnt vmcnt(8)
ds_read_b64_tr_b16 v[232:233], v3 offset:18432
v_mfma_f32_32x32x16_bf16 v[160:175], v[228:231], v[64:67], v[160:175]
ds_read_b64_tr_b16 v[234:235], v3 offset:19456
ds_read_b64_tr_b16 v[236:237], v4 offset:18432
v_mfma_f32_32x32x16_bf16 v[112:127], v[224:227], v[68:71], v[112:127]
ds_read_b64_tr_b16 v[238:239], v4 offset:19456
ds_read_b128 v[80:83], v7 offset:35840
v_mfma_f32_32x32x16_bf16 v[176:191], v[228:231], v[68:71], v[176:191]
ds_read_b128 v[84:87], v7 offset:39936
ds_read_b128 v[88:91], v7 offset:44032
v_mfma_f32_32x32x16_bf16 v[128:143], v[224:227], v[72:75], v[128:143]
ds_read_b128 v[92:95], v7 offset:48128
s_add_u32 m0, s86, 16384
v_mfma_f32_32x32x16_bf16 v[192:207], v[228:231], v[72:75], v[192:207]
s_nop 0
buffer_load_dwordx4 v27, s[28:31], s60 offen lds
v_mfma_f32_32x32x16_bf16 v[144:159], v[224:227], v[76:79], v[144:159]
buffer_load_dwordx4 v28, s[28:31], s60 offen offset:1024 lds
s_add_u32 s60, s60, 131072
v_mfma_f32_32x32x16_bf16 v[208:223], v[228:231], v[76:79], v[208:223]
s_waitcnt lgkmcnt(0)
v_mfma_f32_32x32x16_bf16 v[96:111], v[232:235], v[80:83], v[96:111]
s_waitcnt vmcnt(8)
ds_read_b64_tr_b16 v[224:225], v3 offset:32768
v_mfma_f32_32x32x16_bf16 v[160:175], v[236:239], v[80:83], v[160:175]
ds_read_b64_tr_b16 v[226:227], v3 offset:33792
ds_read_b64_tr_b16 v[228:229], v4 offset:32768
v_mfma_f32_32x32x16_bf16 v[112:127], v[232:235], v[84:87], v[112:127]
ds_read_b64_tr_b16 v[230:231], v4 offset:33792
ds_read_b128 v[64:67], v5 offset:32768
v_mfma_f32_32x32x16_bf16 v[176:191], v[236:239], v[84:87], v[176:191]
ds_read_b128 v[68:71], v5 offset:36864
ds_read_b128 v[72:75], v5 offset:40960
v_mfma_f32_32x32x16_bf16 v[128:143], v[232:235], v[88:91], v[128:143]
ds_read_b128 v[76:79], v5 offset:45056
s_add_u32 m0, s86, 18432
v_mfma_f32_32x32x16_bf16 v[192:207], v[236:239], v[88:91], v[192:207]
s_nop 0
buffer_load_dwordx4 v27, s[28:31], s60 offen lds
v_mfma_f32_32x32x16_bf16 v[144:159], v[232:235], v[92:95], v[144:159]
buffer_load_dwordx4 v28, s[28:31], s60 offen offset:1024 lds
s_add_u32 s60, s60, 131072
v_mfma_f32_32x32x16_bf16 v[208:223], v[236:239], v[92:95], v[208:223]
s_waitcnt lgkmcnt(0)
v_mfma_f32_32x32x16_bf16 v[96:111], v[224:227], v[64:67], v[96:111]
s_waitcnt vmcnt(8)
ds_read_b64_tr_b16 v[232:233], v3 offset:34816
v_mfma_f32_32x32x16_bf16 v[160:175], v[228:231], v[64:67], v[160:175]
ds_read_b64_tr_b16 v[234:235], v3 offset:35840
ds_read_b64_tr_b16 v[236:237], v4 offset:34816
v_mfma_f32_32x32x16_bf16 v[112:127], v[224:227], v[68:71], v[112:127]
ds_read_b64_tr_b16 v[238:239], v4 offset:35840
ds_read_b128 v[80:83], v5 offset:33792
v_mfma_f32_32x32x16_bf16 v[176:191], v[228:231], v[68:71], v[176:191]
ds_read_b128 v[84:87], v5 offset:37888
ds_read_b128 v[88:91], v5 offset:41984
v_mfma_f32_32x32x16_bf16 v[128:143], v[224:227], v[72:75], v[128:143]
ds_read_b128 v[92:95], v5 offset:46080
s_add_u32 m0, s86, 32768
v_mfma_f32_32x32x16_bf16 v[192:207], v[228:231], v[72:75], v[192:207]
s_nop 0
buffer_load_dwordx4 v27, s[28:31], s60 offen lds
v_mfma_f32_32x32x16_bf16 v[144:159], v[224:227], v[76:79], v[144:159]
buffer_load_dwordx4 v28, s[28:31], s60 offen offset:1024 lds
s_add_u32 s60, s60, 131072
v_mfma_f32_32x32x16_bf16 v[208:223], v[228:231], v[76:79], v[208:223]
s_waitcnt lgkmcnt(0)
v_mfma_f32_32x32x16_bf16 v[96:111], v[232:235], v[80:83], v[96:111]
s_waitcnt vmcnt(8)
ds_read_b64_tr_b16 v[224:225], v3
v_mfma_f32_32x32x16_bf16 v[160:175], v[236:239], v[80:83], v[160:175]
ds_read_b64_tr_b16 v[226:227], v3 offset:1024
ds_read_b64_tr_b16 v[228:229], v4
v_mfma_f32_32x32x16_bf16 v[112:127], v[232:235], v[84:87], v[112:127]
ds_read_b64_tr_b16 v[230:231], v4 offset:1024
ds_read_b128 v[64:67], v5 offset:34816
v_mfma_f32_32x32x16_bf16 v[176:191], v[236:239], v[84:87], v[176:191]
ds_read_b128 v[68:71], v5 offset:38912
ds_read_b128 v[72:75], v5 offset:43008
v_mfma_f32_32x32x16_bf16 v[128:143], v[232:235], v[88:91], v[128:143]
ds_read_b128 v[76:79], v5 offset:47104
s_add_u32 m0, s86, 34816
v_mfma_f32_32x32x16_bf16 v[192:207], v[236:239], v[88:91], v[192:207]
s_nop 0
buffer_load_dwordx4 v27, s[28:31], s60 offen lds
v_mfma_f32_32x32x16_bf16 v[144:159], v[232:235], v[92:95], v[144:159]
buffer_load_dwordx4 v28, s[28:31], s60 offen offset:1024 lds
s_add_u32 s60, s60, 131072
v_mfma_f32_32x32x16_bf16 v[208:223], v[236:239], v[92:95], v[208:223]
s_waitcnt lgkmcnt(0)
v_mfma_f32_32x32x16_bf16 v[96:111], v[224:227], v[64:67], v[96:111]
s_waitcnt vmcnt(8)
ds_read_b64_tr_b16 v[232:233], v3 offset:2048
v_mfma_f32_32x32x16_bf16 v[160:175], v[228:231], v[64:67], v[160:175]
ds_read_b64_tr_b16 v[234:235], v3 offset:3072
v_mfma_f32_32x32x16_bf16 v[112:127], v[224:227], v[68:71], v[112:127]
ds_read_b64_tr_b16 v[236:237], v4 offset:2048
v_mfma_f32_32x32x16_bf16 v[176:191], v[228:231], v[68:71], v[176:191]
ds_read_b64_tr_b16 v[238:239], v4 offset:3072
ds_read_b128 v[80:83], v5 offset:35840
v_mfma_f32_32x32x16_bf16 v[128:143], v[224:227], v[72:75], v[128:143]
ds_read_b128 v[84:87], v5 offset:39936
v_mfma_f32_32x32x16_bf16 v[192:207], v[228:231], v[72:75], v[192:207]
ds_read_b128 v[88:91], v5 offset:44032
v_mfma_f32_32x32x16_bf16 v[144:159], v[224:227], v[76:79], v[144:159]
ds_read_b128 v[92:95], v5 offset:48128
v_mfma_f32_32x32x16_bf16 v[208:223], v[228:231], v[76:79], v[208:223]
s_waitcnt lgkmcnt(0)
v_mfma_f32_32x32x16_bf16 v[96:111], v[232:235], v[80:83], v[96:111]
s_waitcnt vmcnt(6)
ds_read_b64_tr_b16 v[224:225], v3 offset:16384
v_mfma_f32_32x32x16_bf16 v[160:175], v[236:239], v[80:83], v[160:175]
ds_read_b64_tr_b16 v[226:227], v3 offset:17408
v_mfma_f32_32x32x16_bf16 v[112:127], v[232:235], v[84:87], v[112:127]
ds_read_b64_tr_b16 v[228:229], v4 offset:16384
v_mfma_f32_32x32x16_bf16 v[176:191], v[236:239], v[84:87], v[176:191]
ds_read_b64_tr_b16 v[230:231], v4 offset:17408
ds_read_b128 v[64:67], v5 offset:49152
v_mfma_f32_32x32x16_bf16 v[128:143], v[232:235], v[88:91], v[128:143]
ds_read_b128 v[68:71], v5 offset:53248
v_mfma_f32_32x32x16_bf16 v[192:207], v[236:239], v[88:91], v[192:207]
ds_read_b128 v[72:75], v5 offset:57344
v_mfma_f32_32x32x16_bf16 v[144:159], v[232:235], v[92:95], v[144:159]
ds_read_b128 v[76:79], v5 offset:61440
v_mfma_f32_32x32x16_bf16 v[208:223], v[236:239], v[92:95], v[208:223]
s_waitcnt lgkmcnt(0)
v_mfma_f32_32x32x16_bf16 v[96:111], v[224:227], v[64:67], v[96:111]
s_waitcnt vmcnt(4)
ds_read_b64_tr_b16 v[232:233], v3 offset:18432
v_mfma_f32_32x32x16_bf16 v[160:175], v[228:231], v[64:67], v[160:175]
ds_read_b64_tr_b16 v[234:235], v3 offset:19456
v_mfma_f32_32x32x16_bf16 v[112:127], v[224:227], v[68:71], v[112:127]
ds_read_b64_tr_b16 v[236:237], v4 offset:18432
v_mfma_f32_32x32x16_bf16 v[176:191], v[228:231], v[68:71], v[176:191]
ds_read_b64_tr_b16 v[238:239], v4 offset:19456
ds_read_b128 v[80:83], v5 offset:50176
v_mfma_f32_32x32x16_bf16 v[128:143], v[224:227], v[72:75], v[128:143]
ds_read_b128 v[84:87], v5 offset:54272
v_mfma_f32_32x32x16_bf16 v[192:207], v[228:231], v[72:75], v[192:207]
ds_read_b128 v[88:91], v5 offset:58368
v_mfma_f32_32x32x16_bf16 v[144:159], v[224:227], v[76:79], v[144:159]
ds_read_b128 v[92:95], v5 offset:62464
v_mfma_f32_32x32x16_bf16 v[208:223], v[228:231], v[76:79], v[208:223]
s_waitcnt lgkmcnt(0)
v_mfma_f32_32x32x16_bf16 v[96:111], v[232:235], v[80:83], v[96:111]
s_waitcnt vmcnt(2)
ds_read_b64_tr_b16 v[224:225], v3 offset:32768
v_mfma_f32_32x32x16_bf16 v[160:175], v[236:239], v[80:83], v[160:175]
ds_read_b64_tr_b16 v[226:227], v3 offset:33792
v_mfma_f32_32x32x16_bf16 v[112:127], v[232:235], v[84:87], v[112:127]
ds_read_b64_tr_b16 v[228:229], v4 offset:32768
v_mfma_f32_32x32x16_bf16 v[176:191], v[236:239], v[84:87], v[176:191]
ds_read_b64_tr_b16 v[230:231], v4 offset:33792
ds_read_b128 v[64:67], v5 offset:51200
v_mfma_f32_32x32x16_bf16 v[128:143], v[232:235], v[88:91], v[128:143]
ds_read_b128 v[68:71], v5 offset:55296
v_mfma_f32_32x32x16_bf16 v[192:207], v[236:239], v[88:91], v[192:207]
ds_read_b128 v[72:75], v5 offset:59392
v_mfma_f32_32x32x16_bf16 v[144:159], v[232:235], v[92:95], v[144:159]
ds_read_b128 v[76:79], v5 offset:63488
v_mfma_f32_32x32x16_bf16 v[208:223], v[236:239], v[92:95], v[208:223]
s_waitcnt lgkmcnt(0)
v_mfma_f32_32x32x16_bf16 v[96:111], v[224:227], v[64:67], v[96:111]
s_waitcnt vmcnt(0)
ds_read_b64_tr_b16 v[232:233], v3 offset:34816
v_mfma_f32_32x32x16_bf16 v[160:175], v[228:231], v[64:67], v[160:175]
ds_read_b64_tr_b16 v[234:235], v3 offset:35840
v_mfma_f32_32x32x16_bf16 v[112:127], v[224:227], v[68:71], v[112:127]
ds_read_b64_tr_b16 v[236:237], v4 offset:34816
v_mfma_f32_32x32x16_bf16 v[176:191], v[228:231], v[68:71], v[176:191]
ds_read_b64_tr_b16 v[238:239], v4 offset:35840
ds_read_b128 v[80:83], v5 offset:52224
v_mfma_f32_32x32x16_bf16 v[128:143], v[224:227], v[72:75], v[128:143]
ds_read_b128 v[84:87], v5 offset:56320
v_mfma_f32_32x32x16_bf16 v[192:207], v[228:231], v[72:75], v[192:207]
ds_read_b128 v[88:91], v5 offset:60416
v_mfma_f32_32x32x16_bf16 v[144:159], v[224:227], v[76:79], v[144:159]
ds_read_b128 v[92:95], v5 offset:64512
v_mfma_f32_32x32x16_bf16 v[208:223], v[228:231], v[76:79], v[208:223]
s_waitcnt lgkmcnt(0)
v_mfma_f32_32x32x16_bf16 v[96:111], v[232:235], v[80:83], v[96:111]
v_mfma_f32_32x32x16_bf16 v[160:175], v[236:239], v[80:83], v[160:175]
v_mfma_f32_32x32x16_bf16 v[112:127], v[232:235], v[84:87], v[112:127]
v_mfma_f32_32x32x16_bf16 v[176:191], v[236:239], v[84:87], v[176:191]
v_mfma_f32_32x32x16_bf16 v[128:143], v[232:235], v[88:91], v[128:143]
v_mfma_f32_32x32x16_bf16 v[192:207], v[236:239], v[88:91], v[192:207]
v_mfma_f32_32x32x16_bf16 v[144:159], v[232:235], v[92:95], v[144:159]
v_mfma_f32_32x32x16_bf16 v[208:223], v[236:239], v[92:95], v[208:223]
s_barrier
s_branch PB_JOIN
PA_V:
s_waitcnt vmcnt(7)
s_barrier
ds_read_b128 v[64:67], v16
ds_read_b64_tr_b16 v[96:97], v17
ds_read_b64_tr_b16 v[98:99], v17 offset:2048
ds_read_b128 v[68:71], v16 offset:1024
ds_read_b64_tr_b16 v[100:101], v18
ds_read_b64_tr_b16 v[102:103], v18 offset:2048
ds_read_b128 v[72:75], v16 offset:4096
ds_read_b64_tr_b16 v[104:105], v19
ds_read_b64_tr_b16 v[106:107], v19 offset:2048
ds_read_b128 v[76:79], v16 offset:5120
ds_read_b64_tr_b16 v[108:109], v20
ds_read_b64_tr_b16 v[110:111], v20 offset:2048
ds_read_b128 v[80:83], v16 offset:8192
ds_read_b64_tr_b16 v[112:113], v21
ds_read_b64_tr_b16 v[114:115], v21 offset:2048
ds_read_b128 v[84:87], v16 offset:9216
ds_read_b64_tr_b16 v[116:117], v22
ds_read_b64_tr_b16 v[118:119], v22 offset:2048
ds_read_b128 v[88:91], v16 offset:12288
ds_read_b64_tr_b16 v[120:121], v23
ds_read_b64_tr_b16 v[122:123], v23 offset:2048
ds_read_b128 v[92:95], v16 offset:13312
ds_read_b64_tr_b16 v[124:125], v24
ds_read_b64_tr_b16 v[126:127], v24 offset:2048
s_waitcnt lgkmcnt(0)
v_mfma_f32_16x16x32_bf16 a[0:3], v[64:67], v[96:99], 0
s_add_u32 m0, s64, 98304
s_nop 0
buffer_load_dwordx4 v12, s[12:15], s66 offen lds
v_mfma_f32_16x16x32_bf16 a[4:7], v[64:67], v[100:103], 0
buffer_load_dwordx4 v13, s[12:15], s66 offen offset:1024 lds
buffer_load_dwordx4 v14, s[12:15], s66 offen offset:2048 lds
buffer_load_dwordx4 v15, s[12:15], s66 offen offset:3072 lds
v_mfma_f32_16x16x32_bf16 a[8:11], v[64:67], v[104:107], 0
s_add_u32 s66, s66, 262144
s_add_u32 m0, s63, 32768
s_add_u32 s62, s65, 0
v_mfma_f32_16x16x32_bf16 a[12:15], v[64:67], v[108:111], 0
buffer_load_dwordx4 v8, s[8:11], s62 offen lds
s_add_u32 s62, s65, 15360
v_mfma_f32_16x16x32_bf16 a[16:19], v[64:67], v[112:115], 0
buffer_load_dwordx4 v8, s[8:11], s62 offen offset:1024 lds
s_add_u32 s62, s65, 30720
buffer_load_dwordx4 v9, s[8:11], s62 offen offset:2048 lds
v_mfma_f32_16x16x32_bf16 a[20:23], v[64:67], v[116:119], 0
s_add_u32 s62, s65, 46080
buffer_load_dwordx4 v9, s[8:11], s62 offen offset:3072 lds
s_add_u32 m0, s63, 36864
v_mfma_f32_16x16x32_bf16 a[24:27], v[64:67], v[120:123], 0
s_add_u32 s62, s65, 65536
buffer_load_dwordx4 v8, s[8:11], s62 offen lds
s_add_u32 s62, s65, 80896
v_mfma_f32_16x16x32_bf16 a[28:31], v[64:67], v[124:127], 0
buffer_load_dwordx4 v8, s[8:11], s62 offen offset:1024 lds
s_add_u32 s62, s65, 96256
v_mfma_f32_16x16x32_bf16 a[32:35], v[68:71], v[96:99], 0
buffer_load_dwordx4 v9, s[8:11], s62 offen offset:2048 lds
s_add_u32 s62, s65, 111616
buffer_load_dwordx4 v9, s[8:11], s62 offen offset:3072 lds
v_mfma_f32_16x16x32_bf16 a[36:39], v[68:71], v[100:103], 0
s_add_u32 s65, s65, 128
s_add_u32 m0, s64, 114688
s_nop 0
v_mfma_f32_16x16x32_bf16 a[40:43], v[68:71], v[104:107], 0
buffer_load_dwordx4 v12, s[12:15], s66 offen lds
buffer_load_dwordx4 v13, s[12:15], s66 offen offset:1024 lds
buffer_load_dwordx4 v14, s[12:15], s66 offen offset:2048 lds
v_mfma_f32_16x16x32_bf16 a[44:47], v[68:71], v[108:111], 0
buffer_load_dwordx4 v15, s[12:15], s66 offen offset:3072 lds
s_add_u32 s66, s66, 262144
v_mfma_f32_16x16x32_bf16 a[48:51], v[68:71], v[112:115], 0
s_waitcnt vmcnt(19)
s_barrier
v_mfma_f32_16x16x32_bf16 a[52:55], v[68:71], v[116:119], 0
ds_read_b128 v[128:131], v10
v_mfma_f32_16x16x32_bf16 a[56:59], v[68:71], v[120:123], 0
ds_read_b64_tr_b16 v[160:161], v17 offset:16384
s_add_u32 m0, s64, 65536
v_mfma_f32_16x16x32_bf16 a[60:63], v[68:71], v[124:127], 0
v_mfma_f32_16x16x32_bf16 a[64:67], v[72:75], v[96:99], 0
ds_read_b64_tr_b16 v[162:163], v17 offset:18432
v_mfma_f32_16x16x32_bf16 a[68:71], v[72:75], v[100:103], 0
v_mfma_f32_16x16x32_bf16 a[72:75], v[72:75], v[104:107], 0
ds_read_b128 v[132:135], v10 offset:1024
v_mfma_f32_16x16x32_bf16 a[76:79], v[72:75], v[108:111], 0
s_nop 0
v_mfma_f32_16x16x32_bf16 a[80:83], v[72:75], v[112:115], 0
ds_read_b64_tr_b16 v[164:165], v18 offset:16384
v_mfma_f32_16x16x32_bf16 a[84:87], v[72:75], v[116:119], 0
ds_read_b64_tr_b16 v[166:167], v18 offset:18432
v_mfma_f32_16x16x32_bf16 a[88:91], v[72:75], v[120:123], 0
v_mfma_f32_16x16x32_bf16 a[92:95], v[72:75], v[124:127], 0
ds_read_b128 v[136:139], v10 offset:4096
v_mfma_f32_16x16x32_bf16 a[96:99], v[76:79], v[96:99], 0
buffer_load_dwordx4 v12, s[12:15], s66 offen lds
v_mfma_f32_16x16x32_bf16 a[100:103], v[76:79], v[100:103], 0
ds_read_b64_tr_b16 v[168:169], v19 offset:16384
v_mfma_f32_16x16x32_bf16 a[104:107], v[76:79], v[104:107], 0
v_mfma_f32_16x16x32_bf16 a[108:111], v[76:79], v[108:111], 0
ds_read_b64_tr_b16 v[170:171], v19 offset:18432
v_mfma_f32_16x16x32_bf16 a[112:115], v[76:79], v[112:115], 0
ds_read_b128 v[140:143], v10 offset:5120
v_mfma_f32_16x16x32_bf16 a[116:119], v[76:79], v[116:119], 0
buffer_load_dwordx4 v13, s[12:15], s66 offen offset:1024 lds
v_mfma_f32_16x16x32_bf16 a[120:123], v[76:79], v[120:123], 0
ds_read_b64_tr_b16 v[172:173], v20 offset:16384
v_mfma_f32_16x16x32_bf16 a[124:127], v[76:79], v[124:127], 0
v_mfma_f32_16x16x32_bf16 a[128:131], v[80:83], v[96:99], 0
ds_read_b64_tr_b16 v[174:175], v20 offset:18432
v_mfma_f32_16x16x32_bf16 a[132:135], v[80:83], v[100:103], 0
v_mfma_f32_16x16x32_bf16 a[136:139], v[80:83], v[104:107], 0
ds_read_b128 v[144:147], v10 offset:8192
buffer_load_dwordx4 v14, s[12:15], s66 offen offset:2048 lds
v_mfma_f32_16x16x32_bf16 a[140:143], v[80:83], v[108:111], 0
ds_read_b64_tr_b16 v[176:177], v21 offset:16384
v_mfma_f32_16x16x32_bf16 a[144:147], v[80:83], v[112:115], 0
v_mfma_f32_16x16x32_bf16 a[148:151], v[80:83], v[116:119], 0
ds_read_b64_tr_b16 v[178:179], v21 offset:18432
v_mfma_f32_16x16x32_bf16 a[152:155], v[80:83], v[120:123], 0
v_mfma_f32_16x16x32_bf16 a[156:159], v[80:83], v[124:127], 0
ds_read_b128 v[148:151], v10 offset:9216
buffer_load_dwordx4 v15, s[12:15], s66 offen offset:3072 lds
v_mfma_f32_16x16x32_bf16 a[160:163], v[84:87], v[96:99], 0
v_mfma_f32_16x16x32_bf16 a[164:167], v[84:87], v[100:103], 0
ds_read_b64_tr_b16 v[180:181], v22 offset:16384
v_mfma_f32_16x16x32_bf16 a[168:171], v[84:87], v[104:107], 0
ds_read_b64_tr_b16 v[182:183], v22 offset:18432
v_mfma_f32_16x16x32_bf16 a[172:175], v[84:87], v[108:111], 0
v_mfma_f32_16x16x32_bf16 a[176:179], v[84:87], v[112:115], 0
ds_read_b128 v[152:155], v10 offset:12288
s_add_u32 s66, s66, 262144
v_mfma_f32_16x16x32_bf16 a[180:183], v[84:87], v[116:119], 0
v_mfma_f32_16x16x32_bf16 a[184:187], v[84:87], v[120:123], 0
ds_read_b64_tr_b16 v[184:185], v23 offset:16384
v_mfma_f32_16x16x32_bf16 a[188:191], v[84:87], v[124:127], 0
v_mfma_f32_16x16x32_bf16 a[192:195], v[88:91], v[96:99], 0
ds_read_b64_tr_b16 v[186:187], v23 offset:18432
v_mfma_f32_16x16x32_bf16 a[196:199], v[88:91], v[100:103], 0
ds_read_b128 v[156:159], v10 offset:13312
v_mfma_f32_16x16x32_bf16 a[200:203], v[88:91], v[104:107], 0
v_add_u32 v242, 0x100000, v242
global_load_dword v245, v242, s[98:99]
v_mfma_f32_16x16x32_bf16 a[204:207], v[88:91], v[108:111], 0
ds_read_b64_tr_b16 v[188:189], v24 offset:16384
v_mfma_f32_16x16x32_bf16 a[208:211], v[88:91], v[112:115], 0
v_mfma_f32_16x16x32_bf16 a[212:215], v[88:91], v[116:119], 0
ds_read_b64_tr_b16 v[190:191], v24 offset:18432
v_mfma_f32_16x16x32_bf16 a[216:219], v[88:91], v[120:123], 0
v_mfma_f32_16x16x32_bf16 a[220:223], v[88:91], v[124:127], 0
v_mfma_f32_16x16x32_bf16 a[224:227], v[92:95], v[96:99], 0
v_mfma_f32_16x16x32_bf16 a[228:231], v[92:95], v[100:103], 0
v_mfma_f32_16x16x32_bf16 a[232:235], v[92:95], v[104:107], 0
v_mfma_f32_16x16x32_bf16 a[236:239], v[92:95], v[108:111], 0
v_mfma_f32_16x16x32_bf16 a[240:243], v[92:95], v[112:115], 0
v_mfma_f32_16x16x32_bf16 a[244:247], v[92:95], v[116:119], 0
v_mfma_f32_16x16x32_bf16 a[248:251], v[92:95], v[120:123], 0
v_mfma_f32_16x16x32_bf16 a[252:255], v[92:95], v[124:127], 0
s_waitcnt lgkmcnt(0)
v_mfma_f32_16x16x32_bf16 a[0:3], v[128:131], v[160:163], a[0:3]
s_waitcnt vmcnt(9)
s_barrier
v_mfma_f32_16x16x32_bf16 a[4:7], v[128:131], v[164:167], a[4:7]
ds_read_b128 v[64:67], v16 offset:32768
v_mfma_f32_16x16x32_bf16 a[8:11], v[128:131], v[168:171], a[8:11]
s_add_u32 m0, s63, 0
v_mfma_f32_16x16x32_bf16 a[12:15], v[128:131], v[172:175], a[12:15]
ds_read_b64_tr_b16 v[96:97], v17 offset:32768
s_add_u32 s62, s65, 0
v_mfma_f32_16x16x32_bf16 a[16:19], v[128:131], v[176:179], a[16:19]
v_mfma_f32_16x16x32_bf16 a[20:23], v[128:131], v[180:183], a[20:23]
ds_read_b64_tr_b16 v[98:99], v17 offset:34816
buffer_load_dwordx4 v8, s[8:11], s62 offen lds
v_mfma_f32_16x16x32_bf16 a[24:27], v[128:131], v[184:187], a[24:27]
v_mfma_f32_16x16x32_bf16 a[28:31], v[128:131], v[188:191], a[28:31]
ds_read_b128 v[68:71], v16 offset:33792
s_add_u32 s62, s65, 15360
v_mfma_f32_16x16x32_bf16 a[32:35], v[132:135], v[160:163], a[32:35]
v_mfma_f32_16x16x32_bf16 a[36:39], v[132:135], v[164:167], a[36:39]
buffer_load_dwordx4 v8, s[8:11], s62 offen offset:1024 lds
v_mfma_f32_16x16x32_bf16 a[40:43], v[132:135], v[168:171], a[40:43]
ds_read_b64_tr_b16 v[100:101], v18 offset:32768
v_mfma_f32_16x16x32_bf16 a[44:47], v[132:135], v[172:175], a[44:47]
s_add_u32 s62, s65, 30720
v_mfma_f32_16x16x32_bf16 a[48:51], v[132:135], v[176:179], a[48:51]
ds_read_b64_tr_b16 v[102:103], v18 offset:34816
buffer_load_dwordx4 v9, s[8:11], s62 offen offset:2048 lds
v_mfma_f32_16x16x32_bf16 a[52:55], v[132:135], v[180:183], a[52:55]
v_mfma_f32_16x16x32_bf16 a[56:59], v[132:135], v[184:187], a[56:59]
ds_read_b128 v[72:75], v16 offset:36864
s_add_u32 s62, s65, 46080
v_mfma_f32_16x16x32_bf16 a[60:63], v[132:135], v[188:191], a[60:63]
v_mfma_f32_16x16x32_bf16 a[64:67], v[136:139], v[160:163], a[64:67]
ds_read_b64_tr_b16 v[104:105], v19 offset:32768
buffer_load_dwordx4 v9, s[8:11], s62 offen offset:3072 lds
v_mfma_f32_16x16x32_bf16 a[68:71], v[136:139], v[164:167], a[68:71]
v_mfma_f32_16x16x32_bf16 a[72:75], v[136:139], v[168:171], a[72:75]
s_add_u32 m0, s63, 4096
v_mfma_f32_16x16x32_bf16 a[76:79], v[136:139], v[172:175], a[76:79]
ds_read_b64_tr_b16 v[106:107], v19 offset:34816
v_mfma_f32_16x16x32_bf16 a[80:83], v[136:139], v[176:179], a[80:83]
s_add_u32 s62, s65, 65536
v_mfma_f32_16x16x32_bf16 a[84:87], v[136:139], v[180:183], a[84:87]
ds_read_b128 v[76:79], v16 offset:37888
buffer_load_dwordx4 v8, s[8:11], s62 offen lds
v_mfma_f32_16x16x32_bf16 a[88:91], v[136:139], v[184:187], a[88:91]
v_mfma_f32_16x16x32_bf16 a[92:95], v[136:139], v[188:191], a[92:95]
ds_read_b64_tr_b16 v[108:109], v20 offset:32768
s_add_u32 s62, s65, 80896
v_mfma_f32_16x16x32_bf16 a[96:99], v[140:143], v[160:163], a[96:99]
v_mfma_f32_16x16x32_bf16 a[100:103], v[140:143], v[164:167], a[100:103]
ds_read_b64_tr_b16 v[110:111], v20 offset:34816
buffer_load_dwordx4 v8, s[8:11], s62 offen offset:1024 lds
v_mfma_f32_16x16x32_bf16 a[104:107], v[140:143], v[168:171], a[104:107]
v_mfma_f32_16x16x32_bf16 a[108:111], v[140:143], v[172:175], a[108:111]
s_add_u32 s62, s65, 96256
v_mfma_f32_16x16x32_bf16 a[112:115], v[140:143], v[176:179], a[112:115]
ds_read_b128 v[80:83], v16 offset:40960
v_mfma_f32_16x16x32_bf16 a[116:119], v[140:143], v[180:183], a[116:119]
buffer_load_dwordx4 v9, s[8:11], s62 offen offset:2048 lds
v_mfma_f32_16x16x32_bf16 a[120:123], v[140:143], v[184:187], a[120:123]
ds_read_b64_tr_b16 v[112:113], v21 offset:32768
s_add_u32 s62, s65, 111616
v_mfma_f32_16x16x32_bf16 a[124:127], v[140:143], v[188:191], a[124:127]
v_mfma_f32_16x16x32_bf16 a[128:131], v[144:147], v[160:163], a[128:131]
ds_read_b64_tr_b16 v[114:115], v21 offset:34816
buffer_load_dwordx4 v9, s[8:11], s62 offen offset:3072 lds
v_mfma_f32_16x16x32_bf16 a[132:135], v[144:147], v[164:167], a[132:135]
v_mfma_f32_16x16x32_bf16 a[136:139], v[144:147], v[168:171], a[136:139]
ds_read_b128 v[84:87], v16 offset:41984
s_add_u32 s65, s65, 128
v_mfma_f32_16x16x32_bf16 a[140:143], v[144:147], v[172:175], a[140:143]
v_mfma_f32_16x16x32_bf16 a[144:147], v[144:147], v[176:179], a[144:147]
s_add_u32 m0, s64, 81920
v_mfma_f32_16x16x32_bf16 a[148:151], v[144:147], v[180:183], a[148:151]
ds_read_b64_tr_b16 v[116:117], v22 offset:32768
v_mfma_f32_16x16x32_bf16 a[152:155], v[144:147], v[184:187], a[152:155]
s_nop 0
v_mfma_f32_16x16x32_bf16 a[156:159], v[144:147], v[188:191], a[156:159]
ds_read_b64_tr_b16 v[118:119], v22 offset:34816
buffer_load_dwordx4 v12, s[12:15], s66 offen lds
v_mfma_f32_16x16x32_bf16 a[160:163], v[148:151], v[160:163], a[160:163]
v_mfma_f32_16x16x32_bf16 a[164:167], v[148:151], v[164:167], a[164:167]
ds_read_b128 v[88:91], v16 offset:45056
buffer_load_dwordx4 v13, s[12:15], s66 offen offset:1024 lds
v_mfma_f32_16x16x32_bf16 a[168:171], v[148:151], v[168:171], a[168:171]
v_mfma_f32_16x16x32_bf16 a[172:175], v[148:151], v[172:175], a[172:175]
ds_read_b64_tr_b16 v[120:121], v23 offset:32768
buffer_load_dwordx4 v14, s[12:15], s66 offen offset:2048 lds
v_mfma_f32_16x16x32_bf16 a[176:179], v[148:151], v[176:179], a[176:179]
v_mfma_f32_16x16x32_bf16 a[180:183], v[148:151], v[180:183], a[180:183]
buffer_load_dwordx4 v15, s[12:15], s66 offen offset:3072 lds
v_mfma_f32_16x16x32_bf16 a[184:187], v[148:151], v[184:187], a[184:187]
ds_read_b64_tr_b16 v[122:123], v23 offset:34816
v_mfma_f32_16x16x32_bf16 a[188:191], v[148:151], v[188:191], a[188:191]
s_add_u32 s66, s66, 262144
v_mfma_f32_16x16x32_bf16 a[192:195], v[152:155], v[160:163], a[192:195]
ds_read_b128 v[92:95], v16 offset:46080
v_mfma_f32_16x16x32_bf16 a[196:199], v[152:155], v[164:167], a[196:199]
v_mfma_f32_16x16x32_bf16 a[200:203], v[152:155], v[168:171], a[200:203]
ds_read_b64_tr_b16 v[124:125], v24 offset:32768
v_mfma_f32_16x16x32_bf16 a[204:207], v[152:155], v[172:175], a[204:207]
v_mfma_f32_16x16x32_bf16 a[208:211], v[152:155], v[176:179], a[208:211]
ds_read_b64_tr_b16 v[126:127], v24 offset:34816
v_mfma_f32_16x16x32_bf16 a[212:215], v[152:155], v[180:183], a[212:215]
v_mfma_f32_16x16x32_bf16 a[216:219], v[152:155], v[184:187], a[216:219]
v_mfma_f32_16x16x32_bf16 a[220:223], v[152:155], v[188:191], a[220:223]
v_mfma_f32_16x16x32_bf16 a[224:227], v[156:159], v[160:163], a[224:227]
v_mfma_f32_16x16x32_bf16 a[228:231], v[156:159], v[164:167], a[228:231]
v_mfma_f32_16x16x32_bf16 a[232:235], v[156:159], v[168:171], a[232:235]
v_mfma_f32_16x16x32_bf16 a[236:239], v[156:159], v[172:175], a[236:239]
v_mfma_f32_16x16x32_bf16 a[240:243], v[156:159], v[176:179], a[240:243]
v_mfma_f32_16x16x32_bf16 a[244:247], v[156:159], v[180:183], a[244:247]
v_mfma_f32_16x16x32_bf16 a[248:251], v[156:159], v[184:187], a[248:251]
v_mfma_f32_16x16x32_bf16 a[252:255], v[156:159], v[188:191], a[252:255]
s_waitcnt lgkmcnt(0)
v_mfma_f32_16x16x32_bf16 a[0:3], v[64:67], v[96:99], a[0:3]
s_waitcnt vmcnt(17)
s_barrier
v_mfma_f32_16x16x32_bf16 a[4:7], v[64:67], v[100:103], a[4:7]
ds_read_b128 v[128:131], v10 offset:32768
v_mfma_f32_16x16x32_bf16 a[8:11], v[64:67], v[104:107], a[8:11]
s_add_u32 m0, s64, 98304
v_mfma_f32_16x16x32_bf16 a[12:15], v[64:67], v[108:111], a[12:15]
ds_read_b64_tr_b16 v[160:161], v17 offset:49152
v_mfma_f32_16x16x32_bf16 a[16:19], v[64:67], v[112:115], a[16:19]
v_mfma_f32_16x16x32_bf16 a[20:23], v[64:67], v[116:119], a[20:23]
ds_read_b64_tr_b16 v[162:163], v17 offset:51200
v_mfma_f32_16x16x32_bf16 a[24:27], v[64:67], v[120:123], a[24:27]
v_mfma_f32_16x16x32_bf16 a[28:31], v[64:67], v[124:127], a[28:31]
ds_read_b128 v[132:135], v10 offset:33792
v_mfma_f32_16x16x32_bf16 a[32:35], v[68:71], v[96:99], a[32:35]
s_nop 0
v_mfma_f32_16x16x32_bf16 a[36:39], v[68:71], v[100:103], a[36:39]
v_mfma_f32_16x16x32_bf16 a[40:43], v[68:71], v[104:107], a[40:43]
ds_read_b64_tr_b16 v[164:165], v18 offset:49152
v_mfma_f32_16x16x32_bf16 a[44:47], v[68:71], v[108:111], a[44:47]
v_mfma_f32_16x16x32_bf16 a[48:51], v[68:71], v[112:115], a[48:51]
ds_read_b64_tr_b16 v[166:167], v18 offset:51200
v_mfma_f32_16x16x32_bf16 a[52:55], v[68:71], v[116:119], a[52:55]
v_mfma_f32_16x16x32_bf16 a[56:59], v[68:71], v[120:123], a[56:59]
ds_read_b128 v[136:139], v10 offset:36864
v_mfma_f32_16x16x32_bf16 a[60:63], v[68:71], v[124:127], a[60:63]
buffer_load_dwordx4 v12, s[12:15], s66 offen lds
v_mfma_f32_16x16x32_bf16 a[64:67], v[72:75], v[96:99], a[64:67]
ds_read_b64_tr_b16 v[168:169], v19 offset:49152
v_mfma_f32_16x16x32_bf16 a[68:71], v[72:75], v[100:103], a[68:71]
v_mfma_f32_16x16x32_bf16 a[72:75], v[72:75], v[104:107], a[72:75]
v_mfma_f32_16x16x32_bf16 a[76:79], v[72:75], v[108:111], a[76:79]
ds_read_b64_tr_b16 v[170:171], v19 offset:51200
v_mfma_f32_16x16x32_bf16 a[80:83], v[72:75], v[112:115], a[80:83]
v_mfma_f32_16x16x32_bf16 a[84:87], v[72:75], v[116:119], a[84:87]
ds_read_b128 v[140:143], v10 offset:37888
v_mfma_f32_16x16x32_bf16 a[88:91], v[72:75], v[120:123], a[88:91]
buffer_load_dwordx4 v13, s[12:15], s66 offen offset:1024 lds
v_mfma_f32_16x16x32_bf16 a[92:95], v[72:75], v[124:127], a[92:95]
ds_read_b64_tr_b16 v[172:173], v20 offset:49152
v_mfma_f32_16x16x32_bf16 a[96:99], v[76:79], v[96:99], a[96:99]
v_mfma_f32_16x16x32_bf16 a[100:103], v[76:79], v[100:103], a[100:103]
ds_read_b64_tr_b16 v[174:175], v20 offset:51200
v_mfma_f32_16x16x32_bf16 a[104:107], v[76:79], v[104:107], a[104:107]
v_mfma_f32_16x16x32_bf16 a[108:111], v[76:79], v[108:111], a[108:111]
v_mfma_f32_16x16x32_bf16 a[112:115], v[76:79], v[112:115], a[112:115]
ds_read_b128 v[144:147], v10 offset:40960
buffer_load_dwordx4 v14, s[12:15], s66 offen offset:2048 lds
v_mfma_f32_16x16x32_bf16 a[116:119], v[76:79], v[116:119], a[116:119]
v_mfma_f32_16x16x32_bf16 a[120:123], v[76:79], v[120:123], a[120:123]
ds_read_b64_tr_b16 v[176:177], v21 offset:49152
v_mfma_f32_16x16x32_bf16 a[124:127], v[76:79], v[124:127], a[124:127]
v_mfma_f32_16x16x32_bf16 a[128:131], v[80:83], v[96:99], a[128:131]
ds_read_b64_tr_b16 v[178:179], v21 offset:51200
v_mfma_f32_16x16x32_bf16 a[132:135], v[80:83], v[100:103], a[132:135]
v_mfma_f32_16x16x32_bf16 a[136:139], v[80:83], v[104:107], a[136:139]
ds_read_b128 v[148:151], v10 offset:41984
v_mfma_f32_16x16x32_bf16 a[140:143], v[80:83], v[108:111], a[140:143]
buffer_load_dwordx4 v15, s[12:15], s66 offen offset:3072 lds
v_mfma_f32_16x16x32_bf16 a[144:147], v[80:83], v[112:115], a[144:147]
v_mfma_f32_16x16x32_bf16 a[148:151], v[80:83], v[116:119], a[148:151]
ds_read_b64_tr_b16 v[180:181], v22 offset:49152
v_mfma_f32_16x16x32_bf16 a[152:155], v[80:83], v[120:123], a[152:155]
v_mfma_f32_16x16x32_bf16 a[156:159], v[80:83], v[124:127], a[156:159]
ds_read_b64_tr_b16 v[182:183], v22 offset:51200
v_mfma_f32_16x16x32_bf16 a[160:163], v[84:87], v[96:99], a[160:163]
v_mfma_f32_16x16x32_bf16 a[164:167], v[84:87], v[100:103], a[164:167]
ds_read_b128 v[152:155], v10 offset:45056
v_mfma_f32_16x16x32_bf16 a[168:171], v[84:87], v[104:107], a[168:171]
s_add_u32 s66, s66, 262144
v_mfma_f32_16x16x32_bf16 a[172:175], v[84:87], v[108:111], a[172:175]
ds_read_b64_tr_b16 v[184:185], v23 offset:49152
v_mfma_f32_16x16x32_bf16 a[176:179], v[84:87], v[112:115], a[176:179]
v_mfma_f32_16x16x32_bf16 a[180:183], v[84:87], v[116:119], a[180:183]
v_mfma_f32_16x16x32_bf16 a[184:187], v[84:87], v[120:123], a[184:187]
ds_read_b64_tr_b16 v[186:187], v23 offset:51200
v_mfma_f32_16x16x32_bf16 a[188:191], v[84:87], v[124:127], a[188:191]
v_mfma_f32_16x16x32_bf16 a[192:195], v[88:91], v[96:99], a[192:195]
ds_read_b128 v[156:159], v10 offset:46080
v_mfma_f32_16x16x32_bf16 a[196:199], v[88:91], v[100:103], a[196:199]
v_mfma_f32_16x16x32_bf16 a[200:203], v[88:91], v[104:107], a[200:203]
ds_read_b64_tr_b16 v[188:189], v24 offset:49152
v_mfma_f32_16x16x32_bf16 a[204:207], v[88:91], v[108:111], a[204:207]
buffer_load_dwordx4 v[32:35], v25, s[20:23], 0 offen
buffer_load_dwordx4 v[36:39], v25, s[20:23], 0 offen offset:16
v_mfma_f32_16x16x32_bf16 a[208:211], v[88:91], v[112:115], a[208:211]
ds_read_b64_tr_b16 v[190:191], v24 offset:51200
buffer_load_dword v248, v247, s[28:31], 0 offen
v_mfma_f32_16x16x32_bf16 a[212:215], v[88:91], v[116:119], a[212:215]
v_mfma_f32_16x16x32_bf16 a[216:219], v[88:91], v[120:123], a[216:219]
v_mfma_f32_16x16x32_bf16 a[220:223], v[88:91], v[124:127], a[220:223]
v_mfma_f32_16x16x32_bf16 a[224:227], v[92:95], v[96:99], a[224:227]
v_mfma_f32_16x16x32_bf16 a[228:231], v[92:95], v[100:103], a[228:231]
v_mfma_f32_16x16x32_bf16 a[232:235], v[92:95], v[104:107], a[232:235]
v_mfma_f32_16x16x32_bf16 a[236:239], v[92:95], v[108:111], a[236:239]
v_mfma_f32_16x16x32_bf16 a[240:243], v[92:95], v[112:115], a[240:243]
v_mfma_f32_16x16x32_bf16 a[244:247], v[92:95], v[116:119], a[244:247]
v_mfma_f32_16x16x32_bf16 a[248:251], v[92:95], v[120:123], a[248:251]
v_mfma_f32_16x16x32_bf16 a[252:255], v[92:95], v[124:127], a[252:255]
s_waitcnt lgkmcnt(0)
v_mfma_f32_16x16x32_bf16 a[0:3], v[128:131], v[160:163], a[0:3]
s_waitcnt vmcnt(11)
s_barrier
v_mfma_f32_16x16x32_bf16 a[4:7], v[128:131], v[164:167], a[4:7]
ds_read_b128 v[64:67], v16
v_mfma_f32_16x16x32_bf16 a[8:11], v[128:131], v[168:171], a[8:11]
s_add_u32 m0, s63, 32768
v_mfma_f32_16x16x32_bf16 a[12:15], v[128:131], v[172:175], a[12:15]
ds_read_b64_tr_b16 v[96:97], v17
s_add_u32 s62, s65, 0
v_mfma_f32_16x16x32_bf16 a[16:19], v[128:131], v[176:179], a[16:19]
v_mfma_f32_16x16x32_bf16 a[20:23], v[128:131], v[180:183], a[20:23]
ds_read_b64_tr_b16 v[98:99], v17 offset:2048
buffer_load_dwordx4 v8, s[8:11], s62 offen lds
v_mfma_f32_16x16x32_bf16 a[24:27], v[128:131], v[184:187], a[24:27]
v_mfma_f32_16x16x32_bf16 a[28:31], v[128:131], v[188:191], a[28:31]
ds_read_b128 v[68:71], v16 offset:1024
s_add_u32 s62, s65, 15360
v_mfma_f32_16x16x32_bf16 a[32:35], v[132:135], v[160:163], a[32:35]
v_mfma_f32_16x16x32_bf16 a[36:39], v[132:135], v[164:167], a[36:39]
buffer_load_dwordx4 v8, s[8:11], s62 offen offset:1024 lds
v_mfma_f32_16x16x32_bf16 a[40:43], v[132:135], v[168:171], a[40:43]
ds_read_b64_tr_b16 v[100:101], v18
v_mfma_f32_16x16x32_bf16 a[44:47], v[132:135], v[172:175], a[44:47]
s_add_u32 s62, s65, 30720
v_mfma_f32_16x16x32_bf16 a[48:51], v[132:135], v[176:179], a[48:51]
ds_read_b64_tr_b16 v[102:103], v18 offset:2048
buffer_load_dwordx4 v9, s[8:11], s62 offen offset:2048 lds
v_mfma_f32_16x16x32_bf16 a[52:55], v[132:135], v[180:183], a[52:55]
v_mfma_f32_16x16x32_bf16 a[56:59], v[132:135], v[184:187], a[56:59]
ds_read_b128 v[72:75], v16 offset:4096
s_add_u32 s62, s65, 46080
v_mfma_f32_16x16x32_bf16 a[60:63], v[132:135], v[188:191], a[60:63]
v_mfma_f32_16x16x32_bf16 a[64:67], v[136:139], v[160:163], a[64:67]
ds_read_b64_tr_b16 v[104:105], v19
buffer_load_dwordx4 v9, s[8:11], s62 offen offset:3072 lds
v_mfma_f32_16x16x32_bf16 a[68:71], v[136:139], v[164:167], a[68:71]
v_mfma_f32_16x16x32_bf16 a[72:75], v[136:139], v[168:171], a[72:75]
s_add_u32 m0, s63, 36864
v_mfma_f32_16x16x32_bf16 a[76:79], v[136:139], v[172:175], a[76:79]
ds_read_b64_tr_b16 v[106:107], v19 offset:2048
v_mfma_f32_16x16x32_bf16 a[80:83], v[136:139], v[176:179], a[80:83]
s_add_u32 s62, s65, 65536
v_mfma_f32_16x16x32_bf16 a[84:87], v[136:139], v[180:183], a[84:87]
ds_read_b128 v[76:79], v16 offset:5120
buffer_load_dwordx4 v8, s[8:11], s62 offen lds
v_mfma_f32_16x16x32_bf16 a[88:91], v[136:139], v[184:187], a[88:91]
v_mfma_f32_16x16x32_bf16 a[92:95], v[136:139], v[188:191], a[92:95]
ds_read_b64_tr_b16 v[108:109], v20
s_add_u32 s62, s65, 80896
v_mfma_f32_16x16x32_bf16 a[96:99], v[140:143], v[160:163], a[96:99]
v_mfma_f32_16x16x32_bf16 a[100:103], v[140:143], v[164:167], a[100:103]
ds_read_b64_tr_b16 v[110:111], v20 offset:2048
buffer_load_dwordx4 v8, s[8:11], s62 offen offset:1024 lds
v_mfma_f32_16x16x32_bf16 a[104:107], v[140:143], v[168:171], a[104:107]
v_mfma_f32_16x16x32_bf16 a[108:111], v[140:143], v[172:175], a[108:111]
s_add_u32 s62, s65, 96256
v_mfma_f32_16x16x32_bf16 a[112:115], v[140:143], v[176:179], a[112:115]
ds_read_b128 v[80:83], v16 offset:8192
v_mfma_f32_16x16x32_bf16 a[116:119], v[140:143], v[180:183], a[116:119]
buffer_load_dwordx4 v9, s[8:11], s62 offen offset:2048 lds
v_mfma_f32_16x16x32_bf16 a[120:123], v[140:143], v[184:187], a[120:123]
ds_read_b64_tr_b16 v[112:113], v21
s_add_u32 s62, s65, 111616
v_mfma_f32_16x16x32_bf16 a[124:127], v[140:143], v[188:191], a[124:127]
v_mfma_f32_16x16x32_bf16 a[128:131], v[144:147], v[160:163], a[128:131]
ds_read_b64_tr_b16 v[114:115], v21 offset:2048
buffer_load_dwordx4 v9, s[8:11], s62 offen offset:3072 lds
v_mfma_f32_16x16x32_bf16 a[132:135], v[144:147], v[164:167], a[132:135]
v_mfma_f32_16x16x32_bf16 a[136:139], v[144:147], v[168:171], a[136:139]
ds_read_b128 v[84:87], v16 offset:9216
s_add_u32 s65, s65, 128
v_mfma_f32_16x16x32_bf16 a[140:143], v[144:147], v[172:175], a[140:143]
v_mfma_f32_16x16x32_bf16 a[144:147], v[144:147], v[176:179], a[144:147]
s_add_u32 m0, s64, 114688
v_mfma_f32_16x16x32_bf16 a[148:151], v[144:147], v[180:183], a[148:151]
ds_read_b64_tr_b16 v[116:117], v22
v_mfma_f32_16x16x32_bf16 a[152:155], v[144:147], v[184:187], a[152:155]
s_nop 0
v_mfma_f32_16x16x32_bf16 a[156:159], v[144:147], v[188:191], a[156:159]
ds_read_b64_tr_b16 v[118:119], v22 offset:2048
buffer_load_dwordx4 v12, s[12:15], s66 offen lds
v_mfma_f32_16x16x32_bf16 a[160:163], v[148:151], v[160:163], a[160:163]
v_mfma_f32_16x16x32_bf16 a[164:167], v[148:151], v[164:167], a[164:167]
ds_read_b128 v[88:91], v16 offset:12288
buffer_load_dwordx4 v13, s[12:15], s66 offen offset:1024 lds
v_mfma_f32_16x16x32_bf16 a[168:171], v[148:151], v[168:171], a[168:171]
v_mfma_f32_16x16x32_bf16 a[172:175], v[148:151], v[172:175], a[172:175]
ds_read_b64_tr_b16 v[120:121], v23
buffer_load_dwordx4 v14, s[12:15], s66 offen offset:2048 lds
v_mfma_f32_16x16x32_bf16 a[176:179], v[148:151], v[176:179], a[176:179]
v_mfma_f32_16x16x32_bf16 a[180:183], v[148:151], v[180:183], a[180:183]
buffer_load_dwordx4 v15, s[12:15], s66 offen offset:3072 lds
v_mfma_f32_16x16x32_bf16 a[184:187], v[148:151], v[184:187], a[184:187]
ds_read_b64_tr_b16 v[122:123], v23 offset:2048
v_mfma_f32_16x16x32_bf16 a[188:191], v[148:151], v[188:191], a[188:191]
s_add_u32 s66, s66, 262144
v_mfma_f32_16x16x32_bf16 a[192:195], v[152:155], v[160:163], a[192:195]
ds_read_b128 v[92:95], v16 offset:13312
v_mfma_f32_16x16x32_bf16 a[196:199], v[152:155], v[164:167], a[196:199]
v_mfma_f32_16x16x32_bf16 a[200:203], v[152:155], v[168:171], a[200:203]
ds_read_b64_tr_b16 v[124:125], v24
v_add_u32 v242, 0x100000, v242
global_load_dword v245, v242, s[98:99]
v_mfma_f32_16x16x32_bf16 a[204:207], v[152:155], v[172:175], a[204:207]
v_mfma_f32_16x16x32_bf16 a[208:211], v[152:155], v[176:179], a[208:211]
ds_read_b64_tr_b16 v[126:127], v24 offset:2048
v_mfma_f32_16x16x32_bf16 a[212:215], v[152:155], v[180:183], a[212:215]
v_mfma_f32_16x16x32_bf16 a[216:219], v[152:155], v[184:187], a[216:219]
v_mfma_f32_16x16x32_bf16 a[220:223], v[152:155], v[188:191], a[220:223]
v_mfma_f32_16x16x32_bf16 a[224:227], v[156:159], v[160:163], a[224:227]
v_mfma_f32_16x16x32_bf16 a[228:231], v[156:159], v[164:167], a[228:231]
v_mfma_f32_16x16x32_bf16 a[232:235], v[156:159], v[168:171], a[232:235]
v_mfma_f32_16x16x32_bf16 a[236:239], v[156:159], v[172:175], a[236:239]
v_mfma_f32_16x16x32_bf16 a[240:243], v[156:159], v[176:179], a[240:243]
v_mfma_f32_16x16x32_bf16 a[244:247], v[156:159], v[180:183], a[244:247]
v_mfma_f32_16x16x32_bf16 a[248:251], v[156:159], v[184:187], a[248:251]
v_mfma_f32_16x16x32_bf16 a[252:255], v[156:159], v[188:191], a[252:255]
s_waitcnt lgkmcnt(0)
v_mfma_f32_16x16x32_bf16 a[0:3], v[64:67], v[96:99], a[0:3]
s_waitcnt vmcnt(20)
s_barrier
v_mfma_f32_16x16x32_bf16 a[4:7], v[64:67], v[100:103], a[4:7]
ds_read_b128 v[128:131], v10
v_mfma_f32_16x16x32_bf16 a[8:11], v[64:67], v[104:107], a[8:11]
s_add_u32 m0, s64, 65536
v_mfma_f32_16x16x32_bf16 a[12:15], v[64:67], v[108:111], a[12:15]
ds_read_b64_tr_b16 v[160:161], v17 offset:16384
v_mfma_f32_16x16x32_bf16 a[16:19], v[64:67], v[112:115], a[16:19]
v_mfma_f32_16x16x32_bf16 a[20:23], v[64:67], v[116:119], a[20:23]
ds_read_b64_tr_b16 v[162:163], v17 offset:18432
v_mfma_f32_16x16x32_bf16 a[24:27], v[64:67], v[120:123], a[24:27]
v_mfma_f32_16x16x32_bf16 a[28:31], v[64:67], v[124:127], a[28:31]
ds_read_b128 v[132:135], v10 offset:1024
v_mfma_f32_16x16x32_bf16 a[32:35], v[68:71], v[96:99], a[32:35]
s_nop 0
v_mfma_f32_16x16x32_bf16 a[36:39], v[68:71], v[100:103], a[36:39]
v_mfma_f32_16x16x32_bf16 a[40:43], v[68:71], v[104:107], a[40:43]
ds_read_b64_tr_b16 v[164:165], v18 offset:16384
v_mfma_f32_16x16x32_bf16 a[44:47], v[68:71], v[108:111], a[44:47]
v_mfma_f32_16x16x32_bf16 a[48:51], v[68:71], v[112:115], a[48:51]
ds_read_b64_tr_b16 v[166:167], v18 offset:18432
v_mfma_f32_16x16x32_bf16 a[52:55], v[68:71], v[116:119], a[52:55]
v_mfma_f32_16x16x32_bf16 a[56:59], v[68:71], v[120:123], a[56:59]
ds_read_b128 v[136:139], v10 offset:4096
v_mfma_f32_16x16x32_bf16 a[60:63], v[68:71], v[124:127], a[60:63]
buffer_load_dwordx4 v12, s[12:15], s66 offen lds
v_mfma_f32_16x16x32_bf16 a[64:67], v[72:75], v[96:99], a[64:67]
ds_read_b64_tr_b16 v[168:169], v19 offset:16384
v_mfma_f32_16x16x32_bf16 a[68:71], v[72:75], v[100:103], a[68:71]
v_mfma_f32_16x16x32_bf16 a[72:75], v[72:75], v[104:107], a[72:75]
v_mfma_f32_16x16x32_bf16 a[76:79], v[72:75], v[108:111], a[76:79]
ds_read_b64_tr_b16 v[170:171], v19 offset:18432
v_mfma_f32_16x16x32_bf16 a[80:83], v[72:75], v[112:115], a[80:83]
v_mfma_f32_16x16x32_bf16 a[84:87], v[72:75], v[116:119], a[84:87]
ds_read_b128 v[140:143], v10 offset:5120
v_mfma_f32_16x16x32_bf16 a[88:91], v[72:75], v[120:123], a[88:91]
buffer_load_dwordx4 v13, s[12:15], s66 offen offset:1024 lds
v_mfma_f32_16x16x32_bf16 a[92:95], v[72:75], v[124:127], a[92:95]
ds_read_b64_tr_b16 v[172:173], v20 offset:16384
v_mfma_f32_16x16x32_bf16 a[96:99], v[76:79], v[96:99], a[96:99]
v_mfma_f32_16x16x32_bf16 a[100:103], v[76:79], v[100:103], a[100:103]
ds_read_b64_tr_b16 v[174:175], v20 offset:18432
v_mfma_f32_16x16x32_bf16 a[104:107], v[76:79], v[104:107], a[104:107]
v_mfma_f32_16x16x32_bf16 a[108:111], v[76:79], v[108:111], a[108:111]
v_mfma_f32_16x16x32_bf16 a[112:115], v[76:79], v[112:115], a[112:115]
ds_read_b128 v[144:147], v10 offset:8192
buffer_load_dwordx4 v14, s[12:15], s66 offen offset:2048 lds
v_mfma_f32_16x16x32_bf16 a[116:119], v[76:79], v[116:119], a[116:119]
v_mfma_f32_16x16x32_bf16 a[120:123], v[76:79], v[120:123], a[120:123]
ds_read_b64_tr_b16 v[176:177], v21 offset:16384
v_mfma_f32_16x16x32_bf16 a[124:127], v[76:79], v[124:127], a[124:127]
v_mfma_f32_16x16x32_bf16 a[128:131], v[80:83], v[96:99], a[128:131]
ds_read_b64_tr_b16 v[178:179], v21 offset:18432
v_mfma_f32_16x16x32_bf16 a[132:135], v[80:83], v[100:103], a[132:135]
v_mfma_f32_16x16x32_bf16 a[136:139], v[80:83], v[104:107], a[136:139]
ds_read_b128 v[148:151], v10 offset:9216
v_mfma_f32_16x16x32_bf16 a[140:143], v[80:83], v[108:111], a[140:143]
buffer_load_dwordx4 v15, s[12:15], s66 offen offset:3072 lds
v_mfma_f32_16x16x32_bf16 a[144:147], v[80:83], v[112:115], a[144:147]
v_mfma_f32_16x16x32_bf16 a[148:151], v[80:83], v[116:119], a[148:151]
ds_read_b64_tr_b16 v[180:181], v22 offset:16384
v_mfma_f32_16x16x32_bf16 a[152:155], v[80:83], v[120:123], a[152:155]
v_mfma_f32_16x16x32_bf16 a[156:159], v[80:83], v[124:127], a[156:159]
ds_read_b64_tr_b16 v[182:183], v22 offset:18432
v_mfma_f32_16x16x32_bf16 a[160:163], v[84:87], v[96:99], a[160:163]
v_mfma_f32_16x16x32_bf16 a[164:167], v[84:87], v[100:103], a[164:167]
ds_read_b128 v[152:155], v10 offset:12288
v_mfma_f32_16x16x32_bf16 a[168:171], v[84:87], v[104:107], a[168:171]
s_add_u32 s66, s66, 262144
v_mfma_f32_16x16x32_bf16 a[172:175], v[84:87], v[108:111], a[172:175]
ds_read_b64_tr_b16 v[184:185], v23 offset:16384
v_mfma_f32_16x16x32_bf16 a[176:179], v[84:87], v[112:115], a[176:179]
v_mfma_f32_16x16x32_bf16 a[180:183], v[84:87], v[116:119], a[180:183]
v_mfma_f32_16x16x32_bf16 a[184:187], v[84:87], v[120:123], a[184:187]
ds_read_b64_tr_b16 v[186:187], v23 offset:18432
v_mfma_f32_16x16x32_bf16 a[188:191], v[84:87], v[124:127], a[188:191]
v_mfma_f32_16x16x32_bf16 a[192:195], v[88:91], v[96:99], a[192:195]
ds_read_b128 v[156:159], v10 offset:13312
v_mfma_f32_16x16x32_bf16 a[196:199], v[88:91], v[100:103], a[196:199]
v_mfma_f32_16x16x32_bf16 a[200:203], v[88:91], v[104:107], a[200:203]
ds_read_b64_tr_b16 v[188:189], v24 offset:16384
v_mfma_f32_16x16x32_bf16 a[204:207], v[88:91], v[108:111], a[204:207]
v_mfma_f32_16x16x32_bf16 a[208:211], v[88:91], v[112:115], a[208:211]
ds_read_b64_tr_b16 v[190:191], v24 offset:18432
buffer_load_dword v248, v247, s[28:31], 0 offen offset:2048
v_mfma_f32_16x16x32_bf16 a[212:215], v[88:91], v[116:119], a[212:215]
v_mfma_f32_16x16x32_bf16 a[216:219], v[88:91], v[120:123], a[216:219]
v_mfma_f32_16x16x32_bf16 a[220:223], v[88:91], v[124:127], a[220:223]
v_mfma_f32_16x16x32_bf16 a[224:227], v[92:95], v[96:99], a[224:227]
v_mfma_f32_16x16x32_bf16 a[228:231], v[92:95], v[100:103], a[228:231]
v_mfma_f32_16x16x32_bf16 a[232:235], v[92:95], v[104:107], a[232:235]
v_mfma_f32_16x16x32_bf16 a[236:239], v[92:95], v[108:111], a[236:239]
v_mfma_f32_16x16x32_bf16 a[240:243], v[92:95], v[112:115], a[240:243]
v_mfma_f32_16x16x32_bf16 a[244:247], v[92:95], v[116:119], a[244:247]
v_mfma_f32_16x16x32_bf16 a[248:251], v[92:95], v[120:123], a[248:251]
v_mfma_f32_16x16x32_bf16 a[252:255], v[92:95], v[124:127], a[252:255]
s_waitcnt lgkmcnt(0)
v_mfma_f32_16x16x32_bf16 a[0:3], v[128:131], v[160:163], a[0:3]
s_waitcnt vmcnt(10)
s_barrier
s_or_b32 s56, s2, s3
s_cbranch_scc1 RDBG_6
s_mov_b64 exec, 1
global_store_dword v29, v30, s[92:93] sc1
s_mov_b64 exec, -1
RDBG_6:
v_mfma_f32_16x16x32_bf16 a[4:7], v[128:131], v[164:167], a[4:7]
ds_read_b128 v[64:67], v16 offset:32768
s_waitcnt vmcnt(19)
v_mfma_f32_16x16x32_bf16 a[8:11], v[128:131], v[168:171], a[8:11]
s_add_u32 m0, s63, 0
v_lshlrev_b32 v40, 16, v32
v_mfma_f32_16x16x32_bf16 a[12:15], v[128:131], v[172:175], a[12:15]
ds_read_b64_tr_b16 v[96:97], v17 offset:32768
s_add_u32 s62, s65, 0
v_mfma_f32_16x16x32_bf16 a[16:19], v[128:131], v[176:179], a[16:19]
v_and_b32 v41, 0xffff0000, v32
v_lshlrev_b32 v42, 16, v33
v_mfma_f32_16x16x32_bf16 a[20:23], v[128:131], v[180:183], a[20:23]
ds_read_b64_tr_b16 v[98:99], v17 offset:34816
buffer_load_dwordx4 v8, s[8:11], s62 offen lds
v_mfma_f32_16x16x32_bf16 a[24:27], v[128:131], v[184:187], a[24:27]
v_and_b32 v43, 0xffff0000, v33
v_lshlrev_b32 v44, 16, v34
v_mfma_f32_16x16x32_bf16 a[28:31], v[128:131], v[188:191], a[28:31]
ds_read_b128 v[68:71], v16 offset:33792
s_add_u32 s62, s65, 15360
v_mfma_f32_16x16x32_bf16 a[32:35], v[132:135], v[160:163], a[32:35]
v_and_b32 v45, 0xffff0000, v34
v_lshlrev_b32 v46, 16, v35
v_mfma_f32_16x16x32_bf16 a[36:39], v[132:135], v[164:167], a[36:39]
buffer_load_dwordx4 v8, s[8:11], s62 offen offset:1024 lds
v_and_b32 v47, 0xffff0000, v35
v_mfma_f32_16x16x32_bf16 a[40:43], v[132:135], v[168:171], a[40:43]
ds_read_b64_tr_b16 v[100:101], v18 offset:32768
v_lshlrev_b32 v48, 16, v36
v_mfma_f32_16x16x32_bf16 a[44:47], v[132:135], v[172:175], a[44:47]
s_add_u32 s62, s65, 30720
v_and_b32 v49, 0xffff0000, v36
v_mfma_f32_16x16x32_bf16 a[48:51], v[132:135], v[176:179], a[48:51]
ds_read_b64_tr_b16 v[102:103], v18 offset:34816
buffer_load_dwordx4 v9, s[8:11], s62 offen offset:2048 lds
v_mfma_f32_16x16x32_bf16 a[52:55], v[132:135], v[180:183], a[52:55]
v_lshlrev_b32 v50, 16, v37
v_and_b32 v51, 0xffff0000, v37
v_mfma_f32_16x16x32_bf16 a[56:59], v[132:135], v[184:187], a[56:59]
ds_read_b128 v[72:75], v16 offset:36864
s_add_u32 s62, s65, 46080
v_mfma_f32_16x16x32_bf16 a[60:63], v[132:135], v[188:191], a[60:63]
v_lshlrev_b32 v52, 16, v38
v_and_b32 v53, 0xffff0000, v38
v_mfma_f32_16x16x32_bf16 a[64:67], v[136:139], v[160:163], a[64:67]
ds_read_b64_tr_b16 v[104:105], v19 offset:32768
buffer_load_dwordx4 v9, s[8:11], s62 offen offset:3072 lds
v_mfma_f32_16x16x32_bf16 a[68:71], v[136:139], v[164:167], a[68:71]
v_lshlrev_b32 v54, 16, v39
v_and_b32 v55, 0xffff0000, v39
v_mfma_f32_16x16x32_bf16 a[72:75], v[136:139], v[168:171], a[72:75]
s_add_u32 m0, s63, 4096
v_add_f32 v56, v40, v41
v_mfma_f32_16x16x32_bf16 a[76:79], v[136:139], v[172:175], a[76:79]
ds_read_b64_tr_b16 v[106:107], v19 offset:34816
v_add_f32 v56, v56, v42
v_mfma_f32_16x16x32_bf16 a[80:83], v[136:139], v[176:179], a[80:83]
s_add_u32 s62, s65, 65536
v_add_f32 v56, v56, v43
v_mfma_f32_16x16x32_bf16 a[84:87], v[136:139], v[180:183], a[84:87]
ds_read_b128 v[76:79], v16 offset:37888
buffer_load_dwordx4 v8, s[8:11], s62 offen lds
v_mfma_f32_16x16x32_bf16 a[88:91], v[136:139], v[184:187], a[88:91]
v_add_f32 v56, v56, v44
v_add_f32 v56, v56, v45
v_mfma_f32_16x16x32_bf16 a[92:95], v[136:139], v[188:191], a[92:95]
ds_read_b64_tr_b16 v[108:109], v20 offset:32768
s_add_u32 s62, s65, 80896
v_mfma_f32_16x16x32_bf16 a[96:99], v[140:143], v[160:163], a[96:99]
v_add_f32 v56, v56, v46
v_add_f32 v56, v56, v47
v_mfma_f32_16x16x32_bf16 a[100:103], v[140:143], v[164:167], a[100:103]
ds_read_b64_tr_b16 v[110:111], v20 offset:34816
buffer_load_dwordx4 v8, s[8:11], s62 offen offset:1024 lds
v_mfma_f32_16x16x32_bf16 a[104:107], v[140:143], v[168:171], a[104:107]
v_add_f32 v56, v56, v48
v_add_f32 v56, v56, v49
v_mfma_f32_16x16x32_bf16 a[108:111], v[140:143], v[172:175], a[108:111]
s_add_u32 s62, s65, 96256
v_add_f32 v56, v56, v50
v_mfma_f32_16x16x32_bf16 a[112:115], v[140:143], v[176:179], a[112:115]
ds_read_b128 v[80:83], v16 offset:40960
v_add_f32 v56, v56, v51
v_mfma_f32_16x16x32_bf16 a[116:119], v[140:143], v[180:183], a[116:119]
buffer_load_dwordx4 v9, s[8:11], s62 offen offset:2048 lds
v_add_f32 v56, v56, v52
v_mfma_f32_16x16x32_bf16 a[120:123], v[140:143], v[184:187], a[120:123]
ds_read_b64_tr_b16 v[112:113], v21 offset:32768
s_add_u32 s62, s65, 111616
v_mfma_f32_16x16x32_bf16 a[124:127], v[140:143], v[188:191], a[124:127]
v_add_f32 v56, v56, v53
v_add_f32 v56, v56, v54
v_mfma_f32_16x16x32_bf16 a[128:131], v[144:147], v[160:163], a[128:131]
ds_read_b64_tr_b16 v[114:115], v21 offset:34816
buffer_load_dwordx4 v9, s[8:11], s62 offen offset:3072 lds
v_mfma_f32_16x16x32_bf16 a[132:135], v[144:147], v[164:167], a[132:135]
v_add_f32 v56, v56, v55
s_nop 1
v_mfma_f32_16x16x32_bf16 a[136:139], v[144:147], v[168:171], a[136:139]
ds_read_b128 v[84:87], v16 offset:41984
s_add_u32 s65, s65, 128
v_mfma_f32_16x16x32_bf16 a[140:143], v[144:147], v[172:175], a[140:143]
v_add_f32_dpp v56, v56, v56 quad_perm:[1,0,3,2] row_mask:0xf bank_mask:0xf
s_nop 1
v_mfma_f32_16x16x32_bf16 a[144:147], v[144:147], v[176:179], a[144:147]
s_add_u32 m0, s64, 81920
v_add_f32_dpp v56, v56, v56 quad_perm:[2,3,0,1] row_mask:0xf bank_mask:0xf
v_mfma_f32_16x16x32_bf16 a[148:151], v[144:147], v[180:183], a[148:151]
ds_read_b64_tr_b16 v[116:117], v22 offset:32768
s_nop 1
v_mfma_f32_16x16x32_bf16 a[152:155], v[144:147], v[184:187], a[152:155]
s_nop 0
v_add_f32_dpp v56, v56, v56 row_half_mirror row_mask:0xf bank_mask:0xf
v_mfma_f32_16x16x32_bf16 a[156:159], v[144:147], v[188:191], a[156:159]
ds_read_b64_tr_b16 v[118:119], v22 offset:34816
buffer_load_dwordx4 v12, s[12:15], s66 offen lds
v_mfma_f32_16x16x32_bf16 a[160:163], v[148:151], v[160:163], a[160:163]
s_nop 1
v_add_f32_dpp v56, v56, v56 row_mirror row_mask:0xf bank_mask:0xf
v_mfma_f32_16x16x32_bf16 a[164:167], v[148:151], v[164:167], a[164:167]
ds_read_b128 v[88:91], v16 offset:45056
buffer_load_dwordx4 v13, s[12:15], s66 offen offset:1024 lds
v_mfma_f32_16x16x32_bf16 a[168:171], v[148:151], v[168:171], a[168:171]
v_mov_b32 v57, v56
s_nop 1
v_mfma_f32_16x16x32_bf16 a[172:175], v[148:151], v[172:175], a[172:175]
ds_read_b64_tr_b16 v[120:121], v23 offset:32768
buffer_load_dwordx4 v14, s[12:15], s66 offen offset:2048 lds
v_mfma_f32_16x16x32_bf16 a[176:179], v[148:151], v[176:179], a[176:179]
v_permlane16_swap_b32 v56, v57
v_add_f32 v56, v56, v57
v_mfma_f32_16x16x32_bf16 a[180:183], v[148:151], v[180:183], a[180:183]
buffer_load_dwordx4 v15, s[12:15], s66 offen offset:3072 lds
v_mul_f32 v56, 0x3b124925, v56
v_mfma_f32_16x16x32_bf16 a[184:187], v[148:151], v[184:187], a[184:187]
ds_read_b64_tr_b16 v[122:123], v23 offset:34816
v_mov_b32 v58, 0
v_mfma_f32_16x16x32_bf16 a[188:191], v[148:151], v[188:191], a[188:191]
s_add_u32 s66, s66, 262144
v_sub_f32 v57, v40, v56
v_mfma_f32_16x16x32_bf16 a[192:195], v[152:155], v[160:163], a[192:195]
ds_read_b128 v[92:95], v16 offset:46080
v_fmac_f32 v58, v57, v57
v_mfma_f32_16x16x32_bf16 a[196:199], v[152:155], v[164:167], a[196:199]
v_sub_f32 v57, v41, v56
v_fmac_f32 v58, v57, v57
v_mfma_f32_16x16x32_bf16 a[200:203], v[152:155], v[168:171], a[200:203]
ds_read_b64_tr_b16 v[124:125], v24 offset:32768
v_sub_f32 v57, v42, v56
v_mfma_f32_16x16x32_bf16 a[204:207], v[152:155], v[172:175], a[204:207]
v_fmac_f32 v58, v57, v57
v_sub_f32 v57, v43, v56
v_mfma_f32_16x16x32_bf16 a[208:211], v[152:155], v[176:179], a[208:211]
ds_read_b64_tr_b16 v[126:127], v24 offset:34816
v_fmac_f32 v58, v57, v57
v_mfma_f32_16x16x32_bf16 a[212:215], v[152:155], v[180:183], a[212:215]
v_sub_f32 v57, v44, v56
v_fmac_f32 v58, v57, v57
v_mfma_f32_16x16x32_bf16 a[216:219], v[152:155], v[184:187], a[216:219]
v_sub_f32 v57, v45, v56
v_fmac_f32 v58, v57, v57
v_mfma_f32_16x16x32_bf16 a[220:223], v[152:155], v[188:191], a[220:223]
v_sub_f32 v57, v46, v56
v_fmac_f32 v58, v57, v57
v_mfma_f32_16x16x32_bf16 a[224:227], v[156:159], v[160:163], a[224:227]
v_sub_f32 v57, v47, v56
v_fmac_f32 v58, v57, v57
v_mfma_f32_16x16x32_bf16 a[228:231], v[156:159], v[164:167], a[228:231]
v_sub_f32 v57, v48, v56
v_fmac_f32 v58, v57, v57
v_mfma_f32_16x16x32_bf16 a[232:235], v[156:159], v[168:171], a[232:235]
v_sub_f32 v57, v49, v56
v_fmac_f32 v58, v57, v57
v_mfma_f32_16x16x32_bf16 a[236:239], v[156:159], v[172:175], a[236:239]
v_sub_f32 v57, v50, v56
v_fmac_f32 v58, v57, v57
v_mfma_f32_16x16x32_bf16 a[240:243], v[156:159], v[176:179], a[240:243]
v_sub_f32 v57, v51, v56
v_fmac_f32 v58, v57, v57
v_mfma_f32_16x16x32_bf16 a[244:247], v[156:159], v[180:183], a[244:247]
v_sub_f32 v57, v52, v56
v_fmac_f32 v58, v57, v57
v_mfma_f32_16x16x32_bf16 a[248:251], v[156:159], v[184:187], a[248:251]
v_sub_f32 v57, v53, v56
v_fmac_f32 v58, v57, v57
v_mfma_f32_16x16x32_bf16 a[252:255], v[156:159], v[188:191], a[252:255]
v_sub_f32 v57, v54, v56
v_fmac_f32 v58, v57, v57
s_waitcnt lgkmcnt(0)
v_mfma_f32_16x16x32_bf16 a[0:3], v[64:67], v[96:99], a[0:3]
s_waitcnt vmcnt(18)
s_barrier
v_mfma_f32_16x16x32_bf16 a[4:7], v[64:67], v[100:103], a[4:7]
ds_read_b128 v[128:131], v10 offset:32768
v_sub_f32 v57, v55, v56
v_mfma_f32_16x16x32_bf16 a[8:11], v[64:67], v[104:107], a[8:11]
s_add_u32 m0, s64, 98304
v_fmac_f32 v58, v57, v57
v_mfma_f32_16x16x32_bf16 a[12:15], v[64:67], v[108:111], a[12:15]
ds_read_b64_tr_b16 v[160:161], v17 offset:49152
v_mul_f32 v58, v58, v7
v_mfma_f32_16x16x32_bf16 a[16:19], v[64:67], v[112:115], a[16:19]
s_nop 1
v_add_f32_dpp v58, v58, v58 quad_perm:[1,0,3,2] row_mask:0xf bank_mask:0xf
v_mfma_f32_16x16x32_bf16 a[20:23], v[64:67], v[116:119], a[20:23]
ds_read_b64_tr_b16 v[162:163], v17 offset:51200
s_nop 1
v_mfma_f32_16x16x32_bf16 a[24:27], v[64:67], v[120:123], a[24:27]
v_add_f32_dpp v58, v58, v58 quad_perm:[2,3,0,1] row_mask:0xf bank_mask:0xf
s_nop 1
v_mfma_f32_16x16x32_bf16 a[28:31], v[64:67], v[124:127], a[28:31]
ds_read_b128 v[132:135], v10 offset:33792
v_add_f32_dpp v58, v58, v58 row_half_mirror row_mask:0xf bank_mask:0xf
v_mfma_f32_16x16x32_bf16 a[32:35], v[68:71], v[96:99], a[32:35]
s_nop 0
s_nop 1
v_mfma_f32_16x16x32_bf16 a[36:39], v[68:71], v[100:103], a[36:39]
v_add_f32_dpp v58, v58, v58 row_mirror row_mask:0xf bank_mask:0xf
v_mov_b32 v57, v58
v_mfma_f32_16x16x32_bf16 a[40:43], v[68:71], v[104:107], a[40:43]
ds_read_b64_tr_b16 v[164:165], v18 offset:49152
s_nop 1
v_mfma_f32_16x16x32_bf16 a[44:47], v[68:71], v[108:111], a[44:47]
v_permlane16_swap_b32 v58, v57
v_add_f32 v58, v58, v57
v_mfma_f32_16x16x32_bf16 a[48:51], v[68:71], v[112:115], a[48:51]
ds_read_b64_tr_b16 v[166:167], v18 offset:51200
v_mul_f32 v58, 0x3b124925, v58
v_mfma_f32_16x16x32_bf16 a[52:55], v[68:71], v[116:119], a[52:55]
v_cvt_pk_bf16_f32 v56, v56, v56
v_lshlrev_b32 v56, 16, v56
v_mfma_f32_16x16x32_bf16 a[56:59], v[68:71], v[120:123], a[56:59]
ds_read_b128 v[136:139], v10 offset:36864
v_cvt_pk_bf16_f32 v58, v58, v58
v_mfma_f32_16x16x32_bf16 a[60:63], v[68:71], v[124:127], a[60:63]
buffer_load_dwordx4 v12, s[12:15], s66 offen lds
v_lshlrev_b32 v58, 16, v58
v_mfma_f32_16x16x32_bf16 a[64:67], v[72:75], v[96:99], a[64:67]
ds_read_b64_tr_b16 v[168:169], v19 offset:49152
v_add_f32 v58, 0x3727c5ac, v58
v_mfma_f32_16x16x32_bf16 a[68:71], v[72:75], v[100:103], a[68:71]
v_cvt_pk_bf16_f32 v58, v58, v58
v_lshlrev_b32 v58, 16, v58
v_mfma_f32_16x16x32_bf16 a[72:75], v[72:75], v[104:107], a[72:75]
v_sqrt_f32 v58, v58
v_mfma_f32_16x16x32_bf16 a[76:79], v[72:75], v[108:111], a[76:79]
ds_read_b64_tr_b16 v[170:171], v19 offset:51200
s_nop 0
v_mfma_f32_16x16x32_bf16 a[80:83], v[72:75], v[112:115], a[80:83]
v_cvt_pk_bf16_f32 v58, v58, v58
v_lshlrev_b32 v58, 16, v58
v_mfma_f32_16x16x32_bf16 a[84:87], v[72:75], v[116:119], a[84:87]
ds_read_b128 v[140:143], v10 offset:37888
v_rcp_f32 v58, v58
v_mfma_f32_16x16x32_bf16 a[88:91], v[72:75], v[120:123], a[88:91]
buffer_load_dwordx4 v13, s[12:15], s66 offen offset:1024 lds
v_sub_f32 v40, v40, v56
v_mfma_f32_16x16x32_bf16 a[92:95], v[72:75], v[124:127], a[92:95]
ds_read_b64_tr_b16 v[172:173], v20 offset:49152
v_sub_f32 v41, v41, v56
v_mfma_f32_16x16x32_bf16 a[96:99], v[76:79], v[96:99], a[96:99]
v_sub_f32 v42, v42, v56
v_sub_f32 v43, v43, v56
v_mfma_f32_16x16x32_bf16 a[100:103], v[76:79], v[100:103], a[100:103]
ds_read_b64_tr_b16 v[174:175], v20 offset:51200
v_sub_f32 v44, v44, v56
v_mfma_f32_16x16x32_bf16 a[104:107], v[76:79], v[104:107], a[104:107]
v_sub_f32 v45, v45, v56
v_sub_f32 v46, v46, v56
v_mfma_f32_16x16x32_bf16 a[108:111], v[76:79], v[108:111], a[108:111]
v_sub_f32 v47, v47, v56
v_sub_f32 v48, v48, v56
v_mfma_f32_16x16x32_bf16 a[112:115], v[76:79], v[112:115], a[112:115]
ds_read_b128 v[144:147], v10 offset:40960
buffer_load_dwordx4 v14, s[12:15], s66 offen offset:2048 lds
v_mfma_f32_16x16x32_bf16 a[116:119], v[76:79], v[116:119], a[116:119]
v_sub_f32 v49, v49, v56
v_sub_f32 v50, v50, v56
v_mfma_f32_16x16x32_bf16 a[120:123], v[76:79], v[120:123], a[120:123]
ds_read_b64_tr_b16 v[176:177], v21 offset:49152
v_sub_f32 v51, v51, v56
v_mfma_f32_16x16x32_bf16 a[124:127], v[76:79], v[124:127], a[124:127]
v_sub_f32 v52, v52, v56
v_sub_f32 v53, v53, v56
v_mfma_f32_16x16x32_bf16 a[128:131], v[80:83], v[96:99], a[128:131]
ds_read_b64_tr_b16 v[178:179], v21 offset:51200
v_sub_f32 v54, v54, v56
v_mfma_f32_16x16x32_bf16 a[132:135], v[80:83], v[100:103], a[132:135]
v_sub_f32 v55, v55, v56
v_cvt_pk_bf16_f32 v32, v40, v41
v_mfma_f32_16x16x32_bf16 a[136:139], v[80:83], v[104:107], a[136:139]
ds_read_b128 v[148:151], v10 offset:41984
v_cvt_pk_bf16_f32 v33, v42, v43
v_mfma_f32_16x16x32_bf16 a[140:143], v[80:83], v[108:111], a[140:143]
buffer_load_dwordx4 v15, s[12:15], s66 offen offset:3072 lds
v_cvt_pk_bf16_f32 v34, v44, v45
v_mfma_f32_16x16x32_bf16 a[144:147], v[80:83], v[112:115], a[144:147]
v_cvt_pk_bf16_f32 v35, v46, v47
v_cvt_pk_bf16_f32 v36, v48, v49
v_mfma_f32_16x16x32_bf16 a[148:151], v[80:83], v[116:119], a[148:151]
ds_read_b64_tr_b16 v[180:181], v22 offset:49152
v_cvt_pk_bf16_f32 v37, v50, v51
v_mfma_f32_16x16x32_bf16 a[152:155], v[80:83], v[120:123], a[152:155]
v_cvt_pk_bf16_f32 v38, v52, v53
v_cvt_pk_bf16_f32 v39, v54, v55
v_mfma_f32_16x16x32_bf16 a[156:159], v[80:83], v[124:127], a[156:159]
ds_read_b64_tr_b16 v[182:183], v22 offset:51200
v_lshlrev_b32 v40, 16, v32
v_mfma_f32_16x16x32_bf16 a[160:163], v[84:87], v[96:99], a[160:163]
v_and_b32 v41, 0xffff0000, v32
v_lshlrev_b32 v42, 16, v33
v_mfma_f32_16x16x32_bf16 a[164:167], v[84:87], v[100:103], a[164:167]
ds_read_b128 v[152:155], v10 offset:45056
v_and_b32 v43, 0xffff0000, v33
v_mfma_f32_16x16x32_bf16 a[168:171], v[84:87], v[104:107], a[168:171]
s_add_u32 s66, s66, 262144
v_lshlrev_b32 v44, 16, v34
v_mfma_f32_16x16x32_bf16 a[172:175], v[84:87], v[108:111], a[172:175]
ds_read_b64_tr_b16 v[184:185], v23 offset:49152
v_and_b32 v45, 0xffff0000, v34
v_mfma_f32_16x16x32_bf16 a[176:179], v[84:87], v[112:115], a[176:179]
v_lshlrev_b32 v46, 16, v35
v_and_b32 v47, 0xffff0000, v35
v_mfma_f32_16x16x32_bf16 a[180:183], v[84:87], v[116:119], a[180:183]
v_lshlrev_b32 v48, 16, v36
v_and_b32 v49, 0xffff0000, v36
v_mfma_f32_16x16x32_bf16 a[184:187], v[84:87], v[120:123], a[184:187]
ds_read_b64_tr_b16 v[186:187], v23 offset:51200
v_lshlrev_b32 v50, 16, v37
v_mfma_f32_16x16x32_bf16 a[188:191], v[84:87], v[124:127], a[188:191]
v_and_b32 v51, 0xffff0000, v37
v_lshlrev_b32 v52, 16, v38
v_mfma_f32_16x16x32_bf16 a[192:195], v[88:91], v[96:99], a[192:195]
ds_read_b128 v[156:159], v10 offset:46080
v_and_b32 v53, 0xffff0000, v38
v_mfma_f32_16x16x32_bf16 a[196:199], v[88:91], v[100:103], a[196:199]
v_lshlrev_b32 v54, 16, v39
v_and_b32 v55, 0xffff0000, v39
v_mfma_f32_16x16x32_bf16 a[200:203], v[88:91], v[104:107], a[200:203]
ds_read_b64_tr_b16 v[188:189], v24 offset:49152
v_add_u32 v242, 0x100000, v242
global_load_dword v245, v242, s[98:99]
v_mfma_f32_16x16x32_bf16 a[204:207], v[88:91], v[108:111], a[204:207]
v_mul_f32 v40, v40, v58
v_mul_f32 v41, v41, v58
v_mfma_f32_16x16x32_bf16 a[208:211], v[88:91], v[112:115], a[208:211]
ds_read_b64_tr_b16 v[190:191], v24 offset:51200
v_mul_f32 v42, v42, v58
v_mfma_f32_16x16x32_bf16 a[212:215], v[88:91], v[116:119], a[212:215]
v_mul_f32 v43, v43, v58
v_mul_f32 v44, v44, v58
v_mfma_f32_16x16x32_bf16 a[216:219], v[88:91], v[120:123], a[216:219]
v_mul_f32 v45, v45, v58
v_mul_f32 v46, v46, v58
v_mfma_f32_16x16x32_bf16 a[220:223], v[88:91], v[124:127], a[220:223]
v_mul_f32 v47, v47, v58
v_mul_f32 v48, v48, v58
v_mfma_f32_16x16x32_bf16 a[224:227], v[92:95], v[96:99], a[224:227]
v_mul_f32 v49, v49, v58
v_mul_f32 v50, v50, v58
v_mfma_f32_16x16x32_bf16 a[228:231], v[92:95], v[100:103], a[228:231]
v_mul_f32 v51, v51, v58
v_mul_f32 v52, v52, v58
v_mfma_f32_16x16x32_bf16 a[232:235], v[92:95], v[104:107], a[232:235]
v_mul_f32 v53, v53, v58
v_mul_f32 v54, v54, v58
v_mfma_f32_16x16x32_bf16 a[236:239], v[92:95], v[108:111], a[236:239]
v_mul_f32 v55, v55, v58
v_cvt_pk_bf16_f32 v32, v40, v41
v_mfma_f32_16x16x32_bf16 a[240:243], v[92:95], v[112:115], a[240:243]
v_cvt_pk_bf16_f32 v33, v42, v43
v_cvt_pk_bf16_f32 v36, v44, v45
v_mfma_f32_16x16x32_bf16 a[244:247], v[92:95], v[116:119], a[244:247]
v_cvt_pk_bf16_f32 v37, v46, v47
v_cvt_pk_bf16_f32 v34, v48, v49
v_mfma_f32_16x16x32_bf16 a[248:251], v[92:95], v[120:123], a[248:251]
v_cvt_pk_bf16_f32 v35, v50, v51
v_cvt_pk_bf16_f32 v38, v52, v53
v_mfma_f32_16x16x32_bf16 a[252:255], v[92:95], v[124:127], a[252:255]
v_cvt_pk_bf16_f32 v39, v54, v55
ds_write_b128 v26, v[32:35]
s_waitcnt lgkmcnt(0)
v_mfma_f32_16x16x32_bf16 a[0:3], v[128:131], v[160:163], a[0:3]
s_waitcnt vmcnt(9)
s_barrier
v_mfma_f32_16x16x32_bf16 a[4:7], v[128:131], v[164:167], a[4:7]
ds_read_b128 v[64:67], v16
ds_write_b128 v26, v[36:39] offset:128
v_mfma_f32_16x16x32_bf16 a[8:11], v[128:131], v[168:171], a[8:11]
s_add_u32 m0, s63, 32768
v_mfma_f32_16x16x32_bf16 a[12:15], v[128:131], v[172:175], a[12:15]
ds_read_b64_tr_b16 v[96:97], v17
s_add_u32 s62, s65, 0
v_mfma_f32_16x16x32_bf16 a[16:19], v[128:131], v[176:179], a[16:19]
v_mfma_f32_16x16x32_bf16 a[20:23], v[128:131], v[180:183], a[20:23]
ds_read_b64_tr_b16 v[98:99], v17 offset:2048
buffer_load_dwordx4 v8, s[8:11], s62 offen lds
v_mfma_f32_16x16x32_bf16 a[24:27], v[128:131], v[184:187], a[24:27]
v_mfma_f32_16x16x32_bf16 a[28:31], v[128:131], v[188:191], a[28:31]
ds_read_b128 v[68:71], v16 offset:1024
s_add_u32 s62, s65, 15360
v_mfma_f32_16x16x32_bf16 a[32:35], v[132:135], v[160:163], a[32:35]
v_mfma_f32_16x16x32_bf16 a[36:39], v[132:135], v[164:167], a[36:39]
buffer_load_dwordx4 v8, s[8:11], s62 offen offset:1024 lds
v_mfma_f32_16x16x32_bf16 a[40:43], v[132:135], v[168:171], a[40:43]
ds_read_b64_tr_b16 v[100:101], v18
v_mfma_f32_16x16x32_bf16 a[44:47], v[132:135], v[172:175], a[44:47]
s_add_u32 s62, s65, 30720
v_mfma_f32_16x16x32_bf16 a[48:51], v[132:135], v[176:179], a[48:51]
ds_read_b64_tr_b16 v[102:103], v18 offset:2048
buffer_load_dwordx4 v9, s[8:11], s62 offen offset:2048 lds
v_mfma_f32_16x16x32_bf16 a[52:55], v[132:135], v[180:183], a[52:55]
v_mfma_f32_16x16x32_bf16 a[56:59], v[132:135], v[184:187], a[56:59]
ds_read_b128 v[72:75], v16 offset:4096
s_add_u32 s62, s65, 46080
v_mfma_f32_16x16x32_bf16 a[60:63], v[132:135], v[188:191], a[60:63]
v_mfma_f32_16x16x32_bf16 a[64:67], v[136:139], v[160:163], a[64:67]
ds_read_b64_tr_b16 v[104:105], v19
buffer_load_dwordx4 v9, s[8:11], s62 offen offset:3072 lds
v_mfma_f32_16x16x32_bf16 a[68:71], v[136:139], v[164:167], a[68:71]
v_mfma_f32_16x16x32_bf16 a[72:75], v[136:139], v[168:171], a[72:75]
s_add_u32 m0, s63, 36864
v_mfma_f32_16x16x32_bf16 a[76:79], v[136:139], v[172:175], a[76:79]
ds_read_b64_tr_b16 v[106:107], v19 offset:2048
v_mfma_f32_16x16x32_bf16 a[80:83], v[136:139], v[176:179], a[80:83]
s_add_u32 s62, s65, 65536
v_mfma_f32_16x16x32_bf16 a[84:87], v[136:139], v[180:183], a[84:87]
ds_read_b128 v[76:79], v16 offset:5120
buffer_load_dwordx4 v8, s[8:11], s62 offen lds
v_mfma_f32_16x16x32_bf16 a[88:91], v[136:139], v[184:187], a[88:91]
v_mfma_f32_16x16x32_bf16 a[92:95], v[136:139], v[188:191], a[92:95]
ds_read_b64_tr_b16 v[108:109], v20
s_add_u32 s62, s65, 80896
v_mfma_f32_16x16x32_bf16 a[96:99], v[140:143], v[160:163], a[96:99]
v_mfma_f32_16x16x32_bf16 a[100:103], v[140:143], v[164:167], a[100:103]
ds_read_b64_tr_b16 v[110:111], v20 offset:2048
buffer_load_dwordx4 v8, s[8:11], s62 offen offset:1024 lds
v_mfma_f32_16x16x32_bf16 a[104:107], v[140:143], v[168:171], a[104:107]
v_mfma_f32_16x16x32_bf16 a[108:111], v[140:143], v[172:175], a[108:111]
s_add_u32 s62, s65, 96256
v_mfma_f32_16x16x32_bf16 a[112:115], v[140:143], v[176:179], a[112:115]
ds_read_b128 v[80:83], v16 offset:8192
v_mfma_f32_16x16x32_bf16 a[116:119], v[140:143], v[180:183], a[116:119]
buffer_load_dwordx4 v9, s[8:11], s62 offen offset:2048 lds
v_mfma_f32_16x16x32_bf16 a[120:123], v[140:143], v[184:187], a[120:123]
ds_read_b64_tr_b16 v[112:113], v21
s_add_u32 s62, s65, 111616
v_mfma_f32_16x16x32_bf16 a[124:127], v[140:143], v[188:191], a[124:127]
v_mfma_f32_16x16x32_bf16 a[128:131], v[144:147], v[160:163], a[128:131]
ds_read_b64_tr_b16 v[114:115], v21 offset:2048
buffer_load_dwordx4 v9, s[8:11], s62 offen offset:3072 lds
v_mfma_f32_16x16x32_bf16 a[132:135], v[144:147], v[164:167], a[132:135]
v_mfma_f32_16x16x32_bf16 a[136:139], v[144:147], v[168:171], a[136:139]
ds_read_b128 v[84:87], v16 offset:9216
s_add_u32 s65, s65, 128
v_mfma_f32_16x16x32_bf16 a[140:143], v[144:147], v[172:175], a[140:143]
v_mfma_f32_16x16x32_bf16 a[144:147], v[144:147], v[176:179], a[144:147]
s_add_u32 m0, s64, 114688
v_mfma_f32_16x16x32_bf16 a[148:151], v[144:147], v[180:183], a[148:151]
ds_read_b64_tr_b16 v[116:117], v22
v_mfma_f32_16x16x32_bf16 a[152:155], v[144:147], v[184:187], a[152:155]
s_nop 0
v_mfma_f32_16x16x32_bf16 a[156:159], v[144:147], v[188:191], a[156:159]
ds_read_b64_tr_b16 v[118:119], v22 offset:2048
buffer_load_dwordx4 v12, s[12:15], s66 offen lds
v_mfma_f32_16x16x32_bf16 a[160:163], v[148:151], v[160:163], a[160:163]
v_mfma_f32_16x16x32_bf16 a[164:167], v[148:151], v[164:167], a[164:167]
ds_read_b128 v[88:91], v16 offset:12288
buffer_load_dwordx4 v13, s[12:15], s66 offen offset:1024 lds
v_mfma_f32_16x16x32_bf16 a[168:171], v[148:151], v[168:171], a[168:171]
v_mfma_f32_16x16x32_bf16 a[172:175], v[148:151], v[172:175], a[172:175]
ds_read_b64_tr_b16 v[120:121], v23
buffer_load_dwordx4 v14, s[12:15], s66 offen offset:2048 lds
v_mfma_f32_16x16x32_bf16 a[176:179], v[148:151], v[176:179], a[176:179]
v_mfma_f32_16x16x32_bf16 a[180:183], v[148:151], v[180:183], a[180:183]
buffer_load_dwordx4 v15, s[12:15], s66 offen offset:3072 lds
v_mfma_f32_16x16x32_bf16 a[184:187], v[148:151], v[184:187], a[184:187]
ds_read_b64_tr_b16 v[122:123], v23 offset:2048
v_mfma_f32_16x16x32_bf16 a[188:191], v[148:151], v[188:191], a[188:191]
s_add_u32 s66, s66, 262144
v_mfma_f32_16x16x32_bf16 a[192:195], v[152:155], v[160:163], a[192:195]
ds_read_b128 v[92:95], v16 offset:13312
v_mfma_f32_16x16x32_bf16 a[196:199], v[152:155], v[164:167], a[196:199]
v_mfma_f32_16x16x32_bf16 a[200:203], v[152:155], v[168:171], a[200:203]
ds_read_b64_tr_b16 v[124:125], v24
buffer_load_dword v244, v241, s[8:11], 0 offen offset:1024
v_mfma_f32_16x16x32_bf16 a[204:207], v[152:155], v[172:175], a[204:207]
v_mfma_f32_16x16x32_bf16 a[208:211], v[152:155], v[176:179], a[208:211]
ds_read_b64_tr_b16 v[126:127], v24 offset:2048
v_mfma_f32_16x16x32_bf16 a[212:215], v[152:155], v[180:183], a[212:215]
v_mfma_f32_16x16x32_bf16 a[216:219], v[152:155], v[184:187], a[216:219]
v_mfma_f32_16x16x32_bf16 a[220:223], v[152:155], v[188:191], a[220:223]
v_mfma_f32_16x16x32_bf16 a[224:227], v[156:159], v[160:163], a[224:227]
v_mfma_f32_16x16x32_bf16 a[228:231], v[156:159], v[164:167], a[228:231]
v_mfma_f32_16x16x32_bf16 a[232:235], v[156:159], v[168:171], a[232:235]
v_mfma_f32_16x16x32_bf16 a[236:239], v[156:159], v[172:175], a[236:239]
v_mfma_f32_16x16x32_bf16 a[240:243], v[156:159], v[176:179], a[240:243]
v_mfma_f32_16x16x32_bf16 a[244:247], v[156:159], v[180:183], a[244:247]
v_mfma_f32_16x16x32_bf16 a[248:251], v[156:159], v[184:187], a[248:251]
v_mfma_f32_16x16x32_bf16 a[252:255], v[156:159], v[188:191], a[252:255]
s_waitcnt lgkmcnt(0)
v_mfma_f32_16x16x32_bf16 a[0:3], v[64:67], v[96:99], a[0:3]
s_waitcnt vmcnt(18)
s_barrier
v_mfma_f32_16x16x32_bf16 a[4:7], v[64:67], v[100:103], a[4:7]
ds_read_b128 v[128:131], v10
v_mfma_f32_16x16x32_bf16 a[8:11], v[64:67], v[104:107], a[8:11]
s_add_u32 m0, s64, 65536
v_mfma_f32_16x16x32_bf16 a[12:15], v[64:67], v[108:111], a[12:15]
ds_read_b64_tr_b16 v[160:161], v17 offset:16384
v_mfma_f32_16x16x32_bf16 a[16:19], v[64:67], v[112:115], a[16:19]
v_mfma_f32_16x16x32_bf16 a[20:23], v[64:67], v[116:119], a[20:23]
ds_read_b64_tr_b16 v[162:163], v17 offset:18432
v_mfma_f32_16x16x32_bf16 a[24:27], v[64:67], v[120:123], a[24:27]
v_mfma_f32_16x16x32_bf16 a[28:31], v[64:67], v[124:127], a[28:31]
ds_read_b128 v[132:135], v10 offset:1024
v_mfma_f32_16x16x32_bf16 a[32:35], v[68:71], v[96:99], a[32:35]
s_nop 0
v_mfma_f32_16x16x32_bf16 a[36:39], v[68:71], v[100:103], a[36:39]
v_mfma_f32_16x16x32_bf16 a[40:43], v[68:71], v[104:107], a[40:43]
ds_read_b64_tr_b16 v[164:165], v18 offset:16384
v_mfma_f32_16x16x32_bf16 a[44:47], v[68:71], v[108:111], a[44:47]
v_mfma_f32_16x16x32_bf16 a[48:51], v[68:71], v[112:115], a[48:51]
ds_read_b64_tr_b16 v[166:167], v18 offset:18432
v_mfma_f32_16x16x32_bf16 a[52:55], v[68:71], v[116:119], a[52:55]
v_mfma_f32_16x16x32_bf16 a[56:59], v[68:71], v[120:123], a[56:59]
ds_read_b128 v[136:139], v10 offset:4096
v_mfma_f32_16x16x32_bf16 a[60:63], v[68:71], v[124:127], a[60:63]
buffer_load_dwordx4 v12, s[12:15], s66 offen lds
v_mfma_f32_16x16x32_bf16 a[64:67], v[72:75], v[96:99], a[64:67]
ds_read_b64_tr_b16 v[168:169], v19 offset:16384
v_mfma_f32_16x16x32_bf16 a[68:71], v[72:75], v[100:103], a[68:71]
v_mfma_f32_16x16x32_bf16 a[72:75], v[72:75], v[104:107], a[72:75]
v_mfma_f32_16x16x32_bf16 a[76:79], v[72:75], v[108:111], a[76:79]
ds_read_b64_tr_b16 v[170:171], v19 offset:18432
v_mfma_f32_16x16x32_bf16 a[80:83], v[72:75], v[112:115], a[80:83]
v_mfma_f32_16x16x32_bf16 a[84:87], v[72:75], v[116:119], a[84:87]
ds_read_b128 v[140:143], v10 offset:5120
v_mfma_f32_16x16x32_bf16 a[88:91], v[72:75], v[120:123], a[88:91]
buffer_load_dwordx4 v13, s[12:15], s66 offen offset:1024 lds
v_mfma_f32_16x16x32_bf16 a[92:95], v[72:75], v[124:127], a[92:95]
ds_read_b64_tr_b16 v[172:173], v20 offset:16384
v_mfma_f32_16x16x32_bf16 a[96:99], v[76:79], v[96:99], a[96:99]
v_mfma_f32_16x16x32_bf16 a[100:103], v[76:79], v[100:103], a[100:103]
ds_read_b64_tr_b16 v[174:175], v20 offset:18432
v_mfma_f32_16x16x32_bf16 a[104:107], v[76:79], v[104:107], a[104:107]
v_mfma_f32_16x16x32_bf16 a[108:111], v[76:79], v[108:111], a[108:111]
v_mfma_f32_16x16x32_bf16 a[112:115], v[76:79], v[112:115], a[112:115]
ds_read_b128 v[144:147], v10 offset:8192
buffer_load_dwordx4 v14, s[12:15], s66 offen offset:2048 lds
v_mfma_f32_16x16x32_bf16 a[116:119], v[76:79], v[116:119], a[116:119]
v_mfma_f32_16x16x32_bf16 a[120:123], v[76:79], v[120:123], a[120:123]
ds_read_b64_tr_b16 v[176:177], v21 offset:16384
v_mfma_f32_16x16x32_bf16 a[124:127], v[76:79], v[124:127], a[124:127]
v_mfma_f32_16x16x32_bf16 a[128:131], v[80:83], v[96:99], a[128:131]
ds_read_b64_tr_b16 v[178:179], v21 offset:18432
v_mfma_f32_16x16x32_bf16 a[132:135], v[80:83], v[100:103], a[132:135]
v_mfma_f32_16x16x32_bf16 a[136:139], v[80:83], v[104:107], a[136:139]
ds_read_b128 v[148:151], v10 offset:9216
v_mfma_f32_16x16x32_bf16 a[140:143], v[80:83], v[108:111], a[140:143]
buffer_load_dwordx4 v15, s[12:15], s66 offen offset:3072 lds
v_mfma_f32_16x16x32_bf16 a[144:147], v[80:83], v[112:115], a[144:147]
v_mfma_f32_16x16x32_bf16 a[148:151], v[80:83], v[116:119], a[148:151]
ds_read_b64_tr_b16 v[180:181], v22 offset:16384
v_mfma_f32_16x16x32_bf16 a[152:155], v[80:83], v[120:123], a[152:155]
v_mfma_f32_16x16x32_bf16 a[156:159], v[80:83], v[124:127], a[156:159]
ds_read_b64_tr_b16 v[182:183], v22 offset:18432
v_mfma_f32_16x16x32_bf16 a[160:163], v[84:87], v[96:99], a[160:163]
v_mfma_f32_16x16x32_bf16 a[164:167], v[84:87], v[100:103], a[164:167]
ds_read_b128 v[152:155], v10 offset:12288
v_mfma_f32_16x16x32_bf16 a[168:171], v[84:87], v[104:107], a[168:171]
s_add_u32 s66, s66, 262144
v_mfma_f32_16x16x32_bf16 a[172:175], v[84:87], v[108:111], a[172:175]
ds_read_b64_tr_b16 v[184:185], v23 offset:16384
v_mfma_f32_16x16x32_bf16 a[176:179], v[84:87], v[112:115], a[176:179]
v_mfma_f32_16x16x32_bf16 a[180:183], v[84:87], v[116:119], a[180:183]
v_mfma_f32_16x16x32_bf16 a[184:187], v[84:87], v[120:123], a[184:187]
ds_read_b64_tr_b16 v[186:187], v23 offset:18432
v_mfma_f32_16x16x32_bf16 a[188:191], v[84:87], v[124:127], a[188:191]
v_mfma_f32_16x16x32_bf16 a[192:195], v[88:91], v[96:99], a[192:195]
ds_read_b128 v[156:159], v10 offset:13312
v_mfma_f32_16x16x32_bf16 a[196:199], v[88:91], v[100:103], a[196:199]
v_mfma_f32_16x16x32_bf16 a[200:203], v[88:91], v[104:107], a[200:203]
ds_read_b64_tr_b16 v[188:189], v24 offset:16384
v_mfma_f32_16x16x32_bf16 a[204:207], v[88:91], v[108:111], a[204:207]
v_mfma_f32_16x16x32_bf16 a[208:211], v[88:91], v[112:115], a[208:211]
ds_read_b64_tr_b16 v[190:191], v24 offset:18432
v_mfma_f32_16x16x32_bf16 a[212:215], v[88:91], v[116:119], a[212:215]
v_mfma_f32_16x16x32_bf16 a[216:219], v[88:91], v[120:123], a[216:219]
v_mfma_f32_16x16x32_bf16 a[220:223], v[88:91], v[124:127], a[220:223]
v_mfma_f32_16x16x32_bf16 a[224:227], v[92:95], v[96:99], a[224:227]
v_mfma_f32_16x16x32_bf16 a[228:231], v[92:95], v[100:103], a[228:231]
v_mfma_f32_16x16x32_bf16 a[232:235], v[92:95], v[104:107], a[232:235]
v_mfma_f32_16x16x32_bf16 a[236:239], v[92:95], v[108:111], a[236:239]
v_mfma_f32_16x16x32_bf16 a[240:243], v[92:95], v[112:115], a[240:243]
v_mfma_f32_16x16x32_bf16 a[244:247], v[92:95], v[116:119], a[244:247]
v_mfma_f32_16x16x32_bf16 a[248:251], v[92:95], v[120:123], a[248:251]
v_mfma_f32_16x16x32_bf16 a[252:255], v[92:95], v[124:127], a[252:255]
s_waitcnt lgkmcnt(0)
v_mfma_f32_16x16x32_bf16 a[0:3], v[128:131], v[160:163], a[0:3]
s_waitcnt vmcnt(9)
s_barrier
v_mfma_f32_16x16x32_bf16 a[4:7], v[128:131], v[164:167], a[4:7]
ds_read_b128 v[64:67], v16 offset:32768
v_mfma_f32_16x16x32_bf16 a[8:11], v[128:131], v[168:171], a[8:11]
s_add_u32 m0, s63, 0
v_mfma_f32_16x16x32_bf16 a[12:15], v[128:131], v[172:175], a[12:15]
ds_read_b64_tr_b16 v[96:97], v17 offset:32768
s_add_u32 s62, s65, 0
v_mfma_f32_16x16x32_bf16 a[16:19], v[128:131], v[176:179], a[16:19]
v_mfma_f32_16x16x32_bf16 a[20:23], v[128:131], v[180:183], a[20:23]
ds_read_b64_tr_b16 v[98:99], v17 offset:34816
buffer_load_dwordx4 v8, s[8:11], s62 offen lds
v_mfma_f32_16x16x32_bf16 a[24:27], v[128:131], v[184:187], a[24:27]
v_mfma_f32_16x16x32_bf16 a[28:31], v[128:131], v[188:191], a[28:31]
ds_read_b128 v[68:71], v16 offset:33792
s_add_u32 s62, s65, 15360
v_mfma_f32_16x16x32_bf16 a[32:35], v[132:135], v[160:163], a[32:35]
v_mfma_f32_16x16x32_bf16 a[36:39], v[132:135], v[164:167], a[36:39]
buffer_load_dwordx4 v8, s[8:11], s62 offen offset:1024 lds
v_mfma_f32_16x16x32_bf16 a[40:43], v[132:135], v[168:171], a[40:43]
ds_read_b64_tr_b16 v[100:101], v18 offset:32768
v_mfma_f32_16x16x32_bf16 a[44:47], v[132:135], v[172:175], a[44:47]
s_add_u32 s62, s65, 30720
v_mfma_f32_16x16x32_bf16 a[48:51], v[132:135], v[176:179], a[48:51]
ds_read_b64_tr_b16 v[102:103], v18 offset:34816
buffer_load_dwordx4 v9, s[8:11], s62 offen offset:2048 lds
v_mfma_f32_16x16x32_bf16 a[52:55], v[132:135], v[180:183], a[52:55]
v_mfma_f32_16x16x32_bf16 a[56:59], v[132:135], v[184:187], a[56:59]
ds_read_b128 v[72:75], v16 offset:36864
s_add_u32 s62, s65, 46080
v_mfma_f32_16x16x32_bf16 a[60:63], v[132:135], v[188:191], a[60:63]
v_mfma_f32_16x16x32_bf16 a[64:67], v[136:139], v[160:163], a[64:67]
ds_read_b64_tr_b16 v[104:105], v19 offset:32768
buffer_load_dwordx4 v9, s[8:11], s62 offen offset:3072 lds
v_mfma_f32_16x16x32_bf16 a[68:71], v[136:139], v[164:167], a[68:71]
v_mfma_f32_16x16x32_bf16 a[72:75], v[136:139], v[168:171], a[72:75]
s_add_u32 m0, s63, 4096
v_mfma_f32_16x16x32_bf16 a[76:79], v[136:139], v[172:175], a[76:79]
ds_read_b64_tr_b16 v[106:107], v19 offset:34816
v_mfma_f32_16x16x32_bf16 a[80:83], v[136:139], v[176:179], a[80:83]
s_add_u32 s62, s65, 65536
ds_read_b128 v[32:35], v252
ds_read_b128 v[36:39], v252 offset:896
v_mfma_f32_16x16x32_bf16 a[84:87], v[136:139], v[180:183], a[84:87]
ds_read_b128 v[76:79], v16 offset:37888
buffer_load_dwordx4 v8, s[8:11], s62 offen lds
v_mfma_f32_16x16x32_bf16 a[88:91], v[136:139], v[184:187], a[88:91]
v_mfma_f32_16x16x32_bf16 a[92:95], v[136:139], v[188:191], a[92:95]
ds_read_b64_tr_b16 v[108:109], v20 offset:32768
s_add_u32 s62, s65, 80896
v_mfma_f32_16x16x32_bf16 a[96:99], v[140:143], v[160:163], a[96:99]
v_mfma_f32_16x16x32_bf16 a[100:103], v[140:143], v[164:167], a[100:103]
ds_read_b64_tr_b16 v[110:111], v20 offset:34816
buffer_load_dwordx4 v8, s[8:11], s62 offen offset:1024 lds
v_mfma_f32_16x16x32_bf16 a[104:107], v[140:143], v[168:171], a[104:107]
v_mfma_f32_16x16x32_bf16 a[108:111], v[140:143], v[172:175], a[108:111]
s_add_u32 s62, s65, 96256
v_mfma_f32_16x16x32_bf16 a[112:115], v[140:143], v[176:179], a[112:115]
ds_read_b128 v[80:83], v16 offset:40960
v_mfma_f32_16x16x32_bf16 a[116:119], v[140:143], v[180:183], a[116:119]
buffer_load_dwordx4 v9, s[8:11], s62 offen offset:2048 lds
v_mfma_f32_16x16x32_bf16 a[120:123], v[140:143], v[184:187], a[120:123]
ds_read_b64_tr_b16 v[112:113], v21 offset:32768
s_add_u32 s62, s65, 111616
v_mfma_f32_16x16x32_bf16 a[124:127], v[140:143], v[188:191], a[124:127]
v_mfma_f32_16x16x32_bf16 a[128:131], v[144:147], v[160:163], a[128:131]
ds_read_b64_tr_b16 v[114:115], v21 offset:34816
buffer_load_dwordx4 v9, s[8:11], s62 offen offset:3072 lds
v_mfma_f32_16x16x32_bf16 a[132:135], v[144:147], v[164:167], a[132:135]
v_mfma_f32_16x16x32_bf16 a[136:139], v[144:147], v[168:171], a[136:139]
ds_read_b128 v[84:87], v16 offset:41984
s_add_u32 s65, s65, 128
v_mfma_f32_16x16x32_bf16 a[140:143], v[144:147], v[172:175], a[140:143]
v_mfma_f32_16x16x32_bf16 a[144:147], v[144:147], v[176:179], a[144:147]
s_add_u32 m0, s64, 81920
v_mfma_f32_16x16x32_bf16 a[148:151], v[144:147], v[180:183], a[148:151]
ds_read_b64_tr_b16 v[116:117], v22 offset:32768
v_mfma_f32_16x16x32_bf16 a[152:155], v[144:147], v[184:187], a[152:155]
s_nop 0
v_mfma_f32_16x16x32_bf16 a[156:159], v[144:147], v[188:191], a[156:159]
ds_read_b64_tr_b16 v[118:119], v22 offset:34816
buffer_load_dwordx4 v12, s[12:15], s66 offen lds
v_mfma_f32_16x16x32_bf16 a[160:163], v[148:151], v[160:163], a[160:163]
v_mfma_f32_16x16x32_bf16 a[164:167], v[148:151], v[164:167], a[164:167]
ds_read_b128 v[88:91], v16 offset:45056
buffer_load_dwordx4 v13, s[12:15], s66 offen offset:1024 lds
v_mfma_f32_16x16x32_bf16 a[168:171], v[148:151], v[168:171], a[168:171]
v_mfma_f32_16x16x32_bf16 a[172:175], v[148:151], v[172:175], a[172:175]
ds_read_b64_tr_b16 v[120:121], v23 offset:32768
buffer_load_dwordx4 v14, s[12:15], s66 offen offset:2048 lds
v_mfma_f32_16x16x32_bf16 a[176:179], v[148:151], v[176:179], a[176:179]
v_mfma_f32_16x16x32_bf16 a[180:183], v[148:151], v[180:183], a[180:183]
buffer_load_dwordx4 v15, s[12:15], s66 offen offset:3072 lds
v_mfma_f32_16x16x32_bf16 a[184:187], v[148:151], v[184:187], a[184:187]
ds_read_b64_tr_b16 v[122:123], v23 offset:34816
v_mfma_f32_16x16x32_bf16 a[188:191], v[148:151], v[188:191], a[188:191]
s_add_u32 s66, s66, 262144
v_mfma_f32_16x16x32_bf16 a[192:195], v[152:155], v[160:163], a[192:195]
ds_read_b128 v[92:95], v16 offset:46080
v_mfma_f32_16x16x32_bf16 a[196:199], v[152:155], v[164:167], a[196:199]
v_mfma_f32_16x16x32_bf16 a[200:203], v[152:155], v[168:171], a[200:203]
ds_read_b64_tr_b16 v[124:125], v24 offset:32768
v_add_u32 v242, 0x100000, v242
global_load_dword v245, v242, s[98:99]
v_mfma_f32_16x16x32_bf16 a[204:207], v[152:155], v[172:175], a[204:207]
v_mfma_f32_16x16x32_bf16 a[208:211], v[152:155], v[176:179], a[208:211]
ds_read_b64_tr_b16 v[126:127], v24 offset:34816
v_mfma_f32_16x16x32_bf16 a[212:215], v[152:155], v[180:183], a[212:215]
v_mfma_f32_16x16x32_bf16 a[216:219], v[152:155], v[184:187], a[216:219]
v_mfma_f32_16x16x32_bf16 a[220:223], v[152:155], v[188:191], a[220:223]
v_mfma_f32_16x16x32_bf16 a[224:227], v[156:159], v[160:163], a[224:227]
v_mfma_f32_16x16x32_bf16 a[228:231], v[156:159], v[164:167], a[228:231]
v_mfma_f32_16x16x32_bf16 a[232:235], v[156:159], v[168:171], a[232:235]
v_mfma_f32_16x16x32_bf16 a[236:239], v[156:159], v[172:175], a[236:239]
v_mfma_f32_16x16x32_bf16 a[240:243], v[156:159], v[176:179], a[240:243]
v_mfma_f32_16x16x32_bf16 a[244:247], v[156:159], v[180:183], a[244:247]
v_mfma_f32_16x16x32_bf16 a[248:251], v[156:159], v[184:187], a[248:251]
v_mfma_f32_16x16x32_bf16 a[252:255], v[156:159], v[188:191], a[252:255]
s_waitcnt lgkmcnt(0)
v_mfma_f32_16x16x32_bf16 a[0:3], v[64:67], v[96:99], a[0:3]
s_waitcnt vmcnt(18)
s_barrier
v_mfma_f32_16x16x32_bf16 a[4:7], v[64:67], v[100:103], a[4:7]
ds_read_b128 v[128:131], v10 offset:32768
v_mfma_f32_16x16x32_bf16 a[8:11], v[64:67], v[104:107], a[8:11]
s_add_u32 m0, s64, 98304
v_mfma_f32_16x16x32_bf16 a[12:15], v[64:67], v[108:111], a[12:15]
ds_read_b64_tr_b16 v[160:161], v17 offset:49152
v_mfma_f32_16x16x32_bf16 a[16:19], v[64:67], v[112:115], a[16:19]
v_mfma_f32_16x16x32_bf16 a[20:23], v[64:67], v[116:119], a[20:23]
ds_read_b64_tr_b16 v[162:163], v17 offset:51200
v_mfma_f32_16x16x32_bf16 a[24:27], v[64:67], v[120:123], a[24:27]
v_mfma_f32_16x16x32_bf16 a[28:31], v[64:67], v[124:127], a[28:31]
ds_read_b128 v[132:135], v10 offset:33792
v_mfma_f32_16x16x32_bf16 a[32:35], v[68:71], v[96:99], a[32:35]
s_nop 0
v_mfma_f32_16x16x32_bf16 a[36:39], v[68:71], v[100:103], a[36:39]
v_mfma_f32_16x16x32_bf16 a[40:43], v[68:71], v[104:107], a[40:43]
ds_read_b64_tr_b16 v[164:165], v18 offset:49152
v_mfma_f32_16x16x32_bf16 a[44:47], v[68:71], v[108:111], a[44:47]
v_mfma_f32_16x16x32_bf16 a[48:51], v[68:71], v[112:115], a[48:51]
ds_read_b64_tr_b16 v[166:167], v18 offset:51200
v_mfma_f32_16x16x32_bf16 a[52:55], v[68:71], v[116:119], a[52:55]
v_mfma_f32_16x16x32_bf16 a[56:59], v[68:71], v[120:123], a[56:59]
ds_read_b128 v[136:139], v10 offset:36864
v_mfma_f32_16x16x32_bf16 a[60:63], v[68:71], v[124:127], a[60:63]
buffer_load_dwordx4 v12, s[12:15], s66 offen lds
v_mfma_f32_16x16x32_bf16 a[64:67], v[72:75], v[96:99], a[64:67]
ds_read_b64_tr_b16 v[168:169], v19 offset:49152
v_mfma_f32_16x16x32_bf16 a[68:71], v[72:75], v[100:103], a[68:71]
v_mfma_f32_16x16x32_bf16 a[72:75], v[72:75], v[104:107], a[72:75]
v_mfma_f32_16x16x32_bf16 a[76:79], v[72:75], v[108:111], a[76:79]
ds_read_b64_tr_b16 v[170:171], v19 offset:51200
v_mfma_f32_16x16x32_bf16 a[80:83], v[72:75], v[112:115], a[80:83]
buffer_store_dwordx4 v[32:35], v253, s[24:27], 0 offen sc1
buffer_store_dwordx4 v[36:39], v253, s[24:27], 0 offen offset:3584 sc1
v_mfma_f32_16x16x32_bf16 a[84:87], v[72:75], v[116:119], a[84:87]
ds_read_b128 v[140:143], v10 offset:37888
v_mfma_f32_16x16x32_bf16 a[88:91], v[72:75], v[120:123], a[88:91]
buffer_load_dwordx4 v13, s[12:15], s66 offen offset:1024 lds
v_mfma_f32_16x16x32_bf16 a[92:95], v[72:75], v[124:127], a[92:95]
ds_read_b64_tr_b16 v[172:173], v20 offset:49152
v_mfma_f32_16x16x32_bf16 a[96:99], v[76:79], v[96:99], a[96:99]
v_mfma_f32_16x16x32_bf16 a[100:103], v[76:79], v[100:103], a[100:103]
ds_read_b64_tr_b16 v[174:175], v20 offset:51200
v_mfma_f32_16x16x32_bf16 a[104:107], v[76:79], v[104:107], a[104:107]
v_mfma_f32_16x16x32_bf16 a[108:111], v[76:79], v[108:111], a[108:111]
v_mfma_f32_16x16x32_bf16 a[112:115], v[76:79], v[112:115], a[112:115]
ds_read_b128 v[144:147], v10 offset:40960
buffer_load_dwordx4 v14, s[12:15], s66 offen offset:2048 lds
v_mfma_f32_16x16x32_bf16 a[116:119], v[76:79], v[116:119], a[116:119]
v_mfma_f32_16x16x32_bf16 a[120:123], v[76:79], v[120:123], a[120:123]
ds_read_b64_tr_b16 v[176:177], v21 offset:49152
v_mfma_f32_16x16x32_bf16 a[124:127], v[76:79], v[124:127], a[124:127]
v_mfma_f32_16x16x32_bf16 a[128:131], v[80:83], v[96:99], a[128:131]
ds_read_b64_tr_b16 v[178:179], v21 offset:51200
v_mfma_f32_16x16x32_bf16 a[132:135], v[80:83], v[100:103], a[132:135]
v_mfma_f32_16x16x32_bf16 a[136:139], v[80:83], v[104:107], a[136:139]
ds_read_b128 v[148:151], v10 offset:41984
v_mfma_f32_16x16x32_bf16 a[140:143], v[80:83], v[108:111], a[140:143]
buffer_load_dwordx4 v15, s[12:15], s66 offen offset:3072 lds
v_mfma_f32_16x16x32_bf16 a[144:147], v[80:83], v[112:115], a[144:147]
v_mfma_f32_16x16x32_bf16 a[148:151], v[80:83], v[116:119], a[148:151]
ds_read_b64_tr_b16 v[180:181], v22 offset:49152
v_mfma_f32_16x16x32_bf16 a[152:155], v[80:83], v[120:123], a[152:155]
v_mfma_f32_16x16x32_bf16 a[156:159], v[80:83], v[124:127], a[156:159]
ds_read_b64_tr_b16 v[182:183], v22 offset:51200
v_mfma_f32_16x16x32_bf16 a[160:163], v[84:87], v[96:99], a[160:163]
v_mfma_f32_16x16x32_bf16 a[164:167], v[84:87], v[100:103], a[164:167]
ds_read_b128 v[152:155], v10 offset:45056
v_mfma_f32_16x16x32_bf16 a[168:171], v[84:87], v[104:107], a[168:171]
s_add_u32 s66, s66, 262144
v_mfma_f32_16x16x32_bf16 a[172:175], v[84:87], v[108:111], a[172:175]
ds_read_b64_tr_b16 v[184:185], v23 offset:49152
v_mfma_f32_16x16x32_bf16 a[176:179], v[84:87], v[112:115], a[176:179]
v_mfma_f32_16x16x32_bf16 a[180:183], v[84:87], v[116:119], a[180:183]
v_mfma_f32_16x16x32_bf16 a[184:187], v[84:87], v[120:123], a[184:187]
ds_read_b64_tr_b16 v[186:187], v23 offset:51200
v_mfma_f32_16x16x32_bf16 a[188:191], v[84:87], v[124:127], a[188:191]
v_mfma_f32_16x16x32_bf16 a[192:195], v[88:91], v[96:99], a[192:195]
ds_read_b128 v[156:159], v10 offset:46080
v_mfma_f32_16x16x32_bf16 a[196:199], v[88:91], v[100:103], a[196:199]
v_mfma_f32_16x16x32_bf16 a[200:203], v[88:91], v[104:107], a[200:203]
ds_read_b64_tr_b16 v[188:189], v24 offset:49152
v_mfma_f32_16x16x32_bf16 a[204:207], v[88:91], v[108:111], a[204:207]
v_mfma_f32_16x16x32_bf16 a[208:211], v[88:91], v[112:115], a[208:211]
ds_read_b64_tr_b16 v[190:191], v24 offset:51200
v_mfma_f32_16x16x32_bf16 a[212:215], v[88:91], v[116:119], a[212:215]
v_mfma_f32_16x16x32_bf16 a[216:219], v[88:91], v[120:123], a[216:219]
v_mfma_f32_16x16x32_bf16 a[220:223], v[88:91], v[124:127], a[220:223]
v_mfma_f32_16x16x32_bf16 a[224:227], v[92:95], v[96:99], a[224:227]
v_mfma_f32_16x16x32_bf16 a[228:231], v[92:95], v[100:103], a[228:231]
v_mfma_f32_16x16x32_bf16 a[232:235], v[92:95], v[104:107], a[232:235]
v_mfma_f32_16x16x32_bf16 a[236:239], v[92:95], v[108:111], a[236:239]
v_mfma_f32_16x16x32_bf16 a[240:243], v[92:95], v[112:115], a[240:243]
v_mfma_f32_16x16x32_bf16 a[244:247], v[92:95], v[116:119], a[244:247]
v_mfma_f32_16x16x32_bf16 a[248:251], v[92:95], v[120:123], a[248:251]
v_mfma_f32_16x16x32_bf16 a[252:255], v[92:95], v[124:127], a[252:255]
s_waitcnt lgkmcnt(0)
v_mfma_f32_16x16x32_bf16 a[0:3], v[128:131], v[160:163], a[0:3]
s_waitcnt vmcnt(11)
s_barrier
v_mfma_f32_16x16x32_bf16 a[4:7], v[128:131], v[164:167], a[4:7]
ds_read_b128 v[64:67], v16
v_mfma_f32_16x16x32_bf16 a[8:11], v[128:131], v[168:171], a[8:11]
s_add_u32 m0, s63, 32768
v_mfma_f32_16x16x32_bf16 a[12:15], v[128:131], v[172:175], a[12:15]
ds_read_b64_tr_b16 v[96:97], v17
s_add_u32 s62, s65, 0
v_mfma_f32_16x16x32_bf16 a[16:19], v[128:131], v[176:179], a[16:19]
v_mfma_f32_16x16x32_bf16 a[20:23], v[128:131], v[180:183], a[20:23]
ds_read_b64_tr_b16 v[98:99], v17 offset:2048
buffer_load_dwordx4 v8, s[8:11], s62 offen lds
v_mfma_f32_16x16x32_bf16 a[24:27], v[128:131], v[184:187], a[24:27]
v_mfma_f32_16x16x32_bf16 a[28:31], v[128:131], v[188:191], a[28:31]
ds_read_b128 v[68:71], v16 offset:1024
s_add_u32 s62, s65, 15360
v_mfma_f32_16x16x32_bf16 a[32:35], v[132:135], v[160:163], a[32:35]
v_mfma_f32_16x16x32_bf16 a[36:39], v[132:135], v[164:167], a[36:39]
buffer_load_dwordx4 v8, s[8:11], s62 offen offset:1024 lds
v_mfma_f32_16x16x32_bf16 a[40:43], v[132:135], v[168:171], a[40:43]
ds_read_b64_tr_b16 v[100:101], v18
v_mfma_f32_16x16x32_bf16 a[44:47], v[132:135], v[172:175], a[44:47]
s_add_u32 s62, s65, 30720
v_mfma_f32_16x16x32_bf16 a[48:51], v[132:135], v[176:179], a[48:51]
ds_read_b64_tr_b16 v[102:103], v18 offset:2048
buffer_load_dwordx4 v9, s[8:11], s62 offen offset:2048 lds
v_mfma_f32_16x16x32_bf16 a[52:55], v[132:135], v[180:183], a[52:55]
v_mfma_f32_16x16x32_bf16 a[56:59], v[132:135], v[184:187], a[56:59]
ds_read_b128 v[72:75], v16 offset:4096
s_add_u32 s62, s65, 46080
v_mfma_f32_16x16x32_bf16 a[60:63], v[132:135], v[188:191], a[60:63]
v_mfma_f32_16x16x32_bf16 a[64:67], v[136:139], v[160:163], a[64:67]
ds_read_b64_tr_b16 v[104:105], v19
buffer_load_dwordx4 v9, s[8:11], s62 offen offset:3072 lds
v_mfma_f32_16x16x32_bf16 a[68:71], v[136:139], v[164:167], a[68:71]
v_mfma_f32_16x16x32_bf16 a[72:75], v[136:139], v[168:171], a[72:75]
s_add_u32 m0, s63, 36864
v_mfma_f32_16x16x32_bf16 a[76:79], v[136:139], v[172:175], a[76:79]
ds_read_b64_tr_b16 v[106:107], v19 offset:2048
v_mfma_f32_16x16x32_bf16 a[80:83], v[136:139], v[176:179], a[80:83]
s_add_u32 s62, s65, 65536
v_mfma_f32_16x16x32_bf16 a[84:87], v[136:139], v[180:183], a[84:87]
ds_read_b128 v[76:79], v16 offset:5120
buffer_load_dwordx4 v8, s[8:11], s62 offen lds
v_mfma_f32_16x16x32_bf16 a[88:91], v[136:139], v[184:187], a[88:91]
v_mfma_f32_16x16x32_bf16 a[92:95], v[136:139], v[188:191], a[92:95]
ds_read_b64_tr_b16 v[108:109], v20
s_add_u32 s62, s65, 80896
v_mfma_f32_16x16x32_bf16 a[96:99], v[140:143], v[160:163], a[96:99]
v_mfma_f32_16x16x32_bf16 a[100:103], v[140:143], v[164:167], a[100:103]
ds_read_b64_tr_b16 v[110:111], v20 offset:2048
buffer_load_dwordx4 v8, s[8:11], s62 offen offset:1024 lds
v_mfma_f32_16x16x32_bf16 a[104:107], v[140:143], v[168:171], a[104:107]
v_mfma_f32_16x16x32_bf16 a[108:111], v[140:143], v[172:175], a[108:111]
s_add_u32 s62, s65, 96256
v_mfma_f32_16x16x32_bf16 a[112:115], v[140:143], v[176:179], a[112:115]
ds_read_b128 v[80:83], v16 offset:8192
v_mfma_f32_16x16x32_bf16 a[116:119], v[140:143], v[180:183], a[116:119]
buffer_load_dwordx4 v9, s[8:11], s62 offen offset:2048 lds
v_mfma_f32_16x16x32_bf16 a[120:123], v[140:143], v[184:187], a[120:123]
ds_read_b64_tr_b16 v[112:113], v21
s_add_u32 s62, s65, 111616
v_mfma_f32_16x16x32_bf16 a[124:127], v[140:143], v[188:191], a[124:127]
v_mfma_f32_16x16x32_bf16 a[128:131], v[144:147], v[160:163], a[128:131]
ds_read_b64_tr_b16 v[114:115], v21 offset:2048
buffer_load_dwordx4 v9, s[8:11], s62 offen offset:3072 lds
v_mfma_f32_16x16x32_bf16 a[132:135], v[144:147], v[164:167], a[132:135]
v_mfma_f32_16x16x32_bf16 a[136:139], v[144:147], v[168:171], a[136:139]
ds_read_b128 v[84:87], v16 offset:9216
s_add_u32 s65, s65, 128
v_mfma_f32_16x16x32_bf16 a[140:143], v[144:147], v[172:175], a[140:143]
v_mfma_f32_16x16x32_bf16 a[144:147], v[144:147], v[176:179], a[144:147]
s_add_u32 m0, s64, 114688
v_mfma_f32_16x16x32_bf16 a[148:151], v[144:147], v[180:183], a[148:151]
ds_read_b64_tr_b16 v[116:117], v22
v_mfma_f32_16x16x32_bf16 a[152:155], v[144:147], v[184:187], a[152:155]
s_nop 0
v_mfma_f32_16x16x32_bf16 a[156:159], v[144:147], v[188:191], a[156:159]
ds_read_b64_tr_b16 v[118:119], v22 offset:2048
buffer_load_dwordx4 v12, s[12:15], s66 offen lds
v_mfma_f32_16x16x32_bf16 a[160:163], v[148:151], v[160:163], a[160:163]
v_mfma_f32_16x16x32_bf16 a[164:167], v[148:151], v[164:167], a[164:167]
ds_read_b128 v[88:91], v16 offset:12288
buffer_load_dwordx4 v13, s[12:15], s66 offen offset:1024 lds
v_mfma_f32_16x16x32_bf16 a[168:171], v[148:151], v[168:171], a[168:171]
v_mfma_f32_16x16x32_bf16 a[172:175], v[148:151], v[172:175], a[172:175]
ds_read_b64_tr_b16 v[120:121], v23
buffer_load_dwordx4 v14, s[12:15], s66 offen offset:2048 lds
v_mfma_f32_16x16x32_bf16 a[176:179], v[148:151], v[176:179], a[176:179]
v_mfma_f32_16x16x32_bf16 a[180:183], v[148:151], v[180:183], a[180:183]
buffer_load_dwordx4 v15, s[12:15], s66 offen offset:3072 lds
v_mfma_f32_16x16x32_bf16 a[184:187], v[148:151], v[184:187], a[184:187]
ds_read_b64_tr_b16 v[122:123], v23 offset:2048
v_mfma_f32_16x16x32_bf16 a[188:191], v[148:151], v[188:191], a[188:191]
s_add_u32 s66, s66, 262144
v_mfma_f32_16x16x32_bf16 a[192:195], v[152:155], v[160:163], a[192:195]
ds_read_b128 v[92:95], v16 offset:13312
v_mfma_f32_16x16x32_bf16 a[196:199], v[152:155], v[164:167], a[196:199]
v_mfma_f32_16x16x32_bf16 a[200:203], v[152:155], v[168:171], a[200:203]
ds_read_b64_tr_b16 v[124:125], v24
v_mfma_f32_16x16x32_bf16 a[204:207], v[152:155], v[172:175], a[204:207]
v_mfma_f32_16x16x32_bf16 a[208:211], v[152:155], v[176:179], a[208:211]
ds_read_b64_tr_b16 v[126:127], v24 offset:2048
v_mfma_f32_16x16x32_bf16 a[212:215], v[152:155], v[180:183], a[212:215]
v_mfma_f32_16x16x32_bf16 a[216:219], v[152:155], v[184:187], a[216:219]
v_mfma_f32_16x16x32_bf16 a[220:223], v[152:155], v[188:191], a[220:223]
v_mfma_f32_16x16x32_bf16 a[224:227], v[156:159], v[160:163], a[224:227]
v_mfma_f32_16x16x32_bf16 a[228:231], v[156:159], v[164:167], a[228:231]
v_mfma_f32_16x16x32_bf16 a[232:235], v[156:159], v[168:171], a[232:235]
v_mfma_f32_16x16x32_bf16 a[236:239], v[156:159], v[172:175], a[236:239]
v_mfma_f32_16x16x32_bf16 a[240:243], v[156:159], v[176:179], a[240:243]
v_mfma_f32_16x16x32_bf16 a[244:247], v[156:159], v[180:183], a[244:247]
v_mfma_f32_16x16x32_bf16 a[248:251], v[156:159], v[184:187], a[248:251]
v_mfma_f32_16x16x32_bf16 a[252:255], v[156:159], v[188:191], a[252:255]
s_waitcnt lgkmcnt(0)
v_mfma_f32_16x16x32_bf16 a[0:3], v[64:67], v[96:99], a[0:3]
s_waitcnt vmcnt(19)
s_barrier
v_mfma_f32_16x16x32_bf16 a[4:7], v[64:67], v[100:103], a[4:7]
ds_read_b128 v[128:131], v10
v_mfma_f32_16x16x32_bf16 a[8:11], v[64:67], v[104:107], a[8:11]
s_add_u32 m0, s64, 65536
v_mfma_f32_16x16x32_bf16 a[12:15], v[64:67], v[108:111], a[12:15]
ds_read_b64_tr_b16 v[160:161], v17 offset:16384
v_mfma_f32_16x16x32_bf16 a[16:19], v[64:67], v[112:115], a[16:19]
v_mfma_f32_16x16x32_bf16 a[20:23], v[64:67], v[116:119], a[20:23]
ds_read_b64_tr_b16 v[162:163], v17 offset:18432
v_mfma_f32_16x16x32_bf16 a[24:27], v[64:67], v[120:123], a[24:27]
v_mfma_f32_16x16x32_bf16 a[28:31], v[64:67], v[124:127], a[28:31]
ds_read_b128 v[132:135], v10 offset:1024
v_mfma_f32_16x16x32_bf16 a[32:35], v[68:71], v[96:99], a[32:35]
s_nop 0
v_mfma_f32_16x16x32_bf16 a[36:39], v[68:71], v[100:103], a[36:39]
v_mfma_f32_16x16x32_bf16 a[40:43], v[68:71], v[104:107], a[40:43]
ds_read_b64_tr_b16 v[164:165], v18 offset:16384
v_mfma_f32_16x16x32_bf16 a[44:47], v[68:71], v[108:111], a[44:47]
v_mfma_f32_16x16x32_bf16 a[48:51], v[68:71], v[112:115], a[48:51]
ds_read_b64_tr_b16 v[166:167], v18 offset:18432
v_mfma_f32_16x16x32_bf16 a[52:55], v[68:71], v[116:119], a[52:55]
v_mfma_f32_16x16x32_bf16 a[56:59], v[68:71], v[120:123], a[56:59]
ds_read_b128 v[136:139], v10 offset:4096
v_mfma_f32_16x16x32_bf16 a[60:63], v[68:71], v[124:127], a[60:63]
buffer_load_dwordx4 v12, s[12:15], s66 offen lds
v_mfma_f32_16x16x32_bf16 a[64:67], v[72:75], v[96:99], a[64:67]
ds_read_b64_tr_b16 v[168:169], v19 offset:16384
v_mfma_f32_16x16x32_bf16 a[68:71], v[72:75], v[100:103], a[68:71]
v_mfma_f32_16x16x32_bf16 a[72:75], v[72:75], v[104:107], a[72:75]
v_mfma_f32_16x16x32_bf16 a[76:79], v[72:75], v[108:111], a[76:79]
ds_read_b64_tr_b16 v[170:171], v19 offset:18432
v_mfma_f32_16x16x32_bf16 a[80:83], v[72:75], v[112:115], a[80:83]
v_mfma_f32_16x16x32_bf16 a[84:87], v[72:75], v[116:119], a[84:87]
ds_read_b128 v[140:143], v10 offset:5120
v_mfma_f32_16x16x32_bf16 a[88:91], v[72:75], v[120:123], a[88:91]
buffer_load_dwordx4 v13, s[12:15], s66 offen offset:1024 lds
v_mfma_f32_16x16x32_bf16 a[92:95], v[72:75], v[124:127], a[92:95]
ds_read_b64_tr_b16 v[172:173], v20 offset:16384
v_mfma_f32_16x16x32_bf16 a[96:99], v[76:79], v[96:99], a[96:99]
v_mfma_f32_16x16x32_bf16 a[100:103], v[76:79], v[100:103], a[100:103]
ds_read_b64_tr_b16 v[174:175], v20 offset:18432
v_mfma_f32_16x16x32_bf16 a[104:107], v[76:79], v[104:107], a[104:107]
v_mfma_f32_16x16x32_bf16 a[108:111], v[76:79], v[108:111], a[108:111]
v_mfma_f32_16x16x32_bf16 a[112:115], v[76:79], v[112:115], a[112:115]
ds_read_b128 v[144:147], v10 offset:8192
buffer_load_dwordx4 v14, s[12:15], s66 offen offset:2048 lds
v_mfma_f32_16x16x32_bf16 a[116:119], v[76:79], v[116:119], a[116:119]
v_mfma_f32_16x16x32_bf16 a[120:123], v[76:79], v[120:123], a[120:123]
ds_read_b64_tr_b16 v[176:177], v21 offset:16384
v_mfma_f32_16x16x32_bf16 a[124:127], v[76:79], v[124:127], a[124:127]
v_mfma_f32_16x16x32_bf16 a[128:131], v[80:83], v[96:99], a[128:131]
ds_read_b64_tr_b16 v[178:179], v21 offset:18432
v_mfma_f32_16x16x32_bf16 a[132:135], v[80:83], v[100:103], a[132:135]
v_mfma_f32_16x16x32_bf16 a[136:139], v[80:83], v[104:107], a[136:139]
ds_read_b128 v[148:151], v10 offset:9216
v_mfma_f32_16x16x32_bf16 a[140:143], v[80:83], v[108:111], a[140:143]
buffer_load_dwordx4 v15, s[12:15], s66 offen offset:3072 lds
v_mfma_f32_16x16x32_bf16 a[144:147], v[80:83], v[112:115], a[144:147]
v_mfma_f32_16x16x32_bf16 a[148:151], v[80:83], v[116:119], a[148:151]
ds_read_b64_tr_b16 v[180:181], v22 offset:16384
v_mfma_f32_16x16x32_bf16 a[152:155], v[80:83], v[120:123], a[152:155]
v_mfma_f32_16x16x32_bf16 a[156:159], v[80:83], v[124:127], a[156:159]
ds_read_b64_tr_b16 v[182:183], v22 offset:18432
v_mfma_f32_16x16x32_bf16 a[160:163], v[84:87], v[96:99], a[160:163]
v_mfma_f32_16x16x32_bf16 a[164:167], v[84:87], v[100:103], a[164:167]
ds_read_b128 v[152:155], v10 offset:12288
v_mfma_f32_16x16x32_bf16 a[168:171], v[84:87], v[104:107], a[168:171]
s_add_u32 s66, s66, 262144
v_mfma_f32_16x16x32_bf16 a[172:175], v[84:87], v[108:111], a[172:175]
ds_read_b64_tr_b16 v[184:185], v23 offset:16384
v_mfma_f32_16x16x32_bf16 a[176:179], v[84:87], v[112:115], a[176:179]
v_mfma_f32_16x16x32_bf16 a[180:183], v[84:87], v[116:119], a[180:183]
v_mfma_f32_16x16x32_bf16 a[184:187], v[84:87], v[120:123], a[184:187]
ds_read_b64_tr_b16 v[186:187], v23 offset:18432
v_mfma_f32_16x16x32_bf16 a[188:191], v[84:87], v[124:127], a[188:191]
v_mfma_f32_16x16x32_bf16 a[192:195], v[88:91], v[96:99], a[192:195]
ds_read_b128 v[156:159], v10 offset:13312
v_mfma_f32_16x16x32_bf16 a[196:199], v[88:91], v[100:103], a[196:199]
v_mfma_f32_16x16x32_bf16 a[200:203], v[88:91], v[104:107], a[200:203]
ds_read_b64_tr_b16 v[188:189], v24 offset:16384
global_load_dword v59, v29, s[92:93] sc1
v_mfma_f32_16x16x32_bf16 a[204:207], v[88:91], v[108:111], a[204:207]
v_mfma_f32_16x16x32_bf16 a[208:211], v[88:91], v[112:115], a[208:211]
ds_read_b64_tr_b16 v[190:191], v24 offset:18432
v_mfma_f32_16x16x32_bf16 a[212:215], v[88:91], v[116:119], a[212:215]
v_mfma_f32_16x16x32_bf16 a[216:219], v[88:91], v[120:123], a[216:219]
v_mfma_f32_16x16x32_bf16 a[220:223], v[88:91], v[124:127], a[220:223]
v_mfma_f32_16x16x32_bf16 a[224:227], v[92:95], v[96:99], a[224:227]
v_mfma_f32_16x16x32_bf16 a[228:231], v[92:95], v[100:103], a[228:231]
v_mfma_f32_16x16x32_bf16 a[232:235], v[92:95], v[104:107], a[232:235]
v_mfma_f32_16x16x32_bf16 a[236:239], v[92:95], v[108:111], a[236:239]
v_mfma_f32_16x16x32_bf16 a[240:243], v[92:95], v[112:115], a[240:243]
v_mfma_f32_16x16x32_bf16 a[244:247], v[92:95], v[116:119], a[244:247]
v_mfma_f32_16x16x32_bf16 a[248:251], v[92:95], v[120:123], a[248:251]
v_mfma_f32_16x16x32_bf16 a[252:255], v[92:95], v[124:127], a[252:255]
s_waitcnt lgkmcnt(0)
v_mfma_f32_16x16x32_bf16 a[0:3], v[128:131], v[160:163], a[0:3]
s_waitcnt vmcnt(9)
s_barrier
v_mfma_f32_16x16x32_bf16 a[4:7], v[128:131], v[164:167], a[4:7]
ds_read_b128 v[64:67], v16 offset:32768
v_mfma_f32_16x16x32_bf16 a[8:11], v[128:131], v[168:171], a[8:11]
s_add_u32 m0, s63, 0
v_mfma_f32_16x16x32_bf16 a[12:15], v[128:131], v[172:175], a[12:15]
ds_read_b64_tr_b16 v[96:97], v17 offset:32768
s_add_u32 s62, s65, 0
v_mfma_f32_16x16x32_bf16 a[16:19], v[128:131], v[176:179], a[16:19]
v_mfma_f32_16x16x32_bf16 a[20:23], v[128:131], v[180:183], a[20:23]
ds_read_b64_tr_b16 v[98:99], v17 offset:34816
buffer_load_dwordx4 v8, s[8:11], s62 offen lds
v_mfma_f32_16x16x32_bf16 a[24:27], v[128:131], v[184:187], a[24:27]
v_mfma_f32_16x16x32_bf16 a[28:31], v[128:131], v[188:191], a[28:31]
ds_read_b128 v[68:71], v16 offset:33792
s_add_u32 s62, s65, 15360
v_mfma_f32_16x16x32_bf16 a[32:35], v[132:135], v[160:163], a[32:35]
v_mfma_f32_16x16x32_bf16 a[36:39], v[132:135], v[164:167], a[36:39]
buffer_load_dwordx4 v8, s[8:11], s62 offen offset:1024 lds
v_mfma_f32_16x16x32_bf16 a[40:43], v[132:135], v[168:171], a[40:43]
ds_read_b64_tr_b16 v[100:101], v18 offset:32768
v_mfma_f32_16x16x32_bf16 a[44:47], v[132:135], v[172:175], a[44:47]
s_add_u32 s62, s65, 30720
v_mfma_f32_16x16x32_bf16 a[48:51], v[132:135], v[176:179], a[48:51]
ds_read_b64_tr_b16 v[102:103], v18 offset:34816
buffer_load_dwordx4 v9, s[8:11], s62 offen offset:2048 lds
v_mfma_f32_16x16x32_bf16 a[52:55], v[132:135], v[180:183], a[52:55]
v_mfma_f32_16x16x32_bf16 a[56:59], v[132:135], v[184:187], a[56:59]
ds_read_b128 v[72:75], v16 offset:36864
s_add_u32 s62, s65, 46080
v_mfma_f32_16x16x32_bf16 a[60:63], v[132:135], v[188:191], a[60:63]
v_mfma_f32_16x16x32_bf16 a[64:67], v[136:139], v[160:163], a[64:67]
ds_read_b64_tr_b16 v[104:105], v19 offset:32768
buffer_load_dwordx4 v9, s[8:11], s62 offen offset:3072 lds
v_mfma_f32_16x16x32_bf16 a[68:71], v[136:139], v[164:167], a[68:71]
v_mfma_f32_16x16x32_bf16 a[72:75], v[136:139], v[168:171], a[72:75]
s_add_u32 m0, s63, 4096
v_mfma_f32_16x16x32_bf16 a[76:79], v[136:139], v[172:175], a[76:79]
ds_read_b64_tr_b16 v[106:107], v19 offset:34816
v_mfma_f32_16x16x32_bf16 a[80:83], v[136:139], v[176:179], a[80:83]
s_add_u32 s62, s65, 65536
v_mfma_f32_16x16x32_bf16 a[84:87], v[136:139], v[180:183], a[84:87]
ds_read_b128 v[76:79], v16 offset:37888
buffer_load_dwordx4 v8, s[8:11], s62 offen lds
v_mfma_f32_16x16x32_bf16 a[88:91], v[136:139], v[184:187], a[88:91]
v_mfma_f32_16x16x32_bf16 a[92:95], v[136:139], v[188:191], a[92:95]
ds_read_b64_tr_b16 v[108:109], v20 offset:32768
s_add_u32 s62, s65, 80896
v_mfma_f32_16x16x32_bf16 a[96:99], v[140:143], v[160:163], a[96:99]
v_mfma_f32_16x16x32_bf16 a[100:103], v[140:143], v[164:167], a[100:103]
ds_read_b64_tr_b16 v[110:111], v20 offset:34816
buffer_load_dwordx4 v8, s[8:11], s62 offen offset:1024 lds
v_mfma_f32_16x16x32_bf16 a[104:107], v[140:143], v[168:171], a[104:107]
v_mfma_f32_16x16x32_bf16 a[108:111], v[140:143], v[172:175], a[108:111]
s_add_u32 s62, s65, 96256
v_mfma_f32_16x16x32_bf16 a[112:115], v[140:143], v[176:179], a[112:115]
ds_read_b128 v[80:83], v16 offset:40960
v_mfma_f32_16x16x32_bf16 a[116:119], v[140:143], v[180:183], a[116:119]
buffer_load_dwordx4 v9, s[8:11], s62 offen offset:2048 lds
v_mfma_f32_16x16x32_bf16 a[120:123], v[140:143], v[184:187], a[120:123]
ds_read_b64_tr_b16 v[112:113], v21 offset:32768
s_add_u32 s62, s65, 111616
v_mfma_f32_16x16x32_bf16 a[124:127], v[140:143], v[188:191], a[124:127]
v_mfma_f32_16x16x32_bf16 a[128:131], v[144:147], v[160:163], a[128:131]
ds_read_b64_tr_b16 v[114:115], v21 offset:34816
buffer_load_dwordx4 v9, s[8:11], s62 offen offset:3072 lds
v_mfma_f32_16x16x32_bf16 a[132:135], v[144:147], v[164:167], a[132:135]
v_mfma_f32_16x16x32_bf16 a[136:139], v[144:147], v[168:171], a[136:139]
ds_read_b128 v[84:87], v16 offset:41984
s_add_u32 s65, s65, 128
v_mfma_f32_16x16x32_bf16 a[140:143], v[144:147], v[172:175], a[140:143]
v_mfma_f32_16x16x32_bf16 a[144:147], v[144:147], v[176:179], a[144:147]
s_add_u32 m0, s64, 81920
v_mfma_f32_16x16x32_bf16 a[148:151], v[144:147], v[180:183], a[148:151]
ds_read_b64_tr_b16 v[116:117], v22 offset:32768
v_mfma_f32_16x16x32_bf16 a[152:155], v[144:147], v[184:187], a[152:155]
s_nop 0
v_mfma_f32_16x16x32_bf16 a[156:159], v[144:147], v[188:191], a[156:159]
ds_read_b64_tr_b16 v[118:119], v22 offset:34816
buffer_load_dwordx4 v12, s[12:15], s66 offen lds
v_mfma_f32_16x16x32_bf16 a[160:163], v[148:151], v[160:163], a[160:163]
v_mfma_f32_16x16x32_bf16 a[164:167], v[148:151], v[164:167], a[164:167]
ds_read_b128 v[88:91], v16 offset:45056
buffer_load_dwordx4 v13, s[12:15], s66 offen offset:1024 lds
v_mfma_f32_16x16x32_bf16 a[168:171], v[148:151], v[168:171], a[168:171]
v_mfma_f32_16x16x32_bf16 a[172:175], v[148:151], v[172:175], a[172:175]
ds_read_b64_tr_b16 v[120:121], v23 offset:32768
buffer_load_dwordx4 v14, s[12:15], s66 offen offset:2048 lds
v_mfma_f32_16x16x32_bf16 a[176:179], v[148:151], v[176:179], a[176:179]
v_mfma_f32_16x16x32_bf16 a[180:183], v[148:151], v[180:183], a[180:183]
buffer_load_dwordx4 v15, s[12:15], s66 offen offset:3072 lds
v_mfma_f32_16x16x32_bf16 a[184:187], v[148:151], v[184:187], a[184:187]
ds_read_b64_tr_b16 v[122:123], v23 offset:34816
v_mfma_f32_16x16x32_bf16 a[188:191], v[148:151], v[188:191], a[188:191]
s_add_u32 s66, s66, 262144
v_mfma_f32_16x16x32_bf16 a[192:195], v[152:155], v[160:163], a[192:195]
ds_read_b128 v[92:95], v16 offset:46080
v_mfma_f32_16x16x32_bf16 a[196:199], v[152:155], v[164:167], a[196:199]
v_mfma_f32_16x16x32_bf16 a[200:203], v[152:155], v[168:171], a[200:203]
ds_read_b64_tr_b16 v[124:125], v24 offset:32768
v_add_u32 v242, 0x100000, v242
global_load_dword v245, v242, s[98:99]
v_mfma_f32_16x16x32_bf16 a[204:207], v[152:155], v[172:175], a[204:207]
v_mfma_f32_16x16x32_bf16 a[208:211], v[152:155], v[176:179], a[208:211]
ds_read_b64_tr_b16 v[126:127], v24 offset:34816
v_mfma_f32_16x16x32_bf16 a[212:215], v[152:155], v[180:183], a[212:215]
v_mfma_f32_16x16x32_bf16 a[216:219], v[152:155], v[184:187], a[216:219]
v_mfma_f32_16x16x32_bf16 a[220:223], v[152:155], v[188:191], a[220:223]
v_mfma_f32_16x16x32_bf16 a[224:227], v[156:159], v[160:163], a[224:227]
v_mfma_f32_16x16x32_bf16 a[228:231], v[156:159], v[164:167], a[228:231]
v_mfma_f32_16x16x32_bf16 a[232:235], v[156:159], v[168:171], a[232:235]
v_mfma_f32_16x16x32_bf16 a[236:239], v[156:159], v[172:175], a[236:239]
v_mfma_f32_16x16x32_bf16 a[240:243], v[156:159], v[176:179], a[240:243]
v_mfma_f32_16x16x32_bf16 a[244:247], v[156:159], v[180:183], a[244:247]
v_mfma_f32_16x16x32_bf16 a[248:251], v[156:159], v[184:187], a[248:251]
v_mfma_f32_16x16x32_bf16 a[252:255], v[156:159], v[188:191], a[252:255]
s_waitcnt lgkmcnt(0)
v_mfma_f32_16x16x32_bf16 a[0:3], v[64:67], v[96:99], a[0:3]
s_waitcnt vmcnt(18)
s_barrier
v_mfma_f32_16x16x32_bf16 a[4:7], v[64:67], v[100:103], a[4:7]
ds_read_b128 v[128:131], v10 offset:32768
v_mfma_f32_16x16x32_bf16 a[8:11], v[64:67], v[104:107], a[8:11]
s_add_u32 m0, s64, 98304
v_mfma_f32_16x16x32_bf16 a[12:15], v[64:67], v[108:111], a[12:15]
ds_read_b64_tr_b16 v[160:161], v17 offset:49152
v_mfma_f32_16x16x32_bf16 a[16:19], v[64:67], v[112:115], a[16:19]
v_mfma_f32_16x16x32_bf16 a[20:23], v[64:67], v[116:119], a[20:23]
ds_read_b64_tr_b16 v[162:163], v17 offset:51200
v_mfma_f32_16x16x32_bf16 a[24:27], v[64:67], v[120:123], a[24:27]
v_mfma_f32_16x16x32_bf16 a[28:31], v[64:67], v[124:127], a[28:31]
ds_read_b128 v[132:135], v10 offset:33792
v_mfma_f32_16x16x32_bf16 a[32:35], v[68:71], v[96:99], a[32:35]
s_nop 0
v_mfma_f32_16x16x32_bf16 a[36:39], v[68:71], v[100:103], a[36:39]
v_mfma_f32_16x16x32_bf16 a[40:43], v[68:71], v[104:107], a[40:43]
ds_read_b64_tr_b16 v[164:165], v18 offset:49152
v_mfma_f32_16x16x32_bf16 a[44:47], v[68:71], v[108:111], a[44:47]
v_mfma_f32_16x16x32_bf16 a[48:51], v[68:71], v[112:115], a[48:51]
ds_read_b64_tr_b16 v[166:167], v18 offset:51200
v_mfma_f32_16x16x32_bf16 a[52:55], v[68:71], v[116:119], a[52:55]
v_mfma_f32_16x16x32_bf16 a[56:59], v[68:71], v[120:123], a[56:59]
ds_read_b128 v[136:139], v10 offset:36864
v_mfma_f32_16x16x32_bf16 a[60:63], v[68:71], v[124:127], a[60:63]
buffer_load_dwordx4 v12, s[12:15], s66 offen lds
v_mfma_f32_16x16x32_bf16 a[64:67], v[72:75], v[96:99], a[64:67]
ds_read_b64_tr_b16 v[168:169], v19 offset:49152
v_mfma_f32_16x16x32_bf16 a[68:71], v[72:75], v[100:103], a[68:71]
v_mfma_f32_16x16x32_bf16 a[72:75], v[72:75], v[104:107], a[72:75]
v_mfma_f32_16x16x32_bf16 a[76:79], v[72:75], v[108:111], a[76:79]
ds_read_b64_tr_b16 v[170:171], v19 offset:51200
v_mfma_f32_16x16x32_bf16 a[80:83], v[72:75], v[112:115], a[80:83]
v_mfma_f32_16x16x32_bf16 a[84:87], v[72:75], v[116:119], a[84:87]
ds_read_b128 v[140:143], v10 offset:37888
v_mfma_f32_16x16x32_bf16 a[88:91], v[72:75], v[120:123], a[88:91]
buffer_load_dwordx4 v13, s[12:15], s66 offen offset:1024 lds
v_mfma_f32_16x16x32_bf16 a[92:95], v[72:75], v[124:127], a[92:95]
ds_read_b64_tr_b16 v[172:173], v20 offset:49152
v_mfma_f32_16x16x32_bf16 a[96:99], v[76:79], v[96:99], a[96:99]
v_mfma_f32_16x16x32_bf16 a[100:103], v[76:79], v[100:103], a[100:103]
ds_read_b64_tr_b16 v[174:175], v20 offset:51200
v_mfma_f32_16x16x32_bf16 a[104:107], v[76:79], v[104:107], a[104:107]
v_mfma_f32_16x16x32_bf16 a[108:111], v[76:79], v[108:111], a[108:111]
v_mfma_f32_16x16x32_bf16 a[112:115], v[76:79], v[112:115], a[112:115]
ds_read_b128 v[144:147], v10 offset:40960
buffer_load_dwordx4 v14, s[12:15], s66 offen offset:2048 lds
v_mfma_f32_16x16x32_bf16 a[116:119], v[76:79], v[116:119], a[116:119]
v_mfma_f32_16x16x32_bf16 a[120:123], v[76:79], v[120:123], a[120:123]
ds_read_b64_tr_b16 v[176:177], v21 offset:49152
v_mfma_f32_16x16x32_bf16 a[124:127], v[76:79], v[124:127], a[124:127]
v_mfma_f32_16x16x32_bf16 a[128:131], v[80:83], v[96:99], a[128:131]
ds_read_b64_tr_b16 v[178:179], v21 offset:51200
v_mfma_f32_16x16x32_bf16 a[132:135], v[80:83], v[100:103], a[132:135]
v_mfma_f32_16x16x32_bf16 a[136:139], v[80:83], v[104:107], a[136:139]
ds_read_b128 v[148:151], v10 offset:41984
v_mfma_f32_16x16x32_bf16 a[140:143], v[80:83], v[108:111], a[140:143]
buffer_load_dwordx4 v15, s[12:15], s66 offen offset:3072 lds
v_mfma_f32_16x16x32_bf16 a[144:147], v[80:83], v[112:115], a[144:147]
v_mfma_f32_16x16x32_bf16 a[148:151], v[80:83], v[116:119], a[148:151]
ds_read_b64_tr_b16 v[180:181], v22 offset:49152
v_mfma_f32_16x16x32_bf16 a[152:155], v[80:83], v[120:123], a[152:155]
v_mfma_f32_16x16x32_bf16 a[156:159], v[80:83], v[124:127], a[156:159]
ds_read_b64_tr_b16 v[182:183], v22 offset:51200
v_mfma_f32_16x16x32_bf16 a[160:163], v[84:87], v[96:99], a[160:163]
v_mfma_f32_16x16x32_bf16 a[164:167], v[84:87], v[100:103], a[164:167]
ds_read_b128 v[152:155], v10 offset:45056
v_mfma_f32_16x16x32_bf16 a[168:171], v[84:87], v[104:107], a[168:171]
s_add_u32 s66, s66, 262144
v_mfma_f32_16x16x32_bf16 a[172:175], v[84:87], v[108:111], a[172:175]
ds_read_b64_tr_b16 v[184:185], v23 offset:49152
v_mfma_f32_16x16x32_bf16 a[176:179], v[84:87], v[112:115], a[176:179]
v_mfma_f32_16x16x32_bf16 a[180:183], v[84:87], v[116:119], a[180:183]
v_mfma_f32_16x16x32_bf16 a[184:187], v[84:87], v[120:123], a[184:187]
ds_read_b64_tr_b16 v[186:187], v23 offset:51200
v_mfma_f32_16x16x32_bf16 a[188:191], v[84:87], v[124:127], a[188:191]
v_mfma_f32_16x16x32_bf16 a[192:195], v[88:91], v[96:99], a[192:195]
ds_read_b128 v[156:159], v10 offset:46080
v_mfma_f32_16x16x32_bf16 a[196:199], v[88:91], v[100:103], a[196:199]
v_mfma_f32_16x16x32_bf16 a[200:203], v[88:91], v[104:107], a[200:203]
ds_read_b64_tr_b16 v[188:189], v24 offset:49152
v_mfma_f32_16x16x32_bf16 a[204:207], v[88:91], v[108:111], a[204:207]
v_mfma_f32_16x16x32_bf16 a[208:211], v[88:91], v[112:115], a[208:211]
ds_read_b64_tr_b16 v[190:191], v24 offset:51200
v_mfma_f32_16x16x32_bf16 a[212:215], v[88:91], v[116:119], a[212:215]
v_mfma_f32_16x16x32_bf16 a[216:219], v[88:91], v[120:123], a[216:219]
v_mfma_f32_16x16x32_bf16 a[220:223], v[88:91], v[124:127], a[220:223]
v_mfma_f32_16x16x32_bf16 a[224:227], v[92:95], v[96:99], a[224:227]
v_mfma_f32_16x16x32_bf16 a[228:231], v[92:95], v[100:103], a[228:231]
v_mfma_f32_16x16x32_bf16 a[232:235], v[92:95], v[104:107], a[232:235]
v_mfma_f32_16x16x32_bf16 a[236:239], v[92:95], v[108:111], a[236:239]
v_mfma_f32_16x16x32_bf16 a[240:243], v[92:95], v[112:115], a[240:243]
v_mfma_f32_16x16x32_bf16 a[244:247], v[92:95], v[116:119], a[244:247]
v_mfma_f32_16x16x32_bf16 a[248:251], v[92:95], v[120:123], a[248:251]
v_mfma_f32_16x16x32_bf16 a[252:255], v[92:95], v[124:127], a[252:255]
s_waitcnt lgkmcnt(0)
v_mfma_f32_16x16x32_bf16 a[0:3], v[128:131], v[160:163], a[0:3]
s_waitcnt vmcnt(9)
s_barrier
v_mfma_f32_16x16x32_bf16 a[4:7], v[128:131], v[164:167], a[4:7]
ds_read_b128 v[64:67], v16
v_mfma_f32_16x16x32_bf16 a[8:11], v[128:131], v[168:171], a[8:11]
s_add_u32 m0, s63, 32768
v_mfma_f32_16x16x32_bf16 a[12:15], v[128:131], v[172:175], a[12:15]
ds_read_b64_tr_b16 v[96:97], v17
s_add_u32 s62, s65, 0
v_mfma_f32_16x16x32_bf16 a[16:19], v[128:131], v[176:179], a[16:19]
v_mfma_f32_16x16x32_bf16 a[20:23], v[128:131], v[180:183], a[20:23]
ds_read_b64_tr_b16 v[98:99], v17 offset:2048
buffer_load_dwordx4 v8, s[8:11], s62 offen lds
v_mfma_f32_16x16x32_bf16 a[24:27], v[128:131], v[184:187], a[24:27]
v_mfma_f32_16x16x32_bf16 a[28:31], v[128:131], v[188:191], a[28:31]
ds_read_b128 v[68:71], v16 offset:1024
s_add_u32 s62, s65, 15360
v_mfma_f32_16x16x32_bf16 a[32:35], v[132:135], v[160:163], a[32:35]
v_mfma_f32_16x16x32_bf16 a[36:39], v[132:135], v[164:167], a[36:39]
buffer_load_dwordx4 v8, s[8:11], s62 offen offset:1024 lds
v_mfma_f32_16x16x32_bf16 a[40:43], v[132:135], v[168:171], a[40:43]
ds_read_b64_tr_b16 v[100:101], v18
v_mfma_f32_16x16x32_bf16 a[44:47], v[132:135], v[172:175], a[44:47]
s_add_u32 s62, s65, 30720
v_mfma_f32_16x16x32_bf16 a[48:51], v[132:135], v[176:179], a[48:51]
ds_read_b64_tr_b16 v[102:103], v18 offset:2048
buffer_load_dwordx4 v9, s[8:11], s62 offen offset:2048 lds
v_mfma_f32_16x16x32_bf16 a[52:55], v[132:135], v[180:183], a[52:55]
v_mfma_f32_16x16x32_bf16 a[56:59], v[132:135], v[184:187], a[56:59]
ds_read_b128 v[72:75], v16 offset:4096
s_add_u32 s62, s65, 46080
v_mfma_f32_16x16x32_bf16 a[60:63], v[132:135], v[188:191], a[60:63]
v_mfma_f32_16x16x32_bf16 a[64:67], v[136:139], v[160:163], a[64:67]
ds_read_b64_tr_b16 v[104:105], v19
buffer_load_dwordx4 v9, s[8:11], s62 offen offset:3072 lds
v_mfma_f32_16x16x32_bf16 a[68:71], v[136:139], v[164:167], a[68:71]
v_mfma_f32_16x16x32_bf16 a[72:75], v[136:139], v[168:171], a[72:75]
s_add_u32 m0, s63, 36864
v_mfma_f32_16x16x32_bf16 a[76:79], v[136:139], v[172:175], a[76:79]
ds_read_b64_tr_b16 v[106:107], v19 offset:2048
v_mfma_f32_16x16x32_bf16 a[80:83], v[136:139], v[176:179], a[80:83]
s_add_u32 s62, s65, 65536
v_mfma_f32_16x16x32_bf16 a[84:87], v[136:139], v[180:183], a[84:87]
ds_read_b128 v[76:79], v16 offset:5120
buffer_load_dwordx4 v8, s[8:11], s62 offen lds
v_mfma_f32_16x16x32_bf16 a[88:91], v[136:139], v[184:187], a[88:91]
v_mfma_f32_16x16x32_bf16 a[92:95], v[136:139], v[188:191], a[92:95]
ds_read_b64_tr_b16 v[108:109], v20
s_add_u32 s62, s65, 80896
v_mfma_f32_16x16x32_bf16 a[96:99], v[140:143], v[160:163], a[96:99]
v_mfma_f32_16x16x32_bf16 a[100:103], v[140:143], v[164:167], a[100:103]
ds_read_b64_tr_b16 v[110:111], v20 offset:2048
buffer_load_dwordx4 v8, s[8:11], s62 offen offset:1024 lds
v_mfma_f32_16x16x32_bf16 a[104:107], v[140:143], v[168:171], a[104:107]
v_mfma_f32_16x16x32_bf16 a[108:111], v[140:143], v[172:175], a[108:111]
s_add_u32 s62, s65, 96256
v_mfma_f32_16x16x32_bf16 a[112:115], v[140:143], v[176:179], a[112:115]
ds_read_b128 v[80:83], v16 offset:8192
v_mfma_f32_16x16x32_bf16 a[116:119], v[140:143], v[180:183], a[116:119]
buffer_load_dwordx4 v9, s[8:11], s62 offen offset:2048 lds
v_mfma_f32_16x16x32_bf16 a[120:123], v[140:143], v[184:187], a[120:123]
ds_read_b64_tr_b16 v[112:113], v21
s_add_u32 s62, s65, 111616
v_mfma_f32_16x16x32_bf16 a[124:127], v[140:143], v[188:191], a[124:127]
v_mfma_f32_16x16x32_bf16 a[128:131], v[144:147], v[160:163], a[128:131]
ds_read_b64_tr_b16 v[114:115], v21 offset:2048
buffer_load_dwordx4 v9, s[8:11], s62 offen offset:3072 lds
v_mfma_f32_16x16x32_bf16 a[132:135], v[144:147], v[164:167], a[132:135]
v_mfma_f32_16x16x32_bf16 a[136:139], v[144:147], v[168:171], a[136:139]
ds_read_b128 v[84:87], v16 offset:9216
s_add_u32 s65, s65, 128
v_mfma_f32_16x16x32_bf16 a[140:143], v[144:147], v[172:175], a[140:143]
v_mfma_f32_16x16x32_bf16 a[144:147], v[144:147], v[176:179], a[144:147]
s_add_u32 m0, s64, 114688
v_mfma_f32_16x16x32_bf16 a[148:151], v[144:147], v[180:183], a[148:151]
ds_read_b64_tr_b16 v[116:117], v22
v_mfma_f32_16x16x32_bf16 a[152:155], v[144:147], v[184:187], a[152:155]
s_nop 0
v_mfma_f32_16x16x32_bf16 a[156:159], v[144:147], v[188:191], a[156:159]
ds_read_b64_tr_b16 v[118:119], v22 offset:2048
buffer_load_dwordx4 v12, s[12:15], s66 offen lds
v_mfma_f32_16x16x32_bf16 a[160:163], v[148:151], v[160:163], a[160:163]
v_mfma_f32_16x16x32_bf16 a[164:167], v[148:151], v[164:167], a[164:167]
ds_read_b128 v[88:91], v16 offset:12288
buffer_load_dwordx4 v13, s[12:15], s66 offen offset:1024 lds
v_mfma_f32_16x16x32_bf16 a[168:171], v[148:151], v[168:171], a[168:171]
v_mfma_f32_16x16x32_bf16 a[172:175], v[148:151], v[172:175], a[172:175]
ds_read_b64_tr_b16 v[120:121], v23
buffer_load_dwordx4 v14, s[12:15], s66 offen offset:2048 lds
v_mfma_f32_16x16x32_bf16 a[176:179], v[148:151], v[176:179], a[176:179]
v_mfma_f32_16x16x32_bf16 a[180:183], v[148:151], v[180:183], a[180:183]
buffer_load_dwordx4 v15, s[12:15], s66 offen offset:3072 lds
v_mfma_f32_16x16x32_bf16 a[184:187], v[148:151], v[184:187], a[184:187]
ds_read_b64_tr_b16 v[122:123], v23 offset:2048
v_mfma_f32_16x16x32_bf16 a[188:191], v[148:151], v[188:191], a[188:191]
s_add_u32 s66, s66, 262144
v_mfma_f32_16x16x32_bf16 a[192:195], v[152:155], v[160:163], a[192:195]
ds_read_b128 v[92:95], v16 offset:13312
v_mfma_f32_16x16x32_bf16 a[196:199], v[152:155], v[164:167], a[196:199]
v_mfma_f32_16x16x32_bf16 a[200:203], v[152:155], v[168:171], a[200:203]
ds_read_b64_tr_b16 v[124:125], v24
s_waitcnt vmcnt(29)
s_mov_b32 s87, 0
DBG_7:
v_cmp_ne_u32 vcc, 1, v59
s_cbranch_vccz DBG_7_OK
s_sleep 1
global_load_dword v59, v29, s[92:93] sc1
s_waitcnt vmcnt(0)
s_add_u32 s87, s87, 1
s_cmp_lt_u32 s87, 65536
s_cbranch_scc1 DBG_7
DBG_7_OK:
v_mfma_f32_16x16x32_bf16 a[204:207], v[152:155], v[172:175], a[204:207]
v_mfma_f32_16x16x32_bf16 a[208:211], v[152:155], v[176:179], a[208:211]
ds_read_b64_tr_b16 v[126:127], v24 offset:2048
v_mfma_f32_16x16x32_bf16 a[212:215], v[152:155], v[180:183], a[212:215]
v_mfma_f32_16x16x32_bf16 a[216:219], v[152:155], v[184:187], a[216:219]
v_mfma_f32_16x16x32_bf16 a[220:223], v[152:155], v[188:191], a[220:223]
v_mfma_f32_16x16x32_bf16 a[224:227], v[156:159], v[160:163], a[224:227]
v_mfma_f32_16x16x32_bf16 a[228:231], v[156:159], v[164:167], a[228:231]
v_mfma_f32_16x16x32_bf16 a[232:235], v[156:159], v[168:171], a[232:235]
v_mfma_f32_16x16x32_bf16 a[236:239], v[156:159], v[172:175], a[236:239]
v_mfma_f32_16x16x32_bf16 a[240:243], v[156:159], v[176:179], a[240:243]
v_mfma_f32_16x16x32_bf16 a[244:247], v[156:159], v[180:183], a[244:247]
v_mfma_f32_16x16x32_bf16 a[248:251], v[156:159], v[184:187], a[248:251]
v_mfma_f32_16x16x32_bf16 a[252:255], v[156:159], v[188:191], a[252:255]
s_waitcnt lgkmcnt(0)
v_mfma_f32_16x16x32_bf16 a[0:3], v[64:67], v[96:99], a[0:3]
s_waitcnt vmcnt(17)
s_barrier
s_lshl_b32 s56, s2, 2
s_cmp_lg_u32 s3, 0
s_cbranch_scc1 SETF_8
s_mov_b64 exec, 1
buffer_store_dword v30, v29, s[88:91], s56 offen sc1
s_mov_b64 exec, -1
SETF_8:
v_mfma_f32_16x16x32_bf16 a[4:7], v[64:67], v[100:103], a[4:7]
ds_read_b128 v[128:131], v10
v_mfma_f32_16x16x32_bf16 a[8:11], v[64:67], v[104:107], a[8:11]
s_add_u32 m0, s64, 65536
v_mfma_f32_16x16x32_bf16 a[12:15], v[64:67], v[108:111], a[12:15]
ds_read_b64_tr_b16 v[160:161], v17 offset:16384
v_mfma_f32_16x16x32_bf16 a[16:19], v[64:67], v[112:115], a[16:19]
v_mfma_f32_16x16x32_bf16 a[20:23], v[64:67], v[116:119], a[20:23]
ds_read_b64_tr_b16 v[162:163], v17 offset:18432
v_mfma_f32_16x16x32_bf16 a[24:27], v[64:67], v[120:123], a[24:27]
v_mfma_f32_16x16x32_bf16 a[28:31], v[64:67], v[124:127], a[28:31]
ds_read_b128 v[132:135], v10 offset:1024
v_mfma_f32_16x16x32_bf16 a[32:35], v[68:71], v[96:99], a[32:35]
s_nop 0
v_mfma_f32_16x16x32_bf16 a[36:39], v[68:71], v[100:103], a[36:39]
v_mfma_f32_16x16x32_bf16 a[40:43], v[68:71], v[104:107], a[40:43]
ds_read_b64_tr_b16 v[164:165], v18 offset:16384
v_mfma_f32_16x16x32_bf16 a[44:47], v[68:71], v[108:111], a[44:47]
v_mfma_f32_16x16x32_bf16 a[48:51], v[68:71], v[112:115], a[48:51]
ds_read_b64_tr_b16 v[166:167], v18 offset:18432
v_mfma_f32_16x16x32_bf16 a[52:55], v[68:71], v[116:119], a[52:55]
v_mfma_f32_16x16x32_bf16 a[56:59], v[68:71], v[120:123], a[56:59]
ds_read_b128 v[136:139], v10 offset:4096
v_mfma_f32_16x16x32_bf16 a[60:63], v[68:71], v[124:127], a[60:63]
buffer_load_dwordx4 v12, s[12:15], s66 offen lds
v_mfma_f32_16x16x32_bf16 a[64:67], v[72:75], v[96:99], a[64:67]
ds_read_b64_tr_b16 v[168:169], v19 offset:16384
v_mfma_f32_16x16x32_bf16 a[68:71], v[72:75], v[100:103], a[68:71]
v_mfma_f32_16x16x32_bf16 a[72:75], v[72:75], v[104:107], a[72:75]
v_mfma_f32_16x16x32_bf16 a[76:79], v[72:75], v[108:111], a[76:79]
ds_read_b64_tr_b16 v[170:171], v19 offset:18432
v_mfma_f32_16x16x32_bf16 a[80:83], v[72:75], v[112:115], a[80:83]
v_mfma_f32_16x16x32_bf16 a[84:87], v[72:75], v[116:119], a[84:87]
ds_read_b128 v[140:143], v10 offset:5120
v_mfma_f32_16x16x32_bf16 a[88:91], v[72:75], v[120:123], a[88:91]
buffer_load_dwordx4 v13, s[12:15], s66 offen offset:1024 lds
v_mfma_f32_16x16x32_bf16 a[92:95], v[72:75], v[124:127], a[92:95]
ds_read_b64_tr_b16 v[172:173], v20 offset:16384
v_mfma_f32_16x16x32_bf16 a[96:99], v[76:79], v[96:99], a[96:99]
v_mfma_f32_16x16x32_bf16 a[100:103], v[76:79], v[100:103], a[100:103]
ds_read_b64_tr_b16 v[174:175], v20 offset:18432
v_mfma_f32_16x16x32_bf16 a[104:107], v[76:79], v[104:107], a[104:107]
v_mfma_f32_16x16x32_bf16 a[108:111], v[76:79], v[108:111], a[108:111]
v_mfma_f32_16x16x32_bf16 a[112:115], v[76:79], v[112:115], a[112:115]
ds_read_b128 v[144:147], v10 offset:8192
buffer_load_dwordx4 v14, s[12:15], s66 offen offset:2048 lds
v_mfma_f32_16x16x32_bf16 a[116:119], v[76:79], v[116:119], a[116:119]
v_mfma_f32_16x16x32_bf16 a[120:123], v[76:79], v[120:123], a[120:123]
ds_read_b64_tr_b16 v[176:177], v21 offset:16384
v_mfma_f32_16x16x32_bf16 a[124:127], v[76:79], v[124:127], a[124:127]
v_mfma_f32_16x16x32_bf16 a[128:131], v[80:83], v[96:99], a[128:131]
ds_read_b64_tr_b16 v[178:179], v21 offset:18432
v_mfma_f32_16x16x32_bf16 a[132:135], v[80:83], v[100:103], a[132:135]
v_mfma_f32_16x16x32_bf16 a[136:139], v[80:83], v[104:107], a[136:139]
ds_read_b128 v[148:151], v10 offset:9216
v_mfma_f32_16x16x32_bf16 a[140:143], v[80:83], v[108:111], a[140:143]
buffer_load_dwordx4 v15, s[12:15], s66 offen offset:3072 lds
v_mfma_f32_16x16x32_bf16 a[144:147], v[80:83], v[112:115], a[144:147]
v_mfma_f32_16x16x32_bf16 a[148:151], v[80:83], v[116:119], a[148:151]
ds_read_b64_tr_b16 v[180:181], v22 offset:16384
v_mfma_f32_16x16x32_bf16 a[152:155], v[80:83], v[120:123], a[152:155]
v_mfma_f32_16x16x32_bf16 a[156:159], v[80:83], v[124:127], a[156:159]
ds_read_b64_tr_b16 v[182:183], v22 offset:18432
v_mfma_f32_16x16x32_bf16 a[160:163], v[84:87], v[96:99], a[160:163]
v_mfma_f32_16x16x32_bf16 a[164:167], v[84:87], v[100:103], a[164:167]
ds_read_b128 v[152:155], v10 offset:12288
v_mfma_f32_16x16x32_bf16 a[168:171], v[84:87], v[104:107], a[168:171]
s_add_u32 s66, s66, 262144
v_mfma_f32_16x16x32_bf16 a[172:175], v[84:87], v[108:111], a[172:175]
ds_read_b64_tr_b16 v[184:185], v23 offset:16384
v_mfma_f32_16x16x32_bf16 a[176:179], v[84:87], v[112:115], a[176:179]
v_mfma_f32_16x16x32_bf16 a[180:183], v[84:87], v[116:119], a[180:183]
v_mfma_f32_16x16x32_bf16 a[184:187], v[84:87], v[120:123], a[184:187]
ds_read_b64_tr_b16 v[186:187], v23 offset:18432
v_mfma_f32_16x16x32_bf16 a[188:191], v[84:87], v[124:127], a[188:191]
v_mfma_f32_16x16x32_bf16 a[192:195], v[88:91], v[96:99], a[192:195]
ds_read_b128 v[156:159], v10 offset:13312
v_mfma_f32_16x16x32_bf16 a[196:199], v[88:91], v[100:103], a[196:199]
v_mfma_f32_16x16x32_bf16 a[200:203], v[88:91], v[104:107], a[200:203]
ds_read_b64_tr_b16 v[188:189], v24 offset:16384
v_mfma_f32_16x16x32_bf16 a[204:207], v[88:91], v[108:111], a[204:207]
v_mfma_f32_16x16x32_bf16 a[208:211], v[88:91], v[112:115], a[208:211]
ds_read_b64_tr_b16 v[190:191], v24 offset:18432
v_mfma_f32_16x16x32_bf16 a[212:215], v[88:91], v[116:119], a[212:215]
v_mfma_f32_16x16x32_bf16 a[216:219], v[88:91], v[120:123], a[216:219]
v_mfma_f32_16x16x32_bf16 a[220:223], v[88:91], v[124:127], a[220:223]
v_mfma_f32_16x16x32_bf16 a[224:227], v[92:95], v[96:99], a[224:227]
v_mfma_f32_16x16x32_bf16 a[228:231], v[92:95], v[100:103], a[228:231]
v_mfma_f32_16x16x32_bf16 a[232:235], v[92:95], v[104:107], a[232:235]
v_mfma_f32_16x16x32_bf16 a[236:239], v[92:95], v[108:111], a[236:239]
v_mfma_f32_16x16x32_bf16 a[240:243], v[92:95], v[112:115], a[240:243]
v_mfma_f32_16x16x32_bf16 a[244:247], v[92:95], v[116:119], a[244:247]
v_mfma_f32_16x16x32_bf16 a[248:251], v[92:95], v[120:123], a[248:251]
v_mfma_f32_16x16x32_bf16 a[252:255], v[92:95], v[124:127], a[252:255]
s_waitcnt lgkmcnt(0)
v_mfma_f32_16x16x32_bf16 a[0:3], v[128:131], v[160:163], a[0:3]
s_waitcnt vmcnt(8)
s_barrier
v_mfma_f32_16x16x32_bf16 a[4:7], v[128:131], v[164:167], a[4:7]
ds_read_b128 v[64:67], v16 offset:32768
v_mfma_f32_16x16x32_bf16 a[8:11], v[128:131], v[168:171], a[8:11]
s_add_u32 m0, s63, 0
v_mfma_f32_16x16x32_bf16 a[12:15], v[128:131], v[172:175], a[12:15]
ds_read_b64_tr_b16 v[96:97], v17 offset:32768
s_add_u32 s62, s65, 0
v_mfma_f32_16x16x32_bf16 a[16:19], v[128:131], v[176:179], a[16:19]
v_mfma_f32_16x16x32_bf16 a[20:23], v[128:131], v[180:183], a[20:23]
ds_read_b64_tr_b16 v[98:99], v17 offset:34816
buffer_load_dwordx4 v8, s[8:11], s62 offen lds
v_mfma_f32_16x16x32_bf16 a[24:27], v[128:131], v[184:187], a[24:27]
v_mfma_f32_16x16x32_bf16 a[28:31], v[128:131], v[188:191], a[28:31]
ds_read_b128 v[68:71], v16 offset:33792
s_add_u32 s62, s65, 15360
v_mfma_f32_16x16x32_bf16 a[32:35], v[132:135], v[160:163], a[32:35]
v_mfma_f32_16x16x32_bf16 a[36:39], v[132:135], v[164:167], a[36:39]
buffer_load_dwordx4 v8, s[8:11], s62 offen offset:1024 lds
v_mfma_f32_16x16x32_bf16 a[40:43], v[132:135], v[168:171], a[40:43]
ds_read_b64_tr_b16 v[100:101], v18 offset:32768
v_mfma_f32_16x16x32_bf16 a[44:47], v[132:135], v[172:175], a[44:47]
s_add_u32 s62, s65, 30720
v_mfma_f32_16x16x32_bf16 a[48:51], v[132:135], v[176:179], a[48:51]
ds_read_b64_tr_b16 v[102:103], v18 offset:34816
buffer_load_dwordx4 v9, s[8:11], s62 offen offset:2048 lds
v_mfma_f32_16x16x32_bf16 a[52:55], v[132:135], v[180:183], a[52:55]
v_mfma_f32_16x16x32_bf16 a[56:59], v[132:135], v[184:187], a[56:59]
ds_read_b128 v[72:75], v16 offset:36864
s_add_u32 s62, s65, 46080
v_mfma_f32_16x16x32_bf16 a[60:63], v[132:135], v[188:191], a[60:63]
v_mfma_f32_16x16x32_bf16 a[64:67], v[136:139], v[160:163], a[64:67]
ds_read_b64_tr_b16 v[104:105], v19 offset:32768
buffer_load_dwordx4 v9, s[8:11], s62 offen offset:3072 lds
v_mfma_f32_16x16x32_bf16 a[68:71], v[136:139], v[164:167], a[68:71]
v_mfma_f32_16x16x32_bf16 a[72:75], v[136:139], v[168:171], a[72:75]
s_add_u32 m0, s63, 4096
v_mfma_f32_16x16x32_bf16 a[76:79], v[136:139], v[172:175], a[76:79]
ds_read_b64_tr_b16 v[106:107], v19 offset:34816
v_mfma_f32_16x16x32_bf16 a[80:83], v[136:139], v[176:179], a[80:83]
s_add_u32 s62, s65, 65536
v_mfma_f32_16x16x32_bf16 a[84:87], v[136:139], v[180:183], a[84:87]
ds_read_b128 v[76:79], v16 offset:37888
buffer_load_dwordx4 v8, s[8:11], s62 offen lds
v_mfma_f32_16x16x32_bf16 a[88:91], v[136:139], v[184:187], a[88:91]
v_mfma_f32_16x16x32_bf16 a[92:95], v[136:139], v[188:191], a[92:95]
ds_read_b64_tr_b16 v[108:109], v20 offset:32768
s_add_u32 s62, s65, 80896
v_mfma_f32_16x16x32_bf16 a[96:99], v[140:143], v[160:163], a[96:99]
v_mfma_f32_16x16x32_bf16 a[100:103], v[140:143], v[164:167], a[100:103]
ds_read_b64_tr_b16 v[110:111], v20 offset:34816
buffer_load_dwordx4 v8, s[8:11], s62 offen offset:1024 lds
v_mfma_f32_16x16x32_bf16 a[104:107], v[140:143], v[168:171], a[104:107]
v_mfma_f32_16x16x32_bf16 a[108:111], v[140:143], v[172:175], a[108:111]
s_add_u32 s62, s65, 96256
v_mfma_f32_16x16x32_bf16 a[112:115], v[140:143], v[176:179], a[112:115]
ds_read_b128 v[80:83], v16 offset:40960
v_mfma_f32_16x16x32_bf16 a[116:119], v[140:143], v[180:183], a[116:119]
buffer_load_dwordx4 v9, s[8:11], s62 offen offset:2048 lds
v_mfma_f32_16x16x32_bf16 a[120:123], v[140:143], v[184:187], a[120:123]
ds_read_b64_tr_b16 v[112:113], v21 offset:32768
s_add_u32 s62, s65, 111616
v_mfma_f32_16x16x32_bf16 a[124:127], v[140:143], v[188:191], a[124:127]
v_mfma_f32_16x16x32_bf16 a[128:131], v[144:147], v[160:163], a[128:131]
ds_read_b64_tr_b16 v[114:115], v21 offset:34816
buffer_load_dwordx4 v9, s[8:11], s62 offen offset:3072 lds
v_mfma_f32_16x16x32_bf16 a[132:135], v[144:147], v[164:167], a[132:135]
v_mfma_f32_16x16x32_bf16 a[136:139], v[144:147], v[168:171], a[136:139]
ds_read_b128 v[84:87], v16 offset:41984
s_add_u32 s65, s65, 128
v_mfma_f32_16x16x32_bf16 a[140:143], v[144:147], v[172:175], a[140:143]
v_mfma_f32_16x16x32_bf16 a[144:147], v[144:147], v[176:179], a[144:147]
s_add_u32 m0, s64, 81920
v_mfma_f32_16x16x32_bf16 a[148:151], v[144:147], v[180:183], a[148:151]
ds_read_b64_tr_b16 v[116:117], v22 offset:32768
v_mfma_f32_16x16x32_bf16 a[152:155], v[144:147], v[184:187], a[152:155]
s_nop 0
v_mfma_f32_16x16x32_bf16 a[156:159], v[144:147], v[188:191], a[156:159]
ds_read_b64_tr_b16 v[118:119], v22 offset:34816
buffer_load_dwordx4 v12, s[12:15], s66 offen lds
v_mfma_f32_16x16x32_bf16 a[160:163], v[148:151], v[160:163], a[160:163]
v_mfma_f32_16x16x32_bf16 a[164:167], v[148:151], v[164:167], a[164:167]
ds_read_b128 v[88:91], v16 offset:45056
buffer_load_dwordx4 v13, s[12:15], s66 offen offset:1024 lds
v_mfma_f32_16x16x32_bf16 a[168:171], v[148:151], v[168:171], a[168:171]
v_mfma_f32_16x16x32_bf16 a[172:175], v[148:151], v[172:175], a[172:175]
ds_read_b64_tr_b16 v[120:121], v23 offset:32768
buffer_load_dwordx4 v14, s[12:15], s66 offen offset:2048 lds
v_mfma_f32_16x16x32_bf16 a[176:179], v[148:151], v[176:179], a[176:179]
v_mfma_f32_16x16x32_bf16 a[180:183], v[148:151], v[180:183], a[180:183]
buffer_load_dwordx4 v15, s[12:15], s66 offen offset:3072 lds
v_mfma_f32_16x16x32_bf16 a[184:187], v[148:151], v[184:187], a[184:187]
ds_read_b64_tr_b16 v[122:123], v23 offset:34816
v_mfma_f32_16x16x32_bf16 a[188:191], v[148:151], v[188:191], a[188:191]
s_add_u32 s66, s66, 262144
v_mfma_f32_16x16x32_bf16 a[192:195], v[152:155], v[160:163], a[192:195]
ds_read_b128 v[92:95], v16 offset:46080
v_mfma_f32_16x16x32_bf16 a[196:199], v[152:155], v[164:167], a[196:199]
v_mfma_f32_16x16x32_bf16 a[200:203], v[152:155], v[168:171], a[200:203]
ds_read_b64_tr_b16 v[124:125], v24 offset:32768
v_add_u32 v242, 0x100000, v242
global_load_dword v245, v242, s[98:99]
v_mfma_f32_16x16x32_bf16 a[204:207], v[152:155], v[172:175], a[204:207]
v_mfma_f32_16x16x32_bf16 a[208:211], v[152:155], v[176:179], a[208:211]
ds_read_b64_tr_b16 v[126:127], v24 offset:34816
v_mfma_f32_16x16x32_bf16 a[212:215], v[152:155], v[180:183], a[212:215]
v_mfma_f32_16x16x32_bf16 a[216:219], v[152:155], v[184:187], a[216:219]
v_mfma_f32_16x16x32_bf16 a[220:223], v[152:155], v[188:191], a[220:223]
v_mfma_f32_16x16x32_bf16 a[224:227], v[156:159], v[160:163], a[224:227]
v_mfma_f32_16x16x32_bf16 a[228:231], v[156:159], v[164:167], a[228:231]
v_mfma_f32_16x16x32_bf16 a[232:235], v[156:159], v[168:171], a[232:235]
v_mfma_f32_16x16x32_bf16 a[236:239], v[156:159], v[172:175], a[236:239]
v_mfma_f32_16x16x32_bf16 a[240:243], v[156:159], v[176:179], a[240:243]
v_mfma_f32_16x16x32_bf16 a[244:247], v[156:159], v[180:183], a[244:247]
v_mfma_f32_16x16x32_bf16 a[248:251], v[156:159], v[184:187], a[248:251]
v_mfma_f32_16x16x32_bf16 a[252:255], v[156:159], v[188:191], a[252:255]
s_waitcnt lgkmcnt(0)
v_mfma_f32_16x16x32_bf16 a[0:3], v[64:67], v[96:99], a[0:3]
s_waitcnt vmcnt(17)
s_barrier
v_mfma_f32_16x16x32_bf16 a[4:7], v[64:67], v[100:103], a[4:7]
ds_read_b128 v[128:131], v10 offset:32768
v_mfma_f32_16x16x32_bf16 a[8:11], v[64:67], v[104:107], a[8:11]
s_add_u32 m0, s64, 98304
v_mfma_f32_16x16x32_bf16 a[12:15], v[64:67], v[108:111], a[12:15]
ds_read_b64_tr_b16 v[160:161], v17 offset:49152
v_mfma_f32_16x16x32_bf16 a[16:19], v[64:67], v[112:115], a[16:19]
v_mfma_f32_16x16x32_bf16 a[20:23], v[64:67], v[116:119], a[20:23]
ds_read_b64_tr_b16 v[162:163], v17 offset:51200
v_mfma_f32_16x16x32_bf16 a[24:27], v[64:67], v[120:123], a[24:27]
v_mfma_f32_16x16x32_bf16 a[28:31], v[64:67], v[124:127], a[28:31]
ds_read_b128 v[132:135], v10 offset:33792
v_mfma_f32_16x16x32_bf16 a[32:35], v[68:71], v[96:99], a[32:35]
s_nop 0
v_mfma_f32_16x16x32_bf16 a[36:39], v[68:71], v[100:103], a[36:39]
v_mfma_f32_16x16x32_bf16 a[40:43], v[68:71], v[104:107], a[40:43]
ds_read_b64_tr_b16 v[164:165], v18 offset:49152
v_mfma_f32_16x16x32_bf16 a[44:47], v[68:71], v[108:111], a[44:47]
v_mfma_f32_16x16x32_bf16 a[48:51], v[68:71], v[112:115], a[48:51]
ds_read_b64_tr_b16 v[166:167], v18 offset:51200
v_mfma_f32_16x16x32_bf16 a[52:55], v[68:71], v[116:119], a[52:55]
v_mfma_f32_16x16x32_bf16 a[56:59], v[68:71], v[120:123], a[56:59]
ds_read_b128 v[136:139], v10 offset:36864
v_mfma_f32_16x16x32_bf16 a[60:63], v[68:71], v[124:127], a[60:63]
buffer_load_dwordx4 v12, s[12:15], s66 offen lds
v_mfma_f32_16x16x32_bf16 a[64:67], v[72:75], v[96:99], a[64:67]
ds_read_b64_tr_b16 v[168:169], v19 offset:49152
v_mfma_f32_16x16x32_bf16 a[68:71], v[72:75], v[100:103], a[68:71]
v_mfma_f32_16x16x32_bf16 a[72:75], v[72:75], v[104:107], a[72:75]
v_mfma_f32_16x16x32_bf16 a[76:79], v[72:75], v[108:111], a[76:79]
ds_read_b64_tr_b16 v[170:171], v19 offset:51200
v_mfma_f32_16x16x32_bf16 a[80:83], v[72:75], v[112:115], a[80:83]
v_mfma_f32_16x16x32_bf16 a[84:87], v[72:75], v[116:119], a[84:87]
ds_read_b128 v[140:143], v10 offset:37888
v_mfma_f32_16x16x32_bf16 a[88:91], v[72:75], v[120:123], a[88:91]
buffer_load_dwordx4 v13, s[12:15], s66 offen offset:1024 lds
v_mfma_f32_16x16x32_bf16 a[92:95], v[72:75], v[124:127], a[92:95]
ds_read_b64_tr_b16 v[172:173], v20 offset:49152
v_mfma_f32_16x16x32_bf16 a[96:99], v[76:79], v[96:99], a[96:99]
v_mfma_f32_16x16x32_bf16 a[100:103], v[76:79], v[100:103], a[100:103]
ds_read_b64_tr_b16 v[174:175], v20 offset:51200
v_mfma_f32_16x16x32_bf16 a[104:107], v[76:79], v[104:107], a[104:107]
v_mfma_f32_16x16x32_bf16 a[108:111], v[76:79], v[108:111], a[108:111]
v_mfma_f32_16x16x32_bf16 a[112:115], v[76:79], v[112:115], a[112:115]
ds_read_b128 v[144:147], v10 offset:40960
buffer_load_dwordx4 v14, s[12:15], s66 offen offset:2048 lds
v_mfma_f32_16x16x32_bf16 a[116:119], v[76:79], v[116:119], a[116:119]
v_mfma_f32_16x16x32_bf16 a[120:123], v[76:79], v[120:123], a[120:123]
ds_read_b64_tr_b16 v[176:177], v21 offset:49152
v_mfma_f32_16x16x32_bf16 a[124:127], v[76:79], v[124:127], a[124:127]
v_mfma_f32_16x16x32_bf16 a[128:131], v[80:83], v[96:99], a[128:131]
ds_read_b64_tr_b16 v[178:179], v21 offset:51200
v_mfma_f32_16x16x32_bf16 a[132:135], v[80:83], v[100:103], a[132:135]
v_mfma_f32_16x16x32_bf16 a[136:139], v[80:83], v[104:107], a[136:139]
ds_read_b128 v[148:151], v10 offset:41984
v_mfma_f32_16x16x32_bf16 a[140:143], v[80:83], v[108:111], a[140:143]
buffer_load_dwordx4 v15, s[12:15], s66 offen offset:3072 lds
v_mfma_f32_16x16x32_bf16 a[144:147], v[80:83], v[112:115], a[144:147]
v_mfma_f32_16x16x32_bf16 a[148:151], v[80:83], v[116:119], a[148:151]
ds_read_b64_tr_b16 v[180:181], v22 offset:49152
v_mfma_f32_16x16x32_bf16 a[152:155], v[80:83], v[120:123], a[152:155]
v_mfma_f32_16x16x32_bf16 a[156:159], v[80:83], v[124:127], a[156:159]
ds_read_b64_tr_b16 v[182:183], v22 offset:51200
v_mfma_f32_16x16x32_bf16 a[160:163], v[84:87], v[96:99], a[160:163]
v_mfma_f32_16x16x32_bf16 a[164:167], v[84:87], v[100:103], a[164:167]
ds_read_b128 v[152:155], v10 offset:45056
v_mfma_f32_16x16x32_bf16 a[168:171], v[84:87], v[104:107], a[168:171]
s_add_u32 s66, s66, 262144
v_mfma_f32_16x16x32_bf16 a[172:175], v[84:87], v[108:111], a[172:175]
ds_read_b64_tr_b16 v[184:185], v23 offset:49152
v_mfma_f32_16x16x32_bf16 a[176:179], v[84:87], v[112:115], a[176:179]
v_mfma_f32_16x16x32_bf16 a[180:183], v[84:87], v[116:119], a[180:183]
v_mfma_f32_16x16x32_bf16 a[184:187], v[84:87], v[120:123], a[184:187]
ds_read_b64_tr_b16 v[186:187], v23 offset:51200
v_mfma_f32_16x16x32_bf16 a[188:191], v[84:87], v[124:127], a[188:191]
v_mfma_f32_16x16x32_bf16 a[192:195], v[88:91], v[96:99], a[192:195]
ds_read_b128 v[156:159], v10 offset:46080
v_mfma_f32_16x16x32_bf16 a[196:199], v[88:91], v[100:103], a[196:199]
v_mfma_f32_16x16x32_bf16 a[200:203], v[88:91], v[104:107], a[200:203]
ds_read_b64_tr_b16 v[188:189], v24 offset:49152
v_mfma_f32_16x16x32_bf16 a[204:207], v[88:91], v[108:111], a[204:207]
v_mfma_f32_16x16x32_bf16 a[208:211], v[88:91], v[112:115], a[208:211]
ds_read_b64_tr_b16 v[190:191], v24 offset:51200
v_mfma_f32_16x16x32_bf16 a[212:215], v[88:91], v[116:119], a[212:215]
v_mfma_f32_16x16x32_bf16 a[216:219], v[88:91], v[120:123], a[216:219]
v_mfma_f32_16x16x32_bf16 a[220:223], v[88:91], v[124:127], a[220:223]
v_mfma_f32_16x16x32_bf16 a[224:227], v[92:95], v[96:99], a[224:227]
v_mfma_f32_16x16x32_bf16 a[228:231], v[92:95], v[100:103], a[228:231]
v_mfma_f32_16x16x32_bf16 a[232:235], v[92:95], v[104:107], a[232:235]
v_mfma_f32_16x16x32_bf16 a[236:239], v[92:95], v[108:111], a[236:239]
v_mfma_f32_16x16x32_bf16 a[240:243], v[92:95], v[112:115], a[240:243]
v_mfma_f32_16x16x32_bf16 a[244:247], v[92:95], v[116:119], a[244:247]
v_mfma_f32_16x16x32_bf16 a[248:251], v[92:95], v[120:123], a[248:251]
v_mfma_f32_16x16x32_bf16 a[252:255], v[92:95], v[124:127], a[252:255]
s_waitcnt lgkmcnt(0)
v_mfma_f32_16x16x32_bf16 a[0:3], v[128:131], v[160:163], a[0:3]
s_waitcnt vmcnt(9)
s_barrier
v_mfma_f32_16x16x32_bf16 a[4:7], v[128:131], v[164:167], a[4:7]
ds_read_b128 v[64:67], v16
v_mfma_f32_16x16x32_bf16 a[8:11], v[128:131], v[168:171], a[8:11]
s_add_u32 m0, s63, 32768
v_mfma_f32_16x16x32_bf16 a[12:15], v[128:131], v[172:175], a[12:15]
ds_read_b64_tr_b16 v[96:97], v17
s_add_u32 s62, s65, 0
v_mfma_f32_16x16x32_bf16 a[16:19], v[128:131], v[176:179], a[16:19]
v_mfma_f32_16x16x32_bf16 a[20:23], v[128:131], v[180:183], a[20:23]
ds_read_b64_tr_b16 v[98:99], v17 offset:2048
buffer_load_dwordx4 v8, s[8:11], s62 offen lds
v_mfma_f32_16x16x32_bf16 a[24:27], v[128:131], v[184:187], a[24:27]
v_mfma_f32_16x16x32_bf16 a[28:31], v[128:131], v[188:191], a[28:31]
ds_read_b128 v[68:71], v16 offset:1024
s_add_u32 s62, s65, 15360
v_mfma_f32_16x16x32_bf16 a[32:35], v[132:135], v[160:163], a[32:35]
v_mfma_f32_16x16x32_bf16 a[36:39], v[132:135], v[164:167], a[36:39]
buffer_load_dwordx4 v8, s[8:11], s62 offen offset:1024 lds
v_mfma_f32_16x16x32_bf16 a[40:43], v[132:135], v[168:171], a[40:43]
ds_read_b64_tr_b16 v[100:101], v18
v_mfma_f32_16x16x32_bf16 a[44:47], v[132:135], v[172:175], a[44:47]
s_add_u32 s62, s65, 30720
v_mfma_f32_16x16x32_bf16 a[48:51], v[132:135], v[176:179], a[48:51]
ds_read_b64_tr_b16 v[102:103], v18 offset:2048
buffer_load_dwordx4 v9, s[8:11], s62 offen offset:2048 lds
v_mfma_f32_16x16x32_bf16 a[52:55], v[132:135], v[180:183], a[52:55]
v_mfma_f32_16x16x32_bf16 a[56:59], v[132:135], v[184:187], a[56:59]
ds_read_b128 v[72:75], v16 offset:4096
s_add_u32 s62, s65, 46080
v_mfma_f32_16x16x32_bf16 a[60:63], v[132:135], v[188:191], a[60:63]
v_mfma_f32_16x16x32_bf16 a[64:67], v[136:139], v[160:163], a[64:67]
ds_read_b64_tr_b16 v[104:105], v19
buffer_load_dwordx4 v9, s[8:11], s62 offen offset:3072 lds
v_mfma_f32_16x16x32_bf16 a[68:71], v[136:139], v[164:167], a[68:71]
v_mfma_f32_16x16x32_bf16 a[72:75], v[136:139], v[168:171], a[72:75]
s_add_u32 m0, s63, 36864
v_mfma_f32_16x16x32_bf16 a[76:79], v[136:139], v[172:175], a[76:79]
ds_read_b64_tr_b16 v[106:107], v19 offset:2048
v_mfma_f32_16x16x32_bf16 a[80:83], v[136:139], v[176:179], a[80:83]
s_add_u32 s62, s65, 65536
v_mfma_f32_16x16x32_bf16 a[84:87], v[136:139], v[180:183], a[84:87]
ds_read_b128 v[76:79], v16 offset:5120
buffer_load_dwordx4 v8, s[8:11], s62 offen lds
v_mfma_f32_16x16x32_bf16 a[88:91], v[136:139], v[184:187], a[88:91]
v_mfma_f32_16x16x32_bf16 a[92:95], v[136:139], v[188:191], a[92:95]
ds_read_b64_tr_b16 v[108:109], v20
s_add_u32 s62, s65, 80896
v_mfma_f32_16x16x32_bf16 a[96:99], v[140:143], v[160:163], a[96:99]
v_mfma_f32_16x16x32_bf16 a[100:103], v[140:143], v[164:167], a[100:103]
ds_read_b64_tr_b16 v[110:111], v20 offset:2048
buffer_load_dwordx4 v8, s[8:11], s62 offen offset:1024 lds
v_mfma_f32_16x16x32_bf16 a[104:107], v[140:143], v[168:171], a[104:107]
v_mfma_f32_16x16x32_bf16 a[108:111], v[140:143], v[172:175], a[108:111]
s_add_u32 s62, s65, 96256
v_mfma_f32_16x16x32_bf16 a[112:115], v[140:143], v[176:179], a[112:115]
ds_read_b128 v[80:83], v16 offset:8192
v_mfma_f32_16x16x32_bf16 a[116:119], v[140:143], v[180:183], a[116:119]
buffer_load_dwordx4 v9, s[8:11], s62 offen offset:2048 lds
v_mfma_f32_16x16x32_bf16 a[120:123], v[140:143], v[184:187], a[120:123]
ds_read_b64_tr_b16 v[112:113], v21
s_add_u32 s62, s65, 111616
v_mfma_f32_16x16x32_bf16 a[124:127], v[140:143], v[188:191], a[124:127]
v_mfma_f32_16x16x32_bf16 a[128:131], v[144:147], v[160:163], a[128:131]
ds_read_b64_tr_b16 v[114:115], v21 offset:2048
buffer_load_dwordx4 v9, s[8:11], s62 offen offset:3072 lds
v_mfma_f32_16x16x32_bf16 a[132:135], v[144:147], v[164:167], a[132:135]
v_mfma_f32_16x16x32_bf16 a[136:139], v[144:147], v[168:171], a[136:139]
ds_read_b128 v[84:87], v16 offset:9216
s_add_u32 s65, s65, 128
v_mfma_f32_16x16x32_bf16 a[140:143], v[144:147], v[172:175], a[140:143]
v_mfma_f32_16x16x32_bf16 a[144:147], v[144:147], v[176:179], a[144:147]
s_add_u32 m0, s64, 114688
v_mfma_f32_16x16x32_bf16 a[148:151], v[144:147], v[180:183], a[148:151]
ds_read_b64_tr_b16 v[116:117], v22
v_mfma_f32_16x16x32_bf16 a[152:155], v[144:147], v[184:187], a[152:155]
s_nop 0
v_mfma_f32_16x16x32_bf16 a[156:159], v[144:147], v[188:191], a[156:159]
ds_read_b64_tr_b16 v[118:119], v22 offset:2048
buffer_load_dwordx4 v12, s[12:15], s66 offen lds
v_mfma_f32_16x16x32_bf16 a[160:163], v[148:151], v[160:163], a[160:163]
v_mfma_f32_16x16x32_bf16 a[164:167], v[148:151], v[164:167], a[164:167]
ds_read_b128 v[88:91], v16 offset:12288
buffer_load_dwordx4 v13, s[12:15], s66 offen offset:1024 lds
v_mfma_f32_16x16x32_bf16 a[168:171], v[148:151], v[168:171], a[168:171]
v_mfma_f32_16x16x32_bf16 a[172:175], v[148:151], v[172:175], a[172:175]
ds_read_b64_tr_b16 v[120:121], v23
buffer_load_dwordx4 v14, s[12:15], s66 offen offset:2048 lds
v_mfma_f32_16x16x32_bf16 a[176:179], v[148:151], v[176:179], a[176:179]
v_mfma_f32_16x16x32_bf16 a[180:183], v[148:151], v[180:183], a[180:183]
buffer_load_dwordx4 v15, s[12:15], s66 offen offset:3072 lds
v_mfma_f32_16x16x32_bf16 a[184:187], v[148:151], v[184:187], a[184:187]
ds_read_b64_tr_b16 v[122:123], v23 offset:2048
v_mfma_f32_16x16x32_bf16 a[188:191], v[148:151], v[188:191], a[188:191]
s_add_u32 s66, s66, 262144
v_mfma_f32_16x16x32_bf16 a[192:195], v[152:155], v[160:163], a[192:195]
ds_read_b128 v[92:95], v16 offset:13312
v_mfma_f32_16x16x32_bf16 a[196:199], v[152:155], v[164:167], a[196:199]
v_mfma_f32_16x16x32_bf16 a[200:203], v[152:155], v[168:171], a[200:203]
ds_read_b64_tr_b16 v[124:125], v24
v_mfma_f32_16x16x32_bf16 a[204:207], v[152:155], v[172:175], a[204:207]
v_mfma_f32_16x16x32_bf16 a[208:211], v[152:155], v[176:179], a[208:211]
ds_read_b64_tr_b16 v[126:127], v24 offset:2048
buffer_load_dword v248, v247, s[32:35], 0 offen
v_mfma_f32_16x16x32_bf16 a[212:215], v[152:155], v[180:183], a[212:215]
v_mfma_f32_16x16x32_bf16 a[216:219], v[152:155], v[184:187], a[216:219]
v_mfma_f32_16x16x32_bf16 a[220:223], v[152:155], v[188:191], a[220:223]
v_mfma_f32_16x16x32_bf16 a[224:227], v[156:159], v[160:163], a[224:227]
v_mfma_f32_16x16x32_bf16 a[228:231], v[156:159], v[164:167], a[228:231]
v_mfma_f32_16x16x32_bf16 a[232:235], v[156:159], v[168:171], a[232:235]
v_mfma_f32_16x16x32_bf16 a[236:239], v[156:159], v[172:175], a[236:239]
v_mfma_f32_16x16x32_bf16 a[240:243], v[156:159], v[176:179], a[240:243]
v_mfma_f32_16x16x32_bf16 a[244:247], v[156:159], v[180:183], a[244:247]
v_mfma_f32_16x16x32_bf16 a[248:251], v[156:159], v[184:187], a[248:251]
v_mfma_f32_16x16x32_bf16 a[252:255], v[156:159], v[188:191], a[252:255]
s_waitcnt lgkmcnt(0)
v_mfma_f32_16x16x32_bf16 a[0:3], v[64:67], v[96:99], a[0:3]
s_waitcnt vmcnt(18)
s_barrier
v_mfma_f32_16x16x32_bf16 a[4:7], v[64:67], v[100:103], a[4:7]
ds_read_b128 v[128:131], v10
v_mfma_f32_16x16x32_bf16 a[8:11], v[64:67], v[104:107], a[8:11]
s_add_u32 m0, s64, 65536
v_mfma_f32_16x16x32_bf16 a[12:15], v[64:67], v[108:111], a[12:15]
ds_read_b64_tr_b16 v[160:161], v17 offset:16384
v_mfma_f32_16x16x32_bf16 a[16:19], v[64:67], v[112:115], a[16:19]
v_mfma_f32_16x16x32_bf16 a[20:23], v[64:67], v[116:119], a[20:23]
ds_read_b64_tr_b16 v[162:163], v17 offset:18432
v_mfma_f32_16x16x32_bf16 a[24:27], v[64:67], v[120:123], a[24:27]
v_mfma_f32_16x16x32_bf16 a[28:31], v[64:67], v[124:127], a[28:31]
ds_read_b128 v[132:135], v10 offset:1024
v_mfma_f32_16x16x32_bf16 a[32:35], v[68:71], v[96:99], a[32:35]
s_nop 0
v_mfma_f32_16x16x32_bf16 a[36:39], v[68:71], v[100:103], a[36:39]
v_mfma_f32_16x16x32_bf16 a[40:43], v[68:71], v[104:107], a[40:43]
ds_read_b64_tr_b16 v[164:165], v18 offset:16384
v_mfma_f32_16x16x32_bf16 a[44:47], v[68:71], v[108:111], a[44:47]
v_mfma_f32_16x16x32_bf16 a[48:51], v[68:71], v[112:115], a[48:51]
ds_read_b64_tr_b16 v[166:167], v18 offset:18432
v_mfma_f32_16x16x32_bf16 a[52:55], v[68:71], v[116:119], a[52:55]
v_mfma_f32_16x16x32_bf16 a[56:59], v[68:71], v[120:123], a[56:59]
ds_read_b128 v[136:139], v10 offset:4096
v_mfma_f32_16x16x32_bf16 a[60:63], v[68:71], v[124:127], a[60:63]
buffer_load_dwordx4 v12, s[12:15], s66 offen lds
v_mfma_f32_16x16x32_bf16 a[64:67], v[72:75], v[96:99], a[64:67]
ds_read_b64_tr_b16 v[168:169], v19 offset:16384
v_mfma_f32_16x16x32_bf16 a[68:71], v[72:75], v[100:103], a[68:71]
v_mfma_f32_16x16x32_bf16 a[72:75], v[72:75], v[104:107], a[72:75]
v_mfma_f32_16x16x32_bf16 a[76:79], v[72:75], v[108:111], a[76:79]
ds_read_b64_tr_b16 v[170:171], v19 offset:18432
v_mfma_f32_16x16x32_bf16 a[80:83], v[72:75], v[112:115], a[80:83]
v_mfma_f32_16x16x32_bf16 a[84:87], v[72:75], v[116:119], a[84:87]
ds_read_b128 v[140:143], v10 offset:5120
v_mfma_f32_16x16x32_bf16 a[88:91], v[72:75], v[120:123], a[88:91]
buffer_load_dwordx4 v13, s[12:15], s66 offen offset:1024 lds
v_mfma_f32_16x16x32_bf16 a[92:95], v[72:75], v[124:127], a[92:95]
ds_read_b64_tr_b16 v[172:173], v20 offset:16384
v_mfma_f32_16x16x32_bf16 a[96:99], v[76:79], v[96:99], a[96:99]
v_mfma_f32_16x16x32_bf16 a[100:103], v[76:79], v[100:103], a[100:103]
ds_read_b64_tr_b16 v[174:175], v20 offset:18432
v_mfma_f32_16x16x32_bf16 a[104:107], v[76:79], v[104:107], a[104:107]
v_mfma_f32_16x16x32_bf16 a[108:111], v[76:79], v[108:111], a[108:111]
v_mfma_f32_16x16x32_bf16 a[112:115], v[76:79], v[112:115], a[112:115]
ds_read_b128 v[144:147], v10 offset:8192
buffer_load_dwordx4 v14, s[12:15], s66 offen offset:2048 lds
v_mfma_f32_16x16x32_bf16 a[116:119], v[76:79], v[116:119], a[116:119]
v_mfma_f32_16x16x32_bf16 a[120:123], v[76:79], v[120:123], a[120:123]
ds_read_b64_tr_b16 v[176:177], v21 offset:16384
v_mfma_f32_16x16x32_bf16 a[124:127], v[76:79], v[124:127], a[124:127]
v_mfma_f32_16x16x32_bf16 a[128:131], v[80:83], v[96:99], a[128:131]
ds_read_b64_tr_b16 v[178:179], v21 offset:18432
v_mfma_f32_16x16x32_bf16 a[132:135], v[80:83], v[100:103], a[132:135]
v_mfma_f32_16x16x32_bf16 a[136:139], v[80:83], v[104:107], a[136:139]
ds_read_b128 v[148:151], v10 offset:9216
v_mfma_f32_16x16x32_bf16 a[140:143], v[80:83], v[108:111], a[140:143]
buffer_load_dwordx4 v15, s[12:15], s66 offen offset:3072 lds
v_mfma_f32_16x16x32_bf16 a[144:147], v[80:83], v[112:115], a[144:147]
v_mfma_f32_16x16x32_bf16 a[148:151], v[80:83], v[116:119], a[148:151]
ds_read_b64_tr_b16 v[180:181], v22 offset:16384
v_mfma_f32_16x16x32_bf16 a[152:155], v[80:83], v[120:123], a[152:155]
v_mfma_f32_16x16x32_bf16 a[156:159], v[80:83], v[124:127], a[156:159]
ds_read_b64_tr_b16 v[182:183], v22 offset:18432
v_mfma_f32_16x16x32_bf16 a[160:163], v[84:87], v[96:99], a[160:163]
v_mfma_f32_16x16x32_bf16 a[164:167], v[84:87], v[100:103], a[164:167]
ds_read_b128 v[152:155], v10 offset:12288
v_mfma_f32_16x16x32_bf16 a[168:171], v[84:87], v[104:107], a[168:171]
s_add_u32 s66, s66, 262144
v_mfma_f32_16x16x32_bf16 a[172:175], v[84:87], v[108:111], a[172:175]
ds_read_b64_tr_b16 v[184:185], v23 offset:16384
v_mfma_f32_16x16x32_bf16 a[176:179], v[84:87], v[112:115], a[176:179]
v_mfma_f32_16x16x32_bf16 a[180:183], v[84:87], v[116:119], a[180:183]
v_mfma_f32_16x16x32_bf16 a[184:187], v[84:87], v[120:123], a[184:187]
ds_read_b64_tr_b16 v[186:187], v23 offset:18432
v_mfma_f32_16x16x32_bf16 a[188:191], v[84:87], v[124:127], a[188:191]
v_mfma_f32_16x16x32_bf16 a[192:195], v[88:91], v[96:99], a[192:195]
ds_read_b128 v[156:159], v10 offset:13312
v_mfma_f32_16x16x32_bf16 a[196:199], v[88:91], v[100:103], a[196:199]
v_mfma_f32_16x16x32_bf16 a[200:203], v[88:91], v[104:107], a[200:203]
ds_read_b64_tr_b16 v[188:189], v24 offset:16384
v_mfma_f32_16x16x32_bf16 a[204:207], v[88:91], v[108:111], a[204:207]
v_mfma_f32_16x16x32_bf16 a[208:211], v[88:91], v[112:115], a[208:211]
ds_read_b64_tr_b16 v[190:191], v24 offset:18432
v_mfma_f32_16x16x32_bf16 a[212:215], v[88:91], v[116:119], a[212:215]
v_mfma_f32_16x16x32_bf16 a[216:219], v[88:91], v[120:123], a[216:219]
v_mfma_f32_16x16x32_bf16 a[220:223], v[88:91], v[124:127], a[220:223]
v_mfma_f32_16x16x32_bf16 a[224:227], v[92:95], v[96:99], a[224:227]
v_mfma_f32_16x16x32_bf16 a[228:231], v[92:95], v[100:103], a[228:231]
v_mfma_f32_16x16x32_bf16 a[232:235], v[92:95], v[104:107], a[232:235]
v_mfma_f32_16x16x32_bf16 a[236:239], v[92:95], v[108:111], a[236:239]
v_mfma_f32_16x16x32_bf16 a[240:243], v[92:95], v[112:115], a[240:243]
v_mfma_f32_16x16x32_bf16 a[244:247], v[92:95], v[116:119], a[244:247]
v_mfma_f32_16x16x32_bf16 a[248:251], v[92:95], v[120:123], a[248:251]
v_mfma_f32_16x16x32_bf16 a[252:255], v[92:95], v[124:127], a[252:255]
s_waitcnt lgkmcnt(0)
v_mfma_f32_16x16x32_bf16 a[0:3], v[128:131], v[160:163], a[0:3]
s_waitcnt vmcnt(9)
s_barrier
v_mfma_f32_16x16x32_bf16 a[4:7], v[128:131], v[164:167], a[4:7]
ds_read_b128 v[64:67], v16 offset:32768
v_mfma_f32_16x16x32_bf16 a[8:11], v[128:131], v[168:171], a[8:11]
s_add_u32 m0, s63, 0
v_mfma_f32_16x16x32_bf16 a[12:15], v[128:131], v[172:175], a[12:15]
ds_read_b64_tr_b16 v[96:97], v17 offset:32768
s_add_u32 s62, s65, 0
v_mfma_f32_16x16x32_bf16 a[16:19], v[128:131], v[176:179], a[16:19]
v_mfma_f32_16x16x32_bf16 a[20:23], v[128:131], v[180:183], a[20:23]
ds_read_b64_tr_b16 v[98:99], v17 offset:34816
buffer_load_dwordx4 v8, s[8:11], s62 offen lds
v_mfma_f32_16x16x32_bf16 a[24:27], v[128:131], v[184:187], a[24:27]
v_mfma_f32_16x16x32_bf16 a[28:31], v[128:131], v[188:191], a[28:31]
ds_read_b128 v[68:71], v16 offset:33792
s_add_u32 s62, s65, 15360
v_mfma_f32_16x16x32_bf16 a[32:35], v[132:135], v[160:163], a[32:35]
v_mfma_f32_16x16x32_bf16 a[36:39], v[132:135], v[164:167], a[36:39]
buffer_load_dwordx4 v8, s[8:11], s62 offen offset:1024 lds
v_mfma_f32_16x16x32_bf16 a[40:43], v[132:135], v[168:171], a[40:43]
ds_read_b64_tr_b16 v[100:101], v18 offset:32768
v_mfma_f32_16x16x32_bf16 a[44:47], v[132:135], v[172:175], a[44:47]
s_add_u32 s62, s65, 30720
v_mfma_f32_16x16x32_bf16 a[48:51], v[132:135], v[176:179], a[48:51]
ds_read_b64_tr_b16 v[102:103], v18 offset:34816
buffer_load_dwordx4 v9, s[8:11], s62 offen offset:2048 lds
v_mfma_f32_16x16x32_bf16 a[52:55], v[132:135], v[180:183], a[52:55]
v_mfma_f32_16x16x32_bf16 a[56:59], v[132:135], v[184:187], a[56:59]
ds_read_b128 v[72:75], v16 offset:36864
s_add_u32 s62, s65, 46080
v_mfma_f32_16x16x32_bf16 a[60:63], v[132:135], v[188:191], a[60:63]
v_mfma_f32_16x16x32_bf16 a[64:67], v[136:139], v[160:163], a[64:67]
ds_read_b64_tr_b16 v[104:105], v19 offset:32768
buffer_load_dwordx4 v9, s[8:11], s62 offen offset:3072 lds
v_mfma_f32_16x16x32_bf16 a[68:71], v[136:139], v[164:167], a[68:71]
v_mfma_f32_16x16x32_bf16 a[72:75], v[136:139], v[168:171], a[72:75]
s_add_u32 m0, s63, 4096
v_mfma_f32_16x16x32_bf16 a[76:79], v[136:139], v[172:175], a[76:79]
ds_read_b64_tr_b16 v[106:107], v19 offset:34816
v_mfma_f32_16x16x32_bf16 a[80:83], v[136:139], v[176:179], a[80:83]
s_add_u32 s62, s65, 65536
v_mfma_f32_16x16x32_bf16 a[84:87], v[136:139], v[180:183], a[84:87]
ds_read_b128 v[76:79], v16 offset:37888
buffer_load_dwordx4 v8, s[8:11], s62 offen lds
v_mfma_f32_16x16x32_bf16 a[88:91], v[136:139], v[184:187], a[88:91]
v_mfma_f32_16x16x32_bf16 a[92:95], v[136:139], v[188:191], a[92:95]
ds_read_b64_tr_b16 v[108:109], v20 offset:32768
s_add_u32 s62, s65, 80896
v_mfma_f32_16x16x32_bf16 a[96:99], v[140:143], v[160:163], a[96:99]
v_mfma_f32_16x16x32_bf16 a[100:103], v[140:143], v[164:167], a[100:103]
ds_read_b64_tr_b16 v[110:111], v20 offset:34816
buffer_load_dwordx4 v8, s[8:11], s62 offen offset:1024 lds
v_mfma_f32_16x16x32_bf16 a[104:107], v[140:143], v[168:171], a[104:107]
v_mfma_f32_16x16x32_bf16 a[108:111], v[140:143], v[172:175], a[108:111]
s_add_u32 s62, s65, 96256
v_mfma_f32_16x16x32_bf16 a[112:115], v[140:143], v[176:179], a[112:115]
ds_read_b128 v[80:83], v16 offset:40960
v_mfma_f32_16x16x32_bf16 a[116:119], v[140:143], v[180:183], a[116:119]
buffer_load_dwordx4 v9, s[8:11], s62 offen offset:2048 lds
v_mfma_f32_16x16x32_bf16 a[120:123], v[140:143], v[184:187], a[120:123]
ds_read_b64_tr_b16 v[112:113], v21 offset:32768
s_add_u32 s62, s65, 111616
v_mfma_f32_16x16x32_bf16 a[124:127], v[140:143], v[188:191], a[124:127]
v_mfma_f32_16x16x32_bf16 a[128:131], v[144:147], v[160:163], a[128:131]
ds_read_b64_tr_b16 v[114:115], v21 offset:34816
buffer_load_dwordx4 v9, s[8:11], s62 offen offset:3072 lds
v_mfma_f32_16x16x32_bf16 a[132:135], v[144:147], v[164:167], a[132:135]
v_mfma_f32_16x16x32_bf16 a[136:139], v[144:147], v[168:171], a[136:139]
ds_read_b128 v[84:87], v16 offset:41984
s_add_u32 s65, s65, 128
v_mfma_f32_16x16x32_bf16 a[140:143], v[144:147], v[172:175], a[140:143]
v_mfma_f32_16x16x32_bf16 a[144:147], v[144:147], v[176:179], a[144:147]
s_add_u32 m0, s64, 81920
v_mfma_f32_16x16x32_bf16 a[148:151], v[144:147], v[180:183], a[148:151]
ds_read_b64_tr_b16 v[116:117], v22 offset:32768
v_mfma_f32_16x16x32_bf16 a[152:155], v[144:147], v[184:187], a[152:155]
s_nop 0
v_mfma_f32_16x16x32_bf16 a[156:159], v[144:147], v[188:191], a[156:159]
ds_read_b64_tr_b16 v[118:119], v22 offset:34816
buffer_load_dwordx4 v12, s[12:15], s66 offen lds
v_mfma_f32_16x16x32_bf16 a[160:163], v[148:151], v[160:163], a[160:163]
v_mfma_f32_16x16x32_bf16 a[164:167], v[148:151], v[164:167], a[164:167]
ds_read_b128 v[88:91], v16 offset:45056
buffer_load_dwordx4 v13, s[12:15], s66 offen offset:1024 lds
v_mfma_f32_16x16x32_bf16 a[168:171], v[148:151], v[168:171], a[168:171]
v_mfma_f32_16x16x32_bf16 a[172:175], v[148:151], v[172:175], a[172:175]
ds_read_b64_tr_b16 v[120:121], v23 offset:32768
buffer_load_dwordx4 v14, s[12:15], s66 offen offset:2048 lds
v_mfma_f32_16x16x32_bf16 a[176:179], v[148:151], v[176:179], a[176:179]
v_mfma_f32_16x16x32_bf16 a[180:183], v[148:151], v[180:183], a[180:183]
buffer_load_dwordx4 v15, s[12:15], s66 offen offset:3072 lds
v_mfma_f32_16x16x32_bf16 a[184:187], v[148:151], v[184:187], a[184:187]
ds_read_b64_tr_b16 v[122:123], v23 offset:34816
v_mfma_f32_16x16x32_bf16 a[188:191], v[148:151], v[188:191], a[188:191]
s_add_u32 s66, s66, 262144
v_mfma_f32_16x16x32_bf16 a[192:195], v[152:155], v[160:163], a[192:195]
ds_read_b128 v[92:95], v16 offset:46080
v_mfma_f32_16x16x32_bf16 a[196:199], v[152:155], v[164:167], a[196:199]
v_mfma_f32_16x16x32_bf16 a[200:203], v[152:155], v[168:171], a[200:203]
ds_read_b64_tr_b16 v[124:125], v24 offset:32768
v_mfma_f32_16x16x32_bf16 a[204:207], v[152:155], v[172:175], a[204:207]
v_mfma_f32_16x16x32_bf16 a[208:211], v[152:155], v[176:179], a[208:211]
ds_read_b64_tr_b16 v[126:127], v24 offset:34816
buffer_load_dword v248, v247, s[32:35], 0 offen offset:2048
v_mfma_f32_16x16x32_bf16 a[212:215], v[152:155], v[180:183], a[212:215]
v_mfma_f32_16x16x32_bf16 a[216:219], v[152:155], v[184:187], a[216:219]
v_mfma_f32_16x16x32_bf16 a[220:223], v[152:155], v[188:191], a[220:223]
v_mfma_f32_16x16x32_bf16 a[224:227], v[156:159], v[160:163], a[224:227]
v_mfma_f32_16x16x32_bf16 a[228:231], v[156:159], v[164:167], a[228:231]
v_mfma_f32_16x16x32_bf16 a[232:235], v[156:159], v[168:171], a[232:235]
v_mfma_f32_16x16x32_bf16 a[236:239], v[156:159], v[172:175], a[236:239]
v_mfma_f32_16x16x32_bf16 a[240:243], v[156:159], v[176:179], a[240:243]
v_mfma_f32_16x16x32_bf16 a[244:247], v[156:159], v[180:183], a[244:247]
v_mfma_f32_16x16x32_bf16 a[248:251], v[156:159], v[184:187], a[248:251]
v_mfma_f32_16x16x32_bf16 a[252:255], v[156:159], v[188:191], a[252:255]
s_waitcnt lgkmcnt(0)
v_mfma_f32_16x16x32_bf16 a[0:3], v[64:67], v[96:99], a[0:3]
s_waitcnt vmcnt(18)
s_barrier
v_mfma_f32_16x16x32_bf16 a[4:7], v[64:67], v[100:103], a[4:7]
ds_read_b128 v[128:131], v10 offset:32768
v_mfma_f32_16x16x32_bf16 a[8:11], v[64:67], v[104:107], a[8:11]
s_add_u32 m0, s64, 98304
v_mfma_f32_16x16x32_bf16 a[12:15], v[64:67], v[108:111], a[12:15]
ds_read_b64_tr_b16 v[160:161], v17 offset:49152
v_mfma_f32_16x16x32_bf16 a[16:19], v[64:67], v[112:115], a[16:19]
v_mfma_f32_16x16x32_bf16 a[20:23], v[64:67], v[116:119], a[20:23]
ds_read_b64_tr_b16 v[162:163], v17 offset:51200
v_mfma_f32_16x16x32_bf16 a[24:27], v[64:67], v[120:123], a[24:27]
v_mfma_f32_16x16x32_bf16 a[28:31], v[64:67], v[124:127], a[28:31]
ds_read_b128 v[132:135], v10 offset:33792
v_mfma_f32_16x16x32_bf16 a[32:35], v[68:71], v[96:99], a[32:35]
s_nop 0
v_mfma_f32_16x16x32_bf16 a[36:39], v[68:71], v[100:103], a[36:39]
v_mfma_f32_16x16x32_bf16 a[40:43], v[68:71], v[104:107], a[40:43]
ds_read_b64_tr_b16 v[164:165], v18 offset:49152
v_mfma_f32_16x16x32_bf16 a[44:47], v[68:71], v[108:111], a[44:47]
v_mfma_f32_16x16x32_bf16 a[48:51], v[68:71], v[112:115], a[48:51]
ds_read_b64_tr_b16 v[166:167], v18 offset:51200
v_mfma_f32_16x16x32_bf16 a[52:55], v[68:71], v[116:119], a[52:55]
v_mfma_f32_16x16x32_bf16 a[56:59], v[68:71], v[120:123], a[56:59]
ds_read_b128 v[136:139], v10 offset:36864
v_mfma_f32_16x16x32_bf16 a[60:63], v[68:71], v[124:127], a[60:63]
buffer_load_dwordx4 v12, s[12:15], s66 offen lds
v_mfma_f32_16x16x32_bf16 a[64:67], v[72:75], v[96:99], a[64:67]
ds_read_b64_tr_b16 v[168:169], v19 offset:49152
v_mfma_f32_16x16x32_bf16 a[68:71], v[72:75], v[100:103], a[68:71]
v_mfma_f32_16x16x32_bf16 a[72:75], v[72:75], v[104:107], a[72:75]
v_mfma_f32_16x16x32_bf16 a[76:79], v[72:75], v[108:111], a[76:79]
ds_read_b64_tr_b16 v[170:171], v19 offset:51200
v_mfma_f32_16x16x32_bf16 a[80:83], v[72:75], v[112:115], a[80:83]
v_mfma_f32_16x16x32_bf16 a[84:87], v[72:75], v[116:119], a[84:87]
ds_read_b128 v[140:143], v10 offset:37888
v_mfma_f32_16x16x32_bf16 a[88:91], v[72:75], v[120:123], a[88:91]
buffer_load_dwordx4 v13, s[12:15], s66 offen offset:1024 lds
v_mfma_f32_16x16x32_bf16 a[92:95], v[72:75], v[124:127], a[92:95]
ds_read_b64_tr_b16 v[172:173], v20 offset:49152
v_mfma_f32_16x16x32_bf16 a[96:99], v[76:79], v[96:99], a[96:99]
v_mfma_f32_16x16x32_bf16 a[100:103], v[76:79], v[100:103], a[100:103]
ds_read_b64_tr_b16 v[174:175], v20 offset:51200
v_mfma_f32_16x16x32_bf16 a[104:107], v[76:79], v[104:107], a[104:107]
v_mfma_f32_16x16x32_bf16 a[108:111], v[76:79], v[108:111], a[108:111]
v_mfma_f32_16x16x32_bf16 a[112:115], v[76:79], v[112:115], a[112:115]
ds_read_b128 v[144:147], v10 offset:40960
buffer_load_dwordx4 v14, s[12:15], s66 offen offset:2048 lds
v_mfma_f32_16x16x32_bf16 a[116:119], v[76:79], v[116:119], a[116:119]
v_mfma_f32_16x16x32_bf16 a[120:123], v[76:79], v[120:123], a[120:123]
ds_read_b64_tr_b16 v[176:177], v21 offset:49152
v_mfma_f32_16x16x32_bf16 a[124:127], v[76:79], v[124:127], a[124:127]
v_mfma_f32_16x16x32_bf16 a[128:131], v[80:83], v[96:99], a[128:131]
ds_read_b64_tr_b16 v[178:179], v21 offset:51200
v_mfma_f32_16x16x32_bf16 a[132:135], v[80:83], v[100:103], a[132:135]
v_mfma_f32_16x16x32_bf16 a[136:139], v[80:83], v[104:107], a[136:139]
ds_read_b128 v[148:151], v10 offset:41984
v_mfma_f32_16x16x32_bf16 a[140:143], v[80:83], v[108:111], a[140:143]
buffer_load_dwordx4 v15, s[12:15], s66 offen offset:3072 lds
v_mfma_f32_16x16x32_bf16 a[144:147], v[80:83], v[112:115], a[144:147]
v_mfma_f32_16x16x32_bf16 a[148:151], v[80:83], v[116:119], a[148:151]
ds_read_b64_tr_b16 v[180:181], v22 offset:49152
v_mfma_f32_16x16x32_bf16 a[152:155], v[80:83], v[120:123], a[152:155]
v_mfma_f32_16x16x32_bf16 a[156:159], v[80:83], v[124:127], a[156:159]
ds_read_b64_tr_b16 v[182:183], v22 offset:51200
v_mfma_f32_16x16x32_bf16 a[160:163], v[84:87], v[96:99], a[160:163]
v_mfma_f32_16x16x32_bf16 a[164:167], v[84:87], v[100:103], a[164:167]
ds_read_b128 v[152:155], v10 offset:45056
v_mfma_f32_16x16x32_bf16 a[168:171], v[84:87], v[104:107], a[168:171]
s_add_u32 s66, s66, 262144
v_mfma_f32_16x16x32_bf16 a[172:175], v[84:87], v[108:111], a[172:175]
ds_read_b64_tr_b16 v[184:185], v23 offset:49152
v_mfma_f32_16x16x32_bf16 a[176:179], v[84:87], v[112:115], a[176:179]
v_mfma_f32_16x16x32_bf16 a[180:183], v[84:87], v[116:119], a[180:183]
v_mfma_f32_16x16x32_bf16 a[184:187], v[84:87], v[120:123], a[184:187]
ds_read_b64_tr_b16 v[186:187], v23 offset:51200
v_mfma_f32_16x16x32_bf16 a[188:191], v[84:87], v[124:127], a[188:191]
v_mfma_f32_16x16x32_bf16 a[192:195], v[88:91], v[96:99], a[192:195]
ds_read_b128 v[156:159], v10 offset:46080
v_mfma_f32_16x16x32_bf16 a[196:199], v[88:91], v[100:103], a[196:199]
v_mfma_f32_16x16x32_bf16 a[200:203], v[88:91], v[104:107], a[200:203]
ds_read_b64_tr_b16 v[188:189], v24 offset:49152
v_mfma_f32_16x16x32_bf16 a[204:207], v[88:91], v[108:111], a[204:207]
v_mfma_f32_16x16x32_bf16 a[208:211], v[88:91], v[112:115], a[208:211]
ds_read_b64_tr_b16 v[190:191], v24 offset:51200
v_mfma_f32_16x16x32_bf16 a[212:215], v[88:91], v[116:119], a[212:215]
v_mfma_f32_16x16x32_bf16 a[216:219], v[88:91], v[120:123], a[216:219]
v_mfma_f32_16x16x32_bf16 a[220:223], v[88:91], v[124:127], a[220:223]
v_mfma_f32_16x16x32_bf16 a[224:227], v[92:95], v[96:99], a[224:227]
v_mfma_f32_16x16x32_bf16 a[228:231], v[92:95], v[100:103], a[228:231]
v_mfma_f32_16x16x32_bf16 a[232:235], v[92:95], v[104:107], a[232:235]
v_mfma_f32_16x16x32_bf16 a[236:239], v[92:95], v[108:111], a[236:239]
v_mfma_f32_16x16x32_bf16 a[240:243], v[92:95], v[112:115], a[240:243]
v_mfma_f32_16x16x32_bf16 a[244:247], v[92:95], v[116:119], a[244:247]
v_mfma_f32_16x16x32_bf16 a[248:251], v[92:95], v[120:123], a[248:251]
v_mfma_f32_16x16x32_bf16 a[252:255], v[92:95], v[124:127], a[252:255]
s_waitcnt lgkmcnt(0)
v_mfma_f32_16x16x32_bf16 a[0:3], v[128:131], v[160:163], a[0:3]
s_waitcnt vmcnt(9)
s_barrier
v_mfma_f32_16x16x32_bf16 a[4:7], v[128:131], v[164:167], a[4:7]
ds_read_b128 v[64:67], v16
v_mfma_f32_16x16x32_bf16 a[8:11], v[128:131], v[168:171], a[8:11]
s_add_u32 m0, s63, 32768
v_mfma_f32_16x16x32_bf16 a[12:15], v[128:131], v[172:175], a[12:15]
ds_read_b64_tr_b16 v[96:97], v17
s_add_u32 s62, s65, 0
v_mfma_f32_16x16x32_bf16 a[16:19], v[128:131], v[176:179], a[16:19]
v_mfma_f32_16x16x32_bf16 a[20:23], v[128:131], v[180:183], a[20:23]
ds_read_b64_tr_b16 v[98:99], v17 offset:2048
buffer_load_dwordx4 v8, s[8:11], s62 offen lds
v_mfma_f32_16x16x32_bf16 a[24:27], v[128:131], v[184:187], a[24:27]
v_mfma_f32_16x16x32_bf16 a[28:31], v[128:131], v[188:191], a[28:31]
ds_read_b128 v[68:71], v16 offset:1024
s_add_u32 s62, s65, 15360
v_mfma_f32_16x16x32_bf16 a[32:35], v[132:135], v[160:163], a[32:35]
v_mfma_f32_16x16x32_bf16 a[36:39], v[132:135], v[164:167], a[36:39]
buffer_load_dwordx4 v8, s[8:11], s62 offen offset:1024 lds
v_mfma_f32_16x16x32_bf16 a[40:43], v[132:135], v[168:171], a[40:43]
ds_read_b64_tr_b16 v[100:101], v18
v_mfma_f32_16x16x32_bf16 a[44:47], v[132:135], v[172:175], a[44:47]
s_add_u32 s62, s65, 30720
v_mfma_f32_16x16x32_bf16 a[48:51], v[132:135], v[176:179], a[48:51]
ds_read_b64_tr_b16 v[102:103], v18 offset:2048
buffer_load_dwordx4 v9, s[8:11], s62 offen offset:2048 lds
v_mfma_f32_16x16x32_bf16 a[52:55], v[132:135], v[180:183], a[52:55]
v_mfma_f32_16x16x32_bf16 a[56:59], v[132:135], v[184:187], a[56:59]
ds_read_b128 v[72:75], v16 offset:4096
s_add_u32 s62, s65, 46080
v_mfma_f32_16x16x32_bf16 a[60:63], v[132:135], v[188:191], a[60:63]
v_mfma_f32_16x16x32_bf16 a[64:67], v[136:139], v[160:163], a[64:67]
ds_read_b64_tr_b16 v[104:105], v19
buffer_load_dwordx4 v9, s[8:11], s62 offen offset:3072 lds
v_mfma_f32_16x16x32_bf16 a[68:71], v[136:139], v[164:167], a[68:71]
v_mfma_f32_16x16x32_bf16 a[72:75], v[136:139], v[168:171], a[72:75]
s_add_u32 m0, s63, 36864
v_mfma_f32_16x16x32_bf16 a[76:79], v[136:139], v[172:175], a[76:79]
ds_read_b64_tr_b16 v[106:107], v19 offset:2048
v_mfma_f32_16x16x32_bf16 a[80:83], v[136:139], v[176:179], a[80:83]
s_add_u32 s62, s65, 65536
v_mfma_f32_16x16x32_bf16 a[84:87], v[136:139], v[180:183], a[84:87]
ds_read_b128 v[76:79], v16 offset:5120
buffer_load_dwordx4 v8, s[8:11], s62 offen lds
v_mfma_f32_16x16x32_bf16 a[88:91], v[136:139], v[184:187], a[88:91]
v_mfma_f32_16x16x32_bf16 a[92:95], v[136:139], v[188:191], a[92:95]
ds_read_b64_tr_b16 v[108:109], v20
s_add_u32 s62, s65, 80896
v_mfma_f32_16x16x32_bf16 a[96:99], v[140:143], v[160:163], a[96:99]
v_mfma_f32_16x16x32_bf16 a[100:103], v[140:143], v[164:167], a[100:103]
ds_read_b64_tr_b16 v[110:111], v20 offset:2048
buffer_load_dwordx4 v8, s[8:11], s62 offen offset:1024 lds
v_mfma_f32_16x16x32_bf16 a[104:107], v[140:143], v[168:171], a[104:107]
v_mfma_f32_16x16x32_bf16 a[108:111], v[140:143], v[172:175], a[108:111]
s_add_u32 s62, s65, 96256
v_mfma_f32_16x16x32_bf16 a[112:115], v[140:143], v[176:179], a[112:115]
ds_read_b128 v[80:83], v16 offset:8192
v_mfma_f32_16x16x32_bf16 a[116:119], v[140:143], v[180:183], a[116:119]
buffer_load_dwordx4 v9, s[8:11], s62 offen offset:2048 lds
v_mfma_f32_16x16x32_bf16 a[120:123], v[140:143], v[184:187], a[120:123]
ds_read_b64_tr_b16 v[112:113], v21
s_add_u32 s62, s65, 111616
v_mfma_f32_16x16x32_bf16 a[124:127], v[140:143], v[188:191], a[124:127]
v_mfma_f32_16x16x32_bf16 a[128:131], v[144:147], v[160:163], a[128:131]
ds_read_b64_tr_b16 v[114:115], v21 offset:2048
buffer_load_dwordx4 v9, s[8:11], s62 offen offset:3072 lds
v_mfma_f32_16x16x32_bf16 a[132:135], v[144:147], v[164:167], a[132:135]
v_mfma_f32_16x16x32_bf16 a[136:139], v[144:147], v[168:171], a[136:139]
ds_read_b128 v[84:87], v16 offset:9216
s_add_u32 s65, s65, 128
v_mfma_f32_16x16x32_bf16 a[140:143], v[144:147], v[172:175], a[140:143]
v_mfma_f32_16x16x32_bf16 a[144:147], v[144:147], v[176:179], a[144:147]
s_add_u32 m0, s64, 114688
v_mfma_f32_16x16x32_bf16 a[148:151], v[144:147], v[180:183], a[148:151]
ds_read_b64_tr_b16 v[116:117], v22
v_mfma_f32_16x16x32_bf16 a[152:155], v[144:147], v[184:187], a[152:155]
s_nop 0
v_mfma_f32_16x16x32_bf16 a[156:159], v[144:147], v[188:191], a[156:159]
ds_read_b64_tr_b16 v[118:119], v22 offset:2048
buffer_load_dwordx4 v12, s[12:15], s66 offen lds
v_mfma_f32_16x16x32_bf16 a[160:163], v[148:151], v[160:163], a[160:163]
v_mfma_f32_16x16x32_bf16 a[164:167], v[148:151], v[164:167], a[164:167]
ds_read_b128 v[88:91], v16 offset:12288
buffer_load_dwordx4 v13, s[12:15], s66 offen offset:1024 lds
v_mfma_f32_16x16x32_bf16 a[168:171], v[148:151], v[168:171], a[168:171]
v_mfma_f32_16x16x32_bf16 a[172:175], v[148:151], v[172:175], a[172:175]
ds_read_b64_tr_b16 v[120:121], v23
buffer_load_dwordx4 v14, s[12:15], s66 offen offset:2048 lds
v_mfma_f32_16x16x32_bf16 a[176:179], v[148:151], v[176:179], a[176:179]
v_mfma_f32_16x16x32_bf16 a[180:183], v[148:151], v[180:183], a[180:183]
buffer_load_dwordx4 v15, s[12:15], s66 offen offset:3072 lds
v_mfma_f32_16x16x32_bf16 a[184:187], v[148:151], v[184:187], a[184:187]
ds_read_b64_tr_b16 v[122:123], v23 offset:2048
v_mfma_f32_16x16x32_bf16 a[188:191], v[148:151], v[188:191], a[188:191]
s_add_u32 s66, s66, 262144
v_mfma_f32_16x16x32_bf16 a[192:195], v[152:155], v[160:163], a[192:195]
ds_read_b128 v[92:95], v16 offset:13312
v_mfma_f32_16x16x32_bf16 a[196:199], v[152:155], v[164:167], a[196:199]
v_mfma_f32_16x16x32_bf16 a[200:203], v[152:155], v[168:171], a[200:203]
ds_read_b64_tr_b16 v[124:125], v24
v_mfma_f32_16x16x32_bf16 a[204:207], v[152:155], v[172:175], a[204:207]
v_mfma_f32_16x16x32_bf16 a[208:211], v[152:155], v[176:179], a[208:211]
ds_read_b64_tr_b16 v[126:127], v24 offset:2048
buffer_load_dword v248, v246, s[76:79], 0 offen
v_mfma_f32_16x16x32_bf16 a[212:215], v[152:155], v[180:183], a[212:215]
v_mfma_f32_16x16x32_bf16 a[216:219], v[152:155], v[184:187], a[216:219]
v_mfma_f32_16x16x32_bf16 a[220:223], v[152:155], v[188:191], a[220:223]
v_mfma_f32_16x16x32_bf16 a[224:227], v[156:159], v[160:163], a[224:227]
v_mfma_f32_16x16x32_bf16 a[228:231], v[156:159], v[164:167], a[228:231]
v_mfma_f32_16x16x32_bf16 a[232:235], v[156:159], v[168:171], a[232:235]
v_mfma_f32_16x16x32_bf16 a[236:239], v[156:159], v[172:175], a[236:239]
v_mfma_f32_16x16x32_bf16 a[240:243], v[156:159], v[176:179], a[240:243]
v_mfma_f32_16x16x32_bf16 a[244:247], v[156:159], v[180:183], a[244:247]
v_mfma_f32_16x16x32_bf16 a[248:251], v[156:159], v[184:187], a[248:251]
v_mfma_f32_16x16x32_bf16 a[252:255], v[156:159], v[188:191], a[252:255]
s_waitcnt lgkmcnt(0)
v_mfma_f32_16x16x32_bf16 a[0:3], v[64:67], v[96:99], a[0:3]
s_waitcnt vmcnt(18)
s_barrier
v_mfma_f32_16x16x32_bf16 a[4:7], v[64:67], v[100:103], a[4:7]
ds_read_b128 v[128:131], v10
v_mfma_f32_16x16x32_bf16 a[8:11], v[64:67], v[104:107], a[8:11]
s_add_u32 m0, s64, 65536
v_mfma_f32_16x16x32_bf16 a[12:15], v[64:67], v[108:111], a[12:15]
ds_read_b64_tr_b16 v[160:161], v17 offset:16384
v_mfma_f32_16x16x32_bf16 a[16:19], v[64:67], v[112:115], a[16:19]
v_mfma_f32_16x16x32_bf16 a[20:23], v[64:67], v[116:119], a[20:23]
ds_read_b64_tr_b16 v[162:163], v17 offset:18432
v_mfma_f32_16x16x32_bf16 a[24:27], v[64:67], v[120:123], a[24:27]
v_mfma_f32_16x16x32_bf16 a[28:31], v[64:67], v[124:127], a[28:31]
ds_read_b128 v[132:135], v10 offset:1024
v_mfma_f32_16x16x32_bf16 a[32:35], v[68:71], v[96:99], a[32:35]
s_nop 0
v_mfma_f32_16x16x32_bf16 a[36:39], v[68:71], v[100:103], a[36:39]
v_mfma_f32_16x16x32_bf16 a[40:43], v[68:71], v[104:107], a[40:43]
ds_read_b64_tr_b16 v[164:165], v18 offset:16384
v_mfma_f32_16x16x32_bf16 a[44:47], v[68:71], v[108:111], a[44:47]
v_mfma_f32_16x16x32_bf16 a[48:51], v[68:71], v[112:115], a[48:51]
ds_read_b64_tr_b16 v[166:167], v18 offset:18432
v_mfma_f32_16x16x32_bf16 a[52:55], v[68:71], v[116:119], a[52:55]
v_mfma_f32_16x16x32_bf16 a[56:59], v[68:71], v[120:123], a[56:59]
ds_read_b128 v[136:139], v10 offset:4096
v_mfma_f32_16x16x32_bf16 a[60:63], v[68:71], v[124:127], a[60:63]
buffer_load_dwordx4 v12, s[12:15], s66 offen lds
v_mfma_f32_16x16x32_bf16 a[64:67], v[72:75], v[96:99], a[64:67]
ds_read_b64_tr_b16 v[168:169], v19 offset:16384
v_mfma_f32_16x16x32_bf16 a[68:71], v[72:75], v[100:103], a[68:71]
v_mfma_f32_16x16x32_bf16 a[72:75], v[72:75], v[104:107], a[72:75]
v_mfma_f32_16x16x32_bf16 a[76:79], v[72:75], v[108:111], a[76:79]
ds_read_b64_tr_b16 v[170:171], v19 offset:18432
v_mfma_f32_16x16x32_bf16 a[80:83], v[72:75], v[112:115], a[80:83]
v_mfma_f32_16x16x32_bf16 a[84:87], v[72:75], v[116:119], a[84:87]
ds_read_b128 v[140:143], v10 offset:5120
v_mfma_f32_16x16x32_bf16 a[88:91], v[72:75], v[120:123], a[88:91]
buffer_load_dwordx4 v13, s[12:15], s66 offen offset:1024 lds
v_mfma_f32_16x16x32_bf16 a[92:95], v[72:75], v[124:127], a[92:95]
ds_read_b64_tr_b16 v[172:173], v20 offset:16384
v_mfma_f32_16x16x32_bf16 a[96:99], v[76:79], v[96:99], a[96:99]
v_mfma_f32_16x16x32_bf16 a[100:103], v[76:79], v[100:103], a[100:103]
ds_read_b64_tr_b16 v[174:175], v20 offset:18432
v_mfma_f32_16x16x32_bf16 a[104:107], v[76:79], v[104:107], a[104:107]
v_mfma_f32_16x16x32_bf16 a[108:111], v[76:79], v[108:111], a[108:111]
v_mfma_f32_16x16x32_bf16 a[112:115], v[76:79], v[112:115], a[112:115]
ds_read_b128 v[144:147], v10 offset:8192
buffer_load_dwordx4 v14, s[12:15], s66 offen offset:2048 lds
v_mfma_f32_16x16x32_bf16 a[116:119], v[76:79], v[116:119], a[116:119]
v_mfma_f32_16x16x32_bf16 a[120:123], v[76:79], v[120:123], a[120:123]
ds_read_b64_tr_b16 v[176:177], v21 offset:16384
v_mfma_f32_16x16x32_bf16 a[124:127], v[76:79], v[124:127], a[124:127]
v_mfma_f32_16x16x32_bf16 a[128:131], v[80:83], v[96:99], a[128:131]
ds_read_b64_tr_b16 v[178:179], v21 offset:18432
v_mfma_f32_16x16x32_bf16 a[132:135], v[80:83], v[100:103], a[132:135]
v_mfma_f32_16x16x32_bf16 a[136:139], v[80:83], v[104:107], a[136:139]
ds_read_b128 v[148:151], v10 offset:9216
v_mfma_f32_16x16x32_bf16 a[140:143], v[80:83], v[108:111], a[140:143]
buffer_load_dwordx4 v15, s[12:15], s66 offen offset:3072 lds
v_mfma_f32_16x16x32_bf16 a[144:147], v[80:83], v[112:115], a[144:147]
v_mfma_f32_16x16x32_bf16 a[148:151], v[80:83], v[116:119], a[148:151]
ds_read_b64_tr_b16 v[180:181], v22 offset:16384
v_mfma_f32_16x16x32_bf16 a[152:155], v[80:83], v[120:123], a[152:155]
v_mfma_f32_16x16x32_bf16 a[156:159], v[80:83], v[124:127], a[156:159]
ds_read_b64_tr_b16 v[182:183], v22 offset:18432
v_mfma_f32_16x16x32_bf16 a[160:163], v[84:87], v[96:99], a[160:163]
v_mfma_f32_16x16x32_bf16 a[164:167], v[84:87], v[100:103], a[164:167]
ds_read_b128 v[152:155], v10 offset:12288
v_mfma_f32_16x16x32_bf16 a[168:171], v[84:87], v[104:107], a[168:171]
s_add_u32 s66, s66, 262144
v_mfma_f32_16x16x32_bf16 a[172:175], v[84:87], v[108:111], a[172:175]
ds_read_b64_tr_b16 v[184:185], v23 offset:16384
v_mfma_f32_16x16x32_bf16 a[176:179], v[84:87], v[112:115], a[176:179]
v_mfma_f32_16x16x32_bf16 a[180:183], v[84:87], v[116:119], a[180:183]
v_mfma_f32_16x16x32_bf16 a[184:187], v[84:87], v[120:123], a[184:187]
ds_read_b64_tr_b16 v[186:187], v23 offset:18432
v_mfma_f32_16x16x32_bf16 a[188:191], v[84:87], v[124:127], a[188:191]
v_mfma_f32_16x16x32_bf16 a[192:195], v[88:91], v[96:99], a[192:195]
ds_read_b128 v[156:159], v10 offset:13312
v_mfma_f32_16x16x32_bf16 a[196:199], v[88:91], v[100:103], a[196:199]
v_mfma_f32_16x16x32_bf16 a[200:203], v[88:91], v[104:107], a[200:203]
ds_read_b64_tr_b16 v[188:189], v24 offset:16384
buffer_load_dwordx4 v[56:59], v5, s[88:91], 0 offen sc1
v_mfma_f32_16x16x32_bf16 a[204:207], v[88:91], v[108:111], a[204:207]
v_mfma_f32_16x16x32_bf16 a[208:211], v[88:91], v[112:115], a[208:211]
ds_read_b64_tr_b16 v[190:191], v24 offset:18432
v_mfma_f32_16x16x32_bf16 a[212:215], v[88:91], v[116:119], a[212:215]
v_mfma_f32_16x16x32_bf16 a[216:219], v[88:91], v[120:123], a[216:219]
v_mfma_f32_16x16x32_bf16 a[220:223], v[88:91], v[124:127], a[220:223]
v_mfma_f32_16x16x32_bf16 a[224:227], v[92:95], v[96:99], a[224:227]
v_mfma_f32_16x16x32_bf16 a[228:231], v[92:95], v[100:103], a[228:231]
v_mfma_f32_16x16x32_bf16 a[232:235], v[92:95], v[104:107], a[232:235]
v_mfma_f32_16x16x32_bf16 a[236:239], v[92:95], v[108:111], a[236:239]
v_mfma_f32_16x16x32_bf16 a[240:243], v[92:95], v[112:115], a[240:243]
v_mfma_f32_16x16x32_bf16 a[244:247], v[92:95], v[116:119], a[244:247]
v_mfma_f32_16x16x32_bf16 a[248:251], v[92:95], v[120:123], a[248:251]
v_mfma_f32_16x16x32_bf16 a[252:255], v[92:95], v[124:127], a[252:255]
s_waitcnt lgkmcnt(0)
v_mfma_f32_16x16x32_bf16 a[0:3], v[128:131], v[160:163], a[0:3]
s_waitcnt vmcnt(10)
s_barrier
v_mfma_f32_16x16x32_bf16 a[4:7], v[128:131], v[164:167], a[4:7]
ds_read_b128 v[64:67], v16 offset:32768
v_mfma_f32_16x16x32_bf16 a[8:11], v[128:131], v[168:171], a[8:11]
s_add_u32 m0, s63, 0
v_mfma_f32_16x16x32_bf16 a[12:15], v[128:131], v[172:175], a[12:15]
ds_read_b64_tr_b16 v[96:97], v17 offset:32768
s_add_u32 s62, s65, 0
v_mfma_f32_16x16x32_bf16 a[16:19], v[128:131], v[176:179], a[16:19]
v_mfma_f32_16x16x32_bf16 a[20:23], v[128:131], v[180:183], a[20:23]
ds_read_b64_tr_b16 v[98:99], v17 offset:34816
buffer_load_dwordx4 v8, s[8:11], s62 offen lds
v_mfma_f32_16x16x32_bf16 a[24:27], v[128:131], v[184:187], a[24:27]
v_mfma_f32_16x16x32_bf16 a[28:31], v[128:131], v[188:191], a[28:31]
ds_read_b128 v[68:71], v16 offset:33792
s_add_u32 s62, s65, 15360
v_mfma_f32_16x16x32_bf16 a[32:35], v[132:135], v[160:163], a[32:35]
v_mfma_f32_16x16x32_bf16 a[36:39], v[132:135], v[164:167], a[36:39]
buffer_load_dwordx4 v8, s[8:11], s62 offen offset:1024 lds
v_mfma_f32_16x16x32_bf16 a[40:43], v[132:135], v[168:171], a[40:43]
ds_read_b64_tr_b16 v[100:101], v18 offset:32768
v_mfma_f32_16x16x32_bf16 a[44:47], v[132:135], v[172:175], a[44:47]
s_add_u32 s62, s65, 30720
v_mfma_f32_16x16x32_bf16 a[48:51], v[132:135], v[176:179], a[48:51]
ds_read_b64_tr_b16 v[102:103], v18 offset:34816
buffer_load_dwordx4 v9, s[8:11], s62 offen offset:2048 lds
v_mfma_f32_16x16x32_bf16 a[52:55], v[132:135], v[180:183], a[52:55]
v_mfma_f32_16x16x32_bf16 a[56:59], v[132:135], v[184:187], a[56:59]
ds_read_b128 v[72:75], v16 offset:36864
s_add_u32 s62, s65, 46080
v_mfma_f32_16x16x32_bf16 a[60:63], v[132:135], v[188:191], a[60:63]
v_mfma_f32_16x16x32_bf16 a[64:67], v[136:139], v[160:163], a[64:67]
ds_read_b64_tr_b16 v[104:105], v19 offset:32768
buffer_load_dwordx4 v9, s[8:11], s62 offen offset:3072 lds
v_mfma_f32_16x16x32_bf16 a[68:71], v[136:139], v[164:167], a[68:71]
v_mfma_f32_16x16x32_bf16 a[72:75], v[136:139], v[168:171], a[72:75]
s_add_u32 m0, s63, 4096
v_mfma_f32_16x16x32_bf16 a[76:79], v[136:139], v[172:175], a[76:79]
ds_read_b64_tr_b16 v[106:107], v19 offset:34816
v_mfma_f32_16x16x32_bf16 a[80:83], v[136:139], v[176:179], a[80:83]
s_add_u32 s62, s65, 65536
v_mfma_f32_16x16x32_bf16 a[84:87], v[136:139], v[180:183], a[84:87]
ds_read_b128 v[76:79], v16 offset:37888
buffer_load_dwordx4 v8, s[8:11], s62 offen lds
v_mfma_f32_16x16x32_bf16 a[88:91], v[136:139], v[184:187], a[88:91]
v_mfma_f32_16x16x32_bf16 a[92:95], v[136:139], v[188:191], a[92:95]
ds_read_b64_tr_b16 v[108:109], v20 offset:32768
s_add_u32 s62, s65, 80896
v_mfma_f32_16x16x32_bf16 a[96:99], v[140:143], v[160:163], a[96:99]
v_mfma_f32_16x16x32_bf16 a[100:103], v[140:143], v[164:167], a[100:103]
ds_read_b64_tr_b16 v[110:111], v20 offset:34816
buffer_load_dwordx4 v8, s[8:11], s62 offen offset:1024 lds
v_mfma_f32_16x16x32_bf16 a[104:107], v[140:143], v[168:171], a[104:107]
v_mfma_f32_16x16x32_bf16 a[108:111], v[140:143], v[172:175], a[108:111]
s_add_u32 s62, s65, 96256
v_mfma_f32_16x16x32_bf16 a[112:115], v[140:143], v[176:179], a[112:115]
ds_read_b128 v[80:83], v16 offset:40960
v_mfma_f32_16x16x32_bf16 a[116:119], v[140:143], v[180:183], a[116:119]
buffer_load_dwordx4 v9, s[8:11], s62 offen offset:2048 lds
v_mfma_f32_16x16x32_bf16 a[120:123], v[140:143], v[184:187], a[120:123]
ds_read_b64_tr_b16 v[112:113], v21 offset:32768
s_add_u32 s62, s65, 111616
v_mfma_f32_16x16x32_bf16 a[124:127], v[140:143], v[188:191], a[124:127]
v_mfma_f32_16x16x32_bf16 a[128:131], v[144:147], v[160:163], a[128:131]
ds_read_b64_tr_b16 v[114:115], v21 offset:34816
buffer_load_dwordx4 v9, s[8:11], s62 offen offset:3072 lds
v_mfma_f32_16x16x32_bf16 a[132:135], v[144:147], v[164:167], a[132:135]
v_mfma_f32_16x16x32_bf16 a[136:139], v[144:147], v[168:171], a[136:139]
ds_read_b128 v[84:87], v16 offset:41984
s_add_u32 s65, s65, 128
v_mfma_f32_16x16x32_bf16 a[140:143], v[144:147], v[172:175], a[140:143]
v_mfma_f32_16x16x32_bf16 a[144:147], v[144:147], v[176:179], a[144:147]
s_add_u32 m0, s64, 81920
v_mfma_f32_16x16x32_bf16 a[148:151], v[144:147], v[180:183], a[148:151]
ds_read_b64_tr_b16 v[116:117], v22 offset:32768
v_mfma_f32_16x16x32_bf16 a[152:155], v[144:147], v[184:187], a[152:155]
s_nop 0
v_mfma_f32_16x16x32_bf16 a[156:159], v[144:147], v[188:191], a[156:159]
ds_read_b64_tr_b16 v[118:119], v22 offset:34816
buffer_load_dwordx4 v12, s[12:15], s66 offen lds
v_mfma_f32_16x16x32_bf16 a[160:163], v[148:151], v[160:163], a[160:163]
v_mfma_f32_16x16x32_bf16 a[164:167], v[148:151], v[164:167], a[164:167]
ds_read_b128 v[88:91], v16 offset:45056
buffer_load_dwordx4 v13, s[12:15], s66 offen offset:1024 lds
v_mfma_f32_16x16x32_bf16 a[168:171], v[148:151], v[168:171], a[168:171]
v_mfma_f32_16x16x32_bf16 a[172:175], v[148:151], v[172:175], a[172:175]
ds_read_b64_tr_b16 v[120:121], v23 offset:32768
buffer_load_dwordx4 v14, s[12:15], s66 offen offset:2048 lds
v_mfma_f32_16x16x32_bf16 a[176:179], v[148:151], v[176:179], a[176:179]
v_mfma_f32_16x16x32_bf16 a[180:183], v[148:151], v[180:183], a[180:183]
buffer_load_dwordx4 v15, s[12:15], s66 offen offset:3072 lds
v_mfma_f32_16x16x32_bf16 a[184:187], v[148:151], v[184:187], a[184:187]
ds_read_b64_tr_b16 v[122:123], v23 offset:34816
v_mfma_f32_16x16x32_bf16 a[188:191], v[148:151], v[188:191], a[188:191]
s_add_u32 s66, s66, 262144
v_mfma_f32_16x16x32_bf16 a[192:195], v[152:155], v[160:163], a[192:195]
ds_read_b128 v[92:95], v16 offset:46080
v_mfma_f32_16x16x32_bf16 a[196:199], v[152:155], v[164:167], a[196:199]
v_mfma_f32_16x16x32_bf16 a[200:203], v[152:155], v[168:171], a[200:203]
ds_read_b64_tr_b16 v[124:125], v24 offset:32768
v_mfma_f32_16x16x32_bf16 a[204:207], v[152:155], v[172:175], a[204:207]
v_mfma_f32_16x16x32_bf16 a[208:211], v[152:155], v[176:179], a[208:211]
ds_read_b64_tr_b16 v[126:127], v24 offset:34816
buffer_load_dword v248, v246, s[80:83], 0 offen
v_mfma_f32_16x16x32_bf16 a[212:215], v[152:155], v[180:183], a[212:215]
v_mfma_f32_16x16x32_bf16 a[216:219], v[152:155], v[184:187], a[216:219]
v_mfma_f32_16x16x32_bf16 a[220:223], v[152:155], v[188:191], a[220:223]
v_mfma_f32_16x16x32_bf16 a[224:227], v[156:159], v[160:163], a[224:227]
v_mfma_f32_16x16x32_bf16 a[228:231], v[156:159], v[164:167], a[228:231]
v_mfma_f32_16x16x32_bf16 a[232:235], v[156:159], v[168:171], a[232:235]
v_mfma_f32_16x16x32_bf16 a[236:239], v[156:159], v[172:175], a[236:239]
v_mfma_f32_16x16x32_bf16 a[240:243], v[156:159], v[176:179], a[240:243]
v_mfma_f32_16x16x32_bf16 a[244:247], v[156:159], v[180:183], a[244:247]
v_mfma_f32_16x16x32_bf16 a[248:251], v[156:159], v[184:187], a[248:251]
v_mfma_f32_16x16x32_bf16 a[252:255], v[156:159], v[188:191], a[252:255]
s_waitcnt lgkmcnt(0)
v_mfma_f32_16x16x32_bf16 a[0:3], v[64:67], v[96:99], a[0:3]
s_waitcnt vmcnt(19)
s_barrier
v_mfma_f32_16x16x32_bf16 a[4:7], v[64:67], v[100:103], a[4:7]
ds_read_b128 v[128:131], v10 offset:32768
v_mfma_f32_16x16x32_bf16 a[8:11], v[64:67], v[104:107], a[8:11]
s_add_u32 m0, s64, 98304
v_mfma_f32_16x16x32_bf16 a[12:15], v[64:67], v[108:111], a[12:15]
ds_read_b64_tr_b16 v[160:161], v17 offset:49152
v_mfma_f32_16x16x32_bf16 a[16:19], v[64:67], v[112:115], a[16:19]
v_mfma_f32_16x16x32_bf16 a[20:23], v[64:67], v[116:119], a[20:23]
ds_read_b64_tr_b16 v[162:163], v17 offset:51200
v_mfma_f32_16x16x32_bf16 a[24:27], v[64:67], v[120:123], a[24:27]
v_mfma_f32_16x16x32_bf16 a[28:31], v[64:67], v[124:127], a[28:31]
ds_read_b128 v[132:135], v10 offset:33792
v_mfma_f32_16x16x32_bf16 a[32:35], v[68:71], v[96:99], a[32:35]
s_nop 0
v_mfma_f32_16x16x32_bf16 a[36:39], v[68:71], v[100:103], a[36:39]
v_mfma_f32_16x16x32_bf16 a[40:43], v[68:71], v[104:107], a[40:43]
ds_read_b64_tr_b16 v[164:165], v18 offset:49152
v_mfma_f32_16x16x32_bf16 a[44:47], v[68:71], v[108:111], a[44:47]
v_mfma_f32_16x16x32_bf16 a[48:51], v[68:71], v[112:115], a[48:51]
ds_read_b64_tr_b16 v[166:167], v18 offset:51200
v_mfma_f32_16x16x32_bf16 a[52:55], v[68:71], v[116:119], a[52:55]
v_mfma_f32_16x16x32_bf16 a[56:59], v[68:71], v[120:123], a[56:59]
ds_read_b128 v[136:139], v10 offset:36864
v_mfma_f32_16x16x32_bf16 a[60:63], v[68:71], v[124:127], a[60:63]
buffer_load_dwordx4 v12, s[12:15], s66 offen lds
v_mfma_f32_16x16x32_bf16 a[64:67], v[72:75], v[96:99], a[64:67]
ds_read_b64_tr_b16 v[168:169], v19 offset:49152
v_mfma_f32_16x16x32_bf16 a[68:71], v[72:75], v[100:103], a[68:71]
v_mfma_f32_16x16x32_bf16 a[72:75], v[72:75], v[104:107], a[72:75]
v_mfma_f32_16x16x32_bf16 a[76:79], v[72:75], v[108:111], a[76:79]
ds_read_b64_tr_b16 v[170:171], v19 offset:51200
v_mfma_f32_16x16x32_bf16 a[80:83], v[72:75], v[112:115], a[80:83]
v_mfma_f32_16x16x32_bf16 a[84:87], v[72:75], v[116:119], a[84:87]
ds_read_b128 v[140:143], v10 offset:37888
v_mfma_f32_16x16x32_bf16 a[88:91], v[72:75], v[120:123], a[88:91]
buffer_load_dwordx4 v13, s[12:15], s66 offen offset:1024 lds
v_mfma_f32_16x16x32_bf16 a[92:95], v[72:75], v[124:127], a[92:95]
ds_read_b64_tr_b16 v[172:173], v20 offset:49152
v_mfma_f32_16x16x32_bf16 a[96:99], v[76:79], v[96:99], a[96:99]
v_mfma_f32_16x16x32_bf16 a[100:103], v[76:79], v[100:103], a[100:103]
ds_read_b64_tr_b16 v[174:175], v20 offset:51200
v_mfma_f32_16x16x32_bf16 a[104:107], v[76:79], v[104:107], a[104:107]
v_mfma_f32_16x16x32_bf16 a[108:111], v[76:79], v[108:111], a[108:111]
v_mfma_f32_16x16x32_bf16 a[112:115], v[76:79], v[112:115], a[112:115]
ds_read_b128 v[144:147], v10 offset:40960
buffer_load_dwordx4 v14, s[12:15], s66 offen offset:2048 lds
v_mfma_f32_16x16x32_bf16 a[116:119], v[76:79], v[116:119], a[116:119]
v_mfma_f32_16x16x32_bf16 a[120:123], v[76:79], v[120:123], a[120:123]
ds_read_b64_tr_b16 v[176:177], v21 offset:49152
v_mfma_f32_16x16x32_bf16 a[124:127], v[76:79], v[124:127], a[124:127]
v_mfma_f32_16x16x32_bf16 a[128:131], v[80:83], v[96:99], a[128:131]
ds_read_b64_tr_b16 v[178:179], v21 offset:51200
v_mfma_f32_16x16x32_bf16 a[132:135], v[80:83], v[100:103], a[132:135]
v_mfma_f32_16x16x32_bf16 a[136:139], v[80:83], v[104:107], a[136:139]
ds_read_b128 v[148:151], v10 offset:41984
v_mfma_f32_16x16x32_bf16 a[140:143], v[80:83], v[108:111], a[140:143]
buffer_load_dwordx4 v15, s[12:15], s66 offen offset:3072 lds
v_mfma_f32_16x16x32_bf16 a[144:147], v[80:83], v[112:115], a[144:147]
v_mfma_f32_16x16x32_bf16 a[148:151], v[80:83], v[116:119], a[148:151]
ds_read_b64_tr_b16 v[180:181], v22 offset:49152
v_mfma_f32_16x16x32_bf16 a[152:155], v[80:83], v[120:123], a[152:155]
v_mfma_f32_16x16x32_bf16 a[156:159], v[80:83], v[124:127], a[156:159]
ds_read_b64_tr_b16 v[182:183], v22 offset:51200
v_mfma_f32_16x16x32_bf16 a[160:163], v[84:87], v[96:99], a[160:163]
v_mfma_f32_16x16x32_bf16 a[164:167], v[84:87], v[100:103], a[164:167]
ds_read_b128 v[152:155], v10 offset:45056
v_mfma_f32_16x16x32_bf16 a[168:171], v[84:87], v[104:107], a[168:171]
s_add_u32 s66, s66, 262144
v_mfma_f32_16x16x32_bf16 a[172:175], v[84:87], v[108:111], a[172:175]
ds_read_b64_tr_b16 v[184:185], v23 offset:49152
v_mfma_f32_16x16x32_bf16 a[176:179], v[84:87], v[112:115], a[176:179]
v_mfma_f32_16x16x32_bf16 a[180:183], v[84:87], v[116:119], a[180:183]
v_mfma_f32_16x16x32_bf16 a[184:187], v[84:87], v[120:123], a[184:187]
ds_read_b64_tr_b16 v[186:187], v23 offset:51200
v_mfma_f32_16x16x32_bf16 a[188:191], v[84:87], v[124:127], a[188:191]
v_mfma_f32_16x16x32_bf16 a[192:195], v[88:91], v[96:99], a[192:195]
ds_read_b128 v[156:159], v10 offset:46080
v_mfma_f32_16x16x32_bf16 a[196:199], v[88:91], v[100:103], a[196:199]
v_mfma_f32_16x16x32_bf16 a[200:203], v[88:91], v[104:107], a[200:203]
ds_read_b64_tr_b16 v[188:189], v24 offset:49152
s_waitcnt vmcnt(17)
s_mov_b32 s87, 0
PSA_9:
v_and_b32 v56, v56, v57
v_and_b32 v58, v58, v59
v_and_b32 v56, v56, v58
v_cmp_ne_u32 vcc, 1, v56
s_cbranch_vccz PSA_9_OK
s_sleep 1
buffer_load_dwordx4 v[56:59], v5, s[88:91], 0 offen sc1
s_waitcnt vmcnt(0)
s_add_u32 s87, s87, 1
s_cmp_lt_u32 s87, 65536
s_cbranch_scc1 PSA_9
PSA_9_OK:
v_mfma_f32_16x16x32_bf16 a[204:207], v[88:91], v[108:111], a[204:207]
v_mfma_f32_16x16x32_bf16 a[208:211], v[88:91], v[112:115], a[208:211]
ds_read_b64_tr_b16 v[190:191], v24 offset:51200
v_mfma_f32_16x16x32_bf16 a[212:215], v[88:91], v[116:119], a[212:215]
v_mfma_f32_16x16x32_bf16 a[216:219], v[88:91], v[120:123], a[216:219]
v_mfma_f32_16x16x32_bf16 a[220:223], v[88:91], v[124:127], a[220:223]
v_mfma_f32_16x16x32_bf16 a[224:227], v[92:95], v[96:99], a[224:227]
v_mfma_f32_16x16x32_bf16 a[228:231], v[92:95], v[100:103], a[228:231]
v_mfma_f32_16x16x32_bf16 a[232:235], v[92:95], v[104:107], a[232:235]
v_mfma_f32_16x16x32_bf16 a[236:239], v[92:95], v[108:111], a[236:239]
v_mfma_f32_16x16x32_bf16 a[240:243], v[92:95], v[112:115], a[240:243]
v_mfma_f32_16x16x32_bf16 a[244:247], v[92:95], v[116:119], a[244:247]
v_mfma_f32_16x16x32_bf16 a[248:251], v[92:95], v[120:123], a[248:251]
v_mfma_f32_16x16x32_bf16 a[252:255], v[92:95], v[124:127], a[252:255]
s_waitcnt lgkmcnt(0)
v_mfma_f32_16x16x32_bf16 a[0:3], v[128:131], v[160:163], a[0:3]
s_waitcnt vmcnt(9)
s_barrier
v_mfma_f32_16x16x32_bf16 a[4:7], v[128:131], v[164:167], a[4:7]
ds_read_b128 v[64:67], v16
v_mfma_f32_16x16x32_bf16 a[8:11], v[128:131], v[168:171], a[8:11]
s_add_u32 m0, s63, 32768
v_mfma_f32_16x16x32_bf16 a[12:15], v[128:131], v[172:175], a[12:15]
ds_read_b64_tr_b16 v[96:97], v17
s_add_u32 s62, s65, 0
v_mfma_f32_16x16x32_bf16 a[16:19], v[128:131], v[176:179], a[16:19]
v_mfma_f32_16x16x32_bf16 a[20:23], v[128:131], v[180:183], a[20:23]
ds_read_b64_tr_b16 v[98:99], v17 offset:2048
buffer_load_dwordx4 v8, s[8:11], s62 offen lds
v_mfma_f32_16x16x32_bf16 a[24:27], v[128:131], v[184:187], a[24:27]
v_mfma_f32_16x16x32_bf16 a[28:31], v[128:131], v[188:191], a[28:31]
ds_read_b128 v[68:71], v16 offset:1024
s_add_u32 s62, s65, 15360
v_mfma_f32_16x16x32_bf16 a[32:35], v[132:135], v[160:163], a[32:35]
v_mfma_f32_16x16x32_bf16 a[36:39], v[132:135], v[164:167], a[36:39]
buffer_load_dwordx4 v8, s[8:11], s62 offen offset:1024 lds
v_mfma_f32_16x16x32_bf16 a[40:43], v[132:135], v[168:171], a[40:43]
ds_read_b64_tr_b16 v[100:101], v18
v_mfma_f32_16x16x32_bf16 a[44:47], v[132:135], v[172:175], a[44:47]
s_add_u32 s62, s65, 30720
v_mfma_f32_16x16x32_bf16 a[48:51], v[132:135], v[176:179], a[48:51]
ds_read_b64_tr_b16 v[102:103], v18 offset:2048
buffer_load_dwordx4 v9, s[8:11], s62 offen offset:2048 lds
v_mfma_f32_16x16x32_bf16 a[52:55], v[132:135], v[180:183], a[52:55]
v_mfma_f32_16x16x32_bf16 a[56:59], v[132:135], v[184:187], a[56:59]
ds_read_b128 v[72:75], v16 offset:4096
s_add_u32 s62, s65, 46080
v_mfma_f32_16x16x32_bf16 a[60:63], v[132:135], v[188:191], a[60:63]
v_mfma_f32_16x16x32_bf16 a[64:67], v[136:139], v[160:163], a[64:67]
ds_read_b64_tr_b16 v[104:105], v19
buffer_load_dwordx4 v9, s[8:11], s62 offen offset:3072 lds
v_mfma_f32_16x16x32_bf16 a[68:71], v[136:139], v[164:167], a[68:71]
v_mfma_f32_16x16x32_bf16 a[72:75], v[136:139], v[168:171], a[72:75]
s_add_u32 m0, s63, 36864
v_mfma_f32_16x16x32_bf16 a[76:79], v[136:139], v[172:175], a[76:79]
ds_read_b64_tr_b16 v[106:107], v19 offset:2048
v_mfma_f32_16x16x32_bf16 a[80:83], v[136:139], v[176:179], a[80:83]
s_add_u32 s62, s65, 65536
v_mfma_f32_16x16x32_bf16 a[84:87], v[136:139], v[180:183], a[84:87]
ds_read_b128 v[76:79], v16 offset:5120
buffer_load_dwordx4 v8, s[8:11], s62 offen lds
v_mfma_f32_16x16x32_bf16 a[88:91], v[136:139], v[184:187], a[88:91]
v_mfma_f32_16x16x32_bf16 a[92:95], v[136:139], v[188:191], a[92:95]
ds_read_b64_tr_b16 v[108:109], v20
s_add_u32 s62, s65, 80896
v_mfma_f32_16x16x32_bf16 a[96:99], v[140:143], v[160:163], a[96:99]
v_mfma_f32_16x16x32_bf16 a[100:103], v[140:143], v[164:167], a[100:103]
ds_read_b64_tr_b16 v[110:111], v20 offset:2048
buffer_load_dwordx4 v8, s[8:11], s62 offen offset:1024 lds
v_mfma_f32_16x16x32_bf16 a[104:107], v[140:143], v[168:171], a[104:107]
v_mfma_f32_16x16x32_bf16 a[108:111], v[140:143], v[172:175], a[108:111]
s_add_u32 s62, s65, 96256
v_mfma_f32_16x16x32_bf16 a[112:115], v[140:143], v[176:179], a[112:115]
ds_read_b128 v[80:83], v16 offset:8192
v_mfma_f32_16x16x32_bf16 a[116:119], v[140:143], v[180:183], a[116:119]
buffer_load_dwordx4 v9, s[8:11], s62 offen offset:2048 lds
v_mfma_f32_16x16x32_bf16 a[120:123], v[140:143], v[184:187], a[120:123]
ds_read_b64_tr_b16 v[112:113], v21
s_add_u32 s62, s65, 111616
v_mfma_f32_16x16x32_bf16 a[124:127], v[140:143], v[188:191], a[124:127]
v_mfma_f32_16x16x32_bf16 a[128:131], v[144:147], v[160:163], a[128:131]
ds_read_b64_tr_b16 v[114:115], v21 offset:2048
buffer_load_dwordx4 v9, s[8:11], s62 offen offset:3072 lds
v_mfma_f32_16x16x32_bf16 a[132:135], v[144:147], v[164:167], a[132:135]
v_mfma_f32_16x16x32_bf16 a[136:139], v[144:147], v[168:171], a[136:139]
ds_read_b128 v[84:87], v16 offset:9216
s_add_u32 s65, s65, 128
v_mfma_f32_16x16x32_bf16 a[140:143], v[144:147], v[172:175], a[140:143]
v_mfma_f32_16x16x32_bf16 a[144:147], v[144:147], v[176:179], a[144:147]
s_add_u32 m0, s64, 114688
v_mfma_f32_16x16x32_bf16 a[148:151], v[144:147], v[180:183], a[148:151]
ds_read_b64_tr_b16 v[116:117], v22
v_mfma_f32_16x16x32_bf16 a[152:155], v[144:147], v[184:187], a[152:155]
s_nop 0
v_mfma_f32_16x16x32_bf16 a[156:159], v[144:147], v[188:191], a[156:159]
ds_read_b64_tr_b16 v[118:119], v22 offset:2048
buffer_load_dwordx4 v12, s[12:15], s66 offen lds
v_mfma_f32_16x16x32_bf16 a[160:163], v[148:151], v[160:163], a[160:163]
v_mfma_f32_16x16x32_bf16 a[164:167], v[148:151], v[164:167], a[164:167]
ds_read_b128 v[88:91], v16 offset:12288
buffer_load_dwordx4 v13, s[12:15], s66 offen offset:1024 lds
v_mfma_f32_16x16x32_bf16 a[168:171], v[148:151], v[168:171], a[168:171]
v_mfma_f32_16x16x32_bf16 a[172:175], v[148:151], v[172:175], a[172:175]
ds_read_b64_tr_b16 v[120:121], v23
buffer_load_dwordx4 v14, s[12:15], s66 offen offset:2048 lds
v_mfma_f32_16x16x32_bf16 a[176:179], v[148:151], v[176:179], a[176:179]
v_mfma_f32_16x16x32_bf16 a[180:183], v[148:151], v[180:183], a[180:183]
buffer_load_dwordx4 v15, s[12:15], s66 offen offset:3072 lds
v_mfma_f32_16x16x32_bf16 a[184:187], v[148:151], v[184:187], a[184:187]
ds_read_b64_tr_b16 v[122:123], v23 offset:2048
v_mfma_f32_16x16x32_bf16 a[188:191], v[148:151], v[188:191], a[188:191]
s_add_u32 s66, s66, 262144
v_mfma_f32_16x16x32_bf16 a[192:195], v[152:155], v[160:163], a[192:195]
ds_read_b128 v[92:95], v16 offset:13312
v_mfma_f32_16x16x32_bf16 a[196:199], v[152:155], v[164:167], a[196:199]
v_mfma_f32_16x16x32_bf16 a[200:203], v[152:155], v[168:171], a[200:203]
ds_read_b64_tr_b16 v[124:125], v24
v_mfma_f32_16x16x32_bf16 a[204:207], v[152:155], v[172:175], a[204:207]
v_mfma_f32_16x16x32_bf16 a[208:211], v[152:155], v[176:179], a[208:211]
ds_read_b64_tr_b16 v[126:127], v24 offset:2048
v_mfma_f32_16x16x32_bf16 a[212:215], v[152:155], v[180:183], a[212:215]
v_mfma_f32_16x16x32_bf16 a[216:219], v[152:155], v[184:187], a[216:219]
v_mfma_f32_16x16x32_bf16 a[220:223], v[152:155], v[188:191], a[220:223]
v_mfma_f32_16x16x32_bf16 a[224:227], v[156:159], v[160:163], a[224:227]
v_mfma_f32_16x16x32_bf16 a[228:231], v[156:159], v[164:167], a[228:231]
v_mfma_f32_16x16x32_bf16 a[232:235], v[156:159], v[168:171], a[232:235]
v_mfma_f32_16x16x32_bf16 a[236:239], v[156:159], v[172:175], a[236:239]
v_mfma_f32_16x16x32_bf16 a[240:243], v[156:159], v[176:179], a[240:243]
v_mfma_f32_16x16x32_bf16 a[244:247], v[156:159], v[180:183], a[244:247]
v_mfma_f32_16x16x32_bf16 a[248:251], v[156:159], v[184:187], a[248:251]
v_mfma_f32_16x16x32_bf16 a[252:255], v[156:159], v[188:191], a[252:255]
s_waitcnt lgkmcnt(0)
v_mfma_f32_16x16x32_bf16 a[0:3], v[64:67], v[96:99], a[0:3]
s_waitcnt vmcnt(17)
s_barrier
v_mfma_f32_16x16x32_bf16 a[4:7], v[64:67], v[100:103], a[4:7]
ds_read_b128 v[128:131], v10
v_mfma_f32_16x16x32_bf16 a[8:11], v[64:67], v[104:107], a[8:11]
s_add_u32 m0, s64, 65536
v_mfma_f32_16x16x32_bf16 a[12:15], v[64:67], v[108:111], a[12:15]
ds_read_b64_tr_b16 v[160:161], v17 offset:16384
v_mfma_f32_16x16x32_bf16 a[16:19], v[64:67], v[112:115], a[16:19]
v_mfma_f32_16x16x32_bf16 a[20:23], v[64:67], v[116:119], a[20:23]
ds_read_b64_tr_b16 v[162:163], v17 offset:18432
v_mfma_f32_16x16x32_bf16 a[24:27], v[64:67], v[120:123], a[24:27]
s_add_u32 s56, s69, 0
v_mfma_f32_16x16x32_bf16 a[28:31], v[64:67], v[124:127], a[28:31]
ds_read_b128 v[132:135], v10 offset:1024
v_mfma_f32_16x16x32_bf16 a[32:35], v[68:71], v[96:99], a[32:35]
v_mfma_f32_16x16x32_bf16 a[36:39], v[68:71], v[100:103], a[36:39]
v_mfma_f32_16x16x32_bf16 a[40:43], v[68:71], v[104:107], a[40:43]
ds_read_b64_tr_b16 v[164:165], v18 offset:16384
v_mfma_f32_16x16x32_bf16 a[44:47], v[68:71], v[108:111], a[44:47]
buffer_load_dwordx4 v5, s[24:27], s56 offen sc1 lds
v_mfma_f32_16x16x32_bf16 a[48:51], v[68:71], v[112:115], a[48:51]
ds_read_b64_tr_b16 v[166:167], v18 offset:18432
v_mfma_f32_16x16x32_bf16 a[52:55], v[68:71], v[116:119], a[52:55]
v_mfma_f32_16x16x32_bf16 a[56:59], v[68:71], v[120:123], a[56:59]
ds_read_b128 v[136:139], v10 offset:4096
v_mfma_f32_16x16x32_bf16 a[60:63], v[68:71], v[124:127], a[60:63]
v_mfma_f32_16x16x32_bf16 a[64:67], v[72:75], v[96:99], a[64:67]
ds_read_b64_tr_b16 v[168:169], v19 offset:16384
buffer_load_dwordx4 v5, s[24:27], s56 offen offset:1024 sc1 lds
v_mfma_f32_16x16x32_bf16 a[68:71], v[72:75], v[100:103], a[68:71]
v_mfma_f32_16x16x32_bf16 a[72:75], v[72:75], v[104:107], a[72:75]
v_mfma_f32_16x16x32_bf16 a[76:79], v[72:75], v[108:111], a[76:79]
ds_read_b64_tr_b16 v[170:171], v19 offset:18432
v_mfma_f32_16x16x32_bf16 a[80:83], v[72:75], v[112:115], a[80:83]
v_mfma_f32_16x16x32_bf16 a[84:87], v[72:75], v[116:119], a[84:87]
ds_read_b128 v[140:143], v10 offset:5120
buffer_load_dwordx4 v5, s[24:27], s56 offen offset:2048 sc1 lds
v_mfma_f32_16x16x32_bf16 a[88:91], v[72:75], v[120:123], a[88:91]
v_mfma_f32_16x16x32_bf16 a[92:95], v[72:75], v[124:127], a[92:95]
ds_read_b64_tr_b16 v[172:173], v20 offset:16384
v_mfma_f32_16x16x32_bf16 a[96:99], v[76:79], v[96:99], a[96:99]
v_mfma_f32_16x16x32_bf16 a[100:103], v[76:79], v[100:103], a[100:103]
ds_read_b64_tr_b16 v[174:175], v20 offset:18432
v_mfma_f32_16x16x32_bf16 a[104:107], v[76:79], v[104:107], a[104:107]
buffer_load_dwordx4 v5, s[24:27], s56 offen offset:3072 sc1 lds
v_mfma_f32_16x16x32_bf16 a[108:111], v[76:79], v[108:111], a[108:111]
v_mfma_f32_16x16x32_bf16 a[112:115], v[76:79], v[112:115], a[112:115]
ds_read_b128 v[144:147], v10 offset:8192
v_mfma_f32_16x16x32_bf16 a[116:119], v[76:79], v[116:119], a[116:119]
v_mfma_f32_16x16x32_bf16 a[120:123], v[76:79], v[120:123], a[120:123]
ds_read_b64_tr_b16 v[176:177], v21 offset:16384
v_mfma_f32_16x16x32_bf16 a[124:127], v[76:79], v[124:127], a[124:127]
v_mfma_f32_16x16x32_bf16 a[128:131], v[80:83], v[96:99], a[128:131]
ds_read_b64_tr_b16 v[178:179], v21 offset:18432
v_mfma_f32_16x16x32_bf16 a[132:135], v[80:83], v[100:103], a[132:135]
v_mfma_f32_16x16x32_bf16 a[136:139], v[80:83], v[104:107], a[136:139]
ds_read_b128 v[148:151], v10 offset:9216
s_add_u32 m0, s86, 16384
v_mfma_f32_16x16x32_bf16 a[140:143], v[80:83], v[108:111], a[140:143]
v_mfma_f32_16x16x32_bf16 a[144:147], v[80:83], v[112:115], a[144:147]
s_nop 0
v_mfma_f32_16x16x32_bf16 a[148:151], v[80:83], v[116:119], a[148:151]
ds_read_b64_tr_b16 v[180:181], v22 offset:16384
v_mfma_f32_16x16x32_bf16 a[152:155], v[80:83], v[120:123], a[152:155]
v_mfma_f32_16x16x32_bf16 a[156:159], v[80:83], v[124:127], a[156:159]
ds_read_b64_tr_b16 v[182:183], v22 offset:18432
buffer_load_dwordx4 v27, s[28:31], s60 offen lds
v_mfma_f32_16x16x32_bf16 a[160:163], v[84:87], v[96:99], a[160:163]
v_mfma_f32_16x16x32_bf16 a[164:167], v[84:87], v[100:103], a[164:167]
ds_read_b128 v[152:155], v10 offset:12288
v_mfma_f32_16x16x32_bf16 a[168:171], v[84:87], v[104:107], a[168:171]
buffer_load_dwordx4 v28, s[28:31], s60 offen offset:1024 lds
v_mfma_f32_16x16x32_bf16 a[172:175], v[84:87], v[108:111], a[172:175]
ds_read_b64_tr_b16 v[184:185], v23 offset:16384
v_mfma_f32_16x16x32_bf16 a[176:179], v[84:87], v[112:115], a[176:179]
s_add_u32 s60, s60, 131072
v_mfma_f32_16x16x32_bf16 a[180:183], v[84:87], v[116:119], a[180:183]
v_mfma_f32_16x16x32_bf16 a[184:187], v[84:87], v[120:123], a[184:187]
ds_read_b64_tr_b16 v[186:187], v23 offset:18432
v_mfma_f32_16x16x32_bf16 a[188:191], v[84:87], v[124:127], a[188:191]
s_add_u32 m0, s86, 18432
v_mfma_f32_16x16x32_bf16 a[192:195], v[88:91], v[96:99], a[192:195]
ds_read_b128 v[156:159], v10 offset:13312
v_mfma_f32_16x16x32_bf16 a[196:199], v[88:91], v[100:103], a[196:199]
v_mfma_f32_16x16x32_bf16 a[200:203], v[88:91], v[104:107], a[200:203]
ds_read_b64_tr_b16 v[188:189], v24 offset:16384
s_nop 0
v_mfma_f32_16x16x32_bf16 a[204:207], v[88:91], v[108:111], a[204:207]
v_mfma_f32_16x16x32_bf16 a[208:211], v[88:91], v[112:115], a[208:211]
ds_read_b64_tr_b16 v[190:191], v24 offset:18432
buffer_load_dwordx4 v27, s[28:31], s60 offen lds
v_mfma_f32_16x16x32_bf16 a[212:215], v[88:91], v[116:119], a[212:215]
v_mfma_f32_16x16x32_bf16 a[216:219], v[88:91], v[120:123], a[216:219]
v_mfma_f32_16x16x32_bf16 a[220:223], v[88:91], v[124:127], a[220:223]
buffer_load_dwordx4 v28, s[28:31], s60 offen offset:1024 lds
v_mfma_f32_16x16x32_bf16 a[224:227], v[92:95], v[96:99], a[224:227]
v_mfma_f32_16x16x32_bf16 a[228:231], v[92:95], v[100:103], a[228:231]
v_mfma_f32_16x16x32_bf16 a[232:235], v[92:95], v[104:107], a[232:235]
s_add_u32 s60, s60, 131072
v_mfma_f32_16x16x32_bf16 a[236:239], v[92:95], v[108:111], a[236:239]
v_mfma_f32_16x16x32_bf16 a[240:243], v[92:95], v[112:115], a[240:243]
v_mfma_f32_16x16x32_bf16 a[244:247], v[92:95], v[116:119], a[244:247]
v_mfma_f32_16x16x32_bf16 a[248:251], v[92:95], v[120:123], a[248:251]
v_mfma_f32_16x16x32_bf16 a[252:255], v[92:95], v[124:127], a[252:255]
s_waitcnt lgkmcnt(0)
v_mfma_f32_16x16x32_bf16 a[0:3], v[128:131], v[160:163], a[0:3]
s_waitcnt vmcnt(12)
s_barrier
v_mfma_f32_16x16x32_bf16 a[4:7], v[128:131], v[164:167], a[4:7]
ds_read_b128 v[64:67], v16 offset:32768
v_mfma_f32_16x16x32_bf16 a[8:11], v[128:131], v[168:171], a[8:11]
s_add_u32 m0, s64, 81920
v_mfma_f32_16x16x32_bf16 a[12:15], v[128:131], v[172:175], a[12:15]
ds_read_b64_tr_b16 v[96:97], v17 offset:32768
s_add_u32 s56, s69, 4096
v_mfma_f32_16x16x32_bf16 a[16:19], v[128:131], v[176:179], a[16:19]
v_mfma_f32_16x16x32_bf16 a[20:23], v[128:131], v[180:183], a[20:23]
ds_read_b64_tr_b16 v[98:99], v17 offset:34816
buffer_load_dwordx4 v5, s[24:27], s56 offen sc1 lds
v_mfma_f32_16x16x32_bf16 a[24:27], v[128:131], v[184:187], a[24:27]
buffer_load_dwordx4 v5, s[24:27], s56 offen offset:1024 sc1 lds
v_mfma_f32_16x16x32_bf16 a[28:31], v[128:131], v[188:191], a[28:31]
ds_read_b128 v[68:71], v16 offset:33792
v_mfma_f32_16x16x32_bf16 a[32:35], v[132:135], v[160:163], a[32:35]
buffer_load_dwordx4 v5, s[24:27], s56 offen offset:2048 sc1 lds
v_mfma_f32_16x16x32_bf16 a[36:39], v[132:135], v[164:167], a[36:39]
v_mfma_f32_16x16x32_bf16 a[40:43], v[132:135], v[168:171], a[40:43]
ds_read_b64_tr_b16 v[100:101], v18 offset:32768
buffer_load_dwordx4 v5, s[24:27], s56 offen offset:3072 sc1 lds
v_mfma_f32_16x16x32_bf16 a[44:47], v[132:135], v[172:175], a[44:47]
s_add_u32 m0, s64, 0
v_mfma_f32_16x16x32_bf16 a[48:51], v[132:135], v[176:179], a[48:51]
ds_read_b64_tr_b16 v[102:103], v18 offset:34816
v_mfma_f32_16x16x32_bf16 a[52:55], v[132:135], v[180:183], a[52:55]
s_add_u32 s56, s69, 8192
v_mfma_f32_16x16x32_bf16 a[56:59], v[132:135], v[184:187], a[56:59]
ds_read_b128 v[72:75], v16 offset:36864
buffer_load_dwordx4 v5, s[24:27], s56 offen sc1 lds
v_mfma_f32_16x16x32_bf16 a[60:63], v[132:135], v[188:191], a[60:63]
v_mfma_f32_16x16x32_bf16 a[64:67], v[136:139], v[160:163], a[64:67]
ds_read_b64_tr_b16 v[104:105], v19 offset:32768
buffer_load_dwordx4 v5, s[24:27], s56 offen offset:1024 sc1 lds
v_mfma_f32_16x16x32_bf16 a[68:71], v[136:139], v[164:167], a[68:71]
v_mfma_f32_16x16x32_bf16 a[72:75], v[136:139], v[168:171], a[72:75]
buffer_load_dwordx4 v5, s[24:27], s56 offen offset:2048 sc1 lds
v_mfma_f32_16x16x32_bf16 a[76:79], v[136:139], v[172:175], a[76:79]
ds_read_b64_tr_b16 v[106:107], v19 offset:34816
buffer_load_dwordx4 v5, s[24:27], s56 offen offset:3072 sc1 lds
v_mfma_f32_16x16x32_bf16 a[80:83], v[136:139], v[176:179], a[80:83]
v_mfma_f32_16x16x32_bf16 a[84:87], v[136:139], v[180:183], a[84:87]
ds_read_b128 v[76:79], v16 offset:37888
s_add_u32 m0, s64, 16384
v_mfma_f32_16x16x32_bf16 a[88:91], v[136:139], v[184:187], a[88:91]
s_add_u32 s56, s69, 12288
v_mfma_f32_16x16x32_bf16 a[92:95], v[136:139], v[188:191], a[92:95]
ds_read_b64_tr_b16 v[108:109], v20 offset:32768
v_mfma_f32_16x16x32_bf16 a[96:99], v[140:143], v[160:163], a[96:99]
buffer_load_dwordx4 v5, s[24:27], s56 offen sc1 lds
v_mfma_f32_16x16x32_bf16 a[100:103], v[140:143], v[164:167], a[100:103]
ds_read_b64_tr_b16 v[110:111], v20 offset:34816
v_mfma_f32_16x16x32_bf16 a[104:107], v[140:143], v[168:171], a[104:107]
buffer_load_dwordx4 v5, s[24:27], s56 offen offset:1024 sc1 lds
v_mfma_f32_16x16x32_bf16 a[108:111], v[140:143], v[172:175], a[108:111]
buffer_load_dwordx4 v5, s[24:27], s56 offen offset:2048 sc1 lds
v_mfma_f32_16x16x32_bf16 a[112:115], v[140:143], v[176:179], a[112:115]
ds_read_b128 v[80:83], v16 offset:40960
v_mfma_f32_16x16x32_bf16 a[116:119], v[140:143], v[180:183], a[116:119]
buffer_load_dwordx4 v5, s[24:27], s56 offen offset:3072 sc1 lds
v_mfma_f32_16x16x32_bf16 a[120:123], v[140:143], v[184:187], a[120:123]
ds_read_b64_tr_b16 v[112:113], v21 offset:32768
v_mfma_f32_16x16x32_bf16 a[124:127], v[140:143], v[188:191], a[124:127]
v_mfma_f32_16x16x32_bf16 a[128:131], v[144:147], v[160:163], a[128:131]
ds_read_b64_tr_b16 v[114:115], v21 offset:34816
v_mfma_f32_16x16x32_bf16 a[132:135], v[144:147], v[164:167], a[132:135]
v_mfma_f32_16x16x32_bf16 a[136:139], v[144:147], v[168:171], a[136:139]
ds_read_b128 v[84:87], v16 offset:41984
s_add_u32 m0, s86, 32768
v_mfma_f32_16x16x32_bf16 a[140:143], v[144:147], v[172:175], a[140:143]
v_mfma_f32_16x16x32_bf16 a[144:147], v[144:147], v[176:179], a[144:147]
s_nop 0
v_mfma_f32_16x16x32_bf16 a[148:151], v[144:147], v[180:183], a[148:151]
ds_read_b64_tr_b16 v[116:117], v22 offset:32768
v_mfma_f32_16x16x32_bf16 a[152:155], v[144:147], v[184:187], a[152:155]
v_mfma_f32_16x16x32_bf16 a[156:159], v[144:147], v[188:191], a[156:159]
ds_read_b64_tr_b16 v[118:119], v22 offset:34816
buffer_load_dwordx4 v27, s[28:31], s60 offen lds
v_mfma_f32_16x16x32_bf16 a[160:163], v[148:151], v[160:163], a[160:163]
v_mfma_f32_16x16x32_bf16 a[164:167], v[148:151], v[164:167], a[164:167]
ds_read_b128 v[88:91], v16 offset:45056
v_mfma_f32_16x16x32_bf16 a[168:171], v[148:151], v[168:171], a[168:171]
buffer_load_dwordx4 v28, s[28:31], s60 offen offset:1024 lds
v_mfma_f32_16x16x32_bf16 a[172:175], v[148:151], v[172:175], a[172:175]
ds_read_b64_tr_b16 v[120:121], v23 offset:32768
v_mfma_f32_16x16x32_bf16 a[176:179], v[148:151], v[176:179], a[176:179]
s_add_u32 s60, s60, 131072
v_mfma_f32_16x16x32_bf16 a[180:183], v[148:151], v[180:183], a[180:183]
v_mfma_f32_16x16x32_bf16 a[184:187], v[148:151], v[184:187], a[184:187]
ds_read_b64_tr_b16 v[122:123], v23 offset:34816
v_mfma_f32_16x16x32_bf16 a[188:191], v[148:151], v[188:191], a[188:191]
s_add_u32 m0, s86, 34816
v_mfma_f32_16x16x32_bf16 a[192:195], v[152:155], v[160:163], a[192:195]
ds_read_b128 v[92:95], v16 offset:46080
v_mfma_f32_16x16x32_bf16 a[196:199], v[152:155], v[164:167], a[196:199]
v_mfma_f32_16x16x32_bf16 a[200:203], v[152:155], v[168:171], a[200:203]
ds_read_b64_tr_b16 v[124:125], v24 offset:32768
s_nop 0
v_mfma_f32_16x16x32_bf16 a[204:207], v[152:155], v[172:175], a[204:207]
v_mfma_f32_16x16x32_bf16 a[208:211], v[152:155], v[176:179], a[208:211]
ds_read_b64_tr_b16 v[126:127], v24 offset:34816
buffer_load_dwordx4 v27, s[28:31], s60 offen lds
v_mfma_f32_16x16x32_bf16 a[212:215], v[152:155], v[180:183], a[212:215]
v_mfma_f32_16x16x32_bf16 a[216:219], v[152:155], v[184:187], a[216:219]
v_mfma_f32_16x16x32_bf16 a[220:223], v[152:155], v[188:191], a[220:223]
buffer_load_dwordx4 v28, s[28:31], s60 offen offset:1024 lds
v_mfma_f32_16x16x32_bf16 a[224:227], v[156:159], v[160:163], a[224:227]
v_mfma_f32_16x16x32_bf16 a[228:231], v[156:159], v[164:167], a[228:231]
v_mfma_f32_16x16x32_bf16 a[232:235], v[156:159], v[168:171], a[232:235]
s_add_u32 s60, s60, 131072
v_mfma_f32_16x16x32_bf16 a[236:239], v[156:159], v[172:175], a[236:239]
v_mfma_f32_16x16x32_bf16 a[240:243], v[156:159], v[176:179], a[240:243]
v_mfma_f32_16x16x32_bf16 a[244:247], v[156:159], v[180:183], a[244:247]
v_mfma_f32_16x16x32_bf16 a[248:251], v[156:159], v[184:187], a[248:251]
v_mfma_f32_16x16x32_bf16 a[252:255], v[156:159], v[188:191], a[252:255]
s_waitcnt lgkmcnt(0)
v_mfma_f32_16x16x32_bf16 a[0:3], v[64:67], v[96:99], a[0:3]
s_waitcnt vmcnt(24)
s_barrier
v_mfma_f32_16x16x32_bf16 a[4:7], v[64:67], v[100:103], a[4:7]
ds_read_b128 v[128:131], v10 offset:32768
v_mfma_f32_16x16x32_bf16 a[8:11], v[64:67], v[104:107], a[8:11]
s_add_u32 m0, s64, 98304
v_mfma_f32_16x16x32_bf16 a[12:15], v[64:67], v[108:111], a[12:15]
ds_read_b64_tr_b16 v[160:161], v17 offset:49152
v_mfma_f32_16x16x32_bf16 a[16:19], v[64:67], v[112:115], a[16:19]
v_mfma_f32_16x16x32_bf16 a[20:23], v[64:67], v[116:119], a[20:23]
ds_read_b64_tr_b16 v[162:163], v17 offset:51200
v_mfma_f32_16x16x32_bf16 a[24:27], v[64:67], v[120:123], a[24:27]
s_add_u32 s56, s69, 16384
v_mfma_f32_16x16x32_bf16 a[28:31], v[64:67], v[124:127], a[28:31]
ds_read_b128 v[132:135], v10 offset:33792
v_mfma_f32_16x16x32_bf16 a[32:35], v[68:71], v[96:99], a[32:35]
v_mfma_f32_16x16x32_bf16 a[36:39], v[68:71], v[100:103], a[36:39]
v_mfma_f32_16x16x32_bf16 a[40:43], v[68:71], v[104:107], a[40:43]
ds_read_b64_tr_b16 v[164:165], v18 offset:49152
v_mfma_f32_16x16x32_bf16 a[44:47], v[68:71], v[108:111], a[44:47]
buffer_load_dwordx4 v5, s[24:27], s56 offen sc1 lds
v_mfma_f32_16x16x32_bf16 a[48:51], v[68:71], v[112:115], a[48:51]
ds_read_b64_tr_b16 v[166:167], v18 offset:51200
v_mfma_f32_16x16x32_bf16 a[52:55], v[68:71], v[116:119], a[52:55]
v_mfma_f32_16x16x32_bf16 a[56:59], v[68:71], v[120:123], a[56:59]
ds_read_b128 v[136:139], v10 offset:36864
v_mfma_f32_16x16x32_bf16 a[60:63], v[68:71], v[124:127], a[60:63]
v_mfma_f32_16x16x32_bf16 a[64:67], v[72:75], v[96:99], a[64:67]
ds_read_b64_tr_b16 v[168:169], v19 offset:49152
buffer_load_dwordx4 v5, s[24:27], s56 offen offset:1024 sc1 lds
v_mfma_f32_16x16x32_bf16 a[68:71], v[72:75], v[100:103], a[68:71]
v_mfma_f32_16x16x32_bf16 a[72:75], v[72:75], v[104:107], a[72:75]
v_mfma_f32_16x16x32_bf16 a[76:79], v[72:75], v[108:111], a[76:79]
ds_read_b64_tr_b16 v[170:171], v19 offset:51200
v_mfma_f32_16x16x32_bf16 a[80:83], v[72:75], v[112:115], a[80:83]
v_mfma_f32_16x16x32_bf16 a[84:87], v[72:75], v[116:119], a[84:87]
ds_read_b128 v[140:143], v10 offset:37888
buffer_load_dwordx4 v5, s[24:27], s56 offen offset:2048 sc1 lds
v_mfma_f32_16x16x32_bf16 a[88:91], v[72:75], v[120:123], a[88:91]
v_mfma_f32_16x16x32_bf16 a[92:95], v[72:75], v[124:127], a[92:95]
ds_read_b64_tr_b16 v[172:173], v20 offset:49152
v_mfma_f32_16x16x32_bf16 a[96:99], v[76:79], v[96:99], a[96:99]
v_mfma_f32_16x16x32_bf16 a[100:103], v[76:79], v[100:103], a[100:103]
ds_read_b64_tr_b16 v[174:175], v20 offset:51200
v_mfma_f32_16x16x32_bf16 a[104:107], v[76:79], v[104:107], a[104:107]
buffer_load_dwordx4 v5, s[24:27], s56 offen offset:3072 sc1 lds
v_mfma_f32_16x16x32_bf16 a[108:111], v[76:79], v[108:111], a[108:111]
v_mfma_f32_16x16x32_bf16 a[112:115], v[76:79], v[112:115], a[112:115]
ds_read_b128 v[144:147], v10 offset:40960
v_mfma_f32_16x16x32_bf16 a[116:119], v[76:79], v[116:119], a[116:119]
v_mfma_f32_16x16x32_bf16 a[120:123], v[76:79], v[120:123], a[120:123]
ds_read_b64_tr_b16 v[176:177], v21 offset:49152
v_mfma_f32_16x16x32_bf16 a[124:127], v[76:79], v[124:127], a[124:127]
v_mfma_f32_16x16x32_bf16 a[128:131], v[80:83], v[96:99], a[128:131]
ds_read_b64_tr_b16 v[178:179], v21 offset:51200
v_mfma_f32_16x16x32_bf16 a[132:135], v[80:83], v[100:103], a[132:135]
v_mfma_f32_16x16x32_bf16 a[136:139], v[80:83], v[104:107], a[136:139]
ds_read_b128 v[148:151], v10 offset:41984
v_mfma_f32_16x16x32_bf16 a[140:143], v[80:83], v[108:111], a[140:143]
v_mfma_f32_16x16x32_bf16 a[144:147], v[80:83], v[112:115], a[144:147]
v_mfma_f32_16x16x32_bf16 a[148:151], v[80:83], v[116:119], a[148:151]
ds_read_b64_tr_b16 v[180:181], v22 offset:49152
v_mfma_f32_16x16x32_bf16 a[152:155], v[80:83], v[120:123], a[152:155]
v_mfma_f32_16x16x32_bf16 a[156:159], v[80:83], v[124:127], a[156:159]
ds_read_b64_tr_b16 v[182:183], v22 offset:51200
v_mfma_f32_16x16x32_bf16 a[160:163], v[84:87], v[96:99], a[160:163]
v_mfma_f32_16x16x32_bf16 a[164:167], v[84:87], v[100:103], a[164:167]
ds_read_b128 v[152:155], v10 offset:45056
v_mfma_f32_16x16x32_bf16 a[168:171], v[84:87], v[104:107], a[168:171]
v_mfma_f32_16x16x32_bf16 a[172:175], v[84:87], v[108:111], a[172:175]
ds_read_b64_tr_b16 v[184:185], v23 offset:49152
v_mfma_f32_16x16x32_bf16 a[176:179], v[84:87], v[112:115], a[176:179]
v_mfma_f32_16x16x32_bf16 a[180:183], v[84:87], v[116:119], a[180:183]
v_mfma_f32_16x16x32_bf16 a[184:187], v[84:87], v[120:123], a[184:187]
ds_read_b64_tr_b16 v[186:187], v23 offset:51200
v_mfma_f32_16x16x32_bf16 a[188:191], v[84:87], v[124:127], a[188:191]
v_mfma_f32_16x16x32_bf16 a[192:195], v[88:91], v[96:99], a[192:195]
ds_read_b128 v[156:159], v10 offset:46080
v_mfma_f32_16x16x32_bf16 a[196:199], v[88:91], v[100:103], a[196:199]
v_mfma_f32_16x16x32_bf16 a[200:203], v[88:91], v[104:107], a[200:203]
ds_read_b64_tr_b16 v[188:189], v24 offset:49152
v_mfma_f32_16x16x32_bf16 a[204:207], v[88:91], v[108:111], a[204:207]
v_mfma_f32_16x16x32_bf16 a[208:211], v[88:91], v[112:115], a[208:211]
ds_read_b64_tr_b16 v[190:191], v24 offset:51200
v_mfma_f32_16x16x32_bf16 a[212:215], v[88:91], v[116:119], a[212:215]
v_mfma_f32_16x16x32_bf16 a[216:219], v[88:91], v[120:123], a[216:219]
v_mfma_f32_16x16x32_bf16 a[220:223], v[88:91], v[124:127], a[220:223]
v_mfma_f32_16x16x32_bf16 a[224:227], v[92:95], v[96:99], a[224:227]
v_mfma_f32_16x16x32_bf16 a[228:231], v[92:95], v[100:103], a[228:231]
v_mfma_f32_16x16x32_bf16 a[232:235], v[92:95], v[104:107], a[232:235]
v_mfma_f32_16x16x32_bf16 a[236:239], v[92:95], v[108:111], a[236:239]
v_mfma_f32_16x16x32_bf16 a[240:243], v[92:95], v[112:115], a[240:243]
v_mfma_f32_16x16x32_bf16 a[244:247], v[92:95], v[116:119], a[244:247]
v_mfma_f32_16x16x32_bf16 a[248:251], v[92:95], v[120:123], a[248:251]
v_mfma_f32_16x16x32_bf16 a[252:255], v[92:95], v[124:127], a[252:255]
s_waitcnt lgkmcnt(0)
v_mfma_f32_16x16x32_bf16 a[0:3], v[128:131], v[160:163], a[0:3]
s_barrier
v_mfma_f32_16x16x32_bf16 a[4:7], v[128:131], v[164:167], a[4:7]
v_mfma_f32_16x16x32_bf16 a[8:11], v[128:131], v[168:171], a[8:11]
s_add_u32 m0, s64, 32768
v_mfma_f32_16x16x32_bf16 a[12:15], v[128:131], v[172:175], a[12:15]
v_mfma_f32_16x16x32_bf16 a[16:19], v[128:131], v[176:179], a[16:19]
s_add_u32 s56, s69, 20480
v_mfma_f32_16x16x32_bf16 a[20:23], v[128:131], v[180:183], a[20:23]
v_mfma_f32_16x16x32_bf16 a[24:27], v[128:131], v[184:187], a[24:27]
buffer_load_dwordx4 v5, s[24:27], s56 offen sc1 lds
v_mfma_f32_16x16x32_bf16 a[28:31], v[128:131], v[188:191], a[28:31]
v_mfma_f32_16x16x32_bf16 a[32:35], v[132:135], v[160:163], a[32:35]
v_mfma_f32_16x16x32_bf16 a[36:39], v[132:135], v[164:167], a[36:39]
buffer_load_dwordx4 v5, s[24:27], s56 offen offset:1024 sc1 lds
v_mfma_f32_16x16x32_bf16 a[40:43], v[132:135], v[168:171], a[40:43]
v_mfma_f32_16x16x32_bf16 a[44:47], v[132:135], v[172:175], a[44:47]
buffer_load_dwordx4 v5, s[24:27], s56 offen offset:2048 sc1 lds
v_mfma_f32_16x16x32_bf16 a[48:51], v[132:135], v[176:179], a[48:51]
v_mfma_f32_16x16x32_bf16 a[52:55], v[132:135], v[180:183], a[52:55]
v_mfma_f32_16x16x32_bf16 a[56:59], v[132:135], v[184:187], a[56:59]
buffer_load_dwordx4 v5, s[24:27], s56 offen offset:3072 sc1 lds
v_mfma_f32_16x16x32_bf16 a[60:63], v[132:135], v[188:191], a[60:63]
v_mfma_f32_16x16x32_bf16 a[64:67], v[136:139], v[160:163], a[64:67]
s_add_u32 m0, s64, 49152
v_mfma_f32_16x16x32_bf16 a[68:71], v[136:139], v[164:167], a[68:71]
v_mfma_f32_16x16x32_bf16 a[72:75], v[136:139], v[168:171], a[72:75]
s_add_u32 s56, s69, 24576
v_mfma_f32_16x16x32_bf16 a[76:79], v[136:139], v[172:175], a[76:79]
v_mfma_f32_16x16x32_bf16 a[80:83], v[136:139], v[176:179], a[80:83]
v_mfma_f32_16x16x32_bf16 a[84:87], v[136:139], v[180:183], a[84:87]
buffer_load_dwordx4 v5, s[24:27], s56 offen sc1 lds
v_mfma_f32_16x16x32_bf16 a[88:91], v[136:139], v[184:187], a[88:91]
v_mfma_f32_16x16x32_bf16 a[92:95], v[136:139], v[188:191], a[92:95]
buffer_load_dwordx4 v5, s[24:27], s56 offen offset:1024 sc1 lds
v_mfma_f32_16x16x32_bf16 a[96:99], v[140:143], v[160:163], a[96:99]
v_mfma_f32_16x16x32_bf16 a[100:103], v[140:143], v[164:167], a[100:103]
v_mfma_f32_16x16x32_bf16 a[104:107], v[140:143], v[168:171], a[104:107]
buffer_load_dwordx4 v5, s[24:27], s56 offen offset:2048 sc1 lds
v_mfma_f32_16x16x32_bf16 a[108:111], v[140:143], v[172:175], a[108:111]
v_mfma_f32_16x16x32_bf16 a[112:115], v[140:143], v[176:179], a[112:115]
buffer_load_dwordx4 v5, s[24:27], s56 offen offset:3072 sc1 lds
v_mfma_f32_16x16x32_bf16 a[116:119], v[140:143], v[180:183], a[116:119]
v_mfma_f32_16x16x32_bf16 a[120:123], v[140:143], v[184:187], a[120:123]
v_mfma_f32_16x16x32_bf16 a[124:127], v[140:143], v[188:191], a[124:127]
v_mfma_f32_16x16x32_bf16 a[128:131], v[144:147], v[160:163], a[128:131]
v_mfma_f32_16x16x32_bf16 a[132:135], v[144:147], v[164:167], a[132:135]
v_mfma_f32_16x16x32_bf16 a[136:139], v[144:147], v[168:171], a[136:139]
s_add_u32 m0, s86, 0
v_mfma_f32_16x16x32_bf16 a[140:143], v[144:147], v[172:175], a[140:143]
v_mfma_f32_16x16x32_bf16 a[144:147], v[144:147], v[176:179], a[144:147]
s_nop 0
v_mfma_f32_16x16x32_bf16 a[148:151], v[144:147], v[180:183], a[148:151]
v_mfma_f32_16x16x32_bf16 a[152:155], v[144:147], v[184:187], a[152:155]
v_mfma_f32_16x16x32_bf16 a[156:159], v[144:147], v[188:191], a[156:159]
buffer_load_dwordx4 v27, s[28:31], s60 offen lds
v_mfma_f32_16x16x32_bf16 a[160:163], v[148:151], v[160:163], a[160:163]
v_mfma_f32_16x16x32_bf16 a[164:167], v[148:151], v[164:167], a[164:167]
v_mfma_f32_16x16x32_bf16 a[168:171], v[148:151], v[168:171], a[168:171]
buffer_load_dwordx4 v28, s[28:31], s60 offen offset:1024 lds
v_mfma_f32_16x16x32_bf16 a[172:175], v[148:151], v[172:175], a[172:175]
v_mfma_f32_16x16x32_bf16 a[176:179], v[148:151], v[176:179], a[176:179]
s_add_u32 s60, s60, 131072
v_mfma_f32_16x16x32_bf16 a[180:183], v[148:151], v[180:183], a[180:183]
v_mfma_f32_16x16x32_bf16 a[184:187], v[148:151], v[184:187], a[184:187]
v_mfma_f32_16x16x32_bf16 a[188:191], v[148:151], v[188:191], a[188:191]
s_add_u32 m0, s86, 2048
v_mfma_f32_16x16x32_bf16 a[192:195], v[152:155], v[160:163], a[192:195]
v_mfma_f32_16x16x32_bf16 a[196:199], v[152:155], v[164:167], a[196:199]
v_mfma_f32_16x16x32_bf16 a[200:203], v[152:155], v[168:171], a[200:203]
s_nop 0
v_mfma_f32_16x16x32_bf16 a[204:207], v[152:155], v[172:175], a[204:207]
v_mfma_f32_16x16x32_bf16 a[208:211], v[152:155], v[176:179], a[208:211]
buffer_load_dwordx4 v27, s[28:31], s60 offen lds
v_mfma_f32_16x16x32_bf16 a[212:215], v[152:155], v[180:183], a[212:215]
v_mfma_f32_16x16x32_bf16 a[216:219], v[152:155], v[184:187], a[216:219]
v_mfma_f32_16x16x32_bf16 a[220:223], v[152:155], v[188:191], a[220:223]
buffer_load_dwordx4 v28, s[28:31], s60 offen offset:1024 lds
v_mfma_f32_16x16x32_bf16 a[224:227], v[156:159], v[160:163], a[224:227]
v_mfma_f32_16x16x32_bf16 a[228:231], v[156:159], v[164:167], a[228:231]
v_mfma_f32_16x16x32_bf16 a[232:235], v[156:159], v[168:171], a[232:235]
s_add_u32 s60, s60, 131072
v_mfma_f32_16x16x32_bf16 a[236:239], v[156:159], v[172:175], a[236:239]
v_mfma_f32_16x16x32_bf16 a[240:243], v[156:159], v[176:179], a[240:243]
v_mfma_f32_16x16x32_bf16 a[244:247], v[156:159], v[180:183], a[244:247]
v_mfma_f32_16x16x32_bf16 a[248:251], v[156:159], v[184:187], a[248:251]
v_mfma_f32_16x16x32_bf16 a[252:255], v[156:159], v[188:191], a[252:255]
s_lshl_b32 s70, s4, 21
s_lshl_b32 s71, s6, 18
s_add_u32 s70, s70, s71
s_lshl_b32 s71, s67, 17
s_add_u32 s70, s70, s71
s_lshl_b32 s71, s68, 13
s_add_u32 s70, s70, s71
s_add_u32 s70, s70, 16384
s_add_u32 s72, s70, 0
s_nop 0
s_add_u32 s73, s70, 4096
s_add_u32 s74, s70, 32768
s_add_u32 s75, s70, 36864
s_add_u32 s76, s70, 65536
s_add_u32 s77, s70, 69632
s_add_u32 s78, s70, 98304
s_add_u32 s79, s70, 102400
v_add_u32 v7, 0x10000, v5
v_add_u32 v8, 0x20000, v5
s_waitcnt vmcnt(20)
s_barrier
ds_read_b128 v[64:67], v7
ds_read_b128 v[68:71], v7 offset:4096
ds_read_b128 v[72:75], v7 offset:8192
ds_read_b128 v[76:79], v7 offset:12288
ds_read_b64_tr_b16 v[224:225], v3 offset:16384
ds_read_b64_tr_b16 v[226:227], v3 offset:17408
ds_read_b64_tr_b16 v[228:229], v4 offset:16384
ds_read_b64_tr_b16 v[230:231], v4 offset:17408
s_waitcnt lgkmcnt(0)
v_mfma_f32_32x32x16_bf16 v[96:111], v[224:227], v[64:67], 0
s_waitcnt vmcnt(32)
ds_read_b64_tr_b16 v[232:233], v3 offset:18432
v_mfma_f32_32x32x16_bf16 v[160:175], v[228:231], v[64:67], 0
ds_read_b64_tr_b16 v[234:235], v3 offset:19456
ds_read_b64_tr_b16 v[236:237], v4 offset:18432
v_mfma_f32_32x32x16_bf16 v[112:127], v[224:227], v[68:71], 0
ds_read_b64_tr_b16 v[238:239], v4 offset:19456
ds_read_b128 v[80:83], v7 offset:1024
v_mfma_f32_32x32x16_bf16 v[176:191], v[228:231], v[68:71], 0
ds_read_b128 v[84:87], v7 offset:5120
ds_read_b128 v[88:91], v7 offset:9216
v_mfma_f32_32x32x16_bf16 v[128:143], v[224:227], v[72:75], 0
ds_read_b128 v[92:95], v7 offset:13312
s_add_u32 m0, s86, 16384
v_mfma_f32_32x32x16_bf16 v[192:207], v[228:231], v[72:75], 0
s_nop 0
buffer_load_dwordx4 v27, s[28:31], s60 offen lds
v_mfma_f32_32x32x16_bf16 v[144:159], v[224:227], v[76:79], 0
buffer_load_dwordx4 v28, s[28:31], s60 offen offset:1024 lds
s_add_u32 s60, s60, 131072
v_mfma_f32_32x32x16_bf16 v[208:223], v[228:231], v[76:79], 0
s_waitcnt lgkmcnt(0)
v_mfma_f32_32x32x16_bf16 v[96:111], v[232:235], v[80:83], v[96:111]
s_waitcnt vmcnt(20)
ds_read_b64_tr_b16 v[224:225], v3 offset:32768
v_mfma_f32_32x32x16_bf16 v[160:175], v[236:239], v[80:83], v[160:175]
ds_read_b64_tr_b16 v[226:227], v3 offset:33792
ds_read_b64_tr_b16 v[228:229], v4 offset:32768
v_mfma_f32_32x32x16_bf16 v[112:127], v[232:235], v[84:87], v[112:127]
ds_read_b64_tr_b16 v[230:231], v4 offset:33792
ds_read_b128 v[64:67], v7 offset:2048
v_mfma_f32_32x32x16_bf16 v[176:191], v[236:239], v[84:87], v[176:191]
ds_read_b128 v[68:71], v7 offset:6144
ds_read_b128 v[72:75], v7 offset:10240
v_mfma_f32_32x32x16_bf16 v[128:143], v[232:235], v[88:91], v[128:143]
ds_read_b128 v[76:79], v7 offset:14336
s_add_u32 m0, s86, 18432
v_mfma_f32_32x32x16_bf16 v[192:207], v[236:239], v[88:91], v[192:207]
s_nop 0
buffer_load_dwordx4 v27, s[28:31], s60 offen lds
v_mfma_f32_32x32x16_bf16 v[144:159], v[232:235], v[92:95], v[144:159]
buffer_load_dwordx4 v28, s[28:31], s60 offen offset:1024 lds
s_add_u32 s60, s60, 131072
v_mfma_f32_32x32x16_bf16 v[208:223], v[236:239], v[92:95], v[208:223]
s_waitcnt lgkmcnt(0)
v_mfma_f32_32x32x16_bf16 v[96:111], v[224:227], v[64:67], v[96:111]
s_waitcnt vmcnt(20)
ds_read_b64_tr_b16 v[232:233], v3 offset:34816
v_mfma_f32_32x32x16_bf16 v[160:175], v[228:231], v[64:67], v[160:175]
ds_read_b64_tr_b16 v[234:235], v3 offset:35840
ds_read_b64_tr_b16 v[236:237], v4 offset:34816
v_mfma_f32_32x32x16_bf16 v[112:127], v[224:227], v[68:71], v[112:127]
ds_read_b64_tr_b16 v[238:239], v4 offset:35840
ds_read_b128 v[80:83], v7 offset:3072
v_mfma_f32_32x32x16_bf16 v[176:191], v[228:231], v[68:71], v[176:191]
ds_read_b128 v[84:87], v7 offset:7168
ds_read_b128 v[88:91], v7 offset:11264
v_mfma_f32_32x32x16_bf16 v[128:143], v[224:227], v[72:75], v[128:143]
ds_read_b128 v[92:95], v7 offset:15360
s_add_u32 m0, s86, 32768
v_mfma_f32_32x32x16_bf16 v[192:207], v[228:231], v[72:75], v[192:207]
s_nop 0
buffer_load_dwordx4 v27, s[28:31], s60 offen lds
v_mfma_f32_32x32x16_bf16 v[144:159], v[224:227], v[76:79], v[144:159]
buffer_load_dwordx4 v28, s[28:31], s60 offen offset:1024 lds
s_add_u32 s60, s60, 131072
v_mfma_f32_32x32x16_bf16 v[208:223], v[228:231], v[76:79], v[208:223]
s_waitcnt lgkmcnt(0)
v_mfma_f32_32x32x16_bf16 v[96:111], v[232:235], v[80:83], v[96:111]
s_waitcnt vmcnt(8)
ds_read_b64_tr_b16 v[224:225], v3
v_mfma_f32_32x32x16_bf16 v[160:175], v[236:239], v[80:83], v[160:175]
ds_read_b64_tr_b16 v[226:227], v3 offset:1024
ds_read_b64_tr_b16 v[228:229], v4
v_mfma_f32_32x32x16_bf16 v[112:127], v[232:235], v[84:87], v[112:127]
ds_read_b64_tr_b16 v[230:231], v4 offset:1024
ds_read_b128 v[64:67], v7 offset:16384
v_mfma_f32_32x32x16_bf16 v[176:191], v[236:239], v[84:87], v[176:191]
ds_read_b128 v[68:71], v7 offset:20480
ds_read_b128 v[72:75], v7 offset:24576
v_mfma_f32_32x32x16_bf16 v[128:143], v[232:235], v[88:91], v[128:143]
ds_read_b128 v[76:79], v7 offset:28672
s_add_u32 m0, s86, 34816
v_mfma_f32_32x32x16_bf16 v[192:207], v[236:239], v[88:91], v[192:207]
s_nop 0
buffer_load_dwordx4 v27, s[28:31], s60 offen lds
v_mfma_f32_32x32x16_bf16 v[144:159], v[232:235], v[92:95], v[144:159]
buffer_load_dwordx4 v28, s[28:31], s60 offen offset:1024 lds
s_add_u32 s60, s60, 131072
v_mfma_f32_32x32x16_bf16 v[208:223], v[236:239], v[92:95], v[208:223]
s_waitcnt lgkmcnt(0)
v_mfma_f32_32x32x16_bf16 v[96:111], v[224:227], v[64:67], v[96:111]
s_waitcnt vmcnt(8)
ds_read_b64_tr_b16 v[232:233], v3 offset:2048
v_mfma_f32_32x32x16_bf16 v[160:175], v[228:231], v[64:67], v[160:175]
ds_read_b64_tr_b16 v[234:235], v3 offset:3072
ds_read_b64_tr_b16 v[236:237], v4 offset:2048
v_mfma_f32_32x32x16_bf16 v[112:127], v[224:227], v[68:71], v[112:127]
ds_read_b64_tr_b16 v[238:239], v4 offset:3072
ds_read_b128 v[80:83], v7 offset:17408
v_mfma_f32_32x32x16_bf16 v[176:191], v[228:231], v[68:71], v[176:191]
ds_read_b128 v[84:87], v7 offset:21504
ds_read_b128 v[88:91], v7 offset:25600
v_mfma_f32_32x32x16_bf16 v[128:143], v[224:227], v[72:75], v[128:143]
ds_read_b128 v[92:95], v7 offset:29696
s_add_u32 m0, s86, 0
v_mfma_f32_32x32x16_bf16 v[192:207], v[228:231], v[72:75], v[192:207]
s_nop 0
buffer_load_dwordx4 v27, s[28:31], s60 offen lds
v_mfma_f32_32x32x16_bf16 v[144:159], v[224:227], v[76:79], v[144:159]
buffer_load_dwordx4 v28, s[28:31], s60 offen offset:1024 lds
s_add_u32 s60, s60, 131072
v_mfma_f32_32x32x16_bf16 v[208:223], v[228:231], v[76:79], v[208:223]
s_waitcnt lgkmcnt(0)
v_mfma_f32_32x32x16_bf16 v[96:111], v[232:235], v[80:83], v[96:111]
s_waitcnt vmcnt(8)
ds_read_b64_tr_b16 v[224:225], v3 offset:16384
v_mfma_f32_32x32x16_bf16 v[160:175], v[236:239], v[80:83], v[160:175]
ds_read_b64_tr_b16 v[226:227], v3 offset:17408
ds_read_b64_tr_b16 v[228:229], v4 offset:16384
v_mfma_f32_32x32x16_bf16 v[112:127], v[232:235], v[84:87], v[112:127]
ds_read_b64_tr_b16 v[230:231], v4 offset:17408
ds_read_b128 v[64:67], v7 offset:18432
v_mfma_f32_32x32x16_bf16 v[176:191], v[236:239], v[84:87], v[176:191]
ds_read_b128 v[68:71], v7 offset:22528
ds_read_b128 v[72:75], v7 offset:26624
v_mfma_f32_32x32x16_bf16 v[128:143], v[232:235], v[88:91], v[128:143]
ds_read_b128 v[76:79], v7 offset:30720
s_add_u32 m0, s86, 2048
v_mfma_f32_32x32x16_bf16 v[192:207], v[236:239], v[88:91], v[192:207]
s_nop 0
buffer_load_dwordx4 v27, s[28:31], s60 offen lds
v_mfma_f32_32x32x16_bf16 v[144:159], v[232:235], v[92:95], v[144:159]
buffer_load_dwordx4 v28, s[28:31], s60 offen offset:1024 lds
s_add_u32 s60, s60, 131072
v_mfma_f32_32x32x16_bf16 v[208:223], v[236:239], v[92:95], v[208:223]
s_waitcnt lgkmcnt(0)
v_mfma_f32_32x32x16_bf16 v[96:111], v[224:227], v[64:67], v[96:111]
s_waitcnt vmcnt(8)
ds_read_b64_tr_b16 v[232:233], v3 offset:18432
v_mfma_f32_32x32x16_bf16 v[160:175], v[228:231], v[64:67], v[160:175]
ds_read_b64_tr_b16 v[234:235], v3 offset:19456
ds_read_b64_tr_b16 v[236:237], v4 offset:18432
v_mfma_f32_32x32x16_bf16 v[112:127], v[224:227], v[68:71], v[112:127]
ds_read_b64_tr_b16 v[238:239], v4 offset:19456
ds_read_b128 v[80:83], v7 offset:19456
v_mfma_f32_32x32x16_bf16 v[176:191], v[228:231], v[68:71], v[176:191]
ds_read_b128 v[84:87], v7 offset:23552
ds_read_b128 v[88:91], v7 offset:27648
v_mfma_f32_32x32x16_bf16 v[128:143], v[224:227], v[72:75], v[128:143]
ds_read_b128 v[92:95], v7 offset:31744
s_add_u32 m0, s86, 16384
v_mfma_f32_32x32x16_bf16 v[192:207], v[228:231], v[72:75], v[192:207]
s_nop 0
buffer_load_dwordx4 v27, s[28:31], s60 offen lds
v_mfma_f32_32x32x16_bf16 v[144:159], v[224:227], v[76:79], v[144:159]
buffer_load_dwordx4 v28, s[28:31], s60 offen offset:1024 lds
s_add_u32 s60, s60, 131072
v_mfma_f32_32x32x16_bf16 v[208:223], v[228:231], v[76:79], v[208:223]
s_waitcnt lgkmcnt(0)
v_mfma_f32_32x32x16_bf16 v[96:111], v[232:235], v[80:83], v[96:111]
s_waitcnt vmcnt(8)
ds_read_b64_tr_b16 v[224:225], v3 offset:32768
v_mfma_f32_32x32x16_bf16 v[160:175], v[236:239], v[80:83], v[160:175]
ds_read_b64_tr_b16 v[226:227], v3 offset:33792
ds_read_b64_tr_b16 v[228:229], v4 offset:32768
v_mfma_f32_32x32x16_bf16 v[112:127], v[232:235], v[84:87], v[112:127]
ds_read_b64_tr_b16 v[230:231], v4 offset:33792
ds_read_b128 v[64:67], v5
v_mfma_f32_32x32x16_bf16 v[176:191], v[236:239], v[84:87], v[176:191]
ds_read_b128 v[68:71], v5 offset:4096
ds_read_b128 v[72:75], v5 offset:8192
v_mfma_f32_32x32x16_bf16 v[128:143], v[232:235], v[88:91], v[128:143]
ds_read_b128 v[76:79], v5 offset:12288
s_add_u32 m0, s86, 18432
v_mfma_f32_32x32x16_bf16 v[192:207], v[236:239], v[88:91], v[192:207]
s_nop 0
buffer_load_dwordx4 v27, s[28:31], s60 offen lds
v_mfma_f32_32x32x16_bf16 v[144:159], v[232:235], v[92:95], v[144:159]
buffer_load_dwordx4 v28, s[28:31], s60 offen offset:1024 lds
s_add_u32 s60, s60, 131072
v_mfma_f32_32x32x16_bf16 v[208:223], v[236:239], v[92:95], v[208:223]
s_waitcnt lgkmcnt(0)
v_mfma_f32_32x32x16_bf16 v[96:111], v[224:227], v[64:67], v[96:111]
s_waitcnt vmcnt(8)
ds_read_b64_tr_b16 v[232:233], v3 offset:34816
v_mfma_f32_32x32x16_bf16 v[160:175], v[228:231], v[64:67], v[160:175]
ds_read_b64_tr_b16 v[234:235], v3 offset:35840
ds_read_b64_tr_b16 v[236:237], v4 offset:34816
v_mfma_f32_32x32x16_bf16 v[112:127], v[224:227], v[68:71], v[112:127]
ds_read_b64_tr_b16 v[238:239], v4 offset:35840
ds_read_b128 v[80:83], v5 offset:1024
v_mfma_f32_32x32x16_bf16 v[176:191], v[228:231], v[68:71], v[176:191]
ds_read_b128 v[84:87], v5 offset:5120
ds_read_b128 v[88:91], v5 offset:9216
v_mfma_f32_32x32x16_bf16 v[128:143], v[224:227], v[72:75], v[128:143]
ds_read_b128 v[92:95], v5 offset:13312
s_add_u32 m0, s86, 32768
v_mfma_f32_32x32x16_bf16 v[192:207], v[228:231], v[72:75], v[192:207]
s_nop 0
buffer_load_dwordx4 v27, s[28:31], s60 offen lds
v_mfma_f32_32x32x16_bf16 v[144:159], v[224:227], v[76:79], v[144:159]
buffer_load_dwordx4 v28, s[28:31], s60 offen offset:1024 lds
s_add_u32 s60, s60, 131072
v_mfma_f32_32x32x16_bf16 v[208:223], v[228:231], v[76:79], v[208:223]
s_waitcnt lgkmcnt(0)
v_mfma_f32_32x32x16_bf16 v[96:111], v[232:235], v[80:83], v[96:111]
s_waitcnt vmcnt(8)
ds_read_b64_tr_b16 v[224:225], v3
v_mfma_f32_32x32x16_bf16 v[160:175], v[236:239], v[80:83], v[160:175]
ds_read_b64_tr_b16 v[226:227], v3 offset:1024
ds_read_b64_tr_b16 v[228:229], v4
v_mfma_f32_32x32x16_bf16 v[112:127], v[232:235], v[84:87], v[112:127]
ds_read_b64_tr_b16 v[230:231], v4 offset:1024
ds_read_b128 v[64:67], v5 offset:2048
v_mfma_f32_32x32x16_bf16 v[176:191], v[236:239], v[84:87], v[176:191]
ds_read_b128 v[68:71], v5 offset:6144
ds_read_b128 v[72:75], v5 offset:10240
v_mfma_f32_32x32x16_bf16 v[128:143], v[232:235], v[88:91], v[128:143]
ds_read_b128 v[76:79], v5 offset:14336
s_add_u32 m0, s86, 34816
v_mfma_f32_32x32x16_bf16 v[192:207], v[236:239], v[88:91], v[192:207]
s_nop 0
buffer_load_dwordx4 v27, s[28:31], s60 offen lds
v_mfma_f32_32x32x16_bf16 v[144:159], v[232:235], v[92:95], v[144:159]
buffer_load_dwordx4 v28, s[28:31], s60 offen offset:1024 lds
s_add_u32 s60, s60, 131072
v_mfma_f32_32x32x16_bf16 v[208:223], v[236:239], v[92:95], v[208:223]
s_waitcnt lgkmcnt(0)
v_mfma_f32_32x32x16_bf16 v[96:111], v[224:227], v[64:67], v[96:111]
s_waitcnt vmcnt(8)
s_nop 0
ds_read_b64_tr_b16 v[232:233], v3 offset:2048
v_accvgpr_read_b32 v32, a0
v_accvgpr_read_b32 v33, a1
v_accvgpr_read_b32 v34, a2
v_accvgpr_read_b32 v35, a3
v_mfma_f32_32x32x16_bf16 v[160:175], v[228:231], v[64:67], v[160:175]
ds_read_b64_tr_b16 v[234:235], v3 offset:3072
ds_read_b64_tr_b16 v[236:237], v4 offset:2048
v_accvgpr_read_b32 v36, a32
v_accvgpr_read_b32 v37, a33
v_accvgpr_read_b32 v38, a34
v_accvgpr_read_b32 v39, a35
v_mfma_f32_32x32x16_bf16 v[112:127], v[224:227], v[68:71], v[112:127]
ds_read_b64_tr_b16 v[238:239], v4 offset:3072
ds_read_b128 v[80:83], v5 offset:3072
v_cvt_pk_bf16_f32 v40, v32, v33
v_cvt_pk_bf16_f32 v41, v34, v35
v_cvt_pk_bf16_f32 v42, v36, v37
v_cvt_pk_bf16_f32 v43, v38, v39
v_mfma_f32_32x32x16_bf16 v[176:191], v[228:231], v[68:71], v[176:191]
ds_read_b128 v[84:87], v5 offset:7168
ds_read_b128 v[88:91], v5 offset:11264
buffer_store_dwordx4 v[40:43], v6, s[16:19], s72 offen sc1
v_accvgpr_read_b32 v48, a64
v_accvgpr_read_b32 v49, a65
v_accvgpr_read_b32 v50, a66
v_mfma_f32_32x32x16_bf16 v[128:143], v[224:227], v[72:75], v[128:143]
ds_read_b128 v[92:95], v5 offset:15360
s_add_u32 m0, s86, 0
v_accvgpr_read_b32 v51, a67
v_accvgpr_read_b32 v52, a96
v_accvgpr_read_b32 v53, a97
v_accvgpr_read_b32 v54, a98
v_mfma_f32_32x32x16_bf16 v[192:207], v[228:231], v[72:75], v[192:207]
s_nop 0
buffer_load_dwordx4 v27, s[28:31], s60 offen lds
v_accvgpr_read_b32 v55, a99
v_cvt_pk_bf16_f32 v56, v48, v49
v_cvt_pk_bf16_f32 v57, v50, v51
v_cvt_pk_bf16_f32 v58, v52, v53
v_mfma_f32_32x32x16_bf16 v[144:159], v[224:227], v[76:79], v[144:159]
buffer_load_dwordx4 v28, s[28:31], s60 offen offset:1024 lds
s_add_u32 s60, s60, 131072
v_cvt_pk_bf16_f32 v59, v54, v55
buffer_store_dwordx4 v[56:59], v6, s[16:19], s74 offen sc1
v_accvgpr_read_b32 v32, a128
v_accvgpr_read_b32 v33, a129
v_mfma_f32_32x32x16_bf16 v[208:223], v[228:231], v[76:79], v[208:223]
v_accvgpr_read_b32 v34, a130
v_accvgpr_read_b32 v35, a131
v_accvgpr_read_b32 v36, a160
v_accvgpr_read_b32 v37, a161
v_accvgpr_read_b32 v38, a162
v_accvgpr_read_b32 v39, a163
s_waitcnt lgkmcnt(0)
v_mfma_f32_32x32x16_bf16 v[96:111], v[232:235], v[80:83], v[96:111]
s_waitcnt vmcnt(10)
ds_read_b64_tr_b16 v[224:225], v3 offset:16384
v_cvt_pk_bf16_f32 v40, v32, v33
v_cvt_pk_bf16_f32 v41, v34, v35
v_cvt_pk_bf16_f32 v42, v36, v37
v_cvt_pk_bf16_f32 v43, v38, v39
v_mfma_f32_32x32x16_bf16 v[160:175], v[236:239], v[80:83], v[160:175]
ds_read_b64_tr_b16 v[226:227], v3 offset:17408
ds_read_b64_tr_b16 v[228:229], v4 offset:16384
buffer_store_dwordx4 v[40:43], v6, s[16:19], s76 offen sc1
v_accvgpr_read_b32 v48, a192
v_accvgpr_read_b32 v49, a193
v_accvgpr_read_b32 v50, a194
v_mfma_f32_32x32x16_bf16 v[112:127], v[232:235], v[84:87], v[112:127]
ds_read_b64_tr_b16 v[230:231], v4 offset:17408
ds_read_b128 v[64:67], v5 offset:16384
v_accvgpr_read_b32 v51, a195
v_accvgpr_read_b32 v52, a224
v_accvgpr_read_b32 v53, a225
v_accvgpr_read_b32 v54, a226
v_mfma_f32_32x32x16_bf16 v[176:191], v[236:239], v[84:87], v[176:191]
ds_read_b128 v[68:71], v5 offset:20480
ds_read_b128 v[72:75], v5 offset:24576
v_accvgpr_read_b32 v55, a227
v_cvt_pk_bf16_f32 v56, v48, v49
v_cvt_pk_bf16_f32 v57, v50, v51
v_cvt_pk_bf16_f32 v58, v52, v53
v_mfma_f32_32x32x16_bf16 v[128:143], v[232:235], v[88:91], v[128:143]
ds_read_b128 v[76:79], v5 offset:28672
s_add_u32 m0, s86, 2048
v_cvt_pk_bf16_f32 v59, v54, v55
buffer_store_dwordx4 v[56:59], v6, s[16:19], s78 offen sc1
v_accvgpr_read_b32 v32, a4
v_accvgpr_read_b32 v33, a5
v_mfma_f32_32x32x16_bf16 v[192:207], v[236:239], v[88:91], v[192:207]
s_nop 0
s_nop 0
buffer_load_dwordx4 v27, s[28:31], s60 offen lds
v_accvgpr_read_b32 v34, a6
v_accvgpr_read_b32 v35, a7
v_accvgpr_read_b32 v36, a36
v_accvgpr_read_b32 v37, a37
v_mfma_f32_32x32x16_bf16 v[144:159], v[232:235], v[92:95], v[144:159]
buffer_load_dwordx4 v28, s[28:31], s60 offen offset:1024 lds
s_add_u32 s60, s60, 131072
v_accvgpr_read_b32 v38, a38
v_accvgpr_read_b32 v39, a39
v_cvt_pk_bf16_f32 v40, v32, v33
v_cvt_pk_bf16_f32 v41, v34, v35
v_mfma_f32_32x32x16_bf16 v[208:223], v[236:239], v[92:95], v[208:223]
v_cvt_pk_bf16_f32 v42, v36, v37
v_cvt_pk_bf16_f32 v43, v38, v39
buffer_store_dwordx4 v[40:43], v6, s[16:19], s72 offen offset:128 sc1
v_accvgpr_read_b32 v48, a68
v_accvgpr_read_b32 v49, a69
v_accvgpr_read_b32 v50, a70
s_waitcnt lgkmcnt(0)
v_mfma_f32_32x32x16_bf16 v[96:111], v[224:227], v[64:67], v[96:111]
s_waitcnt vmcnt(13)
ds_read_b64_tr_b16 v[232:233], v3 offset:18432
v_accvgpr_read_b32 v51, a71
v_accvgpr_read_b32 v52, a100
v_accvgpr_read_b32 v53, a101
v_accvgpr_read_b32 v54, a102
v_mfma_f32_32x32x16_bf16 v[160:175], v[228:231], v[64:67], v[160:175]
ds_read_b64_tr_b16 v[234:235], v3 offset:19456
ds_read_b64_tr_b16 v[236:237], v4 offset:18432
v_accvgpr_read_b32 v55, a103
v_cvt_pk_bf16_f32 v56, v48, v49
v_cvt_pk_bf16_f32 v57, v50, v51
v_cvt_pk_bf16_f32 v58, v52, v53
v_mfma_f32_32x32x16_bf16 v[112:127], v[224:227], v[68:71], v[112:127]
ds_read_b64_tr_b16 v[238:239], v4 offset:19456
ds_read_b128 v[80:83], v5 offset:17408
v_cvt_pk_bf16_f32 v59, v54, v55
buffer_store_dwordx4 v[56:59], v6, s[16:19], s74 offen offset:128 sc1
v_accvgpr_read_b32 v32, a132
v_accvgpr_read_b32 v33, a133
v_mfma_f32_32x32x16_bf16 v[176:191], v[228:231], v[68:71], v[176:191]
ds_read_b128 v[84:87], v5 offset:21504
ds_read_b128 v[88:91], v5 offset:25600
v_accvgpr_read_b32 v34, a134
v_accvgpr_read_b32 v35, a135
v_accvgpr_read_b32 v36, a164
v_accvgpr_read_b32 v37, a165
v_mfma_f32_32x32x16_bf16 v[128:143], v[224:227], v[72:75], v[128:143]
ds_read_b128 v[92:95], v5 offset:29696
s_add_u32 m0, s86, 16384
v_accvgpr_read_b32 v38, a166
v_accvgpr_read_b32 v39, a167
v_cvt_pk_bf16_f32 v40, v32, v33
v_cvt_pk_bf16_f32 v41, v34, v35
v_mfma_f32_32x32x16_bf16 v[192:207], v[228:231], v[72:75], v[192:207]
s_nop 0
s_nop 0
buffer_load_dwordx4 v27, s[28:31], s60 offen lds
v_cvt_pk_bf16_f32 v42, v36, v37
v_cvt_pk_bf16_f32 v43, v38, v39
buffer_store_dwordx4 v[40:43], v6, s[16:19], s76 offen offset:128 sc1
v_accvgpr_read_b32 v48, a196
v_mfma_f32_32x32x16_bf16 v[144:159], v[224:227], v[76:79], v[144:159]
buffer_load_dwordx4 v28, s[28:31], s60 offen offset:1024 lds
s_add_u32 s60, s60, 131072
v_accvgpr_read_b32 v49, a197
v_accvgpr_read_b32 v50, a198
v_accvgpr_read_b32 v51, a199
v_accvgpr_read_b32 v52, a228
v_mfma_f32_32x32x16_bf16 v[208:223], v[228:231], v[76:79], v[208:223]
v_accvgpr_read_b32 v53, a229
v_accvgpr_read_b32 v54, a230
v_accvgpr_read_b32 v55, a231
v_cvt_pk_bf16_f32 v56, v48, v49
v_cvt_pk_bf16_f32 v57, v50, v51
v_cvt_pk_bf16_f32 v58, v52, v53
s_waitcnt lgkmcnt(0)
v_mfma_f32_32x32x16_bf16 v[96:111], v[232:235], v[80:83], v[96:111]
s_waitcnt vmcnt(15)
ds_read_b64_tr_b16 v[224:225], v3 offset:32768
v_cvt_pk_bf16_f32 v59, v54, v55
buffer_store_dwordx4 v[56:59], v6, s[16:19], s78 offen offset:128 sc1
v_accvgpr_read_b32 v32, a8
v_accvgpr_read_b32 v33, a9
v_mfma_f32_32x32x16_bf16 v[160:175], v[236:239], v[80:83], v[160:175]
ds_read_b64_tr_b16 v[226:227], v3 offset:33792
ds_read_b64_tr_b16 v[228:229], v4 offset:32768
v_accvgpr_read_b32 v34, a10
v_accvgpr_read_b32 v35, a11
v_accvgpr_read_b32 v36, a40
v_accvgpr_read_b32 v37, a41
v_mfma_f32_32x32x16_bf16 v[112:127], v[232:235], v[84:87], v[112:127]
ds_read_b64_tr_b16 v[230:231], v4 offset:33792
ds_read_b128 v[64:67], v5 offset:18432
v_accvgpr_read_b32 v38, a42
v_accvgpr_read_b32 v39, a43
v_cvt_pk_bf16_f32 v40, v32, v33
v_cvt_pk_bf16_f32 v41, v34, v35
v_mfma_f32_32x32x16_bf16 v[176:191], v[236:239], v[84:87], v[176:191]
ds_read_b128 v[68:71], v5 offset:22528
ds_read_b128 v[72:75], v5 offset:26624
v_cvt_pk_bf16_f32 v42, v36, v37
v_cvt_pk_bf16_f32 v43, v38, v39
buffer_store_dwordx4 v[40:43], v6, s[16:19], s72 offen offset:2048 sc1
v_accvgpr_read_b32 v48, a72
v_mfma_f32_32x32x16_bf16 v[128:143], v[232:235], v[88:91], v[128:143]
ds_read_b128 v[76:79], v5 offset:30720
s_add_u32 m0, s86, 18432
v_accvgpr_read_b32 v49, a73
v_accvgpr_read_b32 v50, a74
v_accvgpr_read_b32 v51, a75
v_accvgpr_read_b32 v52, a104
v_mfma_f32_32x32x16_bf16 v[192:207], v[236:239], v[88:91], v[192:207]
s_nop 0
s_nop 0
buffer_load_dwordx4 v27, s[28:31], s60 offen lds
v_accvgpr_read_b32 v53, a105
v_accvgpr_read_b32 v54, a106
v_accvgpr_read_b32 v55, a107
v_cvt_pk_bf16_f32 v56, v48, v49
v_mfma_f32_32x32x16_bf16 v[144:159], v[232:235], v[92:95], v[144:159]
buffer_load_dwordx4 v28, s[28:31], s60 offen offset:1024 lds
s_add_u32 s60, s60, 131072
v_cvt_pk_bf16_f32 v57, v50, v51
v_cvt_pk_bf16_f32 v58, v52, v53
v_cvt_pk_bf16_f32 v59, v54, v55
buffer_store_dwordx4 v[56:59], v6, s[16:19], s74 offen offset:2048 sc1
v_mfma_f32_32x32x16_bf16 v[208:223], v[236:239], v[92:95], v[208:223]
v_accvgpr_read_b32 v32, a136
v_accvgpr_read_b32 v33, a137
v_accvgpr_read_b32 v34, a138
v_accvgpr_read_b32 v35, a139
v_accvgpr_read_b32 v36, a168
v_accvgpr_read_b32 v37, a169
s_waitcnt lgkmcnt(0)
v_mfma_f32_32x32x16_bf16 v[96:111], v[224:227], v[64:67], v[96:111]
s_waitcnt vmcnt(18)
ds_read_b64_tr_b16 v[232:233], v3 offset:34816
v_accvgpr_read_b32 v38, a170
v_accvgpr_read_b32 v39, a171
v_cvt_pk_bf16_f32 v40, v32, v33
v_cvt_pk_bf16_f32 v41, v34, v35
v_mfma_f32_32x32x16_bf16 v[160:175], v[228:231], v[64:67], v[160:175]
ds_read_b64_tr_b16 v[234:235], v3 offset:35840
ds_read_b64_tr_b16 v[236:237], v4 offset:34816
v_cvt_pk_bf16_f32 v42, v36, v37
v_cvt_pk_bf16_f32 v43, v38, v39
buffer_store_dwordx4 v[40:43], v6, s[16:19], s76 offen offset:2048 sc1
v_accvgpr_read_b32 v48, a200
v_mfma_f32_32x32x16_bf16 v[112:127], v[224:227], v[68:71], v[112:127]
ds_read_b64_tr_b16 v[238:239], v4 offset:35840
ds_read_b128 v[80:83], v5 offset:19456
v_accvgpr_read_b32 v49, a201
v_accvgpr_read_b32 v50, a202
v_accvgpr_read_b32 v51, a203
v_accvgpr_read_b32 v52, a232
v_mfma_f32_32x32x16_bf16 v[176:191], v[228:231], v[68:71], v[176:191]
ds_read_b128 v[84:87], v5 offset:23552
ds_read_b128 v[88:91], v5 offset:27648
v_accvgpr_read_b32 v53, a233
v_accvgpr_read_b32 v54, a234
v_accvgpr_read_b32 v55, a235
v_cvt_pk_bf16_f32 v56, v48, v49
v_mfma_f32_32x32x16_bf16 v[128:143], v[224:227], v[72:75], v[128:143]
ds_read_b128 v[92:95], v5 offset:31744
s_add_u32 m0, s86, 32768
v_cvt_pk_bf16_f32 v57, v50, v51
v_cvt_pk_bf16_f32 v58, v52, v53
v_cvt_pk_bf16_f32 v59, v54, v55
buffer_store_dwordx4 v[56:59], v6, s[16:19], s78 offen offset:2048 sc1
v_mfma_f32_32x32x16_bf16 v[192:207], v[228:231], v[72:75], v[192:207]
s_nop 0
s_nop 0
buffer_load_dwordx4 v27, s[28:31], s60 offen lds
v_accvgpr_read_b32 v32, a12
v_accvgpr_read_b32 v33, a13
v_accvgpr_read_b32 v34, a14
v_accvgpr_read_b32 v35, a15
v_mfma_f32_32x32x16_bf16 v[144:159], v[224:227], v[76:79], v[144:159]
buffer_load_dwordx4 v28, s[28:31], s60 offen offset:1024 lds
s_add_u32 s60, s60, 131072
v_accvgpr_read_b32 v36, a44
v_accvgpr_read_b32 v37, a45
v_accvgpr_read_b32 v38, a46
v_accvgpr_read_b32 v39, a47
v_mfma_f32_32x32x16_bf16 v[208:223], v[228:231], v[76:79], v[208:223]
v_cvt_pk_bf16_f32 v40, v32, v33
v_cvt_pk_bf16_f32 v41, v34, v35
v_cvt_pk_bf16_f32 v42, v36, v37
v_cvt_pk_bf16_f32 v43, v38, v39
buffer_store_dwordx4 v[40:43], v6, s[16:19], s72 offen offset:2176 sc1
v_accvgpr_read_b32 v48, a76
s_waitcnt lgkmcnt(0)
v_mfma_f32_32x32x16_bf16 v[96:111], v[232:235], v[80:83], v[96:111]
s_waitcnt vmcnt(20)
s_barrier
s_nop 0
ds_read_b64_tr_b16 v[224:225], v3
v_accvgpr_read_b32 v49, a77
v_accvgpr_read_b32 v50, a78
v_accvgpr_read_b32 v51, a79
v_accvgpr_read_b32 v52, a108
v_mfma_f32_32x32x16_bf16 v[160:175], v[236:239], v[80:83], v[160:175]
ds_read_b64_tr_b16 v[226:227], v3 offset:1024
ds_read_b64_tr_b16 v[228:229], v4
v_accvgpr_read_b32 v53, a109
v_accvgpr_read_b32 v54, a110
v_accvgpr_read_b32 v55, a111
v_cvt_pk_bf16_f32 v56, v48, v49
v_mfma_f32_32x32x16_bf16 v[112:127], v[232:235], v[84:87], v[112:127]
ds_read_b64_tr_b16 v[230:231], v4 offset:1024
ds_read_b128 v[64:67], v7 offset:32768
v_cvt_pk_bf16_f32 v57, v50, v51
v_cvt_pk_bf16_f32 v58, v52, v53
v_cvt_pk_bf16_f32 v59, v54, v55
buffer_store_dwordx4 v[56:59], v6, s[16:19], s74 offen offset:2176 sc1
v_mfma_f32_32x32x16_bf16 v[176:191], v[236:239], v[84:87], v[176:191]
ds_read_b128 v[68:71], v7 offset:36864
ds_read_b128 v[72:75], v7 offset:40960
v_accvgpr_read_b32 v32, a140
v_accvgpr_read_b32 v33, a141
v_accvgpr_read_b32 v34, a142
v_accvgpr_read_b32 v35, a143
v_mfma_f32_32x32x16_bf16 v[128:143], v[232:235], v[88:91], v[128:143]
ds_read_b128 v[76:79], v7 offset:45056
s_add_u32 m0, s86, 34816
v_accvgpr_read_b32 v36, a172
v_accvgpr_read_b32 v37, a173
v_accvgpr_read_b32 v38, a174
v_accvgpr_read_b32 v39, a175
v_mfma_f32_32x32x16_bf16 v[192:207], v[236:239], v[88:91], v[192:207]
s_nop 0
s_nop 0
buffer_load_dwordx4 v27, s[28:31], s60 offen lds
v_cvt_pk_bf16_f32 v40, v32, v33
v_cvt_pk_bf16_f32 v41, v34, v35
v_cvt_pk_bf16_f32 v42, v36, v37
v_cvt_pk_bf16_f32 v43, v38, v39
v_mfma_f32_32x32x16_bf16 v[144:159], v[232:235], v[92:95], v[144:159]
buffer_load_dwordx4 v28, s[28:31], s60 offen offset:1024 lds
s_add_u32 s60, s60, 131072
buffer_store_dwordx4 v[40:43], v6, s[16:19], s76 offen offset:2176 sc1
v_accvgpr_read_b32 v48, a204
v_accvgpr_read_b32 v49, a205
v_accvgpr_read_b32 v50, a206
v_mfma_f32_32x32x16_bf16 v[208:223], v[236:239], v[92:95], v[208:223]
v_accvgpr_read_b32 v51, a207
v_accvgpr_read_b32 v52, a236
v_accvgpr_read_b32 v53, a237
v_accvgpr_read_b32 v54, a238
v_accvgpr_read_b32 v55, a239
v_cvt_pk_bf16_f32 v56, v48, v49
s_waitcnt lgkmcnt(0)
v_mfma_f32_32x32x16_bf16 v[96:111], v[224:227], v[64:67], v[96:111]
s_waitcnt vmcnt(19)
ds_read_b64_tr_b16 v[232:233], v3 offset:2048
v_cvt_pk_bf16_f32 v57, v50, v51
v_cvt_pk_bf16_f32 v58, v52, v53
v_cvt_pk_bf16_f32 v59, v54, v55
buffer_store_dwordx4 v[56:59], v6, s[16:19], s78 offen offset:2176 sc1
v_mfma_f32_32x32x16_bf16 v[160:175], v[228:231], v[64:67], v[160:175]
ds_read_b64_tr_b16 v[234:235], v3 offset:3072
ds_read_b64_tr_b16 v[236:237], v4 offset:2048
v_accvgpr_read_b32 v32, a16
v_accvgpr_read_b32 v33, a17
v_accvgpr_read_b32 v34, a18
v_accvgpr_read_b32 v35, a19
v_mfma_f32_32x32x16_bf16 v[112:127], v[224:227], v[68:71], v[112:127]
ds_read_b64_tr_b16 v[238:239], v4 offset:3072
ds_read_b128 v[80:83], v7 offset:33792
v_accvgpr_read_b32 v36, a48
v_accvgpr_read_b32 v37, a49
v_accvgpr_read_b32 v38, a50
v_accvgpr_read_b32 v39, a51
v_mfma_f32_32x32x16_bf16 v[176:191], v[228:231], v[68:71], v[176:191]
ds_read_b128 v[84:87], v7 offset:37888
ds_read_b128 v[88:91], v7 offset:41984
v_cvt_pk_bf16_f32 v40, v32, v33
v_cvt_pk_bf16_f32 v41, v34, v35
v_cvt_pk_bf16_f32 v42, v36, v37
v_cvt_pk_bf16_f32 v43, v38, v39
v_mfma_f32_32x32x16_bf16 v[128:143], v[224:227], v[72:75], v[128:143]
ds_read_b128 v[92:95], v7 offset:46080
s_add_u32 m0, s86, 0
buffer_store_dwordx4 v[40:43], v6, s[16:19], s73 offen sc1
v_accvgpr_read_b32 v48, a80
v_accvgpr_read_b32 v49, a81
v_accvgpr_read_b32 v50, a82
v_mfma_f32_32x32x16_bf16 v[192:207], v[228:231], v[72:75], v[192:207]
s_nop 0
buffer_load_dwordx4 v27, s[28:31], s60 offen lds
v_accvgpr_read_b32 v51, a83
v_accvgpr_read_b32 v52, a112
v_accvgpr_read_b32 v53, a113
v_accvgpr_read_b32 v54, a114
v_mfma_f32_32x32x16_bf16 v[144:159], v[224:227], v[76:79], v[144:159]
buffer_load_dwordx4 v28, s[28:31], s60 offen offset:1024 lds
s_add_u32 s60, s60, 131072
v_accvgpr_read_b32 v55, a115
v_cvt_pk_bf16_f32 v56, v48, v49
v_cvt_pk_bf16_f32 v57, v50, v51
v_cvt_pk_bf16_f32 v58, v52, v53
v_mfma_f32_32x32x16_bf16 v[208:223], v[228:231], v[76:79], v[208:223]
v_cvt_pk_bf16_f32 v59, v54, v55
buffer_store_dwordx4 v[56:59], v6, s[16:19], s75 offen sc1
v_accvgpr_read_b32 v32, a144
v_accvgpr_read_b32 v33, a145
v_accvgpr_read_b32 v34, a146
v_accvgpr_read_b32 v35, a147
s_waitcnt lgkmcnt(0)
v_mfma_f32_32x32x16_bf16 v[96:111], v[232:235], v[80:83], v[96:111]
s_waitcnt vmcnt(19)
ds_read_b64_tr_b16 v[224:225], v3 offset:16384
v_accvgpr_read_b32 v36, a176
v_accvgpr_read_b32 v37, a177
v_accvgpr_read_b32 v38, a178
v_accvgpr_read_b32 v39, a179
v_mfma_f32_32x32x16_bf16 v[160:175], v[236:239], v[80:83], v[160:175]
ds_read_b64_tr_b16 v[226:227], v3 offset:17408
ds_read_b64_tr_b16 v[228:229], v4 offset:16384
v_cvt_pk_bf16_f32 v40, v32, v33
v_cvt_pk_bf16_f32 v41, v34, v35
v_cvt_pk_bf16_f32 v42, v36, v37
v_cvt_pk_bf16_f32 v43, v38, v39
v_mfma_f32_32x32x16_bf16 v[112:127], v[232:235], v[84:87], v[112:127]
ds_read_b64_tr_b16 v[230:231], v4 offset:17408
ds_read_b128 v[64:67], v7 offset:34816
buffer_store_dwordx4 v[40:43], v6, s[16:19], s77 offen sc1
v_accvgpr_read_b32 v48, a208
v_accvgpr_read_b32 v49, a209
v_accvgpr_read_b32 v50, a210
v_mfma_f32_32x32x16_bf16 v[176:191], v[236:239], v[84:87], v[176:191]
ds_read_b128 v[68:71], v7 offset:38912
ds_read_b128 v[72:75], v7 offset:43008
v_accvgpr_read_b32 v51, a211
v_accvgpr_read_b32 v52, a240
v_accvgpr_read_b32 v53, a241
v_accvgpr_read_b32 v54, a242
v_mfma_f32_32x32x16_bf16 v[128:143], v[232:235], v[88:91], v[128:143]
ds_read_b128 v[76:79], v7 offset:47104
s_add_u32 m0, s86, 2048
v_accvgpr_read_b32 v55, a243
v_cvt_pk_bf16_f32 v56, v48, v49
v_cvt_pk_bf16_f32 v57, v50, v51
v_cvt_pk_bf16_f32 v58, v52, v53
v_mfma_f32_32x32x16_bf16 v[192:207], v[236:239], v[88:91], v[192:207]
s_nop 0
s_nop 0
buffer_load_dwordx4 v27, s[28:31], s60 offen lds
v_cvt_pk_bf16_f32 v59, v54, v55
buffer_store_dwordx4 v[56:59], v6, s[16:19], s79 offen sc1
v_accvgpr_read_b32 v32, a20
v_accvgpr_read_b32 v33, a21
v_mfma_f32_32x32x16_bf16 v[144:159], v[232:235], v[92:95], v[144:159]
buffer_load_dwordx4 v28, s[28:31], s60 offen offset:1024 lds
s_add_u32 s60, s60, 131072
v_accvgpr_read_b32 v34, a22
v_accvgpr_read_b32 v35, a23
v_accvgpr_read_b32 v36, a52
v_accvgpr_read_b32 v37, a53
v_mfma_f32_32x32x16_bf16 v[208:223], v[236:239], v[92:95], v[208:223]
v_accvgpr_read_b32 v38, a54
v_accvgpr_read_b32 v39, a55
v_cvt_pk_bf16_f32 v40, v32, v33
v_cvt_pk_bf16_f32 v41, v34, v35
v_cvt_pk_bf16_f32 v42, v36, v37
v_cvt_pk_bf16_f32 v43, v38, v39
s_waitcnt lgkmcnt(0)
v_mfma_f32_32x32x16_bf16 v[96:111], v[224:227], v[64:67], v[96:111]
s_waitcnt vmcnt(19)
ds_read_b64_tr_b16 v[232:233], v3 offset:18432
buffer_store_dwordx4 v[40:43], v6, s[16:19], s73 offen offset:128 sc1
v_accvgpr_read_b32 v48, a84
v_accvgpr_read_b32 v49, a85
v_accvgpr_read_b32 v50, a86
v_mfma_f32_32x32x16_bf16 v[160:175], v[228:231], v[64:67], v[160:175]
ds_read_b64_tr_b16 v[234:235], v3 offset:19456
ds_read_b64_tr_b16 v[236:237], v4 offset:18432
v_accvgpr_read_b32 v51, a87
v_accvgpr_read_b32 v52, a116
v_accvgpr_read_b32 v53, a117
v_accvgpr_read_b32 v54, a118
v_mfma_f32_32x32x16_bf16 v[112:127], v[224:227], v[68:71], v[112:127]
ds_read_b64_tr_b16 v[238:239], v4 offset:19456
ds_read_b128 v[80:83], v7 offset:35840
v_accvgpr_read_b32 v55, a119
v_cvt_pk_bf16_f32 v56, v48, v49
v_cvt_pk_bf16_f32 v57, v50, v51
v_cvt_pk_bf16_f32 v58, v52, v53
v_mfma_f32_32x32x16_bf16 v[176:191], v[228:231], v[68:71], v[176:191]
ds_read_b128 v[84:87], v7 offset:39936
ds_read_b128 v[88:91], v7 offset:44032
v_cvt_pk_bf16_f32 v59, v54, v55
buffer_store_dwordx4 v[56:59], v6, s[16:19], s75 offen offset:128 sc1
v_accvgpr_read_b32 v32, a148
v_accvgpr_read_b32 v33, a149
v_mfma_f32_32x32x16_bf16 v[128:143], v[224:227], v[72:75], v[128:143]
ds_read_b128 v[92:95], v7 offset:48128
s_add_u32 m0, s86, 16384
v_accvgpr_read_b32 v34, a150
v_accvgpr_read_b32 v35, a151
v_accvgpr_read_b32 v36, a180
v_accvgpr_read_b32 v37, a181
v_mfma_f32_32x32x16_bf16 v[192:207], v[228:231], v[72:75], v[192:207]
s_nop 0
s_nop 0
buffer_load_dwordx4 v27, s[28:31], s60 offen lds
v_accvgpr_read_b32 v38, a182
v_accvgpr_read_b32 v39, a183
v_cvt_pk_bf16_f32 v40, v32, v33
v_cvt_pk_bf16_f32 v41, v34, v35
v_mfma_f32_32x32x16_bf16 v[144:159], v[224:227], v[76:79], v[144:159]
buffer_load_dwordx4 v28, s[28:31], s60 offen offset:1024 lds
s_add_u32 s60, s60, 131072
v_cvt_pk_bf16_f32 v42, v36, v37
v_cvt_pk_bf16_f32 v43, v38, v39
buffer_store_dwordx4 v[40:43], v6, s[16:19], s77 offen offset:128 sc1
v_accvgpr_read_b32 v48, a212
v_mfma_f32_32x32x16_bf16 v[208:223], v[228:231], v[76:79], v[208:223]
v_accvgpr_read_b32 v49, a213
v_accvgpr_read_b32 v50, a214
v_accvgpr_read_b32 v51, a215
v_accvgpr_read_b32 v52, a244
v_accvgpr_read_b32 v53, a245
v_accvgpr_read_b32 v54, a246
s_waitcnt lgkmcnt(0)
v_mfma_f32_32x32x16_bf16 v[96:111], v[232:235], v[80:83], v[96:111]
s_waitcnt vmcnt(19)
ds_read_b64_tr_b16 v[224:225], v3 offset:32768
v_accvgpr_read_b32 v55, a247
v_cvt_pk_bf16_f32 v56, v48, v49
v_cvt_pk_bf16_f32 v57, v50, v51
v_cvt_pk_bf16_f32 v58, v52, v53
v_mfma_f32_32x32x16_bf16 v[160:175], v[236:239], v[80:83], v[160:175]
ds_read_b64_tr_b16 v[226:227], v3 offset:33792
ds_read_b64_tr_b16 v[228:229], v4 offset:32768
v_cvt_pk_bf16_f32 v59, v54, v55
buffer_store_dwordx4 v[56:59], v6, s[16:19], s79 offen offset:128 sc1
v_accvgpr_read_b32 v32, a24
v_accvgpr_read_b32 v33, a25
v_mfma_f32_32x32x16_bf16 v[112:127], v[232:235], v[84:87], v[112:127]
ds_read_b64_tr_b16 v[230:231], v4 offset:33792
ds_read_b128 v[64:67], v5 offset:32768
v_accvgpr_read_b32 v34, a26
v_accvgpr_read_b32 v35, a27
v_accvgpr_read_b32 v36, a56
v_accvgpr_read_b32 v37, a57
v_mfma_f32_32x32x16_bf16 v[176:191], v[236:239], v[84:87], v[176:191]
ds_read_b128 v[68:71], v5 offset:36864
ds_read_b128 v[72:75], v5 offset:40960
v_accvgpr_read_b32 v38, a58
v_accvgpr_read_b32 v39, a59
v_cvt_pk_bf16_f32 v40, v32, v33
v_cvt_pk_bf16_f32 v41, v34, v35
v_mfma_f32_32x32x16_bf16 v[128:143], v[232:235], v[88:91], v[128:143]
ds_read_b128 v[76:79], v5 offset:45056
s_add_u32 m0, s86, 18432
v_cvt_pk_bf16_f32 v42, v36, v37
v_cvt_pk_bf16_f32 v43, v38, v39
buffer_store_dwordx4 v[40:43], v6, s[16:19], s73 offen offset:2048 sc1
v_accvgpr_read_b32 v48, a88
v_mfma_f32_32x32x16_bf16 v[192:207], v[236:239], v[88:91], v[192:207]
s_nop 0
s_nop 0
buffer_load_dwordx4 v27, s[28:31], s60 offen lds
v_accvgpr_read_b32 v49, a89
v_accvgpr_read_b32 v50, a90
v_accvgpr_read_b32 v51, a91
v_accvgpr_read_b32 v52, a120
v_mfma_f32_32x32x16_bf16 v[144:159], v[232:235], v[92:95], v[144:159]
buffer_load_dwordx4 v28, s[28:31], s60 offen offset:1024 lds
s_add_u32 s60, s60, 131072
v_accvgpr_read_b32 v53, a121
v_accvgpr_read_b32 v54, a122
v_accvgpr_read_b32 v55, a123
v_cvt_pk_bf16_f32 v56, v48, v49
v_mfma_f32_32x32x16_bf16 v[208:223], v[236:239], v[92:95], v[208:223]
v_cvt_pk_bf16_f32 v57, v50, v51
v_cvt_pk_bf16_f32 v58, v52, v53
v_cvt_pk_bf16_f32 v59, v54, v55
buffer_store_dwordx4 v[56:59], v6, s[16:19], s75 offen offset:2048 sc1
v_accvgpr_read_b32 v32, a152
v_accvgpr_read_b32 v33, a153
s_waitcnt lgkmcnt(0)
v_mfma_f32_32x32x16_bf16 v[96:111], v[224:227], v[64:67], v[96:111]
s_waitcnt vmcnt(20)
ds_read_b64_tr_b16 v[232:233], v3 offset:34816
v_accvgpr_read_b32 v34, a154
v_accvgpr_read_b32 v35, a155
v_accvgpr_read_b32 v36, a184
v_accvgpr_read_b32 v37, a185
v_mfma_f32_32x32x16_bf16 v[160:175], v[228:231], v[64:67], v[160:175]
ds_read_b64_tr_b16 v[234:235], v3 offset:35840
ds_read_b64_tr_b16 v[236:237], v4 offset:34816
v_accvgpr_read_b32 v38, a186
v_accvgpr_read_b32 v39, a187
v_cvt_pk_bf16_f32 v40, v32, v33
v_cvt_pk_bf16_f32 v41, v34, v35
v_mfma_f32_32x32x16_bf16 v[112:127], v[224:227], v[68:71], v[112:127]
ds_read_b64_tr_b16 v[238:239], v4 offset:35840
ds_read_b128 v[80:83], v5 offset:33792
v_cvt_pk_bf16_f32 v42, v36, v37
v_cvt_pk_bf16_f32 v43, v38, v39
buffer_store_dwordx4 v[40:43], v6, s[16:19], s77 offen offset:2048 sc1
v_accvgpr_read_b32 v48, a216
v_mfma_f32_32x32x16_bf16 v[176:191], v[228:231], v[68:71], v[176:191]
ds_read_b128 v[84:87], v5 offset:37888
ds_read_b128 v[88:91], v5 offset:41984
v_accvgpr_read_b32 v49, a217
v_accvgpr_read_b32 v50, a218
v_accvgpr_read_b32 v51, a219
v_accvgpr_read_b32 v52, a248
v_mfma_f32_32x32x16_bf16 v[128:143], v[224:227], v[72:75], v[128:143]
ds_read_b128 v[92:95], v5 offset:46080
s_add_u32 m0, s86, 32768
v_accvgpr_read_b32 v53, a249
v_accvgpr_read_b32 v54, a250
v_accvgpr_read_b32 v55, a251
v_cvt_pk_bf16_f32 v56, v48, v49
v_mfma_f32_32x32x16_bf16 v[192:207], v[228:231], v[72:75], v[192:207]
s_nop 0
s_nop 0
buffer_load_dwordx4 v27, s[28:31], s60 offen lds
v_cvt_pk_bf16_f32 v57, v50, v51
v_cvt_pk_bf16_f32 v58, v52, v53
v_cvt_pk_bf16_f32 v59, v54, v55
buffer_store_dwordx4 v[56:59], v6, s[16:19], s79 offen offset:2048 sc1
v_mfma_f32_32x32x16_bf16 v[144:159], v[224:227], v[76:79], v[144:159]
buffer_load_dwordx4 v28, s[28:31], s60 offen offset:1024 lds
s_add_u32 s60, s60, 131072
v_accvgpr_read_b32 v32, a28
v_accvgpr_read_b32 v33, a29
v_accvgpr_read_b32 v34, a30
v_accvgpr_read_b32 v35, a31
v_mfma_f32_32x32x16_bf16 v[208:223], v[228:231], v[76:79], v[208:223]
v_accvgpr_read_b32 v36, a60
v_accvgpr_read_b32 v37, a61
v_accvgpr_read_b32 v38, a62
v_accvgpr_read_b32 v39, a63
v_cvt_pk_bf16_f32 v40, v32, v33
v_cvt_pk_bf16_f32 v41, v34, v35
s_waitcnt lgkmcnt(0)
v_mfma_f32_32x32x16_bf16 v[96:111], v[232:235], v[80:83], v[96:111]
s_waitcnt vmcnt(19)
ds_read_b64_tr_b16 v[224:225], v3
v_cvt_pk_bf16_f32 v42, v36, v37
v_cvt_pk_bf16_f32 v43, v38, v39
buffer_store_dwordx4 v[40:43], v6, s[16:19], s73 offen offset:2176 sc1
v_accvgpr_read_b32 v48, a92
v_mfma_f32_32x32x16_bf16 v[160:175], v[236:239], v[80:83], v[160:175]
ds_read_b64_tr_b16 v[226:227], v3 offset:1024
ds_read_b64_tr_b16 v[228:229], v4
v_accvgpr_read_b32 v49, a93
v_accvgpr_read_b32 v50, a94
v_accvgpr_read_b32 v51, a95
v_accvgpr_read_b32 v52, a124
v_mfma_f32_32x32x16_bf16 v[112:127], v[232:235], v[84:87], v[112:127]
ds_read_b64_tr_b16 v[230:231], v4 offset:1024
ds_read_b128 v[64:67], v5 offset:34816
v_accvgpr_read_b32 v53, a125
v_accvgpr_read_b32 v54, a126
v_accvgpr_read_b32 v55, a127
v_cvt_pk_bf16_f32 v56, v48, v49
v_mfma_f32_32x32x16_bf16 v[176:191], v[236:239], v[84:87], v[176:191]
ds_read_b128 v[68:71], v5 offset:38912
ds_read_b128 v[72:75], v5 offset:43008
v_cvt_pk_bf16_f32 v57, v50, v51
v_cvt_pk_bf16_f32 v58, v52, v53
v_cvt_pk_bf16_f32 v59, v54, v55
buffer_store_dwordx4 v[56:59], v6, s[16:19], s75 offen offset:2176 sc1
v_mfma_f32_32x32x16_bf16 v[128:143], v[232:235], v[88:91], v[128:143]
ds_read_b128 v[76:79], v5 offset:47104
s_add_u32 m0, s86, 34816
v_accvgpr_read_b32 v32, a156
v_accvgpr_read_b32 v33, a157
v_accvgpr_read_b32 v34, a158
v_accvgpr_read_b32 v35, a159
v_mfma_f32_32x32x16_bf16 v[192:207], v[236:239], v[88:91], v[192:207]
s_nop 0
s_nop 0
buffer_load_dwordx4 v27, s[28:31], s60 offen lds
v_accvgpr_read_b32 v36, a188
v_accvgpr_read_b32 v37, a189
v_accvgpr_read_b32 v38, a190
v_accvgpr_read_b32 v39, a191
v_mfma_f32_32x32x16_bf16 v[144:159], v[232:235], v[92:95], v[144:159]
buffer_load_dwordx4 v28, s[28:31], s60 offen offset:1024 lds
s_add_u32 s60, s60, 131072
v_cvt_pk_bf16_f32 v40, v32, v33
v_cvt_pk_bf16_f32 v41, v34, v35
v_cvt_pk_bf16_f32 v42, v36, v37
v_cvt_pk_bf16_f32 v43, v38, v39
v_mfma_f32_32x32x16_bf16 v[208:223], v[236:239], v[92:95], v[208:223]
buffer_store_dwordx4 v[40:43], v6, s[16:19], s77 offen offset:2176 sc1
v_accvgpr_read_b32 v48, a220
v_accvgpr_read_b32 v49, a221
v_accvgpr_read_b32 v50, a222
v_accvgpr_read_b32 v51, a223
v_accvgpr_read_b32 v52, a252
s_waitcnt lgkmcnt(0)
v_mfma_f32_32x32x16_bf16 v[96:111], v[224:227], v[64:67], v[96:111]
s_waitcnt vmcnt(19)
ds_read_b64_tr_b16 v[232:233], v3 offset:2048
v_accvgpr_read_b32 v53, a253
v_accvgpr_read_b32 v54, a254
v_accvgpr_read_b32 v55, a255
v_cvt_pk_bf16_f32 v56, v48, v49
v_mfma_f32_32x32x16_bf16 v[160:175], v[228:231], v[64:67], v[160:175]
ds_read_b64_tr_b16 v[234:235], v3 offset:3072
v_cvt_pk_bf16_f32 v57, v50, v51
v_cvt_pk_bf16_f32 v58, v52, v53
v_cvt_pk_bf16_f32 v59, v54, v55
buffer_store_dwordx4 v[56:59], v6, s[16:19], s79 offen offset:2176 sc1
v_mfma_f32_32x32x16_bf16 v[112:127], v[224:227], v[68:71], v[112:127]
ds_read_b64_tr_b16 v[236:237], v4 offset:2048
v_mfma_f32_32x32x16_bf16 v[176:191], v[228:231], v[68:71], v[176:191]
ds_read_b64_tr_b16 v[238:239], v4 offset:3072
ds_read_b128 v[80:83], v5 offset:35840
v_mfma_f32_32x32x16_bf16 v[128:143], v[224:227], v[72:75], v[128:143]
ds_read_b128 v[84:87], v5 offset:39936
v_mfma_f32_32x32x16_bf16 v[192:207], v[228:231], v[72:75], v[192:207]
ds_read_b128 v[88:91], v5 offset:44032
v_mfma_f32_32x32x16_bf16 v[144:159], v[224:227], v[76:79], v[144:159]
ds_read_b128 v[92:95], v5 offset:48128
v_mfma_f32_32x32x16_bf16 v[208:223], v[228:231], v[76:79], v[208:223]
s_waitcnt lgkmcnt(0)
v_mfma_f32_32x32x16_bf16 v[96:111], v[232:235], v[80:83], v[96:111]
s_waitcnt vmcnt(16)
ds_read_b64_tr_b16 v[224:225], v3 offset:16384
v_mfma_f32_32x32x16_bf16 v[160:175], v[236:239], v[80:83], v[160:175]
ds_read_b64_tr_b16 v[226:227], v3 offset:17408
v_mfma_f32_32x32x16_bf16 v[112:127], v[232:235], v[84:87], v[112:127]
ds_read_b64_tr_b16 v[228:229], v4 offset:16384
v_mfma_f32_32x32x16_bf16 v[176:191], v[236:239], v[84:87], v[176:191]
ds_read_b64_tr_b16 v[230:231], v4 offset:17408
ds_read_b128 v[64:67], v5 offset:49152
v_mfma_f32_32x32x16_bf16 v[128:143], v[232:235], v[88:91], v[128:143]
ds_read_b128 v[68:71], v5 offset:53248
v_mfma_f32_32x32x16_bf16 v[192:207], v[236:239], v[88:91], v[192:207]
ds_read_b128 v[72:75], v5 offset:57344
v_mfma_f32_32x32x16_bf16 v[144:159], v[232:235], v[92:95], v[144:159]
ds_read_b128 v[76:79], v5 offset:61440
v_mfma_f32_32x32x16_bf16 v[208:223], v[236:239], v[92:95], v[208:223]
s_waitcnt lgkmcnt(0)
v_mfma_f32_32x32x16_bf16 v[96:111], v[224:227], v[64:67], v[96:111]
s_waitcnt vmcnt(11)
ds_read_b64_tr_b16 v[232:233], v3 offset:18432
v_mfma_f32_32x32x16_bf16 v[160:175], v[228:231], v[64:67], v[160:175]
ds_read_b64_tr_b16 v[234:235], v3 offset:19456
v_mfma_f32_32x32x16_bf16 v[112:127], v[224:227], v[68:71], v[112:127]
ds_read_b64_tr_b16 v[236:237], v4 offset:18432
v_mfma_f32_32x32x16_bf16 v[176:191], v[228:231], v[68:71], v[176:191]
ds_read_b64_tr_b16 v[238:239], v4 offset:19456
ds_read_b128 v[80:83], v5 offset:50176
v_mfma_f32_32x32x16_bf16 v[128:143], v[224:227], v[72:75], v[128:143]
ds_read_b128 v[84:87], v5 offset:54272
v_mfma_f32_32x32x16_bf16 v[192:207], v[228:231], v[72:75], v[192:207]
ds_read_b128 v[88:91], v5 offset:58368
v_mfma_f32_32x32x16_bf16 v[144:159], v[224:227], v[76:79], v[144:159]
ds_read_b128 v[92:95], v5 offset:62464
v_mfma_f32_32x32x16_bf16 v[208:223], v[228:231], v[76:79], v[208:223]
s_waitcnt lgkmcnt(0)
v_mfma_f32_32x32x16_bf16 v[96:111], v[232:235], v[80:83], v[96:111]
s_waitcnt vmcnt(6)
ds_read_b64_tr_b16 v[224:225], v3 offset:32768
v_mfma_f32_32x32x16_bf16 v[160:175], v[236:239], v[80:83], v[160:175]
ds_read_b64_tr_b16 v[226:227], v3 offset:33792
v_mfma_f32_32x32x16_bf16 v[112:127], v[232:235], v[84:87], v[112:127]
ds_read_b64_tr_b16 v[228:229], v4 offset:32768
v_mfma_f32_32x32x16_bf16 v[176:191], v[236:239], v[84:87], v[176:191]
ds_read_b64_tr_b16 v[230:231], v4 offset:33792
ds_read_b128 v[64:67], v5 offset:51200
v_mfma_f32_32x32x16_bf16 v[128:143], v[232:235], v[88:91], v[128:143]
ds_read_b128 v[68:71], v5 offset:55296
v_mfma_f32_32x32x16_bf16 v[192:207], v[236:239], v[88:91], v[192:207]
ds_read_b128 v[72:75], v5 offset:59392
v_mfma_f32_32x32x16_bf16 v[144:159], v[232:235], v[92:95], v[144:159]
ds_read_b128 v[76:79], v5 offset:63488
v_mfma_f32_32x32x16_bf16 v[208:223], v[236:239], v[92:95], v[208:223]
s_waitcnt lgkmcnt(0)
v_mfma_f32_32x32x16_bf16 v[96:111], v[224:227], v[64:67], v[96:111]
s_waitcnt vmcnt(2)
ds_read_b64_tr_b16 v[232:233], v3 offset:34816
v_mfma_f32_32x32x16_bf16 v[160:175], v[228:231], v[64:67], v[160:175]
ds_read_b64_tr_b16 v[234:235], v3 offset:35840
v_mfma_f32_32x32x16_bf16 v[112:127], v[224:227], v[68:71], v[112:127]
ds_read_b64_tr_b16 v[236:237], v4 offset:34816
v_mfma_f32_32x32x16_bf16 v[176:191], v[228:231], v[68:71], v[176:191]
ds_read_b64_tr_b16 v[238:239], v4 offset:35840
ds_read_b128 v[80:83], v5 offset:52224
v_mfma_f32_32x32x16_bf16 v[128:143], v[224:227], v[72:75], v[128:143]
ds_read_b128 v[84:87], v5 offset:56320
v_mfma_f32_32x32x16_bf16 v[192:207], v[228:231], v[72:75], v[192:207]
ds_read_b128 v[88:91], v5 offset:60416
v_mfma_f32_32x32x16_bf16 v[144:159], v[224:227], v[76:79], v[144:159]
ds_read_b128 v[92:95], v5 offset:64512
v_mfma_f32_32x32x16_bf16 v[208:223], v[228:231], v[76:79], v[208:223]
s_waitcnt lgkmcnt(0)
v_mfma_f32_32x32x16_bf16 v[96:111], v[232:235], v[80:83], v[96:111]
v_mfma_f32_32x32x16_bf16 v[160:175], v[236:239], v[80:83], v[160:175]
v_mfma_f32_32x32x16_bf16 v[112:127], v[232:235], v[84:87], v[112:127]
v_mfma_f32_32x32x16_bf16 v[176:191], v[236:239], v[84:87], v[176:191]
v_mfma_f32_32x32x16_bf16 v[128:143], v[232:235], v[88:91], v[128:143]
v_mfma_f32_32x32x16_bf16 v[192:207], v[236:239], v[88:91], v[192:207]
v_mfma_f32_32x32x16_bf16 v[144:159], v[232:235], v[92:95], v[144:159]
v_mfma_f32_32x32x16_bf16 v[208:223], v[236:239], v[92:95], v[208:223]
s_waitcnt vmcnt(0)
s_barrier
s_lshl_b32 s56, s4, 6
s_lshl_b32 s57, s7, 5
s_add_u32 s56, s56, s57
s_lshl_b32 s57, s6, 2
s_add_u32 s56, s56, s57
s_add_u32 s56, s56, 2048
s_cmp_lg_u32 s3, 0
s_cbranch_scc1 SETF_10
s_mov_b64 exec, 1
buffer_store_dword v30, v29, s[88:91], s56 offen sc1
s_mov_b64 exec, -1
SETF_10:
PB_JOIN:
s_mov_b32 s4, s85
s_lshl_b32 s45, s3, 12
v_add_u32 v4, s45, v5
s_nop 0
v_cvt_pk_bf16_f32 v96, v96, v97
v_cvt_pk_bf16_f32 v97, v98, v99
v_cvt_pk_bf16_f32 v98, v100, v101
v_cvt_pk_bf16_f32 v99, v102, v103
v_cvt_pk_bf16_f32 v100, v104, v105
v_cvt_pk_bf16_f32 v101, v106, v107
v_cvt_pk_bf16_f32 v102, v108, v109
v_cvt_pk_bf16_f32 v103, v110, v111
ds_write_b128 v4, v[96:99]
ds_write_b128 v4, v[100:103] offset:1024
v_cvt_pk_bf16_f32 v160, v160, v161
v_cvt_pk_bf16_f32 v161, v162, v163
v_cvt_pk_bf16_f32 v162, v164, v165
v_cvt_pk_bf16_f32 v163, v166, v167
v_cvt_pk_bf16_f32 v164, v168, v169
v_cvt_pk_bf16_f32 v165, v170, v171
v_cvt_pk_bf16_f32 v166, v172, v173
v_cvt_pk_bf16_f32 v167, v174, v175
ds_write_b128 v4, v[160:163] offset:2048
ds_write_b128 v4, v[164:167] offset:3072
v_cvt_pk_bf16_f32 v112, v112, v113
v_cvt_pk_bf16_f32 v113, v114, v115
v_cvt_pk_bf16_f32 v114, v116, v117
v_cvt_pk_bf16_f32 v115, v118, v119
v_cvt_pk_bf16_f32 v116, v120, v121
v_cvt_pk_bf16_f32 v117, v122, v123
v_cvt_pk_bf16_f32 v118, v124, v125
v_cvt_pk_bf16_f32 v119, v126, v127
ds_write_b128 v4, v[112:115] offset:16384
ds_write_b128 v4, v[116:119] offset:17408
v_cvt_pk_bf16_f32 v176, v176, v177
v_cvt_pk_bf16_f32 v177, v178, v179
v_cvt_pk_bf16_f32 v178, v180, v181
v_cvt_pk_bf16_f32 v179, v182, v183
v_cvt_pk_bf16_f32 v180, v184, v185
v_cvt_pk_bf16_f32 v181, v186, v187
v_cvt_pk_bf16_f32 v182, v188, v189
v_cvt_pk_bf16_f32 v183, v190, v191
ds_write_b128 v4, v[176:179] offset:18432
ds_write_b128 v4, v[180:183] offset:19456
v_cvt_pk_bf16_f32 v128, v128, v129
v_cvt_pk_bf16_f32 v129, v130, v131
v_cvt_pk_bf16_f32 v130, v132, v133
v_cvt_pk_bf16_f32 v131, v134, v135
v_cvt_pk_bf16_f32 v132, v136, v137
v_cvt_pk_bf16_f32 v133, v138, v139
v_cvt_pk_bf16_f32 v134, v140, v141
v_cvt_pk_bf16_f32 v135, v142, v143
ds_write_b128 v4, v[128:131] offset:32768
ds_write_b128 v4, v[132:135] offset:33792
v_cvt_pk_bf16_f32 v192, v192, v193
v_cvt_pk_bf16_f32 v193, v194, v195
v_cvt_pk_bf16_f32 v194, v196, v197
v_cvt_pk_bf16_f32 v195, v198, v199
v_cvt_pk_bf16_f32 v196, v200, v201
v_cvt_pk_bf16_f32 v197, v202, v203
v_cvt_pk_bf16_f32 v198, v204, v205
v_cvt_pk_bf16_f32 v199, v206, v207
ds_write_b128 v4, v[192:195] offset:34816
ds_write_b128 v4, v[196:199] offset:35840
v_cvt_pk_bf16_f32 v144, v144, v145
v_cvt_pk_bf16_f32 v145, v146, v147
v_cvt_pk_bf16_f32 v146, v148, v149
v_cvt_pk_bf16_f32 v147, v150, v151
v_cvt_pk_bf16_f32 v148, v152, v153
v_cvt_pk_bf16_f32 v149, v154, v155
v_cvt_pk_bf16_f32 v150, v156, v157
v_cvt_pk_bf16_f32 v151, v158, v159
ds_write_b128 v4, v[144:147] offset:49152
ds_write_b128 v4, v[148:151] offset:50176
v_cvt_pk_bf16_f32 v208, v208, v209
v_cvt_pk_bf16_f32 v209, v210, v211
v_cvt_pk_bf16_f32 v210, v212, v213
v_cvt_pk_bf16_f32 v211, v214, v215
v_cvt_pk_bf16_f32 v212, v216, v217
v_cvt_pk_bf16_f32 v213, v218, v219
v_cvt_pk_bf16_f32 v214, v220, v221
v_cvt_pk_bf16_f32 v215, v222, v223
ds_write_b128 v4, v[208:211] offset:51200
ds_write_b128 v4, v[212:215] offset:52224
s_add_u32 s20, s54, 0x2e00000
s_addc_u32 s21, s55, 0
s_and_b32 s21, s21, 0xffff
s_mov_b32 s22, 0x1000000
s_mov_b32 s23, 0x00020000
s_and_b32 s45, s3, 1
s_lshl_b32 s45, s45, 1
s_add_u32 s64, s45, 2
s_and_b32 s64, s64, 3
s_lshl_b32 s64, s64, 12
s_add_u32 s65, s45, 3
s_and_b32 s65, s65, 3
s_lshl_b32 s65, s65, 12
s_add_u32 s66, s45, 4
s_and_b32 s66, s66, 3
s_lshl_b32 s66, s66, 12
s_add_u32 s67, s45, 5
s_and_b32 s67, s67, 3
s_lshl_b32 s67, s67, 12
s_lshl_b32 s45, s5, 1
s_sub_u32 s56, 64, s45
s_mul_i32 s57, s3, 17
s_min_u32 s57, s57, 50
s_add_u32 s58, s57, 17
s_cmp_ge_u32 s3, 2
s_cselect_b32 s45, 1, 0
s_sub_u32 s58, s58, s45
s_min_u32 s59, s58, s56
s_sub_i32 s59, s59, s57
s_max_i32 s59, s59, 0
s_max_u32 s60, s57, s56
s_sub_i32 s53, s58, s60
s_max_i32 s53, s53, 0
s_sub_u32 s60, s60, s56
s_cmp_gt_u32 s59, 0
s_cselect_b32 s34, 0, 1
s_cselect_b32 s40, s57, s60
s_cselect_b32 s7, s59, s53
s_cselect_b32 s53, s53, 0
s_mov_b32 s52, 0
s_cmp_gt_u32 s56, 50
s_cselect_b32 s61, 0x8000, 0
s_add_u32 s61, s61, 98304
v_and_b32 v32, 31, v2
v_lshrrev_b32 v33, 5, v2
v_lshlrev_b32 v3, 6, v32
v_add_u32 v3, s61, v3
v_lshlrev_b32 v1, 4, v32
v_add_u32 v1, s61, v1
v_add_u32 v1, 4096, v1
v_lshlrev_b32 v34, 2, v33
v_sub_u32 v34, v32, v34
v_cvt_f32_i32 v0, v34
v_add_f32 v0, 0.5, v0
v_mov_b32 v35, 0x3f80
v_mov_b32 v36, 0x3f800000
v_cmp_eq_u32 vcc, 0, v34
v_cmp_eq_u32 s[50:51], 1, v34
s_nop 1
v_cndmask_b32 v20, 0, v35, vcc
v_cndmask_b32 v20, v20, v36, s[50:51]
v_cmp_eq_u32 vcc, 2, v34
v_cmp_eq_u32 s[50:51], 3, v34
s_nop 1
v_cndmask_b32 v21, 0, v35, vcc
v_cndmask_b32 v21, v21, v36, s[50:51]
v_cmp_eq_u32 vcc, 8, v34
v_cmp_eq_u32 s[50:51], 9, v34
s_nop 1
v_cndmask_b32 v22, 0, v35, vcc
v_cndmask_b32 v22, v22, v36, s[50:51]
v_cmp_eq_u32 vcc, 10, v34
v_cmp_eq_u32 s[50:51], 11, v34
s_nop 1
v_cndmask_b32 v23, 0, v35, vcc
v_cndmask_b32 v23, v23, v36, s[50:51]
v_cmp_eq_u32 vcc, 16, v34
v_cmp_eq_u32 s[50:51], 17, v34
s_nop 1
v_cndmask_b32 v24, 0, v35, vcc
v_cndmask_b32 v24, v24, v36, s[50:51]
v_cmp_eq_u32 vcc, 18, v34
v_cmp_eq_u32 s[50:51], 19, v34
s_nop 1
v_cndmask_b32 v25, 0, v35, vcc
v_cndmask_b32 v25, v25, v36, s[50:51]
v_cmp_eq_u32 vcc, 24, v34
v_cmp_eq_u32 s[50:51], 25, v34
s_nop 1
v_cndmask_b32 v26, 0, v35, vcc
v_cndmask_b32 v26, v26, v36, s[50:51]
v_cmp_eq_u32 vcc, 26, v34
v_cmp_eq_u32 s[50:51], 27, v34
s_nop 1
v_cndmask_b32 v27, 0, v35, vcc
v_cndmask_b32 v27, v27, v36, s[50:51]
s_mov_b32 s68, 0x3db8aa3b
s_mov_b32 s69, 0x42b17218
v_and_b32 v32, 7, v2
v_lshlrev_b32 v32, 2, v32
s_lshl_b32 s45, s4, 6
s_add_u32 s45, s45, 2048
s_mov_b32 s87, 0
POLL_11:
buffer_load_dword v36, v32, s[88:91], s45 offen sc1
s_waitcnt vmcnt(0)
v_cmp_ne_u32 vcc, 1, v36
s_cbranch_vccz POLL_11_OK
s_sleep 1
s_add_u32 s87, s87, 1
s_cmp_lt_u32 s87, 65536
s_cbranch_scc1 POLL_11
POLL_11_OK:
s_lshl_b32 s48, s4, 21
s_lshl_b32 s35, s40, 15
s_add_u32 s35, s35, s48
s_add_u32 s45, s35, 0
buffer_load_dwordx4 a[128:131], v5, s[16:19], s45 offen sc1
buffer_load_dwordx4 a[132:135], v5, s[16:19], s45 offen offset:1024 sc1
buffer_load_dwordx4 a[136:139], v5, s[16:19], s45 offen offset:2048 sc1
buffer_load_dwordx4 a[140:143], v5, s[16:19], s45 offen offset:3072 sc1
s_add_u32 s45, s35, 4096
buffer_load_dwordx4 a[144:147], v5, s[16:19], s45 offen sc1
buffer_load_dwordx4 a[148:151], v5, s[16:19], s45 offen offset:1024 sc1
buffer_load_dwordx4 a[152:155], v5, s[16:19], s45 offen offset:2048 sc1
buffer_load_dwordx4 a[156:159], v5, s[16:19], s45 offen offset:3072 sc1
s_waitcnt lgkmcnt(0)
s_barrier
v_mov_b32 v32, 0xf1800000
v_mov_b32 v33, 0
v_mov_b32 v34, v32
v_mov_b32 v35, 0
ds_write_b128 v3, v[32:35] offset:32
ds_write_b128 v3, v[32:35] offset:48
ds_write_b128 v3, v[32:35] offset:2080
ds_write_b128 v3, v[32:35] offset:2096
s_cmp_eq_u32 s34, 0
s_cselect_b32 s45, 0x8000, 0
v_add_u32 v4, s45, v5
s_nop 0
ds_read_b128 a[0:3], v4
ds_read_b128 a[4:7], v4 offset:1024
ds_read_b128 a[8:11], v4 offset:2048
ds_read_b128 a[12:15], v4 offset:3072
ds_read_b128 a[16:19], v4 offset:4096
ds_read_b128 a[20:23], v4 offset:5120
ds_read_b128 a[24:27], v4 offset:6144
ds_read_b128 a[28:31], v4 offset:7168
ds_read_b128 a[32:35], v4 offset:8192
ds_read_b128 a[36:39], v4 offset:9216
ds_read_b128 a[40:43], v4 offset:10240
ds_read_b128 a[44:47], v4 offset:11264
ds_read_b128 a[48:51], v4 offset:12288
ds_read_b128 a[52:55], v4 offset:13312
ds_read_b128 a[56:59], v4 offset:14336
ds_read_b128 a[60:63], v4 offset:15360
ds_read_b128 a[64:67], v4 offset:16384
ds_read_b128 a[68:71], v4 offset:17408
ds_read_b128 a[72:75], v4 offset:18432
ds_read_b128 a[76:79], v4 offset:19456
ds_read_b128 a[80:83], v4 offset:20480
ds_read_b128 a[84:87], v4 offset:21504
ds_read_b128 a[88:91], v4 offset:22528
ds_read_b128 a[92:95], v4 offset:23552
ds_read_b128 a[96:99], v4 offset:24576
ds_read_b128 a[100:103], v4 offset:25600
ds_read_b128 a[104:107], v4 offset:26624
ds_read_b128 a[108:111], v4 offset:27648
ds_read_b128 a[112:115], v4 offset:28672
ds_read_b128 a[116:119], v4 offset:29696
ds_read_b128 a[120:123], v4 offset:30720
ds_read_b128 a[124:127], v4 offset:31744
s_sub_u32 s6, 31, s5
s_cmp_eq_u32 s34, 0
s_cselect_b32 s6, s6, s5
s_lshl_b32 s41, s6, 1
s_mov_b32 s42, 0
v_mov_b32 v12, 0
v_mov_b32 v13, 0
s_lshr_b32 s43, s3, 1
s_mul_i32 s43, s43, 98304
s_and_b32 s45, s3, 1
s_lshl_b32 s45, s45, 14
s_add_u32 s45, s45, s43
s_add_u32 s45, s45, 32768
s_lshl_b32 s43, s3, 15
s_lshl_b32 s44, s64, 1
s_add_u32 s43, s43, s44
s_lshr_b32 s44, s3, 1
s_xor_b32 s49, s34, 1
s_and_b32 s49, s49, s44
s_cselect_b32 s45, s43, s45
v_add_u32 v28, s45, v5
s_mov_b32 s36, s35
s_add_u32 s43, s35, 32768
s_add_u32 s44, s35, 36864
s_add_u32 s45, s35, 16384
s_add_u32 s38, s45, s64
s_add_u32 s39, s45, s65
s_cmp_gt_u32 s7, 1
s_cselect_b32 s43, s43, s38
s_cselect_b32 s44, s44, s39
s_waitcnt lgkmcnt(0)
s_waitcnt vmcnt(7)
v_mfma_f32_32x32x16_bf16 v[32:47], a[128:131], a[0:3], 0
v_mfma_f32_32x32x16_bf16 v[48:63], a[128:131], a[64:67], 0
s_add_u32 s45, s36, 8192
buffer_load_dwordx4 a[128:131], v5, s[16:19], s45 offen sc1
s_waitcnt vmcnt(7)
v_mfma_f32_32x32x16_bf16 v[32:47], a[132:135], a[4:7], v[32:47]
v_mfma_f32_32x32x16_bf16 v[48:63], a[132:135], a[68:71], v[48:63]
buffer_load_dwordx4 a[132:135], v5, s[16:19], s45 offen offset:1024 sc1
s_waitcnt vmcnt(7)
v_mfma_f32_32x32x16_bf16 v[32:47], a[136:139], a[8:11], v[32:47]
v_mfma_f32_32x32x16_bf16 v[48:63], a[136:139], a[72:75], v[48:63]
buffer_load_dwordx4 a[136:139], v5, s[16:19], s45 offen offset:2048 sc1
s_waitcnt vmcnt(7)
v_mfma_f32_32x32x16_bf16 v[32:47], a[140:143], a[12:15], v[32:47]
v_mfma_f32_32x32x16_bf16 v[48:63], a[140:143], a[76:79], v[48:63]
buffer_load_dwordx4 a[140:143], v5, s[16:19], s45 offen offset:3072 sc1
s_waitcnt vmcnt(7)
v_mfma_f32_32x32x16_bf16 v[32:47], a[144:147], a[16:19], v[32:47]
v_mfma_f32_32x32x16_bf16 v[48:63], a[144:147], a[80:83], v[48:63]
s_add_u32 s45, s36, 12288
buffer_load_dwordx4 a[144:147], v5, s[16:19], s45 offen sc1
s_waitcnt vmcnt(7)
v_mfma_f32_32x32x16_bf16 v[32:47], a[148:151], a[20:23], v[32:47]
v_mfma_f32_32x32x16_bf16 v[48:63], a[148:151], a[84:87], v[48:63]
buffer_load_dwordx4 a[148:151], v5, s[16:19], s45 offen offset:1024 sc1
s_waitcnt vmcnt(7)
v_mfma_f32_32x32x16_bf16 v[32:47], a[152:155], a[24:27], v[32:47]
v_mfma_f32_32x32x16_bf16 v[48:63], a[152:155], a[88:91], v[48:63]
buffer_load_dwordx4 a[152:155], v5, s[16:19], s45 offen offset:2048 sc1
s_waitcnt vmcnt(7)
v_mfma_f32_32x32x16_bf16 v[32:47], a[156:159], a[28:31], v[32:47]
v_mfma_f32_32x32x16_bf16 v[48:63], a[156:159], a[92:95], v[48:63]
buffer_load_dwordx4 a[156:159], v5, s[16:19], s45 offen offset:3072 sc1
s_waitcnt vmcnt(7)
v_mfma_f32_32x32x16_bf16 v[32:47], a[128:131], a[32:35], v[32:47]
v_mfma_f32_32x32x16_bf16 v[48:63], a[128:131], a[96:99], v[48:63]
buffer_load_dwordx4 a[128:131], v5, s[16:19], s43 offen sc1
s_waitcnt vmcnt(7)
v_mfma_f32_32x32x16_bf16 v[32:47], a[132:135], a[36:39], v[32:47]
v_mfma_f32_32x32x16_bf16 v[48:63], a[132:135], a[100:103], v[48:63]
buffer_load_dwordx4 a[132:135], v5, s[16:19], s43 offen offset:1024 sc1
s_waitcnt vmcnt(7)
v_mfma_f32_32x32x16_bf16 v[32:47], a[136:139], a[40:43], v[32:47]
v_mfma_f32_32x32x16_bf16 v[48:63], a[136:139], a[104:107], v[48:63]
buffer_load_dwordx4 a[136:139], v5, s[16:19], s43 offen offset:2048 sc1
s_waitcnt vmcnt(7)
v_mfma_f32_32x32x16_bf16 v[32:47], a[140:143], a[44:47], v[32:47]
v_mfma_f32_32x32x16_bf16 v[48:63], a[140:143], a[108:111], v[48:63]
buffer_load_dwordx4 a[140:143], v5, s[16:19], s43 offen offset:3072 sc1
s_waitcnt vmcnt(7)
v_mfma_f32_32x32x16_bf16 v[32:47], a[144:147], a[48:51], v[32:47]
v_mfma_f32_32x32x16_bf16 v[48:63], a[144:147], a[112:115], v[48:63]
buffer_load_dwordx4 a[144:147], v5, s[16:19], s44 offen sc1
s_waitcnt vmcnt(7)
v_mfma_f32_32x32x16_bf16 v[32:47], a[148:151], a[52:55], v[32:47]
v_mfma_f32_32x32x16_bf16 v[48:63], a[148:151], a[116:119], v[48:63]
buffer_load_dwordx4 a[148:151], v5, s[16:19], s44 offen offset:1024 sc1
s_waitcnt vmcnt(7)
v_mfma_f32_32x32x16_bf16 v[32:47], a[152:155], a[56:59], v[32:47]
v_mfma_f32_32x32x16_bf16 v[48:63], a[152:155], a[120:123], v[48:63]
buffer_load_dwordx4 a[152:155], v5, s[16:19], s44 offen offset:2048 sc1
s_waitcnt vmcnt(7)
v_mfma_f32_32x32x16_bf16 v[32:47], a[156:159], a[60:63], v[32:47]
v_mfma_f32_32x32x16_bf16 v[48:63], a[156:159], a[124:127], v[48:63]
buffer_load_dwordx4 a[156:159], v5, s[16:19], s44 offen offset:3072 sc1
PC_X0DONE:
s_nop 7
s_nop 3
s_cmp_ge_u32 s40, s41
s_cbranch_scc0 PC_NOMASK0
s_lshl_b32 s63, s6, 1
s_sub_u32 s63, s63, s40
s_lshl_b32 s63, s63, 5
v_cvt_f32_i32 v4, s63
v_add_f32 v4, v4, v0
v_mov_b32 v6, v4
v_mul_f32 v6, 0x71800000, v6
v_mov_b32 v7, v6
v_min_f32 v32, v32, v7
v_add_f32 v7, 0xf1800000, v6
v_min_f32 v33, v33, v7
v_add_f32 v7, 0xf2000000, v6
v_min_f32 v34, v34, v7
v_add_f32 v7, 0xf2400000, v6
v_min_f32 v35, v35, v7
v_add_f32 v7, 0xf3000000, v6
v_min_f32 v36, v36, v7
v_add_f32 v7, 0xf3100000, v6
v_min_f32 v37, v37, v7
v_add_f32 v7, 0xf3200000, v6
v_min_f32 v38, v38, v7
v_add_f32 v7, 0xf3300000, v6
v_min_f32 v39, v39, v7
v_add_f32 v7, 0xf3800000, v6
v_min_f32 v40, v40, v7
v_add_f32 v7, 0xf3880000, v6
v_min_f32 v41, v41, v7
v_add_f32 v7, 0xf3900000, v6
v_min_f32 v42, v42, v7
v_add_f32 v7, 0xf3980000, v6
v_min_f32 v43, v43, v7
v_add_f32 v7, 0xf3c00000, v6
v_min_f32 v44, v44, v7
v_add_f32 v7, 0xf3c80000, v6
v_min_f32 v45, v45, v7
v_add_f32 v7, 0xf3d00000, v6
v_min_f32 v46, v46, v7
v_add_f32 v7, 0xf3d80000, v6
v_min_f32 v47, v47, v7
v_add_f32 v6, 0x42000000, v4
v_mul_f32 v6, 0x71800000, v6
v_mov_b32 v7, v6
v_min_f32 v48, v48, v7
v_add_f32 v7, 0xf1800000, v6
v_min_f32 v49, v49, v7
v_add_f32 v7, 0xf2000000, v6
v_min_f32 v50, v50, v7
v_add_f32 v7, 0xf2400000, v6
v_min_f32 v51, v51, v7
v_add_f32 v7, 0xf3000000, v6
v_min_f32 v52, v52, v7
v_add_f32 v7, 0xf3100000, v6
v_min_f32 v53, v53, v7
v_add_f32 v7, 0xf3200000, v6
v_min_f32 v54, v54, v7
v_add_f32 v7, 0xf3300000, v6
v_min_f32 v55, v55, v7
v_add_f32 v7, 0xf3800000, v6
v_min_f32 v56, v56, v7
v_add_f32 v7, 0xf3880000, v6
v_min_f32 v57, v57, v7
v_add_f32 v7, 0xf3900000, v6
v_min_f32 v58, v58, v7
v_add_f32 v7, 0xf3980000, v6
v_min_f32 v59, v59, v7
v_add_f32 v7, 0xf3c00000, v6
v_min_f32 v60, v60, v7
v_add_f32 v7, 0xf3c80000, v6
v_min_f32 v61, v61, v7
v_add_f32 v7, 0xf3d00000, v6
v_min_f32 v62, v62, v7
v_add_f32 v7, 0xf3d80000, v6
v_min_f32 v63, v63, v7
PC_NOMASK0:
v_max3_f32 v16, v32, v33, v34
v_max3_f32 v16, v16, v35, v36
v_max3_f32 v16, v16, v37, v38
v_max3_f32 v16, v16, v39, v40
v_max3_f32 v16, v16, v41, v42
v_max3_f32 v16, v16, v43, v44
v_max3_f32 v16, v16, v45, v46
v_max_f32 v16, v16, v47
s_nop 0
v_max3_f32 v17, v48, v49, v50
v_max3_f32 v17, v17, v51, v52
v_max3_f32 v17, v17, v53, v54
v_max3_f32 v17, v17, v55, v56
v_max3_f32 v17, v17, v57, v58
v_max3_f32 v17, v17, v59, v60
v_max3_f32 v17, v17, v61, v62
v_max_f32 v17, v17, v63
v_mov_b32 v4, v16
s_nop 1
v_permlane32_swap_b32 v16, v4
v_max_f32 v16, v16, v4
v_mov_b32 v6, v17
s_nop 1
v_permlane32_swap_b32 v17, v6
v_max_f32 v17, v17, v6
s_lshl_b32 s45, s34, 10
v_add_u32 v6, s45, v1
s_cmp_lg_u32 s52, 0
s_cbranch_scc1 PC_NOPUB
s_lshl_b32 s43, s3, 2
v_add_u32 v4, s43, v6
s_nop 0
v_xor_b32 v7, 1024, v4
v_mov_b32 v64, 0xf1800000
ds_write_b32 v4, v16
ds_write_b32 v7, v64
ds_write_b32 v4, v17 offset:512
ds_write_b32 v7, v64 offset:512
v_and_b32 v66, 7, v2
v_lshlrev_b32 v66, 2, v66
s_lshl_b32 s45, s4, 6
s_add_u32 s45, s45, 2080
s_mov_b32 s87, 0
POLL_12:
buffer_load_dword v67, v66, s[88:91], s45 offen sc1
s_waitcnt vmcnt(0)
v_cmp_ne_u32 vcc, 1, v67
s_cbranch_vccz POLL_12_OK
s_sleep 1
s_add_u32 s87, s87, 1
s_cmp_lt_u32 s87, 65536
s_cbranch_scc1 POLL_12
POLL_12_OK:
s_waitcnt lgkmcnt(0)
s_barrier
PC_NOPUB:
ds_read_b128 v[64:67], v6
ds_read_b128 v[68:71], v6 offset:512
s_waitcnt lgkmcnt(0)
v_max3_f32 v18, v64, v65, v66
v_max_f32 v18, v18, v67
v_add_f32 v10, s69, v18
v_cmp_gt_f32 vcc, v16, v10
s_nop 1
v_cndmask_b32 v18, v18, v16, vcc
v_mul_f32 v8, s68, v18
v_add_f32 v10, s69, v18
v_max3_f32 v19, v68, v69, v70
v_max_f32 v19, v19, v71
v_add_f32 v11, s69, v19
v_cmp_gt_f32 vcc, v17, v11
s_nop 1
v_cndmask_b32 v19, v19, v17, vcc
v_mul_f32 v9, s68, v19
v_add_f32 v11, s69, v19
s_add_u32 s40, s40, 1
v_fma_f32 v32, v32, s68, -v8
v_fma_f32 v33, v33, s68, -v8
v_exp_f32 v32, v32
v_exp_f32 v33, v33
v_fma_f32 v34, v34, s68, -v8
v_fma_f32 v35, v35, s68, -v8
v_exp_f32 v34, v34
v_exp_f32 v35, v35
v_add_f32 v12, v12, v32
v_add_f32 v12, v12, v33
v_cvt_pk_bf16_f32 v32, v32, v33
v_fma_f32 v36, v36, s68, -v8
v_fma_f32 v37, v37, s68, -v8
v_exp_f32 v36, v36
v_exp_f32 v37, v37
v_add_f32 v12, v12, v34
v_add_f32 v12, v12, v35
v_cvt_pk_bf16_f32 v33, v34, v35
v_fma_f32 v38, v38, s68, -v8
v_fma_f32 v39, v39, s68, -v8
v_exp_f32 v38, v38
v_exp_f32 v39, v39
v_add_f32 v12, v12, v36
v_add_f32 v12, v12, v37
v_cvt_pk_bf16_f32 v34, v36, v37
v_fma_f32 v40, v40, s68, -v8
v_fma_f32 v41, v41, s68, -v8
v_exp_f32 v40, v40
v_exp_f32 v41, v41
v_add_f32 v12, v12, v38
v_add_f32 v12, v12, v39
v_cvt_pk_bf16_f32 v35, v38, v39
v_fma_f32 v42, v42, s68, -v8
v_fma_f32 v43, v43, s68, -v8
v_exp_f32 v42, v42
v_exp_f32 v43, v43
v_add_f32 v12, v12, v40
v_add_f32 v12, v12, v41
v_cvt_pk_bf16_f32 v36, v40, v41
v_fma_f32 v44, v44, s68, -v8
v_fma_f32 v45, v45, s68, -v8
v_exp_f32 v44, v44
v_exp_f32 v45, v45
v_add_f32 v12, v12, v42
v_add_f32 v12, v12, v43
v_cvt_pk_bf16_f32 v37, v42, v43
s_cmp_eq_u32 s7, 1
s_cbranch_scc1 PC_TAILF
s_add_u32 s36, s35, 32768
s_add_u32 s37, s35, 16384
s_add_u32 s43, s37, s64
s_add_u32 s44, s37, s65
s_waitcnt vmcnt(7)
v_mfma_f32_32x32x16_bf16 v[64:79], a[128:131], a[0:3], 0
v_fma_f32 v46, v46, s68, -v8
v_fma_f32 v47, v47, s68, -v8
v_mfma_f32_32x32x16_bf16 v[80:95], a[128:131], a[64:67], 0
s_add_u32 s45, s36, 8192
buffer_load_dwordx4 a[128:131], v5, s[16:19], s45 offen sc1
v_exp_f32 v46, v46
v_exp_f32 v47, v47
s_waitcnt vmcnt(7)
v_mfma_f32_32x32x16_bf16 v[64:79], a[132:135], a[4:7], v[64:79]
v_add_f32 v12, v12, v44
v_add_f32 v12, v12, v45
v_mfma_f32_32x32x16_bf16 v[80:95], a[132:135], a[68:71], v[80:95]
buffer_load_dwordx4 a[132:135], v5, s[16:19], s45 offen offset:1024 sc1
v_cvt_pk_bf16_f32 v38, v44, v45
s_nop 0
v_add_f32 v12, v12, v46
s_waitcnt vmcnt(7)
v_mfma_f32_32x32x16_bf16 v[64:79], a[136:139], a[8:11], v[64:79]
v_add_f32 v12, v12, v47
v_cvt_pk_bf16_f32 v39, v46, v47
v_mfma_f32_32x32x16_bf16 v[80:95], a[136:139], a[72:75], v[80:95]
buffer_load_dwordx4 a[136:139], v5, s[16:19], s45 offen offset:2048 sc1
v_fma_f32 v48, v48, s68, -v9
v_fma_f32 v49, v49, s68, -v9
v_exp_f32 v48, v48
s_waitcnt vmcnt(7)
v_mfma_f32_32x32x16_bf16 v[64:79], a[140:143], a[12:15], v[64:79]
v_exp_f32 v49, v49
v_mfma_f32_32x32x16_bf16 v[80:95], a[140:143], a[76:79], v[80:95]
buffer_load_dwordx4 a[140:143], v5, s[16:19], s45 offen offset:3072 sc1
v_fma_f32 v50, v50, s68, -v9
v_fma_f32 v51, v51, s68, -v9
s_waitcnt vmcnt(7)
v_mfma_f32_32x32x16_bf16 v[64:79], a[144:147], a[16:19], v[64:79]
v_exp_f32 v50, v50
v_exp_f32 v51, v51
v_mfma_f32_32x32x16_bf16 v[80:95], a[144:147], a[80:83], v[80:95]
s_add_u32 s45, s36, 12288
buffer_load_dwordx4 a[144:147], v5, s[16:19], s45 offen sc1
v_add_f32 v13, v13, v48
v_add_f32 v13, v13, v49
s_waitcnt vmcnt(7)
v_mfma_f32_32x32x16_bf16 v[64:79], a[148:151], a[20:23], v[64:79]
v_cvt_pk_bf16_f32 v48, v48, v49
v_fma_f32 v52, v52, s68, -v9
v_fma_f32 v53, v53, s68, -v9
v_mfma_f32_32x32x16_bf16 v[80:95], a[148:151], a[84:87], v[80:95]
buffer_load_dwordx4 a[148:151], v5, s[16:19], s45 offen offset:1024 sc1
v_exp_f32 v52, v52
s_waitcnt vmcnt(7)
v_mfma_f32_32x32x16_bf16 v[64:79], a[152:155], a[24:27], v[64:79]
v_exp_f32 v53, v53
v_add_f32 v13, v13, v50
v_mfma_f32_32x32x16_bf16 v[80:95], a[152:155], a[88:91], v[80:95]
buffer_load_dwordx4 a[152:155], v5, s[16:19], s45 offen offset:2048 sc1
v_add_f32 v13, v13, v51
v_cvt_pk_bf16_f32 v49, v50, v51
v_fma_f32 v54, v54, s68, -v9
s_waitcnt vmcnt(7)
v_mfma_f32_32x32x16_bf16 v[64:79], a[156:159], a[28:31], v[64:79]
v_fma_f32 v55, v55, s68, -v9
v_exp_f32 v54, v54
v_mfma_f32_32x32x16_bf16 v[80:95], a[156:159], a[92:95], v[80:95]
buffer_load_dwordx4 a[156:159], v5, s[16:19], s45 offen offset:3072 sc1
v_exp_f32 v55, v55
s_waitcnt vmcnt(7)
v_mfma_f32_32x32x16_bf16 v[64:79], a[128:131], a[32:35], v[64:79]
v_add_f32 v13, v13, v52
v_add_f32 v13, v13, v53
v_cvt_pk_bf16_f32 v50, v52, v53
v_mfma_f32_32x32x16_bf16 v[80:95], a[128:131], a[96:99], v[80:95]
buffer_load_dwordx4 a[128:131], v5, s[16:19], s43 offen sc1
v_fma_f32 v56, v56, s68, -v9
v_fma_f32 v57, v57, s68, -v9
s_waitcnt vmcnt(7)
v_mfma_f32_32x32x16_bf16 v[64:79], a[132:135], a[36:39], v[64:79]
v_exp_f32 v56, v56
v_exp_f32 v57, v57
v_mfma_f32_32x32x16_bf16 v[80:95], a[132:135], a[100:103], v[80:95]
buffer_load_dwordx4 a[132:135], v5, s[16:19], s43 offen offset:1024 sc1
v_add_f32 v13, v13, v54
v_add_f32 v13, v13, v55
s_waitcnt vmcnt(7)
v_mfma_f32_32x32x16_bf16 v[64:79], a[136:139], a[40:43], v[64:79]
v_cvt_pk_bf16_f32 v51, v54, v55
v_fma_f32 v58, v58, s68, -v9
v_mfma_f32_32x32x16_bf16 v[80:95], a[136:139], a[104:107], v[80:95]
buffer_load_dwordx4 a[136:139], v5, s[16:19], s43 offen offset:2048 sc1
v_fma_f32 v59, v59, s68, -v9
v_exp_f32 v58, v58
s_waitcnt vmcnt(7)
v_mfma_f32_32x32x16_bf16 v[64:79], a[140:143], a[44:47], v[64:79]
v_exp_f32 v59, v59
v_add_f32 v13, v13, v56
v_mfma_f32_32x32x16_bf16 v[80:95], a[140:143], a[108:111], v[80:95]
buffer_load_dwordx4 a[140:143], v5, s[16:19], s43 offen offset:3072 sc1
v_add_f32 v13, v13, v57
v_cvt_pk_bf16_f32 v52, v56, v57
v_fma_f32 v60, v60, s68, -v9
s_waitcnt vmcnt(7)
v_mfma_f32_32x32x16_bf16 v[64:79], a[144:147], a[48:51], v[64:79]
v_fma_f32 v61, v61, s68, -v9
v_exp_f32 v60, v60
v_mfma_f32_32x32x16_bf16 v[80:95], a[144:147], a[112:115], v[80:95]
buffer_load_dwordx4 a[144:147], v5, s[16:19], s44 offen sc1
v_exp_f32 v61, v61
s_waitcnt vmcnt(7)
v_mfma_f32_32x32x16_bf16 v[64:79], a[148:151], a[52:55], v[64:79]
v_add_f32 v13, v13, v58
v_add_f32 v13, v13, v59
v_cvt_pk_bf16_f32 v53, v58, v59
v_mfma_f32_32x32x16_bf16 v[80:95], a[148:151], a[116:119], v[80:95]
buffer_load_dwordx4 a[148:151], v5, s[16:19], s44 offen offset:1024 sc1
v_fma_f32 v62, v62, s68, -v9
v_fma_f32 v63, v63, s68, -v9
s_waitcnt vmcnt(7)
v_mfma_f32_32x32x16_bf16 v[64:79], a[152:155], a[56:59], v[64:79]
v_exp_f32 v62, v62
v_mfma_f32_32x32x16_bf16 v[80:95], a[152:155], a[120:123], v[80:95]
buffer_load_dwordx4 a[152:155], v5, s[16:19], s44 offen offset:2048 sc1
v_exp_f32 v63, v63
v_add_f32 v13, v13, v60
v_add_f32 v13, v13, v61
s_waitcnt vmcnt(7)
v_mfma_f32_32x32x16_bf16 v[64:79], a[156:159], a[60:63], v[64:79]
v_cvt_pk_bf16_f32 v54, v60, v61
s_nop 0
v_mfma_f32_32x32x16_bf16 v[80:95], a[156:159], a[124:127], v[80:95]
buffer_load_dwordx4 a[156:159], v5, s[16:19], s44 offen offset:3072 sc1
v_add_f32 v13, v13, v62
v_add_f32 v13, v13, v63
v_cvt_pk_bf16_f32 v55, v62, v63
s_add_u32 s43, s35, 65536
s_add_u32 s44, s35, 69632
s_add_u32 s45, s35, 49152
s_add_u32 s38, s45, s64
s_add_u32 s39, s45, s65
s_cmp_gt_u32 s7, 2
s_cselect_b32 s43, s43, s38
s_cselect_b32 s44, s44, s39
s_waitcnt vmcnt(7)
v_mfma_f32_32x32x16_bf16 v[128:143], a[128:131], v[32:35], 0
v_mfma_f32_32x32x16_bf16 v[144:159], a[128:131], v[48:51], 0
s_add_u32 s45, s37, s66
buffer_load_dwordx4 a[128:131], v5, s[16:19], s45 offen sc1
s_waitcnt vmcnt(7)
v_mfma_f32_32x32x16_bf16 v[128:143], a[132:135], v[36:39], v[128:143]
s_cmp_ge_u32 s40, s41
s_cbranch_scc1 PC_MASK_BF
PC_MASKRET_BF:
v_mfma_f32_32x32x16_bf16 v[144:159], a[132:135], v[52:55], v[144:159]
buffer_load_dwordx4 a[132:135], v5, s[16:19], s45 offen offset:1024 sc1
v_max3_f32 v16, v64, v65, v66
v_max3_f32 v16, v16, v67, v68
v_max3_f32 v16, v16, v69, v70
s_waitcnt vmcnt(7)
v_mfma_f32_32x32x16_bf16 v[160:175], a[136:139], v[32:35], 0
v_max3_f32 v16, v16, v71, v72
v_max3_f32 v16, v16, v73, v74
v_mfma_f32_32x32x16_bf16 v[176:191], a[136:139], v[48:51], 0
buffer_load_dwordx4 a[136:139], v5, s[16:19], s45 offen offset:2048 sc1
v_max3_f32 v16, v16, v75, v76
v_max3_f32 v16, v16, v77, v78
v_max_f32 v16, v16, v79
s_waitcnt vmcnt(7)
v_mfma_f32_32x32x16_bf16 v[160:175], a[140:143], v[36:39], v[160:175]
v_max3_f32 v17, v80, v81, v82
v_max3_f32 v17, v17, v83, v84
v_max3_f32 v17, v17, v85, v86
v_mfma_f32_32x32x16_bf16 v[176:191], a[140:143], v[52:55], v[176:191]
buffer_load_dwordx4 a[140:143], v5, s[16:19], s45 offen offset:3072 sc1
v_max3_f32 v17, v17, v87, v88
v_max3_f32 v17, v17, v89, v90
v_max3_f32 v17, v17, v91, v92
s_waitcnt vmcnt(7)
v_mfma_f32_32x32x16_bf16 v[192:207], a[144:147], v[32:35], 0
v_max3_f32 v17, v17, v93, v94
v_max_f32 v17, v17, v95
v_mfma_f32_32x32x16_bf16 v[208:223], a[144:147], v[48:51], 0
s_add_u32 s45, s37, s67
buffer_load_dwordx4 a[144:147], v5, s[16:19], s45 offen sc1
v_cmp_gt_f32 vcc, v16, v10
v_cmp_gt_f32 s[50:51], v17, v11
s_or_b64 s[50:51], vcc, s[50:51]
s_cbranch_scc1 PC_RARE_BF
PC_RARERET_BF:
s_waitcnt vmcnt(7)
v_mfma_f32_32x32x16_bf16 v[192:207], a[148:151], v[36:39], v[192:207]
s_add_u32 s40, s40, 1
v_fma_f32 v64, v64, s68, -v8
v_fma_f32 v65, v65, s68, -v8
v_mfma_f32_32x32x16_bf16 v[208:223], a[148:151], v[52:55], v[208:223]
buffer_load_dwordx4 a[148:151], v5, s[16:19], s45 offen offset:1024 sc1
v_exp_f32 v64, v64
s_waitcnt vmcnt(7)
v_mfma_f32_32x32x16_bf16 v[224:239], a[152:155], v[32:35], 0
v_exp_f32 v65, v65
v_fma_f32 v66, v66, s68, -v8
v_mfma_f32_32x32x16_bf16 v[240:255], a[152:155], v[48:51], 0
buffer_load_dwordx4 a[152:155], v5, s[16:19], s45 offen offset:2048 sc1
v_fma_f32 v67, v67, s68, -v8
v_exp_f32 v66, v66
s_waitcnt vmcnt(7)
v_mfma_f32_32x32x16_bf16 v[224:239], a[156:159], v[36:39], v[224:239]
v_exp_f32 v67, v67
v_add_f32 v12, v12, v64
v_mfma_f32_32x32x16_bf16 v[240:255], a[156:159], v[52:55], v[240:255]
buffer_load_dwordx4 a[156:159], v5, s[16:19], s45 offen offset:3072 sc1
v_add_f32 v12, v12, v65
v_cvt_pk_bf16_f32 v64, v64, v65
v_fma_f32 v68, v68, s68, -v8
s_waitcnt vmcnt(7)
v_mfma_f32_32x32x16_bf16 v[96:111], a[128:131], v[32:35], 0
v_fma_f32 v69, v69, s68, -v8
v_exp_f32 v68, v68
v_mfma_f32_32x32x16_bf16 v[112:127], a[128:131], v[48:51], 0
buffer_load_dwordx4 a[128:131], v5, s[16:19], s43 offen sc1
v_exp_f32 v69, v69
s_waitcnt vmcnt(7)
v_mfma_f32_32x32x16_bf16 v[96:111], a[132:135], v[36:39], v[96:111]
v_add_f32 v12, v12, v66
v_add_f32 v12, v12, v67
v_cvt_pk_bf16_f32 v65, v66, v67
v_mfma_f32_32x32x16_bf16 v[112:127], a[132:135], v[52:55], v[112:127]
buffer_load_dwordx4 a[132:135], v5, s[16:19], s43 offen offset:1024 sc1
v_fma_f32 v70, v70, s68, -v8
v_fma_f32 v71, v71, s68, -v8
s_waitcnt vmcnt(7)
v_mfma_f32_32x32x16_bf16 a[160:175], a[136:139], v[32:35], 0
v_exp_f32 v70, v70
v_exp_f32 v71, v71
v_mfma_f32_32x32x16_bf16 a[176:191], a[136:139], v[48:51], 0
buffer_load_dwordx4 a[136:139], v5, s[16:19], s43 offen offset:2048 sc1
v_add_f32 v12, v12, v68
v_add_f32 v12, v12, v69
s_waitcnt vmcnt(7)
v_mfma_f32_32x32x16_bf16 a[160:175], a[140:143], v[36:39], a[160:175]
v_cvt_pk_bf16_f32 v66, v68, v69
v_fma_f32 v72, v72, s68, -v8
v_fma_f32 v73, v73, s68, -v8
v_mfma_f32_32x32x16_bf16 a[176:191], a[140:143], v[52:55], a[176:191]
buffer_load_dwordx4 a[140:143], v5, s[16:19], s43 offen offset:3072 sc1
v_exp_f32 v72, v72
s_waitcnt vmcnt(7)
v_mfma_f32_32x32x16_bf16 a[192:207], a[144:147], v[32:35], 0
v_exp_f32 v73, v73
v_add_f32 v12, v12, v70
v_add_f32 v12, v12, v71
v_mfma_f32_32x32x16_bf16 a[208:223], a[144:147], v[48:51], 0
buffer_load_dwordx4 a[144:147], v5, s[16:19], s44 offen sc1
v_cvt_pk_bf16_f32 v67, v70, v71
v_fma_f32 v74, v74, s68, -v8
s_waitcnt vmcnt(7)
v_mfma_f32_32x32x16_bf16 a[192:207], a[148:151], v[36:39], a[192:207]
v_fma_f32 v75, v75, s68, -v8
v_exp_f32 v74, v74
v_mfma_f32_32x32x16_bf16 a[208:223], a[148:151], v[52:55], a[208:223]
buffer_load_dwordx4 a[148:151], v5, s[16:19], s44 offen offset:1024 sc1
v_exp_f32 v75, v75
v_add_f32 v12, v12, v72
s_waitcnt vmcnt(7)
v_mfma_f32_32x32x16_bf16 a[224:239], a[152:155], v[32:35], 0
v_add_f32 v12, v12, v73
v_cvt_pk_bf16_f32 v68, v72, v73
v_fma_f32 v76, v76, s68, -v8
v_mfma_f32_32x32x16_bf16 a[240:255], a[152:155], v[48:51], 0
buffer_load_dwordx4 a[152:155], v5, s[16:19], s44 offen offset:2048 sc1
v_fma_f32 v77, v77, s68, -v8
v_exp_f32 v76, v76
s_waitcnt vmcnt(7)
v_mfma_f32_32x32x16_bf16 a[224:239], a[156:159], v[36:39], a[224:239]
v_exp_f32 v77, v77
v_mfma_f32_32x32x16_bf16 a[240:255], a[156:159], v[52:55], a[240:255]
buffer_load_dwordx4 a[156:159], v5, s[16:19], s44 offen offset:3072 sc1
v_add_f32 v12, v12, v74
v_add_f32 v12, v12, v75
v_cvt_pk_bf16_f32 v69, v74, v75
s_cmp_lg_u32 s42, 0
s_cbranch_scc1 PC_PEND_BF
PC_PENDRET_BF:
s_add_u32 s35, s35, 32768
s_sub_u32 s7, s7, 1
s_cmp_eq_u32 s7, 1
s_cbranch_scc1 PC_TAIL1
s_branch PC_LOOPB
PC_LOOP:
s_add_u32 s36, s35, 32768
s_add_u32 s37, s35, 16384
s_add_u32 s43, s37, s64
s_add_u32 s44, s37, s65
s_waitcnt vmcnt(7)
v_mfma_f32_32x32x16_bf16 v[64:79], a[128:131], a[0:3], 0
v_fma_f32 v46, v46, s68, -v8
v_fma_f32 v47, v47, s68, -v8
v_mfma_f32_32x32x16_bf16 v[80:95], a[128:131], a[64:67], 0
s_add_u32 s45, s36, 8192
buffer_load_dwordx4 a[128:131], v5, s[16:19], s45 offen sc1
v_exp_f32 v46, v46
v_exp_f32 v47, v47
s_waitcnt vmcnt(7)
v_mfma_f32_32x32x16_bf16 v[64:79], a[132:135], a[4:7], v[64:79]
v_add_f32 v12, v12, v44
v_add_f32 v12, v12, v45
v_mfma_f32_32x32x16_bf16 v[80:95], a[132:135], a[68:71], v[80:95]
buffer_load_dwordx4 a[132:135], v5, s[16:19], s45 offen offset:1024 sc1
v_cvt_pk_bf16_f32 v38, v44, v45
s_nop 0
v_add_f32 v12, v12, v46
s_waitcnt vmcnt(7)
v_mfma_f32_32x32x16_bf16 v[64:79], a[136:139], a[8:11], v[64:79]
v_add_f32 v12, v12, v47
v_cvt_pk_bf16_f32 v39, v46, v47
v_mfma_f32_32x32x16_bf16 v[80:95], a[136:139], a[72:75], v[80:95]
buffer_load_dwordx4 a[136:139], v5, s[16:19], s45 offen offset:2048 sc1
v_fma_f32 v48, v48, s68, -v9
v_fma_f32 v49, v49, s68, -v9
v_exp_f32 v48, v48
s_waitcnt vmcnt(7)
v_mfma_f32_32x32x16_bf16 v[64:79], a[140:143], a[12:15], v[64:79]
v_exp_f32 v49, v49
v_mfma_f32_32x32x16_bf16 v[80:95], a[140:143], a[76:79], v[80:95]
buffer_load_dwordx4 a[140:143], v5, s[16:19], s45 offen offset:3072 sc1
v_fma_f32 v50, v50, s68, -v9
v_fma_f32 v51, v51, s68, -v9
s_waitcnt vmcnt(7)
v_mfma_f32_32x32x16_bf16 v[64:79], a[144:147], a[16:19], v[64:79]
v_exp_f32 v50, v50
v_exp_f32 v51, v51
v_mfma_f32_32x32x16_bf16 v[80:95], a[144:147], a[80:83], v[80:95]
s_add_u32 s45, s36, 12288
buffer_load_dwordx4 a[144:147], v5, s[16:19], s45 offen sc1
v_add_f32 v13, v13, v48
v_add_f32 v13, v13, v49
s_waitcnt vmcnt(7)
v_mfma_f32_32x32x16_bf16 v[64:79], a[148:151], a[20:23], v[64:79]
v_cvt_pk_bf16_f32 v48, v48, v49
v_fma_f32 v52, v52, s68, -v9
v_fma_f32 v53, v53, s68, -v9
v_mfma_f32_32x32x16_bf16 v[80:95], a[148:151], a[84:87], v[80:95]
buffer_load_dwordx4 a[148:151], v5, s[16:19], s45 offen offset:1024 sc1
v_exp_f32 v52, v52
s_waitcnt vmcnt(7)
v_mfma_f32_32x32x16_bf16 v[64:79], a[152:155], a[24:27], v[64:79]
v_exp_f32 v53, v53
v_add_f32 v13, v13, v50
v_mfma_f32_32x32x16_bf16 v[80:95], a[152:155], a[88:91], v[80:95]
buffer_load_dwordx4 a[152:155], v5, s[16:19], s45 offen offset:2048 sc1
v_add_f32 v13, v13, v51
v_cvt_pk_bf16_f32 v49, v50, v51
v_fma_f32 v54, v54, s68, -v9
s_waitcnt vmcnt(7)
v_mfma_f32_32x32x16_bf16 v[64:79], a[156:159], a[28:31], v[64:79]
v_fma_f32 v55, v55, s68, -v9
v_exp_f32 v54, v54
v_mfma_f32_32x32x16_bf16 v[80:95], a[156:159], a[92:95], v[80:95]
buffer_load_dwordx4 a[156:159], v5, s[16:19], s45 offen offset:3072 sc1
v_exp_f32 v55, v55
s_waitcnt vmcnt(7)
v_mfma_f32_32x32x16_bf16 v[64:79], a[128:131], a[32:35], v[64:79]
v_add_f32 v13, v13, v52
v_add_f32 v13, v13, v53
v_cvt_pk_bf16_f32 v50, v52, v53
v_mfma_f32_32x32x16_bf16 v[80:95], a[128:131], a[96:99], v[80:95]
buffer_load_dwordx4 a[128:131], v5, s[16:19], s43 offen sc1
v_fma_f32 v56, v56, s68, -v9
v_fma_f32 v57, v57, s68, -v9
s_waitcnt vmcnt(7)
v_mfma_f32_32x32x16_bf16 v[64:79], a[132:135], a[36:39], v[64:79]
v_exp_f32 v56, v56
v_exp_f32 v57, v57
v_mfma_f32_32x32x16_bf16 v[80:95], a[132:135], a[100:103], v[80:95]
buffer_load_dwordx4 a[132:135], v5, s[16:19], s43 offen offset:1024 sc1
v_add_f32 v13, v13, v54
v_add_f32 v13, v13, v55
s_waitcnt vmcnt(7)
v_mfma_f32_32x32x16_bf16 v[64:79], a[136:139], a[40:43], v[64:79]
v_cvt_pk_bf16_f32 v51, v54, v55
v_fma_f32 v58, v58, s68, -v9
v_mfma_f32_32x32x16_bf16 v[80:95], a[136:139], a[104:107], v[80:95]
buffer_load_dwordx4 a[136:139], v5, s[16:19], s43 offen offset:2048 sc1
v_fma_f32 v59, v59, s68, -v9
v_exp_f32 v58, v58
s_waitcnt vmcnt(7)
v_mfma_f32_32x32x16_bf16 v[64:79], a[140:143], a[44:47], v[64:79]
v_exp_f32 v59, v59
v_add_f32 v13, v13, v56
v_mfma_f32_32x32x16_bf16 v[80:95], a[140:143], a[108:111], v[80:95]
buffer_load_dwordx4 a[140:143], v5, s[16:19], s43 offen offset:3072 sc1
v_add_f32 v13, v13, v57
v_cvt_pk_bf16_f32 v52, v56, v57
v_fma_f32 v60, v60, s68, -v9
s_waitcnt vmcnt(7)
v_mfma_f32_32x32x16_bf16 v[64:79], a[144:147], a[48:51], v[64:79]
v_fma_f32 v61, v61, s68, -v9
v_exp_f32 v60, v60
v_mfma_f32_32x32x16_bf16 v[80:95], a[144:147], a[112:115], v[80:95]
buffer_load_dwordx4 a[144:147], v5, s[16:19], s44 offen sc1
v_exp_f32 v61, v61
s_waitcnt vmcnt(7)
v_mfma_f32_32x32x16_bf16 v[64:79], a[148:151], a[52:55], v[64:79]
v_add_f32 v13, v13, v58
v_add_f32 v13, v13, v59
v_cvt_pk_bf16_f32 v53, v58, v59
v_mfma_f32_32x32x16_bf16 v[80:95], a[148:151], a[116:119], v[80:95]
buffer_load_dwordx4 a[148:151], v5, s[16:19], s44 offen offset:1024 sc1
v_fma_f32 v62, v62, s68, -v9
v_fma_f32 v63, v63, s68, -v9
s_waitcnt vmcnt(7)
v_mfma_f32_32x32x16_bf16 v[64:79], a[152:155], a[56:59], v[64:79]
v_exp_f32 v62, v62
v_mfma_f32_32x32x16_bf16 v[80:95], a[152:155], a[120:123], v[80:95]
buffer_load_dwordx4 a[152:155], v5, s[16:19], s44 offen offset:2048 sc1
v_exp_f32 v63, v63
v_add_f32 v13, v13, v60
v_add_f32 v13, v13, v61
s_waitcnt vmcnt(7)
v_mfma_f32_32x32x16_bf16 v[64:79], a[156:159], a[60:63], v[64:79]
v_cvt_pk_bf16_f32 v54, v60, v61
s_nop 0
v_mfma_f32_32x32x16_bf16 v[80:95], a[156:159], a[124:127], v[80:95]
buffer_load_dwordx4 a[156:159], v5, s[16:19], s44 offen offset:3072 sc1
v_add_f32 v13, v13, v62
v_add_f32 v13, v13, v63
v_cvt_pk_bf16_f32 v55, v62, v63
s_add_u32 s43, s35, 65536
s_add_u32 s44, s35, 69632
s_add_u32 s45, s35, 49152
s_add_u32 s38, s45, s64
s_add_u32 s39, s45, s65
s_cmp_gt_u32 s7, 2
s_cselect_b32 s43, s43, s38
s_cselect_b32 s44, s44, s39
s_waitcnt vmcnt(7)
v_mfma_f32_32x32x16_bf16 v[128:143], a[128:131], v[32:35], v[128:143]
v_mfma_f32_32x32x16_bf16 v[144:159], a[128:131], v[48:51], v[144:159]
s_add_u32 s45, s37, s66
buffer_load_dwordx4 a[128:131], v5, s[16:19], s45 offen sc1
s_waitcnt vmcnt(7)
v_mfma_f32_32x32x16_bf16 v[128:143], a[132:135], v[36:39], v[128:143]
s_cmp_ge_u32 s40, s41
s_cbranch_scc1 PC_MASK_B0
PC_MASKRET_B0:
v_mfma_f32_32x32x16_bf16 v[144:159], a[132:135], v[52:55], v[144:159]
buffer_load_dwordx4 a[132:135], v5, s[16:19], s45 offen offset:1024 sc1
v_max3_f32 v16, v64, v65, v66
v_max3_f32 v16, v16, v67, v68
v_max3_f32 v16, v16, v69, v70
s_waitcnt vmcnt(7)
v_mfma_f32_32x32x16_bf16 v[160:175], a[136:139], v[32:35], v[160:175]
v_max3_f32 v16, v16, v71, v72
v_max3_f32 v16, v16, v73, v74
v_mfma_f32_32x32x16_bf16 v[176:191], a[136:139], v[48:51], v[176:191]
buffer_load_dwordx4 a[136:139], v5, s[16:19], s45 offen offset:2048 sc1
v_max3_f32 v16, v16, v75, v76
v_max3_f32 v16, v16, v77, v78
v_max_f32 v16, v16, v79
s_waitcnt vmcnt(7)
v_mfma_f32_32x32x16_bf16 v[160:175], a[140:143], v[36:39], v[160:175]
v_max3_f32 v17, v80, v81, v82
v_max3_f32 v17, v17, v83, v84
v_max3_f32 v17, v17, v85, v86
v_mfma_f32_32x32x16_bf16 v[176:191], a[140:143], v[52:55], v[176:191]
buffer_load_dwordx4 a[140:143], v5, s[16:19], s45 offen offset:3072 sc1
v_max3_f32 v17, v17, v87, v88
v_max3_f32 v17, v17, v89, v90
v_max3_f32 v17, v17, v91, v92
s_waitcnt vmcnt(7)
v_mfma_f32_32x32x16_bf16 v[192:207], a[144:147], v[32:35], v[192:207]
v_max3_f32 v17, v17, v93, v94
v_max_f32 v17, v17, v95
v_mfma_f32_32x32x16_bf16 v[208:223], a[144:147], v[48:51], v[208:223]
s_add_u32 s45, s37, s67
buffer_load_dwordx4 a[144:147], v5, s[16:19], s45 offen sc1
v_cmp_gt_f32 vcc, v16, v10
v_cmp_gt_f32 s[50:51], v17, v11
s_or_b64 s[50:51], vcc, s[50:51]
s_cbranch_scc1 PC_RARE_B0
PC_RARERET_B0:
s_waitcnt vmcnt(7)
v_mfma_f32_32x32x16_bf16 v[192:207], a[148:151], v[36:39], v[192:207]
s_add_u32 s40, s40, 1
v_fma_f32 v64, v64, s68, -v8
v_fma_f32 v65, v65, s68, -v8
v_mfma_f32_32x32x16_bf16 v[208:223], a[148:151], v[52:55], v[208:223]
buffer_load_dwordx4 a[148:151], v5, s[16:19], s45 offen offset:1024 sc1
v_exp_f32 v64, v64
s_waitcnt vmcnt(7)
v_mfma_f32_32x32x16_bf16 v[224:239], a[152:155], v[32:35], v[224:239]
v_exp_f32 v65, v65
v_fma_f32 v66, v66, s68, -v8
v_mfma_f32_32x32x16_bf16 v[240:255], a[152:155], v[48:51], v[240:255]
buffer_load_dwordx4 a[152:155], v5, s[16:19], s45 offen offset:2048 sc1
v_fma_f32 v67, v67, s68, -v8
v_exp_f32 v66, v66
s_waitcnt vmcnt(7)
v_mfma_f32_32x32x16_bf16 v[224:239], a[156:159], v[36:39], v[224:239]
v_exp_f32 v67, v67
v_add_f32 v12, v12, v64
v_mfma_f32_32x32x16_bf16 v[240:255], a[156:159], v[52:55], v[240:255]
buffer_load_dwordx4 a[156:159], v5, s[16:19], s45 offen offset:3072 sc1
v_add_f32 v12, v12, v65
v_cvt_pk_bf16_f32 v64, v64, v65
v_fma_f32 v68, v68, s68, -v8
s_waitcnt vmcnt(7)
v_mfma_f32_32x32x16_bf16 v[96:111], a[128:131], v[32:35], v[96:111]
v_fma_f32 v69, v69, s68, -v8
v_exp_f32 v68, v68
v_mfma_f32_32x32x16_bf16 v[112:127], a[128:131], v[48:51], v[112:127]
buffer_load_dwordx4 a[128:131], v5, s[16:19], s43 offen sc1
v_exp_f32 v69, v69
s_waitcnt vmcnt(7)
v_mfma_f32_32x32x16_bf16 v[96:111], a[132:135], v[36:39], v[96:111]
v_add_f32 v12, v12, v66
v_add_f32 v12, v12, v67
v_cvt_pk_bf16_f32 v65, v66, v67
v_mfma_f32_32x32x16_bf16 v[112:127], a[132:135], v[52:55], v[112:127]
buffer_load_dwordx4 a[132:135], v5, s[16:19], s43 offen offset:1024 sc1
v_fma_f32 v70, v70, s68, -v8
v_fma_f32 v71, v71, s68, -v8
s_waitcnt vmcnt(7)
v_mfma_f32_32x32x16_bf16 a[160:175], a[136:139], v[32:35], a[160:175]
v_exp_f32 v70, v70
v_exp_f32 v71, v71
v_mfma_f32_32x32x16_bf16 a[176:191], a[136:139], v[48:51], a[176:191]
buffer_load_dwordx4 a[136:139], v5, s[16:19], s43 offen offset:2048 sc1
v_add_f32 v12, v12, v68
v_add_f32 v12, v12, v69
s_waitcnt vmcnt(7)
v_mfma_f32_32x32x16_bf16 a[160:175], a[140:143], v[36:39], a[160:175]
v_cvt_pk_bf16_f32 v66, v68, v69
v_fma_f32 v72, v72, s68, -v8
v_fma_f32 v73, v73, s68, -v8
v_mfma_f32_32x32x16_bf16 a[176:191], a[140:143], v[52:55], a[176:191]
buffer_load_dwordx4 a[140:143], v5, s[16:19], s43 offen offset:3072 sc1
v_exp_f32 v72, v72
s_waitcnt vmcnt(7)
v_mfma_f32_32x32x16_bf16 a[192:207], a[144:147], v[32:35], a[192:207]
v_exp_f32 v73, v73
v_add_f32 v12, v12, v70
v_add_f32 v12, v12, v71
v_mfma_f32_32x32x16_bf16 a[208:223], a[144:147], v[48:51], a[208:223]
buffer_load_dwordx4 a[144:147], v5, s[16:19], s44 offen sc1
v_cvt_pk_bf16_f32 v67, v70, v71
v_fma_f32 v74, v74, s68, -v8
s_waitcnt vmcnt(7)
v_mfma_f32_32x32x16_bf16 a[192:207], a[148:151], v[36:39], a[192:207]
v_fma_f32 v75, v75, s68, -v8
v_exp_f32 v74, v74
v_mfma_f32_32x32x16_bf16 a[208:223], a[148:151], v[52:55], a[208:223]
buffer_load_dwordx4 a[148:151], v5, s[16:19], s44 offen offset:1024 sc1
v_exp_f32 v75, v75
v_add_f32 v12, v12, v72
s_waitcnt vmcnt(7)
v_mfma_f32_32x32x16_bf16 a[224:239], a[152:155], v[32:35], a[224:239]
v_add_f32 v12, v12, v73
v_cvt_pk_bf16_f32 v68, v72, v73
v_fma_f32 v76, v76, s68, -v8
v_mfma_f32_32x32x16_bf16 a[240:255], a[152:155], v[48:51], a[240:255]
buffer_load_dwordx4 a[152:155], v5, s[16:19], s44 offen offset:2048 sc1
v_fma_f32 v77, v77, s68, -v8
v_exp_f32 v76, v76
s_waitcnt vmcnt(7)
v_mfma_f32_32x32x16_bf16 a[224:239], a[156:159], v[36:39], a[224:239]
v_exp_f32 v77, v77
v_mfma_f32_32x32x16_bf16 a[240:255], a[156:159], v[52:55], a[240:255]
buffer_load_dwordx4 a[156:159], v5, s[16:19], s44 offen offset:3072 sc1
v_add_f32 v12, v12, v74
v_add_f32 v12, v12, v75
v_cvt_pk_bf16_f32 v69, v74, v75
s_cmp_lg_u32 s42, 0
s_cbranch_scc1 PC_PEND_B0
PC_PENDRET_B0:
s_add_u32 s35, s35, 32768
s_sub_u32 s7, s7, 1
s_cmp_eq_u32 s7, 1
s_cbranch_scc1 PC_TAIL1
PC_LOOPB:
s_add_u32 s36, s35, 32768
s_add_u32 s37, s35, 16384
s_add_u32 s43, s37, s64
s_add_u32 s44, s37, s65
s_waitcnt vmcnt(7)
v_mfma_f32_32x32x16_bf16 v[32:47], a[128:131], a[0:3], 0
v_fma_f32 v78, v78, s68, -v8
v_fma_f32 v79, v79, s68, -v8
v_mfma_f32_32x32x16_bf16 v[48:63], a[128:131], a[64:67], 0
s_add_u32 s45, s36, 8192
buffer_load_dwordx4 a[128:131], v5, s[16:19], s45 offen sc1
v_exp_f32 v78, v78
v_exp_f32 v79, v79
s_waitcnt vmcnt(7)
v_mfma_f32_32x32x16_bf16 v[32:47], a[132:135], a[4:7], v[32:47]
v_add_f32 v12, v12, v76
v_add_f32 v12, v12, v77
v_mfma_f32_32x32x16_bf16 v[48:63], a[132:135], a[68:71], v[48:63]
buffer_load_dwordx4 a[132:135], v5, s[16:19], s45 offen offset:1024 sc1
v_cvt_pk_bf16_f32 v70, v76, v77
s_nop 0
v_add_f32 v12, v12, v78
s_waitcnt vmcnt(7)
v_mfma_f32_32x32x16_bf16 v[32:47], a[136:139], a[8:11], v[32:47]
v_add_f32 v12, v12, v79
v_cvt_pk_bf16_f32 v71, v78, v79
v_mfma_f32_32x32x16_bf16 v[48:63], a[136:139], a[72:75], v[48:63]
buffer_load_dwordx4 a[136:139], v5, s[16:19], s45 offen offset:2048 sc1
v_fma_f32 v80, v80, s68, -v9
v_fma_f32 v81, v81, s68, -v9
v_exp_f32 v80, v80
s_waitcnt vmcnt(7)
v_mfma_f32_32x32x16_bf16 v[32:47], a[140:143], a[12:15], v[32:47]
v_exp_f32 v81, v81
v_mfma_f32_32x32x16_bf16 v[48:63], a[140:143], a[76:79], v[48:63]
buffer_load_dwordx4 a[140:143], v5, s[16:19], s45 offen offset:3072 sc1
v_fma_f32 v82, v82, s68, -v9
v_fma_f32 v83, v83, s68, -v9
s_waitcnt vmcnt(7)
v_mfma_f32_32x32x16_bf16 v[32:47], a[144:147], a[16:19], v[32:47]
v_exp_f32 v82, v82
v_exp_f32 v83, v83
v_mfma_f32_32x32x16_bf16 v[48:63], a[144:147], a[80:83], v[48:63]
s_add_u32 s45, s36, 12288
buffer_load_dwordx4 a[144:147], v5, s[16:19], s45 offen sc1
v_add_f32 v13, v13, v80
v_add_f32 v13, v13, v81
s_waitcnt vmcnt(7)
v_mfma_f32_32x32x16_bf16 v[32:47], a[148:151], a[20:23], v[32:47]
v_cvt_pk_bf16_f32 v80, v80, v81
v_fma_f32 v84, v84, s68, -v9
v_fma_f32 v85, v85, s68, -v9
v_mfma_f32_32x32x16_bf16 v[48:63], a[148:151], a[84:87], v[48:63]
buffer_load_dwordx4 a[148:151], v5, s[16:19], s45 offen offset:1024 sc1
v_exp_f32 v84, v84
s_waitcnt vmcnt(7)
v_mfma_f32_32x32x16_bf16 v[32:47], a[152:155], a[24:27], v[32:47]
v_exp_f32 v85, v85
v_add_f32 v13, v13, v82
v_mfma_f32_32x32x16_bf16 v[48:63], a[152:155], a[88:91], v[48:63]
buffer_load_dwordx4 a[152:155], v5, s[16:19], s45 offen offset:2048 sc1
v_add_f32 v13, v13, v83
v_cvt_pk_bf16_f32 v81, v82, v83
v_fma_f32 v86, v86, s68, -v9
s_waitcnt vmcnt(7)
v_mfma_f32_32x32x16_bf16 v[32:47], a[156:159], a[28:31], v[32:47]
v_fma_f32 v87, v87, s68, -v9
v_exp_f32 v86, v86
v_mfma_f32_32x32x16_bf16 v[48:63], a[156:159], a[92:95], v[48:63]
buffer_load_dwordx4 a[156:159], v5, s[16:19], s45 offen offset:3072 sc1
v_exp_f32 v87, v87
s_waitcnt vmcnt(7)
v_mfma_f32_32x32x16_bf16 v[32:47], a[128:131], a[32:35], v[32:47]
v_add_f32 v13, v13, v84
v_add_f32 v13, v13, v85
v_cvt_pk_bf16_f32 v82, v84, v85
v_mfma_f32_32x32x16_bf16 v[48:63], a[128:131], a[96:99], v[48:63]
buffer_load_dwordx4 a[128:131], v5, s[16:19], s43 offen sc1
v_fma_f32 v88, v88, s68, -v9
v_fma_f32 v89, v89, s68, -v9
s_waitcnt vmcnt(7)
v_mfma_f32_32x32x16_bf16 v[32:47], a[132:135], a[36:39], v[32:47]
v_exp_f32 v88, v88
v_exp_f32 v89, v89
v_mfma_f32_32x32x16_bf16 v[48:63], a[132:135], a[100:103], v[48:63]
buffer_load_dwordx4 a[132:135], v5, s[16:19], s43 offen offset:1024 sc1
v_add_f32 v13, v13, v86
v_add_f32 v13, v13, v87
s_waitcnt vmcnt(7)
v_mfma_f32_32x32x16_bf16 v[32:47], a[136:139], a[40:43], v[32:47]
v_cvt_pk_bf16_f32 v83, v86, v87
v_fma_f32 v90, v90, s68, -v9
v_mfma_f32_32x32x16_bf16 v[48:63], a[136:139], a[104:107], v[48:63]
buffer_load_dwordx4 a[136:139], v5, s[16:19], s43 offen offset:2048 sc1
v_fma_f32 v91, v91, s68, -v9
v_exp_f32 v90, v90
s_waitcnt vmcnt(7)
v_mfma_f32_32x32x16_bf16 v[32:47], a[140:143], a[44:47], v[32:47]
v_exp_f32 v91, v91
v_add_f32 v13, v13, v88
v_mfma_f32_32x32x16_bf16 v[48:63], a[140:143], a[108:111], v[48:63]
buffer_load_dwordx4 a[140:143], v5, s[16:19], s43 offen offset:3072 sc1
v_add_f32 v13, v13, v89
v_cvt_pk_bf16_f32 v84, v88, v89
v_fma_f32 v92, v92, s68, -v9
s_waitcnt vmcnt(7)
v_mfma_f32_32x32x16_bf16 v[32:47], a[144:147], a[48:51], v[32:47]
v_fma_f32 v93, v93, s68, -v9
v_exp_f32 v92, v92
v_mfma_f32_32x32x16_bf16 v[48:63], a[144:147], a[112:115], v[48:63]
buffer_load_dwordx4 a[144:147], v5, s[16:19], s44 offen sc1
v_exp_f32 v93, v93
s_waitcnt vmcnt(7)
v_mfma_f32_32x32x16_bf16 v[32:47], a[148:151], a[52:55], v[32:47]
v_add_f32 v13, v13, v90
v_add_f32 v13, v13, v91
v_cvt_pk_bf16_f32 v85, v90, v91
v_mfma_f32_32x32x16_bf16 v[48:63], a[148:151], a[116:119], v[48:63]
buffer_load_dwordx4 a[148:151], v5, s[16:19], s44 offen offset:1024 sc1
v_fma_f32 v94, v94, s68, -v9
v_fma_f32 v95, v95, s68, -v9
s_waitcnt vmcnt(7)
v_mfma_f32_32x32x16_bf16 v[32:47], a[152:155], a[56:59], v[32:47]
v_exp_f32 v94, v94
v_mfma_f32_32x32x16_bf16 v[48:63], a[152:155], a[120:123], v[48:63]
buffer_load_dwordx4 a[152:155], v5, s[16:19], s44 offen offset:2048 sc1
v_exp_f32 v95, v95
v_add_f32 v13, v13, v92
v_add_f32 v13, v13, v93
s_waitcnt vmcnt(7)
v_mfma_f32_32x32x16_bf16 v[32:47], a[156:159], a[60:63], v[32:47]
v_cvt_pk_bf16_f32 v86, v92, v93
s_nop 0
v_mfma_f32_32x32x16_bf16 v[48:63], a[156:159], a[124:127], v[48:63]
buffer_load_dwordx4 a[156:159], v5, s[16:19], s44 offen offset:3072 sc1
v_add_f32 v13, v13, v94
v_add_f32 v13, v13, v95
v_cvt_pk_bf16_f32 v87, v94, v95
s_add_u32 s43, s35, 65536
s_add_u32 s44, s35, 69632
s_add_u32 s45, s35, 49152
s_add_u32 s38, s45, s64
s_add_u32 s39, s45, s65
s_cmp_gt_u32 s7, 2
s_cselect_b32 s43, s43, s38
s_cselect_b32 s44, s44, s39
s_waitcnt vmcnt(7)
v_mfma_f32_32x32x16_bf16 v[128:143], a[128:131], v[64:67], v[128:143]
v_mfma_f32_32x32x16_bf16 v[144:159], a[128:131], v[80:83], v[144:159]
s_add_u32 s45, s37, s66
buffer_load_dwordx4 a[128:131], v5, s[16:19], s45 offen sc1
s_waitcnt vmcnt(7)
v_mfma_f32_32x32x16_bf16 v[128:143], a[132:135], v[68:71], v[128:143]
s_cmp_ge_u32 s40, s41
s_cbranch_scc1 PC_MASK_B1
PC_MASKRET_B1:
v_mfma_f32_32x32x16_bf16 v[144:159], a[132:135], v[84:87], v[144:159]
buffer_load_dwordx4 a[132:135], v5, s[16:19], s45 offen offset:1024 sc1
v_max3_f32 v16, v32, v33, v34
v_max3_f32 v16, v16, v35, v36
v_max3_f32 v16, v16, v37, v38
s_waitcnt vmcnt(7)
v_mfma_f32_32x32x16_bf16 v[160:175], a[136:139], v[64:67], v[160:175]
v_max3_f32 v16, v16, v39, v40
v_max3_f32 v16, v16, v41, v42
v_mfma_f32_32x32x16_bf16 v[176:191], a[136:139], v[80:83], v[176:191]
buffer_load_dwordx4 a[136:139], v5, s[16:19], s45 offen offset:2048 sc1
v_max3_f32 v16, v16, v43, v44
v_max3_f32 v16, v16, v45, v46
v_max_f32 v16, v16, v47
s_waitcnt vmcnt(7)
v_mfma_f32_32x32x16_bf16 v[160:175], a[140:143], v[68:71], v[160:175]
v_max3_f32 v17, v48, v49, v50
v_max3_f32 v17, v17, v51, v52
v_max3_f32 v17, v17, v53, v54
v_mfma_f32_32x32x16_bf16 v[176:191], a[140:143], v[84:87], v[176:191]
buffer_load_dwordx4 a[140:143], v5, s[16:19], s45 offen offset:3072 sc1
v_max3_f32 v17, v17, v55, v56
v_max3_f32 v17, v17, v57, v58
v_max3_f32 v17, v17, v59, v60
s_waitcnt vmcnt(7)
v_mfma_f32_32x32x16_bf16 v[192:207], a[144:147], v[64:67], v[192:207]
v_max3_f32 v17, v17, v61, v62
v_max_f32 v17, v17, v63
v_mfma_f32_32x32x16_bf16 v[208:223], a[144:147], v[80:83], v[208:223]
s_add_u32 s45, s37, s67
buffer_load_dwordx4 a[144:147], v5, s[16:19], s45 offen sc1
v_cmp_gt_f32 vcc, v16, v10
v_cmp_gt_f32 s[50:51], v17, v11
s_or_b64 s[50:51], vcc, s[50:51]
s_cbranch_scc1 PC_RARE_B1
PC_RARERET_B1:
s_waitcnt vmcnt(7)
v_mfma_f32_32x32x16_bf16 v[192:207], a[148:151], v[68:71], v[192:207]
s_add_u32 s40, s40, 1
v_fma_f32 v32, v32, s68, -v8
v_fma_f32 v33, v33, s68, -v8
v_mfma_f32_32x32x16_bf16 v[208:223], a[148:151], v[84:87], v[208:223]
buffer_load_dwordx4 a[148:151], v5, s[16:19], s45 offen offset:1024 sc1
v_exp_f32 v32, v32
s_waitcnt vmcnt(7)
v_mfma_f32_32x32x16_bf16 v[224:239], a[152:155], v[64:67], v[224:239]
v_exp_f32 v33, v33
v_fma_f32 v34, v34, s68, -v8
v_mfma_f32_32x32x16_bf16 v[240:255], a[152:155], v[80:83], v[240:255]
buffer_load_dwordx4 a[152:155], v5, s[16:19], s45 offen offset:2048 sc1
v_fma_f32 v35, v35, s68, -v8
v_exp_f32 v34, v34
s_waitcnt vmcnt(7)
v_mfma_f32_32x32x16_bf16 v[224:239], a[156:159], v[68:71], v[224:239]
v_exp_f32 v35, v35
v_add_f32 v12, v12, v32
v_mfma_f32_32x32x16_bf16 v[240:255], a[156:159], v[84:87], v[240:255]
buffer_load_dwordx4 a[156:159], v5, s[16:19], s45 offen offset:3072 sc1
v_add_f32 v12, v12, v33
v_cvt_pk_bf16_f32 v32, v32, v33
v_fma_f32 v36, v36, s68, -v8
s_waitcnt vmcnt(7)
v_mfma_f32_32x32x16_bf16 v[96:111], a[128:131], v[64:67], v[96:111]
v_fma_f32 v37, v37, s68, -v8
v_exp_f32 v36, v36
v_mfma_f32_32x32x16_bf16 v[112:127], a[128:131], v[80:83], v[112:127]
buffer_load_dwordx4 a[128:131], v5, s[16:19], s43 offen sc1
v_exp_f32 v37, v37
s_waitcnt vmcnt(7)
v_mfma_f32_32x32x16_bf16 v[96:111], a[132:135], v[68:71], v[96:111]
v_add_f32 v12, v12, v34
v_add_f32 v12, v12, v35
v_cvt_pk_bf16_f32 v33, v34, v35
v_mfma_f32_32x32x16_bf16 v[112:127], a[132:135], v[84:87], v[112:127]
buffer_load_dwordx4 a[132:135], v5, s[16:19], s43 offen offset:1024 sc1
v_fma_f32 v38, v38, s68, -v8
v_fma_f32 v39, v39, s68, -v8
s_waitcnt vmcnt(7)
v_mfma_f32_32x32x16_bf16 a[160:175], a[136:139], v[64:67], a[160:175]
v_exp_f32 v38, v38
v_exp_f32 v39, v39
v_mfma_f32_32x32x16_bf16 a[176:191], a[136:139], v[80:83], a[176:191]
buffer_load_dwordx4 a[136:139], v5, s[16:19], s43 offen offset:2048 sc1
v_add_f32 v12, v12, v36
v_add_f32 v12, v12, v37
s_waitcnt vmcnt(7)
v_mfma_f32_32x32x16_bf16 a[160:175], a[140:143], v[68:71], a[160:175]
v_cvt_pk_bf16_f32 v34, v36, v37
v_fma_f32 v40, v40, s68, -v8
v_fma_f32 v41, v41, s68, -v8
v_mfma_f32_32x32x16_bf16 a[176:191], a[140:143], v[84:87], a[176:191]
buffer_load_dwordx4 a[140:143], v5, s[16:19], s43 offen offset:3072 sc1
v_exp_f32 v40, v40
s_waitcnt vmcnt(7)
v_mfma_f32_32x32x16_bf16 a[192:207], a[144:147], v[64:67], a[192:207]
v_exp_f32 v41, v41
v_add_f32 v12, v12, v38
v_add_f32 v12, v12, v39
v_mfma_f32_32x32x16_bf16 a[208:223], a[144:147], v[80:83], a[208:223]
buffer_load_dwordx4 a[144:147], v5, s[16:19], s44 offen sc1
v_cvt_pk_bf16_f32 v35, v38, v39
v_fma_f32 v42, v42, s68, -v8
s_waitcnt vmcnt(7)
v_mfma_f32_32x32x16_bf16 a[192:207], a[148:151], v[68:71], a[192:207]
v_fma_f32 v43, v43, s68, -v8
v_exp_f32 v42, v42
v_mfma_f32_32x32x16_bf16 a[208:223], a[148:151], v[84:87], a[208:223]
buffer_load_dwordx4 a[148:151], v5, s[16:19], s44 offen offset:1024 sc1
v_exp_f32 v43, v43
v_add_f32 v12, v12, v40
s_waitcnt vmcnt(7)
v_mfma_f32_32x32x16_bf16 a[224:239], a[152:155], v[64:67], a[224:239]
v_add_f32 v12, v12, v41
v_cvt_pk_bf16_f32 v36, v40, v41
v_fma_f32 v44, v44, s68, -v8
v_mfma_f32_32x32x16_bf16 a[240:255], a[152:155], v[80:83], a[240:255]
buffer_load_dwordx4 a[152:155], v5, s[16:19], s44 offen offset:2048 sc1
v_fma_f32 v45, v45, s68, -v8
v_exp_f32 v44, v44
s_waitcnt vmcnt(7)
v_mfma_f32_32x32x16_bf16 a[224:239], a[156:159], v[68:71], a[224:239]
v_exp_f32 v45, v45
v_mfma_f32_32x32x16_bf16 a[240:255], a[156:159], v[84:87], a[240:255]
buffer_load_dwordx4 a[156:159], v5, s[16:19], s44 offen offset:3072 sc1
v_add_f32 v12, v12, v42
v_add_f32 v12, v12, v43
v_cvt_pk_bf16_f32 v37, v42, v43
s_cmp_lg_u32 s42, 0
s_cbranch_scc1 PC_PEND_B1
PC_PENDRET_B1:
s_add_u32 s35, s35, 32768
s_sub_u32 s7, s7, 1
s_cmp_eq_u32 s7, 1
s_cbranch_scc0 PC_LOOP
PC_TAIL0:
v_fma_f32 v46, v46, s68, -v8
v_fma_f32 v47, v47, s68, -v8
v_exp_f32 v46, v46
v_exp_f32 v47, v47
v_add_f32 v12, v12, v44
v_add_f32 v12, v12, v45
v_cvt_pk_bf16_f32 v38, v44, v45
s_nop 0
v_add_f32 v12, v12, v46
v_add_f32 v12, v12, v47
v_cvt_pk_bf16_f32 v39, v46, v47
v_fma_f32 v48, v48, s68, -v9
v_fma_f32 v49, v49, s68, -v9
v_exp_f32 v48, v48
v_exp_f32 v49, v49
v_fma_f32 v50, v50, s68, -v9
v_fma_f32 v51, v51, s68, -v9
v_exp_f32 v50, v50
v_exp_f32 v51, v51
v_add_f32 v13, v13, v48
v_add_f32 v13, v13, v49
v_cvt_pk_bf16_f32 v48, v48, v49
v_fma_f32 v52, v52, s68, -v9
v_fma_f32 v53, v53, s68, -v9
v_exp_f32 v52, v52
v_exp_f32 v53, v53
v_add_f32 v13, v13, v50
v_add_f32 v13, v13, v51
v_cvt_pk_bf16_f32 v49, v50, v51
v_fma_f32 v54, v54, s68, -v9
v_fma_f32 v55, v55, s68, -v9
v_exp_f32 v54, v54
v_exp_f32 v55, v55
v_add_f32 v13, v13, v52
v_add_f32 v13, v13, v53
v_cvt_pk_bf16_f32 v50, v52, v53
v_fma_f32 v56, v56, s68, -v9
v_fma_f32 v57, v57, s68, -v9
v_exp_f32 v56, v56
v_exp_f32 v57, v57
v_add_f32 v13, v13, v54
v_add_f32 v13, v13, v55
v_cvt_pk_bf16_f32 v51, v54, v55
v_fma_f32 v58, v58, s68, -v9
v_fma_f32 v59, v59, s68, -v9
v_exp_f32 v58, v58
v_exp_f32 v59, v59
v_add_f32 v13, v13, v56
v_add_f32 v13, v13, v57
v_cvt_pk_bf16_f32 v52, v56, v57
v_fma_f32 v60, v60, s68, -v9
v_fma_f32 v61, v61, s68, -v9
v_exp_f32 v60, v60
v_exp_f32 v61, v61
v_add_f32 v13, v13, v58
v_add_f32 v13, v13, v59
v_cvt_pk_bf16_f32 v53, v58, v59
v_fma_f32 v62, v62, s68, -v9
v_fma_f32 v63, v63, s68, -v9
v_exp_f32 v62, v62
v_exp_f32 v63, v63
v_add_f32 v13, v13, v60
v_add_f32 v13, v13, v61
v_cvt_pk_bf16_f32 v54, v60, v61
s_nop 0
v_add_f32 v13, v13, v62
v_add_f32 v13, v13, v63
v_cvt_pk_bf16_f32 v55, v62, v63
s_add_u32 s37, s35, 16384
s_cmp_lg_u32 s53, 0
s_cselect_b32 s43, s48, 0x2000000
s_add_u32 s44, s43, 4096
s_waitcnt vmcnt(7)
v_mfma_f32_32x32x16_bf16 v[128:143], a[128:131], v[32:35], v[128:143]
ds_read_b128 a[0:3], v5
ds_read_b128 a[4:7], v5 offset:1024
ds_read_b128 a[8:11], v5 offset:2048
v_mfma_f32_32x32x16_bf16 v[144:159], a[128:131], v[48:51], v[144:159]
s_add_u32 s45, s37, s66
buffer_load_dwordx4 a[128:131], v5, s[16:19], s45 offen sc1
ds_read_b128 a[12:15], v5 offset:3072
ds_read_b128 a[16:19], v5 offset:4096
s_waitcnt vmcnt(7)
v_mfma_f32_32x32x16_bf16 v[128:143], a[132:135], v[36:39], v[128:143]
ds_read_b128 a[20:23], v5 offset:5120
ds_read_b128 a[24:27], v5 offset:6144
ds_read_b128 a[28:31], v5 offset:7168
v_mfma_f32_32x32x16_bf16 v[144:159], a[132:135], v[52:55], v[144:159]
buffer_load_dwordx4 a[132:135], v5, s[16:19], s45 offen offset:1024 sc1
ds_read_b128 a[32:35], v5 offset:8192
ds_read_b128 a[36:39], v5 offset:9216
ds_read_b128 a[40:43], v5 offset:10240
s_waitcnt vmcnt(7)
v_mfma_f32_32x32x16_bf16 v[160:175], a[136:139], v[32:35], v[160:175]
ds_read_b128 a[44:47], v5 offset:11264
ds_read_b128 a[48:51], v5 offset:12288
v_mfma_f32_32x32x16_bf16 v[176:191], a[136:139], v[48:51], v[176:191]
buffer_load_dwordx4 a[136:139], v5, s[16:19], s45 offen offset:2048 sc1
ds_read_b128 a[52:55], v5 offset:13312
ds_read_b128 a[56:59], v5 offset:14336
ds_read_b128 a[60:63], v5 offset:15360
s_waitcnt vmcnt(7)
v_mfma_f32_32x32x16_bf16 v[160:175], a[140:143], v[36:39], v[160:175]
ds_read_b128 a[64:67], v5 offset:16384
ds_read_b128 a[68:71], v5 offset:17408
ds_read_b128 a[72:75], v5 offset:18432
v_mfma_f32_32x32x16_bf16 v[176:191], a[140:143], v[52:55], v[176:191]
buffer_load_dwordx4 a[140:143], v5, s[16:19], s45 offen offset:3072 sc1
ds_read_b128 a[76:79], v5 offset:19456
ds_read_b128 a[80:83], v5 offset:20480
s_waitcnt vmcnt(7)
v_mfma_f32_32x32x16_bf16 v[192:207], a[144:147], v[32:35], v[192:207]
ds_read_b128 a[84:87], v5 offset:21504
ds_read_b128 a[88:91], v5 offset:22528
ds_read_b128 a[92:95], v5 offset:23552
v_mfma_f32_32x32x16_bf16 v[208:223], a[144:147], v[48:51], v[208:223]
s_add_u32 s45, s37, s67
buffer_load_dwordx4 a[144:147], v5, s[16:19], s45 offen sc1
ds_read_b128 a[96:99], v5 offset:24576
ds_read_b128 a[100:103], v5 offset:25600
ds_read_b128 a[104:107], v5 offset:26624
s_waitcnt vmcnt(7)
v_mfma_f32_32x32x16_bf16 v[192:207], a[148:151], v[36:39], v[192:207]
ds_read_b128 a[108:111], v5 offset:27648
ds_read_b128 a[112:115], v5 offset:28672
v_mfma_f32_32x32x16_bf16 v[208:223], a[148:151], v[52:55], v[208:223]
buffer_load_dwordx4 a[148:151], v5, s[16:19], s45 offen offset:1024 sc1
ds_read_b128 a[116:119], v5 offset:29696
ds_read_b128 a[120:123], v5 offset:30720
ds_read_b128 a[124:127], v5 offset:31744
s_waitcnt vmcnt(7)
v_mfma_f32_32x32x16_bf16 v[224:239], a[152:155], v[32:35], v[224:239]
v_cvt_pk_bf16_f32 v128, v128, v129
v_cvt_pk_bf16_f32 v129, v130, v131
v_cvt_pk_bf16_f32 v130, v132, v133
v_cvt_pk_bf16_f32 v131, v134, v135
v_cvt_pk_bf16_f32 v132, v136, v137
v_mfma_f32_32x32x16_bf16 v[240:255], a[152:155], v[48:51], v[240:255]
buffer_load_dwordx4 a[152:155], v5, s[16:19], s45 offen offset:2048 sc1
v_cvt_pk_bf16_f32 v133, v138, v139
v_cvt_pk_bf16_f32 v134, v140, v141
v_cvt_pk_bf16_f32 v135, v142, v143
ds_write_b128 v28, v[128:131]
ds_write_b128 v28, v[132:135] offset:1024
s_waitcnt vmcnt(7)
v_mfma_f32_32x32x16_bf16 v[224:239], a[156:159], v[36:39], v[224:239]
v_cvt_pk_bf16_f32 v144, v144, v145
v_cvt_pk_bf16_f32 v145, v146, v147
v_cvt_pk_bf16_f32 v146, v148, v149
v_cvt_pk_bf16_f32 v147, v150, v151
v_cvt_pk_bf16_f32 v148, v152, v153
v_mfma_f32_32x32x16_bf16 v[240:255], a[156:159], v[52:55], v[240:255]
buffer_load_dwordx4 a[156:159], v5, s[16:19], s45 offen offset:3072 sc1
v_cvt_pk_bf16_f32 v149, v154, v155
v_cvt_pk_bf16_f32 v150, v156, v157
v_cvt_pk_bf16_f32 v151, v158, v159
ds_write_b128 v28, v[144:147] offset:2048
ds_write_b128 v28, v[148:151] offset:3072
s_waitcnt vmcnt(7)
v_mfma_f32_32x32x16_bf16 v[96:111], a[128:131], v[32:35], v[96:111]
v_cvt_pk_bf16_f32 v160, v160, v161
v_cvt_pk_bf16_f32 v161, v162, v163
v_cvt_pk_bf16_f32 v162, v164, v165
v_cvt_pk_bf16_f32 v163, v166, v167
v_cvt_pk_bf16_f32 v164, v168, v169
v_mfma_f32_32x32x16_bf16 v[112:127], a[128:131], v[48:51], v[112:127]
buffer_load_dwordx4 a[128:131], v5, s[16:19], s43 offen sc1
v_cvt_pk_bf16_f32 v165, v170, v171
v_cvt_pk_bf16_f32 v166, v172, v173
v_cvt_pk_bf16_f32 v167, v174, v175
ds_write_b128 v28, v[160:163] offset:4096
ds_write_b128 v28, v[164:167] offset:5120
s_waitcnt vmcnt(7)
v_mfma_f32_32x32x16_bf16 v[96:111], a[132:135], v[36:39], v[96:111]
v_cvt_pk_bf16_f32 v176, v176, v177
v_cvt_pk_bf16_f32 v177, v178, v179
v_cvt_pk_bf16_f32 v178, v180, v181
v_cvt_pk_bf16_f32 v179, v182, v183
v_cvt_pk_bf16_f32 v180, v184, v185
v_mfma_f32_32x32x16_bf16 v[112:127], a[132:135], v[52:55], v[112:127]
buffer_load_dwordx4 a[132:135], v5, s[16:19], s43 offen offset:1024 sc1
v_cvt_pk_bf16_f32 v181, v186, v187
v_cvt_pk_bf16_f32 v182, v188, v189
v_cvt_pk_bf16_f32 v183, v190, v191
ds_write_b128 v28, v[176:179] offset:6144
ds_write_b128 v28, v[180:183] offset:7168
s_waitcnt vmcnt(7)
v_mfma_f32_32x32x16_bf16 a[160:175], a[136:139], v[32:35], a[160:175]
v_cvt_pk_bf16_f32 v192, v192, v193
v_cvt_pk_bf16_f32 v193, v194, v195
v_cvt_pk_bf16_f32 v194, v196, v197
v_mfma_f32_32x32x16_bf16 a[176:191], a[136:139], v[48:51], a[176:191]
buffer_load_dwordx4 a[136:139], v5, s[16:19], s43 offen offset:2048 sc1
v_cvt_pk_bf16_f32 v195, v198, v199
v_cvt_pk_bf16_f32 v196, v200, v201
v_cvt_pk_bf16_f32 v197, v202, v203
v_cvt_pk_bf16_f32 v198, v204, v205
s_waitcnt vmcnt(7)
v_mfma_f32_32x32x16_bf16 a[160:175], a[140:143], v[36:39], a[160:175]
v_cvt_pk_bf16_f32 v199, v206, v207
ds_write_b128 v28, v[192:195] offset:8192
ds_write_b128 v28, v[196:199] offset:9216
v_mfma_f32_32x32x16_bf16 a[176:191], a[140:143], v[52:55], a[176:191]
buffer_load_dwordx4 a[140:143], v5, s[16:19], s43 offen offset:3072 sc1
v_cvt_pk_bf16_f32 v208, v208, v209
v_cvt_pk_bf16_f32 v209, v210, v211
v_cvt_pk_bf16_f32 v210, v212, v213
s_waitcnt vmcnt(7)
v_mfma_f32_32x32x16_bf16 a[192:207], a[144:147], v[32:35], a[192:207]
v_cvt_pk_bf16_f32 v211, v214, v215
v_cvt_pk_bf16_f32 v212, v216, v217
v_cvt_pk_bf16_f32 v213, v218, v219
v_cvt_pk_bf16_f32 v214, v220, v221
v_mfma_f32_32x32x16_bf16 a[208:223], a[144:147], v[48:51], a[208:223]
buffer_load_dwordx4 a[144:147], v5, s[16:19], s44 offen sc1
v_cvt_pk_bf16_f32 v215, v222, v223
ds_write_b128 v28, v[208:211] offset:10240
ds_write_b128 v28, v[212:215] offset:11264
s_waitcnt vmcnt(7)
v_mfma_f32_32x32x16_bf16 a[192:207], a[148:151], v[36:39], a[192:207]
v_cvt_pk_bf16_f32 v224, v224, v225
v_cvt_pk_bf16_f32 v225, v226, v227
v_cvt_pk_bf16_f32 v226, v228, v229
v_mfma_f32_32x32x16_bf16 a[208:223], a[148:151], v[52:55], a[208:223]
buffer_load_dwordx4 a[148:151], v5, s[16:19], s44 offen offset:1024 sc1
v_cvt_pk_bf16_f32 v227, v230, v231
v_cvt_pk_bf16_f32 v228, v232, v233
v_cvt_pk_bf16_f32 v229, v234, v235
v_cvt_pk_bf16_f32 v230, v236, v237
s_waitcnt vmcnt(7)
v_mfma_f32_32x32x16_bf16 a[224:239], a[152:155], v[32:35], a[224:239]
v_cvt_pk_bf16_f32 v231, v238, v239
ds_write_b128 v28, v[224:227] offset:12288
ds_write_b128 v28, v[228:231] offset:13312
v_mfma_f32_32x32x16_bf16 a[240:255], a[152:155], v[48:51], a[240:255]
buffer_load_dwordx4 a[152:155], v5, s[16:19], s44 offen offset:2048 sc1
v_cvt_pk_bf16_f32 v240, v240, v241
v_cvt_pk_bf16_f32 v241, v242, v243
v_cvt_pk_bf16_f32 v242, v244, v245
s_waitcnt vmcnt(7)
v_mfma_f32_32x32x16_bf16 a[224:239], a[156:159], v[36:39], a[224:239]
v_cvt_pk_bf16_f32 v243, v246, v247
v_cvt_pk_bf16_f32 v244, v248, v249
v_cvt_pk_bf16_f32 v245, v250, v251
v_cvt_pk_bf16_f32 v246, v252, v253
v_mfma_f32_32x32x16_bf16 a[240:255], a[156:159], v[52:55], a[240:255]
buffer_load_dwordx4 a[156:159], v5, s[16:19], s44 offen offset:3072 sc1
v_cvt_pk_bf16_f32 v247, v254, v255
ds_write_b128 v28, v[240:243] offset:14336
ds_write_b128 v28, v[244:247] offset:15360
s_branch PC_SEGEND
PC_TAIL1:
v_fma_f32 v78, v78, s68, -v8
v_fma_f32 v79, v79, s68, -v8
v_exp_f32 v78, v78
v_exp_f32 v79, v79
v_add_f32 v12, v12, v76
v_add_f32 v12, v12, v77
v_cvt_pk_bf16_f32 v70, v76, v77
s_nop 0
v_add_f32 v12, v12, v78
v_add_f32 v12, v12, v79
v_cvt_pk_bf16_f32 v71, v78, v79
v_fma_f32 v80, v80, s68, -v9
v_fma_f32 v81, v81, s68, -v9
v_exp_f32 v80, v80
v_exp_f32 v81, v81
v_fma_f32 v82, v82, s68, -v9
v_fma_f32 v83, v83, s68, -v9
v_exp_f32 v82, v82
v_exp_f32 v83, v83
v_add_f32 v13, v13, v80
v_add_f32 v13, v13, v81
v_cvt_pk_bf16_f32 v80, v80, v81
v_fma_f32 v84, v84, s68, -v9
v_fma_f32 v85, v85, s68, -v9
v_exp_f32 v84, v84
v_exp_f32 v85, v85
v_add_f32 v13, v13, v82
v_add_f32 v13, v13, v83
v_cvt_pk_bf16_f32 v81, v82, v83
v_fma_f32 v86, v86, s68, -v9
v_fma_f32 v87, v87, s68, -v9
v_exp_f32 v86, v86
v_exp_f32 v87, v87
v_add_f32 v13, v13, v84
v_add_f32 v13, v13, v85
v_cvt_pk_bf16_f32 v82, v84, v85
v_fma_f32 v88, v88, s68, -v9
v_fma_f32 v89, v89, s68, -v9
v_exp_f32 v88, v88
v_exp_f32 v89, v89
v_add_f32 v13, v13, v86
v_add_f32 v13, v13, v87
v_cvt_pk_bf16_f32 v83, v86, v87
v_fma_f32 v90, v90, s68, -v9
v_fma_f32 v91, v91, s68, -v9
v_exp_f32 v90, v90
v_exp_f32 v91, v91
v_add_f32 v13, v13, v88
v_add_f32 v13, v13, v89
v_cvt_pk_bf16_f32 v84, v88, v89
v_fma_f32 v92, v92, s68, -v9
v_fma_f32 v93, v93, s68, -v9
v_exp_f32 v92, v92
v_exp_f32 v93, v93
v_add_f32 v13, v13, v90
v_add_f32 v13, v13, v91
v_cvt_pk_bf16_f32 v85, v90, v91
v_fma_f32 v94, v94, s68, -v9
v_fma_f32 v95, v95, s68, -v9
v_exp_f32 v94, v94
v_exp_f32 v95, v95
v_add_f32 v13, v13, v92
v_add_f32 v13, v13, v93
v_cvt_pk_bf16_f32 v86, v92, v93
s_nop 0
v_add_f32 v13, v13, v94
v_add_f32 v13, v13, v95
v_cvt_pk_bf16_f32 v87, v94, v95
s_add_u32 s37, s35, 16384
s_cmp_lg_u32 s53, 0
s_cselect_b32 s43, s48, 0x2000000
s_add_u32 s44, s43, 4096
s_waitcnt vmcnt(7)
v_mfma_f32_32x32x16_bf16 v[128:143], a[128:131], v[64:67], v[128:143]
ds_read_b128 a[0:3], v5
ds_read_b128 a[4:7], v5 offset:1024
ds_read_b128 a[8:11], v5 offset:2048
v_mfma_f32_32x32x16_bf16 v[144:159], a[128:131], v[80:83], v[144:159]
s_add_u32 s45, s37, s66
buffer_load_dwordx4 a[128:131], v5, s[16:19], s45 offen sc1
ds_read_b128 a[12:15], v5 offset:3072
ds_read_b128 a[16:19], v5 offset:4096
s_waitcnt vmcnt(7)
v_mfma_f32_32x32x16_bf16 v[128:143], a[132:135], v[68:71], v[128:143]
ds_read_b128 a[20:23], v5 offset:5120
ds_read_b128 a[24:27], v5 offset:6144
ds_read_b128 a[28:31], v5 offset:7168
v_mfma_f32_32x32x16_bf16 v[144:159], a[132:135], v[84:87], v[144:159]
buffer_load_dwordx4 a[132:135], v5, s[16:19], s45 offen offset:1024 sc1
ds_read_b128 a[32:35], v5 offset:8192
ds_read_b128 a[36:39], v5 offset:9216
ds_read_b128 a[40:43], v5 offset:10240
s_waitcnt vmcnt(7)
v_mfma_f32_32x32x16_bf16 v[160:175], a[136:139], v[64:67], v[160:175]
ds_read_b128 a[44:47], v5 offset:11264
ds_read_b128 a[48:51], v5 offset:12288
v_mfma_f32_32x32x16_bf16 v[176:191], a[136:139], v[80:83], v[176:191]
buffer_load_dwordx4 a[136:139], v5, s[16:19], s45 offen offset:2048 sc1
ds_read_b128 a[52:55], v5 offset:13312
ds_read_b128 a[56:59], v5 offset:14336
ds_read_b128 a[60:63], v5 offset:15360
s_waitcnt vmcnt(7)
v_mfma_f32_32x32x16_bf16 v[160:175], a[140:143], v[68:71], v[160:175]
ds_read_b128 a[64:67], v5 offset:16384
ds_read_b128 a[68:71], v5 offset:17408
ds_read_b128 a[72:75], v5 offset:18432
v_mfma_f32_32x32x16_bf16 v[176:191], a[140:143], v[84:87], v[176:191]
buffer_load_dwordx4 a[140:143], v5, s[16:19], s45 offen offset:3072 sc1
ds_read_b128 a[76:79], v5 offset:19456
ds_read_b128 a[80:83], v5 offset:20480
s_waitcnt vmcnt(7)
v_mfma_f32_32x32x16_bf16 v[192:207], a[144:147], v[64:67], v[192:207]
ds_read_b128 a[84:87], v5 offset:21504
ds_read_b128 a[88:91], v5 offset:22528
ds_read_b128 a[92:95], v5 offset:23552
v_mfma_f32_32x32x16_bf16 v[208:223], a[144:147], v[80:83], v[208:223]
s_add_u32 s45, s37, s67
buffer_load_dwordx4 a[144:147], v5, s[16:19], s45 offen sc1
ds_read_b128 a[96:99], v5 offset:24576
ds_read_b128 a[100:103], v5 offset:25600
ds_read_b128 a[104:107], v5 offset:26624
s_waitcnt vmcnt(7)
v_mfma_f32_32x32x16_bf16 v[192:207], a[148:151], v[68:71], v[192:207]
ds_read_b128 a[108:111], v5 offset:27648
ds_read_b128 a[112:115], v5 offset:28672
v_mfma_f32_32x32x16_bf16 v[208:223], a[148:151], v[84:87], v[208:223]
buffer_load_dwordx4 a[148:151], v5, s[16:19], s45 offen offset:1024 sc1
ds_read_b128 a[116:119], v5 offset:29696
ds_read_b128 a[120:123], v5 offset:30720
ds_read_b128 a[124:127], v5 offset:31744
s_waitcnt vmcnt(7)
v_mfma_f32_32x32x16_bf16 v[224:239], a[152:155], v[64:67], v[224:239]
v_cvt_pk_bf16_f32 v128, v128, v129
v_cvt_pk_bf16_f32 v129, v130, v131
v_cvt_pk_bf16_f32 v130, v132, v133
v_cvt_pk_bf16_f32 v131, v134, v135
v_cvt_pk_bf16_f32 v132, v136, v137
v_mfma_f32_32x32x16_bf16 v[240:255], a[152:155], v[80:83], v[240:255]
buffer_load_dwordx4 a[152:155], v5, s[16:19], s45 offen offset:2048 sc1
v_cvt_pk_bf16_f32 v133, v138, v139
v_cvt_pk_bf16_f32 v134, v140, v141
v_cvt_pk_bf16_f32 v135, v142, v143
ds_write_b128 v28, v[128:131]
ds_write_b128 v28, v[132:135] offset:1024
s_waitcnt vmcnt(7)
v_mfma_f32_32x32x16_bf16 v[224:239], a[156:159], v[68:71], v[224:239]
v_cvt_pk_bf16_f32 v144, v144, v145
v_cvt_pk_bf16_f32 v145, v146, v147
v_cvt_pk_bf16_f32 v146, v148, v149
v_cvt_pk_bf16_f32 v147, v150, v151
v_cvt_pk_bf16_f32 v148, v152, v153
v_mfma_f32_32x32x16_bf16 v[240:255], a[156:159], v[84:87], v[240:255]
buffer_load_dwordx4 a[156:159], v5, s[16:19], s45 offen offset:3072 sc1
v_cvt_pk_bf16_f32 v149, v154, v155
v_cvt_pk_bf16_f32 v150, v156, v157
v_cvt_pk_bf16_f32 v151, v158, v159
ds_write_b128 v28, v[144:147] offset:2048
ds_write_b128 v28, v[148:151] offset:3072
s_waitcnt vmcnt(7)
v_mfma_f32_32x32x16_bf16 v[96:111], a[128:131], v[64:67], v[96:111]
v_cvt_pk_bf16_f32 v160, v160, v161
v_cvt_pk_bf16_f32 v161, v162, v163
v_cvt_pk_bf16_f32 v162, v164, v165
v_cvt_pk_bf16_f32 v163, v166, v167
v_cvt_pk_bf16_f32 v164, v168, v169
v_mfma_f32_32x32x16_bf16 v[112:127], a[128:131], v[80:83], v[112:127]
buffer_load_dwordx4 a[128:131], v5, s[16:19], s43 offen sc1
v_cvt_pk_bf16_f32 v165, v170, v171
v_cvt_pk_bf16_f32 v166, v172, v173
v_cvt_pk_bf16_f32 v167, v174, v175
ds_write_b128 v28, v[160:163] offset:4096
ds_write_b128 v28, v[164:167] offset:5120
s_waitcnt vmcnt(7)
v_mfma_f32_32x32x16_bf16 v[96:111], a[132:135], v[68:71], v[96:111]
v_cvt_pk_bf16_f32 v176, v176, v177
v_cvt_pk_bf16_f32 v177, v178, v179
v_cvt_pk_bf16_f32 v178, v180, v181
v_cvt_pk_bf16_f32 v179, v182, v183
v_cvt_pk_bf16_f32 v180, v184, v185
v_mfma_f32_32x32x16_bf16 v[112:127], a[132:135], v[84:87], v[112:127]
buffer_load_dwordx4 a[132:135], v5, s[16:19], s43 offen offset:1024 sc1
v_cvt_pk_bf16_f32 v181, v186, v187
v_cvt_pk_bf16_f32 v182, v188, v189
v_cvt_pk_bf16_f32 v183, v190, v191
ds_write_b128 v28, v[176:179] offset:6144
ds_write_b128 v28, v[180:183] offset:7168
s_waitcnt vmcnt(7)
v_mfma_f32_32x32x16_bf16 a[160:175], a[136:139], v[64:67], a[160:175]
v_cvt_pk_bf16_f32 v192, v192, v193
v_cvt_pk_bf16_f32 v193, v194, v195
v_cvt_pk_bf16_f32 v194, v196, v197
v_mfma_f32_32x32x16_bf16 a[176:191], a[136:139], v[80:83], a[176:191]
buffer_load_dwordx4 a[136:139], v5, s[16:19], s43 offen offset:2048 sc1
v_cvt_pk_bf16_f32 v195, v198, v199
v_cvt_pk_bf16_f32 v196, v200, v201
v_cvt_pk_bf16_f32 v197, v202, v203
v_cvt_pk_bf16_f32 v198, v204, v205
s_waitcnt vmcnt(7)
v_mfma_f32_32x32x16_bf16 a[160:175], a[140:143], v[68:71], a[160:175]
v_cvt_pk_bf16_f32 v199, v206, v207
ds_write_b128 v28, v[192:195] offset:8192
ds_write_b128 v28, v[196:199] offset:9216
v_mfma_f32_32x32x16_bf16 a[176:191], a[140:143], v[84:87], a[176:191]
buffer_load_dwordx4 a[140:143], v5, s[16:19], s43 offen offset:3072 sc1
v_cvt_pk_bf16_f32 v208, v208, v209
v_cvt_pk_bf16_f32 v209, v210, v211
v_cvt_pk_bf16_f32 v210, v212, v213
s_waitcnt vmcnt(7)
v_mfma_f32_32x32x16_bf16 a[192:207], a[144:147], v[64:67], a[192:207]
v_cvt_pk_bf16_f32 v211, v214, v215
v_cvt_pk_bf16_f32 v212, v216, v217
v_cvt_pk_bf16_f32 v213, v218, v219
v_cvt_pk_bf16_f32 v214, v220, v221
v_mfma_f32_32x32x16_bf16 a[208:223], a[144:147], v[80:83], a[208:223]
buffer_load_dwordx4 a[144:147], v5, s[16:19], s44 offen sc1
v_cvt_pk_bf16_f32 v215, v222, v223
ds_write_b128 v28, v[208:211] offset:10240
ds_write_b128 v28, v[212:215] offset:11264
s_waitcnt vmcnt(7)
v_mfma_f32_32x32x16_bf16 a[192:207], a[148:151], v[68:71], a[192:207]
v_cvt_pk_bf16_f32 v224, v224, v225
v_cvt_pk_bf16_f32 v225, v226, v227
v_cvt_pk_bf16_f32 v226, v228, v229
v_mfma_f32_32x32x16_bf16 a[208:223], a[148:151], v[84:87], a[208:223]
buffer_load_dwordx4 a[148:151], v5, s[16:19], s44 offen offset:1024 sc1
v_cvt_pk_bf16_f32 v227, v230, v231
v_cvt_pk_bf16_f32 v228, v232, v233
v_cvt_pk_bf16_f32 v229, v234, v235
v_cvt_pk_bf16_f32 v230, v236, v237
s_waitcnt vmcnt(7)
v_mfma_f32_32x32x16_bf16 a[224:239], a[152:155], v[64:67], a[224:239]
v_cvt_pk_bf16_f32 v231, v238, v239
ds_write_b128 v28, v[224:227] offset:12288
ds_write_b128 v28, v[228:231] offset:13312
v_mfma_f32_32x32x16_bf16 a[240:255], a[152:155], v[80:83], a[240:255]
buffer_load_dwordx4 a[152:155], v5, s[16:19], s44 offen offset:2048 sc1
v_cvt_pk_bf16_f32 v240, v240, v241
v_cvt_pk_bf16_f32 v241, v242, v243
v_cvt_pk_bf16_f32 v242, v244, v245
s_waitcnt vmcnt(7)
v_mfma_f32_32x32x16_bf16 a[224:239], a[156:159], v[68:71], a[224:239]
v_cvt_pk_bf16_f32 v243, v246, v247
v_cvt_pk_bf16_f32 v244, v248, v249
v_cvt_pk_bf16_f32 v245, v250, v251
v_cvt_pk_bf16_f32 v246, v252, v253
v_mfma_f32_32x32x16_bf16 a[240:255], a[156:159], v[84:87], a[240:255]
buffer_load_dwordx4 a[156:159], v5, s[16:19], s44 offen offset:3072 sc1
v_cvt_pk_bf16_f32 v247, v254, v255
ds_write_b128 v28, v[240:243] offset:14336
ds_write_b128 v28, v[244:247] offset:15360
s_branch PC_SEGEND
PC_TAILF:
v_fma_f32 v46, v46, s68, -v8
v_fma_f32 v47, v47, s68, -v8
v_exp_f32 v46, v46
v_exp_f32 v47, v47
v_add_f32 v12, v12, v44
v_add_f32 v12, v12, v45
v_cvt_pk_bf16_f32 v38, v44, v45
s_nop 0
v_add_f32 v12, v12, v46
v_add_f32 v12, v12, v47
v_cvt_pk_bf16_f32 v39, v46, v47
v_fma_f32 v48, v48, s68, -v9
v_fma_f32 v49, v49, s68, -v9
v_exp_f32 v48, v48
v_exp_f32 v49, v49
v_fma_f32 v50, v50, s68, -v9
v_fma_f32 v51, v51, s68, -v9
v_exp_f32 v50, v50
v_exp_f32 v51, v51
v_add_f32 v13, v13, v48
v_add_f32 v13, v13, v49
v_cvt_pk_bf16_f32 v48, v48, v49
v_fma_f32 v52, v52, s68, -v9
v_fma_f32 v53, v53, s68, -v9
v_exp_f32 v52, v52
v_exp_f32 v53, v53
v_add_f32 v13, v13, v50
v_add_f32 v13, v13, v51
v_cvt_pk_bf16_f32 v49, v50, v51
v_fma_f32 v54, v54, s68, -v9
v_fma_f32 v55, v55, s68, -v9
v_exp_f32 v54, v54
v_exp_f32 v55, v55
v_add_f32 v13, v13, v52
v_add_f32 v13, v13, v53
v_cvt_pk_bf16_f32 v50, v52, v53
v_fma_f32 v56, v56, s68, -v9
v_fma_f32 v57, v57, s68, -v9
v_exp_f32 v56, v56
v_exp_f32 v57, v57
v_add_f32 v13, v13, v54
v_add_f32 v13, v13, v55
v_cvt_pk_bf16_f32 v51, v54, v55
v_fma_f32 v58, v58, s68, -v9
v_fma_f32 v59, v59, s68, -v9
v_exp_f32 v58, v58
v_exp_f32 v59, v59
v_add_f32 v13, v13, v56
v_add_f32 v13, v13, v57
v_cvt_pk_bf16_f32 v52, v56, v57
v_fma_f32 v60, v60, s68, -v9
v_fma_f32 v61, v61, s68, -v9
v_exp_f32 v60, v60
v_exp_f32 v61, v61
v_add_f32 v13, v13, v58
v_add_f32 v13, v13, v59
v_cvt_pk_bf16_f32 v53, v58, v59
v_fma_f32 v62, v62, s68, -v9
v_fma_f32 v63, v63, s68, -v9
v_exp_f32 v62, v62
v_exp_f32 v63, v63
v_add_f32 v13, v13, v60
v_add_f32 v13, v13, v61
v_cvt_pk_bf16_f32 v54, v60, v61
s_nop 0
v_add_f32 v13, v13, v62
v_add_f32 v13, v13, v63
v_cvt_pk_bf16_f32 v55, v62, v63
s_add_u32 s37, s35, 16384
s_cmp_lg_u32 s53, 0
s_cselect_b32 s43, s48, 0x2000000
s_add_u32 s44, s43, 4096
s_waitcnt vmcnt(7)
v_mfma_f32_32x32x16_bf16 v[128:143], a[128:131], v[32:35], 0
ds_read_b128 a[0:3], v5
ds_read_b128 a[4:7], v5 offset:1024
ds_read_b128 a[8:11], v5 offset:2048
v_mfma_f32_32x32x16_bf16 v[144:159], a[128:131], v[48:51], 0
s_add_u32 s45, s37, s66
buffer_load_dwordx4 a[128:131], v5, s[16:19], s45 offen sc1
ds_read_b128 a[12:15], v5 offset:3072
ds_read_b128 a[16:19], v5 offset:4096
s_waitcnt vmcnt(7)
v_mfma_f32_32x32x16_bf16 v[128:143], a[132:135], v[36:39], v[128:143]
ds_read_b128 a[20:23], v5 offset:5120
ds_read_b128 a[24:27], v5 offset:6144
ds_read_b128 a[28:31], v5 offset:7168
v_mfma_f32_32x32x16_bf16 v[144:159], a[132:135], v[52:55], v[144:159]
buffer_load_dwordx4 a[132:135], v5, s[16:19], s45 offen offset:1024 sc1
ds_read_b128 a[32:35], v5 offset:8192
ds_read_b128 a[36:39], v5 offset:9216
ds_read_b128 a[40:43], v5 offset:10240
s_waitcnt vmcnt(7)
v_mfma_f32_32x32x16_bf16 v[160:175], a[136:139], v[32:35], 0
ds_read_b128 a[44:47], v5 offset:11264
ds_read_b128 a[48:51], v5 offset:12288
v_mfma_f32_32x32x16_bf16 v[176:191], a[136:139], v[48:51], 0
buffer_load_dwordx4 a[136:139], v5, s[16:19], s45 offen offset:2048 sc1
ds_read_b128 a[52:55], v5 offset:13312
ds_read_b128 a[56:59], v5 offset:14336
ds_read_b128 a[60:63], v5 offset:15360
s_waitcnt vmcnt(7)
v_mfma_f32_32x32x16_bf16 v[160:175], a[140:143], v[36:39], v[160:175]
ds_read_b128 a[64:67], v5 offset:16384
ds_read_b128 a[68:71], v5 offset:17408
ds_read_b128 a[72:75], v5 offset:18432
v_mfma_f32_32x32x16_bf16 v[176:191], a[140:143], v[52:55], v[176:191]
buffer_load_dwordx4 a[140:143], v5, s[16:19], s45 offen offset:3072 sc1
ds_read_b128 a[76:79], v5 offset:19456
ds_read_b128 a[80:83], v5 offset:20480
s_waitcnt vmcnt(7)
v_mfma_f32_32x32x16_bf16 v[192:207], a[144:147], v[32:35], 0
ds_read_b128 a[84:87], v5 offset:21504
ds_read_b128 a[88:91], v5 offset:22528
ds_read_b128 a[92:95], v5 offset:23552
v_mfma_f32_32x32x16_bf16 v[208:223], a[144:147], v[48:51], 0
s_add_u32 s45, s37, s67
buffer_load_dwordx4 a[144:147], v5, s[16:19], s45 offen sc1
ds_read_b128 a[96:99], v5 offset:24576
ds_read_b128 a[100:103], v5 offset:25600
ds_read_b128 a[104:107], v5 offset:26624
s_waitcnt vmcnt(7)
v_mfma_f32_32x32x16_bf16 v[192:207], a[148:151], v[36:39], v[192:207]
ds_read_b128 a[108:111], v5 offset:27648
ds_read_b128 a[112:115], v5 offset:28672
v_mfma_f32_32x32x16_bf16 v[208:223], a[148:151], v[52:55], v[208:223]
buffer_load_dwordx4 a[148:151], v5, s[16:19], s45 offen offset:1024 sc1
ds_read_b128 a[116:119], v5 offset:29696
ds_read_b128 a[120:123], v5 offset:30720
ds_read_b128 a[124:127], v5 offset:31744
s_waitcnt vmcnt(7)
v_mfma_f32_32x32x16_bf16 v[224:239], a[152:155], v[32:35], 0
v_cvt_pk_bf16_f32 v128, v128, v129
v_cvt_pk_bf16_f32 v129, v130, v131
v_cvt_pk_bf16_f32 v130, v132, v133
v_cvt_pk_bf16_f32 v131, v134, v135
v_cvt_pk_bf16_f32 v132, v136, v137
v_mfma_f32_32x32x16_bf16 v[240:255], a[152:155], v[48:51], 0
buffer_load_dwordx4 a[152:155], v5, s[16:19], s45 offen offset:2048 sc1
v_cvt_pk_bf16_f32 v133, v138, v139
v_cvt_pk_bf16_f32 v134, v140, v141
v_cvt_pk_bf16_f32 v135, v142, v143
ds_write_b128 v28, v[128:131]
ds_write_b128 v28, v[132:135] offset:1024
s_waitcnt vmcnt(7)
v_mfma_f32_32x32x16_bf16 v[224:239], a[156:159], v[36:39], v[224:239]
v_cvt_pk_bf16_f32 v144, v144, v145
v_cvt_pk_bf16_f32 v145, v146, v147
v_cvt_pk_bf16_f32 v146, v148, v149
v_cvt_pk_bf16_f32 v147, v150, v151
v_cvt_pk_bf16_f32 v148, v152, v153
v_mfma_f32_32x32x16_bf16 v[240:255], a[156:159], v[52:55], v[240:255]
buffer_load_dwordx4 a[156:159], v5, s[16:19], s45 offen offset:3072 sc1
v_cvt_pk_bf16_f32 v149, v154, v155
v_cvt_pk_bf16_f32 v150, v156, v157
v_cvt_pk_bf16_f32 v151, v158, v159
ds_write_b128 v28, v[144:147] offset:2048
ds_write_b128 v28, v[148:151] offset:3072
s_waitcnt vmcnt(7)
v_mfma_f32_32x32x16_bf16 v[96:111], a[128:131], v[32:35], 0
v_cvt_pk_bf16_f32 v160, v160, v161
v_cvt_pk_bf16_f32 v161, v162, v163
v_cvt_pk_bf16_f32 v162, v164, v165
v_cvt_pk_bf16_f32 v163, v166, v167
v_cvt_pk_bf16_f32 v164, v168, v169
v_mfma_f32_32x32x16_bf16 v[112:127], a[128:131], v[48:51], 0
buffer_load_dwordx4 a[128:131], v5, s[16:19], s43 offen sc1
v_cvt_pk_bf16_f32 v165, v170, v171
v_cvt_pk_bf16_f32 v166, v172, v173
v_cvt_pk_bf16_f32 v167, v174, v175
ds_write_b128 v28, v[160:163] offset:4096
ds_write_b128 v28, v[164:167] offset:5120
s_waitcnt vmcnt(7)
v_mfma_f32_32x32x16_bf16 v[96:111], a[132:135], v[36:39], v[96:111]
v_cvt_pk_bf16_f32 v176, v176, v177
v_cvt_pk_bf16_f32 v177, v178, v179
v_cvt_pk_bf16_f32 v178, v180, v181
v_cvt_pk_bf16_f32 v179, v182, v183
v_cvt_pk_bf16_f32 v180, v184, v185
v_mfma_f32_32x32x16_bf16 v[112:127], a[132:135], v[52:55], v[112:127]
buffer_load_dwordx4 a[132:135], v5, s[16:19], s43 offen offset:1024 sc1
v_cvt_pk_bf16_f32 v181, v186, v187
v_cvt_pk_bf16_f32 v182, v188, v189
v_cvt_pk_bf16_f32 v183, v190, v191
ds_write_b128 v28, v[176:179] offset:6144
ds_write_b128 v28, v[180:183] offset:7168
s_waitcnt vmcnt(7)
v_mfma_f32_32x32x16_bf16 a[160:175], a[136:139], v[32:35], 0
v_cvt_pk_bf16_f32 v192, v192, v193
v_cvt_pk_bf16_f32 v193, v194, v195
v_cvt_pk_bf16_f32 v194, v196, v197
v_mfma_f32_32x32x16_bf16 a[176:191], a[136:139], v[48:51], 0
buffer_load_dwordx4 a[136:139], v5, s[16:19], s43 offen offset:2048 sc1
v_cvt_pk_bf16_f32 v195, v198, v199
v_cvt_pk_bf16_f32 v196, v200, v201
v_cvt_pk_bf16_f32 v197, v202, v203
v_cvt_pk_bf16_f32 v198, v204, v205
s_waitcnt vmcnt(7)
v_mfma_f32_32x32x16_bf16 a[160:175], a[140:143], v[36:39], a[160:175]
v_cvt_pk_bf16_f32 v199, v206, v207
ds_write_b128 v28, v[192:195] offset:8192
ds_write_b128 v28, v[196:199] offset:9216
v_mfma_f32_32x32x16_bf16 a[176:191], a[140:143], v[52:55], a[176:191]
buffer_load_dwordx4 a[140:143], v5, s[16:19], s43 offen offset:3072 sc1
v_cvt_pk_bf16_f32 v208, v208, v209
v_cvt_pk_bf16_f32 v209, v210, v211
v_cvt_pk_bf16_f32 v210, v212, v213
s_waitcnt vmcnt(7)
v_mfma_f32_32x32x16_bf16 a[192:207], a[144:147], v[32:35], 0
v_cvt_pk_bf16_f32 v211, v214, v215
v_cvt_pk_bf16_f32 v212, v216, v217
v_cvt_pk_bf16_f32 v213, v218, v219
v_cvt_pk_bf16_f32 v214, v220, v221
v_mfma_f32_32x32x16_bf16 a[208:223], a[144:147], v[48:51], 0
buffer_load_dwordx4 a[144:147], v5, s[16:19], s44 offen sc1
v_cvt_pk_bf16_f32 v215, v222, v223
ds_write_b128 v28, v[208:211] offset:10240
ds_write_b128 v28, v[212:215] offset:11264
s_waitcnt vmcnt(7)
v_mfma_f32_32x32x16_bf16 a[192:207], a[148:151], v[36:39], a[192:207]
v_cvt_pk_bf16_f32 v224, v224, v225
v_cvt_pk_bf16_f32 v225, v226, v227
v_cvt_pk_bf16_f32 v226, v228, v229
v_mfma_f32_32x32x16_bf16 a[208:223], a[148:151], v[52:55], a[208:223]
buffer_load_dwordx4 a[148:151], v5, s[16:19], s44 offen offset:1024 sc1
v_cvt_pk_bf16_f32 v227, v230, v231
v_cvt_pk_bf16_f32 v228, v232, v233
v_cvt_pk_bf16_f32 v229, v234, v235
v_cvt_pk_bf16_f32 v230, v236, v237
s_waitcnt vmcnt(7)
v_mfma_f32_32x32x16_bf16 a[224:239], a[152:155], v[32:35], 0
v_cvt_pk_bf16_f32 v231, v238, v239
ds_write_b128 v28, v[224:227] offset:12288
ds_write_b128 v28, v[228:231] offset:13312
v_mfma_f32_32x32x16_bf16 a[240:255], a[152:155], v[48:51], 0
buffer_load_dwordx4 a[152:155], v5, s[16:19], s44 offen offset:2048 sc1
v_cvt_pk_bf16_f32 v240, v240, v241
v_cvt_pk_bf16_f32 v241, v242, v243
v_cvt_pk_bf16_f32 v242, v244, v245
s_waitcnt vmcnt(7)
v_mfma_f32_32x32x16_bf16 a[224:239], a[156:159], v[36:39], a[224:239]
v_cvt_pk_bf16_f32 v243, v246, v247
v_cvt_pk_bf16_f32 v244, v248, v249
v_cvt_pk_bf16_f32 v245, v250, v251
v_cvt_pk_bf16_f32 v246, v252, v253
v_mfma_f32_32x32x16_bf16 a[240:255], a[156:159], v[52:55], a[240:255]
buffer_load_dwordx4 a[156:159], v5, s[16:19], s44 offen offset:3072 sc1
v_cvt_pk_bf16_f32 v247, v254, v255
ds_write_b128 v28, v[240:243] offset:14336
ds_write_b128 v28, v[244:247] offset:15360
PC_SEGEND:
v_mov_b32 v4, v12
s_nop 1
v_permlane32_swap_b32 v12, v4
v_add_f32 v12, v12, v4
v_mov_b32 v6, v13
s_nop 1
v_permlane32_swap_b32 v13, v6
v_add_f32 v13, v13, v6
s_cmp_eq_u32 s49, 0
s_cbranch_scc1 PC_NODUMP
s_lshl_b32 s45, s3, 3
s_add_u32 s45, s45, 16
v_add_u32 v4, s45, v3
v_mov_b32 v64, v18
v_mov_b32 v65, v12
ds_write_b64 v4, v[64:65]
v_mov_b32 v66, v19
v_mov_b32 v67, v13
ds_write_b64 v4, v[66:67] offset:2048
v_xor_b32 v7, 0x4000, v28
s_mov_b32 s34, 1
s_cmp_eq_u32 s53, 0
s_cbranch_scc1 PC_EMPTIED
s_mov_b32 s7, s53
s_mov_b32 s53, 0
s_mov_b32 s52, 1
s_mov_b32 s40, 0
s_mov_b32 s35, s48
s_sub_u32 s6, 31, s5
s_cmp_eq_u32 s34, 0
s_cselect_b32 s6, s6, s5
s_lshl_b32 s41, s6, 1
s_mov_b32 s42, 0
v_mov_b32 v12, 0
v_mov_b32 v13, 0
s_lshr_b32 s43, s3, 1
s_mul_i32 s43, s43, 98304
s_and_b32 s45, s3, 1
s_lshl_b32 s45, s45, 14
s_add_u32 s45, s45, s43
s_add_u32 s45, s45, 32768
s_lshl_b32 s43, s3, 15
s_lshl_b32 s44, s64, 1
s_add_u32 s43, s43, s44
s_lshr_b32 s44, s3, 1
s_xor_b32 s49, s34, 1
s_and_b32 s49, s49, s44
s_cselect_b32 s45, s43, s45
v_add_u32 v28, s45, v5
s_mov_b32 s36, s35
s_add_u32 s43, s35, 32768
s_add_u32 s44, s35, 36864
s_add_u32 s45, s35, 16384
s_add_u32 s38, s45, s64
s_add_u32 s39, s45, s65
s_cmp_gt_u32 s7, 1
s_cselect_b32 s43, s43, s38
s_cselect_b32 s44, s44, s39
s_waitcnt lgkmcnt(0)
s_waitcnt vmcnt(7)
v_mfma_f32_32x32x16_bf16 v[32:47], a[128:131], a[0:3], 0
v_cvt_pk_bf16_f32 v96, v96, v97
v_cvt_pk_bf16_f32 v97, v98, v99
v_cvt_pk_bf16_f32 v98, v100, v101
v_cvt_pk_bf16_f32 v99, v102, v103
v_cvt_pk_bf16_f32 v100, v104, v105
v_cvt_pk_bf16_f32 v101, v106, v107
v_mfma_f32_32x32x16_bf16 v[48:63], a[128:131], a[64:67], 0
s_add_u32 s45, s36, 8192
buffer_load_dwordx4 a[128:131], v5, s[16:19], s45 offen sc1
v_cvt_pk_bf16_f32 v102, v108, v109
v_cvt_pk_bf16_f32 v103, v110, v111
ds_write_b128 v7, v[96:99]
ds_write_b128 v7, v[100:103] offset:1024
v_cvt_pk_bf16_f32 v112, v112, v113
s_waitcnt vmcnt(7)
v_mfma_f32_32x32x16_bf16 v[32:47], a[132:135], a[4:7], v[32:47]
v_cvt_pk_bf16_f32 v113, v114, v115
v_cvt_pk_bf16_f32 v114, v116, v117
v_cvt_pk_bf16_f32 v115, v118, v119
v_cvt_pk_bf16_f32 v116, v120, v121
v_cvt_pk_bf16_f32 v117, v122, v123
v_cvt_pk_bf16_f32 v118, v124, v125
v_mfma_f32_32x32x16_bf16 v[48:63], a[132:135], a[68:71], v[48:63]
buffer_load_dwordx4 a[132:135], v5, s[16:19], s45 offen offset:1024 sc1
v_cvt_pk_bf16_f32 v119, v126, v127
ds_write_b128 v7, v[112:115] offset:2048
ds_write_b128 v7, v[116:119] offset:3072
v_accvgpr_read_b32 v64, a160
v_accvgpr_read_b32 v65, a161
s_waitcnt vmcnt(7)
v_mfma_f32_32x32x16_bf16 v[32:47], a[136:139], a[8:11], v[32:47]
v_accvgpr_read_b32 v66, a162
v_accvgpr_read_b32 v67, a163
v_accvgpr_read_b32 v68, a164
v_accvgpr_read_b32 v69, a165
v_accvgpr_read_b32 v70, a166
v_accvgpr_read_b32 v71, a167
v_mfma_f32_32x32x16_bf16 v[48:63], a[136:139], a[72:75], v[48:63]
buffer_load_dwordx4 a[136:139], v5, s[16:19], s45 offen offset:2048 sc1
v_accvgpr_read_b32 v72, a168
v_accvgpr_read_b32 v73, a169
v_accvgpr_read_b32 v74, a170
v_accvgpr_read_b32 v75, a171
v_accvgpr_read_b32 v76, a172
s_waitcnt vmcnt(7)
v_mfma_f32_32x32x16_bf16 v[32:47], a[140:143], a[12:15], v[32:47]
v_accvgpr_read_b32 v77, a173
v_accvgpr_read_b32 v78, a174
v_accvgpr_read_b32 v79, a175
v_cvt_pk_bf16_f32 v64, v64, v65
v_cvt_pk_bf16_f32 v65, v66, v67
v_cvt_pk_bf16_f32 v66, v68, v69
v_mfma_f32_32x32x16_bf16 v[48:63], a[140:143], a[76:79], v[48:63]
buffer_load_dwordx4 a[140:143], v5, s[16:19], s45 offen offset:3072 sc1
v_cvt_pk_bf16_f32 v67, v70, v71
v_cvt_pk_bf16_f32 v68, v72, v73
v_cvt_pk_bf16_f32 v69, v74, v75
v_cvt_pk_bf16_f32 v70, v76, v77
v_cvt_pk_bf16_f32 v71, v78, v79
s_waitcnt vmcnt(7)
v_mfma_f32_32x32x16_bf16 v[32:47], a[144:147], a[16:19], v[32:47]
ds_write_b128 v7, v[64:67] offset:4096
ds_write_b128 v7, v[68:71] offset:5120
v_accvgpr_read_b32 v80, a176
v_accvgpr_read_b32 v81, a177
v_accvgpr_read_b32 v82, a178
v_accvgpr_read_b32 v83, a179
v_mfma_f32_32x32x16_bf16 v[48:63], a[144:147], a[80:83], v[48:63]
s_add_u32 s45, s36, 12288
buffer_load_dwordx4 a[144:147], v5, s[16:19], s45 offen sc1
v_accvgpr_read_b32 v84, a180
v_accvgpr_read_b32 v85, a181
v_accvgpr_read_b32 v86, a182
v_accvgpr_read_b32 v87, a183
v_accvgpr_read_b32 v88, a184
s_waitcnt vmcnt(7)
v_mfma_f32_32x32x16_bf16 v[32:47], a[148:151], a[20:23], v[32:47]
v_accvgpr_read_b32 v89, a185
v_accvgpr_read_b32 v90, a186
v_accvgpr_read_b32 v91, a187
v_accvgpr_read_b32 v92, a188
v_accvgpr_read_b32 v93, a189
v_accvgpr_read_b32 v94, a190
v_mfma_f32_32x32x16_bf16 v[48:63], a[148:151], a[84:87], v[48:63]
buffer_load_dwordx4 a[148:151], v5, s[16:19], s45 offen offset:1024 sc1
v_accvgpr_read_b32 v95, a191
v_cvt_pk_bf16_f32 v80, v80, v81
v_cvt_pk_bf16_f32 v81, v82, v83
v_cvt_pk_bf16_f32 v82, v84, v85
v_cvt_pk_bf16_f32 v83, v86, v87
s_waitcnt vmcnt(7)
v_mfma_f32_32x32x16_bf16 v[32:47], a[152:155], a[24:27], v[32:47]
v_cvt_pk_bf16_f32 v84, v88, v89
v_cvt_pk_bf16_f32 v85, v90, v91
v_cvt_pk_bf16_f32 v86, v92, v93
v_cvt_pk_bf16_f32 v87, v94, v95
ds_write_b128 v7, v[80:83] offset:6144
ds_write_b128 v7, v[84:87] offset:7168
v_mfma_f32_32x32x16_bf16 v[48:63], a[152:155], a[88:91], v[48:63]
buffer_load_dwordx4 a[152:155], v5, s[16:19], s45 offen offset:2048 sc1
v_accvgpr_read_b32 v64, a192
v_accvgpr_read_b32 v65, a193
v_accvgpr_read_b32 v66, a194
v_accvgpr_read_b32 v67, a195
v_accvgpr_read_b32 v68, a196
s_waitcnt vmcnt(7)
v_mfma_f32_32x32x16_bf16 v[32:47], a[156:159], a[28:31], v[32:47]
v_accvgpr_read_b32 v69, a197
v_accvgpr_read_b32 v70, a198
v_accvgpr_read_b32 v71, a199
v_accvgpr_read_b32 v72, a200
v_accvgpr_read_b32 v73, a201
v_accvgpr_read_b32 v74, a202
v_mfma_f32_32x32x16_bf16 v[48:63], a[156:159], a[92:95], v[48:63]
buffer_load_dwordx4 a[156:159], v5, s[16:19], s45 offen offset:3072 sc1
v_accvgpr_read_b32 v75, a203
v_accvgpr_read_b32 v76, a204
v_accvgpr_read_b32 v77, a205
v_accvgpr_read_b32 v78, a206
v_accvgpr_read_b32 v79, a207
s_waitcnt vmcnt(7)
v_mfma_f32_32x32x16_bf16 v[32:47], a[128:131], a[32:35], v[32:47]
v_cvt_pk_bf16_f32 v64, v64, v65
v_cvt_pk_bf16_f32 v65, v66, v67
v_cvt_pk_bf16_f32 v66, v68, v69
v_cvt_pk_bf16_f32 v67, v70, v71
v_cvt_pk_bf16_f32 v68, v72, v73
v_cvt_pk_bf16_f32 v69, v74, v75
v_mfma_f32_32x32x16_bf16 v[48:63], a[128:131], a[96:99], v[48:63]
buffer_load_dwordx4 a[128:131], v5, s[16:19], s43 offen sc1
v_cvt_pk_bf16_f32 v70, v76, v77
v_cvt_pk_bf16_f32 v71, v78, v79
ds_write_b128 v7, v[64:67] offset:8192
ds_write_b128 v7, v[68:71] offset:9216
v_accvgpr_read_b32 v80, a208
s_waitcnt vmcnt(7)
v_mfma_f32_32x32x16_bf16 v[32:47], a[132:135], a[36:39], v[32:47]
v_accvgpr_read_b32 v81, a209
v_accvgpr_read_b32 v82, a210
v_accvgpr_read_b32 v83, a211
v_accvgpr_read_b32 v84, a212
v_accvgpr_read_b32 v85, a213
v_accvgpr_read_b32 v86, a214
v_mfma_f32_32x32x16_bf16 v[48:63], a[132:135], a[100:103], v[48:63]
buffer_load_dwordx4 a[132:135], v5, s[16:19], s43 offen offset:1024 sc1
v_accvgpr_read_b32 v87, a215
v_accvgpr_read_b32 v88, a216
v_accvgpr_read_b32 v89, a217
v_accvgpr_read_b32 v90, a218
v_accvgpr_read_b32 v91, a219
s_waitcnt vmcnt(7)
v_mfma_f32_32x32x16_bf16 v[32:47], a[136:139], a[40:43], v[32:47]
v_accvgpr_read_b32 v92, a220
v_accvgpr_read_b32 v93, a221
v_accvgpr_read_b32 v94, a222
v_accvgpr_read_b32 v95, a223
v_cvt_pk_bf16_f32 v80, v80, v81
v_cvt_pk_bf16_f32 v81, v82, v83
v_mfma_f32_32x32x16_bf16 v[48:63], a[136:139], a[104:107], v[48:63]
buffer_load_dwordx4 a[136:139], v5, s[16:19], s43 offen offset:2048 sc1
v_cvt_pk_bf16_f32 v82, v84, v85
v_cvt_pk_bf16_f32 v83, v86, v87
v_cvt_pk_bf16_f32 v84, v88, v89
v_cvt_pk_bf16_f32 v85, v90, v91
v_cvt_pk_bf16_f32 v86, v92, v93
s_waitcnt vmcnt(7)
v_mfma_f32_32x32x16_bf16 v[32:47], a[140:143], a[44:47], v[32:47]
v_cvt_pk_bf16_f32 v87, v94, v95
ds_write_b128 v7, v[80:83] offset:10240
ds_write_b128 v7, v[84:87] offset:11264
v_accvgpr_read_b32 v64, a224
v_accvgpr_read_b32 v65, a225
v_accvgpr_read_b32 v66, a226
v_mfma_f32_32x32x16_bf16 v[48:63], a[140:143], a[108:111], v[48:63]
buffer_load_dwordx4 a[140:143], v5, s[16:19], s43 offen offset:3072 sc1
v_accvgpr_read_b32 v67, a227
v_accvgpr_read_b32 v68, a228
v_accvgpr_read_b32 v69, a229
v_accvgpr_read_b32 v70, a230
v_accvgpr_read_b32 v71, a231
s_waitcnt vmcnt(7)
v_mfma_f32_32x32x16_bf16 v[32:47], a[144:147], a[48:51], v[32:47]
v_accvgpr_read_b32 v72, a232
v_accvgpr_read_b32 v73, a233
v_accvgpr_read_b32 v74, a234
v_accvgpr_read_b32 v75, a235
v_accvgpr_read_b32 v76, a236
v_accvgpr_read_b32 v77, a237
v_mfma_f32_32x32x16_bf16 v[48:63], a[144:147], a[112:115], v[48:63]
buffer_load_dwordx4 a[144:147], v5, s[16:19], s44 offen sc1
v_accvgpr_read_b32 v78, a238
v_accvgpr_read_b32 v79, a239
v_cvt_pk_bf16_f32 v64, v64, v65
v_cvt_pk_bf16_f32 v65, v66, v67
v_cvt_pk_bf16_f32 v66, v68, v69
s_waitcnt vmcnt(7)
v_mfma_f32_32x32x16_bf16 v[32:47], a[148:151], a[52:55], v[32:47]
v_cvt_pk_bf16_f32 v67, v70, v71
v_cvt_pk_bf16_f32 v68, v72, v73
v_cvt_pk_bf16_f32 v69, v74, v75
v_cvt_pk_bf16_f32 v70, v76, v77
v_cvt_pk_bf16_f32 v71, v78, v79
ds_write_b128 v7, v[64:67] offset:12288
v_mfma_f32_32x32x16_bf16 v[48:63], a[148:151], a[116:119], v[48:63]
buffer_load_dwordx4 a[148:151], v5, s[16:19], s44 offen offset:1024 sc1
ds_write_b128 v7, v[68:71] offset:13312
v_accvgpr_read_b32 v80, a240
v_accvgpr_read_b32 v81, a241
v_accvgpr_read_b32 v82, a242
v_accvgpr_read_b32 v83, a243
s_waitcnt vmcnt(7)
v_mfma_f32_32x32x16_bf16 v[32:47], a[152:155], a[56:59], v[32:47]
v_accvgpr_read_b32 v84, a244
v_accvgpr_read_b32 v85, a245
v_accvgpr_read_b32 v86, a246
v_accvgpr_read_b32 v87, a247
v_accvgpr_read_b32 v88, a248
v_accvgpr_read_b32 v89, a249
v_mfma_f32_32x32x16_bf16 v[48:63], a[152:155], a[120:123], v[48:63]
buffer_load_dwordx4 a[152:155], v5, s[16:19], s44 offen offset:2048 sc1
v_accvgpr_read_b32 v90, a250
v_accvgpr_read_b32 v91, a251
v_accvgpr_read_b32 v92, a252
v_accvgpr_read_b32 v93, a253
v_accvgpr_read_b32 v94, a254
s_waitcnt vmcnt(7)
v_mfma_f32_32x32x16_bf16 v[32:47], a[156:159], a[60:63], v[32:47]
v_accvgpr_read_b32 v95, a255
v_cvt_pk_bf16_f32 v80, v80, v81
v_cvt_pk_bf16_f32 v81, v82, v83
v_cvt_pk_bf16_f32 v82, v84, v85
v_cvt_pk_bf16_f32 v83, v86, v87
v_cvt_pk_bf16_f32 v84, v88, v89
v_mfma_f32_32x32x16_bf16 v[48:63], a[156:159], a[124:127], v[48:63]
buffer_load_dwordx4 a[156:159], v5, s[16:19], s44 offen offset:3072 sc1
v_cvt_pk_bf16_f32 v85, v90, v91
v_cvt_pk_bf16_f32 v86, v92, v93
v_cvt_pk_bf16_f32 v87, v94, v95
ds_write_b128 v7, v[80:83] offset:14336
ds_write_b128 v7, v[84:87] offset:15360
s_branch PC_X0DONE
PC_EMPTIED:
v_cvt_pk_bf16_f32 v96, v96, v97
v_cvt_pk_bf16_f32 v97, v98, v99
v_cvt_pk_bf16_f32 v98, v100, v101
v_cvt_pk_bf16_f32 v99, v102, v103
v_cvt_pk_bf16_f32 v100, v104, v105
v_cvt_pk_bf16_f32 v101, v106, v107
v_cvt_pk_bf16_f32 v102, v108, v109
v_cvt_pk_bf16_f32 v103, v110, v111
ds_write_b128 v7, v[96:99]
ds_write_b128 v7, v[100:103] offset:1024
v_cvt_pk_bf16_f32 v112, v112, v113
v_cvt_pk_bf16_f32 v113, v114, v115
v_cvt_pk_bf16_f32 v114, v116, v117
v_cvt_pk_bf16_f32 v115, v118, v119
v_cvt_pk_bf16_f32 v116, v120, v121
v_cvt_pk_bf16_f32 v117, v122, v123
v_cvt_pk_bf16_f32 v118, v124, v125
v_cvt_pk_bf16_f32 v119, v126, v127
ds_write_b128 v7, v[112:115] offset:2048
ds_write_b128 v7, v[116:119] offset:3072
v_accvgpr_read_b32 v32, a160
v_accvgpr_read_b32 v33, a161
v_accvgpr_read_b32 v34, a162
v_accvgpr_read_b32 v35, a163
v_accvgpr_read_b32 v36, a164
v_accvgpr_read_b32 v37, a165
v_accvgpr_read_b32 v38, a166
v_accvgpr_read_b32 v39, a167
v_accvgpr_read_b32 v40, a168
v_accvgpr_read_b32 v41, a169
v_accvgpr_read_b32 v42, a170
v_accvgpr_read_b32 v43, a171
v_accvgpr_read_b32 v44, a172
v_accvgpr_read_b32 v45, a173
v_accvgpr_read_b32 v46, a174
v_accvgpr_read_b32 v47, a175
v_cvt_pk_bf16_f32 v32, v32, v33
v_cvt_pk_bf16_f32 v33, v34, v35
v_cvt_pk_bf16_f32 v34, v36, v37
v_cvt_pk_bf16_f32 v35, v38, v39
v_cvt_pk_bf16_f32 v36, v40, v41
v_cvt_pk_bf16_f32 v37, v42, v43
v_cvt_pk_bf16_f32 v38, v44, v45
v_cvt_pk_bf16_f32 v39, v46, v47
ds_write_b128 v7, v[32:35] offset:4096
ds_write_b128 v7, v[36:39] offset:5120
v_accvgpr_read_b32 v48, a176
v_accvgpr_read_b32 v49, a177
v_accvgpr_read_b32 v50, a178
v_accvgpr_read_b32 v51, a179
v_accvgpr_read_b32 v52, a180
v_accvgpr_read_b32 v53, a181
v_accvgpr_read_b32 v54, a182
v_accvgpr_read_b32 v55, a183
v_accvgpr_read_b32 v56, a184
v_accvgpr_read_b32 v57, a185
v_accvgpr_read_b32 v58, a186
v_accvgpr_read_b32 v59, a187
v_accvgpr_read_b32 v60, a188
v_accvgpr_read_b32 v61, a189
v_accvgpr_read_b32 v62, a190
v_accvgpr_read_b32 v63, a191
v_cvt_pk_bf16_f32 v48, v48, v49
v_cvt_pk_bf16_f32 v49, v50, v51
v_cvt_pk_bf16_f32 v50, v52, v53
v_cvt_pk_bf16_f32 v51, v54, v55
v_cvt_pk_bf16_f32 v52, v56, v57
v_cvt_pk_bf16_f32 v53, v58, v59
v_cvt_pk_bf16_f32 v54, v60, v61
v_cvt_pk_bf16_f32 v55, v62, v63
ds_write_b128 v7, v[48:51] offset:6144
ds_write_b128 v7, v[52:55] offset:7168
v_accvgpr_read_b32 v32, a192
v_accvgpr_read_b32 v33, a193
v_accvgpr_read_b32 v34, a194
v_accvgpr_read_b32 v35, a195
v_accvgpr_read_b32 v36, a196
v_accvgpr_read_b32 v37, a197
v_accvgpr_read_b32 v38, a198
v_accvgpr_read_b32 v39, a199
v_accvgpr_read_b32 v40, a200
v_accvgpr_read_b32 v41, a201
v_accvgpr_read_b32 v42, a202
v_accvgpr_read_b32 v43, a203
v_accvgpr_read_b32 v44, a204
v_accvgpr_read_b32 v45, a205
v_accvgpr_read_b32 v46, a206
v_accvgpr_read_b32 v47, a207
v_cvt_pk_bf16_f32 v32, v32, v33
v_cvt_pk_bf16_f32 v33, v34, v35
v_cvt_pk_bf16_f32 v34, v36, v37
v_cvt_pk_bf16_f32 v35, v38, v39
v_cvt_pk_bf16_f32 v36, v40, v41
v_cvt_pk_bf16_f32 v37, v42, v43
v_cvt_pk_bf16_f32 v38, v44, v45
v_cvt_pk_bf16_f32 v39, v46, v47
ds_write_b128 v7, v[32:35] offset:8192
ds_write_b128 v7, v[36:39] offset:9216
v_accvgpr_read_b32 v48, a208
v_accvgpr_read_b32 v49, a209
v_accvgpr_read_b32 v50, a210
v_accvgpr_read_b32 v51, a211
v_accvgpr_read_b32 v52, a212
v_accvgpr_read_b32 v53, a213
v_accvgpr_read_b32 v54, a214
v_accvgpr_read_b32 v55, a215
v_accvgpr_read_b32 v56, a216
v_accvgpr_read_b32 v57, a217
v_accvgpr_read_b32 v58, a218
v_accvgpr_read_b32 v59, a219
v_accvgpr_read_b32 v60, a220
v_accvgpr_read_b32 v61, a221
v_accvgpr_read_b32 v62, a222
v_accvgpr_read_b32 v63, a223
v_cvt_pk_bf16_f32 v48, v48, v49
v_cvt_pk_bf16_f32 v49, v50, v51
v_cvt_pk_bf16_f32 v50, v52, v53
v_cvt_pk_bf16_f32 v51, v54, v55
v_cvt_pk_bf16_f32 v52, v56, v57
v_cvt_pk_bf16_f32 v53, v58, v59
v_cvt_pk_bf16_f32 v54, v60, v61
v_cvt_pk_bf16_f32 v55, v62, v63
ds_write_b128 v7, v[48:51] offset:10240
ds_write_b128 v7, v[52:55] offset:11264
v_accvgpr_read_b32 v32, a224
v_accvgpr_read_b32 v33, a225
v_accvgpr_read_b32 v34, a226
v_accvgpr_read_b32 v35, a227
v_accvgpr_read_b32 v36, a228
v_accvgpr_read_b32 v37, a229
v_accvgpr_read_b32 v38, a230
v_accvgpr_read_b32 v39, a231
v_accvgpr_read_b32 v40, a232
v_accvgpr_read_b32 v41, a233
v_accvgpr_read_b32 v42, a234
v_accvgpr_read_b32 v43, a235
v_accvgpr_read_b32 v44, a236
v_accvgpr_read_b32 v45, a237
v_accvgpr_read_b32 v46, a238
v_accvgpr_read_b32 v47, a239
v_cvt_pk_bf16_f32 v32, v32, v33
v_cvt_pk_bf16_f32 v33, v34, v35
v_cvt_pk_bf16_f32 v34, v36, v37
v_cvt_pk_bf16_f32 v35, v38, v39
v_cvt_pk_bf16_f32 v36, v40, v41
v_cvt_pk_bf16_f32 v37, v42, v43
v_cvt_pk_bf16_f32 v38, v44, v45
v_cvt_pk_bf16_f32 v39, v46, v47
ds_write_b128 v7, v[32:35] offset:12288
ds_write_b128 v7, v[36:39] offset:13312
v_accvgpr_read_b32 v48, a240
v_accvgpr_read_b32 v49, a241
v_accvgpr_read_b32 v50, a242
v_accvgpr_read_b32 v51, a243
v_accvgpr_read_b32 v52, a244
v_accvgpr_read_b32 v53, a245
v_accvgpr_read_b32 v54, a246
v_accvgpr_read_b32 v55, a247
v_accvgpr_read_b32 v56, a248
v_accvgpr_read_b32 v57, a249
v_accvgpr_read_b32 v58, a250
v_accvgpr_read_b32 v59, a251
v_accvgpr_read_b32 v60, a252
v_accvgpr_read_b32 v61, a253
v_accvgpr_read_b32 v62, a254
v_accvgpr_read_b32 v63, a255
v_cvt_pk_bf16_f32 v48, v48, v49
v_cvt_pk_bf16_f32 v49, v50, v51
v_cvt_pk_bf16_f32 v50, v52, v53
v_cvt_pk_bf16_f32 v51, v54, v55
v_cvt_pk_bf16_f32 v52, v56, v57
v_cvt_pk_bf16_f32 v53, v58, v59
v_cvt_pk_bf16_f32 v54, v60, v61
v_cvt_pk_bf16_f32 v55, v62, v63
ds_write_b128 v7, v[48:51] offset:14336
ds_write_b128 v7, v[52:55] offset:15360
v_mov_b32 v96, 0
v_mov_b32 v97, 0
v_mov_b32 v98, 0
v_mov_b32 v99, 0
v_mov_b32 v100, 0
v_mov_b32 v101, 0
v_mov_b32 v102, 0
v_mov_b32 v103, 0
v_mov_b32 v104, 0
v_mov_b32 v105, 0
v_mov_b32 v106, 0
v_mov_b32 v107, 0
v_mov_b32 v108, 0
v_mov_b32 v109, 0
v_mov_b32 v110, 0
v_mov_b32 v111, 0
v_mov_b32 v112, 0
v_mov_b32 v113, 0
v_mov_b32 v114, 0
v_mov_b32 v115, 0
v_mov_b32 v116, 0
v_mov_b32 v117, 0
v_mov_b32 v118, 0
v_mov_b32 v119, 0
v_mov_b32 v120, 0
v_mov_b32 v121, 0
v_mov_b32 v122, 0
v_mov_b32 v123, 0
v_mov_b32 v124, 0
v_mov_b32 v125, 0
v_mov_b32 v126, 0
v_mov_b32 v127, 0
v_accvgpr_write_b32 a160, 0
v_accvgpr_write_b32 a161, 0
v_accvgpr_write_b32 a162, 0
v_accvgpr_write_b32 a163, 0
v_accvgpr_write_b32 a164, 0
v_accvgpr_write_b32 a165, 0
v_accvgpr_write_b32 a166, 0
v_accvgpr_write_b32 a167, 0
v_accvgpr_write_b32 a168, 0
v_accvgpr_write_b32 a169, 0
v_accvgpr_write_b32 a170, 0
v_accvgpr_write_b32 a171, 0
v_accvgpr_write_b32 a172, 0
v_accvgpr_write_b32 a173, 0
v_accvgpr_write_b32 a174, 0
v_accvgpr_write_b32 a175, 0
v_accvgpr_write_b32 a176, 0
v_accvgpr_write_b32 a177, 0
v_accvgpr_write_b32 a178, 0
v_accvgpr_write_b32 a179, 0
v_accvgpr_write_b32 a180, 0
v_accvgpr_write_b32 a181, 0
v_accvgpr_write_b32 a182, 0
v_accvgpr_write_b32 a183, 0
v_accvgpr_write_b32 a184, 0
v_accvgpr_write_b32 a185, 0
v_accvgpr_write_b32 a186, 0
v_accvgpr_write_b32 a187, 0
v_accvgpr_write_b32 a188, 0
v_accvgpr_write_b32 a189, 0
v_accvgpr_write_b32 a190, 0
v_accvgpr_write_b32 a191, 0
v_accvgpr_write_b32 a192, 0
v_accvgpr_write_b32 a193, 0
v_accvgpr_write_b32 a194, 0
v_accvgpr_write_b32 a195, 0
v_accvgpr_write_b32 a196, 0
v_accvgpr_write_b32 a197, 0
v_accvgpr_write_b32 a198, 0
v_accvgpr_write_b32 a199, 0
v_accvgpr_write_b32 a200, 0
v_accvgpr_write_b32 a201, 0
v_accvgpr_write_b32 a202, 0
v_accvgpr_write_b32 a203, 0
v_accvgpr_write_b32 a204, 0
v_accvgpr_write_b32 a205, 0
v_accvgpr_write_b32 a206, 0
v_accvgpr_write_b32 a207, 0
v_accvgpr_write_b32 a208, 0
v_accvgpr_write_b32 a209, 0
v_accvgpr_write_b32 a210, 0
v_accvgpr_write_b32 a211, 0
v_accvgpr_write_b32 a212, 0
v_accvgpr_write_b32 a213, 0
v_accvgpr_write_b32 a214, 0
v_accvgpr_write_b32 a215, 0
v_accvgpr_write_b32 a216, 0
v_accvgpr_write_b32 a217, 0
v_accvgpr_write_b32 a218, 0
v_accvgpr_write_b32 a219, 0
v_accvgpr_write_b32 a220, 0
v_accvgpr_write_b32 a221, 0
v_accvgpr_write_b32 a222, 0
v_accvgpr_write_b32 a223, 0
v_accvgpr_write_b32 a224, 0
v_accvgpr_write_b32 a225, 0
v_accvgpr_write_b32 a226, 0
v_accvgpr_write_b32 a227, 0
v_accvgpr_write_b32 a228, 0
v_accvgpr_write_b32 a229, 0
v_accvgpr_write_b32 a230, 0
v_accvgpr_write_b32 a231, 0
v_accvgpr_write_b32 a232, 0
v_accvgpr_write_b32 a233, 0
v_accvgpr_write_b32 a234, 0
v_accvgpr_write_b32 a235, 0
v_accvgpr_write_b32 a236, 0
v_accvgpr_write_b32 a237, 0
v_accvgpr_write_b32 a238, 0
v_accvgpr_write_b32 a239, 0
v_accvgpr_write_b32 a240, 0
v_accvgpr_write_b32 a241, 0
v_accvgpr_write_b32 a242, 0
v_accvgpr_write_b32 a243, 0
v_accvgpr_write_b32 a244, 0
v_accvgpr_write_b32 a245, 0
v_accvgpr_write_b32 a246, 0
v_accvgpr_write_b32 a247, 0
v_accvgpr_write_b32 a248, 0
v_accvgpr_write_b32 a249, 0
v_accvgpr_write_b32 a250, 0
v_accvgpr_write_b32 a251, 0
v_accvgpr_write_b32 a252, 0
v_accvgpr_write_b32 a253, 0
v_accvgpr_write_b32 a254, 0
v_accvgpr_write_b32 a255, 0
v_mov_b32 v18, 0xf1800000
v_mov_b32 v12, 0
v_mov_b32 v19, 0xf1800000
v_mov_b32 v13, 0
PC_NODUMP:
s_lshl_b32 s45, s3, 3
v_add_u32 v4, s45, v3
v_mov_b32 v64, v18
v_mov_b32 v65, v12
ds_write_b64 v4, v[64:65]
v_mov_b32 v66, v19
v_mov_b32 v67, v13
ds_write_b64 v4, v[66:67] offset:2048
PC_SENT:
s_waitcnt lgkmcnt(0)
s_barrier
s_lshr_b32 s45, s3, 1
s_lshl_b32 s45, s45, 4
v_add_u32 v4, s45, v3
ds_read_b128 v[32:35], v4
ds_read_b128 v[36:39], v4 offset:32
ds_read_b128 v[40:43], v4 offset:2048
ds_read_b128 v[44:47], v4 offset:2080
s_cmp_ge_u32 s56, 50
s_cselect_b32 s57, 1, 0
s_cmp_eq_u32 s3, 3
s_cselect_b32 s58, s57, 0
s_cmp_eq_u32 s3, 2
s_cselect_b32 s57, s57, 0
s_cmp_gt_u32 s56, 34
s_cselect_b32 s59, 1, 0
s_cmp_gt_u32 s56, 50
s_cselect_b32 s60, 1, 0
s_cmp_lt_u32 s3, 2
s_cselect_b32 s59, s59, 0
s_cselect_b32 s60, s60, 0
s_and_b32 s45, s3, 1
s_cmp_eq_u32 s45, 1
s_cselect_b64 s[62:63], -1, 0
s_waitcnt lgkmcnt(0)
v_max3_f32 v4, v32, v34, v36
v_max_f32 v4, v4, v38
v_sub_f32 v32, v32, v4
v_mul_f32 v32, s68, v32
v_exp_f32 v32, v32
v_sub_f32 v34, v34, v4
v_mul_f32 v34, s68, v34
v_exp_f32 v34, v34
v_sub_f32 v36, v36, v4
v_mul_f32 v36, s68, v36
v_exp_f32 v36, v36
v_sub_f32 v38, v38, v4
v_mul_f32 v38, s68, v38
v_exp_f32 v38, v38
s_nop 0
v_mul_f32 v12, v32, v33
v_fmac_f32 v12, v34, v35
v_fmac_f32 v12, v36, v37
v_fmac_f32 v12, v38, v39
v_rcp_f32 v12, v12
v_cndmask_b32 v14, v32, v34, s[62:63]
v_cndmask_b32 v16, v34, v32, s[62:63]
v_max3_f32 v4, v40, v42, v44
v_max_f32 v4, v4, v46
v_sub_f32 v40, v40, v4
v_mul_f32 v40, s68, v40
v_exp_f32 v40, v40
v_sub_f32 v42, v42, v4
v_mul_f32 v42, s68, v42
v_exp_f32 v42, v42
v_sub_f32 v44, v44, v4
v_mul_f32 v44, s68, v44
v_exp_f32 v44, v44
v_sub_f32 v46, v46, v4
v_mul_f32 v46, s68, v46
v_exp_f32 v46, v46
s_nop 0
v_mul_f32 v13, v40, v41
v_fmac_f32 v13, v42, v43
v_fmac_f32 v13, v44, v45
v_fmac_f32 v13, v46, v47
v_rcp_f32 v13, v13
v_cndmask_b32 v15, v40, v42, s[62:63]
v_cndmask_b32 v17, v42, v40, s[62:63]
s_mov_b32 s42, 0
v_cmp_neq_f32 vcc, 1.0, v14
v_cmp_neq_f32 s[50:51], 1.0, v15
s_or_b64 s[50:51], vcc, s[50:51]
s_cselect_b32 s43, 1, 0
s_cmp_eq_u32 s57, 1
s_cselect_b32 s43, 0, s43
s_or_b32 s42, s42, s43
v_cmp_neq_f32 vcc, 1.0, v16
v_cmp_neq_f32 s[50:51], 1.0, v17
s_or_b64 s[50:51], vcc, s[50:51]
s_cselect_b32 s43, 1, 0
s_cmp_eq_u32 s58, 1
s_cselect_b32 s43, 0, s43
s_or_b32 s42, s42, s43
v_cmp_neq_f32 vcc, 1.0, v36
v_cmp_neq_f32 s[50:51], 1.0, v44
s_or_b64 s[50:51], vcc, s[50:51]
s_cselect_b32 s43, 1, 0
s_cmp_eq_u32 s59, 0
s_cselect_b32 s43, 0, s43
s_or_b32 s42, s42, s43
v_cmp_neq_f32 vcc, 1.0, v38
v_cmp_neq_f32 s[50:51], 1.0, v46
s_or_b64 s[50:51], vcc, s[50:51]
s_cselect_b32 s43, 1, 0
s_cmp_eq_u32 s60, 0
s_cselect_b32 s43, 0, s43
s_or_b32 s42, s42, s43
s_cmp_lg_u32 s42, 0
s_cbranch_scc1 PC_SLOW
s_xor_b32 s44, s3, 1
s_lshr_b32 s43, s44, 1
s_mul_i32 s43, s43, 98304
s_and_b32 s45, s44, 1
s_lshl_b32 s45, s45, 14
s_add_u32 s45, s45, s43
s_add_u32 s45, s45, 32768
s_cmp_eq_u32 s58, 0
s_cselect_b32 s45, s45, 0
s_cselect_b32 s36, -1, 0
v_add_u32 v4, s45, v5
s_lshl_b32 s45, s3, 14
s_add_u32 s45, s45, 65536
s_add_u32 s44, s45, 32768
s_cmp_lg_u32 s59, 0
s_cselect_b32 s45, s45, 0
s_cselect_b32 s37, -1, 0
v_add_u32 v6, s45, v5
s_cmp_lg_u32 s60, 0
s_cselect_b32 s44, s44, 0
s_cselect_b32 s38, -1, 0
v_add_u32 v7, s44, v5
s_nop 0
ds_read_b128 v[128:131], v4
ds_read_b128 v[132:135], v4 offset:1024
ds_read_b128 v[136:139], v6
ds_read_b128 v[140:143], v6 offset:1024
ds_read_b128 v[144:147], v7
ds_read_b128 v[148:151], v7 offset:1024
ds_read_b128 v[152:155], v4 offset:2048
ds_read_b128 v[156:159], v4 offset:3072
ds_read_b128 v[160:163], v6 offset:2048
ds_read_b128 v[164:167], v6 offset:3072
ds_read_b128 v[168:171], v7 offset:2048
ds_read_b128 v[172:175], v7 offset:3072
ds_read_b128 v[176:179], v4 offset:4096
ds_read_b128 v[180:183], v4 offset:5120
ds_read_b128 v[184:187], v6 offset:4096
ds_read_b128 v[188:191], v6 offset:5120
ds_read_b128 v[192:195], v7 offset:4096
ds_read_b128 v[196:199], v7 offset:5120
v_and_b32 v32, s36, v20
v_and_b32 v33, s36, v21
v_and_b32 v34, s36, v22
v_and_b32 v35, s36, v23
v_and_b32 v36, s36, v24
v_and_b32 v37, s36, v25
v_and_b32 v38, s36, v26
v_and_b32 v39, s36, v27
v_and_b32 v40, s37, v20
v_and_b32 v41, s37, v21
v_and_b32 v42, s37, v22
v_and_b32 v43, s37, v23
v_and_b32 v44, s37, v24
v_and_b32 v45, s37, v25
v_and_b32 v46, s37, v26
v_and_b32 v47, s37, v27
v_and_b32 v48, s38, v20
v_and_b32 v49, s38, v21
v_and_b32 v50, s38, v22
v_and_b32 v51, s38, v23
v_and_b32 v52, s38, v24
v_and_b32 v53, s38, v25
v_and_b32 v54, s38, v26
v_and_b32 v55, s38, v27
s_sub_u32 s6, 31, s5
s_cmp_lt_u32 s3, 2
s_cselect_b32 s6, s6, s5
s_lshl_b32 s45, s6, 19
s_lshl_b32 s43, s4, 14
s_add_u32 s45, s45, s43
s_and_b32 s43, s3, 1
s_lshl_b32 s43, s43, 13
s_add_u32 s45, s45, s43
s_add_u32 s44, s45, 262144
s_add_u32 s46, s45, 4096
s_add_u32 s47, s44, 4096
s_waitcnt lgkmcnt(12)
v_mfma_f32_32x32x16_bf16 v[96:111], v[32:35], v[128:131], v[96:111]
ds_read_b128 v[200:203], v4 offset:6144
v_mfma_f32_32x32x16_bf16 v[96:111], v[36:39], v[132:135], v[96:111]
ds_read_b128 v[204:207], v4 offset:7168
v_mfma_f32_32x32x16_bf16 v[96:111], v[40:43], v[136:139], v[96:111]
ds_read_b128 v[208:211], v6 offset:6144
v_mfma_f32_32x32x16_bf16 v[96:111], v[44:47], v[140:143], v[96:111]
ds_read_b128 v[212:215], v6 offset:7168
v_mfma_f32_32x32x16_bf16 v[96:111], v[48:51], v[144:147], v[96:111]
ds_read_b128 v[216:219], v7 offset:6144
v_mfma_f32_32x32x16_bf16 v[96:111], v[52:55], v[148:151], v[96:111]
ds_read_b128 v[220:223], v7 offset:7168
s_waitcnt lgkmcnt(12)
v_mfma_f32_32x32x16_bf16 v[112:127], v[32:35], v[152:155], v[112:127]
ds_read_b128 v[128:131], v4 offset:8192
v_mfma_f32_32x32x16_bf16 v[112:127], v[36:39], v[156:159], v[112:127]
ds_read_b128 v[132:135], v4 offset:9216
v_mfma_f32_32x32x16_bf16 v[112:127], v[40:43], v[160:163], v[112:127]
ds_read_b128 v[136:139], v6 offset:8192
v_mfma_f32_32x32x16_bf16 v[112:127], v[44:47], v[164:167], v[112:127]
ds_read_b128 v[140:143], v6 offset:9216
v_mfma_f32_32x32x16_bf16 v[112:127], v[48:51], v[168:171], v[112:127]
ds_read_b128 v[144:147], v7 offset:8192
v_mfma_f32_32x32x16_bf16 v[112:127], v[52:55], v[172:175], v[112:127]
ds_read_b128 v[148:151], v7 offset:9216
s_waitcnt lgkmcnt(12)
v_mfma_f32_32x32x16_bf16 a[160:175], v[32:35], v[176:179], a[160:175]
ds_read_b128 v[152:155], v4 offset:10240
ds_read_b128 v[156:159], v4 offset:11264
ds_read_b128 v[160:163], v6 offset:10240
ds_read_b128 v[164:167], v6 offset:11264
v_mfma_f32_32x32x16_bf16 a[160:175], v[36:39], v[180:183], a[160:175]
ds_read_b128 v[168:171], v7 offset:10240
ds_read_b128 v[172:175], v7 offset:11264
v_pk_mul_f32 v[64:65], v[96:97], v[12:13] op_sel:[0,0] op_sel_hi:[1,0]
v_pk_mul_f32 v[66:67], v[98:99], v[12:13] op_sel:[0,0] op_sel_hi:[1,0]
v_mfma_f32_32x32x16_bf16 a[160:175], v[40:43], v[184:187], a[160:175]
v_pk_mul_f32 v[68:69], v[100:101], v[12:13] op_sel:[0,0] op_sel_hi:[1,0]
v_pk_mul_f32 v[70:71], v[102:103], v[12:13] op_sel:[0,0] op_sel_hi:[1,0]
v_pk_mul_f32 v[72:73], v[104:105], v[12:13] op_sel:[0,0] op_sel_hi:[1,0]
v_pk_mul_f32 v[74:75], v[106:107], v[12:13] op_sel:[0,0] op_sel_hi:[1,0]
v_mfma_f32_32x32x16_bf16 a[160:175], v[44:47], v[188:191], a[160:175]
v_pk_mul_f32 v[76:77], v[108:109], v[12:13] op_sel:[0,0] op_sel_hi:[1,0]
v_pk_mul_f32 v[78:79], v[110:111], v[12:13] op_sel:[0,0] op_sel_hi:[1,0]
v_cvt_pk_bf16_f32 v64, v64, v65
v_cvt_pk_bf16_f32 v65, v66, v67
v_mfma_f32_32x32x16_bf16 a[160:175], v[48:51], v[192:195], a[160:175]
v_cvt_pk_bf16_f32 v66, v68, v69
v_cvt_pk_bf16_f32 v67, v70, v71
v_cvt_pk_bf16_f32 v68, v72, v73
v_cvt_pk_bf16_f32 v69, v74, v75
v_mfma_f32_32x32x16_bf16 a[160:175], v[52:55], v[196:199], a[160:175]
v_cvt_pk_bf16_f32 v70, v76, v77
v_cvt_pk_bf16_f32 v71, v78, v79
buffer_store_dwordx4 v[64:67], v5, s[20:23], s45 offen sc1
buffer_store_dwordx4 v[68:71], v5, s[20:23], s45 offen offset:1024 sc1
s_waitcnt lgkmcnt(12)
v_mfma_f32_32x32x16_bf16 a[176:191], v[32:35], v[200:203], a[176:191]
ds_read_b128 v[176:179], v4 offset:12288
ds_read_b128 v[180:183], v4 offset:13312
ds_read_b128 v[184:187], v6 offset:12288
ds_read_b128 v[188:191], v6 offset:13312
v_mfma_f32_32x32x16_bf16 a[176:191], v[36:39], v[204:207], a[176:191]
ds_read_b128 v[192:195], v7 offset:12288
ds_read_b128 v[196:199], v7 offset:13312
v_pk_mul_f32 v[80:81], v[112:113], v[12:13] op_sel:[0,1] op_sel_hi:[1,1]
v_pk_mul_f32 v[82:83], v[114:115], v[12:13] op_sel:[0,1] op_sel_hi:[1,1]
v_mfma_f32_32x32x16_bf16 a[176:191], v[40:43], v[208:211], a[176:191]
v_pk_mul_f32 v[84:85], v[116:117], v[12:13] op_sel:[0,1] op_sel_hi:[1,1]
v_pk_mul_f32 v[86:87], v[118:119], v[12:13] op_sel:[0,1] op_sel_hi:[1,1]
v_pk_mul_f32 v[88:89], v[120:121], v[12:13] op_sel:[0,1] op_sel_hi:[1,1]
v_pk_mul_f32 v[90:91], v[122:123], v[12:13] op_sel:[0,1] op_sel_hi:[1,1]
v_mfma_f32_32x32x16_bf16 a[176:191], v[44:47], v[212:215], a[176:191]
v_pk_mul_f32 v[92:93], v[124:125], v[12:13] op_sel:[0,1] op_sel_hi:[1,1]
v_pk_mul_f32 v[94:95], v[126:127], v[12:13] op_sel:[0,1] op_sel_hi:[1,1]
v_cvt_pk_bf16_f32 v80, v80, v81
v_cvt_pk_bf16_f32 v81, v82, v83
v_mfma_f32_32x32x16_bf16 a[176:191], v[48:51], v[216:219], a[176:191]
v_cvt_pk_bf16_f32 v82, v84, v85
v_cvt_pk_bf16_f32 v83, v86, v87
v_cvt_pk_bf16_f32 v84, v88, v89
v_cvt_pk_bf16_f32 v85, v90, v91
v_mfma_f32_32x32x16_bf16 a[176:191], v[52:55], v[220:223], a[176:191]
v_cvt_pk_bf16_f32 v86, v92, v93
v_cvt_pk_bf16_f32 v87, v94, v95
buffer_store_dwordx4 v[80:83], v5, s[20:23], s44 offen sc1
buffer_store_dwordx4 v[84:87], v5, s[20:23], s44 offen offset:1024 sc1
s_waitcnt lgkmcnt(12)
v_mfma_f32_32x32x16_bf16 a[192:207], v[32:35], v[128:131], a[192:207]
ds_read_b128 v[200:203], v4 offset:14336
ds_read_b128 v[204:207], v4 offset:15360
ds_read_b128 v[208:211], v6 offset:14336
ds_read_b128 v[212:215], v6 offset:15360
ds_read_b128 v[216:219], v7 offset:14336
ds_read_b128 v[220:223], v7 offset:15360
v_accvgpr_read_b32 v64, a160
v_mfma_f32_32x32x16_bf16 a[192:207], v[36:39], v[132:135], a[192:207]
v_accvgpr_read_b32 v65, a161
v_accvgpr_read_b32 v66, a162
v_accvgpr_read_b32 v67, a163
v_accvgpr_read_b32 v68, a164
v_accvgpr_read_b32 v69, a165
v_accvgpr_read_b32 v70, a166
v_mfma_f32_32x32x16_bf16 a[192:207], v[40:43], v[136:139], a[192:207]
v_accvgpr_read_b32 v71, a167
v_accvgpr_read_b32 v72, a168
v_accvgpr_read_b32 v73, a169
v_accvgpr_read_b32 v74, a170
v_accvgpr_read_b32 v75, a171
v_accvgpr_read_b32 v76, a172
v_accvgpr_read_b32 v77, a173
v_mfma_f32_32x32x16_bf16 a[192:207], v[44:47], v[140:143], a[192:207]
v_accvgpr_read_b32 v78, a174
v_accvgpr_read_b32 v79, a175
v_pk_mul_f32 v[64:65], v[64:65], v[12:13] op_sel:[0,0] op_sel_hi:[1,0]
v_pk_mul_f32 v[66:67], v[66:67], v[12:13] op_sel:[0,0] op_sel_hi:[1,0]
v_pk_mul_f32 v[68:69], v[68:69], v[12:13] op_sel:[0,0] op_sel_hi:[1,0]
v_pk_mul_f32 v[70:71], v[70:71], v[12:13] op_sel:[0,0] op_sel_hi:[1,0]
v_pk_mul_f32 v[72:73], v[72:73], v[12:13] op_sel:[0,0] op_sel_hi:[1,0]
v_mfma_f32_32x32x16_bf16 a[192:207], v[48:51], v[144:147], a[192:207]
v_pk_mul_f32 v[74:75], v[74:75], v[12:13] op_sel:[0,0] op_sel_hi:[1,0]
v_pk_mul_f32 v[76:77], v[76:77], v[12:13] op_sel:[0,0] op_sel_hi:[1,0]
v_pk_mul_f32 v[78:79], v[78:79], v[12:13] op_sel:[0,0] op_sel_hi:[1,0]
v_cvt_pk_bf16_f32 v64, v64, v65
v_cvt_pk_bf16_f32 v65, v66, v67
v_cvt_pk_bf16_f32 v66, v68, v69
v_mfma_f32_32x32x16_bf16 a[192:207], v[52:55], v[148:151], a[192:207]
v_cvt_pk_bf16_f32 v67, v70, v71
v_cvt_pk_bf16_f32 v68, v72, v73
v_cvt_pk_bf16_f32 v69, v74, v75
v_cvt_pk_bf16_f32 v70, v76, v77
v_cvt_pk_bf16_f32 v71, v78, v79
buffer_store_dwordx4 v[64:67], v5, s[20:23], s45 offen offset:2048 sc1
buffer_store_dwordx4 v[68:71], v5, s[20:23], s45 offen offset:3072 sc1
s_waitcnt lgkmcnt(12)
s_nop 0
v_mfma_f32_32x32x16_bf16 a[208:223], v[32:35], v[152:155], a[208:223]
v_accvgpr_read_b32 v80, a176
v_accvgpr_read_b32 v81, a177
v_accvgpr_read_b32 v82, a178
v_accvgpr_read_b32 v83, a179
v_accvgpr_read_b32 v84, a180
v_accvgpr_read_b32 v85, a181
v_mfma_f32_32x32x16_bf16 a[208:223], v[36:39], v[156:159], a[208:223]
v_accvgpr_read_b32 v86, a182
v_accvgpr_read_b32 v87, a183
v_accvgpr_read_b32 v88, a184
v_accvgpr_read_b32 v89, a185
v_accvgpr_read_b32 v90, a186
v_mfma_f32_32x32x16_bf16 a[208:223], v[40:43], v[160:163], a[208:223]
v_accvgpr_read_b32 v91, a187
v_accvgpr_read_b32 v92, a188
v_accvgpr_read_b32 v93, a189
v_accvgpr_read_b32 v94, a190
v_accvgpr_read_b32 v95, a191
v_pk_mul_f32 v[80:81], v[80:81], v[12:13] op_sel:[0,1] op_sel_hi:[1,1]
v_mfma_f32_32x32x16_bf16 a[208:223], v[44:47], v[164:167], a[208:223]
v_pk_mul_f32 v[82:83], v[82:83], v[12:13] op_sel:[0,1] op_sel_hi:[1,1]
v_pk_mul_f32 v[84:85], v[84:85], v[12:13] op_sel:[0,1] op_sel_hi:[1,1]
v_pk_mul_f32 v[86:87], v[86:87], v[12:13] op_sel:[0,1] op_sel_hi:[1,1]
v_pk_mul_f32 v[88:89], v[88:89], v[12:13] op_sel:[0,1] op_sel_hi:[1,1]
v_pk_mul_f32 v[90:91], v[90:91], v[12:13] op_sel:[0,1] op_sel_hi:[1,1]
v_pk_mul_f32 v[92:93], v[92:93], v[12:13] op_sel:[0,1] op_sel_hi:[1,1]
v_mfma_f32_32x32x16_bf16 a[208:223], v[48:51], v[168:171], a[208:223]
v_pk_mul_f32 v[94:95], v[94:95], v[12:13] op_sel:[0,1] op_sel_hi:[1,1]
v_cvt_pk_bf16_f32 v80, v80, v81
v_cvt_pk_bf16_f32 v81, v82, v83
v_cvt_pk_bf16_f32 v82, v84, v85
v_cvt_pk_bf16_f32 v83, v86, v87
v_mfma_f32_32x32x16_bf16 a[208:223], v[52:55], v[172:175], a[208:223]
v_cvt_pk_bf16_f32 v84, v88, v89
v_cvt_pk_bf16_f32 v85, v90, v91
v_cvt_pk_bf16_f32 v86, v92, v93
v_cvt_pk_bf16_f32 v87, v94, v95
buffer_store_dwordx4 v[80:83], v5, s[20:23], s44 offen offset:2048 sc1
buffer_store_dwordx4 v[84:87], v5, s[20:23], s44 offen offset:3072 sc1
s_waitcnt lgkmcnt(6)
s_nop 0
v_mfma_f32_32x32x16_bf16 a[224:239], v[32:35], v[176:179], a[224:239]
v_accvgpr_read_b32 v64, a192
v_accvgpr_read_b32 v65, a193
v_accvgpr_read_b32 v66, a194
v_accvgpr_read_b32 v67, a195
v_accvgpr_read_b32 v68, a196
v_accvgpr_read_b32 v69, a197
v_mfma_f32_32x32x16_bf16 a[224:239], v[36:39], v[180:183], a[224:239]
v_accvgpr_read_b32 v70, a198
v_accvgpr_read_b32 v71, a199
v_accvgpr_read_b32 v72, a200
v_accvgpr_read_b32 v73, a201
v_accvgpr_read_b32 v74, a202
v_mfma_f32_32x32x16_bf16 a[224:239], v[40:43], v[184:187], a[224:239]
v_accvgpr_read_b32 v75, a203
v_accvgpr_read_b32 v76, a204
v_accvgpr_read_b32 v77, a205
v_accvgpr_read_b32 v78, a206
v_accvgpr_read_b32 v79, a207
v_pk_mul_f32 v[64:65], v[64:65], v[12:13] op_sel:[0,0] op_sel_hi:[1,0]
v_mfma_f32_32x32x16_bf16 a[224:239], v[44:47], v[188:191], a[224:239]
v_pk_mul_f32 v[66:67], v[66:67], v[12:13] op_sel:[0,0] op_sel_hi:[1,0]
v_pk_mul_f32 v[68:69], v[68:69], v[12:13] op_sel:[0,0] op_sel_hi:[1,0]
v_pk_mul_f32 v[70:71], v[70:71], v[12:13] op_sel:[0,0] op_sel_hi:[1,0]
v_pk_mul_f32 v[72:73], v[72:73], v[12:13] op_sel:[0,0] op_sel_hi:[1,0]
v_pk_mul_f32 v[74:75], v[74:75], v[12:13] op_sel:[0,0] op_sel_hi:[1,0]
v_pk_mul_f32 v[76:77], v[76:77], v[12:13] op_sel:[0,0] op_sel_hi:[1,0]
v_mfma_f32_32x32x16_bf16 a[224:239], v[48:51], v[192:195], a[224:239]
v_pk_mul_f32 v[78:79], v[78:79], v[12:13] op_sel:[0,0] op_sel_hi:[1,0]
v_cvt_pk_bf16_f32 v64, v64, v65
v_cvt_pk_bf16_f32 v65, v66, v67
v_cvt_pk_bf16_f32 v66, v68, v69
v_cvt_pk_bf16_f32 v67, v70, v71
v_mfma_f32_32x32x16_bf16 a[224:239], v[52:55], v[196:199], a[224:239]
v_cvt_pk_bf16_f32 v68, v72, v73
v_cvt_pk_bf16_f32 v69, v74, v75
v_cvt_pk_bf16_f32 v70, v76, v77
v_cvt_pk_bf16_f32 v71, v78, v79
buffer_store_dwordx4 v[64:67], v5, s[20:23], s46 offen sc1
buffer_store_dwordx4 v[68:71], v5, s[20:23], s46 offen offset:1024 sc1
s_waitcnt lgkmcnt(0)
s_nop 0
v_mfma_f32_32x32x16_bf16 a[240:255], v[32:35], v[200:203], a[240:255]
v_accvgpr_read_b32 v80, a208
v_accvgpr_read_b32 v81, a209
v_accvgpr_read_b32 v82, a210
v_accvgpr_read_b32 v83, a211
v_accvgpr_read_b32 v84, a212
v_accvgpr_read_b32 v85, a213
v_mfma_f32_32x32x16_bf16 a[240:255], v[36:39], v[204:207], a[240:255]
v_accvgpr_read_b32 v86, a214
v_accvgpr_read_b32 v87, a215
v_accvgpr_read_b32 v88, a216
v_accvgpr_read_b32 v89, a217
v_accvgpr_read_b32 v90, a218
v_mfma_f32_32x32x16_bf16 a[240:255], v[40:43], v[208:211], a[240:255]
v_accvgpr_read_b32 v91, a219
v_accvgpr_read_b32 v92, a220
v_accvgpr_read_b32 v93, a221
v_accvgpr_read_b32 v94, a222
v_accvgpr_read_b32 v95, a223
v_pk_mul_f32 v[80:81], v[80:81], v[12:13] op_sel:[0,1] op_sel_hi:[1,1]
v_mfma_f32_32x32x16_bf16 a[240:255], v[44:47], v[212:215], a[240:255]
v_pk_mul_f32 v[82:83], v[82:83], v[12:13] op_sel:[0,1] op_sel_hi:[1,1]
v_pk_mul_f32 v[84:85], v[84:85], v[12:13] op_sel:[0,1] op_sel_hi:[1,1]
v_pk_mul_f32 v[86:87], v[86:87], v[12:13] op_sel:[0,1] op_sel_hi:[1,1]
v_pk_mul_f32 v[88:89], v[88:89], v[12:13] op_sel:[0,1] op_sel_hi:[1,1]
v_pk_mul_f32 v[90:91], v[90:91], v[12:13] op_sel:[0,1] op_sel_hi:[1,1]
v_pk_mul_f32 v[92:93], v[92:93], v[12:13] op_sel:[0,1] op_sel_hi:[1,1]
v_mfma_f32_32x32x16_bf16 a[240:255], v[48:51], v[216:219], a[240:255]
v_pk_mul_f32 v[94:95], v[94:95], v[12:13] op_sel:[0,1] op_sel_hi:[1,1]
v_cvt_pk_bf16_f32 v80, v80, v81
v_cvt_pk_bf16_f32 v81, v82, v83
v_cvt_pk_bf16_f32 v82, v84, v85
v_cvt_pk_bf16_f32 v83, v86, v87
v_mfma_f32_32x32x16_bf16 a[240:255], v[52:55], v[220:223], a[240:255]
v_cvt_pk_bf16_f32 v84, v88, v89
v_cvt_pk_bf16_f32 v85, v90, v91
v_cvt_pk_bf16_f32 v86, v92, v93
v_cvt_pk_bf16_f32 v87, v94, v95
buffer_store_dwordx4 v[80:83], v5, s[20:23], s47 offen sc1
buffer_store_dwordx4 v[84:87], v5, s[20:23], s47 offen offset:1024 sc1
v_accvgpr_read_b32 v64, a224
v_accvgpr_read_b32 v65, a225
v_accvgpr_read_b32 v66, a226
v_accvgpr_read_b32 v67, a227
v_accvgpr_read_b32 v68, a228
v_accvgpr_read_b32 v69, a229
v_accvgpr_read_b32 v70, a230
v_accvgpr_read_b32 v71, a231
v_accvgpr_read_b32 v72, a232
v_accvgpr_read_b32 v73, a233
v_accvgpr_read_b32 v74, a234
v_accvgpr_read_b32 v75, a235
v_accvgpr_read_b32 v76, a236
v_accvgpr_read_b32 v77, a237
v_accvgpr_read_b32 v78, a238
v_accvgpr_read_b32 v79, a239
v_pk_mul_f32 v[64:65], v[64:65], v[12:13] op_sel:[0,0] op_sel_hi:[1,0]
v_pk_mul_f32 v[66:67], v[66:67], v[12:13] op_sel:[0,0] op_sel_hi:[1,0]
v_pk_mul_f32 v[68:69], v[68:69], v[12:13] op_sel:[0,0] op_sel_hi:[1,0]
v_pk_mul_f32 v[70:71], v[70:71], v[12:13] op_sel:[0,0] op_sel_hi:[1,0]
v_pk_mul_f32 v[72:73], v[72:73], v[12:13] op_sel:[0,0] op_sel_hi:[1,0]
v_pk_mul_f32 v[74:75], v[74:75], v[12:13] op_sel:[0,0] op_sel_hi:[1,0]
v_pk_mul_f32 v[76:77], v[76:77], v[12:13] op_sel:[0,0] op_sel_hi:[1,0]
v_pk_mul_f32 v[78:79], v[78:79], v[12:13] op_sel:[0,0] op_sel_hi:[1,0]
v_cvt_pk_bf16_f32 v64, v64, v65
v_cvt_pk_bf16_f32 v65, v66, v67
v_cvt_pk_bf16_f32 v66, v68, v69
v_cvt_pk_bf16_f32 v67, v70, v71
v_cvt_pk_bf16_f32 v68, v72, v73
v_cvt_pk_bf16_f32 v69, v74, v75
v_cvt_pk_bf16_f32 v70, v76, v77
v_cvt_pk_bf16_f32 v71, v78, v79
buffer_store_dwordx4 v[64:67], v5, s[20:23], s46 offen offset:2048 sc1
buffer_store_dwordx4 v[68:71], v5, s[20:23], s46 offen offset:3072 sc1
v_accvgpr_read_b32 v80, a240
v_accvgpr_read_b32 v81, a241
v_accvgpr_read_b32 v82, a242
v_accvgpr_read_b32 v83, a243
v_accvgpr_read_b32 v84, a244
v_accvgpr_read_b32 v85, a245
v_accvgpr_read_b32 v86, a246
v_accvgpr_read_b32 v87, a247
v_accvgpr_read_b32 v88, a248
v_accvgpr_read_b32 v89, a249
v_accvgpr_read_b32 v90, a250
v_accvgpr_read_b32 v91, a251
v_accvgpr_read_b32 v92, a252
v_accvgpr_read_b32 v93, a253
v_accvgpr_read_b32 v94, a254
v_accvgpr_read_b32 v95, a255
v_pk_mul_f32 v[80:81], v[80:81], v[12:13] op_sel:[0,1] op_sel_hi:[1,1]
v_pk_mul_f32 v[82:83], v[82:83], v[12:13] op_sel:[0,1] op_sel_hi:[1,1]
v_pk_mul_f32 v[84:85], v[84:85], v[12:13] op_sel:[0,1] op_sel_hi:[1,1]
v_pk_mul_f32 v[86:87], v[86:87], v[12:13] op_sel:[0,1] op_sel_hi:[1,1]
v_pk_mul_f32 v[88:89], v[88:89], v[12:13] op_sel:[0,1] op_sel_hi:[1,1]
v_pk_mul_f32 v[90:91], v[90:91], v[12:13] op_sel:[0,1] op_sel_hi:[1,1]
v_pk_mul_f32 v[92:93], v[92:93], v[12:13] op_sel:[0,1] op_sel_hi:[1,1]
v_pk_mul_f32 v[94:95], v[94:95], v[12:13] op_sel:[0,1] op_sel_hi:[1,1]
v_cvt_pk_bf16_f32 v80, v80, v81
v_cvt_pk_bf16_f32 v81, v82, v83
v_cvt_pk_bf16_f32 v82, v84, v85
v_cvt_pk_bf16_f32 v83, v86, v87
v_cvt_pk_bf16_f32 v84, v88, v89
v_cvt_pk_bf16_f32 v85, v90, v91
v_cvt_pk_bf16_f32 v86, v92, v93
v_cvt_pk_bf16_f32 v87, v94, v95
buffer_store_dwordx4 v[80:83], v5, s[20:23], s47 offen offset:2048 sc1
buffer_store_dwordx4 v[84:87], v5, s[20:23], s47 offen offset:3072 sc1
s_branch PC_DONE
PC_SLOW:
s_cmp_lg_u32 s57, 0
s_cbranch_scc1 PC_NORESC
v_cmp_neq_f32 vcc, 1.0, v14
v_cmp_neq_f32 s[50:51], 1.0, v15
s_or_b64 s[50:51], vcc, s[50:51]
s_cbranch_scc0 PC_NORESC
s_nop 7
s_nop 7
v_mul_f32 v96, v96, v14
v_mul_f32 v97, v97, v14
v_mul_f32 v98, v98, v14
v_mul_f32 v99, v99, v14
v_mul_f32 v100, v100, v14
v_mul_f32 v101, v101, v14
v_mul_f32 v102, v102, v14
v_mul_f32 v103, v103, v14
v_mul_f32 v104, v104, v14
v_mul_f32 v105, v105, v14
v_mul_f32 v106, v106, v14
v_mul_f32 v107, v107, v14
v_mul_f32 v108, v108, v14
v_mul_f32 v109, v109, v14
v_mul_f32 v110, v110, v14
v_mul_f32 v111, v111, v14
v_mul_f32 v112, v112, v15
v_mul_f32 v113, v113, v15
v_mul_f32 v114, v114, v15
v_mul_f32 v115, v115, v15
v_mul_f32 v116, v116, v15
v_mul_f32 v117, v117, v15
v_mul_f32 v118, v118, v15
v_mul_f32 v119, v119, v15
v_mul_f32 v120, v120, v15
v_mul_f32 v121, v121, v15
v_mul_f32 v122, v122, v15
v_mul_f32 v123, v123, v15
v_mul_f32 v124, v124, v15
v_mul_f32 v125, v125, v15
v_mul_f32 v126, v126, v15
v_mul_f32 v127, v127, v15
v_accvgpr_read_b32 v4, a160
v_mul_f32 v4, v4, v14
v_accvgpr_write_b32 a160, v4
v_accvgpr_read_b32 v4, a161
v_mul_f32 v4, v4, v14
v_accvgpr_write_b32 a161, v4
v_accvgpr_read_b32 v4, a162
v_mul_f32 v4, v4, v14
v_accvgpr_write_b32 a162, v4
v_accvgpr_read_b32 v4, a163
v_mul_f32 v4, v4, v14
v_accvgpr_write_b32 a163, v4
v_accvgpr_read_b32 v4, a164
v_mul_f32 v4, v4, v14
v_accvgpr_write_b32 a164, v4
v_accvgpr_read_b32 v4, a165
v_mul_f32 v4, v4, v14
v_accvgpr_write_b32 a165, v4
v_accvgpr_read_b32 v4, a166
v_mul_f32 v4, v4, v14
v_accvgpr_write_b32 a166, v4
v_accvgpr_read_b32 v4, a167
v_mul_f32 v4, v4, v14
v_accvgpr_write_b32 a167, v4
v_accvgpr_read_b32 v4, a168
v_mul_f32 v4, v4, v14
v_accvgpr_write_b32 a168, v4
v_accvgpr_read_b32 v4, a169
v_mul_f32 v4, v4, v14
v_accvgpr_write_b32 a169, v4
v_accvgpr_read_b32 v4, a170
v_mul_f32 v4, v4, v14
v_accvgpr_write_b32 a170, v4
v_accvgpr_read_b32 v4, a171
v_mul_f32 v4, v4, v14
v_accvgpr_write_b32 a171, v4
v_accvgpr_read_b32 v4, a172
v_mul_f32 v4, v4, v14
v_accvgpr_write_b32 a172, v4
v_accvgpr_read_b32 v4, a173
v_mul_f32 v4, v4, v14
v_accvgpr_write_b32 a173, v4
v_accvgpr_read_b32 v4, a174
v_mul_f32 v4, v4, v14
v_accvgpr_write_b32 a174, v4
v_accvgpr_read_b32 v4, a175
v_mul_f32 v4, v4, v14
v_accvgpr_write_b32 a175, v4
v_accvgpr_read_b32 v4, a176
v_mul_f32 v4, v4, v15
v_accvgpr_write_b32 a176, v4
v_accvgpr_read_b32 v4, a177
v_mul_f32 v4, v4, v15
v_accvgpr_write_b32 a177, v4
v_accvgpr_read_b32 v4, a178
v_mul_f32 v4, v4, v15
v_accvgpr_write_b32 a178, v4
v_accvgpr_read_b32 v4, a179
v_mul_f32 v4, v4, v15
v_accvgpr_write_b32 a179, v4
v_accvgpr_read_b32 v4, a180
v_mul_f32 v4, v4, v15
v_accvgpr_write_b32 a180, v4
v_accvgpr_read_b32 v4, a181
v_mul_f32 v4, v4, v15
v_accvgpr_write_b32 a181, v4
v_accvgpr_read_b32 v4, a182
v_mul_f32 v4, v4, v15
v_accvgpr_write_b32 a182, v4
v_accvgpr_read_b32 v4, a183
v_mul_f32 v4, v4, v15
v_accvgpr_write_b32 a183, v4
v_accvgpr_read_b32 v4, a184
v_mul_f32 v4, v4, v15
v_accvgpr_write_b32 a184, v4
v_accvgpr_read_b32 v4, a185
v_mul_f32 v4, v4, v15
v_accvgpr_write_b32 a185, v4
v_accvgpr_read_b32 v4, a186
v_mul_f32 v4, v4, v15
v_accvgpr_write_b32 a186, v4
v_accvgpr_read_b32 v4, a187
v_mul_f32 v4, v4, v15
v_accvgpr_write_b32 a187, v4
v_accvgpr_read_b32 v4, a188
v_mul_f32 v4, v4, v15
v_accvgpr_write_b32 a188, v4
v_accvgpr_read_b32 v4, a189
v_mul_f32 v4, v4, v15
v_accvgpr_write_b32 a189, v4
v_accvgpr_read_b32 v4, a190
v_mul_f32 v4, v4, v15
v_accvgpr_write_b32 a190, v4
v_accvgpr_read_b32 v4, a191
v_mul_f32 v4, v4, v15
v_accvgpr_write_b32 a191, v4
v_accvgpr_read_b32 v4, a192
v_mul_f32 v4, v4, v14
v_accvgpr_write_b32 a192, v4
v_accvgpr_read_b32 v4, a193
v_mul_f32 v4, v4, v14
v_accvgpr_write_b32 a193, v4
v_accvgpr_read_b32 v4, a194
v_mul_f32 v4, v4, v14
v_accvgpr_write_b32 a194, v4
v_accvgpr_read_b32 v4, a195
v_mul_f32 v4, v4, v14
v_accvgpr_write_b32 a195, v4
v_accvgpr_read_b32 v4, a196
v_mul_f32 v4, v4, v14
v_accvgpr_write_b32 a196, v4
v_accvgpr_read_b32 v4, a197
v_mul_f32 v4, v4, v14
v_accvgpr_write_b32 a197, v4
v_accvgpr_read_b32 v4, a198
v_mul_f32 v4, v4, v14
v_accvgpr_write_b32 a198, v4
v_accvgpr_read_b32 v4, a199
v_mul_f32 v4, v4, v14
v_accvgpr_write_b32 a199, v4
v_accvgpr_read_b32 v4, a200
v_mul_f32 v4, v4, v14
v_accvgpr_write_b32 a200, v4
v_accvgpr_read_b32 v4, a201
v_mul_f32 v4, v4, v14
v_accvgpr_write_b32 a201, v4
v_accvgpr_read_b32 v4, a202
v_mul_f32 v4, v4, v14
v_accvgpr_write_b32 a202, v4
v_accvgpr_read_b32 v4, a203
v_mul_f32 v4, v4, v14
v_accvgpr_write_b32 a203, v4
v_accvgpr_read_b32 v4, a204
v_mul_f32 v4, v4, v14
v_accvgpr_write_b32 a204, v4
v_accvgpr_read_b32 v4, a205
v_mul_f32 v4, v4, v14
v_accvgpr_write_b32 a205, v4
v_accvgpr_read_b32 v4, a206
v_mul_f32 v4, v4, v14
v_accvgpr_write_b32 a206, v4
v_accvgpr_read_b32 v4, a207
v_mul_f32 v4, v4, v14
v_accvgpr_write_b32 a207, v4
v_accvgpr_read_b32 v4, a208
v_mul_f32 v4, v4, v15
v_accvgpr_write_b32 a208, v4
v_accvgpr_read_b32 v4, a209
v_mul_f32 v4, v4, v15
v_accvgpr_write_b32 a209, v4
v_accvgpr_read_b32 v4, a210
v_mul_f32 v4, v4, v15
v_accvgpr_write_b32 a210, v4
v_accvgpr_read_b32 v4, a211
v_mul_f32 v4, v4, v15
v_accvgpr_write_b32 a211, v4
v_accvgpr_read_b32 v4, a212
v_mul_f32 v4, v4, v15
v_accvgpr_write_b32 a212, v4
v_accvgpr_read_b32 v4, a213
v_mul_f32 v4, v4, v15
v_accvgpr_write_b32 a213, v4
v_accvgpr_read_b32 v4, a214
v_mul_f32 v4, v4, v15
v_accvgpr_write_b32 a214, v4
v_accvgpr_read_b32 v4, a215
v_mul_f32 v4, v4, v15
v_accvgpr_write_b32 a215, v4
v_accvgpr_read_b32 v4, a216
v_mul_f32 v4, v4, v15
v_accvgpr_write_b32 a216, v4
v_accvgpr_read_b32 v4, a217
v_mul_f32 v4, v4, v15
v_accvgpr_write_b32 a217, v4
v_accvgpr_read_b32 v4, a218
v_mul_f32 v4, v4, v15
v_accvgpr_write_b32 a218, v4
v_accvgpr_read_b32 v4, a219
v_mul_f32 v4, v4, v15
v_accvgpr_write_b32 a219, v4
v_accvgpr_read_b32 v4, a220
v_mul_f32 v4, v4, v15
v_accvgpr_write_b32 a220, v4
v_accvgpr_read_b32 v4, a221
v_mul_f32 v4, v4, v15
v_accvgpr_write_b32 a221, v4
v_accvgpr_read_b32 v4, a222
v_mul_f32 v4, v4, v15
v_accvgpr_write_b32 a222, v4
v_accvgpr_read_b32 v4, a223
v_mul_f32 v4, v4, v15
v_accvgpr_write_b32 a223, v4
v_accvgpr_read_b32 v4, a224
v_mul_f32 v4, v4, v14
v_accvgpr_write_b32 a224, v4
v_accvgpr_read_b32 v4, a225
v_mul_f32 v4, v4, v14
v_accvgpr_write_b32 a225, v4
v_accvgpr_read_b32 v4, a226
v_mul_f32 v4, v4, v14
v_accvgpr_write_b32 a226, v4
v_accvgpr_read_b32 v4, a227
v_mul_f32 v4, v4, v14
v_accvgpr_write_b32 a227, v4
v_accvgpr_read_b32 v4, a228
v_mul_f32 v4, v4, v14
v_accvgpr_write_b32 a228, v4
v_accvgpr_read_b32 v4, a229
v_mul_f32 v4, v4, v14
v_accvgpr_write_b32 a229, v4
v_accvgpr_read_b32 v4, a230
v_mul_f32 v4, v4, v14
v_accvgpr_write_b32 a230, v4
v_accvgpr_read_b32 v4, a231
v_mul_f32 v4, v4, v14
v_accvgpr_write_b32 a231, v4
v_accvgpr_read_b32 v4, a232
v_mul_f32 v4, v4, v14
v_accvgpr_write_b32 a232, v4
v_accvgpr_read_b32 v4, a233
v_mul_f32 v4, v4, v14
v_accvgpr_write_b32 a233, v4
v_accvgpr_read_b32 v4, a234
v_mul_f32 v4, v4, v14
v_accvgpr_write_b32 a234, v4
v_accvgpr_read_b32 v4, a235
v_mul_f32 v4, v4, v14
v_accvgpr_write_b32 a235, v4
v_accvgpr_read_b32 v4, a236
v_mul_f32 v4, v4, v14
v_accvgpr_write_b32 a236, v4
v_accvgpr_read_b32 v4, a237
v_mul_f32 v4, v4, v14
v_accvgpr_write_b32 a237, v4
v_accvgpr_read_b32 v4, a238
v_mul_f32 v4, v4, v14
v_accvgpr_write_b32 a238, v4
v_accvgpr_read_b32 v4, a239
v_mul_f32 v4, v4, v14
v_accvgpr_write_b32 a239, v4
v_accvgpr_read_b32 v4, a240
v_mul_f32 v4, v4, v15
v_accvgpr_write_b32 a240, v4
v_accvgpr_read_b32 v4, a241
v_mul_f32 v4, v4, v15
v_accvgpr_write_b32 a241, v4
v_accvgpr_read_b32 v4, a242
v_mul_f32 v4, v4, v15
v_accvgpr_write_b32 a242, v4
v_accvgpr_read_b32 v4, a243
v_mul_f32 v4, v4, v15
v_accvgpr_write_b32 a243, v4
v_accvgpr_read_b32 v4, a244
v_mul_f32 v4, v4, v15
v_accvgpr_write_b32 a244, v4
v_accvgpr_read_b32 v4, a245
v_mul_f32 v4, v4, v15
v_accvgpr_write_b32 a245, v4
v_accvgpr_read_b32 v4, a246
v_mul_f32 v4, v4, v15
v_accvgpr_write_b32 a246, v4
v_accvgpr_read_b32 v4, a247
v_mul_f32 v4, v4, v15
v_accvgpr_write_b32 a247, v4
v_accvgpr_read_b32 v4, a248
v_mul_f32 v4, v4, v15
v_accvgpr_write_b32 a248, v4
v_accvgpr_read_b32 v4, a249
v_mul_f32 v4, v4, v15
v_accvgpr_write_b32 a249, v4
v_accvgpr_read_b32 v4, a250
v_mul_f32 v4, v4, v15
v_accvgpr_write_b32 a250, v4
v_accvgpr_read_b32 v4, a251
v_mul_f32 v4, v4, v15
v_accvgpr_write_b32 a251, v4
v_accvgpr_read_b32 v4, a252
v_mul_f32 v4, v4, v15
v_accvgpr_write_b32 a252, v4
v_accvgpr_read_b32 v4, a253
v_mul_f32 v4, v4, v15
v_accvgpr_write_b32 a253, v4
v_accvgpr_read_b32 v4, a254
v_mul_f32 v4, v4, v15
v_accvgpr_write_b32 a254, v4
v_accvgpr_read_b32 v4, a255
v_mul_f32 v4, v4, v15
v_accvgpr_write_b32 a255, v4
s_nop 1
PC_NORESC:
s_cmp_lg_u32 s58, 0
s_cbranch_scc1 PC_NOP
s_xor_b32 s44, s3, 1
s_lshr_b32 s43, s44, 1
s_mul_i32 s43, s43, 98304
s_and_b32 s45, s44, 1
s_lshl_b32 s45, s45, 14
s_add_u32 s45, s45, s43
s_add_u32 s45, s45, 32768
v_add_u32 v6, s45, v5
s_nop 0
ds_read_b128 v[128:131], v6
ds_read_b128 v[132:135], v6 offset:1024
ds_read_b128 v[136:139], v6 offset:2048
ds_read_b128 v[140:143], v6 offset:3072
ds_read_b128 v[144:147], v6 offset:4096
ds_read_b128 v[148:151], v6 offset:5120
ds_read_b128 v[152:155], v6 offset:6144
ds_read_b128 v[156:159], v6 offset:7168
ds_read_b128 v[160:163], v6 offset:8192
ds_read_b128 v[164:167], v6 offset:9216
ds_read_b128 v[168:171], v6 offset:10240
ds_read_b128 v[172:175], v6 offset:11264
ds_read_b128 v[176:179], v6 offset:12288
ds_read_b128 v[180:183], v6 offset:13312
ds_read_b128 v[184:187], v6 offset:14336
ds_read_b128 v[188:191], v6 offset:15360
v_cmp_neq_f32 vcc, 1.0, v16
v_cmp_neq_f32 s[50:51], 1.0, v17
s_or_b64 s[50:51], vcc, s[50:51]
s_cbranch_scc0 PC_RX_P
s_waitcnt lgkmcnt(0)
v_lshlrev_b32 v4, 16, v128
v_and_b32 v128, 0xffff0000, v128
v_mul_f32 v4, v4, v16
v_mul_f32 v128, v128, v16
v_cvt_pk_bf16_f32 v128, v4, v128
v_lshlrev_b32 v4, 16, v129
v_and_b32 v129, 0xffff0000, v129
v_mul_f32 v4, v4, v16
v_mul_f32 v129, v129, v16
v_cvt_pk_bf16_f32 v129, v4, v129
v_lshlrev_b32 v4, 16, v130
v_and_b32 v130, 0xffff0000, v130
v_mul_f32 v4, v4, v16
v_mul_f32 v130, v130, v16
v_cvt_pk_bf16_f32 v130, v4, v130
v_lshlrev_b32 v4, 16, v131
v_and_b32 v131, 0xffff0000, v131
v_mul_f32 v4, v4, v16
v_mul_f32 v131, v131, v16
v_cvt_pk_bf16_f32 v131, v4, v131
v_lshlrev_b32 v4, 16, v132
v_and_b32 v132, 0xffff0000, v132
v_mul_f32 v4, v4, v16
v_mul_f32 v132, v132, v16
v_cvt_pk_bf16_f32 v132, v4, v132
v_lshlrev_b32 v4, 16, v133
v_and_b32 v133, 0xffff0000, v133
v_mul_f32 v4, v4, v16
v_mul_f32 v133, v133, v16
v_cvt_pk_bf16_f32 v133, v4, v133
v_lshlrev_b32 v4, 16, v134
v_and_b32 v134, 0xffff0000, v134
v_mul_f32 v4, v4, v16
v_mul_f32 v134, v134, v16
v_cvt_pk_bf16_f32 v134, v4, v134
v_lshlrev_b32 v4, 16, v135
v_and_b32 v135, 0xffff0000, v135
v_mul_f32 v4, v4, v16
v_mul_f32 v135, v135, v16
v_cvt_pk_bf16_f32 v135, v4, v135
v_lshlrev_b32 v4, 16, v136
v_and_b32 v136, 0xffff0000, v136
v_mul_f32 v4, v4, v17
v_mul_f32 v136, v136, v17
v_cvt_pk_bf16_f32 v136, v4, v136
v_lshlrev_b32 v4, 16, v137
v_and_b32 v137, 0xffff0000, v137
v_mul_f32 v4, v4, v17
v_mul_f32 v137, v137, v17
v_cvt_pk_bf16_f32 v137, v4, v137
v_lshlrev_b32 v4, 16, v138
v_and_b32 v138, 0xffff0000, v138
v_mul_f32 v4, v4, v17
v_mul_f32 v138, v138, v17
v_cvt_pk_bf16_f32 v138, v4, v138
v_lshlrev_b32 v4, 16, v139
v_and_b32 v139, 0xffff0000, v139
v_mul_f32 v4, v4, v17
v_mul_f32 v139, v139, v17
v_cvt_pk_bf16_f32 v139, v4, v139
v_lshlrev_b32 v4, 16, v140
v_and_b32 v140, 0xffff0000, v140
v_mul_f32 v4, v4, v17
v_mul_f32 v140, v140, v17
v_cvt_pk_bf16_f32 v140, v4, v140
v_lshlrev_b32 v4, 16, v141
v_and_b32 v141, 0xffff0000, v141
v_mul_f32 v4, v4, v17
v_mul_f32 v141, v141, v17
v_cvt_pk_bf16_f32 v141, v4, v141
v_lshlrev_b32 v4, 16, v142
v_and_b32 v142, 0xffff0000, v142
v_mul_f32 v4, v4, v17
v_mul_f32 v142, v142, v17
v_cvt_pk_bf16_f32 v142, v4, v142
v_lshlrev_b32 v4, 16, v143
v_and_b32 v143, 0xffff0000, v143
v_mul_f32 v4, v4, v17
v_mul_f32 v143, v143, v17
v_cvt_pk_bf16_f32 v143, v4, v143
v_lshlrev_b32 v4, 16, v144
v_and_b32 v144, 0xffff0000, v144
v_mul_f32 v4, v4, v16
v_mul_f32 v144, v144, v16
v_cvt_pk_bf16_f32 v144, v4, v144
v_lshlrev_b32 v4, 16, v145
v_and_b32 v145, 0xffff0000, v145
v_mul_f32 v4, v4, v16
v_mul_f32 v145, v145, v16
v_cvt_pk_bf16_f32 v145, v4, v145
v_lshlrev_b32 v4, 16, v146
v_and_b32 v146, 0xffff0000, v146
v_mul_f32 v4, v4, v16
v_mul_f32 v146, v146, v16
v_cvt_pk_bf16_f32 v146, v4, v146
v_lshlrev_b32 v4, 16, v147
v_and_b32 v147, 0xffff0000, v147
v_mul_f32 v4, v4, v16
v_mul_f32 v147, v147, v16
v_cvt_pk_bf16_f32 v147, v4, v147
v_lshlrev_b32 v4, 16, v148
v_and_b32 v148, 0xffff0000, v148
v_mul_f32 v4, v4, v16
v_mul_f32 v148, v148, v16
v_cvt_pk_bf16_f32 v148, v4, v148
v_lshlrev_b32 v4, 16, v149
v_and_b32 v149, 0xffff0000, v149
v_mul_f32 v4, v4, v16
v_mul_f32 v149, v149, v16
v_cvt_pk_bf16_f32 v149, v4, v149
v_lshlrev_b32 v4, 16, v150
v_and_b32 v150, 0xffff0000, v150
v_mul_f32 v4, v4, v16
v_mul_f32 v150, v150, v16
v_cvt_pk_bf16_f32 v150, v4, v150
v_lshlrev_b32 v4, 16, v151
v_and_b32 v151, 0xffff0000, v151
v_mul_f32 v4, v4, v16
v_mul_f32 v151, v151, v16
v_cvt_pk_bf16_f32 v151, v4, v151
v_lshlrev_b32 v4, 16, v152
v_and_b32 v152, 0xffff0000, v152
v_mul_f32 v4, v4, v17
v_mul_f32 v152, v152, v17
v_cvt_pk_bf16_f32 v152, v4, v152
v_lshlrev_b32 v4, 16, v153
v_and_b32 v153, 0xffff0000, v153
v_mul_f32 v4, v4, v17
v_mul_f32 v153, v153, v17
v_cvt_pk_bf16_f32 v153, v4, v153
v_lshlrev_b32 v4, 16, v154
v_and_b32 v154, 0xffff0000, v154
v_mul_f32 v4, v4, v17
v_mul_f32 v154, v154, v17
v_cvt_pk_bf16_f32 v154, v4, v154
v_lshlrev_b32 v4, 16, v155
v_and_b32 v155, 0xffff0000, v155
v_mul_f32 v4, v4, v17
v_mul_f32 v155, v155, v17
v_cvt_pk_bf16_f32 v155, v4, v155
v_lshlrev_b32 v4, 16, v156
v_and_b32 v156, 0xffff0000, v156
v_mul_f32 v4, v4, v17
v_mul_f32 v156, v156, v17
v_cvt_pk_bf16_f32 v156, v4, v156
v_lshlrev_b32 v4, 16, v157
v_and_b32 v157, 0xffff0000, v157
v_mul_f32 v4, v4, v17
v_mul_f32 v157, v157, v17
v_cvt_pk_bf16_f32 v157, v4, v157
v_lshlrev_b32 v4, 16, v158
v_and_b32 v158, 0xffff0000, v158
v_mul_f32 v4, v4, v17
v_mul_f32 v158, v158, v17
v_cvt_pk_bf16_f32 v158, v4, v158
v_lshlrev_b32 v4, 16, v159
v_and_b32 v159, 0xffff0000, v159
v_mul_f32 v4, v4, v17
v_mul_f32 v159, v159, v17
v_cvt_pk_bf16_f32 v159, v4, v159
v_lshlrev_b32 v4, 16, v160
v_and_b32 v160, 0xffff0000, v160
v_mul_f32 v4, v4, v16
v_mul_f32 v160, v160, v16
v_cvt_pk_bf16_f32 v160, v4, v160
v_lshlrev_b32 v4, 16, v161
v_and_b32 v161, 0xffff0000, v161
v_mul_f32 v4, v4, v16
v_mul_f32 v161, v161, v16
v_cvt_pk_bf16_f32 v161, v4, v161
v_lshlrev_b32 v4, 16, v162
v_and_b32 v162, 0xffff0000, v162
v_mul_f32 v4, v4, v16
v_mul_f32 v162, v162, v16
v_cvt_pk_bf16_f32 v162, v4, v162
v_lshlrev_b32 v4, 16, v163
v_and_b32 v163, 0xffff0000, v163
v_mul_f32 v4, v4, v16
v_mul_f32 v163, v163, v16
v_cvt_pk_bf16_f32 v163, v4, v163
v_lshlrev_b32 v4, 16, v164
v_and_b32 v164, 0xffff0000, v164
v_mul_f32 v4, v4, v16
v_mul_f32 v164, v164, v16
v_cvt_pk_bf16_f32 v164, v4, v164
v_lshlrev_b32 v4, 16, v165
v_and_b32 v165, 0xffff0000, v165
v_mul_f32 v4, v4, v16
v_mul_f32 v165, v165, v16
v_cvt_pk_bf16_f32 v165, v4, v165
v_lshlrev_b32 v4, 16, v166
v_and_b32 v166, 0xffff0000, v166
v_mul_f32 v4, v4, v16
v_mul_f32 v166, v166, v16
v_cvt_pk_bf16_f32 v166, v4, v166
v_lshlrev_b32 v4, 16, v167
v_and_b32 v167, 0xffff0000, v167
v_mul_f32 v4, v4, v16
v_mul_f32 v167, v167, v16
v_cvt_pk_bf16_f32 v167, v4, v167
v_lshlrev_b32 v4, 16, v168
v_and_b32 v168, 0xffff0000, v168
v_mul_f32 v4, v4, v17
v_mul_f32 v168, v168, v17
v_cvt_pk_bf16_f32 v168, v4, v168
v_lshlrev_b32 v4, 16, v169
v_and_b32 v169, 0xffff0000, v169
v_mul_f32 v4, v4, v17
v_mul_f32 v169, v169, v17
v_cvt_pk_bf16_f32 v169, v4, v169
v_lshlrev_b32 v4, 16, v170
v_and_b32 v170, 0xffff0000, v170
v_mul_f32 v4, v4, v17
v_mul_f32 v170, v170, v17
v_cvt_pk_bf16_f32 v170, v4, v170
v_lshlrev_b32 v4, 16, v171
v_and_b32 v171, 0xffff0000, v171
v_mul_f32 v4, v4, v17
v_mul_f32 v171, v171, v17
v_cvt_pk_bf16_f32 v171, v4, v171
v_lshlrev_b32 v4, 16, v172
v_and_b32 v172, 0xffff0000, v172
v_mul_f32 v4, v4, v17
v_mul_f32 v172, v172, v17
v_cvt_pk_bf16_f32 v172, v4, v172
v_lshlrev_b32 v4, 16, v173
v_and_b32 v173, 0xffff0000, v173
v_mul_f32 v4, v4, v17
v_mul_f32 v173, v173, v17
v_cvt_pk_bf16_f32 v173, v4, v173
v_lshlrev_b32 v4, 16, v174
v_and_b32 v174, 0xffff0000, v174
v_mul_f32 v4, v4, v17
v_mul_f32 v174, v174, v17
v_cvt_pk_bf16_f32 v174, v4, v174
v_lshlrev_b32 v4, 16, v175
v_and_b32 v175, 0xffff0000, v175
v_mul_f32 v4, v4, v17
v_mul_f32 v175, v175, v17
v_cvt_pk_bf16_f32 v175, v4, v175
v_lshlrev_b32 v4, 16, v176
v_and_b32 v176, 0xffff0000, v176
v_mul_f32 v4, v4, v16
v_mul_f32 v176, v176, v16
v_cvt_pk_bf16_f32 v176, v4, v176
v_lshlrev_b32 v4, 16, v177
v_and_b32 v177, 0xffff0000, v177
v_mul_f32 v4, v4, v16
v_mul_f32 v177, v177, v16
v_cvt_pk_bf16_f32 v177, v4, v177
v_lshlrev_b32 v4, 16, v178
v_and_b32 v178, 0xffff0000, v178
v_mul_f32 v4, v4, v16
v_mul_f32 v178, v178, v16
v_cvt_pk_bf16_f32 v178, v4, v178
v_lshlrev_b32 v4, 16, v179
v_and_b32 v179, 0xffff0000, v179
v_mul_f32 v4, v4, v16
v_mul_f32 v179, v179, v16
v_cvt_pk_bf16_f32 v179, v4, v179
v_lshlrev_b32 v4, 16, v180
v_and_b32 v180, 0xffff0000, v180
v_mul_f32 v4, v4, v16
v_mul_f32 v180, v180, v16
v_cvt_pk_bf16_f32 v180, v4, v180
v_lshlrev_b32 v4, 16, v181
v_and_b32 v181, 0xffff0000, v181
v_mul_f32 v4, v4, v16
v_mul_f32 v181, v181, v16
v_cvt_pk_bf16_f32 v181, v4, v181
v_lshlrev_b32 v4, 16, v182
v_and_b32 v182, 0xffff0000, v182
v_mul_f32 v4, v4, v16
v_mul_f32 v182, v182, v16
v_cvt_pk_bf16_f32 v182, v4, v182
v_lshlrev_b32 v4, 16, v183
v_and_b32 v183, 0xffff0000, v183
v_mul_f32 v4, v4, v16
v_mul_f32 v183, v183, v16
v_cvt_pk_bf16_f32 v183, v4, v183
v_lshlrev_b32 v4, 16, v184
v_and_b32 v184, 0xffff0000, v184
v_mul_f32 v4, v4, v17
v_mul_f32 v184, v184, v17
v_cvt_pk_bf16_f32 v184, v4, v184
v_lshlrev_b32 v4, 16, v185
v_and_b32 v185, 0xffff0000, v185
v_mul_f32 v4, v4, v17
v_mul_f32 v185, v185, v17
v_cvt_pk_bf16_f32 v185, v4, v185
v_lshlrev_b32 v4, 16, v186
v_and_b32 v186, 0xffff0000, v186
v_mul_f32 v4, v4, v17
v_mul_f32 v186, v186, v17
v_cvt_pk_bf16_f32 v186, v4, v186
v_lshlrev_b32 v4, 16, v187
v_and_b32 v187, 0xffff0000, v187
v_mul_f32 v4, v4, v17
v_mul_f32 v187, v187, v17
v_cvt_pk_bf16_f32 v187, v4, v187
v_lshlrev_b32 v4, 16, v188
v_and_b32 v188, 0xffff0000, v188
v_mul_f32 v4, v4, v17
v_mul_f32 v188, v188, v17
v_cvt_pk_bf16_f32 v188, v4, v188
v_lshlrev_b32 v4, 16, v189
v_and_b32 v189, 0xffff0000, v189
v_mul_f32 v4, v4, v17
v_mul_f32 v189, v189, v17
v_cvt_pk_bf16_f32 v189, v4, v189
v_lshlrev_b32 v4, 16, v190
v_and_b32 v190, 0xffff0000, v190
v_mul_f32 v4, v4, v17
v_mul_f32 v190, v190, v17
v_cvt_pk_bf16_f32 v190, v4, v190
v_lshlrev_b32 v4, 16, v191
v_and_b32 v191, 0xffff0000, v191
v_mul_f32 v4, v4, v17
v_mul_f32 v191, v191, v17
v_cvt_pk_bf16_f32 v191, v4, v191
s_nop 1
PC_RX_P:
s_waitcnt lgkmcnt(15)
v_mfma_f32_32x32x16_bf16 v[96:111], v[20:23], v[128:131], v[96:111]
s_waitcnt lgkmcnt(14)
v_mfma_f32_32x32x16_bf16 v[96:111], v[24:27], v[132:135], v[96:111]
s_waitcnt lgkmcnt(13)
v_mfma_f32_32x32x16_bf16 v[112:127], v[20:23], v[136:139], v[112:127]
s_waitcnt lgkmcnt(12)
v_mfma_f32_32x32x16_bf16 v[112:127], v[24:27], v[140:143], v[112:127]
s_waitcnt lgkmcnt(11)
v_mfma_f32_32x32x16_bf16 a[160:175], v[20:23], v[144:147], a[160:175]
s_waitcnt lgkmcnt(10)
v_mfma_f32_32x32x16_bf16 a[160:175], v[24:27], v[148:151], a[160:175]
s_waitcnt lgkmcnt(9)
v_mfma_f32_32x32x16_bf16 a[176:191], v[20:23], v[152:155], a[176:191]
s_waitcnt lgkmcnt(8)
v_mfma_f32_32x32x16_bf16 a[176:191], v[24:27], v[156:159], a[176:191]
s_waitcnt lgkmcnt(7)
v_mfma_f32_32x32x16_bf16 a[192:207], v[20:23], v[160:163], a[192:207]
s_waitcnt lgkmcnt(6)
v_mfma_f32_32x32x16_bf16 a[192:207], v[24:27], v[164:167], a[192:207]
s_waitcnt lgkmcnt(5)
v_mfma_f32_32x32x16_bf16 a[208:223], v[20:23], v[168:171], a[208:223]
s_waitcnt lgkmcnt(4)
v_mfma_f32_32x32x16_bf16 a[208:223], v[24:27], v[172:175], a[208:223]
s_waitcnt lgkmcnt(3)
v_mfma_f32_32x32x16_bf16 a[224:239], v[20:23], v[176:179], a[224:239]
s_waitcnt lgkmcnt(2)
v_mfma_f32_32x32x16_bf16 a[224:239], v[24:27], v[180:183], a[224:239]
s_waitcnt lgkmcnt(1)
v_mfma_f32_32x32x16_bf16 a[240:255], v[20:23], v[184:187], a[240:255]
s_waitcnt lgkmcnt(0)
v_mfma_f32_32x32x16_bf16 a[240:255], v[24:27], v[188:191], a[240:255]
PC_NOP:
s_cmp_eq_u32 s59, 0
s_cbranch_scc1 PC_NOD0
s_lshl_b32 s45, s3, 14
s_add_u32 s45, s45, 65536
v_add_u32 v6, s45, v5
s_nop 0
ds_read_b128 v[128:131], v6
ds_read_b128 v[132:135], v6 offset:1024
ds_read_b128 v[136:139], v6 offset:2048
ds_read_b128 v[140:143], v6 offset:3072
ds_read_b128 v[144:147], v6 offset:4096
ds_read_b128 v[148:151], v6 offset:5120
ds_read_b128 v[152:155], v6 offset:6144
ds_read_b128 v[156:159], v6 offset:7168
ds_read_b128 v[160:163], v6 offset:8192
ds_read_b128 v[164:167], v6 offset:9216
ds_read_b128 v[168:171], v6 offset:10240
ds_read_b128 v[172:175], v6 offset:11264
ds_read_b128 v[176:179], v6 offset:12288
ds_read_b128 v[180:183], v6 offset:13312
ds_read_b128 v[184:187], v6 offset:14336
ds_read_b128 v[188:191], v6 offset:15360
v_cmp_neq_f32 vcc, 1.0, v36
v_cmp_neq_f32 s[50:51], 1.0, v44
s_or_b64 s[50:51], vcc, s[50:51]
s_cbranch_scc0 PC_RX_D0
s_waitcnt lgkmcnt(0)
v_lshlrev_b32 v4, 16, v128
v_and_b32 v128, 0xffff0000, v128
v_mul_f32 v4, v4, v36
v_mul_f32 v128, v128, v36
v_cvt_pk_bf16_f32 v128, v4, v128
v_lshlrev_b32 v4, 16, v129
v_and_b32 v129, 0xffff0000, v129
v_mul_f32 v4, v4, v36
v_mul_f32 v129, v129, v36
v_cvt_pk_bf16_f32 v129, v4, v129
v_lshlrev_b32 v4, 16, v130
v_and_b32 v130, 0xffff0000, v130
v_mul_f32 v4, v4, v36
v_mul_f32 v130, v130, v36
v_cvt_pk_bf16_f32 v130, v4, v130
v_lshlrev_b32 v4, 16, v131
v_and_b32 v131, 0xffff0000, v131
v_mul_f32 v4, v4, v36
v_mul_f32 v131, v131, v36
v_cvt_pk_bf16_f32 v131, v4, v131
v_lshlrev_b32 v4, 16, v132
v_and_b32 v132, 0xffff0000, v132
v_mul_f32 v4, v4, v36
v_mul_f32 v132, v132, v36
v_cvt_pk_bf16_f32 v132, v4, v132
v_lshlrev_b32 v4, 16, v133
v_and_b32 v133, 0xffff0000, v133
v_mul_f32 v4, v4, v36
v_mul_f32 v133, v133, v36
v_cvt_pk_bf16_f32 v133, v4, v133
v_lshlrev_b32 v4, 16, v134
v_and_b32 v134, 0xffff0000, v134
v_mul_f32 v4, v4, v36
v_mul_f32 v134, v134, v36
v_cvt_pk_bf16_f32 v134, v4, v134
v_lshlrev_b32 v4, 16, v135
v_and_b32 v135, 0xffff0000, v135
v_mul_f32 v4, v4, v36
v_mul_f32 v135, v135, v36
v_cvt_pk_bf16_f32 v135, v4, v135
v_lshlrev_b32 v4, 16, v136
v_and_b32 v136, 0xffff0000, v136
v_mul_f32 v4, v4, v44
v_mul_f32 v136, v136, v44
v_cvt_pk_bf16_f32 v136, v4, v136
v_lshlrev_b32 v4, 16, v137
v_and_b32 v137, 0xffff0000, v137
v_mul_f32 v4, v4, v44
v_mul_f32 v137, v137, v44
v_cvt_pk_bf16_f32 v137, v4, v137
v_lshlrev_b32 v4, 16, v138
v_and_b32 v138, 0xffff0000, v138
v_mul_f32 v4, v4, v44
v_mul_f32 v138, v138, v44
v_cvt_pk_bf16_f32 v138, v4, v138
v_lshlrev_b32 v4, 16, v139
v_and_b32 v139, 0xffff0000, v139
v_mul_f32 v4, v4, v44
v_mul_f32 v139, v139, v44
v_cvt_pk_bf16_f32 v139, v4, v139
v_lshlrev_b32 v4, 16, v140
v_and_b32 v140, 0xffff0000, v140
v_mul_f32 v4, v4, v44
v_mul_f32 v140, v140, v44
v_cvt_pk_bf16_f32 v140, v4, v140
v_lshlrev_b32 v4, 16, v141
v_and_b32 v141, 0xffff0000, v141
v_mul_f32 v4, v4, v44
v_mul_f32 v141, v141, v44
v_cvt_pk_bf16_f32 v141, v4, v141
v_lshlrev_b32 v4, 16, v142
v_and_b32 v142, 0xffff0000, v142
v_mul_f32 v4, v4, v44
v_mul_f32 v142, v142, v44
v_cvt_pk_bf16_f32 v142, v4, v142
v_lshlrev_b32 v4, 16, v143
v_and_b32 v143, 0xffff0000, v143
v_mul_f32 v4, v4, v44
v_mul_f32 v143, v143, v44
v_cvt_pk_bf16_f32 v143, v4, v143
v_lshlrev_b32 v4, 16, v144
v_and_b32 v144, 0xffff0000, v144
v_mul_f32 v4, v4, v36
v_mul_f32 v144, v144, v36
v_cvt_pk_bf16_f32 v144, v4, v144
v_lshlrev_b32 v4, 16, v145
v_and_b32 v145, 0xffff0000, v145
v_mul_f32 v4, v4, v36
v_mul_f32 v145, v145, v36
v_cvt_pk_bf16_f32 v145, v4, v145
v_lshlrev_b32 v4, 16, v146
v_and_b32 v146, 0xffff0000, v146
v_mul_f32 v4, v4, v36
v_mul_f32 v146, v146, v36
v_cvt_pk_bf16_f32 v146, v4, v146
v_lshlrev_b32 v4, 16, v147
v_and_b32 v147, 0xffff0000, v147
v_mul_f32 v4, v4, v36
v_mul_f32 v147, v147, v36
v_cvt_pk_bf16_f32 v147, v4, v147
v_lshlrev_b32 v4, 16, v148
v_and_b32 v148, 0xffff0000, v148
v_mul_f32 v4, v4, v36
v_mul_f32 v148, v148, v36
v_cvt_pk_bf16_f32 v148, v4, v148
v_lshlrev_b32 v4, 16, v149
v_and_b32 v149, 0xffff0000, v149
v_mul_f32 v4, v4, v36
v_mul_f32 v149, v149, v36
v_cvt_pk_bf16_f32 v149, v4, v149
v_lshlrev_b32 v4, 16, v150
v_and_b32 v150, 0xffff0000, v150
v_mul_f32 v4, v4, v36
v_mul_f32 v150, v150, v36
v_cvt_pk_bf16_f32 v150, v4, v150
v_lshlrev_b32 v4, 16, v151
v_and_b32 v151, 0xffff0000, v151
v_mul_f32 v4, v4, v36
v_mul_f32 v151, v151, v36
v_cvt_pk_bf16_f32 v151, v4, v151
v_lshlrev_b32 v4, 16, v152
v_and_b32 v152, 0xffff0000, v152
v_mul_f32 v4, v4, v44
v_mul_f32 v152, v152, v44
v_cvt_pk_bf16_f32 v152, v4, v152
v_lshlrev_b32 v4, 16, v153
v_and_b32 v153, 0xffff0000, v153
v_mul_f32 v4, v4, v44
v_mul_f32 v153, v153, v44
v_cvt_pk_bf16_f32 v153, v4, v153
v_lshlrev_b32 v4, 16, v154
v_and_b32 v154, 0xffff0000, v154
v_mul_f32 v4, v4, v44
v_mul_f32 v154, v154, v44
v_cvt_pk_bf16_f32 v154, v4, v154
v_lshlrev_b32 v4, 16, v155
v_and_b32 v155, 0xffff0000, v155
v_mul_f32 v4, v4, v44
v_mul_f32 v155, v155, v44
v_cvt_pk_bf16_f32 v155, v4, v155
v_lshlrev_b32 v4, 16, v156
v_and_b32 v156, 0xffff0000, v156
v_mul_f32 v4, v4, v44
v_mul_f32 v156, v156, v44
v_cvt_pk_bf16_f32 v156, v4, v156
v_lshlrev_b32 v4, 16, v157
v_and_b32 v157, 0xffff0000, v157
v_mul_f32 v4, v4, v44
v_mul_f32 v157, v157, v44
v_cvt_pk_bf16_f32 v157, v4, v157
v_lshlrev_b32 v4, 16, v158
v_and_b32 v158, 0xffff0000, v158
v_mul_f32 v4, v4, v44
v_mul_f32 v158, v158, v44
v_cvt_pk_bf16_f32 v158, v4, v158
v_lshlrev_b32 v4, 16, v159
v_and_b32 v159, 0xffff0000, v159
v_mul_f32 v4, v4, v44
v_mul_f32 v159, v159, v44
v_cvt_pk_bf16_f32 v159, v4, v159
v_lshlrev_b32 v4, 16, v160
v_and_b32 v160, 0xffff0000, v160
v_mul_f32 v4, v4, v36
v_mul_f32 v160, v160, v36
v_cvt_pk_bf16_f32 v160, v4, v160
v_lshlrev_b32 v4, 16, v161
v_and_b32 v161, 0xffff0000, v161
v_mul_f32 v4, v4, v36
v_mul_f32 v161, v161, v36
v_cvt_pk_bf16_f32 v161, v4, v161
v_lshlrev_b32 v4, 16, v162
v_and_b32 v162, 0xffff0000, v162
v_mul_f32 v4, v4, v36
v_mul_f32 v162, v162, v36
v_cvt_pk_bf16_f32 v162, v4, v162
v_lshlrev_b32 v4, 16, v163
v_and_b32 v163, 0xffff0000, v163
v_mul_f32 v4, v4, v36
v_mul_f32 v163, v163, v36
v_cvt_pk_bf16_f32 v163, v4, v163
v_lshlrev_b32 v4, 16, v164
v_and_b32 v164, 0xffff0000, v164
v_mul_f32 v4, v4, v36
v_mul_f32 v164, v164, v36
v_cvt_pk_bf16_f32 v164, v4, v164
v_lshlrev_b32 v4, 16, v165
v_and_b32 v165, 0xffff0000, v165
v_mul_f32 v4, v4, v36
v_mul_f32 v165, v165, v36
v_cvt_pk_bf16_f32 v165, v4, v165
v_lshlrev_b32 v4, 16, v166
v_and_b32 v166, 0xffff0000, v166
v_mul_f32 v4, v4, v36
v_mul_f32 v166, v166, v36
v_cvt_pk_bf16_f32 v166, v4, v166
v_lshlrev_b32 v4, 16, v167
v_and_b32 v167, 0xffff0000, v167
v_mul_f32 v4, v4, v36
v_mul_f32 v167, v167, v36
v_cvt_pk_bf16_f32 v167, v4, v167
v_lshlrev_b32 v4, 16, v168
v_and_b32 v168, 0xffff0000, v168
v_mul_f32 v4, v4, v44
v_mul_f32 v168, v168, v44
v_cvt_pk_bf16_f32 v168, v4, v168
v_lshlrev_b32 v4, 16, v169
v_and_b32 v169, 0xffff0000, v169
v_mul_f32 v4, v4, v44
v_mul_f32 v169, v169, v44
v_cvt_pk_bf16_f32 v169, v4, v169
v_lshlrev_b32 v4, 16, v170
v_and_b32 v170, 0xffff0000, v170
v_mul_f32 v4, v4, v44
v_mul_f32 v170, v170, v44
v_cvt_pk_bf16_f32 v170, v4, v170
v_lshlrev_b32 v4, 16, v171
v_and_b32 v171, 0xffff0000, v171
v_mul_f32 v4, v4, v44
v_mul_f32 v171, v171, v44
v_cvt_pk_bf16_f32 v171, v4, v171
v_lshlrev_b32 v4, 16, v172
v_and_b32 v172, 0xffff0000, v172
v_mul_f32 v4, v4, v44
v_mul_f32 v172, v172, v44
v_cvt_pk_bf16_f32 v172, v4, v172
v_lshlrev_b32 v4, 16, v173
v_and_b32 v173, 0xffff0000, v173
v_mul_f32 v4, v4, v44
v_mul_f32 v173, v173, v44
v_cvt_pk_bf16_f32 v173, v4, v173
v_lshlrev_b32 v4, 16, v174
v_and_b32 v174, 0xffff0000, v174
v_mul_f32 v4, v4, v44
v_mul_f32 v174, v174, v44
v_cvt_pk_bf16_f32 v174, v4, v174
v_lshlrev_b32 v4, 16, v175
v_and_b32 v175, 0xffff0000, v175
v_mul_f32 v4, v4, v44
v_mul_f32 v175, v175, v44
v_cvt_pk_bf16_f32 v175, v4, v175
v_lshlrev_b32 v4, 16, v176
v_and_b32 v176, 0xffff0000, v176
v_mul_f32 v4, v4, v36
v_mul_f32 v176, v176, v36
v_cvt_pk_bf16_f32 v176, v4, v176
v_lshlrev_b32 v4, 16, v177
v_and_b32 v177, 0xffff0000, v177
v_mul_f32 v4, v4, v36
v_mul_f32 v177, v177, v36
v_cvt_pk_bf16_f32 v177, v4, v177
v_lshlrev_b32 v4, 16, v178
v_and_b32 v178, 0xffff0000, v178
v_mul_f32 v4, v4, v36
v_mul_f32 v178, v178, v36
v_cvt_pk_bf16_f32 v178, v4, v178
v_lshlrev_b32 v4, 16, v179
v_and_b32 v179, 0xffff0000, v179
v_mul_f32 v4, v4, v36
v_mul_f32 v179, v179, v36
v_cvt_pk_bf16_f32 v179, v4, v179
v_lshlrev_b32 v4, 16, v180
v_and_b32 v180, 0xffff0000, v180
v_mul_f32 v4, v4, v36
v_mul_f32 v180, v180, v36
v_cvt_pk_bf16_f32 v180, v4, v180
v_lshlrev_b32 v4, 16, v181
v_and_b32 v181, 0xffff0000, v181
v_mul_f32 v4, v4, v36
v_mul_f32 v181, v181, v36
v_cvt_pk_bf16_f32 v181, v4, v181
v_lshlrev_b32 v4, 16, v182
v_and_b32 v182, 0xffff0000, v182
v_mul_f32 v4, v4, v36
v_mul_f32 v182, v182, v36
v_cvt_pk_bf16_f32 v182, v4, v182
v_lshlrev_b32 v4, 16, v183
v_and_b32 v183, 0xffff0000, v183
v_mul_f32 v4, v4, v36
v_mul_f32 v183, v183, v36
v_cvt_pk_bf16_f32 v183, v4, v183
v_lshlrev_b32 v4, 16, v184
v_and_b32 v184, 0xffff0000, v184
v_mul_f32 v4, v4, v44
v_mul_f32 v184, v184, v44
v_cvt_pk_bf16_f32 v184, v4, v184
v_lshlrev_b32 v4, 16, v185
v_and_b32 v185, 0xffff0000, v185
v_mul_f32 v4, v4, v44
v_mul_f32 v185, v185, v44
v_cvt_pk_bf16_f32 v185, v4, v185
v_lshlrev_b32 v4, 16, v186
v_and_b32 v186, 0xffff0000, v186
v_mul_f32 v4, v4, v44
v_mul_f32 v186, v186, v44
v_cvt_pk_bf16_f32 v186, v4, v186
v_lshlrev_b32 v4, 16, v187
v_and_b32 v187, 0xffff0000, v187
v_mul_f32 v4, v4, v44
v_mul_f32 v187, v187, v44
v_cvt_pk_bf16_f32 v187, v4, v187
v_lshlrev_b32 v4, 16, v188
v_and_b32 v188, 0xffff0000, v188
v_mul_f32 v4, v4, v44
v_mul_f32 v188, v188, v44
v_cvt_pk_bf16_f32 v188, v4, v188
v_lshlrev_b32 v4, 16, v189
v_and_b32 v189, 0xffff0000, v189
v_mul_f32 v4, v4, v44
v_mul_f32 v189, v189, v44
v_cvt_pk_bf16_f32 v189, v4, v189
v_lshlrev_b32 v4, 16, v190
v_and_b32 v190, 0xffff0000, v190
v_mul_f32 v4, v4, v44
v_mul_f32 v190, v190, v44
v_cvt_pk_bf16_f32 v190, v4, v190
v_lshlrev_b32 v4, 16, v191
v_and_b32 v191, 0xffff0000, v191
v_mul_f32 v4, v4, v44
v_mul_f32 v191, v191, v44
v_cvt_pk_bf16_f32 v191, v4, v191
s_nop 1
PC_RX_D0:
s_waitcnt lgkmcnt(15)
v_mfma_f32_32x32x16_bf16 v[96:111], v[20:23], v[128:131], v[96:111]
s_waitcnt lgkmcnt(14)
v_mfma_f32_32x32x16_bf16 v[96:111], v[24:27], v[132:135], v[96:111]
s_waitcnt lgkmcnt(13)
v_mfma_f32_32x32x16_bf16 v[112:127], v[20:23], v[136:139], v[112:127]
s_waitcnt lgkmcnt(12)
v_mfma_f32_32x32x16_bf16 v[112:127], v[24:27], v[140:143], v[112:127]
s_waitcnt lgkmcnt(11)
v_mfma_f32_32x32x16_bf16 a[160:175], v[20:23], v[144:147], a[160:175]
s_waitcnt lgkmcnt(10)
v_mfma_f32_32x32x16_bf16 a[160:175], v[24:27], v[148:151], a[160:175]
s_waitcnt lgkmcnt(9)
v_mfma_f32_32x32x16_bf16 a[176:191], v[20:23], v[152:155], a[176:191]
s_waitcnt lgkmcnt(8)
v_mfma_f32_32x32x16_bf16 a[176:191], v[24:27], v[156:159], a[176:191]
s_waitcnt lgkmcnt(7)
v_mfma_f32_32x32x16_bf16 a[192:207], v[20:23], v[160:163], a[192:207]
s_waitcnt lgkmcnt(6)
v_mfma_f32_32x32x16_bf16 a[192:207], v[24:27], v[164:167], a[192:207]
s_waitcnt lgkmcnt(5)
v_mfma_f32_32x32x16_bf16 a[208:223], v[20:23], v[168:171], a[208:223]
s_waitcnt lgkmcnt(4)
v_mfma_f32_32x32x16_bf16 a[208:223], v[24:27], v[172:175], a[208:223]
s_waitcnt lgkmcnt(3)
v_mfma_f32_32x32x16_bf16 a[224:239], v[20:23], v[176:179], a[224:239]
s_waitcnt lgkmcnt(2)
v_mfma_f32_32x32x16_bf16 a[224:239], v[24:27], v[180:183], a[224:239]
s_waitcnt lgkmcnt(1)
v_mfma_f32_32x32x16_bf16 a[240:255], v[20:23], v[184:187], a[240:255]
s_waitcnt lgkmcnt(0)
v_mfma_f32_32x32x16_bf16 a[240:255], v[24:27], v[188:191], a[240:255]
PC_NOD0:
s_cmp_eq_u32 s60, 0
s_cbranch_scc1 PC_NOD1
s_lshl_b32 s45, s3, 14
s_add_u32 s45, s45, 98304
v_add_u32 v6, s45, v5
s_nop 0
ds_read_b128 v[128:131], v6
ds_read_b128 v[132:135], v6 offset:1024
ds_read_b128 v[136:139], v6 offset:2048
ds_read_b128 v[140:143], v6 offset:3072
ds_read_b128 v[144:147], v6 offset:4096
ds_read_b128 v[148:151], v6 offset:5120
ds_read_b128 v[152:155], v6 offset:6144
ds_read_b128 v[156:159], v6 offset:7168
ds_read_b128 v[160:163], v6 offset:8192
ds_read_b128 v[164:167], v6 offset:9216
ds_read_b128 v[168:171], v6 offset:10240
ds_read_b128 v[172:175], v6 offset:11264
ds_read_b128 v[176:179], v6 offset:12288
ds_read_b128 v[180:183], v6 offset:13312
ds_read_b128 v[184:187], v6 offset:14336
ds_read_b128 v[188:191], v6 offset:15360
v_cmp_neq_f32 vcc, 1.0, v38
v_cmp_neq_f32 s[50:51], 1.0, v46
s_or_b64 s[50:51], vcc, s[50:51]
s_cbranch_scc0 PC_RX_D1
s_waitcnt lgkmcnt(0)
v_lshlrev_b32 v4, 16, v128
v_and_b32 v128, 0xffff0000, v128
v_mul_f32 v4, v4, v38
v_mul_f32 v128, v128, v38
v_cvt_pk_bf16_f32 v128, v4, v128
v_lshlrev_b32 v4, 16, v129
v_and_b32 v129, 0xffff0000, v129
v_mul_f32 v4, v4, v38
v_mul_f32 v129, v129, v38
v_cvt_pk_bf16_f32 v129, v4, v129
v_lshlrev_b32 v4, 16, v130
v_and_b32 v130, 0xffff0000, v130
v_mul_f32 v4, v4, v38
v_mul_f32 v130, v130, v38
v_cvt_pk_bf16_f32 v130, v4, v130
v_lshlrev_b32 v4, 16, v131
v_and_b32 v131, 0xffff0000, v131
v_mul_f32 v4, v4, v38
v_mul_f32 v131, v131, v38
v_cvt_pk_bf16_f32 v131, v4, v131
v_lshlrev_b32 v4, 16, v132
v_and_b32 v132, 0xffff0000, v132
v_mul_f32 v4, v4, v38
v_mul_f32 v132, v132, v38
v_cvt_pk_bf16_f32 v132, v4, v132
v_lshlrev_b32 v4, 16, v133
v_and_b32 v133, 0xffff0000, v133
v_mul_f32 v4, v4, v38
v_mul_f32 v133, v133, v38
v_cvt_pk_bf16_f32 v133, v4, v133
v_lshlrev_b32 v4, 16, v134
v_and_b32 v134, 0xffff0000, v134
v_mul_f32 v4, v4, v38
v_mul_f32 v134, v134, v38
v_cvt_pk_bf16_f32 v134, v4, v134
v_lshlrev_b32 v4, 16, v135
v_and_b32 v135, 0xffff0000, v135
v_mul_f32 v4, v4, v38
v_mul_f32 v135, v135, v38
v_cvt_pk_bf16_f32 v135, v4, v135
v_lshlrev_b32 v4, 16, v136
v_and_b32 v136, 0xffff0000, v136
v_mul_f32 v4, v4, v46
v_mul_f32 v136, v136, v46
v_cvt_pk_bf16_f32 v136, v4, v136
v_lshlrev_b32 v4, 16, v137
v_and_b32 v137, 0xffff0000, v137
v_mul_f32 v4, v4, v46
v_mul_f32 v137, v137, v46
v_cvt_pk_bf16_f32 v137, v4, v137
v_lshlrev_b32 v4, 16, v138
v_and_b32 v138, 0xffff0000, v138
v_mul_f32 v4, v4, v46
v_mul_f32 v138, v138, v46
v_cvt_pk_bf16_f32 v138, v4, v138
v_lshlrev_b32 v4, 16, v139
v_and_b32 v139, 0xffff0000, v139
v_mul_f32 v4, v4, v46
v_mul_f32 v139, v139, v46
v_cvt_pk_bf16_f32 v139, v4, v139
v_lshlrev_b32 v4, 16, v140
v_and_b32 v140, 0xffff0000, v140
v_mul_f32 v4, v4, v46
v_mul_f32 v140, v140, v46
v_cvt_pk_bf16_f32 v140, v4, v140
v_lshlrev_b32 v4, 16, v141
v_and_b32 v141, 0xffff0000, v141
v_mul_f32 v4, v4, v46
v_mul_f32 v141, v141, v46
v_cvt_pk_bf16_f32 v141, v4, v141
v_lshlrev_b32 v4, 16, v142
v_and_b32 v142, 0xffff0000, v142
v_mul_f32 v4, v4, v46
v_mul_f32 v142, v142, v46
v_cvt_pk_bf16_f32 v142, v4, v142
v_lshlrev_b32 v4, 16, v143
v_and_b32 v143, 0xffff0000, v143
v_mul_f32 v4, v4, v46
v_mul_f32 v143, v143, v46
v_cvt_pk_bf16_f32 v143, v4, v143
v_lshlrev_b32 v4, 16, v144
v_and_b32 v144, 0xffff0000, v144
v_mul_f32 v4, v4, v38
v_mul_f32 v144, v144, v38
v_cvt_pk_bf16_f32 v144, v4, v144
v_lshlrev_b32 v4, 16, v145
v_and_b32 v145, 0xffff0000, v145
v_mul_f32 v4, v4, v38
v_mul_f32 v145, v145, v38
v_cvt_pk_bf16_f32 v145, v4, v145
v_lshlrev_b32 v4, 16, v146
v_and_b32 v146, 0xffff0000, v146
v_mul_f32 v4, v4, v38
v_mul_f32 v146, v146, v38
v_cvt_pk_bf16_f32 v146, v4, v146
v_lshlrev_b32 v4, 16, v147
v_and_b32 v147, 0xffff0000, v147
v_mul_f32 v4, v4, v38
v_mul_f32 v147, v147, v38
v_cvt_pk_bf16_f32 v147, v4, v147
v_lshlrev_b32 v4, 16, v148
v_and_b32 v148, 0xffff0000, v148
v_mul_f32 v4, v4, v38
v_mul_f32 v148, v148, v38
v_cvt_pk_bf16_f32 v148, v4, v148
v_lshlrev_b32 v4, 16, v149
v_and_b32 v149, 0xffff0000, v149
v_mul_f32 v4, v4, v38
v_mul_f32 v149, v149, v38
v_cvt_pk_bf16_f32 v149, v4, v149
v_lshlrev_b32 v4, 16, v150
v_and_b32 v150, 0xffff0000, v150
v_mul_f32 v4, v4, v38
v_mul_f32 v150, v150, v38
v_cvt_pk_bf16_f32 v150, v4, v150
v_lshlrev_b32 v4, 16, v151
v_and_b32 v151, 0xffff0000, v151
v_mul_f32 v4, v4, v38
v_mul_f32 v151, v151, v38
v_cvt_pk_bf16_f32 v151, v4, v151
v_lshlrev_b32 v4, 16, v152
v_and_b32 v152, 0xffff0000, v152
v_mul_f32 v4, v4, v46
v_mul_f32 v152, v152, v46
v_cvt_pk_bf16_f32 v152, v4, v152
v_lshlrev_b32 v4, 16, v153
v_and_b32 v153, 0xffff0000, v153
v_mul_f32 v4, v4, v46
v_mul_f32 v153, v153, v46
v_cvt_pk_bf16_f32 v153, v4, v153
v_lshlrev_b32 v4, 16, v154
v_and_b32 v154, 0xffff0000, v154
v_mul_f32 v4, v4, v46
v_mul_f32 v154, v154, v46
v_cvt_pk_bf16_f32 v154, v4, v154
v_lshlrev_b32 v4, 16, v155
v_and_b32 v155, 0xffff0000, v155
v_mul_f32 v4, v4, v46
v_mul_f32 v155, v155, v46
v_cvt_pk_bf16_f32 v155, v4, v155
v_lshlrev_b32 v4, 16, v156
v_and_b32 v156, 0xffff0000, v156
v_mul_f32 v4, v4, v46
v_mul_f32 v156, v156, v46
v_cvt_pk_bf16_f32 v156, v4, v156
v_lshlrev_b32 v4, 16, v157
v_and_b32 v157, 0xffff0000, v157
v_mul_f32 v4, v4, v46
v_mul_f32 v157, v157, v46
v_cvt_pk_bf16_f32 v157, v4, v157
v_lshlrev_b32 v4, 16, v158
v_and_b32 v158, 0xffff0000, v158
v_mul_f32 v4, v4, v46
v_mul_f32 v158, v158, v46
v_cvt_pk_bf16_f32 v158, v4, v158
v_lshlrev_b32 v4, 16, v159
v_and_b32 v159, 0xffff0000, v159
v_mul_f32 v4, v4, v46
v_mul_f32 v159, v159, v46
v_cvt_pk_bf16_f32 v159, v4, v159
v_lshlrev_b32 v4, 16, v160
v_and_b32 v160, 0xffff0000, v160
v_mul_f32 v4, v4, v38
v_mul_f32 v160, v160, v38
v_cvt_pk_bf16_f32 v160, v4, v160
v_lshlrev_b32 v4, 16, v161
v_and_b32 v161, 0xffff0000, v161
v_mul_f32 v4, v4, v38
v_mul_f32 v161, v161, v38
v_cvt_pk_bf16_f32 v161, v4, v161
v_lshlrev_b32 v4, 16, v162
v_and_b32 v162, 0xffff0000, v162
v_mul_f32 v4, v4, v38
v_mul_f32 v162, v162, v38
v_cvt_pk_bf16_f32 v162, v4, v162
v_lshlrev_b32 v4, 16, v163
v_and_b32 v163, 0xffff0000, v163
v_mul_f32 v4, v4, v38
v_mul_f32 v163, v163, v38
v_cvt_pk_bf16_f32 v163, v4, v163
v_lshlrev_b32 v4, 16, v164
v_and_b32 v164, 0xffff0000, v164
v_mul_f32 v4, v4, v38
v_mul_f32 v164, v164, v38
v_cvt_pk_bf16_f32 v164, v4, v164
v_lshlrev_b32 v4, 16, v165
v_and_b32 v165, 0xffff0000, v165
v_mul_f32 v4, v4, v38
v_mul_f32 v165, v165, v38
v_cvt_pk_bf16_f32 v165, v4, v165
v_lshlrev_b32 v4, 16, v166
v_and_b32 v166, 0xffff0000, v166
v_mul_f32 v4, v4, v38
v_mul_f32 v166, v166, v38
v_cvt_pk_bf16_f32 v166, v4, v166
v_lshlrev_b32 v4, 16, v167
v_and_b32 v167, 0xffff0000, v167
v_mul_f32 v4, v4, v38
v_mul_f32 v167, v167, v38
v_cvt_pk_bf16_f32 v167, v4, v167
v_lshlrev_b32 v4, 16, v168
v_and_b32 v168, 0xffff0000, v168
v_mul_f32 v4, v4, v46
v_mul_f32 v168, v168, v46
v_cvt_pk_bf16_f32 v168, v4, v168
v_lshlrev_b32 v4, 16, v169
v_and_b32 v169, 0xffff0000, v169
v_mul_f32 v4, v4, v46
v_mul_f32 v169, v169, v46
v_cvt_pk_bf16_f32 v169, v4, v169
v_lshlrev_b32 v4, 16, v170
v_and_b32 v170, 0xffff0000, v170
v_mul_f32 v4, v4, v46
v_mul_f32 v170, v170, v46
v_cvt_pk_bf16_f32 v170, v4, v170
v_lshlrev_b32 v4, 16, v171
v_and_b32 v171, 0xffff0000, v171
v_mul_f32 v4, v4, v46
v_mul_f32 v171, v171, v46
v_cvt_pk_bf16_f32 v171, v4, v171
v_lshlrev_b32 v4, 16, v172
v_and_b32 v172, 0xffff0000, v172
v_mul_f32 v4, v4, v46
v_mul_f32 v172, v172, v46
v_cvt_pk_bf16_f32 v172, v4, v172
v_lshlrev_b32 v4, 16, v173
v_and_b32 v173, 0xffff0000, v173
v_mul_f32 v4, v4, v46
v_mul_f32 v173, v173, v46
v_cvt_pk_bf16_f32 v173, v4, v173
v_lshlrev_b32 v4, 16, v174
v_and_b32 v174, 0xffff0000, v174
v_mul_f32 v4, v4, v46
v_mul_f32 v174, v174, v46
v_cvt_pk_bf16_f32 v174, v4, v174
v_lshlrev_b32 v4, 16, v175
v_and_b32 v175, 0xffff0000, v175
v_mul_f32 v4, v4, v46
v_mul_f32 v175, v175, v46
v_cvt_pk_bf16_f32 v175, v4, v175
v_lshlrev_b32 v4, 16, v176
v_and_b32 v176, 0xffff0000, v176
v_mul_f32 v4, v4, v38
v_mul_f32 v176, v176, v38
v_cvt_pk_bf16_f32 v176, v4, v176
v_lshlrev_b32 v4, 16, v177
v_and_b32 v177, 0xffff0000, v177
v_mul_f32 v4, v4, v38
v_mul_f32 v177, v177, v38
v_cvt_pk_bf16_f32 v177, v4, v177
v_lshlrev_b32 v4, 16, v178
v_and_b32 v178, 0xffff0000, v178
v_mul_f32 v4, v4, v38
v_mul_f32 v178, v178, v38
v_cvt_pk_bf16_f32 v178, v4, v178
v_lshlrev_b32 v4, 16, v179
v_and_b32 v179, 0xffff0000, v179
v_mul_f32 v4, v4, v38
v_mul_f32 v179, v179, v38
v_cvt_pk_bf16_f32 v179, v4, v179
v_lshlrev_b32 v4, 16, v180
v_and_b32 v180, 0xffff0000, v180
v_mul_f32 v4, v4, v38
v_mul_f32 v180, v180, v38
v_cvt_pk_bf16_f32 v180, v4, v180
v_lshlrev_b32 v4, 16, v181
v_and_b32 v181, 0xffff0000, v181
v_mul_f32 v4, v4, v38
v_mul_f32 v181, v181, v38
v_cvt_pk_bf16_f32 v181, v4, v181
v_lshlrev_b32 v4, 16, v182
v_and_b32 v182, 0xffff0000, v182
v_mul_f32 v4, v4, v38
v_mul_f32 v182, v182, v38
v_cvt_pk_bf16_f32 v182, v4, v182
v_lshlrev_b32 v4, 16, v183
v_and_b32 v183, 0xffff0000, v183
v_mul_f32 v4, v4, v38
v_mul_f32 v183, v183, v38
v_cvt_pk_bf16_f32 v183, v4, v183
v_lshlrev_b32 v4, 16, v184
v_and_b32 v184, 0xffff0000, v184
v_mul_f32 v4, v4, v46
v_mul_f32 v184, v184, v46
v_cvt_pk_bf16_f32 v184, v4, v184
v_lshlrev_b32 v4, 16, v185
v_and_b32 v185, 0xffff0000, v185
v_mul_f32 v4, v4, v46
v_mul_f32 v185, v185, v46
v_cvt_pk_bf16_f32 v185, v4, v185
v_lshlrev_b32 v4, 16, v186
v_and_b32 v186, 0xffff0000, v186
v_mul_f32 v4, v4, v46
v_mul_f32 v186, v186, v46
v_cvt_pk_bf16_f32 v186, v4, v186
v_lshlrev_b32 v4, 16, v187
v_and_b32 v187, 0xffff0000, v187
v_mul_f32 v4, v4, v46
v_mul_f32 v187, v187, v46
v_cvt_pk_bf16_f32 v187, v4, v187
v_lshlrev_b32 v4, 16, v188
v_and_b32 v188, 0xffff0000, v188
v_mul_f32 v4, v4, v46
v_mul_f32 v188, v188, v46
v_cvt_pk_bf16_f32 v188, v4, v188
v_lshlrev_b32 v4, 16, v189
v_and_b32 v189, 0xffff0000, v189
v_mul_f32 v4, v4, v46
v_mul_f32 v189, v189, v46
v_cvt_pk_bf16_f32 v189, v4, v189
v_lshlrev_b32 v4, 16, v190
v_and_b32 v190, 0xffff0000, v190
v_mul_f32 v4, v4, v46
v_mul_f32 v190, v190, v46
v_cvt_pk_bf16_f32 v190, v4, v190
v_lshlrev_b32 v4, 16, v191
v_and_b32 v191, 0xffff0000, v191
v_mul_f32 v4, v4, v46
v_mul_f32 v191, v191, v46
v_cvt_pk_bf16_f32 v191, v4, v191
s_nop 1
PC_RX_D1:
s_waitcnt lgkmcnt(15)
v_mfma_f32_32x32x16_bf16 v[96:111], v[20:23], v[128:131], v[96:111]
s_waitcnt lgkmcnt(14)
v_mfma_f32_32x32x16_bf16 v[96:111], v[24:27], v[132:135], v[96:111]
s_waitcnt lgkmcnt(13)
v_mfma_f32_32x32x16_bf16 v[112:127], v[20:23], v[136:139], v[112:127]
s_waitcnt lgkmcnt(12)
v_mfma_f32_32x32x16_bf16 v[112:127], v[24:27], v[140:143], v[112:127]
s_waitcnt lgkmcnt(11)
v_mfma_f32_32x32x16_bf16 a[160:175], v[20:23], v[144:147], a[160:175]
s_waitcnt lgkmcnt(10)
v_mfma_f32_32x32x16_bf16 a[160:175], v[24:27], v[148:151], a[160:175]
s_waitcnt lgkmcnt(9)
v_mfma_f32_32x32x16_bf16 a[176:191], v[20:23], v[152:155], a[176:191]
s_waitcnt lgkmcnt(8)
v_mfma_f32_32x32x16_bf16 a[176:191], v[24:27], v[156:159], a[176:191]
s_waitcnt lgkmcnt(7)
v_mfma_f32_32x32x16_bf16 a[192:207], v[20:23], v[160:163], a[192:207]
s_waitcnt lgkmcnt(6)
v_mfma_f32_32x32x16_bf16 a[192:207], v[24:27], v[164:167], a[192:207]
s_waitcnt lgkmcnt(5)
v_mfma_f32_32x32x16_bf16 a[208:223], v[20:23], v[168:171], a[208:223]
s_waitcnt lgkmcnt(4)
v_mfma_f32_32x32x16_bf16 a[208:223], v[24:27], v[172:175], a[208:223]
s_waitcnt lgkmcnt(3)
v_mfma_f32_32x32x16_bf16 a[224:239], v[20:23], v[176:179], a[224:239]
s_waitcnt lgkmcnt(2)
v_mfma_f32_32x32x16_bf16 a[224:239], v[24:27], v[180:183], a[224:239]
s_waitcnt lgkmcnt(1)
v_mfma_f32_32x32x16_bf16 a[240:255], v[20:23], v[184:187], a[240:255]
s_waitcnt lgkmcnt(0)
v_mfma_f32_32x32x16_bf16 a[240:255], v[24:27], v[188:191], a[240:255]
PC_NOD1:
s_sub_u32 s6, 31, s5
s_cmp_lt_u32 s3, 2
s_cselect_b32 s6, s6, s5
s_lshl_b32 s45, s6, 19
s_lshl_b32 s43, s4, 14
s_add_u32 s45, s45, s43
s_and_b32 s43, s3, 1
s_lshl_b32 s43, s43, 13
s_add_u32 s45, s45, s43
s_add_u32 s44, s45, 262144
s_add_u32 s46, s45, 4096
s_add_u32 s47, s44, 4096
s_nop 7
s_nop 0
v_pk_mul_f32 v[64:65], v[96:97], v[12:13] op_sel:[0,0] op_sel_hi:[1,0]
v_pk_mul_f32 v[66:67], v[98:99], v[12:13] op_sel:[0,0] op_sel_hi:[1,0]
v_pk_mul_f32 v[68:69], v[100:101], v[12:13] op_sel:[0,0] op_sel_hi:[1,0]
v_pk_mul_f32 v[70:71], v[102:103], v[12:13] op_sel:[0,0] op_sel_hi:[1,0]
v_pk_mul_f32 v[72:73], v[104:105], v[12:13] op_sel:[0,0] op_sel_hi:[1,0]
v_pk_mul_f32 v[74:75], v[106:107], v[12:13] op_sel:[0,0] op_sel_hi:[1,0]
v_pk_mul_f32 v[76:77], v[108:109], v[12:13] op_sel:[0,0] op_sel_hi:[1,0]
v_pk_mul_f32 v[78:79], v[110:111], v[12:13] op_sel:[0,0] op_sel_hi:[1,0]
v_cvt_pk_bf16_f32 v64, v64, v65
v_cvt_pk_bf16_f32 v65, v66, v67
v_cvt_pk_bf16_f32 v66, v68, v69
v_cvt_pk_bf16_f32 v67, v70, v71
v_cvt_pk_bf16_f32 v68, v72, v73
v_cvt_pk_bf16_f32 v69, v74, v75
v_cvt_pk_bf16_f32 v70, v76, v77
v_cvt_pk_bf16_f32 v71, v78, v79
buffer_store_dwordx4 v[64:67], v5, s[20:23], s45 offen sc1
buffer_store_dwordx4 v[68:71], v5, s[20:23], s45 offen offset:1024 sc1
v_pk_mul_f32 v[80:81], v[112:113], v[12:13] op_sel:[0,1] op_sel_hi:[1,1]
v_pk_mul_f32 v[82:83], v[114:115], v[12:13] op_sel:[0,1] op_sel_hi:[1,1]
v_pk_mul_f32 v[84:85], v[116:117], v[12:13] op_sel:[0,1] op_sel_hi:[1,1]
v_pk_mul_f32 v[86:87], v[118:119], v[12:13] op_sel:[0,1] op_sel_hi:[1,1]
v_pk_mul_f32 v[88:89], v[120:121], v[12:13] op_sel:[0,1] op_sel_hi:[1,1]
v_pk_mul_f32 v[90:91], v[122:123], v[12:13] op_sel:[0,1] op_sel_hi:[1,1]
v_pk_mul_f32 v[92:93], v[124:125], v[12:13] op_sel:[0,1] op_sel_hi:[1,1]
v_pk_mul_f32 v[94:95], v[126:127], v[12:13] op_sel:[0,1] op_sel_hi:[1,1]
v_cvt_pk_bf16_f32 v80, v80, v81
v_cvt_pk_bf16_f32 v81, v82, v83
v_cvt_pk_bf16_f32 v82, v84, v85
v_cvt_pk_bf16_f32 v83, v86, v87
v_cvt_pk_bf16_f32 v84, v88, v89
v_cvt_pk_bf16_f32 v85, v90, v91
v_cvt_pk_bf16_f32 v86, v92, v93
v_cvt_pk_bf16_f32 v87, v94, v95
buffer_store_dwordx4 v[80:83], v5, s[20:23], s44 offen sc1
buffer_store_dwordx4 v[84:87], v5, s[20:23], s44 offen offset:1024 sc1
v_accvgpr_read_b32 v64, a160
v_accvgpr_read_b32 v65, a161
v_accvgpr_read_b32 v66, a162
v_accvgpr_read_b32 v67, a163
v_accvgpr_read_b32 v68, a164
v_accvgpr_read_b32 v69, a165
v_accvgpr_read_b32 v70, a166
v_accvgpr_read_b32 v71, a167
v_accvgpr_read_b32 v72, a168
v_accvgpr_read_b32 v73, a169
v_accvgpr_read_b32 v74, a170
v_accvgpr_read_b32 v75, a171
v_accvgpr_read_b32 v76, a172
v_accvgpr_read_b32 v77, a173
v_accvgpr_read_b32 v78, a174
v_accvgpr_read_b32 v79, a175
v_pk_mul_f32 v[64:65], v[64:65], v[12:13] op_sel:[0,0] op_sel_hi:[1,0]
v_pk_mul_f32 v[66:67], v[66:67], v[12:13] op_sel:[0,0] op_sel_hi:[1,0]
v_pk_mul_f32 v[68:69], v[68:69], v[12:13] op_sel:[0,0] op_sel_hi:[1,0]
v_pk_mul_f32 v[70:71], v[70:71], v[12:13] op_sel:[0,0] op_sel_hi:[1,0]
v_pk_mul_f32 v[72:73], v[72:73], v[12:13] op_sel:[0,0] op_sel_hi:[1,0]
v_pk_mul_f32 v[74:75], v[74:75], v[12:13] op_sel:[0,0] op_sel_hi:[1,0]
v_pk_mul_f32 v[76:77], v[76:77], v[12:13] op_sel:[0,0] op_sel_hi:[1,0]
v_pk_mul_f32 v[78:79], v[78:79], v[12:13] op_sel:[0,0] op_sel_hi:[1,0]
v_cvt_pk_bf16_f32 v64, v64, v65
v_cvt_pk_bf16_f32 v65, v66, v67
v_cvt_pk_bf16_f32 v66, v68, v69
v_cvt_pk_bf16_f32 v67, v70, v71
v_cvt_pk_bf16_f32 v68, v72, v73
v_cvt_pk_bf16_f32 v69, v74, v75
v_cvt_pk_bf16_f32 v70, v76, v77
v_cvt_pk_bf16_f32 v71, v78, v79
buffer_store_dwordx4 v[64:67], v5, s[20:23], s45 offen offset:2048 sc1
buffer_store_dwordx4 v[68:71], v5, s[20:23], s45 offen offset:3072 sc1
v_accvgpr_read_b32 v80, a176
v_accvgpr_read_b32 v81, a177
v_accvgpr_read_b32 v82, a178
v_accvgpr_read_b32 v83, a179
v_accvgpr_read_b32 v84, a180
v_accvgpr_read_b32 v85, a181
v_accvgpr_read_b32 v86, a182
v_accvgpr_read_b32 v87, a183
v_accvgpr_read_b32 v88, a184
v_accvgpr_read_b32 v89, a185
v_accvgpr_read_b32 v90, a186
v_accvgpr_read_b32 v91, a187
v_accvgpr_read_b32 v92, a188
v_accvgpr_read_b32 v93, a189
v_accvgpr_read_b32 v94, a190
v_accvgpr_read_b32 v95, a191
v_pk_mul_f32 v[80:81], v[80:81], v[12:13] op_sel:[0,1] op_sel_hi:[1,1]
v_pk_mul_f32 v[82:83], v[82:83], v[12:13] op_sel:[0,1] op_sel_hi:[1,1]
v_pk_mul_f32 v[84:85], v[84:85], v[12:13] op_sel:[0,1] op_sel_hi:[1,1]
v_pk_mul_f32 v[86:87], v[86:87], v[12:13] op_sel:[0,1] op_sel_hi:[1,1]
v_pk_mul_f32 v[88:89], v[88:89], v[12:13] op_sel:[0,1] op_sel_hi:[1,1]
v_pk_mul_f32 v[90:91], v[90:91], v[12:13] op_sel:[0,1] op_sel_hi:[1,1]
v_pk_mul_f32 v[92:93], v[92:93], v[12:13] op_sel:[0,1] op_sel_hi:[1,1]
v_pk_mul_f32 v[94:95], v[94:95], v[12:13] op_sel:[0,1] op_sel_hi:[1,1]
v_cvt_pk_bf16_f32 v80, v80, v81
v_cvt_pk_bf16_f32 v81, v82, v83
v_cvt_pk_bf16_f32 v82, v84, v85
v_cvt_pk_bf16_f32 v83, v86, v87
v_cvt_pk_bf16_f32 v84, v88, v89
v_cvt_pk_bf16_f32 v85, v90, v91
v_cvt_pk_bf16_f32 v86, v92, v93
v_cvt_pk_bf16_f32 v87, v94, v95
buffer_store_dwordx4 v[80:83], v5, s[20:23], s44 offen offset:2048 sc1
buffer_store_dwordx4 v[84:87], v5, s[20:23], s44 offen offset:3072 sc1
v_accvgpr_read_b32 v64, a192
v_accvgpr_read_b32 v65, a193
v_accvgpr_read_b32 v66, a194
v_accvgpr_read_b32 v67, a195
v_accvgpr_read_b32 v68, a196
v_accvgpr_read_b32 v69, a197
v_accvgpr_read_b32 v70, a198
v_accvgpr_read_b32 v71, a199
v_accvgpr_read_b32 v72, a200
v_accvgpr_read_b32 v73, a201
v_accvgpr_read_b32 v74, a202
v_accvgpr_read_b32 v75, a203
v_accvgpr_read_b32 v76, a204
v_accvgpr_read_b32 v77, a205
v_accvgpr_read_b32 v78, a206
v_accvgpr_read_b32 v79, a207
v_pk_mul_f32 v[64:65], v[64:65], v[12:13] op_sel:[0,0] op_sel_hi:[1,0]
v_pk_mul_f32 v[66:67], v[66:67], v[12:13] op_sel:[0,0] op_sel_hi:[1,0]
v_pk_mul_f32 v[68:69], v[68:69], v[12:13] op_sel:[0,0] op_sel_hi:[1,0]
v_pk_mul_f32 v[70:71], v[70:71], v[12:13] op_sel:[0,0] op_sel_hi:[1,0]
v_pk_mul_f32 v[72:73], v[72:73], v[12:13] op_sel:[0,0] op_sel_hi:[1,0]
v_pk_mul_f32 v[74:75], v[74:75], v[12:13] op_sel:[0,0] op_sel_hi:[1,0]
v_pk_mul_f32 v[76:77], v[76:77], v[12:13] op_sel:[0,0] op_sel_hi:[1,0]
v_pk_mul_f32 v[78:79], v[78:79], v[12:13] op_sel:[0,0] op_sel_hi:[1,0]
v_cvt_pk_bf16_f32 v64, v64, v65
v_cvt_pk_bf16_f32 v65, v66, v67
v_cvt_pk_bf16_f32 v66, v68, v69
v_cvt_pk_bf16_f32 v67, v70, v71
v_cvt_pk_bf16_f32 v68, v72, v73
v_cvt_pk_bf16_f32 v69, v74, v75
v_cvt_pk_bf16_f32 v70, v76, v77
v_cvt_pk_bf16_f32 v71, v78, v79
buffer_store_dwordx4 v[64:67], v5, s[20:23], s46 offen sc1
buffer_store_dwordx4 v[68:71], v5, s[20:23], s46 offen offset:1024 sc1
v_accvgpr_read_b32 v80, a208
v_accvgpr_read_b32 v81, a209
v_accvgpr_read_b32 v82, a210
v_accvgpr_read_b32 v83, a211
v_accvgpr_read_b32 v84, a212
v_accvgpr_read_b32 v85, a213
v_accvgpr_read_b32 v86, a214
v_accvgpr_read_b32 v87, a215
v_accvgpr_read_b32 v88, a216
v_accvgpr_read_b32 v89, a217
v_accvgpr_read_b32 v90, a218
v_accvgpr_read_b32 v91, a219
v_accvgpr_read_b32 v92, a220
v_accvgpr_read_b32 v93, a221
v_accvgpr_read_b32 v94, a222
v_accvgpr_read_b32 v95, a223
v_pk_mul_f32 v[80:81], v[80:81], v[12:13] op_sel:[0,1] op_sel_hi:[1,1]
v_pk_mul_f32 v[82:83], v[82:83], v[12:13] op_sel:[0,1] op_sel_hi:[1,1]
v_pk_mul_f32 v[84:85], v[84:85], v[12:13] op_sel:[0,1] op_sel_hi:[1,1]
v_pk_mul_f32 v[86:87], v[86:87], v[12:13] op_sel:[0,1] op_sel_hi:[1,1]
v_pk_mul_f32 v[88:89], v[88:89], v[12:13] op_sel:[0,1] op_sel_hi:[1,1]
v_pk_mul_f32 v[90:91], v[90:91], v[12:13] op_sel:[0,1] op_sel_hi:[1,1]
v_pk_mul_f32 v[92:93], v[92:93], v[12:13] op_sel:[0,1] op_sel_hi:[1,1]
v_pk_mul_f32 v[94:95], v[94:95], v[12:13] op_sel:[0,1] op_sel_hi:[1,1]
v_cvt_pk_bf16_f32 v80, v80, v81
v_cvt_pk_bf16_f32 v81, v82, v83
v_cvt_pk_bf16_f32 v82, v84, v85
v_cvt_pk_bf16_f32 v83, v86, v87
v_cvt_pk_bf16_f32 v84, v88, v89
v_cvt_pk_bf16_f32 v85, v90, v91
v_cvt_pk_bf16_f32 v86, v92, v93
v_cvt_pk_bf16_f32 v87, v94, v95
buffer_store_dwordx4 v[80:83], v5, s[20:23], s47 offen sc1
buffer_store_dwordx4 v[84:87], v5, s[20:23], s47 offen offset:1024 sc1
v_accvgpr_read_b32 v64, a224
v_accvgpr_read_b32 v65, a225
v_accvgpr_read_b32 v66, a226
v_accvgpr_read_b32 v67, a227
v_accvgpr_read_b32 v68, a228
v_accvgpr_read_b32 v69, a229
v_accvgpr_read_b32 v70, a230
v_accvgpr_read_b32 v71, a231
v_accvgpr_read_b32 v72, a232
v_accvgpr_read_b32 v73, a233
v_accvgpr_read_b32 v74, a234
v_accvgpr_read_b32 v75, a235
v_accvgpr_read_b32 v76, a236
v_accvgpr_read_b32 v77, a237
v_accvgpr_read_b32 v78, a238
v_accvgpr_read_b32 v79, a239
v_pk_mul_f32 v[64:65], v[64:65], v[12:13] op_sel:[0,0] op_sel_hi:[1,0]
v_pk_mul_f32 v[66:67], v[66:67], v[12:13] op_sel:[0,0] op_sel_hi:[1,0]
v_pk_mul_f32 v[68:69], v[68:69], v[12:13] op_sel:[0,0] op_sel_hi:[1,0]
v_pk_mul_f32 v[70:71], v[70:71], v[12:13] op_sel:[0,0] op_sel_hi:[1,0]
v_pk_mul_f32 v[72:73], v[72:73], v[12:13] op_sel:[0,0] op_sel_hi:[1,0]
v_pk_mul_f32 v[74:75], v[74:75], v[12:13] op_sel:[0,0] op_sel_hi:[1,0]
v_pk_mul_f32 v[76:77], v[76:77], v[12:13] op_sel:[0,0] op_sel_hi:[1,0]
v_pk_mul_f32 v[78:79], v[78:79], v[12:13] op_sel:[0,0] op_sel_hi:[1,0]
v_cvt_pk_bf16_f32 v64, v64, v65
v_cvt_pk_bf16_f32 v65, v66, v67
v_cvt_pk_bf16_f32 v66, v68, v69
v_cvt_pk_bf16_f32 v67, v70, v71
v_cvt_pk_bf16_f32 v68, v72, v73
v_cvt_pk_bf16_f32 v69, v74, v75
v_cvt_pk_bf16_f32 v70, v76, v77
v_cvt_pk_bf16_f32 v71, v78, v79
buffer_store_dwordx4 v[64:67], v5, s[20:23], s46 offen offset:2048 sc1
buffer_store_dwordx4 v[68:71], v5, s[20:23], s46 offen offset:3072 sc1
v_accvgpr_read_b32 v80, a240
v_accvgpr_read_b32 v81, a241
v_accvgpr_read_b32 v82, a242
v_accvgpr_read_b32 v83, a243
v_accvgpr_read_b32 v84, a244
v_accvgpr_read_b32 v85, a245
v_accvgpr_read_b32 v86, a246
v_accvgpr_read_b32 v87, a247
v_accvgpr_read_b32 v88, a248
v_accvgpr_read_b32 v89, a249
v_accvgpr_read_b32 v90, a250
v_accvgpr_read_b32 v91, a251
v_accvgpr_read_b32 v92, a252
v_accvgpr_read_b32 v93, a253
v_accvgpr_read_b32 v94, a254
v_accvgpr_read_b32 v95, a255
v_pk_mul_f32 v[80:81], v[80:81], v[12:13] op_sel:[0,1] op_sel_hi:[1,1]
v_pk_mul_f32 v[82:83], v[82:83], v[12:13] op_sel:[0,1] op_sel_hi:[1,1]
v_pk_mul_f32 v[84:85], v[84:85], v[12:13] op_sel:[0,1] op_sel_hi:[1,1]
v_pk_mul_f32 v[86:87], v[86:87], v[12:13] op_sel:[0,1] op_sel_hi:[1,1]
v_pk_mul_f32 v[88:89], v[88:89], v[12:13] op_sel:[0,1] op_sel_hi:[1,1]
v_pk_mul_f32 v[90:91], v[90:91], v[12:13] op_sel:[0,1] op_sel_hi:[1,1]
v_pk_mul_f32 v[92:93], v[92:93], v[12:13] op_sel:[0,1] op_sel_hi:[1,1]
v_pk_mul_f32 v[94:95], v[94:95], v[12:13] op_sel:[0,1] op_sel_hi:[1,1]
v_cvt_pk_bf16_f32 v80, v80, v81
v_cvt_pk_bf16_f32 v81, v82, v83
v_cvt_pk_bf16_f32 v82, v84, v85
v_cvt_pk_bf16_f32 v83, v86, v87
v_cvt_pk_bf16_f32 v84, v88, v89
v_cvt_pk_bf16_f32 v85, v90, v91
v_cvt_pk_bf16_f32 v86, v92, v93
v_cvt_pk_bf16_f32 v87, v94, v95
buffer_store_dwordx4 v[80:83], v5, s[20:23], s47 offen offset:2048 sc1
buffer_store_dwordx4 v[84:87], v5, s[20:23], s47 offen offset:3072 sc1
s_branch PC_DONE
PC_MASK_BF:
s_lshl_b32 s63, s6, 1
s_sub_u32 s63, s63, s40
s_lshl_b32 s63, s63, 5
v_cvt_f32_i32 v4, s63
v_add_f32 v4, v4, v0
v_mov_b32 v6, v4
v_mul_f32 v6, 0x71800000, v6
v_mov_b32 v7, v6
v_min_f32 v64, v64, v7
v_add_f32 v7, 0xf1800000, v6
v_min_f32 v65, v65, v7
v_add_f32 v7, 0xf2000000, v6
v_min_f32 v66, v66, v7
v_add_f32 v7, 0xf2400000, v6
v_min_f32 v67, v67, v7
v_add_f32 v7, 0xf3000000, v6
v_min_f32 v68, v68, v7
v_add_f32 v7, 0xf3100000, v6
v_min_f32 v69, v69, v7
v_add_f32 v7, 0xf3200000, v6
v_min_f32 v70, v70, v7
v_add_f32 v7, 0xf3300000, v6
v_min_f32 v71, v71, v7
v_add_f32 v7, 0xf3800000, v6
v_min_f32 v72, v72, v7
v_add_f32 v7, 0xf3880000, v6
v_min_f32 v73, v73, v7
v_add_f32 v7, 0xf3900000, v6
v_min_f32 v74, v74, v7
v_add_f32 v7, 0xf3980000, v6
v_min_f32 v75, v75, v7
v_add_f32 v7, 0xf3c00000, v6
v_min_f32 v76, v76, v7
v_add_f32 v7, 0xf3c80000, v6
v_min_f32 v77, v77, v7
v_add_f32 v7, 0xf3d00000, v6
v_min_f32 v78, v78, v7
v_add_f32 v7, 0xf3d80000, v6
v_min_f32 v79, v79, v7
v_add_f32 v6, 0x42000000, v4
v_mul_f32 v6, 0x71800000, v6
v_mov_b32 v7, v6
v_min_f32 v80, v80, v7
v_add_f32 v7, 0xf1800000, v6
v_min_f32 v81, v81, v7
v_add_f32 v7, 0xf2000000, v6
v_min_f32 v82, v82, v7
v_add_f32 v7, 0xf2400000, v6
v_min_f32 v83, v83, v7
v_add_f32 v7, 0xf3000000, v6
v_min_f32 v84, v84, v7
v_add_f32 v7, 0xf3100000, v6
v_min_f32 v85, v85, v7
v_add_f32 v7, 0xf3200000, v6
v_min_f32 v86, v86, v7
v_add_f32 v7, 0xf3300000, v6
v_min_f32 v87, v87, v7
v_add_f32 v7, 0xf3800000, v6
v_min_f32 v88, v88, v7
v_add_f32 v7, 0xf3880000, v6
v_min_f32 v89, v89, v7
v_add_f32 v7, 0xf3900000, v6
v_min_f32 v90, v90, v7
v_add_f32 v7, 0xf3980000, v6
v_min_f32 v91, v91, v7
v_add_f32 v7, 0xf3c00000, v6
v_min_f32 v92, v92, v7
v_add_f32 v7, 0xf3c80000, v6
v_min_f32 v93, v93, v7
v_add_f32 v7, 0xf3d00000, v6
v_min_f32 v94, v94, v7
v_add_f32 v7, 0xf3d80000, v6
v_min_f32 v95, v95, v7
s_branch PC_MASKRET_BF
PC_RARE_BF:
v_mov_b32 v4, v16
s_nop 1
v_permlane32_swap_b32 v16, v4
v_max_f32 v16, v16, v4
v_max_f32 v16, v16, v18
v_sub_f32 v6, v18, v16
v_mul_f32 v6, s68, v6
v_exp_f32 v14, v6
v_mov_b32 v18, v16
v_mul_f32 v8, s68, v18
v_add_f32 v10, s69, v18
v_mul_f32 v12, v12, v14
v_mov_b32 v4, v17
s_nop 1
v_permlane32_swap_b32 v17, v4
v_max_f32 v17, v17, v4
v_max_f32 v17, v17, v19
v_sub_f32 v6, v19, v17
v_mul_f32 v6, s68, v6
v_exp_f32 v15, v6
v_mov_b32 v19, v17
v_mul_f32 v9, s68, v19
v_add_f32 v11, s69, v19
v_mul_f32 v13, v13, v15
s_mov_b32 s42, 1
s_branch PC_RARERET_BF
PC_PEND_BF:
s_nop 7
s_nop 7
v_mul_f32 v128, v128, v14
v_mul_f32 v129, v129, v14
v_mul_f32 v130, v130, v14
v_mul_f32 v131, v131, v14
v_mul_f32 v132, v132, v14
v_mul_f32 v133, v133, v14
v_mul_f32 v134, v134, v14
v_mul_f32 v135, v135, v14
v_mul_f32 v136, v136, v14
v_mul_f32 v137, v137, v14
v_mul_f32 v138, v138, v14
v_mul_f32 v139, v139, v14
v_mul_f32 v140, v140, v14
v_mul_f32 v141, v141, v14
v_mul_f32 v142, v142, v14
v_mul_f32 v143, v143, v14
v_mul_f32 v144, v144, v15
v_mul_f32 v145, v145, v15
v_mul_f32 v146, v146, v15
v_mul_f32 v147, v147, v15
v_mul_f32 v148, v148, v15
v_mul_f32 v149, v149, v15
v_mul_f32 v150, v150, v15
v_mul_f32 v151, v151, v15
v_mul_f32 v152, v152, v15
v_mul_f32 v153, v153, v15
v_mul_f32 v154, v154, v15
v_mul_f32 v155, v155, v15
v_mul_f32 v156, v156, v15
v_mul_f32 v157, v157, v15
v_mul_f32 v158, v158, v15
v_mul_f32 v159, v159, v15
v_mul_f32 v160, v160, v14
v_mul_f32 v161, v161, v14
v_mul_f32 v162, v162, v14
v_mul_f32 v163, v163, v14
v_mul_f32 v164, v164, v14
v_mul_f32 v165, v165, v14
v_mul_f32 v166, v166, v14
v_mul_f32 v167, v167, v14
v_mul_f32 v168, v168, v14
v_mul_f32 v169, v169, v14
v_mul_f32 v170, v170, v14
v_mul_f32 v171, v171, v14
v_mul_f32 v172, v172, v14
v_mul_f32 v173, v173, v14
v_mul_f32 v174, v174, v14
v_mul_f32 v175, v175, v14
v_mul_f32 v176, v176, v15
v_mul_f32 v177, v177, v15
v_mul_f32 v178, v178, v15
v_mul_f32 v179, v179, v15
v_mul_f32 v180, v180, v15
v_mul_f32 v181, v181, v15
v_mul_f32 v182, v182, v15
v_mul_f32 v183, v183, v15
v_mul_f32 v184, v184, v15
v_mul_f32 v185, v185, v15
v_mul_f32 v186, v186, v15
v_mul_f32 v187, v187, v15
v_mul_f32 v188, v188, v15
v_mul_f32 v189, v189, v15
v_mul_f32 v190, v190, v15
v_mul_f32 v191, v191, v15
v_mul_f32 v192, v192, v14
v_mul_f32 v193, v193, v14
v_mul_f32 v194, v194, v14
v_mul_f32 v195, v195, v14
v_mul_f32 v196, v196, v14
v_mul_f32 v197, v197, v14
v_mul_f32 v198, v198, v14
v_mul_f32 v199, v199, v14
v_mul_f32 v200, v200, v14
v_mul_f32 v201, v201, v14
v_mul_f32 v202, v202, v14
v_mul_f32 v203, v203, v14
v_mul_f32 v204, v204, v14
v_mul_f32 v205, v205, v14
v_mul_f32 v206, v206, v14
v_mul_f32 v207, v207, v14
v_mul_f32 v208, v208, v15
v_mul_f32 v209, v209, v15
v_mul_f32 v210, v210, v15
v_mul_f32 v211, v211, v15
v_mul_f32 v212, v212, v15
v_mul_f32 v213, v213, v15
v_mul_f32 v214, v214, v15
v_mul_f32 v215, v215, v15
v_mul_f32 v216, v216, v15
v_mul_f32 v217, v217, v15
v_mul_f32 v218, v218, v15
v_mul_f32 v219, v219, v15
v_mul_f32 v220, v220, v15
v_mul_f32 v221, v221, v15
v_mul_f32 v222, v222, v15
v_mul_f32 v223, v223, v15
v_mul_f32 v224, v224, v14
v_mul_f32 v225, v225, v14
v_mul_f32 v226, v226, v14
v_mul_f32 v227, v227, v14
v_mul_f32 v228, v228, v14
v_mul_f32 v229, v229, v14
v_mul_f32 v230, v230, v14
v_mul_f32 v231, v231, v14
v_mul_f32 v232, v232, v14
v_mul_f32 v233, v233, v14
v_mul_f32 v234, v234, v14
v_mul_f32 v235, v235, v14
v_mul_f32 v236, v236, v14
v_mul_f32 v237, v237, v14
v_mul_f32 v238, v238, v14
v_mul_f32 v239, v239, v14
v_mul_f32 v240, v240, v15
v_mul_f32 v241, v241, v15
v_mul_f32 v242, v242, v15
v_mul_f32 v243, v243, v15
v_mul_f32 v244, v244, v15
v_mul_f32 v245, v245, v15
v_mul_f32 v246, v246, v15
v_mul_f32 v247, v247, v15
v_mul_f32 v248, v248, v15
v_mul_f32 v249, v249, v15
v_mul_f32 v250, v250, v15
v_mul_f32 v251, v251, v15
v_mul_f32 v252, v252, v15
v_mul_f32 v253, v253, v15
v_mul_f32 v254, v254, v15
v_mul_f32 v255, v255, v15
v_mul_f32 v96, v96, v14
v_mul_f32 v97, v97, v14
v_mul_f32 v98, v98, v14
v_mul_f32 v99, v99, v14
v_mul_f32 v100, v100, v14
v_mul_f32 v101, v101, v14
v_mul_f32 v102, v102, v14
v_mul_f32 v103, v103, v14
v_mul_f32 v104, v104, v14
v_mul_f32 v105, v105, v14
v_mul_f32 v106, v106, v14
v_mul_f32 v107, v107, v14
v_mul_f32 v108, v108, v14
v_mul_f32 v109, v109, v14
v_mul_f32 v110, v110, v14
v_mul_f32 v111, v111, v14
v_mul_f32 v112, v112, v15
v_mul_f32 v113, v113, v15
v_mul_f32 v114, v114, v15
v_mul_f32 v115, v115, v15
v_mul_f32 v116, v116, v15
v_mul_f32 v117, v117, v15
v_mul_f32 v118, v118, v15
v_mul_f32 v119, v119, v15
v_mul_f32 v120, v120, v15
v_mul_f32 v121, v121, v15
v_mul_f32 v122, v122, v15
v_mul_f32 v123, v123, v15
v_mul_f32 v124, v124, v15
v_mul_f32 v125, v125, v15
v_mul_f32 v126, v126, v15
v_mul_f32 v127, v127, v15
v_accvgpr_read_b32 v4, a160
v_mul_f32 v4, v4, v14
v_accvgpr_write_b32 a160, v4
v_accvgpr_read_b32 v4, a161
v_mul_f32 v4, v4, v14
v_accvgpr_write_b32 a161, v4
v_accvgpr_read_b32 v4, a162
v_mul_f32 v4, v4, v14
v_accvgpr_write_b32 a162, v4
v_accvgpr_read_b32 v4, a163
v_mul_f32 v4, v4, v14
v_accvgpr_write_b32 a163, v4
v_accvgpr_read_b32 v4, a164
v_mul_f32 v4, v4, v14
v_accvgpr_write_b32 a164, v4
v_accvgpr_read_b32 v4, a165
v_mul_f32 v4, v4, v14
v_accvgpr_write_b32 a165, v4
v_accvgpr_read_b32 v4, a166
v_mul_f32 v4, v4, v14
v_accvgpr_write_b32 a166, v4
v_accvgpr_read_b32 v4, a167
v_mul_f32 v4, v4, v14
v_accvgpr_write_b32 a167, v4
v_accvgpr_read_b32 v4, a168
v_mul_f32 v4, v4, v14
v_accvgpr_write_b32 a168, v4
v_accvgpr_read_b32 v4, a169
v_mul_f32 v4, v4, v14
v_accvgpr_write_b32 a169, v4
v_accvgpr_read_b32 v4, a170
v_mul_f32 v4, v4, v14
v_accvgpr_write_b32 a170, v4
v_accvgpr_read_b32 v4, a171
v_mul_f32 v4, v4, v14
v_accvgpr_write_b32 a171, v4
v_accvgpr_read_b32 v4, a172
v_mul_f32 v4, v4, v14
v_accvgpr_write_b32 a172, v4
v_accvgpr_read_b32 v4, a173
v_mul_f32 v4, v4, v14
v_accvgpr_write_b32 a173, v4
v_accvgpr_read_b32 v4, a174
v_mul_f32 v4, v4, v14
v_accvgpr_write_b32 a174, v4
v_accvgpr_read_b32 v4, a175
v_mul_f32 v4, v4, v14
v_accvgpr_write_b32 a175, v4
v_accvgpr_read_b32 v4, a176
v_mul_f32 v4, v4, v15
v_accvgpr_write_b32 a176, v4
v_accvgpr_read_b32 v4, a177
v_mul_f32 v4, v4, v15
v_accvgpr_write_b32 a177, v4
v_accvgpr_read_b32 v4, a178
v_mul_f32 v4, v4, v15
v_accvgpr_write_b32 a178, v4
v_accvgpr_read_b32 v4, a179
v_mul_f32 v4, v4, v15
v_accvgpr_write_b32 a179, v4
v_accvgpr_read_b32 v4, a180
v_mul_f32 v4, v4, v15
v_accvgpr_write_b32 a180, v4
v_accvgpr_read_b32 v4, a181
v_mul_f32 v4, v4, v15
v_accvgpr_write_b32 a181, v4
v_accvgpr_read_b32 v4, a182
v_mul_f32 v4, v4, v15
v_accvgpr_write_b32 a182, v4
v_accvgpr_read_b32 v4, a183
v_mul_f32 v4, v4, v15
v_accvgpr_write_b32 a183, v4
v_accvgpr_read_b32 v4, a184
v_mul_f32 v4, v4, v15
v_accvgpr_write_b32 a184, v4
v_accvgpr_read_b32 v4, a185
v_mul_f32 v4, v4, v15
v_accvgpr_write_b32 a185, v4
v_accvgpr_read_b32 v4, a186
v_mul_f32 v4, v4, v15
v_accvgpr_write_b32 a186, v4
v_accvgpr_read_b32 v4, a187
v_mul_f32 v4, v4, v15
v_accvgpr_write_b32 a187, v4
v_accvgpr_read_b32 v4, a188
v_mul_f32 v4, v4, v15
v_accvgpr_write_b32 a188, v4
v_accvgpr_read_b32 v4, a189
v_mul_f32 v4, v4, v15
v_accvgpr_write_b32 a189, v4
v_accvgpr_read_b32 v4, a190
v_mul_f32 v4, v4, v15
v_accvgpr_write_b32 a190, v4
v_accvgpr_read_b32 v4, a191
v_mul_f32 v4, v4, v15
v_accvgpr_write_b32 a191, v4
v_accvgpr_read_b32 v4, a192
v_mul_f32 v4, v4, v14
v_accvgpr_write_b32 a192, v4
v_accvgpr_read_b32 v4, a193
v_mul_f32 v4, v4, v14
v_accvgpr_write_b32 a193, v4
v_accvgpr_read_b32 v4, a194
v_mul_f32 v4, v4, v14
v_accvgpr_write_b32 a194, v4
v_accvgpr_read_b32 v4, a195
v_mul_f32 v4, v4, v14
v_accvgpr_write_b32 a195, v4
v_accvgpr_read_b32 v4, a196
v_mul_f32 v4, v4, v14
v_accvgpr_write_b32 a196, v4
v_accvgpr_read_b32 v4, a197
v_mul_f32 v4, v4, v14
v_accvgpr_write_b32 a197, v4
v_accvgpr_read_b32 v4, a198
v_mul_f32 v4, v4, v14
v_accvgpr_write_b32 a198, v4
v_accvgpr_read_b32 v4, a199
v_mul_f32 v4, v4, v14
v_accvgpr_write_b32 a199, v4
v_accvgpr_read_b32 v4, a200
v_mul_f32 v4, v4, v14
v_accvgpr_write_b32 a200, v4
v_accvgpr_read_b32 v4, a201
v_mul_f32 v4, v4, v14
v_accvgpr_write_b32 a201, v4
v_accvgpr_read_b32 v4, a202
v_mul_f32 v4, v4, v14
v_accvgpr_write_b32 a202, v4
v_accvgpr_read_b32 v4, a203
v_mul_f32 v4, v4, v14
v_accvgpr_write_b32 a203, v4
v_accvgpr_read_b32 v4, a204
v_mul_f32 v4, v4, v14
v_accvgpr_write_b32 a204, v4
v_accvgpr_read_b32 v4, a205
v_mul_f32 v4, v4, v14
v_accvgpr_write_b32 a205, v4
v_accvgpr_read_b32 v4, a206
v_mul_f32 v4, v4, v14
v_accvgpr_write_b32 a206, v4
v_accvgpr_read_b32 v4, a207
v_mul_f32 v4, v4, v14
v_accvgpr_write_b32 a207, v4
v_accvgpr_read_b32 v4, a208
v_mul_f32 v4, v4, v15
v_accvgpr_write_b32 a208, v4
v_accvgpr_read_b32 v4, a209
v_mul_f32 v4, v4, v15
v_accvgpr_write_b32 a209, v4
v_accvgpr_read_b32 v4, a210
v_mul_f32 v4, v4, v15
v_accvgpr_write_b32 a210, v4
v_accvgpr_read_b32 v4, a211
v_mul_f32 v4, v4, v15
v_accvgpr_write_b32 a211, v4
v_accvgpr_read_b32 v4, a212
v_mul_f32 v4, v4, v15
v_accvgpr_write_b32 a212, v4
v_accvgpr_read_b32 v4, a213
v_mul_f32 v4, v4, v15
v_accvgpr_write_b32 a213, v4
v_accvgpr_read_b32 v4, a214
v_mul_f32 v4, v4, v15
v_accvgpr_write_b32 a214, v4
v_accvgpr_read_b32 v4, a215
v_mul_f32 v4, v4, v15
v_accvgpr_write_b32 a215, v4
v_accvgpr_read_b32 v4, a216
v_mul_f32 v4, v4, v15
v_accvgpr_write_b32 a216, v4
v_accvgpr_read_b32 v4, a217
v_mul_f32 v4, v4, v15
v_accvgpr_write_b32 a217, v4
v_accvgpr_read_b32 v4, a218
v_mul_f32 v4, v4, v15
v_accvgpr_write_b32 a218, v4
v_accvgpr_read_b32 v4, a219
v_mul_f32 v4, v4, v15
v_accvgpr_write_b32 a219, v4
v_accvgpr_read_b32 v4, a220
v_mul_f32 v4, v4, v15
v_accvgpr_write_b32 a220, v4
v_accvgpr_read_b32 v4, a221
v_mul_f32 v4, v4, v15
v_accvgpr_write_b32 a221, v4
v_accvgpr_read_b32 v4, a222
v_mul_f32 v4, v4, v15
v_accvgpr_write_b32 a222, v4
v_accvgpr_read_b32 v4, a223
v_mul_f32 v4, v4, v15
v_accvgpr_write_b32 a223, v4
v_accvgpr_read_b32 v4, a224
v_mul_f32 v4, v4, v14
v_accvgpr_write_b32 a224, v4
v_accvgpr_read_b32 v4, a225
v_mul_f32 v4, v4, v14
v_accvgpr_write_b32 a225, v4
v_accvgpr_read_b32 v4, a226
v_mul_f32 v4, v4, v14
v_accvgpr_write_b32 a226, v4
v_accvgpr_read_b32 v4, a227
v_mul_f32 v4, v4, v14
v_accvgpr_write_b32 a227, v4
v_accvgpr_read_b32 v4, a228
v_mul_f32 v4, v4, v14
v_accvgpr_write_b32 a228, v4
v_accvgpr_read_b32 v4, a229
v_mul_f32 v4, v4, v14
v_accvgpr_write_b32 a229, v4
v_accvgpr_read_b32 v4, a230
v_mul_f32 v4, v4, v14
v_accvgpr_write_b32 a230, v4
v_accvgpr_read_b32 v4, a231
v_mul_f32 v4, v4, v14
v_accvgpr_write_b32 a231, v4
v_accvgpr_read_b32 v4, a232
v_mul_f32 v4, v4, v14
v_accvgpr_write_b32 a232, v4
v_accvgpr_read_b32 v4, a233
v_mul_f32 v4, v4, v14
v_accvgpr_write_b32 a233, v4
v_accvgpr_read_b32 v4, a234
v_mul_f32 v4, v4, v14
v_accvgpr_write_b32 a234, v4
v_accvgpr_read_b32 v4, a235
v_mul_f32 v4, v4, v14
v_accvgpr_write_b32 a235, v4
v_accvgpr_read_b32 v4, a236
v_mul_f32 v4, v4, v14
v_accvgpr_write_b32 a236, v4
v_accvgpr_read_b32 v4, a237
v_mul_f32 v4, v4, v14
v_accvgpr_write_b32 a237, v4
v_accvgpr_read_b32 v4, a238
v_mul_f32 v4, v4, v14
v_accvgpr_write_b32 a238, v4
v_accvgpr_read_b32 v4, a239
v_mul_f32 v4, v4, v14
v_accvgpr_write_b32 a239, v4
v_accvgpr_read_b32 v4, a240
v_mul_f32 v4, v4, v15
v_accvgpr_write_b32 a240, v4
v_accvgpr_read_b32 v4, a241
v_mul_f32 v4, v4, v15
v_accvgpr_write_b32 a241, v4
v_accvgpr_read_b32 v4, a242
v_mul_f32 v4, v4, v15
v_accvgpr_write_b32 a242, v4
v_accvgpr_read_b32 v4, a243
v_mul_f32 v4, v4, v15
v_accvgpr_write_b32 a243, v4
v_accvgpr_read_b32 v4, a244
v_mul_f32 v4, v4, v15
v_accvgpr_write_b32 a244, v4
v_accvgpr_read_b32 v4, a245
v_mul_f32 v4, v4, v15
v_accvgpr_write_b32 a245, v4
v_accvgpr_read_b32 v4, a246
v_mul_f32 v4, v4, v15
v_accvgpr_write_b32 a246, v4
v_accvgpr_read_b32 v4, a247
v_mul_f32 v4, v4, v15
v_accvgpr_write_b32 a247, v4
v_accvgpr_read_b32 v4, a248
v_mul_f32 v4, v4, v15
v_accvgpr_write_b32 a248, v4
v_accvgpr_read_b32 v4, a249
v_mul_f32 v4, v4, v15
v_accvgpr_write_b32 a249, v4
v_accvgpr_read_b32 v4, a250
v_mul_f32 v4, v4, v15
v_accvgpr_write_b32 a250, v4
v_accvgpr_read_b32 v4, a251
v_mul_f32 v4, v4, v15
v_accvgpr_write_b32 a251, v4
v_accvgpr_read_b32 v4, a252
v_mul_f32 v4, v4, v15
v_accvgpr_write_b32 a252, v4
v_accvgpr_read_b32 v4, a253
v_mul_f32 v4, v4, v15
v_accvgpr_write_b32 a253, v4
v_accvgpr_read_b32 v4, a254
v_mul_f32 v4, v4, v15
v_accvgpr_write_b32 a254, v4
v_accvgpr_read_b32 v4, a255
v_mul_f32 v4, v4, v15
v_accvgpr_write_b32 a255, v4
s_nop 1
s_mov_b32 s42, 0
s_branch PC_PENDRET_BF
PC_MASK_B0:
s_lshl_b32 s63, s6, 1
s_sub_u32 s63, s63, s40
s_lshl_b32 s63, s63, 5
v_cvt_f32_i32 v4, s63
v_add_f32 v4, v4, v0
v_mov_b32 v6, v4
v_mul_f32 v6, 0x71800000, v6
v_mov_b32 v7, v6
v_min_f32 v64, v64, v7
v_add_f32 v7, 0xf1800000, v6
v_min_f32 v65, v65, v7
v_add_f32 v7, 0xf2000000, v6
v_min_f32 v66, v66, v7
v_add_f32 v7, 0xf2400000, v6
v_min_f32 v67, v67, v7
v_add_f32 v7, 0xf3000000, v6
v_min_f32 v68, v68, v7
v_add_f32 v7, 0xf3100000, v6
v_min_f32 v69, v69, v7
v_add_f32 v7, 0xf3200000, v6
v_min_f32 v70, v70, v7
v_add_f32 v7, 0xf3300000, v6
v_min_f32 v71, v71, v7
v_add_f32 v7, 0xf3800000, v6
v_min_f32 v72, v72, v7
v_add_f32 v7, 0xf3880000, v6
v_min_f32 v73, v73, v7
v_add_f32 v7, 0xf3900000, v6
v_min_f32 v74, v74, v7
v_add_f32 v7, 0xf3980000, v6
v_min_f32 v75, v75, v7
v_add_f32 v7, 0xf3c00000, v6
v_min_f32 v76, v76, v7
v_add_f32 v7, 0xf3c80000, v6
v_min_f32 v77, v77, v7
v_add_f32 v7, 0xf3d00000, v6
v_min_f32 v78, v78, v7
v_add_f32 v7, 0xf3d80000, v6
v_min_f32 v79, v79, v7
v_add_f32 v6, 0x42000000, v4
v_mul_f32 v6, 0x71800000, v6
v_mov_b32 v7, v6
v_min_f32 v80, v80, v7
v_add_f32 v7, 0xf1800000, v6
v_min_f32 v81, v81, v7
v_add_f32 v7, 0xf2000000, v6
v_min_f32 v82, v82, v7
v_add_f32 v7, 0xf2400000, v6
v_min_f32 v83, v83, v7
v_add_f32 v7, 0xf3000000, v6
v_min_f32 v84, v84, v7
v_add_f32 v7, 0xf3100000, v6
v_min_f32 v85, v85, v7
v_add_f32 v7, 0xf3200000, v6
v_min_f32 v86, v86, v7
v_add_f32 v7, 0xf3300000, v6
v_min_f32 v87, v87, v7
v_add_f32 v7, 0xf3800000, v6
v_min_f32 v88, v88, v7
v_add_f32 v7, 0xf3880000, v6
v_min_f32 v89, v89, v7
v_add_f32 v7, 0xf3900000, v6
v_min_f32 v90, v90, v7
v_add_f32 v7, 0xf3980000, v6
v_min_f32 v91, v91, v7
v_add_f32 v7, 0xf3c00000, v6
v_min_f32 v92, v92, v7
v_add_f32 v7, 0xf3c80000, v6
v_min_f32 v93, v93, v7
v_add_f32 v7, 0xf3d00000, v6
v_min_f32 v94, v94, v7
v_add_f32 v7, 0xf3d80000, v6
v_min_f32 v95, v95, v7
s_branch PC_MASKRET_B0
PC_RARE_B0:
v_mov_b32 v4, v16
s_nop 1
v_permlane32_swap_b32 v16, v4
v_max_f32 v16, v16, v4
v_max_f32 v16, v16, v18
v_sub_f32 v6, v18, v16
v_mul_f32 v6, s68, v6
v_exp_f32 v14, v6
v_mov_b32 v18, v16
v_mul_f32 v8, s68, v18
v_add_f32 v10, s69, v18
v_mul_f32 v12, v12, v14
v_mov_b32 v4, v17
s_nop 1
v_permlane32_swap_b32 v17, v4
v_max_f32 v17, v17, v4
v_max_f32 v17, v17, v19
v_sub_f32 v6, v19, v17
v_mul_f32 v6, s68, v6
v_exp_f32 v15, v6
v_mov_b32 v19, v17
v_mul_f32 v9, s68, v19
v_add_f32 v11, s69, v19
v_mul_f32 v13, v13, v15
s_mov_b32 s42, 1
s_branch PC_RARERET_B0
PC_PEND_B0:
s_nop 7
s_nop 7
v_mul_f32 v128, v128, v14
v_mul_f32 v129, v129, v14
v_mul_f32 v130, v130, v14
v_mul_f32 v131, v131, v14
v_mul_f32 v132, v132, v14
v_mul_f32 v133, v133, v14
v_mul_f32 v134, v134, v14
v_mul_f32 v135, v135, v14
v_mul_f32 v136, v136, v14
v_mul_f32 v137, v137, v14
v_mul_f32 v138, v138, v14
v_mul_f32 v139, v139, v14
v_mul_f32 v140, v140, v14
v_mul_f32 v141, v141, v14
v_mul_f32 v142, v142, v14
v_mul_f32 v143, v143, v14
v_mul_f32 v144, v144, v15
v_mul_f32 v145, v145, v15
v_mul_f32 v146, v146, v15
v_mul_f32 v147, v147, v15
v_mul_f32 v148, v148, v15
v_mul_f32 v149, v149, v15
v_mul_f32 v150, v150, v15
v_mul_f32 v151, v151, v15
v_mul_f32 v152, v152, v15
v_mul_f32 v153, v153, v15
v_mul_f32 v154, v154, v15
v_mul_f32 v155, v155, v15
v_mul_f32 v156, v156, v15
v_mul_f32 v157, v157, v15
v_mul_f32 v158, v158, v15
v_mul_f32 v159, v159, v15
v_mul_f32 v160, v160, v14
v_mul_f32 v161, v161, v14
v_mul_f32 v162, v162, v14
v_mul_f32 v163, v163, v14
v_mul_f32 v164, v164, v14
v_mul_f32 v165, v165, v14
v_mul_f32 v166, v166, v14
v_mul_f32 v167, v167, v14
v_mul_f32 v168, v168, v14
v_mul_f32 v169, v169, v14
v_mul_f32 v170, v170, v14
v_mul_f32 v171, v171, v14
v_mul_f32 v172, v172, v14
v_mul_f32 v173, v173, v14
v_mul_f32 v174, v174, v14
v_mul_f32 v175, v175, v14
v_mul_f32 v176, v176, v15
v_mul_f32 v177, v177, v15
v_mul_f32 v178, v178, v15
v_mul_f32 v179, v179, v15
v_mul_f32 v180, v180, v15
v_mul_f32 v181, v181, v15
v_mul_f32 v182, v182, v15
v_mul_f32 v183, v183, v15
v_mul_f32 v184, v184, v15
v_mul_f32 v185, v185, v15
v_mul_f32 v186, v186, v15
v_mul_f32 v187, v187, v15
v_mul_f32 v188, v188, v15
v_mul_f32 v189, v189, v15
v_mul_f32 v190, v190, v15
v_mul_f32 v191, v191, v15
v_mul_f32 v192, v192, v14
v_mul_f32 v193, v193, v14
v_mul_f32 v194, v194, v14
v_mul_f32 v195, v195, v14
v_mul_f32 v196, v196, v14
v_mul_f32 v197, v197, v14
v_mul_f32 v198, v198, v14
v_mul_f32 v199, v199, v14
v_mul_f32 v200, v200, v14
v_mul_f32 v201, v201, v14
v_mul_f32 v202, v202, v14
v_mul_f32 v203, v203, v14
v_mul_f32 v204, v204, v14
v_mul_f32 v205, v205, v14
v_mul_f32 v206, v206, v14
v_mul_f32 v207, v207, v14
v_mul_f32 v208, v208, v15
v_mul_f32 v209, v209, v15
v_mul_f32 v210, v210, v15
v_mul_f32 v211, v211, v15
v_mul_f32 v212, v212, v15
v_mul_f32 v213, v213, v15
v_mul_f32 v214, v214, v15
v_mul_f32 v215, v215, v15
v_mul_f32 v216, v216, v15
v_mul_f32 v217, v217, v15
v_mul_f32 v218, v218, v15
v_mul_f32 v219, v219, v15
v_mul_f32 v220, v220, v15
v_mul_f32 v221, v221, v15
v_mul_f32 v222, v222, v15
v_mul_f32 v223, v223, v15
v_mul_f32 v224, v224, v14
v_mul_f32 v225, v225, v14
v_mul_f32 v226, v226, v14
v_mul_f32 v227, v227, v14
v_mul_f32 v228, v228, v14
v_mul_f32 v229, v229, v14
v_mul_f32 v230, v230, v14
v_mul_f32 v231, v231, v14
v_mul_f32 v232, v232, v14
v_mul_f32 v233, v233, v14
v_mul_f32 v234, v234, v14
v_mul_f32 v235, v235, v14
v_mul_f32 v236, v236, v14
v_mul_f32 v237, v237, v14
v_mul_f32 v238, v238, v14
v_mul_f32 v239, v239, v14
v_mul_f32 v240, v240, v15
v_mul_f32 v241, v241, v15
v_mul_f32 v242, v242, v15
v_mul_f32 v243, v243, v15
v_mul_f32 v244, v244, v15
v_mul_f32 v245, v245, v15
v_mul_f32 v246, v246, v15
v_mul_f32 v247, v247, v15
v_mul_f32 v248, v248, v15
v_mul_f32 v249, v249, v15
v_mul_f32 v250, v250, v15
v_mul_f32 v251, v251, v15
v_mul_f32 v252, v252, v15
v_mul_f32 v253, v253, v15
v_mul_f32 v254, v254, v15
v_mul_f32 v255, v255, v15
v_mul_f32 v96, v96, v14
v_mul_f32 v97, v97, v14
v_mul_f32 v98, v98, v14
v_mul_f32 v99, v99, v14
v_mul_f32 v100, v100, v14
v_mul_f32 v101, v101, v14
v_mul_f32 v102, v102, v14
v_mul_f32 v103, v103, v14
v_mul_f32 v104, v104, v14
v_mul_f32 v105, v105, v14
v_mul_f32 v106, v106, v14
v_mul_f32 v107, v107, v14
v_mul_f32 v108, v108, v14
v_mul_f32 v109, v109, v14
v_mul_f32 v110, v110, v14
v_mul_f32 v111, v111, v14
v_mul_f32 v112, v112, v15
v_mul_f32 v113, v113, v15
v_mul_f32 v114, v114, v15
v_mul_f32 v115, v115, v15
v_mul_f32 v116, v116, v15
v_mul_f32 v117, v117, v15
v_mul_f32 v118, v118, v15
v_mul_f32 v119, v119, v15
v_mul_f32 v120, v120, v15
v_mul_f32 v121, v121, v15
v_mul_f32 v122, v122, v15
v_mul_f32 v123, v123, v15
v_mul_f32 v124, v124, v15
v_mul_f32 v125, v125, v15
v_mul_f32 v126, v126, v15
v_mul_f32 v127, v127, v15
v_accvgpr_read_b32 v4, a160
v_mul_f32 v4, v4, v14
v_accvgpr_write_b32 a160, v4
v_accvgpr_read_b32 v4, a161
v_mul_f32 v4, v4, v14
v_accvgpr_write_b32 a161, v4
v_accvgpr_read_b32 v4, a162
v_mul_f32 v4, v4, v14
v_accvgpr_write_b32 a162, v4
v_accvgpr_read_b32 v4, a163
v_mul_f32 v4, v4, v14
v_accvgpr_write_b32 a163, v4
v_accvgpr_read_b32 v4, a164
v_mul_f32 v4, v4, v14
v_accvgpr_write_b32 a164, v4
v_accvgpr_read_b32 v4, a165
v_mul_f32 v4, v4, v14
v_accvgpr_write_b32 a165, v4
v_accvgpr_read_b32 v4, a166
v_mul_f32 v4, v4, v14
v_accvgpr_write_b32 a166, v4
v_accvgpr_read_b32 v4, a167
v_mul_f32 v4, v4, v14
v_accvgpr_write_b32 a167, v4
v_accvgpr_read_b32 v4, a168
v_mul_f32 v4, v4, v14
v_accvgpr_write_b32 a168, v4
v_accvgpr_read_b32 v4, a169
v_mul_f32 v4, v4, v14
v_accvgpr_write_b32 a169, v4
v_accvgpr_read_b32 v4, a170
v_mul_f32 v4, v4, v14
v_accvgpr_write_b32 a170, v4
v_accvgpr_read_b32 v4, a171
v_mul_f32 v4, v4, v14
v_accvgpr_write_b32 a171, v4
v_accvgpr_read_b32 v4, a172
v_mul_f32 v4, v4, v14
v_accvgpr_write_b32 a172, v4
v_accvgpr_read_b32 v4, a173
v_mul_f32 v4, v4, v14
v_accvgpr_write_b32 a173, v4
v_accvgpr_read_b32 v4, a174
v_mul_f32 v4, v4, v14
v_accvgpr_write_b32 a174, v4
v_accvgpr_read_b32 v4, a175
v_mul_f32 v4, v4, v14
v_accvgpr_write_b32 a175, v4
v_accvgpr_read_b32 v4, a176
v_mul_f32 v4, v4, v15
v_accvgpr_write_b32 a176, v4
v_accvgpr_read_b32 v4, a177
v_mul_f32 v4, v4, v15
v_accvgpr_write_b32 a177, v4
v_accvgpr_read_b32 v4, a178
v_mul_f32 v4, v4, v15
v_accvgpr_write_b32 a178, v4
v_accvgpr_read_b32 v4, a179
v_mul_f32 v4, v4, v15
v_accvgpr_write_b32 a179, v4
v_accvgpr_read_b32 v4, a180
v_mul_f32 v4, v4, v15
v_accvgpr_write_b32 a180, v4
v_accvgpr_read_b32 v4, a181
v_mul_f32 v4, v4, v15
v_accvgpr_write_b32 a181, v4
v_accvgpr_read_b32 v4, a182
v_mul_f32 v4, v4, v15
v_accvgpr_write_b32 a182, v4
v_accvgpr_read_b32 v4, a183
v_mul_f32 v4, v4, v15
v_accvgpr_write_b32 a183, v4
v_accvgpr_read_b32 v4, a184
v_mul_f32 v4, v4, v15
v_accvgpr_write_b32 a184, v4
v_accvgpr_read_b32 v4, a185
v_mul_f32 v4, v4, v15
v_accvgpr_write_b32 a185, v4
v_accvgpr_read_b32 v4, a186
v_mul_f32 v4, v4, v15
v_accvgpr_write_b32 a186, v4
v_accvgpr_read_b32 v4, a187
v_mul_f32 v4, v4, v15
v_accvgpr_write_b32 a187, v4
v_accvgpr_read_b32 v4, a188
v_mul_f32 v4, v4, v15
v_accvgpr_write_b32 a188, v4
v_accvgpr_read_b32 v4, a189
v_mul_f32 v4, v4, v15
v_accvgpr_write_b32 a189, v4
v_accvgpr_read_b32 v4, a190
v_mul_f32 v4, v4, v15
v_accvgpr_write_b32 a190, v4
v_accvgpr_read_b32 v4, a191
v_mul_f32 v4, v4, v15
v_accvgpr_write_b32 a191, v4
v_accvgpr_read_b32 v4, a192
v_mul_f32 v4, v4, v14
v_accvgpr_write_b32 a192, v4
v_accvgpr_read_b32 v4, a193
v_mul_f32 v4, v4, v14
v_accvgpr_write_b32 a193, v4
v_accvgpr_read_b32 v4, a194
v_mul_f32 v4, v4, v14
v_accvgpr_write_b32 a194, v4
v_accvgpr_read_b32 v4, a195
v_mul_f32 v4, v4, v14
v_accvgpr_write_b32 a195, v4
v_accvgpr_read_b32 v4, a196
v_mul_f32 v4, v4, v14
v_accvgpr_write_b32 a196, v4
v_accvgpr_read_b32 v4, a197
v_mul_f32 v4, v4, v14
v_accvgpr_write_b32 a197, v4
v_accvgpr_read_b32 v4, a198
v_mul_f32 v4, v4, v14
v_accvgpr_write_b32 a198, v4
v_accvgpr_read_b32 v4, a199
v_mul_f32 v4, v4, v14
v_accvgpr_write_b32 a199, v4
v_accvgpr_read_b32 v4, a200
v_mul_f32 v4, v4, v14
v_accvgpr_write_b32 a200, v4
v_accvgpr_read_b32 v4, a201
v_mul_f32 v4, v4, v14
v_accvgpr_write_b32 a201, v4
v_accvgpr_read_b32 v4, a202
v_mul_f32 v4, v4, v14
v_accvgpr_write_b32 a202, v4
v_accvgpr_read_b32 v4, a203
v_mul_f32 v4, v4, v14
v_accvgpr_write_b32 a203, v4
v_accvgpr_read_b32 v4, a204
v_mul_f32 v4, v4, v14
v_accvgpr_write_b32 a204, v4
v_accvgpr_read_b32 v4, a205
v_mul_f32 v4, v4, v14
v_accvgpr_write_b32 a205, v4
v_accvgpr_read_b32 v4, a206
v_mul_f32 v4, v4, v14
v_accvgpr_write_b32 a206, v4
v_accvgpr_read_b32 v4, a207
v_mul_f32 v4, v4, v14
v_accvgpr_write_b32 a207, v4
v_accvgpr_read_b32 v4, a208
v_mul_f32 v4, v4, v15
v_accvgpr_write_b32 a208, v4
v_accvgpr_read_b32 v4, a209
v_mul_f32 v4, v4, v15
v_accvgpr_write_b32 a209, v4
v_accvgpr_read_b32 v4, a210
v_mul_f32 v4, v4, v15
v_accvgpr_write_b32 a210, v4
v_accvgpr_read_b32 v4, a211
v_mul_f32 v4, v4, v15
v_accvgpr_write_b32 a211, v4
v_accvgpr_read_b32 v4, a212
v_mul_f32 v4, v4, v15
v_accvgpr_write_b32 a212, v4
v_accvgpr_read_b32 v4, a213
v_mul_f32 v4, v4, v15
v_accvgpr_write_b32 a213, v4
v_accvgpr_read_b32 v4, a214
v_mul_f32 v4, v4, v15
v_accvgpr_write_b32 a214, v4
v_accvgpr_read_b32 v4, a215
v_mul_f32 v4, v4, v15
v_accvgpr_write_b32 a215, v4
v_accvgpr_read_b32 v4, a216
v_mul_f32 v4, v4, v15
v_accvgpr_write_b32 a216, v4
v_accvgpr_read_b32 v4, a217
v_mul_f32 v4, v4, v15
v_accvgpr_write_b32 a217, v4
v_accvgpr_read_b32 v4, a218
v_mul_f32 v4, v4, v15
v_accvgpr_write_b32 a218, v4
v_accvgpr_read_b32 v4, a219
v_mul_f32 v4, v4, v15
v_accvgpr_write_b32 a219, v4
v_accvgpr_read_b32 v4, a220
v_mul_f32 v4, v4, v15
v_accvgpr_write_b32 a220, v4
v_accvgpr_read_b32 v4, a221
v_mul_f32 v4, v4, v15
v_accvgpr_write_b32 a221, v4
v_accvgpr_read_b32 v4, a222
v_mul_f32 v4, v4, v15
v_accvgpr_write_b32 a222, v4
v_accvgpr_read_b32 v4, a223
v_mul_f32 v4, v4, v15
v_accvgpr_write_b32 a223, v4
v_accvgpr_read_b32 v4, a224
v_mul_f32 v4, v4, v14
v_accvgpr_write_b32 a224, v4
v_accvgpr_read_b32 v4, a225
v_mul_f32 v4, v4, v14
v_accvgpr_write_b32 a225, v4
v_accvgpr_read_b32 v4, a226
v_mul_f32 v4, v4, v14
v_accvgpr_write_b32 a226, v4
v_accvgpr_read_b32 v4, a227
v_mul_f32 v4, v4, v14
v_accvgpr_write_b32 a227, v4
v_accvgpr_read_b32 v4, a228
v_mul_f32 v4, v4, v14
v_accvgpr_write_b32 a228, v4
v_accvgpr_read_b32 v4, a229
v_mul_f32 v4, v4, v14
v_accvgpr_write_b32 a229, v4
v_accvgpr_read_b32 v4, a230
v_mul_f32 v4, v4, v14
v_accvgpr_write_b32 a230, v4
v_accvgpr_read_b32 v4, a231
v_mul_f32 v4, v4, v14
v_accvgpr_write_b32 a231, v4
v_accvgpr_read_b32 v4, a232
v_mul_f32 v4, v4, v14
v_accvgpr_write_b32 a232, v4
v_accvgpr_read_b32 v4, a233
v_mul_f32 v4, v4, v14
v_accvgpr_write_b32 a233, v4
v_accvgpr_read_b32 v4, a234
v_mul_f32 v4, v4, v14
v_accvgpr_write_b32 a234, v4
v_accvgpr_read_b32 v4, a235
v_mul_f32 v4, v4, v14
v_accvgpr_write_b32 a235, v4
v_accvgpr_read_b32 v4, a236
v_mul_f32 v4, v4, v14
v_accvgpr_write_b32 a236, v4
v_accvgpr_read_b32 v4, a237
v_mul_f32 v4, v4, v14
v_accvgpr_write_b32 a237, v4
v_accvgpr_read_b32 v4, a238
v_mul_f32 v4, v4, v14
v_accvgpr_write_b32 a238, v4
v_accvgpr_read_b32 v4, a239
v_mul_f32 v4, v4, v14
v_accvgpr_write_b32 a239, v4
v_accvgpr_read_b32 v4, a240
v_mul_f32 v4, v4, v15
v_accvgpr_write_b32 a240, v4
v_accvgpr_read_b32 v4, a241
v_mul_f32 v4, v4, v15
v_accvgpr_write_b32 a241, v4
v_accvgpr_read_b32 v4, a242
v_mul_f32 v4, v4, v15
v_accvgpr_write_b32 a242, v4
v_accvgpr_read_b32 v4, a243
v_mul_f32 v4, v4, v15
v_accvgpr_write_b32 a243, v4
v_accvgpr_read_b32 v4, a244
v_mul_f32 v4, v4, v15
v_accvgpr_write_b32 a244, v4
v_accvgpr_read_b32 v4, a245
v_mul_f32 v4, v4, v15
v_accvgpr_write_b32 a245, v4
v_accvgpr_read_b32 v4, a246
v_mul_f32 v4, v4, v15
v_accvgpr_write_b32 a246, v4
v_accvgpr_read_b32 v4, a247
v_mul_f32 v4, v4, v15
v_accvgpr_write_b32 a247, v4
v_accvgpr_read_b32 v4, a248
v_mul_f32 v4, v4, v15
v_accvgpr_write_b32 a248, v4
v_accvgpr_read_b32 v4, a249
v_mul_f32 v4, v4, v15
v_accvgpr_write_b32 a249, v4
v_accvgpr_read_b32 v4, a250
v_mul_f32 v4, v4, v15
v_accvgpr_write_b32 a250, v4
v_accvgpr_read_b32 v4, a251
v_mul_f32 v4, v4, v15
v_accvgpr_write_b32 a251, v4
v_accvgpr_read_b32 v4, a252
v_mul_f32 v4, v4, v15
v_accvgpr_write_b32 a252, v4
v_accvgpr_read_b32 v4, a253
v_mul_f32 v4, v4, v15
v_accvgpr_write_b32 a253, v4
v_accvgpr_read_b32 v4, a254
v_mul_f32 v4, v4, v15
v_accvgpr_write_b32 a254, v4
v_accvgpr_read_b32 v4, a255
v_mul_f32 v4, v4, v15
v_accvgpr_write_b32 a255, v4
s_nop 1
s_mov_b32 s42, 0
s_branch PC_PENDRET_B0
PC_MASK_B1:
s_lshl_b32 s63, s6, 1
s_sub_u32 s63, s63, s40
s_lshl_b32 s63, s63, 5
v_cvt_f32_i32 v4, s63
v_add_f32 v4, v4, v0
v_mov_b32 v6, v4
v_mul_f32 v6, 0x71800000, v6
v_mov_b32 v7, v6
v_min_f32 v32, v32, v7
v_add_f32 v7, 0xf1800000, v6
v_min_f32 v33, v33, v7
v_add_f32 v7, 0xf2000000, v6
v_min_f32 v34, v34, v7
v_add_f32 v7, 0xf2400000, v6
v_min_f32 v35, v35, v7
v_add_f32 v7, 0xf3000000, v6
v_min_f32 v36, v36, v7
v_add_f32 v7, 0xf3100000, v6
v_min_f32 v37, v37, v7
v_add_f32 v7, 0xf3200000, v6
v_min_f32 v38, v38, v7
v_add_f32 v7, 0xf3300000, v6
v_min_f32 v39, v39, v7
v_add_f32 v7, 0xf3800000, v6
v_min_f32 v40, v40, v7
v_add_f32 v7, 0xf3880000, v6
v_min_f32 v41, v41, v7
v_add_f32 v7, 0xf3900000, v6
v_min_f32 v42, v42, v7
v_add_f32 v7, 0xf3980000, v6
v_min_f32 v43, v43, v7
v_add_f32 v7, 0xf3c00000, v6
v_min_f32 v44, v44, v7
v_add_f32 v7, 0xf3c80000, v6
v_min_f32 v45, v45, v7
v_add_f32 v7, 0xf3d00000, v6
v_min_f32 v46, v46, v7
v_add_f32 v7, 0xf3d80000, v6
v_min_f32 v47, v47, v7
v_add_f32 v6, 0x42000000, v4
v_mul_f32 v6, 0x71800000, v6
v_mov_b32 v7, v6
v_min_f32 v48, v48, v7
v_add_f32 v7, 0xf1800000, v6
v_min_f32 v49, v49, v7
v_add_f32 v7, 0xf2000000, v6
v_min_f32 v50, v50, v7
v_add_f32 v7, 0xf2400000, v6
v_min_f32 v51, v51, v7
v_add_f32 v7, 0xf3000000, v6
v_min_f32 v52, v52, v7
v_add_f32 v7, 0xf3100000, v6
v_min_f32 v53, v53, v7
v_add_f32 v7, 0xf3200000, v6
v_min_f32 v54, v54, v7
v_add_f32 v7, 0xf3300000, v6
v_min_f32 v55, v55, v7
v_add_f32 v7, 0xf3800000, v6
v_min_f32 v56, v56, v7
v_add_f32 v7, 0xf3880000, v6
v_min_f32 v57, v57, v7
v_add_f32 v7, 0xf3900000, v6
v_min_f32 v58, v58, v7
v_add_f32 v7, 0xf3980000, v6
v_min_f32 v59, v59, v7
v_add_f32 v7, 0xf3c00000, v6
v_min_f32 v60, v60, v7
v_add_f32 v7, 0xf3c80000, v6
v_min_f32 v61, v61, v7
v_add_f32 v7, 0xf3d00000, v6
v_min_f32 v62, v62, v7
v_add_f32 v7, 0xf3d80000, v6
v_min_f32 v63, v63, v7
s_branch PC_MASKRET_B1
PC_RARE_B1:
v_mov_b32 v4, v16
s_nop 1
v_permlane32_swap_b32 v16, v4
v_max_f32 v16, v16, v4
v_max_f32 v16, v16, v18
v_sub_f32 v6, v18, v16
v_mul_f32 v6, s68, v6
v_exp_f32 v14, v6
v_mov_b32 v18, v16
v_mul_f32 v8, s68, v18
v_add_f32 v10, s69, v18
v_mul_f32 v12, v12, v14
v_mov_b32 v4, v17
s_nop 1
v_permlane32_swap_b32 v17, v4
v_max_f32 v17, v17, v4
v_max_f32 v17, v17, v19
v_sub_f32 v6, v19, v17
v_mul_f32 v6, s68, v6
v_exp_f32 v15, v6
v_mov_b32 v19, v17
v_mul_f32 v9, s68, v19
v_add_f32 v11, s69, v19
v_mul_f32 v13, v13, v15
s_mov_b32 s42, 1
s_branch PC_RARERET_B1
PC_PEND_B1:
s_nop 7
s_nop 7
v_mul_f32 v128, v128, v14
v_mul_f32 v129, v129, v14
v_mul_f32 v130, v130, v14
v_mul_f32 v131, v131, v14
v_mul_f32 v132, v132, v14
v_mul_f32 v133, v133, v14
v_mul_f32 v134, v134, v14
v_mul_f32 v135, v135, v14
v_mul_f32 v136, v136, v14
v_mul_f32 v137, v137, v14
v_mul_f32 v138, v138, v14
v_mul_f32 v139, v139, v14
v_mul_f32 v140, v140, v14
v_mul_f32 v141, v141, v14
v_mul_f32 v142, v142, v14
v_mul_f32 v143, v143, v14
v_mul_f32 v144, v144, v15
v_mul_f32 v145, v145, v15
v_mul_f32 v146, v146, v15
v_mul_f32 v147, v147, v15
v_mul_f32 v148, v148, v15
v_mul_f32 v149, v149, v15
v_mul_f32 v150, v150, v15
v_mul_f32 v151, v151, v15
v_mul_f32 v152, v152, v15
v_mul_f32 v153, v153, v15
v_mul_f32 v154, v154, v15
v_mul_f32 v155, v155, v15
v_mul_f32 v156, v156, v15
v_mul_f32 v157, v157, v15
v_mul_f32 v158, v158, v15
v_mul_f32 v159, v159, v15
v_mul_f32 v160, v160, v14
v_mul_f32 v161, v161, v14
v_mul_f32 v162, v162, v14
v_mul_f32 v163, v163, v14
v_mul_f32 v164, v164, v14
v_mul_f32 v165, v165, v14
v_mul_f32 v166, v166, v14
v_mul_f32 v167, v167, v14
v_mul_f32 v168, v168, v14
v_mul_f32 v169, v169, v14
v_mul_f32 v170, v170, v14
v_mul_f32 v171, v171, v14
v_mul_f32 v172, v172, v14
v_mul_f32 v173, v173, v14
v_mul_f32 v174, v174, v14
v_mul_f32 v175, v175, v14
v_mul_f32 v176, v176, v15
v_mul_f32 v177, v177, v15
v_mul_f32 v178, v178, v15
v_mul_f32 v179, v179, v15
v_mul_f32 v180, v180, v15
v_mul_f32 v181, v181, v15
v_mul_f32 v182, v182, v15
v_mul_f32 v183, v183, v15
v_mul_f32 v184, v184, v15
v_mul_f32 v185, v185, v15
v_mul_f32 v186, v186, v15
v_mul_f32 v187, v187, v15
v_mul_f32 v188, v188, v15
v_mul_f32 v189, v189, v15
v_mul_f32 v190, v190, v15
v_mul_f32 v191, v191, v15
v_mul_f32 v192, v192, v14
v_mul_f32 v193, v193, v14
v_mul_f32 v194, v194, v14
v_mul_f32 v195, v195, v14
v_mul_f32 v196, v196, v14
v_mul_f32 v197, v197, v14
v_mul_f32 v198, v198, v14
v_mul_f32 v199, v199, v14
v_mul_f32 v200, v200, v14
v_mul_f32 v201, v201, v14
v_mul_f32 v202, v202, v14
v_mul_f32 v203, v203, v14
v_mul_f32 v204, v204, v14
v_mul_f32 v205, v205, v14
v_mul_f32 v206, v206, v14
v_mul_f32 v207, v207, v14
v_mul_f32 v208, v208, v15
v_mul_f32 v209, v209, v15
v_mul_f32 v210, v210, v15
v_mul_f32 v211, v211, v15
v_mul_f32 v212, v212, v15
v_mul_f32 v213, v213, v15
v_mul_f32 v214, v214, v15
v_mul_f32 v215, v215, v15
v_mul_f32 v216, v216, v15
v_mul_f32 v217, v217, v15
v_mul_f32 v218, v218, v15
v_mul_f32 v219, v219, v15
v_mul_f32 v220, v220, v15
v_mul_f32 v221, v221, v15
v_mul_f32 v222, v222, v15
v_mul_f32 v223, v223, v15
v_mul_f32 v224, v224, v14
v_mul_f32 v225, v225, v14
v_mul_f32 v226, v226, v14
v_mul_f32 v227, v227, v14
v_mul_f32 v228, v228, v14
v_mul_f32 v229, v229, v14
v_mul_f32 v230, v230, v14
v_mul_f32 v231, v231, v14
v_mul_f32 v232, v232, v14
v_mul_f32 v233, v233, v14
v_mul_f32 v234, v234, v14
v_mul_f32 v235, v235, v14
v_mul_f32 v236, v236, v14
v_mul_f32 v237, v237, v14
v_mul_f32 v238, v238, v14
v_mul_f32 v239, v239, v14
v_mul_f32 v240, v240, v15
v_mul_f32 v241, v241, v15
v_mul_f32 v242, v242, v15
v_mul_f32 v243, v243, v15
v_mul_f32 v244, v244, v15
v_mul_f32 v245, v245, v15
v_mul_f32 v246, v246, v15
v_mul_f32 v247, v247, v15
v_mul_f32 v248, v248, v15
v_mul_f32 v249, v249, v15
v_mul_f32 v250, v250, v15
v_mul_f32 v251, v251, v15
v_mul_f32 v252, v252, v15
v_mul_f32 v253, v253, v15
v_mul_f32 v254, v254, v15
v_mul_f32 v255, v255, v15
v_mul_f32 v96, v96, v14
v_mul_f32 v97, v97, v14
v_mul_f32 v98, v98, v14
v_mul_f32 v99, v99, v14
v_mul_f32 v100, v100, v14
v_mul_f32 v101, v101, v14
v_mul_f32 v102, v102, v14
v_mul_f32 v103, v103, v14
v_mul_f32 v104, v104, v14
v_mul_f32 v105, v105, v14
v_mul_f32 v106, v106, v14
v_mul_f32 v107, v107, v14
v_mul_f32 v108, v108, v14
v_mul_f32 v109, v109, v14
v_mul_f32 v110, v110, v14
v_mul_f32 v111, v111, v14
v_mul_f32 v112, v112, v15
v_mul_f32 v113, v113, v15
v_mul_f32 v114, v114, v15
v_mul_f32 v115, v115, v15
v_mul_f32 v116, v116, v15
v_mul_f32 v117, v117, v15
v_mul_f32 v118, v118, v15
v_mul_f32 v119, v119, v15
v_mul_f32 v120, v120, v15
v_mul_f32 v121, v121, v15
v_mul_f32 v122, v122, v15
v_mul_f32 v123, v123, v15
v_mul_f32 v124, v124, v15
v_mul_f32 v125, v125, v15
v_mul_f32 v126, v126, v15
v_mul_f32 v127, v127, v15
v_accvgpr_read_b32 v4, a160
v_mul_f32 v4, v4, v14
v_accvgpr_write_b32 a160, v4
v_accvgpr_read_b32 v4, a161
v_mul_f32 v4, v4, v14
v_accvgpr_write_b32 a161, v4
v_accvgpr_read_b32 v4, a162
v_mul_f32 v4, v4, v14
v_accvgpr_write_b32 a162, v4
v_accvgpr_read_b32 v4, a163
v_mul_f32 v4, v4, v14
v_accvgpr_write_b32 a163, v4
v_accvgpr_read_b32 v4, a164
v_mul_f32 v4, v4, v14
v_accvgpr_write_b32 a164, v4
v_accvgpr_read_b32 v4, a165
v_mul_f32 v4, v4, v14
v_accvgpr_write_b32 a165, v4
v_accvgpr_read_b32 v4, a166
v_mul_f32 v4, v4, v14
v_accvgpr_write_b32 a166, v4
v_accvgpr_read_b32 v4, a167
v_mul_f32 v4, v4, v14
v_accvgpr_write_b32 a167, v4
v_accvgpr_read_b32 v4, a168
v_mul_f32 v4, v4, v14
v_accvgpr_write_b32 a168, v4
v_accvgpr_read_b32 v4, a169
v_mul_f32 v4, v4, v14
v_accvgpr_write_b32 a169, v4
v_accvgpr_read_b32 v4, a170
v_mul_f32 v4, v4, v14
v_accvgpr_write_b32 a170, v4
v_accvgpr_read_b32 v4, a171
v_mul_f32 v4, v4, v14
v_accvgpr_write_b32 a171, v4
v_accvgpr_read_b32 v4, a172
v_mul_f32 v4, v4, v14
v_accvgpr_write_b32 a172, v4
v_accvgpr_read_b32 v4, a173
v_mul_f32 v4, v4, v14
v_accvgpr_write_b32 a173, v4
v_accvgpr_read_b32 v4, a174
v_mul_f32 v4, v4, v14
v_accvgpr_write_b32 a174, v4
v_accvgpr_read_b32 v4, a175
v_mul_f32 v4, v4, v14
v_accvgpr_write_b32 a175, v4
v_accvgpr_read_b32 v4, a176
v_mul_f32 v4, v4, v15
v_accvgpr_write_b32 a176, v4
v_accvgpr_read_b32 v4, a177
v_mul_f32 v4, v4, v15
v_accvgpr_write_b32 a177, v4
v_accvgpr_read_b32 v4, a178
v_mul_f32 v4, v4, v15
v_accvgpr_write_b32 a178, v4
v_accvgpr_read_b32 v4, a179
v_mul_f32 v4, v4, v15
v_accvgpr_write_b32 a179, v4
v_accvgpr_read_b32 v4, a180
v_mul_f32 v4, v4, v15
v_accvgpr_write_b32 a180, v4
v_accvgpr_read_b32 v4, a181
v_mul_f32 v4, v4, v15
v_accvgpr_write_b32 a181, v4
v_accvgpr_read_b32 v4, a182
v_mul_f32 v4, v4, v15
v_accvgpr_write_b32 a182, v4
v_accvgpr_read_b32 v4, a183
v_mul_f32 v4, v4, v15
v_accvgpr_write_b32 a183, v4
v_accvgpr_read_b32 v4, a184
v_mul_f32 v4, v4, v15
v_accvgpr_write_b32 a184, v4
v_accvgpr_read_b32 v4, a185
v_mul_f32 v4, v4, v15
v_accvgpr_write_b32 a185, v4
v_accvgpr_read_b32 v4, a186
v_mul_f32 v4, v4, v15
v_accvgpr_write_b32 a186, v4
v_accvgpr_read_b32 v4, a187
v_mul_f32 v4, v4, v15
v_accvgpr_write_b32 a187, v4
v_accvgpr_read_b32 v4, a188
v_mul_f32 v4, v4, v15
v_accvgpr_write_b32 a188, v4
v_accvgpr_read_b32 v4, a189
v_mul_f32 v4, v4, v15
v_accvgpr_write_b32 a189, v4
v_accvgpr_read_b32 v4, a190
v_mul_f32 v4, v4, v15
v_accvgpr_write_b32 a190, v4
v_accvgpr_read_b32 v4, a191
v_mul_f32 v4, v4, v15
v_accvgpr_write_b32 a191, v4
v_accvgpr_read_b32 v4, a192
v_mul_f32 v4, v4, v14
v_accvgpr_write_b32 a192, v4
v_accvgpr_read_b32 v4, a193
v_mul_f32 v4, v4, v14
v_accvgpr_write_b32 a193, v4
v_accvgpr_read_b32 v4, a194
v_mul_f32 v4, v4, v14
v_accvgpr_write_b32 a194, v4
v_accvgpr_read_b32 v4, a195
v_mul_f32 v4, v4, v14
v_accvgpr_write_b32 a195, v4
v_accvgpr_read_b32 v4, a196
v_mul_f32 v4, v4, v14
v_accvgpr_write_b32 a196, v4
v_accvgpr_read_b32 v4, a197
v_mul_f32 v4, v4, v14
v_accvgpr_write_b32 a197, v4
v_accvgpr_read_b32 v4, a198
v_mul_f32 v4, v4, v14
v_accvgpr_write_b32 a198, v4
v_accvgpr_read_b32 v4, a199
v_mul_f32 v4, v4, v14
v_accvgpr_write_b32 a199, v4
v_accvgpr_read_b32 v4, a200
v_mul_f32 v4, v4, v14
v_accvgpr_write_b32 a200, v4
v_accvgpr_read_b32 v4, a201
v_mul_f32 v4, v4, v14
v_accvgpr_write_b32 a201, v4
v_accvgpr_read_b32 v4, a202
v_mul_f32 v4, v4, v14
v_accvgpr_write_b32 a202, v4
v_accvgpr_read_b32 v4, a203
v_mul_f32 v4, v4, v14
v_accvgpr_write_b32 a203, v4
v_accvgpr_read_b32 v4, a204
v_mul_f32 v4, v4, v14
v_accvgpr_write_b32 a204, v4
v_accvgpr_read_b32 v4, a205
v_mul_f32 v4, v4, v14
v_accvgpr_write_b32 a205, v4
v_accvgpr_read_b32 v4, a206
v_mul_f32 v4, v4, v14
v_accvgpr_write_b32 a206, v4
v_accvgpr_read_b32 v4, a207
v_mul_f32 v4, v4, v14
v_accvgpr_write_b32 a207, v4
v_accvgpr_read_b32 v4, a208
v_mul_f32 v4, v4, v15
v_accvgpr_write_b32 a208, v4
v_accvgpr_read_b32 v4, a209
v_mul_f32 v4, v4, v15
v_accvgpr_write_b32 a209, v4
v_accvgpr_read_b32 v4, a210
v_mul_f32 v4, v4, v15
v_accvgpr_write_b32 a210, v4
v_accvgpr_read_b32 v4, a211
v_mul_f32 v4, v4, v15
v_accvgpr_write_b32 a211, v4
v_accvgpr_read_b32 v4, a212
v_mul_f32 v4, v4, v15
v_accvgpr_write_b32 a212, v4
v_accvgpr_read_b32 v4, a213
v_mul_f32 v4, v4, v15
v_accvgpr_write_b32 a213, v4
v_accvgpr_read_b32 v4, a214
v_mul_f32 v4, v4, v15
v_accvgpr_write_b32 a214, v4
v_accvgpr_read_b32 v4, a215
v_mul_f32 v4, v4, v15
v_accvgpr_write_b32 a215, v4
v_accvgpr_read_b32 v4, a216
v_mul_f32 v4, v4, v15
v_accvgpr_write_b32 a216, v4
v_accvgpr_read_b32 v4, a217
v_mul_f32 v4, v4, v15
v_accvgpr_write_b32 a217, v4
v_accvgpr_read_b32 v4, a218
v_mul_f32 v4, v4, v15
v_accvgpr_write_b32 a218, v4
v_accvgpr_read_b32 v4, a219
v_mul_f32 v4, v4, v15
v_accvgpr_write_b32 a219, v4
v_accvgpr_read_b32 v4, a220
v_mul_f32 v4, v4, v15
v_accvgpr_write_b32 a220, v4
v_accvgpr_read_b32 v4, a221
v_mul_f32 v4, v4, v15
v_accvgpr_write_b32 a221, v4
v_accvgpr_read_b32 v4, a222
v_mul_f32 v4, v4, v15
v_accvgpr_write_b32 a222, v4
v_accvgpr_read_b32 v4, a223
v_mul_f32 v4, v4, v15
v_accvgpr_write_b32 a223, v4
v_accvgpr_read_b32 v4, a224
v_mul_f32 v4, v4, v14
v_accvgpr_write_b32 a224, v4
v_accvgpr_read_b32 v4, a225
v_mul_f32 v4, v4, v14
v_accvgpr_write_b32 a225, v4
v_accvgpr_read_b32 v4, a226
v_mul_f32 v4, v4, v14
v_accvgpr_write_b32 a226, v4
v_accvgpr_read_b32 v4, a227
v_mul_f32 v4, v4, v14
v_accvgpr_write_b32 a227, v4
v_accvgpr_read_b32 v4, a228
v_mul_f32 v4, v4, v14
v_accvgpr_write_b32 a228, v4
v_accvgpr_read_b32 v4, a229
v_mul_f32 v4, v4, v14
v_accvgpr_write_b32 a229, v4
v_accvgpr_read_b32 v4, a230
v_mul_f32 v4, v4, v14
v_accvgpr_write_b32 a230, v4
v_accvgpr_read_b32 v4, a231
v_mul_f32 v4, v4, v14
v_accvgpr_write_b32 a231, v4
v_accvgpr_read_b32 v4, a232
v_mul_f32 v4, v4, v14
v_accvgpr_write_b32 a232, v4
v_accvgpr_read_b32 v4, a233
v_mul_f32 v4, v4, v14
v_accvgpr_write_b32 a233, v4
v_accvgpr_read_b32 v4, a234
v_mul_f32 v4, v4, v14
v_accvgpr_write_b32 a234, v4
v_accvgpr_read_b32 v4, a235
v_mul_f32 v4, v4, v14
v_accvgpr_write_b32 a235, v4
v_accvgpr_read_b32 v4, a236
v_mul_f32 v4, v4, v14
v_accvgpr_write_b32 a236, v4
v_accvgpr_read_b32 v4, a237
v_mul_f32 v4, v4, v14
v_accvgpr_write_b32 a237, v4
v_accvgpr_read_b32 v4, a238
v_mul_f32 v4, v4, v14
v_accvgpr_write_b32 a238, v4
v_accvgpr_read_b32 v4, a239
v_mul_f32 v4, v4, v14
v_accvgpr_write_b32 a239, v4
v_accvgpr_read_b32 v4, a240
v_mul_f32 v4, v4, v15
v_accvgpr_write_b32 a240, v4
v_accvgpr_read_b32 v4, a241
v_mul_f32 v4, v4, v15
v_accvgpr_write_b32 a241, v4
v_accvgpr_read_b32 v4, a242
v_mul_f32 v4, v4, v15
v_accvgpr_write_b32 a242, v4
v_accvgpr_read_b32 v4, a243
v_mul_f32 v4, v4, v15
v_accvgpr_write_b32 a243, v4
v_accvgpr_read_b32 v4, a244
v_mul_f32 v4, v4, v15
v_accvgpr_write_b32 a244, v4
v_accvgpr_read_b32 v4, a245
v_mul_f32 v4, v4, v15
v_accvgpr_write_b32 a245, v4
v_accvgpr_read_b32 v4, a246
v_mul_f32 v4, v4, v15
v_accvgpr_write_b32 a246, v4
v_accvgpr_read_b32 v4, a247
v_mul_f32 v4, v4, v15
v_accvgpr_write_b32 a247, v4
v_accvgpr_read_b32 v4, a248
v_mul_f32 v4, v4, v15
v_accvgpr_write_b32 a248, v4
v_accvgpr_read_b32 v4, a249
v_mul_f32 v4, v4, v15
v_accvgpr_write_b32 a249, v4
v_accvgpr_read_b32 v4, a250
v_mul_f32 v4, v4, v15
v_accvgpr_write_b32 a250, v4
v_accvgpr_read_b32 v4, a251
v_mul_f32 v4, v4, v15
v_accvgpr_write_b32 a251, v4
v_accvgpr_read_b32 v4, a252
v_mul_f32 v4, v4, v15
v_accvgpr_write_b32 a252, v4
v_accvgpr_read_b32 v4, a253
v_mul_f32 v4, v4, v15
v_accvgpr_write_b32 a253, v4
v_accvgpr_read_b32 v4, a254
v_mul_f32 v4, v4, v15
v_accvgpr_write_b32 a254, v4
v_accvgpr_read_b32 v4, a255
v_mul_f32 v4, v4, v15
v_accvgpr_write_b32 a255, v4
s_nop 1
s_mov_b32 s42, 0
s_branch PC_PENDRET_B1
PC_DONE:
s_load_dwordx2 s[36:37], s[0:1], 0
s_load_dwordx2 s[38:39], s[0:1], 72
s_load_dwordx2 s[56:57], s[0:1], 40
s_load_dwordx4 s[60:63], s[0:1], 56
s_lshr_b32 s40, s2, 3
s_mul_i32 s6, s40, 9363
s_lshr_b32 s6, s6, 16
s_mul_i32 s7, s6, 7
s_sub_u32 s7, s40, s7
s_and_b32 s41, s2, 7
s_lshl_b32 s41, s41, 2
s_add_u32 s6, s6, s41
s_mul_i32 s86, s3, 40960
s_mul_i32 s42, s3, 917504
s_lshl_b32 s44, s7, 7
s_add_u32 s42, s42, s44
s_mul_i32 s43, s6, 524288
s_lshl_b32 s44, s3, 16
s_add_u32 s43, s43, s44
v_add_u32 v6, 262144, v5
v_lshrrev_b32 v32, 3, v2
v_mul_u32_u24 v0, 896, v32
v_bfe_u32 v32, v2, 4, 1
v_lshlrev_b32 v32, 2, v32
v_and_b32 v33, 7, v2
v_xor_b32 v32, v32, v33
v_lshl_add_u32 v0, v32, 4, v0
v_add_u32 v1, 6144, v0
v_lshrrev_b32 v32, 5, v2
v_bfe_u32 v33, v2, 2, 2
v_lshl_add_u32 v32, v32, 2, v33
v_lshlrev_b32 v32, 7, v32
v_bfe_u32 v33, v2, 3, 1
v_lshl_add_u32 v32, v33, 6, v32
v_bfe_u32 v33, v2, 4, 1
v_lshl_add_u32 v32, v33, 5, v32
v_and_b32 v33, 3, v2
v_lshl_add_u32 v32, v33, 3, v32
v_add_u32 v3, s86, v32
v_xor_b32 v28, 64, v3
s_mov_b32 s58, s42
s_mov_b32 s59, s43
s_and_b32 s53, s2, 7
s_waitcnt vmcnt(0) lgkmcnt(0)
s_barrier
s_mov_b32 s32, s56
s_and_b32 s33, s57, 0xffff
s_mov_b32 s34, 0x380000
s_mov_b32 s35, 0x00020000
s_mov_b32 s76, s60
s_and_b32 s77, s61, 0xffff
s_mov_b32 s78, 0x188000
s_mov_b32 s79, 0x00020000
s_mov_b32 s80, s62
s_and_b32 s81, s63, 0xffff
s_mov_b32 s82, 0x188000
s_mov_b32 s83, 0x00020000
s_lshl_b32 s45, s5, 6
s_lshl_b32 s44, s4, 2
s_add_u32 s45, s45, s44
s_add_u32 s45, s45, 3072
s_cmp_lg_u32 s3, 0
s_cbranch_scc1 SETF_13
s_mov_b64 exec, 1
buffer_store_dword v30, v29, s[88:91], s45 offen sc1
s_mov_b64 exec, -1
SETF_13:
s_sub_u32 s45, 31, s5
s_lshl_b32 s45, s45, 6
s_add_u32 s45, s45, s44
s_add_u32 s45, s45, 3072
s_cmp_lg_u32 s3, 0
s_cbranch_scc1 SETF_14
s_mov_b64 exec, 1
buffer_store_dword v30, v29, s[88:91], s45 offen sc1
s_mov_b64 exec, -1
SETF_14:
s_cmp_lt_u32 s40, 28
s_cbranch_scc0 MEGA_FIN
s_add_u32 s42, s53, 0
s_and_b32 s42, s42, 7
s_mul_i32 s42, s42, 114688
s_add_u32 s42, s42, s58
s_add_u32 m0, s86, 0
s_nop 0
buffer_load_dwordx4 v0, s[32:35], s42 offen lds
buffer_load_dwordx4 v1, s[32:35], s42 offen offset:1024 lds
s_add_u32 s42, s42, 14336
s_add_u32 m0, s86, 2048
s_nop 0
buffer_load_dwordx4 v0, s[32:35], s42 offen lds
buffer_load_dwordx4 v1, s[32:35], s42 offen offset:1024 lds
s_add_u32 s42, s42, 14336
s_add_u32 m0, s86, 4096
s_nop 0
buffer_load_dwordx4 v0, s[32:35], s42 offen lds
buffer_load_dwordx4 v1, s[32:35], s42 offen offset:1024 lds
s_add_u32 s42, s42, 14336
s_add_u32 m0, s86, 6144
s_nop 0
buffer_load_dwordx4 v0, s[32:35], s42 offen lds
buffer_load_dwordx4 v1, s[32:35], s42 offen offset:1024 lds
s_add_u32 s42, s42, 14336
s_add_u32 m0, s86, 8192
s_nop 0
buffer_load_dwordx4 v0, s[32:35], s42 offen lds
buffer_load_dwordx4 v1, s[32:35], s42 offen offset:1024 lds
s_add_u32 s42, s42, 14336
s_add_u32 m0, s86, 10240
s_nop 0
buffer_load_dwordx4 v0, s[32:35], s42 offen lds
buffer_load_dwordx4 v1, s[32:35], s42 offen offset:1024 lds
s_add_u32 s42, s42, 14336
s_add_u32 m0, s86, 12288
s_nop 0
buffer_load_dwordx4 v0, s[32:35], s42 offen lds
buffer_load_dwordx4 v1, s[32:35], s42 offen offset:1024 lds
s_add_u32 s42, s42, 14336
s_add_u32 m0, s86, 14336
s_nop 0
buffer_load_dwordx4 v0, s[32:35], s42 offen lds
buffer_load_dwordx4 v1, s[32:35], s42 offen offset:1024 lds
s_add_u32 s42, s42, 14336
s_add_u32 s42, s53, 1
s_and_b32 s42, s42, 7
s_mul_i32 s42, s42, 114688
s_add_u32 s42, s42, s58
s_add_u32 m0, s86, 16384
s_nop 0
buffer_load_dwordx4 v0, s[32:35], s42 offen lds
buffer_load_dwordx4 v1, s[32:35], s42 offen offset:1024 lds
s_add_u32 s42, s42, 14336
s_add_u32 m0, s86, 18432
s_nop 0
buffer_load_dwordx4 v0, s[32:35], s42 offen lds
buffer_load_dwordx4 v1, s[32:35], s42 offen offset:1024 lds
s_add_u32 s42, s42, 14336
s_add_u32 m0, s86, 20480
s_nop 0
buffer_load_dwordx4 v0, s[32:35], s42 offen lds
buffer_load_dwordx4 v1, s[32:35], s42 offen offset:1024 lds
s_add_u32 s42, s42, 14336
s_add_u32 m0, s86, 22528
s_nop 0
buffer_load_dwordx4 v0, s[32:35], s42 offen lds
buffer_load_dwordx4 v1, s[32:35], s42 offen offset:1024 lds
s_add_u32 s42, s42, 14336
s_add_u32 m0, s86, 24576
s_nop 0
buffer_load_dwordx4 v0, s[32:35], s42 offen lds
buffer_load_dwordx4 v1, s[32:35], s42 offen offset:1024 lds
s_add_u32 s42, s42, 14336
s_add_u32 m0, s86, 26624
s_nop 0
buffer_load_dwordx4 v0, s[32:35], s42 offen lds
buffer_load_dwordx4 v1, s[32:35], s42 offen offset:1024 lds
s_add_u32 s42, s42, 14336
s_add_u32 m0, s86, 28672
s_nop 0
buffer_load_dwordx4 v0, s[32:35], s42 offen lds
buffer_load_dwordx4 v1, s[32:35], s42 offen offset:1024 lds
s_add_u32 s42, s42, 14336
s_add_u32 m0, s86, 30720
s_nop 0
buffer_load_dwordx4 v0, s[32:35], s42 offen lds
buffer_load_dwordx4 v1, s[32:35], s42 offen offset:1024 lds
s_add_u32 s42, s42, 14336
s_add_u32 s42, s53, 2
s_and_b32 s42, s42, 7
s_mul_i32 s42, s42, 114688
s_add_u32 s42, s42, s58
s_add_u32 m0, s86, 32768
s_nop 0
buffer_load_dwordx4 v0, s[32:35], s42 offen lds
buffer_load_dwordx4 v1, s[32:35], s42 offen offset:1024 lds
s_add_u32 s42, s42, 14336
s_add_u32 m0, s86, 34816
s_nop 0
buffer_load_dwordx4 v0, s[32:35], s42 offen lds
buffer_load_dwordx4 v1, s[32:35], s42 offen offset:1024 lds
s_add_u32 s42, s42, 14336
s_add_u32 m0, s86, 36864
s_nop 0
buffer_load_dwordx4 v0, s[32:35], s42 offen lds
buffer_load_dwordx4 v1, s[32:35], s42 offen offset:1024 lds
s_add_u32 s42, s42, 14336
s_add_u32 m0, s86, 38912
s_nop 0
buffer_load_dwordx4 v0, s[32:35], s42 offen lds
buffer_load_dwordx4 v1, s[32:35], s42 offen offset:1024 lds
s_add_u32 s42, s42, 14336
s_add_u32 s16, s54, 0x3e00000
s_addc_u32 s17, s55, 0
s_and_b32 s17, s17, 0xffff
s_mov_b32 s18, 0x1c0000
s_mov_b32 s19, 0x00020000
s_mov_b32 s24, s36
s_and_b32 s25, s37, 0xffff
s_mov_b32 s26, 0x1c0000
s_mov_b32 s27, 0x00020000
s_mov_b32 s28, s38
s_and_b32 s29, s39, 0xffff
s_mov_b32 s30, 0x1c0000
s_mov_b32 s31, 0x00020000
s_add_u32 s8, s54, 0x4000000
s_addc_u32 s9, s55, 0
s_and_b32 s9, s9, 0xffff
s_mov_b32 s10, 0x38000
s_mov_b32 s11, 0x00020000
s_lshr_b32 s46, s3, 1
s_lshl_b32 s45, s7, 1
s_add_u32 s46, s46, s45
s_and_b32 s47, s3, 1
s_lshl_b32 s45, s6, 1
s_add_u32 s47, s47, s45
v_and_b32 v7, 31, v2
v_lshrrev_b32 v8, 5, v2
s_lshl_b32 s45, s47, 5
v_add_u32 v7, s45, v7
v_mul_u32_u24 v9, 896, v7
v_lshl_add_u32 v9, v8, 3, v9
s_lshl_b32 s48, s46, 6
s_mul_i32 s49, s47, 28672
s_lshl_b32 s45, s46, 11
s_add_u32 s49, s49, s45
buffer_load_dwordx2 v[12:13], v9, s[24:27], s48 offen
buffer_load_dwordx2 v[14:15], v9, s[24:27], s48 offen offset:16
buffer_load_dwordx2 v[16:17], v9, s[24:27], s48 offen offset:32
buffer_load_dwordx2 v[18:19], v9, s[24:27], s48 offen offset:48
s_waitcnt vmcnt(42)
ds_read_b64_tr_b16 v[128:129], v3
ds_read_b64_tr_b16 v[130:131], v3 offset:1024
ds_read_b64_tr_b16 v[132:133], v28
ds_read_b64_tr_b16 v[134:135], v28 offset:1024
s_waitcnt vmcnt(40)
ds_read_b64_tr_b16 v[136:137], v3 offset:2048
ds_read_b64_tr_b16 v[138:139], v3 offset:3072
ds_read_b64_tr_b16 v[140:141], v28 offset:2048
ds_read_b64_tr_b16 v[142:143], v28 offset:3072
s_waitcnt vmcnt(38)
ds_read_b64_tr_b16 v[144:145], v3 offset:4096
ds_read_b64_tr_b16 v[146:147], v3 offset:5120
ds_read_b64_tr_b16 v[148:149], v28 offset:4096
ds_read_b64_tr_b16 v[150:151], v28 offset:5120
s_waitcnt lgkmcnt(8)
s_add_u32 m0, s86, 0
s_nop 0
buffer_load_dwordx4 v0, s[32:35], s42 offen lds
buffer_load_dwordx4 v1, s[32:35], s42 offen offset:1024 lds
s_add_u32 s42, s42, 14336
s_waitcnt vmcnt(38)
ds_read_b64_tr_b16 v[152:153], v3 offset:6144
ds_read_b64_tr_b16 v[154:155], v3 offset:7168
ds_read_b64_tr_b16 v[156:157], v28 offset:6144
ds_read_b64_tr_b16 v[158:159], v28 offset:7168
s_waitcnt lgkmcnt(8)
s_add_u32 m0, s86, 2048
s_nop 0
buffer_load_dwordx4 v0, s[32:35], s42 offen lds
buffer_load_dwordx4 v1, s[32:35], s42 offen offset:1024 lds
s_add_u32 s42, s42, 14336
s_waitcnt vmcnt(38)
ds_read_b64_tr_b16 v[160:161], v3 offset:8192
ds_read_b64_tr_b16 v[162:163], v3 offset:9216
ds_read_b64_tr_b16 v[164:165], v28 offset:8192
ds_read_b64_tr_b16 v[166:167], v28 offset:9216
s_waitcnt lgkmcnt(8)
s_add_u32 m0, s86, 4096
s_nop 0
buffer_load_dwordx4 v0, s[32:35], s42 offen lds
buffer_load_dwordx4 v1, s[32:35], s42 offen offset:1024 lds
s_add_u32 s42, s42, 14336
s_waitcnt vmcnt(38)
ds_read_b64_tr_b16 v[168:169], v3 offset:10240
ds_read_b64_tr_b16 v[170:171], v3 offset:11264
ds_read_b64_tr_b16 v[172:173], v28 offset:10240
ds_read_b64_tr_b16 v[174:175], v28 offset:11264
s_waitcnt lgkmcnt(8)
s_add_u32 m0, s86, 6144
s_nop 0
buffer_load_dwordx4 v0, s[32:35], s42 offen lds
buffer_load_dwordx4 v1, s[32:35], s42 offen offset:1024 lds
s_add_u32 s42, s42, 14336
s_waitcnt vmcnt(38)
ds_read_b64_tr_b16 v[176:177], v3 offset:12288
ds_read_b64_tr_b16 v[178:179], v3 offset:13312
ds_read_b64_tr_b16 v[180:181], v28 offset:12288
ds_read_b64_tr_b16 v[182:183], v28 offset:13312
s_waitcnt lgkmcnt(8)
s_add_u32 s42, s53, 3
s_and_b32 s42, s42, 7
s_mul_i32 s42, s42, 114688
s_add_u32 s42, s42, s58
s_add_u32 m0, s86, 8192
s_nop 0
buffer_load_dwordx4 v0, s[32:35], s42 offen lds
buffer_load_dwordx4 v1, s[32:35], s42 offen offset:1024 lds
s_add_u32 s42, s42, 14336
s_waitcnt vmcnt(38)
ds_read_b64_tr_b16 v[184:185], v3 offset:14336
ds_read_b64_tr_b16 v[186:187], v3 offset:15360
ds_read_b64_tr_b16 v[188:189], v28 offset:14336
ds_read_b64_tr_b16 v[190:191], v28 offset:15360
s_waitcnt lgkmcnt(8)
s_add_u32 m0, s86, 10240
s_nop 0
buffer_load_dwordx4 v0, s[32:35], s42 offen lds
buffer_load_dwordx4 v1, s[32:35], s42 offen offset:1024 lds
s_add_u32 s42, s42, 14336
s_waitcnt vmcnt(38)
ds_read_b64_tr_b16 v[192:193], v3 offset:16384
ds_read_b64_tr_b16 v[194:195], v3 offset:17408
ds_read_b64_tr_b16 v[196:197], v28 offset:16384
ds_read_b64_tr_b16 v[198:199], v28 offset:17408
s_waitcnt lgkmcnt(8)
s_add_u32 m0, s86, 12288
s_nop 0
buffer_load_dwordx4 v0, s[32:35], s42 offen lds
buffer_load_dwordx4 v1, s[32:35], s42 offen offset:1024 lds
s_add_u32 s42, s42, 14336
s_waitcnt vmcnt(38)
ds_read_b64_tr_b16 v[200:201], v3 offset:18432
ds_read_b64_tr_b16 v[202:203], v3 offset:19456
ds_read_b64_tr_b16 v[204:205], v28 offset:18432
ds_read_b64_tr_b16 v[206:207], v28 offset:19456
s_waitcnt lgkmcnt(8)
s_add_u32 m0, s86, 14336
s_nop 0
buffer_load_dwordx4 v0, s[32:35], s42 offen lds
buffer_load_dwordx4 v1, s[32:35], s42 offen offset:1024 lds
s_add_u32 s42, s42, 14336
s_waitcnt vmcnt(38)
ds_read_b64_tr_b16 v[208:209], v3 offset:20480
ds_read_b64_tr_b16 v[210:211], v3 offset:21504
ds_read_b64_tr_b16 v[212:213], v28 offset:20480
ds_read_b64_tr_b16 v[214:215], v28 offset:21504
s_waitcnt lgkmcnt(8)
s_add_u32 m0, s86, 16384
s_nop 0
buffer_load_dwordx4 v0, s[32:35], s42 offen lds
buffer_load_dwordx4 v1, s[32:35], s42 offen offset:1024 lds
s_add_u32 s42, s42, 14336
s_waitcnt vmcnt(38)
ds_read_b64_tr_b16 v[216:217], v3 offset:22528
ds_read_b64_tr_b16 v[218:219], v3 offset:23552
ds_read_b64_tr_b16 v[220:221], v28 offset:22528
ds_read_b64_tr_b16 v[222:223], v28 offset:23552
s_waitcnt lgkmcnt(8)
s_add_u32 m0, s86, 18432
s_nop 0
buffer_load_dwordx4 v0, s[32:35], s42 offen lds
buffer_load_dwordx4 v1, s[32:35], s42 offen offset:1024 lds
s_add_u32 s42, s42, 14336
s_waitcnt vmcnt(38)
ds_read_b64_tr_b16 v[224:225], v3 offset:24576
ds_read_b64_tr_b16 v[226:227], v3 offset:25600
ds_read_b64_tr_b16 v[228:229], v28 offset:24576
ds_read_b64_tr_b16 v[230:231], v28 offset:25600
s_waitcnt lgkmcnt(8)
s_add_u32 m0, s86, 20480
s_nop 0
buffer_load_dwordx4 v0, s[32:35], s42 offen lds
buffer_load_dwordx4 v1, s[32:35], s42 offen offset:1024 lds
s_add_u32 s42, s42, 14336
s_waitcnt vmcnt(38)
ds_read_b64_tr_b16 v[232:233], v3 offset:26624
ds_read_b64_tr_b16 v[234:235], v3 offset:27648
ds_read_b64_tr_b16 v[236:237], v28 offset:26624
ds_read_b64_tr_b16 v[238:239], v28 offset:27648
s_waitcnt lgkmcnt(8)
s_add_u32 m0, s86, 22528
s_nop 0
buffer_load_dwordx4 v0, s[32:35], s42 offen lds
buffer_load_dwordx4 v1, s[32:35], s42 offen offset:1024 lds
s_add_u32 s42, s42, 14336
s_waitcnt vmcnt(38)
ds_read_b64_tr_b16 v[240:241], v3 offset:28672
ds_read_b64_tr_b16 v[242:243], v3 offset:29696
ds_read_b64_tr_b16 v[244:245], v28 offset:28672
ds_read_b64_tr_b16 v[246:247], v28 offset:29696
s_waitcnt lgkmcnt(8)
s_add_u32 s42, s53, 4
s_and_b32 s42, s42, 7
s_mul_i32 s42, s42, 114688
s_add_u32 s42, s42, s58
s_add_u32 m0, s86, 24576
s_nop 0
buffer_load_dwordx4 v0, s[32:35], s42 offen lds
buffer_load_dwordx4 v1, s[32:35], s42 offen offset:1024 lds
s_add_u32 s42, s42, 14336
s_waitcnt vmcnt(38)
ds_read_b64_tr_b16 v[248:249], v3 offset:30720
ds_read_b64_tr_b16 v[250:251], v3 offset:31744
ds_read_b64_tr_b16 v[252:253], v28 offset:30720
ds_read_b64_tr_b16 v[254:255], v28 offset:31744
s_waitcnt lgkmcnt(8)
s_add_u32 m0, s86, 26624
s_nop 0
buffer_load_dwordx4 v0, s[32:35], s42 offen lds
buffer_load_dwordx4 v1, s[32:35], s42 offen offset:1024 lds
s_add_u32 s42, s42, 14336
s_waitcnt vmcnt(38)
ds_read_b64_tr_b16 a[64:65], v3 offset:32768
ds_read_b64_tr_b16 a[66:67], v3 offset:33792
ds_read_b64_tr_b16 a[68:69], v28 offset:32768
ds_read_b64_tr_b16 a[70:71], v28 offset:33792
s_waitcnt lgkmcnt(8)
s_add_u32 m0, s86, 28672
s_nop 0
buffer_load_dwordx4 v0, s[32:35], s42 offen lds
buffer_load_dwordx4 v1, s[32:35], s42 offen offset:1024 lds
s_add_u32 s42, s42, 14336
s_waitcnt vmcnt(38)
ds_read_b64_tr_b16 a[72:73], v3 offset:34816
ds_read_b64_tr_b16 a[74:75], v3 offset:35840
ds_read_b64_tr_b16 a[76:77], v28 offset:34816
ds_read_b64_tr_b16 a[78:79], v28 offset:35840
s_waitcnt lgkmcnt(8)
s_add_u32 m0, s86, 30720
s_nop 0
buffer_load_dwordx4 v0, s[32:35], s42 offen lds
buffer_load_dwordx4 v1, s[32:35], s42 offen offset:1024 lds
s_add_u32 s42, s42, 14336
s_waitcnt vmcnt(38)
ds_read_b64_tr_b16 a[80:81], v3 offset:36864
ds_read_b64_tr_b16 a[82:83], v3 offset:37888
ds_read_b64_tr_b16 a[84:85], v28 offset:36864
ds_read_b64_tr_b16 a[86:87], v28 offset:37888
s_waitcnt lgkmcnt(8)
s_add_u32 m0, s86, 32768
s_nop 0
buffer_load_dwordx4 v0, s[32:35], s42 offen lds
buffer_load_dwordx4 v1, s[32:35], s42 offen offset:1024 lds
s_add_u32 s42, s42, 14336
s_waitcnt vmcnt(38)
ds_read_b64_tr_b16 a[88:89], v3 offset:38912
ds_read_b64_tr_b16 a[90:91], v3 offset:39936
ds_read_b64_tr_b16 a[92:93], v28 offset:38912
ds_read_b64_tr_b16 a[94:95], v28 offset:39936
s_waitcnt lgkmcnt(8)
s_add_u32 m0, s86, 34816
s_nop 0
buffer_load_dwordx4 v0, s[32:35], s42 offen lds
buffer_load_dwordx4 v1, s[32:35], s42 offen offset:1024 lds
s_add_u32 s42, s42, 14336
s_waitcnt vmcnt(34)
ds_read_b64_tr_b16 a[96:97], v3
ds_read_b64_tr_b16 a[98:99], v3 offset:1024
ds_read_b64_tr_b16 a[100:101], v28
ds_read_b64_tr_b16 a[102:103], v28 offset:1024
s_waitcnt lgkmcnt(8)
s_add_u32 m0, s86, 36864
s_nop 0
buffer_load_dwordx4 v0, s[32:35], s42 offen lds
buffer_load_dwordx4 v1, s[32:35], s42 offen offset:1024 lds
s_add_u32 s42, s42, 14336
s_waitcnt vmcnt(34)
ds_read_b64_tr_b16 a[104:105], v3 offset:2048
ds_read_b64_tr_b16 a[106:107], v3 offset:3072
ds_read_b64_tr_b16 a[108:109], v28 offset:2048
ds_read_b64_tr_b16 a[110:111], v28 offset:3072
s_waitcnt lgkmcnt(8)
s_add_u32 m0, s86, 38912
s_nop 0
buffer_load_dwordx4 v0, s[32:35], s42 offen lds
buffer_load_dwordx4 v1, s[32:35], s42 offen offset:1024 lds
s_add_u32 s42, s42, 14336
s_waitcnt vmcnt(34)
ds_read_b64_tr_b16 a[112:113], v3 offset:4096
ds_read_b64_tr_b16 a[114:115], v3 offset:5120
ds_read_b64_tr_b16 a[116:117], v28 offset:4096
ds_read_b64_tr_b16 a[118:119], v28 offset:5120
s_waitcnt lgkmcnt(8)
s_add_u32 s42, s53, 5
s_and_b32 s42, s42, 7
s_mul_i32 s42, s42, 114688
s_add_u32 s42, s42, s58
s_add_u32 m0, s86, 0
s_nop 0
buffer_load_dwordx4 v0, s[32:35], s42 offen lds
buffer_load_dwordx4 v1, s[32:35], s42 offen offset:1024 lds
s_add_u32 s42, s42, 14336
s_waitcnt vmcnt(34)
ds_read_b64_tr_b16 a[120:121], v3 offset:6144
ds_read_b64_tr_b16 a[122:123], v3 offset:7168
ds_read_b64_tr_b16 a[124:125], v28 offset:6144
ds_read_b64_tr_b16 a[126:127], v28 offset:7168
s_waitcnt lgkmcnt(8)
s_add_u32 m0, s86, 2048
s_nop 0
buffer_load_dwordx4 v0, s[32:35], s42 offen lds
buffer_load_dwordx4 v1, s[32:35], s42 offen offset:1024 lds
s_add_u32 s42, s42, 14336
s_waitcnt vmcnt(34)
ds_read_b64_tr_b16 a[128:129], v3 offset:8192
ds_read_b64_tr_b16 a[130:131], v3 offset:9216
ds_read_b64_tr_b16 a[132:133], v28 offset:8192
ds_read_b64_tr_b16 a[134:135], v28 offset:9216
s_waitcnt lgkmcnt(8)
s_add_u32 m0, s86, 4096
s_nop 0
buffer_load_dwordx4 v0, s[32:35], s42 offen lds
buffer_load_dwordx4 v1, s[32:35], s42 offen offset:1024 lds
s_add_u32 s42, s42, 14336
s_waitcnt vmcnt(34)
ds_read_b64_tr_b16 a[136:137], v3 offset:10240
ds_read_b64_tr_b16 a[138:139], v3 offset:11264
ds_read_b64_tr_b16 a[140:141], v28 offset:10240
ds_read_b64_tr_b16 a[142:143], v28 offset:11264
s_waitcnt lgkmcnt(8)
s_add_u32 m0, s86, 6144
s_nop 0
buffer_load_dwordx4 v0, s[32:35], s42 offen lds
buffer_load_dwordx4 v1, s[32:35], s42 offen offset:1024 lds
s_add_u32 s42, s42, 14336
s_waitcnt vmcnt(34)
ds_read_b64_tr_b16 a[144:145], v3 offset:12288
ds_read_b64_tr_b16 a[146:147], v3 offset:13312
ds_read_b64_tr_b16 a[148:149], v28 offset:12288
ds_read_b64_tr_b16 a[150:151], v28 offset:13312
s_waitcnt lgkmcnt(8)
s_add_u32 m0, s86, 8192
s_nop 0
buffer_load_dwordx4 v0, s[32:35], s42 offen lds
buffer_load_dwordx4 v1, s[32:35], s42 offen offset:1024 lds
s_add_u32 s42, s42, 14336
s_waitcnt vmcnt(34)
ds_read_b64_tr_b16 a[152:153], v3 offset:14336
ds_read_b64_tr_b16 a[154:155], v3 offset:15360
ds_read_b64_tr_b16 a[156:157], v28 offset:14336
ds_read_b64_tr_b16 a[158:159], v28 offset:15360
s_waitcnt lgkmcnt(8)
s_add_u32 m0, s86, 10240
s_nop 0
buffer_load_dwordx4 v0, s[32:35], s42 offen lds
buffer_load_dwordx4 v1, s[32:35], s42 offen offset:1024 lds
s_add_u32 s42, s42, 14336
s_waitcnt vmcnt(34)
ds_read_b64_tr_b16 a[160:161], v3 offset:16384
ds_read_b64_tr_b16 a[162:163], v3 offset:17408
ds_read_b64_tr_b16 a[164:165], v28 offset:16384
ds_read_b64_tr_b16 a[166:167], v28 offset:17408
s_waitcnt lgkmcnt(8)
s_add_u32 m0, s86, 12288
s_nop 0
buffer_load_dwordx4 v0, s[32:35], s42 offen lds
buffer_load_dwordx4 v1, s[32:35], s42 offen offset:1024 lds
s_add_u32 s42, s42, 14336
s_waitcnt vmcnt(34)
ds_read_b64_tr_b16 a[168:169], v3 offset:18432
ds_read_b64_tr_b16 a[170:171], v3 offset:19456
ds_read_b64_tr_b16 a[172:173], v28 offset:18432
ds_read_b64_tr_b16 a[174:175], v28 offset:19456
s_waitcnt lgkmcnt(8)
s_add_u32 m0, s86, 14336
s_nop 0
buffer_load_dwordx4 v0, s[32:35], s42 offen lds
buffer_load_dwordx4 v1, s[32:35], s42 offen offset:1024 lds
s_add_u32 s42, s42, 14336
s_waitcnt vmcnt(34)
ds_read_b64_tr_b16 a[176:177], v3 offset:20480
ds_read_b64_tr_b16 a[178:179], v3 offset:21504
ds_read_b64_tr_b16 a[180:181], v28 offset:20480
ds_read_b64_tr_b16 a[182:183], v28 offset:21504
s_waitcnt lgkmcnt(8)
s_add_u32 s42, s53, 6
s_and_b32 s42, s42, 7
s_mul_i32 s42, s42, 114688
s_add_u32 s42, s42, s58
s_add_u32 m0, s86, 16384
s_nop 0
buffer_load_dwordx4 v0, s[32:35], s42 offen lds
buffer_load_dwordx4 v1, s[32:35], s42 offen offset:1024 lds
s_add_u32 s42, s42, 14336
s_waitcnt vmcnt(34)
ds_read_b64_tr_b16 a[184:185], v3 offset:22528
ds_read_b64_tr_b16 a[186:187], v3 offset:23552
ds_read_b64_tr_b16 a[188:189], v28 offset:22528
ds_read_b64_tr_b16 a[190:191], v28 offset:23552
s_waitcnt lgkmcnt(8)
s_add_u32 m0, s86, 18432
s_nop 0
buffer_load_dwordx4 v0, s[32:35], s42 offen lds
buffer_load_dwordx4 v1, s[32:35], s42 offen offset:1024 lds
s_add_u32 s42, s42, 14336
s_waitcnt vmcnt(34)
ds_read_b64_tr_b16 a[192:193], v3 offset:24576
ds_read_b64_tr_b16 a[194:195], v3 offset:25600
ds_read_b64_tr_b16 a[196:197], v28 offset:24576
ds_read_b64_tr_b16 a[198:199], v28 offset:25600
s_waitcnt lgkmcnt(8)
s_add_u32 m0, s86, 20480
s_nop 0
buffer_load_dwordx4 v0, s[32:35], s42 offen lds
buffer_load_dwordx4 v1, s[32:35], s42 offen offset:1024 lds
s_add_u32 s42, s42, 14336
s_waitcnt vmcnt(34)
ds_read_b64_tr_b16 a[200:201], v3 offset:26624
ds_read_b64_tr_b16 a[202:203], v3 offset:27648
ds_read_b64_tr_b16 a[204:205], v28 offset:26624
ds_read_b64_tr_b16 a[206:207], v28 offset:27648
s_waitcnt lgkmcnt(8)
s_add_u32 m0, s86, 22528
s_nop 0
buffer_load_dwordx4 v0, s[32:35], s42 offen lds
buffer_load_dwordx4 v1, s[32:35], s42 offen offset:1024 lds
s_add_u32 s42, s42, 14336
s_waitcnt vmcnt(34)
ds_read_b64_tr_b16 a[208:209], v3 offset:28672
ds_read_b64_tr_b16 a[210:211], v3 offset:29696
ds_read_b64_tr_b16 a[212:213], v28 offset:28672
ds_read_b64_tr_b16 a[214:215], v28 offset:29696
s_waitcnt lgkmcnt(8)
s_add_u32 m0, s86, 24576
s_nop 0
buffer_load_dwordx4 v0, s[32:35], s42 offen lds
buffer_load_dwordx4 v1, s[32:35], s42 offen offset:1024 lds
s_add_u32 s42, s42, 14336
s_waitcnt vmcnt(34)
ds_read_b64_tr_b16 a[216:217], v3 offset:30720
ds_read_b64_tr_b16 a[218:219], v3 offset:31744
ds_read_b64_tr_b16 a[220:221], v28 offset:30720
ds_read_b64_tr_b16 a[222:223], v28 offset:31744
s_waitcnt lgkmcnt(8)
s_add_u32 m0, s86, 26624
s_nop 0
buffer_load_dwordx4 v0, s[32:35], s42 offen lds
buffer_load_dwordx4 v1, s[32:35], s42 offen offset:1024 lds
s_add_u32 s42, s42, 14336
s_waitcnt vmcnt(34)
ds_read_b64_tr_b16 a[224:225], v3 offset:32768
ds_read_b64_tr_b16 a[226:227], v3 offset:33792
ds_read_b64_tr_b16 a[228:229], v28 offset:32768
ds_read_b64_tr_b16 a[230:231], v28 offset:33792
s_waitcnt lgkmcnt(8)
s_add_u32 m0, s86, 28672
s_nop 0
buffer_load_dwordx4 v0, s[32:35], s42 offen lds
buffer_load_dwordx4 v1, s[32:35], s42 offen offset:1024 lds
s_add_u32 s42, s42, 14336
s_waitcnt vmcnt(34)
ds_read_b64_tr_b16 a[232:233], v3 offset:34816
ds_read_b64_tr_b16 a[234:235], v3 offset:35840
ds_read_b64_tr_b16 a[236:237], v28 offset:34816
ds_read_b64_tr_b16 a[238:239], v28 offset:35840
s_waitcnt lgkmcnt(8)
s_add_u32 m0, s86, 30720
s_nop 0
buffer_load_dwordx4 v0, s[32:35], s42 offen lds
buffer_load_dwordx4 v1, s[32:35], s42 offen offset:1024 lds
s_add_u32 s42, s42, 14336
s_waitcnt vmcnt(34)
ds_read_b64_tr_b16 a[240:241], v3 offset:36864
ds_read_b64_tr_b16 a[242:243], v3 offset:37888
ds_read_b64_tr_b16 a[244:245], v28 offset:36864
ds_read_b64_tr_b16 a[246:247], v28 offset:37888
s_waitcnt lgkmcnt(8)
s_add_u32 s42, s53, 7
s_and_b32 s42, s42, 7
s_mul_i32 s42, s42, 114688
s_add_u32 s42, s42, s58
s_add_u32 m0, s86, 32768
s_nop 0
buffer_load_dwordx4 v0, s[32:35], s42 offen lds
buffer_load_dwordx4 v1, s[32:35], s42 offen offset:1024 lds
s_add_u32 s42, s42, 14336
s_waitcnt vmcnt(34)
ds_read_b64_tr_b16 a[248:249], v3 offset:38912
ds_read_b64_tr_b16 a[250:251], v3 offset:39936
ds_read_b64_tr_b16 a[252:253], v28 offset:38912
ds_read_b64_tr_b16 a[254:255], v28 offset:39936
s_waitcnt lgkmcnt(8)
s_add_u32 m0, s86, 34816
s_nop 0
buffer_load_dwordx4 v0, s[32:35], s42 offen lds
buffer_load_dwordx4 v1, s[32:35], s42 offen offset:1024 lds
s_add_u32 s42, s42, 14336
s_waitcnt lgkmcnt(4)
s_add_u32 m0, s86, 36864
s_nop 0
buffer_load_dwordx4 v0, s[32:35], s42 offen lds
buffer_load_dwordx4 v1, s[32:35], s42 offen offset:1024 lds
s_add_u32 s42, s42, 14336
s_waitcnt lgkmcnt(0)
s_add_u32 m0, s86, 38912
s_nop 0
buffer_load_dwordx4 v0, s[32:35], s42 offen lds
buffer_load_dwordx4 v1, s[32:35], s42 offen offset:1024 lds
s_add_u32 s42, s42, 14336
v_and_b32 v10, 15, v2
v_lshlrev_b32 v10, 2, v10
s_lshl_b32 s45, s6, 6
s_add_u32 s45, s45, 3072
s_mov_b32 s87, 0
POLL_15:
buffer_load_dword v11, v10, s[88:91], s45 offen sc1
s_waitcnt vmcnt(0)
v_cmp_ne_u32 vcc, 1, v11
s_cbranch_vccz POLL_15_OK
s_sleep 1
s_add_u32 s87, s87, 1
s_cmp_lt_u32 s87, 65536
s_cbranch_scc1 POLL_15
POLL_15_OK:
s_add_u32 s43, s53, 0
s_and_b32 s43, s43, 7
s_lshl_b32 s43, s43, 13
s_add_u32 s43, s43, s59
s_nop 0
buffer_load_dwordx4 a[0:3], v5, s[20:23], s43 offen sc1
buffer_load_dwordx4 a[4:7], v6, s[20:23], s43 offen sc1
buffer_load_dwordx4 a[8:11], v5, s[20:23], s43 offen offset:1024 sc1
buffer_load_dwordx4 a[12:15], v6, s[20:23], s43 offen offset:1024 sc1
buffer_load_dwordx4 a[16:19], v5, s[20:23], s43 offen offset:2048 sc1
buffer_load_dwordx4 a[20:23], v6, s[20:23], s43 offen offset:2048 sc1
buffer_load_dwordx4 a[24:27], v5, s[20:23], s43 offen offset:3072 sc1
buffer_load_dwordx4 a[28:31], v6, s[20:23], s43 offen offset:3072 sc1
s_add_u32 s43, s43, 4096
buffer_load_dwordx4 a[32:35], v5, s[20:23], s43 offen sc1
buffer_load_dwordx4 a[36:39], v6, s[20:23], s43 offen sc1
buffer_load_dwordx4 a[40:43], v5, s[20:23], s43 offen offset:1024 sc1
buffer_load_dwordx4 a[44:47], v6, s[20:23], s43 offen offset:1024 sc1
buffer_load_dwordx4 a[48:51], v5, s[20:23], s43 offen offset:2048 sc1
buffer_load_dwordx4 a[52:55], v6, s[20:23], s43 offen offset:2048 sc1
buffer_load_dwordx4 a[56:59], v5, s[20:23], s43 offen offset:3072 sc1
buffer_load_dwordx4 a[60:63], v6, s[20:23], s43 offen offset:3072 sc1
s_add_u32 s43, s43, 4096
s_waitcnt vmcnt(14)
v_mfma_f32_32x32x16_bf16 v[32:47], v[128:131], a[0:3], 0
v_mfma_f32_32x32x16_bf16 v[48:63], v[128:131], a[4:7], 0
v_mfma_f32_32x32x16_bf16 v[64:79], v[132:135], a[0:3], 0
v_mfma_f32_32x32x16_bf16 v[80:95], v[132:135], a[4:7], 0
s_add_u32 s43, s53, 1
s_and_b32 s43, s43, 7
s_lshl_b32 s43, s43, 13
s_add_u32 s43, s43, s59
buffer_load_dwordx4 a[0:3], v5, s[20:23], s43 offen sc1
buffer_load_dwordx4 a[4:7], v6, s[20:23], s43 offen sc1
s_waitcnt vmcnt(14)
v_mfma_f32_32x32x16_bf16 v[32:47], v[136:139], a[8:11], v[32:47]
v_mfma_f32_32x32x16_bf16 v[48:63], v[136:139], a[12:15], v[48:63]
v_mfma_f32_32x32x16_bf16 v[64:79], v[140:143], a[8:11], v[64:79]
v_mfma_f32_32x32x16_bf16 v[80:95], v[140:143], a[12:15], v[80:95]
buffer_load_dwordx4 a[8:11], v5, s[20:23], s43 offen offset:1024 sc1
buffer_load_dwordx4 a[12:15], v6, s[20:23], s43 offen offset:1024 sc1
s_waitcnt vmcnt(14)
v_mfma_f32_32x32x16_bf16 v[32:47], v[144:147], a[16:19], v[32:47]
v_mfma_f32_32x32x16_bf16 v[48:63], v[144:147], a[20:23], v[48:63]
v_mfma_f32_32x32x16_bf16 v[64:79], v[148:151], a[16:19], v[64:79]
v_mfma_f32_32x32x16_bf16 v[80:95], v[148:151], a[20:23], v[80:95]
buffer_load_dwordx4 a[16:19], v5, s[20:23], s43 offen offset:2048 sc1
buffer_load_dwordx4 a[20:23], v6, s[20:23], s43 offen offset:2048 sc1
s_waitcnt vmcnt(14)
v_mfma_f32_32x32x16_bf16 v[32:47], v[152:155], a[24:27], v[32:47]
v_mfma_f32_32x32x16_bf16 v[48:63], v[152:155], a[28:31], v[48:63]
v_mfma_f32_32x32x16_bf16 v[64:79], v[156:159], a[24:27], v[64:79]
v_mfma_f32_32x32x16_bf16 v[80:95], v[156:159], a[28:31], v[80:95]
buffer_load_dwordx4 a[24:27], v5, s[20:23], s43 offen offset:3072 sc1
buffer_load_dwordx4 a[28:31], v6, s[20:23], s43 offen offset:3072 sc1
s_add_u32 s43, s43, 4096
s_waitcnt vmcnt(14)
v_mfma_f32_32x32x16_bf16 v[32:47], v[160:163], a[32:35], v[32:47]
v_mfma_f32_32x32x16_bf16 v[48:63], v[160:163], a[36:39], v[48:63]
v_mfma_f32_32x32x16_bf16 v[64:79], v[164:167], a[32:35], v[64:79]
v_mfma_f32_32x32x16_bf16 v[80:95], v[164:167], a[36:39], v[80:95]
buffer_load_dwordx4 a[32:35], v5, s[20:23], s43 offen sc1
buffer_load_dwordx4 a[36:39], v6, s[20:23], s43 offen sc1
s_waitcnt vmcnt(14)
v_mfma_f32_32x32x16_bf16 v[32:47], v[168:171], a[40:43], v[32:47]
v_mfma_f32_32x32x16_bf16 v[48:63], v[168:171], a[44:47], v[48:63]
v_mfma_f32_32x32x16_bf16 v[64:79], v[172:175], a[40:43], v[64:79]
v_mfma_f32_32x32x16_bf16 v[80:95], v[172:175], a[44:47], v[80:95]
buffer_load_dwordx4 a[40:43], v5, s[20:23], s43 offen offset:1024 sc1
buffer_load_dwordx4 a[44:47], v6, s[20:23], s43 offen offset:1024 sc1
s_waitcnt vmcnt(14)
v_mfma_f32_32x32x16_bf16 v[32:47], v[176:179], a[48:51], v[32:47]
v_mfma_f32_32x32x16_bf16 v[48:63], v[176:179], a[52:55], v[48:63]
v_mfma_f32_32x32x16_bf16 v[64:79], v[180:183], a[48:51], v[64:79]
v_mfma_f32_32x32x16_bf16 v[80:95], v[180:183], a[52:55], v[80:95]
buffer_load_dwordx4 a[48:51], v5, s[20:23], s43 offen offset:2048 sc1
buffer_load_dwordx4 a[52:55], v6, s[20:23], s43 offen offset:2048 sc1
s_waitcnt vmcnt(14)
v_mfma_f32_32x32x16_bf16 v[32:47], v[184:187], a[56:59], v[32:47]
v_mfma_f32_32x32x16_bf16 v[48:63], v[184:187], a[60:63], v[48:63]
v_mfma_f32_32x32x16_bf16 v[64:79], v[188:191], a[56:59], v[64:79]
v_mfma_f32_32x32x16_bf16 v[80:95], v[188:191], a[60:63], v[80:95]
buffer_load_dwordx4 a[56:59], v5, s[20:23], s43 offen offset:3072 sc1
buffer_load_dwordx4 a[60:63], v6, s[20:23], s43 offen offset:3072 sc1
s_add_u32 s43, s43, 4096
s_waitcnt vmcnt(14)
v_mfma_f32_32x32x16_bf16 v[32:47], v[192:195], a[0:3], v[32:47]
v_mfma_f32_32x32x16_bf16 v[48:63], v[192:195], a[4:7], v[48:63]
v_mfma_f32_32x32x16_bf16 v[64:79], v[196:199], a[0:3], v[64:79]
v_mfma_f32_32x32x16_bf16 v[80:95], v[196:199], a[4:7], v[80:95]
s_add_u32 s43, s53, 2
s_and_b32 s43, s43, 7
s_lshl_b32 s43, s43, 13
s_add_u32 s43, s43, s59
buffer_load_dwordx4 a[0:3], v5, s[20:23], s43 offen sc1
buffer_load_dwordx4 a[4:7], v6, s[20:23], s43 offen sc1
s_waitcnt vmcnt(14)
v_mfma_f32_32x32x16_bf16 v[32:47], v[200:203], a[8:11], v[32:47]
v_mfma_f32_32x32x16_bf16 v[48:63], v[200:203], a[12:15], v[48:63]
v_mfma_f32_32x32x16_bf16 v[64:79], v[204:207], a[8:11], v[64:79]
v_mfma_f32_32x32x16_bf16 v[80:95], v[204:207], a[12:15], v[80:95]
buffer_load_dwordx4 a[8:11], v5, s[20:23], s43 offen offset:1024 sc1
buffer_load_dwordx4 a[12:15], v6, s[20:23], s43 offen offset:1024 sc1
s_waitcnt vmcnt(14)
v_mfma_f32_32x32x16_bf16 v[32:47], v[208:211], a[16:19], v[32:47]
v_mfma_f32_32x32x16_bf16 v[48:63], v[208:211], a[20:23], v[48:63]
v_mfma_f32_32x32x16_bf16 v[64:79], v[212:215], a[16:19], v[64:79]
v_mfma_f32_32x32x16_bf16 v[80:95], v[212:215], a[20:23], v[80:95]
buffer_load_dwordx4 a[16:19], v5, s[20:23], s43 offen offset:2048 sc1
buffer_load_dwordx4 a[20:23], v6, s[20:23], s43 offen offset:2048 sc1
s_waitcnt vmcnt(14)
v_mfma_f32_32x32x16_bf16 v[32:47], v[216:219], a[24:27], v[32:47]
v_mfma_f32_32x32x16_bf16 v[48:63], v[216:219], a[28:31], v[48:63]
v_mfma_f32_32x32x16_bf16 v[64:79], v[220:223], a[24:27], v[64:79]
v_mfma_f32_32x32x16_bf16 v[80:95], v[220:223], a[28:31], v[80:95]
buffer_load_dwordx4 a[24:27], v5, s[20:23], s43 offen offset:3072 sc1
buffer_load_dwordx4 a[28:31], v6, s[20:23], s43 offen offset:3072 sc1
s_add_u32 s43, s43, 4096
s_waitcnt vmcnt(14)
v_mfma_f32_32x32x16_bf16 v[32:47], v[224:227], a[32:35], v[32:47]
v_mfma_f32_32x32x16_bf16 v[48:63], v[224:227], a[36:39], v[48:63]
v_mfma_f32_32x32x16_bf16 v[64:79], v[228:231], a[32:35], v[64:79]
v_mfma_f32_32x32x16_bf16 v[80:95], v[228:231], a[36:39], v[80:95]
buffer_load_dwordx4 a[32:35], v5, s[20:23], s43 offen sc1
buffer_load_dwordx4 a[36:39], v6, s[20:23], s43 offen sc1
s_waitcnt vmcnt(14)
v_mfma_f32_32x32x16_bf16 v[32:47], v[232:235], a[40:43], v[32:47]
v_mfma_f32_32x32x16_bf16 v[48:63], v[232:235], a[44:47], v[48:63]
v_mfma_f32_32x32x16_bf16 v[64:79], v[236:239], a[40:43], v[64:79]
v_mfma_f32_32x32x16_bf16 v[80:95], v[236:239], a[44:47], v[80:95]
buffer_load_dwordx4 a[40:43], v5, s[20:23], s43 offen offset:1024 sc1
buffer_load_dwordx4 a[44:47], v6, s[20:23], s43 offen offset:1024 sc1
s_waitcnt vmcnt(14)
v_mfma_f32_32x32x16_bf16 v[32:47], v[240:243], a[48:51], v[32:47]
v_mfma_f32_32x32x16_bf16 v[48:63], v[240:243], a[52:55], v[48:63]
v_mfma_f32_32x32x16_bf16 v[64:79], v[244:247], a[48:51], v[64:79]
v_mfma_f32_32x32x16_bf16 v[80:95], v[244:247], a[52:55], v[80:95]
buffer_load_dwordx4 a[48:51], v5, s[20:23], s43 offen offset:2048 sc1
buffer_load_dwordx4 a[52:55], v6, s[20:23], s43 offen offset:2048 sc1
s_waitcnt vmcnt(14)
v_mfma_f32_32x32x16_bf16 v[32:47], v[248:251], a[56:59], v[32:47]
v_mfma_f32_32x32x16_bf16 v[48:63], v[248:251], a[60:63], v[48:63]
v_mfma_f32_32x32x16_bf16 v[64:79], v[252:255], a[56:59], v[64:79]
v_mfma_f32_32x32x16_bf16 v[80:95], v[252:255], a[60:63], v[80:95]
buffer_load_dwordx4 a[56:59], v5, s[20:23], s43 offen offset:3072 sc1
buffer_load_dwordx4 a[60:63], v6, s[20:23], s43 offen offset:3072 sc1
s_add_u32 s43, s43, 4096
s_waitcnt vmcnt(14)
v_mfma_f32_32x32x16_bf16 v[32:47], a[64:67], a[0:3], v[32:47]
v_mfma_f32_32x32x16_bf16 v[48:63], a[64:67], a[4:7], v[48:63]
v_mfma_f32_32x32x16_bf16 v[64:79], a[68:71], a[0:3], v[64:79]
v_mfma_f32_32x32x16_bf16 v[80:95], a[68:71], a[4:7], v[80:95]
s_add_u32 s43, s53, 3
s_and_b32 s43, s43, 7
s_lshl_b32 s43, s43, 13
s_add_u32 s43, s43, s59
buffer_load_dwordx4 a[0:3], v5, s[20:23], s43 offen sc1
buffer_load_dwordx4 a[4:7], v6, s[20:23], s43 offen sc1
s_waitcnt vmcnt(14)
v_mfma_f32_32x32x16_bf16 v[32:47], a[72:75], a[8:11], v[32:47]
v_mfma_f32_32x32x16_bf16 v[48:63], a[72:75], a[12:15], v[48:63]
v_mfma_f32_32x32x16_bf16 v[64:79], a[76:79], a[8:11], v[64:79]
v_mfma_f32_32x32x16_bf16 v[80:95], a[76:79], a[12:15], v[80:95]
buffer_load_dwordx4 a[8:11], v5, s[20:23], s43 offen offset:1024 sc1
buffer_load_dwordx4 a[12:15], v6, s[20:23], s43 offen offset:1024 sc1
s_waitcnt vmcnt(14)
v_mfma_f32_32x32x16_bf16 v[32:47], a[80:83], a[16:19], v[32:47]
v_mfma_f32_32x32x16_bf16 v[48:63], a[80:83], a[20:23], v[48:63]
v_mfma_f32_32x32x16_bf16 v[64:79], a[84:87], a[16:19], v[64:79]
v_mfma_f32_32x32x16_bf16 v[80:95], a[84:87], a[20:23], v[80:95]
buffer_load_dwordx4 a[16:19], v5, s[20:23], s43 offen offset:2048 sc1
buffer_load_dwordx4 a[20:23], v6, s[20:23], s43 offen offset:2048 sc1
s_waitcnt vmcnt(14)
v_mfma_f32_32x32x16_bf16 v[32:47], a[88:91], a[24:27], v[32:47]
v_mfma_f32_32x32x16_bf16 v[48:63], a[88:91], a[28:31], v[48:63]
v_mfma_f32_32x32x16_bf16 v[64:79], a[92:95], a[24:27], v[64:79]
v_mfma_f32_32x32x16_bf16 v[80:95], a[92:95], a[28:31], v[80:95]
buffer_load_dwordx4 a[24:27], v5, s[20:23], s43 offen offset:3072 sc1
buffer_load_dwordx4 a[28:31], v6, s[20:23], s43 offen offset:3072 sc1
s_add_u32 s43, s43, 4096
s_waitcnt vmcnt(14)
v_mfma_f32_32x32x16_bf16 v[32:47], a[96:99], a[32:35], v[32:47]
v_mfma_f32_32x32x16_bf16 v[48:63], a[96:99], a[36:39], v[48:63]
v_mfma_f32_32x32x16_bf16 v[64:79], a[100:103], a[32:35], v[64:79]
v_mfma_f32_32x32x16_bf16 v[80:95], a[100:103], a[36:39], v[80:95]
buffer_load_dwordx4 a[32:35], v5, s[20:23], s43 offen sc1
buffer_load_dwordx4 a[36:39], v6, s[20:23], s43 offen sc1
s_waitcnt vmcnt(14)
v_mfma_f32_32x32x16_bf16 v[32:47], a[104:107], a[40:43], v[32:47]
v_mfma_f32_32x32x16_bf16 v[48:63], a[104:107], a[44:47], v[48:63]
v_mfma_f32_32x32x16_bf16 v[64:79], a[108:111], a[40:43], v[64:79]
v_mfma_f32_32x32x16_bf16 v[80:95], a[108:111], a[44:47], v[80:95]
buffer_load_dwordx4 a[40:43], v5, s[20:23], s43 offen offset:1024 sc1
buffer_load_dwordx4 a[44:47], v6, s[20:23], s43 offen offset:1024 sc1
s_waitcnt vmcnt(14)
v_mfma_f32_32x32x16_bf16 v[32:47], a[112:115], a[48:51], v[32:47]
v_mfma_f32_32x32x16_bf16 v[48:63], a[112:115], a[52:55], v[48:63]
v_mfma_f32_32x32x16_bf16 v[64:79], a[116:119], a[48:51], v[64:79]
v_mfma_f32_32x32x16_bf16 v[80:95], a[116:119], a[52:55], v[80:95]
buffer_load_dwordx4 a[48:51], v5, s[20:23], s43 offen offset:2048 sc1
buffer_load_dwordx4 a[52:55], v6, s[20:23], s43 offen offset:2048 sc1
s_waitcnt vmcnt(14)
v_mfma_f32_32x32x16_bf16 v[32:47], a[120:123], a[56:59], v[32:47]
v_mfma_f32_32x32x16_bf16 v[48:63], a[120:123], a[60:63], v[48:63]
v_mfma_f32_32x32x16_bf16 v[64:79], a[124:127], a[56:59], v[64:79]
v_mfma_f32_32x32x16_bf16 v[80:95], a[124:127], a[60:63], v[80:95]
buffer_load_dwordx4 a[56:59], v5, s[20:23], s43 offen offset:3072 sc1
buffer_load_dwordx4 a[60:63], v6, s[20:23], s43 offen offset:3072 sc1
s_add_u32 s43, s43, 4096
s_waitcnt vmcnt(14)
v_mfma_f32_32x32x16_bf16 v[32:47], a[128:131], a[0:3], v[32:47]
v_mfma_f32_32x32x16_bf16 v[48:63], a[128:131], a[4:7], v[48:63]
v_mfma_f32_32x32x16_bf16 v[64:79], a[132:135], a[0:3], v[64:79]
v_mfma_f32_32x32x16_bf16 v[80:95], a[132:135], a[4:7], v[80:95]
s_add_u32 s43, s53, 4
s_and_b32 s43, s43, 7
s_lshl_b32 s43, s43, 13
s_add_u32 s43, s43, s59
buffer_load_dwordx4 a[0:3], v5, s[20:23], s43 offen sc1
buffer_load_dwordx4 a[4:7], v6, s[20:23], s43 offen sc1
s_waitcnt vmcnt(14)
v_mfma_f32_32x32x16_bf16 v[32:47], a[136:139], a[8:11], v[32:47]
v_mfma_f32_32x32x16_bf16 v[48:63], a[136:139], a[12:15], v[48:63]
v_mfma_f32_32x32x16_bf16 v[64:79], a[140:143], a[8:11], v[64:79]
v_mfma_f32_32x32x16_bf16 v[80:95], a[140:143], a[12:15], v[80:95]
buffer_load_dwordx4 a[8:11], v5, s[20:23], s43 offen offset:1024 sc1
buffer_load_dwordx4 a[12:15], v6, s[20:23], s43 offen offset:1024 sc1
s_waitcnt vmcnt(14)
v_mfma_f32_32x32x16_bf16 v[32:47], a[144:147], a[16:19], v[32:47]
v_mfma_f32_32x32x16_bf16 v[48:63], a[144:147], a[20:23], v[48:63]
v_mfma_f32_32x32x16_bf16 v[64:79], a[148:151], a[16:19], v[64:79]
v_mfma_f32_32x32x16_bf16 v[80:95], a[148:151], a[20:23], v[80:95]
buffer_load_dwordx4 a[16:19], v5, s[20:23], s43 offen offset:2048 sc1
buffer_load_dwordx4 a[20:23], v6, s[20:23], s43 offen offset:2048 sc1
s_waitcnt vmcnt(14)
v_mfma_f32_32x32x16_bf16 v[32:47], a[152:155], a[24:27], v[32:47]
v_mfma_f32_32x32x16_bf16 v[48:63], a[152:155], a[28:31], v[48:63]
v_mfma_f32_32x32x16_bf16 v[64:79], a[156:159], a[24:27], v[64:79]
v_mfma_f32_32x32x16_bf16 v[80:95], a[156:159], a[28:31], v[80:95]
buffer_load_dwordx4 a[24:27], v5, s[20:23], s43 offen offset:3072 sc1
buffer_load_dwordx4 a[28:31], v6, s[20:23], s43 offen offset:3072 sc1
s_add_u32 s43, s43, 4096
s_waitcnt vmcnt(14)
v_mfma_f32_32x32x16_bf16 v[32:47], a[160:163], a[32:35], v[32:47]
v_mfma_f32_32x32x16_bf16 v[48:63], a[160:163], a[36:39], v[48:63]
v_mfma_f32_32x32x16_bf16 v[64:79], a[164:167], a[32:35], v[64:79]
v_mfma_f32_32x32x16_bf16 v[80:95], a[164:167], a[36:39], v[80:95]
buffer_load_dwordx4 a[32:35], v5, s[20:23], s43 offen sc1
buffer_load_dwordx4 a[36:39], v6, s[20:23], s43 offen sc1
s_waitcnt vmcnt(14)
v_mfma_f32_32x32x16_bf16 v[32:47], a[168:171], a[40:43], v[32:47]
v_mfma_f32_32x32x16_bf16 v[48:63], a[168:171], a[44:47], v[48:63]
v_mfma_f32_32x32x16_bf16 v[64:79], a[172:175], a[40:43], v[64:79]
v_mfma_f32_32x32x16_bf16 v[80:95], a[172:175], a[44:47], v[80:95]
buffer_load_dwordx4 a[40:43], v5, s[20:23], s43 offen offset:1024 sc1
buffer_load_dwordx4 a[44:47], v6, s[20:23], s43 offen offset:1024 sc1
s_waitcnt vmcnt(14)
v_mfma_f32_32x32x16_bf16 v[32:47], a[176:179], a[48:51], v[32:47]
v_mfma_f32_32x32x16_bf16 v[48:63], a[176:179], a[52:55], v[48:63]
v_mfma_f32_32x32x16_bf16 v[64:79], a[180:183], a[48:51], v[64:79]
v_mfma_f32_32x32x16_bf16 v[80:95], a[180:183], a[52:55], v[80:95]
buffer_load_dwordx4 a[48:51], v5, s[20:23], s43 offen offset:2048 sc1
buffer_load_dwordx4 a[52:55], v6, s[20:23], s43 offen offset:2048 sc1
s_waitcnt vmcnt(14)
v_mfma_f32_32x32x16_bf16 v[32:47], a[184:187], a[56:59], v[32:47]
v_mfma_f32_32x32x16_bf16 v[48:63], a[184:187], a[60:63], v[48:63]
v_mfma_f32_32x32x16_bf16 v[64:79], a[188:191], a[56:59], v[64:79]
v_mfma_f32_32x32x16_bf16 v[80:95], a[188:191], a[60:63], v[80:95]
buffer_load_dwordx4 a[56:59], v5, s[20:23], s43 offen offset:3072 sc1
buffer_load_dwordx4 a[60:63], v6, s[20:23], s43 offen offset:3072 sc1
s_add_u32 s43, s43, 4096
s_waitcnt vmcnt(14)
v_mfma_f32_32x32x16_bf16 v[32:47], a[192:195], a[0:3], v[32:47]
v_mfma_f32_32x32x16_bf16 v[48:63], a[192:195], a[4:7], v[48:63]
v_mfma_f32_32x32x16_bf16 v[64:79], a[196:199], a[0:3], v[64:79]
v_mfma_f32_32x32x16_bf16 v[80:95], a[196:199], a[4:7], v[80:95]
s_add_u32 s43, s53, 5
s_and_b32 s43, s43, 7
s_lshl_b32 s43, s43, 13
s_add_u32 s43, s43, s59
buffer_load_dwordx4 a[0:3], v5, s[20:23], s43 offen sc1
buffer_load_dwordx4 a[4:7], v6, s[20:23], s43 offen sc1
s_waitcnt vmcnt(14)
v_mfma_f32_32x32x16_bf16 v[32:47], a[200:203], a[8:11], v[32:47]
v_mfma_f32_32x32x16_bf16 v[48:63], a[200:203], a[12:15], v[48:63]
v_mfma_f32_32x32x16_bf16 v[64:79], a[204:207], a[8:11], v[64:79]
v_mfma_f32_32x32x16_bf16 v[80:95], a[204:207], a[12:15], v[80:95]
buffer_load_dwordx4 a[8:11], v5, s[20:23], s43 offen offset:1024 sc1
buffer_load_dwordx4 a[12:15], v6, s[20:23], s43 offen offset:1024 sc1
s_waitcnt vmcnt(14)
v_mfma_f32_32x32x16_bf16 v[32:47], a[208:211], a[16:19], v[32:47]
v_mfma_f32_32x32x16_bf16 v[48:63], a[208:211], a[20:23], v[48:63]
v_mfma_f32_32x32x16_bf16 v[64:79], a[212:215], a[16:19], v[64:79]
v_mfma_f32_32x32x16_bf16 v[80:95], a[212:215], a[20:23], v[80:95]
buffer_load_dwordx4 a[16:19], v5, s[20:23], s43 offen offset:2048 sc1
buffer_load_dwordx4 a[20:23], v6, s[20:23], s43 offen offset:2048 sc1
s_waitcnt vmcnt(14)
v_mfma_f32_32x32x16_bf16 v[32:47], a[216:219], a[24:27], v[32:47]
v_mfma_f32_32x32x16_bf16 v[48:63], a[216:219], a[28:31], v[48:63]
v_mfma_f32_32x32x16_bf16 v[64:79], a[220:223], a[24:27], v[64:79]
v_mfma_f32_32x32x16_bf16 v[80:95], a[220:223], a[28:31], v[80:95]
buffer_load_dwordx4 a[24:27], v5, s[20:23], s43 offen offset:3072 sc1
buffer_load_dwordx4 a[28:31], v6, s[20:23], s43 offen offset:3072 sc1
s_add_u32 s43, s43, 4096
s_waitcnt vmcnt(14)
v_mfma_f32_32x32x16_bf16 v[32:47], a[224:227], a[32:35], v[32:47]
v_mfma_f32_32x32x16_bf16 v[48:63], a[224:227], a[36:39], v[48:63]
v_mfma_f32_32x32x16_bf16 v[64:79], a[228:231], a[32:35], v[64:79]
v_mfma_f32_32x32x16_bf16 v[80:95], a[228:231], a[36:39], v[80:95]
buffer_load_dwordx4 a[32:35], v5, s[20:23], s43 offen sc1
buffer_load_dwordx4 a[36:39], v6, s[20:23], s43 offen sc1
s_waitcnt vmcnt(14)
v_mfma_f32_32x32x16_bf16 v[32:47], a[232:235], a[40:43], v[32:47]
v_mfma_f32_32x32x16_bf16 v[48:63], a[232:235], a[44:47], v[48:63]
v_mfma_f32_32x32x16_bf16 v[64:79], a[236:239], a[40:43], v[64:79]
v_mfma_f32_32x32x16_bf16 v[80:95], a[236:239], a[44:47], v[80:95]
buffer_load_dwordx4 a[40:43], v5, s[20:23], s43 offen offset:1024 sc1
buffer_load_dwordx4 a[44:47], v6, s[20:23], s43 offen offset:1024 sc1
s_waitcnt vmcnt(14)
ds_read_b64_tr_b16 v[96:97], v3
ds_read_b64_tr_b16 v[98:99], v3 offset:1024
ds_read_b64_tr_b16 v[100:101], v28
ds_read_b64_tr_b16 v[102:103], v28 offset:1024
v_mfma_f32_32x32x16_bf16 v[32:47], a[240:243], a[48:51], v[32:47]
v_mfma_f32_32x32x16_bf16 v[48:63], a[240:243], a[52:55], v[48:63]
v_mfma_f32_32x32x16_bf16 v[64:79], a[244:247], a[48:51], v[64:79]
v_mfma_f32_32x32x16_bf16 v[80:95], a[244:247], a[52:55], v[80:95]
buffer_load_dwordx4 a[48:51], v5, s[20:23], s43 offen offset:2048 sc1
buffer_load_dwordx4 a[52:55], v6, s[20:23], s43 offen offset:2048 sc1
s_waitcnt vmcnt(14)
ds_read_b64_tr_b16 v[104:105], v3 offset:2048
ds_read_b64_tr_b16 v[106:107], v3 offset:3072
ds_read_b64_tr_b16 v[108:109], v28 offset:2048
ds_read_b64_tr_b16 v[110:111], v28 offset:3072
v_mfma_f32_32x32x16_bf16 v[32:47], a[248:251], a[56:59], v[32:47]
v_mfma_f32_32x32x16_bf16 v[48:63], a[248:251], a[60:63], v[48:63]
v_mfma_f32_32x32x16_bf16 v[64:79], a[252:255], a[56:59], v[64:79]
v_mfma_f32_32x32x16_bf16 v[80:95], a[252:255], a[60:63], v[80:95]
buffer_load_dwordx4 a[56:59], v5, s[20:23], s43 offen offset:3072 sc1
buffer_load_dwordx4 a[60:63], v6, s[20:23], s43 offen offset:3072 sc1
s_add_u32 s43, s43, 4096
s_waitcnt vmcnt(14)
ds_read_b64_tr_b16 v[112:113], v3 offset:4096
ds_read_b64_tr_b16 v[114:115], v3 offset:5120
ds_read_b64_tr_b16 v[116:117], v28 offset:4096
ds_read_b64_tr_b16 v[118:119], v28 offset:5120
s_waitcnt lgkmcnt(8)
v_mfma_f32_32x32x16_bf16 v[32:47], v[96:99], a[0:3], v[32:47]
v_mfma_f32_32x32x16_bf16 v[48:63], v[96:99], a[4:7], v[48:63]
v_mfma_f32_32x32x16_bf16 v[64:79], v[100:103], a[0:3], v[64:79]
v_mfma_f32_32x32x16_bf16 v[80:95], v[100:103], a[4:7], v[80:95]
s_add_u32 m0, s86, 0
s_nop 0
buffer_load_dwordx4 v0, s[32:35], s42 offen lds
buffer_load_dwordx4 v1, s[32:35], s42 offen offset:1024 lds
s_add_u32 s42, s42, 14336
s_add_u32 s43, s53, 6
s_and_b32 s43, s43, 7
s_lshl_b32 s43, s43, 13
s_add_u32 s43, s43, s59
buffer_load_dwordx4 a[0:3], v5, s[20:23], s43 offen sc1
buffer_load_dwordx4 a[4:7], v6, s[20:23], s43 offen sc1
s_waitcnt vmcnt(16)
ds_read_b64_tr_b16 v[120:121], v3 offset:6144
ds_read_b64_tr_b16 v[122:123], v3 offset:7168
ds_read_b64_tr_b16 v[124:125], v28 offset:6144
ds_read_b64_tr_b16 v[126:127], v28 offset:7168
s_waitcnt lgkmcnt(8)
v_mfma_f32_32x32x16_bf16 v[32:47], v[104:107], a[8:11], v[32:47]
v_mfma_f32_32x32x16_bf16 v[48:63], v[104:107], a[12:15], v[48:63]
v_mfma_f32_32x32x16_bf16 v[64:79], v[108:111], a[8:11], v[64:79]
v_mfma_f32_32x32x16_bf16 v[80:95], v[108:111], a[12:15], v[80:95]
s_add_u32 m0, s86, 2048
s_nop 0
s_nop 0
buffer_load_dwordx4 v0, s[32:35], s42 offen lds
buffer_load_dwordx4 v1, s[32:35], s42 offen offset:1024 lds
s_add_u32 s42, s42, 14336
buffer_load_dwordx4 a[8:11], v5, s[20:23], s43 offen offset:1024 sc1
buffer_load_dwordx4 a[12:15], v6, s[20:23], s43 offen offset:1024 sc1
s_waitcnt vmcnt(18)
ds_read_b64_tr_b16 v[96:97], v3 offset:8192
ds_read_b64_tr_b16 v[98:99], v3 offset:9216
ds_read_b64_tr_b16 v[100:101], v28 offset:8192
ds_read_b64_tr_b16 v[102:103], v28 offset:9216
s_waitcnt lgkmcnt(8)
v_mfma_f32_32x32x16_bf16 v[32:47], v[112:115], a[16:19], v[32:47]
v_mfma_f32_32x32x16_bf16 v[48:63], v[112:115], a[20:23], v[48:63]
v_mfma_f32_32x32x16_bf16 v[64:79], v[116:119], a[16:19], v[64:79]
v_mfma_f32_32x32x16_bf16 v[80:95], v[116:119], a[20:23], v[80:95]
s_add_u32 m0, s86, 4096
s_nop 0
s_nop 0
buffer_load_dwordx4 v0, s[32:35], s42 offen lds
buffer_load_dwordx4 v1, s[32:35], s42 offen offset:1024 lds
s_add_u32 s42, s42, 14336
buffer_load_dwordx4 a[16:19], v5, s[20:23], s43 offen offset:2048 sc1
buffer_load_dwordx4 a[20:23], v6, s[20:23], s43 offen offset:2048 sc1
s_waitcnt vmcnt(20)
ds_read_b64_tr_b16 v[104:105], v3 offset:10240
ds_read_b64_tr_b16 v[106:107], v3 offset:11264
ds_read_b64_tr_b16 v[108:109], v28 offset:10240
ds_read_b64_tr_b16 v[110:111], v28 offset:11264
s_waitcnt lgkmcnt(8)
v_mfma_f32_32x32x16_bf16 v[32:47], v[120:123], a[24:27], v[32:47]
v_mfma_f32_32x32x16_bf16 v[48:63], v[120:123], a[28:31], v[48:63]
v_mfma_f32_32x32x16_bf16 v[64:79], v[124:127], a[24:27], v[64:79]
v_mfma_f32_32x32x16_bf16 v[80:95], v[124:127], a[28:31], v[80:95]
s_add_u32 m0, s86, 6144
s_nop 0
s_nop 0
buffer_load_dwordx4 v0, s[32:35], s42 offen lds
buffer_load_dwordx4 v1, s[32:35], s42 offen offset:1024 lds
s_add_u32 s42, s42, 14336
buffer_load_dwordx4 a[24:27], v5, s[20:23], s43 offen offset:3072 sc1
buffer_load_dwordx4 a[28:31], v6, s[20:23], s43 offen offset:3072 sc1
s_add_u32 s43, s43, 4096
s_waitcnt vmcnt(22)
ds_read_b64_tr_b16 v[112:113], v3 offset:12288
ds_read_b64_tr_b16 v[114:115], v3 offset:13312
ds_read_b64_tr_b16 v[116:117], v28 offset:12288
ds_read_b64_tr_b16 v[118:119], v28 offset:13312
s_waitcnt lgkmcnt(8)
v_mfma_f32_32x32x16_bf16 v[32:47], v[96:99], a[32:35], v[32:47]
v_mfma_f32_32x32x16_bf16 v[48:63], v[96:99], a[36:39], v[48:63]
v_mfma_f32_32x32x16_bf16 v[64:79], v[100:103], a[32:35], v[64:79]
v_mfma_f32_32x32x16_bf16 v[80:95], v[100:103], a[36:39], v[80:95]
buffer_load_dwordx4 a[32:35], v5, s[20:23], s43 offen sc1
buffer_load_dwordx4 a[36:39], v6, s[20:23], s43 offen sc1
s_waitcnt vmcnt(22)
ds_read_b64_tr_b16 v[120:121], v3 offset:14336
ds_read_b64_tr_b16 v[122:123], v3 offset:15360
ds_read_b64_tr_b16 v[124:125], v28 offset:14336
ds_read_b64_tr_b16 v[126:127], v28 offset:15360
s_waitcnt lgkmcnt(8)
v_mfma_f32_32x32x16_bf16 v[32:47], v[104:107], a[40:43], v[32:47]
v_mfma_f32_32x32x16_bf16 v[48:63], v[104:107], a[44:47], v[48:63]
v_mfma_f32_32x32x16_bf16 v[64:79], v[108:111], a[40:43], v[64:79]
v_mfma_f32_32x32x16_bf16 v[80:95], v[108:111], a[44:47], v[80:95]
buffer_load_dwordx4 a[40:43], v5, s[20:23], s43 offen offset:1024 sc1
buffer_load_dwordx4 a[44:47], v6, s[20:23], s43 offen offset:1024 sc1
s_waitcnt vmcnt(22)
ds_read_b64_tr_b16 v[96:97], v3 offset:16384
ds_read_b64_tr_b16 v[98:99], v3 offset:17408
ds_read_b64_tr_b16 v[100:101], v28 offset:16384
ds_read_b64_tr_b16 v[102:103], v28 offset:17408
s_waitcnt lgkmcnt(8)
v_mfma_f32_32x32x16_bf16 v[32:47], v[112:115], a[48:51], v[32:47]
v_mfma_f32_32x32x16_bf16 v[48:63], v[112:115], a[52:55], v[48:63]
v_mfma_f32_32x32x16_bf16 v[64:79], v[116:119], a[48:51], v[64:79]
v_mfma_f32_32x32x16_bf16 v[80:95], v[116:119], a[52:55], v[80:95]
buffer_load_dwordx4 a[48:51], v5, s[20:23], s43 offen offset:2048 sc1
buffer_load_dwordx4 a[52:55], v6, s[20:23], s43 offen offset:2048 sc1
s_waitcnt vmcnt(22)
ds_read_b64_tr_b16 v[104:105], v3 offset:18432
ds_read_b64_tr_b16 v[106:107], v3 offset:19456
ds_read_b64_tr_b16 v[108:109], v28 offset:18432
ds_read_b64_tr_b16 v[110:111], v28 offset:19456
s_waitcnt lgkmcnt(8)
v_mfma_f32_32x32x16_bf16 v[32:47], v[120:123], a[56:59], v[32:47]
v_mfma_f32_32x32x16_bf16 v[48:63], v[120:123], a[60:63], v[48:63]
v_mfma_f32_32x32x16_bf16 v[64:79], v[124:127], a[56:59], v[64:79]
v_mfma_f32_32x32x16_bf16 v[80:95], v[124:127], a[60:63], v[80:95]
buffer_load_dwordx4 a[56:59], v5, s[20:23], s43 offen offset:3072 sc1
buffer_load_dwordx4 a[60:63], v6, s[20:23], s43 offen offset:3072 sc1
s_add_u32 s43, s43, 4096
s_waitcnt vmcnt(20)
ds_read_b64_tr_b16 v[112:113], v3 offset:20480
ds_read_b64_tr_b16 v[114:115], v3 offset:21504
ds_read_b64_tr_b16 v[116:117], v28 offset:20480
ds_read_b64_tr_b16 v[118:119], v28 offset:21504
s_waitcnt lgkmcnt(8)
v_mfma_f32_32x32x16_bf16 v[32:47], v[96:99], a[0:3], v[32:47]
v_mfma_f32_32x32x16_bf16 v[48:63], v[96:99], a[4:7], v[48:63]
v_mfma_f32_32x32x16_bf16 v[64:79], v[100:103], a[0:3], v[64:79]
v_mfma_f32_32x32x16_bf16 v[80:95], v[100:103], a[4:7], v[80:95]
s_add_u32 s43, s53, 7
s_and_b32 s43, s43, 7
s_lshl_b32 s43, s43, 13
s_add_u32 s43, s43, s59
buffer_load_dwordx4 a[0:3], v5, s[20:23], s43 offen sc1
buffer_load_dwordx4 a[4:7], v6, s[20:23], s43 offen sc1
s_waitcnt vmcnt(18)
ds_read_b64_tr_b16 v[120:121], v3 offset:22528
ds_read_b64_tr_b16 v[122:123], v3 offset:23552
ds_read_b64_tr_b16 v[124:125], v28 offset:22528
ds_read_b64_tr_b16 v[126:127], v28 offset:23552
s_waitcnt lgkmcnt(8)
v_mfma_f32_32x32x16_bf16 v[32:47], v[104:107], a[8:11], v[32:47]
v_mfma_f32_32x32x16_bf16 v[48:63], v[104:107], a[12:15], v[48:63]
v_mfma_f32_32x32x16_bf16 v[64:79], v[108:111], a[8:11], v[64:79]
v_mfma_f32_32x32x16_bf16 v[80:95], v[108:111], a[12:15], v[80:95]
buffer_load_dwordx4 a[8:11], v5, s[20:23], s43 offen offset:1024 sc1
buffer_load_dwordx4 a[12:15], v6, s[20:23], s43 offen offset:1024 sc1
s_waitcnt vmcnt(16)
ds_read_b64_tr_b16 v[96:97], v3 offset:24576
ds_read_b64_tr_b16 v[98:99], v3 offset:25600
ds_read_b64_tr_b16 v[100:101], v28 offset:24576
ds_read_b64_tr_b16 v[102:103], v28 offset:25600
s_waitcnt lgkmcnt(8)
v_mfma_f32_32x32x16_bf16 v[32:47], v[112:115], a[16:19], v[32:47]
v_mfma_f32_32x32x16_bf16 v[48:63], v[112:115], a[20:23], v[48:63]
v_mfma_f32_32x32x16_bf16 v[64:79], v[116:119], a[16:19], v[64:79]
v_mfma_f32_32x32x16_bf16 v[80:95], v[116:119], a[20:23], v[80:95]
buffer_load_dwordx4 a[16:19], v5, s[20:23], s43 offen offset:2048 sc1
buffer_load_dwordx4 a[20:23], v6, s[20:23], s43 offen offset:2048 sc1
s_waitcnt vmcnt(14)
ds_read_b64_tr_b16 v[104:105], v3 offset:26624
ds_read_b64_tr_b16 v[106:107], v3 offset:27648
ds_read_b64_tr_b16 v[108:109], v28 offset:26624
ds_read_b64_tr_b16 v[110:111], v28 offset:27648
s_waitcnt lgkmcnt(8)
v_mfma_f32_32x32x16_bf16 v[32:47], v[120:123], a[24:27], v[32:47]
v_mfma_f32_32x32x16_bf16 v[48:63], v[120:123], a[28:31], v[48:63]
v_mfma_f32_32x32x16_bf16 v[64:79], v[124:127], a[24:27], v[64:79]
v_mfma_f32_32x32x16_bf16 v[80:95], v[124:127], a[28:31], v[80:95]
buffer_load_dwordx4 a[24:27], v5, s[20:23], s43 offen offset:3072 sc1
buffer_load_dwordx4 a[28:31], v6, s[20:23], s43 offen offset:3072 sc1
s_add_u32 s43, s43, 4096
s_waitcnt vmcnt(14)
ds_read_b64_tr_b16 v[112:113], v3 offset:28672
ds_read_b64_tr_b16 v[114:115], v3 offset:29696
ds_read_b64_tr_b16 v[116:117], v28 offset:28672
ds_read_b64_tr_b16 v[118:119], v28 offset:29696
s_waitcnt lgkmcnt(8)
v_mfma_f32_32x32x16_bf16 v[32:47], v[96:99], a[32:35], v[32:47]
v_mfma_f32_32x32x16_bf16 v[48:63], v[96:99], a[36:39], v[48:63]
v_mfma_f32_32x32x16_bf16 v[64:79], v[100:103], a[32:35], v[64:79]
v_mfma_f32_32x32x16_bf16 v[80:95], v[100:103], a[36:39], v[80:95]
buffer_load_dwordx4 a[32:35], v5, s[20:23], s43 offen sc1
buffer_load_dwordx4 a[36:39], v6, s[20:23], s43 offen sc1
s_waitcnt vmcnt(14)
ds_read_b64_tr_b16 v[120:121], v3 offset:30720
ds_read_b64_tr_b16 v[122:123], v3 offset:31744
ds_read_b64_tr_b16 v[124:125], v28 offset:30720
ds_read_b64_tr_b16 v[126:127], v28 offset:31744
s_waitcnt lgkmcnt(8)
v_mfma_f32_32x32x16_bf16 v[32:47], v[104:107], a[40:43], v[32:47]
v_mfma_f32_32x32x16_bf16 v[48:63], v[104:107], a[44:47], v[48:63]
v_mfma_f32_32x32x16_bf16 v[64:79], v[108:111], a[40:43], v[64:79]
v_mfma_f32_32x32x16_bf16 v[80:95], v[108:111], a[44:47], v[80:95]
buffer_load_dwordx4 a[40:43], v5, s[20:23], s43 offen offset:1024 sc1
buffer_load_dwordx4 a[44:47], v6, s[20:23], s43 offen offset:1024 sc1
s_waitcnt vmcnt(14)
ds_read_b64_tr_b16 v[96:97], v3 offset:32768
ds_read_b64_tr_b16 v[98:99], v3 offset:33792
ds_read_b64_tr_b16 v[100:101], v28 offset:32768
ds_read_b64_tr_b16 v[102:103], v28 offset:33792
s_waitcnt lgkmcnt(8)
v_mfma_f32_32x32x16_bf16 v[32:47], v[112:115], a[48:51], v[32:47]
v_mfma_f32_32x32x16_bf16 v[48:63], v[112:115], a[52:55], v[48:63]
v_mfma_f32_32x32x16_bf16 v[64:79], v[116:119], a[48:51], v[64:79]
v_mfma_f32_32x32x16_bf16 v[80:95], v[116:119], a[52:55], v[80:95]
buffer_load_dwordx4 a[48:51], v5, s[20:23], s43 offen offset:2048 sc1
buffer_load_dwordx4 a[52:55], v6, s[20:23], s43 offen offset:2048 sc1
s_waitcnt vmcnt(14)
ds_read_b64_tr_b16 v[104:105], v3 offset:34816
ds_read_b64_tr_b16 v[106:107], v3 offset:35840
ds_read_b64_tr_b16 v[108:109], v28 offset:34816
ds_read_b64_tr_b16 v[110:111], v28 offset:35840
s_waitcnt lgkmcnt(8)
v_mfma_f32_32x32x16_bf16 v[32:47], v[120:123], a[56:59], v[32:47]
v_mfma_f32_32x32x16_bf16 v[48:63], v[120:123], a[60:63], v[48:63]
v_mfma_f32_32x32x16_bf16 v[64:79], v[124:127], a[56:59], v[64:79]
v_mfma_f32_32x32x16_bf16 v[80:95], v[124:127], a[60:63], v[80:95]
buffer_load_dwordx4 a[56:59], v5, s[20:23], s43 offen offset:3072 sc1
buffer_load_dwordx4 a[60:63], v6, s[20:23], s43 offen offset:3072 sc1
s_add_u32 s43, s43, 4096
s_waitcnt vmcnt(14)
ds_read_b64_tr_b16 v[112:113], v3 offset:36864
ds_read_b64_tr_b16 v[114:115], v3 offset:37888
ds_read_b64_tr_b16 v[116:117], v28 offset:36864
ds_read_b64_tr_b16 v[118:119], v28 offset:37888
s_waitcnt lgkmcnt(8)
v_mfma_f32_32x32x16_bf16 v[32:47], v[96:99], a[0:3], v[32:47]
v_mfma_f32_32x32x16_bf16 v[48:63], v[96:99], a[4:7], v[48:63]
v_mfma_f32_32x32x16_bf16 v[64:79], v[100:103], a[0:3], v[64:79]
v_mfma_f32_32x32x16_bf16 v[80:95], v[100:103], a[4:7], v[80:95]
s_waitcnt vmcnt(12)
ds_read_b64_tr_b16 v[120:121], v3 offset:38912
ds_read_b64_tr_b16 v[122:123], v3 offset:39936
ds_read_b64_tr_b16 v[124:125], v28 offset:38912
ds_read_b64_tr_b16 v[126:127], v28 offset:39936
s_waitcnt lgkmcnt(8)
v_mfma_f32_32x32x16_bf16 v[32:47], v[104:107], a[8:11], v[32:47]
v_mfma_f32_32x32x16_bf16 v[48:63], v[104:107], a[12:15], v[48:63]
v_mfma_f32_32x32x16_bf16 v[64:79], v[108:111], a[8:11], v[64:79]
v_mfma_f32_32x32x16_bf16 v[80:95], v[108:111], a[12:15], v[80:95]
s_waitcnt vmcnt(10)
ds_read_b64_tr_b16 v[96:97], v3
ds_read_b64_tr_b16 v[98:99], v3 offset:1024
ds_read_b64_tr_b16 v[100:101], v28
ds_read_b64_tr_b16 v[102:103], v28 offset:1024
s_waitcnt lgkmcnt(8)
v_mfma_f32_32x32x16_bf16 v[32:47], v[112:115], a[16:19], v[32:47]
v_mfma_f32_32x32x16_bf16 v[48:63], v[112:115], a[20:23], v[48:63]
v_mfma_f32_32x32x16_bf16 v[64:79], v[116:119], a[16:19], v[64:79]
v_mfma_f32_32x32x16_bf16 v[80:95], v[116:119], a[20:23], v[80:95]
s_waitcnt vmcnt(8)
ds_read_b64_tr_b16 v[104:105], v3 offset:2048
ds_read_b64_tr_b16 v[106:107], v3 offset:3072
ds_read_b64_tr_b16 v[108:109], v28 offset:2048
ds_read_b64_tr_b16 v[110:111], v28 offset:3072
s_waitcnt lgkmcnt(8)
v_mfma_f32_32x32x16_bf16 v[32:47], v[120:123], a[24:27], v[32:47]
v_mfma_f32_32x32x16_bf16 v[48:63], v[120:123], a[28:31], v[48:63]
v_mfma_f32_32x32x16_bf16 v[64:79], v[124:127], a[24:27], v[64:79]
v_mfma_f32_32x32x16_bf16 v[80:95], v[124:127], a[28:31], v[80:95]
s_waitcnt vmcnt(6)
ds_read_b64_tr_b16 v[112:113], v3 offset:4096
ds_read_b64_tr_b16 v[114:115], v3 offset:5120
ds_read_b64_tr_b16 v[116:117], v28 offset:4096
ds_read_b64_tr_b16 v[118:119], v28 offset:5120
s_waitcnt lgkmcnt(8)
v_mfma_f32_32x32x16_bf16 v[32:47], v[96:99], a[32:35], v[32:47]
v_mfma_f32_32x32x16_bf16 v[48:63], v[96:99], a[36:39], v[48:63]
v_mfma_f32_32x32x16_bf16 v[64:79], v[100:103], a[32:35], v[64:79]
v_mfma_f32_32x32x16_bf16 v[80:95], v[100:103], a[36:39], v[80:95]
s_waitcnt vmcnt(4)
ds_read_b64_tr_b16 v[120:121], v3 offset:6144
ds_read_b64_tr_b16 v[122:123], v3 offset:7168
ds_read_b64_tr_b16 v[124:125], v28 offset:6144
ds_read_b64_tr_b16 v[126:127], v28 offset:7168
s_waitcnt lgkmcnt(8)
v_mfma_f32_32x32x16_bf16 v[32:47], v[104:107], a[40:43], v[32:47]
v_mfma_f32_32x32x16_bf16 v[48:63], v[104:107], a[44:47], v[48:63]
v_mfma_f32_32x32x16_bf16 v[64:79], v[108:111], a[40:43], v[64:79]
v_mfma_f32_32x32x16_bf16 v[80:95], v[108:111], a[44:47], v[80:95]
s_waitcnt vmcnt(2)
s_waitcnt lgkmcnt(4)
v_mfma_f32_32x32x16_bf16 v[32:47], v[112:115], a[48:51], v[32:47]
v_mfma_f32_32x32x16_bf16 v[48:63], v[112:115], a[52:55], v[48:63]
v_mfma_f32_32x32x16_bf16 v[64:79], v[116:119], a[48:51], v[64:79]
v_mfma_f32_32x32x16_bf16 v[80:95], v[116:119], a[52:55], v[80:95]
s_waitcnt vmcnt(0)
s_waitcnt lgkmcnt(0)
v_mfma_f32_32x32x16_bf16 v[32:47], v[120:123], a[56:59], v[32:47]
v_mfma_f32_32x32x16_bf16 v[48:63], v[120:123], a[60:63], v[48:63]
v_mfma_f32_32x32x16_bf16 v[64:79], v[124:127], a[56:59], v[64:79]
v_mfma_f32_32x32x16_bf16 v[80:95], v[124:127], a[60:63], v[80:95]
s_lshl_b32 s42, s7, 9
s_lshl_b32 s45, s3, 7
s_add_u32 s42, s42, s45
s_lshl_b32 s51, s7, 3
s_lshl_b32 s45, s3, 1
s_add_u32 s51, s51, s45
v_lshrrev_b32 v96, 3, v2
v_mul_u32_u24 v0, 3584, v96
v_bfe_u32 v96, v2, 4, 1
v_lshlrev_b32 v96, 2, v96
v_and_b32 v97, 7, v2
v_xor_b32 v96, v96, v97
v_lshl_add_u32 v0, v96, 4, v0
v_add_u32 v1, 27648, v0
v_xor_b32 v8, 64, v3
v_add_u32 v4, s86, v5
s_nop 7
s_nop 2
ds_write_b128 v4, v[32:35]
ds_write_b128 v4, v[36:39] offset:1024
ds_write_b128 v4, v[40:43] offset:2048
ds_write_b128 v4, v[44:47] offset:3072
ds_write_b128 v4, v[48:51] offset:4096
s_add_u32 m0, s86, 16384
s_nop 0
s_nop 0
buffer_load_dwordx4 v0, s[76:79], s42 offen lds
buffer_load_dwordx4 v1, s[76:79], s42 offen offset:1024 lds
s_add_u32 s42, s42, 57344
ds_write_b128 v4, v[52:55] offset:5120
ds_write_b128 v4, v[56:59] offset:6144
ds_write_b128 v4, v[60:63] offset:7168
ds_write_b128 v4, v[64:67] offset:8192
ds_write_b128 v4, v[68:71] offset:9216
ds_write_b128 v4, v[72:75] offset:10240
ds_write_b128 v4, v[76:79] offset:11264
ds_write_b128 v4, v[80:83] offset:12288
s_add_u32 m0, s86, 18432
s_nop 0
s_nop 0
buffer_load_dwordx4 v0, s[76:79], s42 offen lds
buffer_load_dwordx4 v1, s[76:79], s42 offen offset:1024 lds
s_add_u32 s42, s42, 57344
ds_write_b128 v4, v[84:87] offset:13312
ds_write_b128 v4, v[88:91] offset:14336
ds_write_b128 v4, v[92:95] offset:15360
s_waitcnt lgkmcnt(0)
s_barrier
s_lshl_b32 s45, s3, 12
v_add_u32 v4, s45, v5
v_add_u32 v28, 81920, v4
s_add_u32 m0, s86, 20480
s_nop 0
s_nop 0
buffer_load_dwordx4 v0, s[76:79], s42 offen lds
buffer_load_dwordx4 v1, s[76:79], s42 offen offset:1024 lds
s_add_u32 s42, s42, 57344
ds_read_b128 v[32:35], v4
ds_read_b128 v[36:39], v4 offset:1024
ds_read_b128 v[40:43], v4 offset:2048
ds_read_b128 v[44:47], v4 offset:3072
ds_read_b128 v[48:51], v4 offset:40960
ds_read_b128 v[52:55], v4 offset:41984
ds_read_b128 v[56:59], v4 offset:43008
ds_read_b128 v[60:63], v4 offset:44032
s_add_u32 m0, s86, 22528
s_nop 0
s_nop 0
buffer_load_dwordx4 v0, s[76:79], s42 offen lds
buffer_load_dwordx4 v1, s[76:79], s42 offen offset:1024 lds
s_add_u32 s42, s42, 57344
ds_read_b128 v[64:67], v28
ds_read_b128 v[68:71], v28 offset:1024
ds_read_b128 v[72:75], v28 offset:2048
ds_read_b128 v[76:79], v28 offset:3072
ds_read_b128 v[80:83], v28 offset:40960
ds_read_b128 v[84:87], v28 offset:41984
ds_read_b128 v[88:91], v28 offset:43008
ds_read_b128 v[92:95], v28 offset:44032
s_add_u32 m0, s86, 24576
s_nop 0
buffer_load_dwordx4 v0, s[76:79], s42 offen lds
buffer_load_dwordx4 v1, s[76:79], s42 offen offset:1024 lds
s_add_u32 s42, s42, 57344
s_waitcnt lgkmcnt(0)
v_pk_add_f32 v[32:33], v[32:33], v[48:49]
v_pk_add_f32 v[64:65], v[64:65], v[80:81]
v_pk_add_f32 v[34:35], v[34:35], v[50:51]
v_pk_add_f32 v[66:67], v[66:67], v[82:83]
v_pk_add_f32 v[36:37], v[36:37], v[52:53]
v_pk_add_f32 v[68:69], v[68:69], v[84:85]
v_pk_add_f32 v[38:39], v[38:39], v[54:55]
s_add_u32 m0, s86, 26624
s_nop 0
s_nop 0
buffer_load_dwordx4 v0, s[76:79], s42 offen lds
buffer_load_dwordx4 v1, s[76:79], s42 offen offset:1024 lds
s_add_u32 s42, s42, 57344
v_pk_add_f32 v[70:71], v[70:71], v[86:87]
v_pk_add_f32 v[40:41], v[40:41], v[56:57]
v_pk_add_f32 v[72:73], v[72:73], v[88:89]
v_pk_add_f32 v[42:43], v[42:43], v[58:59]
v_pk_add_f32 v[74:75], v[74:75], v[90:91]
v_pk_add_f32 v[44:45], v[44:45], v[60:61]
v_pk_add_f32 v[76:77], v[76:77], v[92:93]
v_pk_add_f32 v[46:47], v[46:47], v[62:63]
s_add_u32 m0, s86, 28672
s_nop 0
s_nop 0
buffer_load_dwordx4 v0, s[76:79], s42 offen lds
buffer_load_dwordx4 v1, s[76:79], s42 offen offset:1024 lds
s_add_u32 s42, s42, 57344
v_pk_add_f32 v[78:79], v[78:79], v[94:95]
v_pk_add_f32 v[32:33], v[32:33], v[64:65]
v_pk_add_f32 v[34:35], v[34:35], v[66:67]
v_pk_add_f32 v[36:37], v[36:37], v[68:69]
v_pk_add_f32 v[38:39], v[38:39], v[70:71]
v_pk_add_f32 v[40:41], v[40:41], v[72:73]
v_pk_add_f32 v[42:43], v[42:43], v[74:75]
v_pk_add_f32 v[44:45], v[44:45], v[76:77]
s_add_u32 m0, s86, 30720
s_nop 0
s_nop 0
buffer_load_dwordx4 v0, s[76:79], s42 offen lds
buffer_load_dwordx4 v1, s[76:79], s42 offen offset:1024 lds
s_add_u32 s42, s42, 57344
v_pk_add_f32 v[46:47], v[46:47], v[78:79]
v_cvt_pk_bf16_f32 v48, v32, v33
v_cvt_pk_bf16_f32 v49, v34, v35
v_cvt_pk_bf16_f32 v50, v36, v37
v_cvt_pk_bf16_f32 v51, v38, v39
v_cvt_pk_bf16_f32 v52, v40, v41
v_cvt_pk_bf16_f32 v53, v42, v43
v_cvt_pk_bf16_f32 v54, v44, v45
s_add_u32 m0, s86, 32768
s_nop 0
buffer_load_dwordx4 v0, s[76:79], s42 offen lds
buffer_load_dwordx4 v1, s[76:79], s42 offen offset:1024 lds
s_add_u32 s42, s42, 57344
v_cvt_pk_bf16_f32 v55, v46, v47
v_lshlrev_b32 v32, 16, v48
v_and_b32 v33, 0xffff0000, v48
v_lshlrev_b32 v64, 16, v12
v_and_b32 v65, 0xffff0000, v12
v_lshlrev_b32 v34, 16, v49
v_and_b32 v35, 0xffff0000, v49
v_lshlrev_b32 v66, 16, v13
s_add_u32 m0, s86, 34816
s_nop 0
buffer_load_dwordx4 v0, s[76:79], s42 offen lds
buffer_load_dwordx4 v1, s[76:79], s42 offen offset:1024 lds
s_add_u32 s42, s42, 57344
v_and_b32 v67, 0xffff0000, v13
v_lshlrev_b32 v36, 16, v50
v_and_b32 v37, 0xffff0000, v50
v_lshlrev_b32 v68, 16, v14
v_and_b32 v69, 0xffff0000, v14
v_lshlrev_b32 v38, 16, v51
v_and_b32 v39, 0xffff0000, v51
v_lshlrev_b32 v70, 16, v15
s_add_u32 m0, s86, 36864
s_nop 0
buffer_load_dwordx4 v0, s[76:79], s42 offen lds
buffer_load_dwordx4 v1, s[76:79], s42 offen offset:1024 lds
s_add_u32 s42, s42, 57344
v_and_b32 v71, 0xffff0000, v15
v_lshlrev_b32 v40, 16, v52
v_and_b32 v41, 0xffff0000, v52
v_lshlrev_b32 v72, 16, v16
v_and_b32 v73, 0xffff0000, v16
v_lshlrev_b32 v42, 16, v53
v_and_b32 v43, 0xffff0000, v53
v_lshlrev_b32 v74, 16, v17
s_add_u32 m0, s86, 38912
s_nop 0
buffer_load_dwordx4 v0, s[76:79], s42 offen lds
buffer_load_dwordx4 v1, s[76:79], s42 offen offset:1024 lds
s_add_u32 s42, s42, 57344
v_and_b32 v75, 0xffff0000, v17
v_lshlrev_b32 v44, 16, v54
v_and_b32 v45, 0xffff0000, v54
v_lshlrev_b32 v76, 16, v18
v_and_b32 v77, 0xffff0000, v18
v_lshlrev_b32 v46, 16, v55
v_and_b32 v47, 0xffff0000, v55
v_lshlrev_b32 v78, 16, v19
v_and_b32 v79, 0xffff0000, v19
v_pk_add_f32 v[32:33], v[32:33], v[64:65]
v_pk_add_f32 v[34:35], v[34:35], v[66:67]
v_pk_add_f32 v[36:37], v[36:37], v[68:69]
v_pk_add_f32 v[38:39], v[38:39], v[70:71]
v_pk_add_f32 v[40:41], v[40:41], v[72:73]
v_pk_add_f32 v[42:43], v[42:43], v[74:75]
v_pk_add_f32 v[44:45], v[44:45], v[76:77]
v_pk_add_f32 v[46:47], v[46:47], v[78:79]
v_cvt_pk_bf16_f32 v20, v32, v33
v_cvt_pk_bf16_f32 v21, v34, v35
v_cvt_pk_bf16_f32 v22, v36, v37
v_cvt_pk_bf16_f32 v23, v38, v39
v_cvt_pk_bf16_f32 v24, v40, v41
v_cvt_pk_bf16_f32 v25, v42, v43
v_cvt_pk_bf16_f32 v26, v44, v45
v_cvt_pk_bf16_f32 v27, v46, v47
buffer_store_dwordx4 v[20:23], v5, s[16:19], s49 offen sc1
buffer_store_dwordx4 v[24:27], v5, s[16:19], s49 offen offset:1024 sc1
v_lshlrev_b32 v32, 16, v20
v_and_b32 v33, 0xffff0000, v20
v_lshlrev_b32 v34, 16, v21
v_and_b32 v35, 0xffff0000, v21
v_lshlrev_b32 v36, 16, v22
v_and_b32 v37, 0xffff0000, v22
v_lshlrev_b32 v38, 16, v23
v_and_b32 v39, 0xffff0000, v23
v_lshlrev_b32 v40, 16, v24
v_and_b32 v41, 0xffff0000, v24
v_lshlrev_b32 v42, 16, v25
v_and_b32 v43, 0xffff0000, v25
v_lshlrev_b32 v44, 16, v26
v_and_b32 v45, 0xffff0000, v26
v_lshlrev_b32 v46, 16, v27
v_and_b32 v47, 0xffff0000, v27
v_add_f32 v10, v32, v33
v_add_f32 v10, v10, v34
v_add_f32 v10, v10, v35
v_add_f32 v10, v10, v36
v_add_f32 v10, v10, v37
v_add_f32 v10, v10, v38
v_add_f32 v10, v10, v39
v_add_f32 v10, v10, v40
v_add_f32 v10, v10, v41
v_add_f32 v10, v10, v42
v_add_f32 v10, v10, v43
v_add_f32 v10, v10, v44
v_add_f32 v10, v10, v45
v_add_f32 v10, v10, v46
v_add_f32 v10, v10, v47
v_mov_b32 v12, v10
s_nop 1
v_permlane32_swap_b32 v10, v12
v_add_f32 v10, v10, v12
v_mul_f32 v13, 0x3d000000, v10
v_mov_b32 v11, 0
v_sub_f32 v12, v32, v13
v_fmac_f32 v11, v12, v12
v_sub_f32 v12, v33, v13
v_fmac_f32 v11, v12, v12
v_sub_f32 v12, v34, v13
v_fmac_f32 v11, v12, v12
v_sub_f32 v12, v35, v13
v_fmac_f32 v11, v12, v12
v_sub_f32 v12, v36, v13
v_fmac_f32 v11, v12, v12
v_sub_f32 v12, v37, v13
v_fmac_f32 v11, v12, v12
v_sub_f32 v12, v38, v13
v_fmac_f32 v11, v12, v12
v_sub_f32 v12, v39, v13
v_fmac_f32 v11, v12, v12
v_sub_f32 v12, v40, v13
v_fmac_f32 v11, v12, v12
v_sub_f32 v12, v41, v13
v_fmac_f32 v11, v12, v12
v_sub_f32 v12, v42, v13
v_fmac_f32 v11, v12, v12
v_sub_f32 v12, v43, v13
v_fmac_f32 v11, v12, v12
v_sub_f32 v12, v44, v13
v_fmac_f32 v11, v12, v12
v_sub_f32 v12, v45, v13
v_fmac_f32 v11, v12, v12
v_sub_f32 v12, v46, v13
v_fmac_f32 v11, v12, v12
v_sub_f32 v12, v47, v13
v_fmac_f32 v11, v12, v12
v_mov_b32 v12, v11
s_nop 1
v_permlane32_swap_b32 v11, v12
v_add_f32 v11, v11, v12
v_and_b32 v12, 31, v2
v_lshlrev_b32 v12, 3, v12
s_mul_i32 s45, s47, 3584
s_lshl_b32 s44, s46, 8
s_add_u32 s45, s45, s44
buffer_store_dwordx2 v[10:11], v12, s[8:11], s45 offen sc1
s_waitcnt vmcnt(0)
s_barrier
s_lshl_b32 s45, s6, 5
s_lshl_b32 s44, s7, 2
s_add_u32 s45, s45, s44
s_add_u32 s52, s45, 6144
s_add_u32 s45, s45, 5120
s_cmp_lg_u32 s3, 0
s_cbranch_scc1 SETF_16
s_mov_b64 exec, 1
buffer_store_dword v30, v29, s[88:91], s45 offen sc1
s_mov_b64 exec, -1
SETF_16:
v_mov_b32 v12, 0x3f803f80
v_mov_b32 v13, 0x3f803f80
v_mov_b32 v14, 0x3f803f80
v_mov_b32 v15, 0x3f803f80
s_waitcnt vmcnt(25)
ds_read_b64_tr_b16 a[0:1], v3 offset:16384
ds_read_b64_tr_b16 a[2:3], v3 offset:17408
ds_read_b64_tr_b16 a[112:113], v8 offset:16384
ds_read_b64_tr_b16 a[114:115], v8 offset:17408
s_waitcnt vmcnt(23)
ds_read_b64_tr_b16 a[4:5], v3 offset:18432
ds_read_b64_tr_b16 a[6:7], v3 offset:19456
ds_read_b64_tr_b16 a[116:117], v8 offset:18432
ds_read_b64_tr_b16 a[118:119], v8 offset:19456
s_waitcnt vmcnt(21)
ds_read_b64_tr_b16 a[8:9], v3 offset:20480
ds_read_b64_tr_b16 a[10:11], v3 offset:21504
ds_read_b64_tr_b16 a[120:121], v8 offset:20480
ds_read_b64_tr_b16 a[122:123], v8 offset:21504
s_waitcnt lgkmcnt(8)
v_mfma_f32_32x32x16_bf16 v[96:111], a[0:3], v[12:15], 0
v_mfma_f32_32x32x16_bf16 v[112:127], a[112:115], v[12:15], 0
s_add_u32 m0, s86, 16384
s_nop 0
buffer_load_dwordx4 v0, s[76:79], s42 offen lds
buffer_load_dwordx4 v1, s[76:79], s42 offen offset:1024 lds
s_add_u32 s42, s42, 57344
s_waitcnt vmcnt(21)
ds_read_b64_tr_b16 a[12:13], v3 offset:22528
ds_read_b64_tr_b16 a[14:15], v3 offset:23552
ds_read_b64_tr_b16 a[124:125], v8 offset:22528
ds_read_b64_tr_b16 a[126:127], v8 offset:23552
s_waitcnt lgkmcnt(8)
v_mfma_f32_32x32x16_bf16 v[96:111], a[4:7], v[12:15], v[96:111]
v_mfma_f32_32x32x16_bf16 v[112:127], a[116:119], v[12:15], v[112:127]
s_add_u32 m0, s86, 18432
s_nop 0
buffer_load_dwordx4 v0, s[76:79], s42 offen lds
buffer_load_dwordx4 v1, s[76:79], s42 offen offset:1024 lds
s_add_u32 s42, s42, 57344
s_waitcnt vmcnt(21)
ds_read_b64_tr_b16 a[16:17], v3 offset:24576
ds_read_b64_tr_b16 a[18:19], v3 offset:25600
ds_read_b64_tr_b16 a[128:129], v8 offset:24576
ds_read_b64_tr_b16 a[130:131], v8 offset:25600
s_waitcnt lgkmcnt(8)
v_mfma_f32_32x32x16_bf16 v[96:111], a[8:11], v[12:15], v[96:111]
v_mfma_f32_32x32x16_bf16 v[112:127], a[120:123], v[12:15], v[112:127]
s_add_u32 m0, s86, 20480
s_nop 0
buffer_load_dwordx4 v0, s[76:79], s42 offen lds
buffer_load_dwordx4 v1, s[76:79], s42 offen offset:1024 lds
s_add_u32 s42, s42, 57344
s_waitcnt vmcnt(21)
ds_read_b64_tr_b16 a[20:21], v3 offset:26624
ds_read_b64_tr_b16 a[22:23], v3 offset:27648
ds_read_b64_tr_b16 a[132:133], v8 offset:26624
ds_read_b64_tr_b16 a[134:135], v8 offset:27648
s_waitcnt lgkmcnt(8)
v_mfma_f32_32x32x16_bf16 v[96:111], a[12:15], v[12:15], v[96:111]
v_mfma_f32_32x32x16_bf16 v[112:127], a[124:127], v[12:15], v[112:127]
s_add_u32 m0, s86, 22528
s_nop 0
buffer_load_dwordx4 v0, s[76:79], s42 offen lds
buffer_load_dwordx4 v1, s[76:79], s42 offen offset:1024 lds
s_add_u32 s42, s42, 57344
s_waitcnt vmcnt(21)
ds_read_b64_tr_b16 a[24:25], v3 offset:28672
ds_read_b64_tr_b16 a[26:27], v3 offset:29696
ds_read_b64_tr_b16 a[136:137], v8 offset:28672
ds_read_b64_tr_b16 a[138:139], v8 offset:29696
s_waitcnt lgkmcnt(8)
v_mfma_f32_32x32x16_bf16 v[96:111], a[16:19], v[12:15], v[96:111]
v_mfma_f32_32x32x16_bf16 v[112:127], a[128:131], v[12:15], v[112:127]
s_add_u32 m0, s86, 24576
s_nop 0
buffer_load_dwordx4 v0, s[76:79], s42 offen lds
buffer_load_dwordx4 v1, s[76:79], s42 offen offset:1024 lds
s_add_u32 s42, s42, 57344
s_waitcnt vmcnt(21)
ds_read_b64_tr_b16 a[28:29], v3 offset:30720
ds_read_b64_tr_b16 a[30:31], v3 offset:31744
ds_read_b64_tr_b16 a[140:141], v8 offset:30720
ds_read_b64_tr_b16 a[142:143], v8 offset:31744
s_waitcnt lgkmcnt(8)
v_mfma_f32_32x32x16_bf16 v[96:111], a[20:23], v[12:15], v[96:111]
v_mfma_f32_32x32x16_bf16 v[112:127], a[132:135], v[12:15], v[112:127]
s_add_u32 m0, s86, 26624
s_nop 0
buffer_load_dwordx4 v0, s[76:79], s42 offen lds
buffer_load_dwordx4 v1, s[76:79], s42 offen offset:1024 lds
s_add_u32 s42, s42, 57344
s_waitcnt vmcnt(21)
ds_read_b64_tr_b16 a[32:33], v3 offset:32768
ds_read_b64_tr_b16 a[34:35], v3 offset:33792
ds_read_b64_tr_b16 a[144:145], v8 offset:32768
ds_read_b64_tr_b16 a[146:147], v8 offset:33792
s_waitcnt lgkmcnt(8)
v_mfma_f32_32x32x16_bf16 v[96:111], a[24:27], v[12:15], v[96:111]
v_mfma_f32_32x32x16_bf16 v[112:127], a[136:139], v[12:15], v[112:127]
s_add_u32 m0, s86, 28672
s_nop 0
buffer_load_dwordx4 v0, s[76:79], s42 offen lds
buffer_load_dwordx4 v1, s[76:79], s42 offen offset:1024 lds
s_add_u32 s42, s42, 57344
s_waitcnt vmcnt(21)
ds_read_b64_tr_b16 a[36:37], v3 offset:34816
ds_read_b64_tr_b16 a[38:39], v3 offset:35840
ds_read_b64_tr_b16 a[148:149], v8 offset:34816
ds_read_b64_tr_b16 a[150:151], v8 offset:35840
s_waitcnt lgkmcnt(8)
v_mfma_f32_32x32x16_bf16 v[96:111], a[28:31], v[12:15], v[96:111]
v_mfma_f32_32x32x16_bf16 v[112:127], a[140:143], v[12:15], v[112:127]
s_add_u32 m0, s86, 30720
s_nop 0
buffer_load_dwordx4 v0, s[76:79], s42 offen lds
buffer_load_dwordx4 v1, s[76:79], s42 offen offset:1024 lds
s_add_u32 s42, s42, 57344
s_waitcnt vmcnt(21)
ds_read_b64_tr_b16 a[40:41], v3 offset:36864
ds_read_b64_tr_b16 a[42:43], v3 offset:37888
ds_read_b64_tr_b16 a[152:153], v8 offset:36864
ds_read_b64_tr_b16 a[154:155], v8 offset:37888
s_waitcnt lgkmcnt(8)
v_mfma_f32_32x32x16_bf16 v[96:111], a[32:35], v[12:15], v[96:111]
v_mfma_f32_32x32x16_bf16 v[112:127], a[144:147], v[12:15], v[112:127]
s_add_u32 m0, s86, 32768
s_nop 0
buffer_load_dwordx4 v0, s[76:79], s42 offen lds
buffer_load_dwordx4 v1, s[76:79], s42 offen offset:1024 lds
s_add_u32 s42, s42, 57344
s_waitcnt vmcnt(21)
ds_read_b64_tr_b16 a[44:45], v3 offset:38912
ds_read_b64_tr_b16 a[46:47], v3 offset:39936
ds_read_b64_tr_b16 a[156:157], v8 offset:38912
ds_read_b64_tr_b16 a[158:159], v8 offset:39936
s_waitcnt lgkmcnt(8)
v_mfma_f32_32x32x16_bf16 v[96:111], a[36:39], v[12:15], v[96:111]
v_mfma_f32_32x32x16_bf16 v[112:127], a[148:151], v[12:15], v[112:127]
s_add_u32 m0, s86, 34816
s_nop 0
buffer_load_dwordx4 v0, s[76:79], s42 offen lds
buffer_load_dwordx4 v1, s[76:79], s42 offen offset:1024 lds
s_add_u32 s42, s42, 57344
s_waitcnt vmcnt(18)
ds_read_b64_tr_b16 a[48:49], v3 offset:16384
ds_read_b64_tr_b16 a[50:51], v3 offset:17408
ds_read_b64_tr_b16 a[160:161], v8 offset:16384
ds_read_b64_tr_b16 a[162:163], v8 offset:17408
s_waitcnt lgkmcnt(8)
v_mfma_f32_32x32x16_bf16 v[96:111], a[40:43], v[12:15], v[96:111]
v_mfma_f32_32x32x16_bf16 v[112:127], a[152:155], v[12:15], v[112:127]
s_add_u32 m0, s86, 36864
s_nop 0
buffer_load_dwordx4 v0, s[76:79], s42 offen lds
buffer_load_dwordx4 v1, s[76:79], s42 offen offset:1024 lds
s_add_u32 s42, s42, 57344
s_waitcnt vmcnt(18)
ds_read_b64_tr_b16 a[52:53], v3 offset:18432
ds_read_b64_tr_b16 a[54:55], v3 offset:19456
ds_read_b64_tr_b16 a[164:165], v8 offset:18432
ds_read_b64_tr_b16 a[166:167], v8 offset:19456
s_waitcnt lgkmcnt(8)
v_mfma_f32_32x32x16_bf16 v[96:111], a[44:47], v[12:15], v[96:111]
v_mfma_f32_32x32x16_bf16 v[112:127], a[156:159], v[12:15], v[112:127]
s_add_u32 m0, s86, 38912
s_nop 0
buffer_load_dwordx4 v0, s[76:79], s42 offen lds
buffer_load_dwordx4 v1, s[76:79], s42 offen offset:1024 lds
s_add_u32 s42, s42, 57344
s_waitcnt vmcnt(18)
ds_read_b64_tr_b16 a[56:57], v3 offset:20480
ds_read_b64_tr_b16 a[58:59], v3 offset:21504
ds_read_b64_tr_b16 a[168:169], v8 offset:20480
ds_read_b64_tr_b16 a[170:171], v8 offset:21504
s_waitcnt lgkmcnt(8)
v_mfma_f32_32x32x16_bf16 v[96:111], a[48:51], v[12:15], v[96:111]
v_mfma_f32_32x32x16_bf16 v[112:127], a[160:163], v[12:15], v[112:127]
s_add_u32 m0, s86, 16384
s_nop 0
buffer_load_dwordx4 v0, s[76:79], s42 offen lds
buffer_load_dwordx4 v1, s[76:79], s42 offen offset:1024 lds
s_add_u32 s42, s42, 57344
s_waitcnt vmcnt(18)
ds_read_b64_tr_b16 a[60:61], v3 offset:22528
ds_read_b64_tr_b16 a[62:63], v3 offset:23552
ds_read_b64_tr_b16 a[172:173], v8 offset:22528
ds_read_b64_tr_b16 a[174:175], v8 offset:23552
s_waitcnt lgkmcnt(8)
v_mfma_f32_32x32x16_bf16 v[96:111], a[52:55], v[12:15], v[96:111]
v_mfma_f32_32x32x16_bf16 v[112:127], a[164:167], v[12:15], v[112:127]
s_add_u32 m0, s86, 18432
s_nop 0
buffer_load_dwordx4 v0, s[76:79], s42 offen lds
buffer_load_dwordx4 v1, s[76:79], s42 offen offset:1024 lds
s_add_u32 s42, s42, 57344
s_waitcnt vmcnt(18)
ds_read_b64_tr_b16 a[64:65], v3 offset:24576
ds_read_b64_tr_b16 a[66:67], v3 offset:25600
ds_read_b64_tr_b16 a[176:177], v8 offset:24576
ds_read_b64_tr_b16 a[178:179], v8 offset:25600
s_waitcnt lgkmcnt(8)
v_mfma_f32_32x32x16_bf16 v[96:111], a[56:59], v[12:15], v[96:111]
v_mfma_f32_32x32x16_bf16 v[112:127], a[168:171], v[12:15], v[112:127]
s_add_u32 m0, s86, 20480
s_nop 0
buffer_load_dwordx4 v0, s[76:79], s42 offen lds
buffer_load_dwordx4 v1, s[76:79], s42 offen offset:1024 lds
s_add_u32 s42, s42, 57344
s_waitcnt vmcnt(18)
ds_read_b64_tr_b16 a[68:69], v3 offset:26624
ds_read_b64_tr_b16 a[70:71], v3 offset:27648
ds_read_b64_tr_b16 a[180:181], v8 offset:26624
ds_read_b64_tr_b16 a[182:183], v8 offset:27648
s_waitcnt lgkmcnt(8)
v_mfma_f32_32x32x16_bf16 v[96:111], a[60:63], v[12:15], v[96:111]
v_mfma_f32_32x32x16_bf16 v[112:127], a[172:175], v[12:15], v[112:127]
s_add_u32 m0, s86, 22528
s_nop 0
buffer_load_dwordx4 v0, s[76:79], s42 offen lds
buffer_load_dwordx4 v1, s[76:79], s42 offen offset:1024 lds
s_add_u32 s42, s42, 57344
s_waitcnt vmcnt(18)
ds_read_b64_tr_b16 a[72:73], v3 offset:28672
ds_read_b64_tr_b16 a[74:75], v3 offset:29696
ds_read_b64_tr_b16 a[184:185], v8 offset:28672
ds_read_b64_tr_b16 a[186:187], v8 offset:29696
s_waitcnt lgkmcnt(8)
v_mfma_f32_32x32x16_bf16 v[96:111], a[64:67], v[12:15], v[96:111]
v_mfma_f32_32x32x16_bf16 v[112:127], a[176:179], v[12:15], v[112:127]
s_waitcnt vmcnt(16)
ds_read_b64_tr_b16 a[76:77], v3 offset:30720
ds_read_b64_tr_b16 a[78:79], v3 offset:31744
ds_read_b64_tr_b16 a[188:189], v8 offset:30720
ds_read_b64_tr_b16 a[190:191], v8 offset:31744
s_waitcnt lgkmcnt(8)
v_mfma_f32_32x32x16_bf16 v[96:111], a[68:71], v[12:15], v[96:111]
v_mfma_f32_32x32x16_bf16 v[112:127], a[180:183], v[12:15], v[112:127]
s_waitcnt vmcnt(14)
ds_read_b64_tr_b16 a[80:81], v3 offset:32768
ds_read_b64_tr_b16 a[82:83], v3 offset:33792
ds_read_b64_tr_b16 a[192:193], v8 offset:32768
ds_read_b64_tr_b16 a[194:195], v8 offset:33792
s_waitcnt lgkmcnt(8)
v_mfma_f32_32x32x16_bf16 v[96:111], a[72:75], v[12:15], v[96:111]
v_mfma_f32_32x32x16_bf16 v[112:127], a[184:187], v[12:15], v[112:127]
s_waitcnt vmcnt(12)
ds_read_b64_tr_b16 a[84:85], v3 offset:34816
ds_read_b64_tr_b16 a[86:87], v3 offset:35840
ds_read_b64_tr_b16 a[196:197], v8 offset:34816
ds_read_b64_tr_b16 a[198:199], v8 offset:35840
s_waitcnt lgkmcnt(8)
v_mfma_f32_32x32x16_bf16 v[96:111], a[76:79], v[12:15], v[96:111]
v_mfma_f32_32x32x16_bf16 v[112:127], a[188:191], v[12:15], v[112:127]
s_waitcnt vmcnt(10)
ds_read_b64_tr_b16 a[88:89], v3 offset:36864
ds_read_b64_tr_b16 a[90:91], v3 offset:37888
ds_read_b64_tr_b16 a[200:201], v8 offset:36864
ds_read_b64_tr_b16 a[202:203], v8 offset:37888
s_waitcnt lgkmcnt(8)
v_mfma_f32_32x32x16_bf16 v[96:111], a[80:83], v[12:15], v[96:111]
v_mfma_f32_32x32x16_bf16 v[112:127], a[192:195], v[12:15], v[112:127]
s_waitcnt vmcnt(8)
ds_read_b64_tr_b16 a[92:93], v3 offset:38912
ds_read_b64_tr_b16 a[94:95], v3 offset:39936
ds_read_b64_tr_b16 a[204:205], v8 offset:38912
ds_read_b64_tr_b16 a[206:207], v8 offset:39936
s_waitcnt lgkmcnt(8)
v_mfma_f32_32x32x16_bf16 v[96:111], a[84:87], v[12:15], v[96:111]
v_mfma_f32_32x32x16_bf16 v[112:127], a[196:199], v[12:15], v[112:127]
s_waitcnt vmcnt(6)
ds_read_b64_tr_b16 a[96:97], v3 offset:16384
ds_read_b64_tr_b16 a[98:99], v3 offset:17408
ds_read_b64_tr_b16 a[208:209], v8 offset:16384
ds_read_b64_tr_b16 a[210:211], v8 offset:17408
s_waitcnt lgkmcnt(8)
v_mfma_f32_32x32x16_bf16 v[96:111], a[88:91], v[12:15], v[96:111]
v_mfma_f32_32x32x16_bf16 v[112:127], a[200:203], v[12:15], v[112:127]
s_waitcnt vmcnt(4)
ds_read_b64_tr_b16 a[100:101], v3 offset:18432
ds_read_b64_tr_b16 a[102:103], v3 offset:19456
ds_read_b64_tr_b16 a[212:213], v8 offset:18432
ds_read_b64_tr_b16 a[214:215], v8 offset:19456
s_waitcnt lgkmcnt(8)
v_mfma_f32_32x32x16_bf16 v[96:111], a[92:95], v[12:15], v[96:111]
v_mfma_f32_32x32x16_bf16 v[112:127], a[204:207], v[12:15], v[112:127]
s_waitcnt vmcnt(2)
ds_read_b64_tr_b16 a[104:105], v3 offset:20480
ds_read_b64_tr_b16 a[106:107], v3 offset:21504
ds_read_b64_tr_b16 a[216:217], v8 offset:20480
ds_read_b64_tr_b16 a[218:219], v8 offset:21504
s_waitcnt lgkmcnt(8)
v_mfma_f32_32x32x16_bf16 v[96:111], a[96:99], v[12:15], v[96:111]
v_mfma_f32_32x32x16_bf16 v[112:127], a[208:211], v[12:15], v[112:127]
s_waitcnt vmcnt(0)
ds_read_b64_tr_b16 a[108:109], v3 offset:22528
ds_read_b64_tr_b16 a[110:111], v3 offset:23552
ds_read_b64_tr_b16 a[220:221], v8 offset:22528
ds_read_b64_tr_b16 a[222:223], v8 offset:23552
s_waitcnt lgkmcnt(8)
v_mfma_f32_32x32x16_bf16 v[96:111], a[100:103], v[12:15], v[96:111]
v_mfma_f32_32x32x16_bf16 v[112:127], a[212:215], v[12:15], v[112:127]
s_waitcnt lgkmcnt(4)
v_mfma_f32_32x32x16_bf16 v[96:111], a[104:107], v[12:15], v[96:111]
v_mfma_f32_32x32x16_bf16 v[112:127], a[216:219], v[12:15], v[112:127]
s_waitcnt lgkmcnt(0)
v_mfma_f32_32x32x16_bf16 v[96:111], a[108:111], v[12:15], v[96:111]
v_mfma_f32_32x32x16_bf16 v[112:127], a[220:223], v[12:15], v[112:127]
v_and_b32 v10, 7, v2
v_min_u32 v10, 6, v10
v_lshlrev_b32 v10, 2, v10
s_lshl_b32 s45, s6, 5
s_add_u32 s45, s45, 5120
s_mov_b32 s87, 0
POLL_17:
buffer_load_dword v11, v10, s[88:91], s45 offen sc1
s_waitcnt vmcnt(0)
v_cmp_ne_u32 vcc, 1, v11
s_cbranch_vccz POLL_17_OK
s_sleep 1
s_add_u32 s87, s87, 1
s_cmp_lt_u32 s87, 65536
s_cbranch_scc1 POLL_17
POLL_17_OK:
s_mul_i32 s42, s6, 57344
s_mul_i32 s43, s3, 14336
s_add_u32 s42, s42, s43
s_add_u32 m0, s86, 0
s_add_u32 s44, s42, 0
s_nop 0
buffer_load_dwordx4 v5, s[16:19], s44 offen sc1 lds
buffer_load_dwordx4 v5, s[16:19], s44 offen offset:1024 sc1 lds
buffer_load_dwordx4 v5, s[16:19], s44 offen offset:2048 sc1 lds
buffer_load_dwordx4 v5, s[16:19], s44 offen offset:3072 sc1 lds
s_add_u32 m0, s86, 4096
s_add_u32 s44, s42, 4096
buffer_load_dwordx4 v5, s[16:19], s44 offen sc1 lds
buffer_load_dwordx4 v5, s[16:19], s44 offen offset:1024 sc1 lds
buffer_load_dwordx4 v5, s[16:19], s44 offen offset:2048 sc1 lds
buffer_load_dwordx4 v5, s[16:19], s44 offen offset:3072 sc1 lds
s_add_u32 m0, s86, 8192
s_add_u32 s44, s42, 8192
buffer_load_dwordx4 v5, s[16:19], s44 offen sc1 lds
buffer_load_dwordx4 v5, s[16:19], s44 offen offset:1024 sc1 lds
buffer_load_dwordx4 v5, s[16:19], s44 offen offset:2048 sc1 lds
buffer_load_dwordx4 v5, s[16:19], s44 offen offset:3072 sc1 lds
s_add_u32 m0, s86, 12288
s_add_u32 s44, s42, 12288
buffer_load_dwordx4 v5, s[16:19], s44 offen sc1 lds
buffer_load_dwordx4 v5, s[16:19], s44 offen offset:1024 sc1 lds
v_and_b32 v10, 31, v2
v_lshlrev_b32 v10, 3, v10
s_mul_i32 s45, s6, 7168
s_add_u32 s44, s45, 3584
buffer_load_dwordx2 v[128:129], v10, s[8:11], s45 offen sc1
buffer_load_dwordx2 v[130:131], v10, s[8:11], s45 offen offset:256 sc1
buffer_load_dwordx2 v[132:133], v10, s[8:11], s45 offen offset:512 sc1
buffer_load_dwordx2 v[134:135], v10, s[8:11], s45 offen offset:768 sc1
buffer_load_dwordx2 v[136:137], v10, s[8:11], s45 offen offset:1024 sc1
buffer_load_dwordx2 v[138:139], v10, s[8:11], s45 offen offset:1280 sc1
buffer_load_dwordx2 v[140:141], v10, s[8:11], s45 offen offset:1536 sc1
buffer_load_dwordx2 v[142:143], v10, s[8:11], s45 offen offset:1792 sc1
buffer_load_dwordx2 v[144:145], v10, s[8:11], s45 offen offset:2048 sc1
buffer_load_dwordx2 v[146:147], v10, s[8:11], s45 offen offset:2304 sc1
buffer_load_dwordx2 v[148:149], v10, s[8:11], s45 offen offset:2560 sc1
buffer_load_dwordx2 v[150:151], v10, s[8:11], s45 offen offset:2816 sc1
buffer_load_dwordx2 v[152:153], v10, s[8:11], s45 offen offset:3072 sc1
buffer_load_dwordx2 v[154:155], v10, s[8:11], s45 offen offset:3328 sc1
buffer_load_dwordx2 v[156:157], v10, s[8:11], s44 offen sc1
buffer_load_dwordx2 v[158:159], v10, s[8:11], s44 offen offset:256 sc1
buffer_load_dwordx2 v[160:161], v10, s[8:11], s44 offen offset:512 sc1
buffer_load_dwordx2 v[162:163], v10, s[8:11], s44 offen offset:768 sc1
buffer_load_dwordx2 v[164:165], v10, s[8:11], s44 offen offset:1024 sc1
buffer_load_dwordx2 v[166:167], v10, s[8:11], s44 offen offset:1280 sc1
buffer_load_dwordx2 v[168:169], v10, s[8:11], s44 offen offset:1536 sc1
buffer_load_dwordx2 v[170:171], v10, s[8:11], s44 offen offset:1792 sc1
buffer_load_dwordx2 v[172:173], v10, s[8:11], s44 offen offset:2048 sc1
buffer_load_dwordx2 v[174:175], v10, s[8:11], s44 offen offset:2304 sc1
buffer_load_dwordx2 v[176:177], v10, s[8:11], s44 offen offset:2560 sc1
buffer_load_dwordx2 v[178:179], v10, s[8:11], s44 offen offset:2816 sc1
buffer_load_dwordx2 v[180:181], v10, s[8:11], s44 offen offset:3072 sc1
buffer_load_dwordx2 v[182:183], v10, s[8:11], s44 offen offset:3328 sc1
s_mul_i32 s42, s3, 401408
s_lshl_b32 s44, s7, 7
s_add_u32 s42, s42, s44
v_lshrrev_b32 v192, 3, v2
v_mul_u32_u24 v0, 896, v192
v_bfe_u32 v192, v2, 4, 1
v_lshlrev_b32 v192, 2, v192
v_and_b32 v193, 7, v2
v_xor_b32 v192, v192, v193
v_lshl_add_u32 v0, v192, 4, v0
v_add_u32 v1, 6144, v0
v_add_u32 v6, 81920, v5
s_waitcnt vmcnt(28)
s_barrier
ds_read_b128 v[192:195], v5
ds_read_b128 v[196:199], v6
ds_read_b128 v[200:203], v5 offset:1024
ds_read_b128 v[204:207], v6 offset:1024
ds_read_b128 v[208:211], v5 offset:2048
ds_read_b128 v[212:215], v6 offset:2048
s_waitcnt lgkmcnt(4)
v_mfma_f32_32x32x16_bf16 v[32:47], a[0:3], v[192:195], 0
ds_read_b128 v[216:219], v5 offset:3072
v_mfma_f32_32x32x16_bf16 v[48:63], a[0:3], v[196:199], 0
ds_read_b128 v[220:223], v6 offset:3072
v_mfma_f32_32x32x16_bf16 v[64:79], a[112:115], v[192:195], 0
s_add_u32 m0, s86, 16384
s_nop 0
buffer_load_dwordx4 v0, s[80:83], s42 offen lds
buffer_load_dwordx4 v1, s[80:83], s42 offen offset:1024 lds
s_add_u32 s42, s42, 14336
v_mfma_f32_32x32x16_bf16 v[80:95], a[112:115], v[196:199], 0
s_waitcnt lgkmcnt(4)
v_mfma_f32_32x32x16_bf16 v[32:47], a[4:7], v[200:203], v[32:47]
ds_read_b128 v[192:195], v5 offset:4096
v_mfma_f32_32x32x16_bf16 v[48:63], a[4:7], v[204:207], v[48:63]
ds_read_b128 v[196:199], v6 offset:4096
v_mfma_f32_32x32x16_bf16 v[64:79], a[116:119], v[200:203], v[64:79]
s_add_u32 m0, s86, 18432
s_nop 0
buffer_load_dwordx4 v0, s[80:83], s42 offen lds
buffer_load_dwordx4 v1, s[80:83], s42 offen offset:1024 lds
s_add_u32 s42, s42, 14336
v_mfma_f32_32x32x16_bf16 v[80:95], a[116:119], v[204:207], v[80:95]
s_waitcnt lgkmcnt(4)
v_mfma_f32_32x32x16_bf16 v[32:47], a[8:11], v[208:211], v[32:47]
ds_read_b128 v[200:203], v5 offset:5120
v_mfma_f32_32x32x16_bf16 v[48:63], a[8:11], v[212:215], v[48:63]
ds_read_b128 v[204:207], v6 offset:5120
v_mfma_f32_32x32x16_bf16 v[64:79], a[120:123], v[208:211], v[64:79]
s_add_u32 m0, s86, 20480
s_nop 0
buffer_load_dwordx4 v0, s[80:83], s42 offen lds
buffer_load_dwordx4 v1, s[80:83], s42 offen offset:1024 lds
s_add_u32 s42, s42, 14336
v_mfma_f32_32x32x16_bf16 v[80:95], a[120:123], v[212:215], v[80:95]
s_waitcnt lgkmcnt(4)
v_mfma_f32_32x32x16_bf16 v[32:47], a[12:15], v[216:219], v[32:47]
ds_read_b128 v[208:211], v5 offset:6144
v_mfma_f32_32x32x16_bf16 v[48:63], a[12:15], v[220:223], v[48:63]
ds_read_b128 v[212:215], v6 offset:6144
v_mfma_f32_32x32x16_bf16 v[64:79], a[124:127], v[216:219], v[64:79]
s_add_u32 m0, s86, 22528
s_nop 0
buffer_load_dwordx4 v0, s[80:83], s42 offen lds
buffer_load_dwordx4 v1, s[80:83], s42 offen offset:1024 lds
s_add_u32 s42, s42, 14336
v_mfma_f32_32x32x16_bf16 v[80:95], a[124:127], v[220:223], v[80:95]
s_waitcnt lgkmcnt(4)
v_mfma_f32_32x32x16_bf16 v[32:47], a[16:19], v[192:195], v[32:47]
ds_read_b128 v[216:219], v5 offset:7168
s_waitcnt vmcnt(8)
v_add_f32 v10, v128, v130
v_add_f32 v10, v10, v132
v_mfma_f32_32x32x16_bf16 v[48:63], a[16:19], v[196:199], v[48:63]
ds_read_b128 v[220:223], v6 offset:7168
v_add_f32 v10, v10, v134
v_add_f32 v10, v10, v136
v_add_f32 v10, v10, v138
v_mfma_f32_32x32x16_bf16 v[64:79], a[128:131], v[192:195], v[64:79]
s_add_u32 m0, s86, 24576
s_nop 0
buffer_load_dwordx4 v0, s[80:83], s42 offen lds
buffer_load_dwordx4 v1, s[80:83], s42 offen offset:1024 lds
s_add_u32 s42, s42, 14336
v_mfma_f32_32x32x16_bf16 v[80:95], a[128:131], v[196:199], v[80:95]
v_add_f32 v10, v10, v140
v_add_f32 v10, v10, v142
v_add_f32 v10, v10, v144
v_add_f32 v10, v10, v146
s_waitcnt lgkmcnt(4)
v_mfma_f32_32x32x16_bf16 v[32:47], a[20:23], v[200:203], v[32:47]
ds_read_b128 v[192:195], v5 offset:8192
v_add_f32 v10, v10, v148
v_add_f32 v10, v10, v150
v_add_f32 v10, v10, v152
v_mfma_f32_32x32x16_bf16 v[48:63], a[20:23], v[204:207], v[48:63]
ds_read_b128 v[196:199], v6 offset:8192
v_add_f32 v10, v10, v154
v_mul_f32 v10, 0x3b124925, v10
v_add_f32 v11, v129, v131
v_mfma_f32_32x32x16_bf16 v[64:79], a[132:135], v[200:203], v[64:79]
s_add_u32 m0, s86, 26624
s_nop 0
buffer_load_dwordx4 v0, s[80:83], s42 offen lds
buffer_load_dwordx4 v1, s[80:83], s42 offen offset:1024 lds
s_add_u32 s42, s42, 14336
v_mfma_f32_32x32x16_bf16 v[80:95], a[132:135], v[204:207], v[80:95]
v_add_f32 v11, v11, v133
v_add_f32 v11, v11, v135
v_add_f32 v11, v11, v137
v_add_f32 v11, v11, v139
s_waitcnt lgkmcnt(4)
v_mfma_f32_32x32x16_bf16 v[32:47], a[24:27], v[208:211], v[32:47]
ds_read_b128 v[200:203], v5 offset:9216
v_add_f32 v11, v11, v141
v_add_f32 v11, v11, v143
v_add_f32 v11, v11, v145
v_mfma_f32_32x32x16_bf16 v[48:63], a[24:27], v[212:215], v[48:63]
ds_read_b128 v[204:207], v6 offset:9216
v_add_f32 v11, v11, v147
v_add_f32 v11, v11, v149
v_add_f32 v11, v11, v151
v_mfma_f32_32x32x16_bf16 v[64:79], a[136:139], v[208:211], v[64:79]
s_add_u32 m0, s86, 28672
s_nop 0
buffer_load_dwordx4 v0, s[80:83], s42 offen lds
buffer_load_dwordx4 v1, s[80:83], s42 offen offset:1024 lds
s_add_u32 s42, s42, 14336
v_mfma_f32_32x32x16_bf16 v[80:95], a[136:139], v[212:215], v[80:95]
v_add_f32 v11, v11, v153
v_add_f32 v11, v11, v155
v_mov_b32 v4, 0
v_mul_f32 v128, 0x3d000000, v128
s_waitcnt lgkmcnt(4)
v_mfma_f32_32x32x16_bf16 v[32:47], a[28:31], v[216:219], v[32:47]
ds_read_b128 v[208:211], v5 offset:10240
v_sub_f32 v128, v128, v10
v_fmac_f32 v4, v128, v128
v_mul_f32 v130, 0x3d000000, v130
v_mfma_f32_32x32x16_bf16 v[48:63], a[28:31], v[220:223], v[48:63]
ds_read_b128 v[212:215], v6 offset:10240
v_sub_f32 v130, v130, v10
v_fmac_f32 v4, v130, v130
v_mul_f32 v132, 0x3d000000, v132
v_mfma_f32_32x32x16_bf16 v[64:79], a[140:143], v[216:219], v[64:79]
s_add_u32 m0, s86, 30720
s_nop 0
buffer_load_dwordx4 v0, s[80:83], s42 offen lds
buffer_load_dwordx4 v1, s[80:83], s42 offen offset:1024 lds
s_add_u32 s42, s42, 14336
v_mfma_f32_32x32x16_bf16 v[80:95], a[140:143], v[220:223], v[80:95]
v_sub_f32 v132, v132, v10
v_fmac_f32 v4, v132, v132
v_mul_f32 v134, 0x3d000000, v134
v_sub_f32 v134, v134, v10
s_waitcnt lgkmcnt(4)
v_mfma_f32_32x32x16_bf16 v[32:47], a[32:35], v[192:195], v[32:47]
ds_read_b128 v[216:219], v5 offset:11264
v_fmac_f32 v4, v134, v134
v_mul_f32 v136, 0x3d000000, v136
v_sub_f32 v136, v136, v10
v_mfma_f32_32x32x16_bf16 v[48:63], a[32:35], v[196:199], v[48:63]
ds_read_b128 v[220:223], v6 offset:11264
v_fmac_f32 v4, v136, v136
v_mul_f32 v138, 0x3d000000, v138
v_sub_f32 v138, v138, v10
v_mfma_f32_32x32x16_bf16 v[64:79], a[144:147], v[192:195], v[64:79]
s_add_u32 m0, s86, 32768
s_nop 0
buffer_load_dwordx4 v0, s[80:83], s42 offen lds
buffer_load_dwordx4 v1, s[80:83], s42 offen offset:1024 lds
s_add_u32 s42, s42, 14336
v_mfma_f32_32x32x16_bf16 v[80:95], a[144:147], v[196:199], v[80:95]
v_fmac_f32 v4, v138, v138
v_mul_f32 v140, 0x3d000000, v140
v_sub_f32 v140, v140, v10
v_fmac_f32 v4, v140, v140
s_waitcnt lgkmcnt(4)
v_mfma_f32_32x32x16_bf16 v[32:47], a[36:39], v[200:203], v[32:47]
ds_read_b128 v[192:195], v5 offset:12288
v_mul_f32 v142, 0x3d000000, v142
v_sub_f32 v142, v142, v10
v_fmac_f32 v4, v142, v142
v_mfma_f32_32x32x16_bf16 v[48:63], a[36:39], v[204:207], v[48:63]
ds_read_b128 v[196:199], v6 offset:12288
v_mul_f32 v144, 0x3d000000, v144
v_sub_f32 v144, v144, v10
v_fmac_f32 v4, v144, v144
v_mfma_f32_32x32x16_bf16 v[64:79], a[148:151], v[200:203], v[64:79]
s_add_u32 m0, s86, 34816
s_nop 0
buffer_load_dwordx4 v0, s[80:83], s42 offen lds
buffer_load_dwordx4 v1, s[80:83], s42 offen offset:1024 lds
s_add_u32 s42, s42, 14336
v_mfma_f32_32x32x16_bf16 v[80:95], a[148:151], v[204:207], v[80:95]
v_mul_f32 v146, 0x3d000000, v146
v_sub_f32 v146, v146, v10
v_fmac_f32 v4, v146, v146
v_mul_f32 v148, 0x3d000000, v148
s_waitcnt lgkmcnt(4)
v_mfma_f32_32x32x16_bf16 v[32:47], a[40:43], v[208:211], v[32:47]
ds_read_b128 v[200:203], v5 offset:13312
v_sub_f32 v148, v148, v10
v_fmac_f32 v4, v148, v148
v_mul_f32 v150, 0x3d000000, v150
v_mfma_f32_32x32x16_bf16 v[48:63], a[40:43], v[212:215], v[48:63]
ds_read_b128 v[204:207], v6 offset:13312
v_sub_f32 v150, v150, v10
v_fmac_f32 v4, v150, v150
v_mul_f32 v152, 0x3d000000, v152
v_mfma_f32_32x32x16_bf16 v[64:79], a[152:155], v[208:211], v[64:79]
s_add_u32 m0, s86, 36864
s_nop 0
buffer_load_dwordx4 v0, s[80:83], s42 offen lds
buffer_load_dwordx4 v1, s[80:83], s42 offen offset:1024 lds
s_add_u32 s42, s42, 14336
v_mfma_f32_32x32x16_bf16 v[80:95], a[152:155], v[212:215], v[80:95]
v_sub_f32 v152, v152, v10
v_fmac_f32 v4, v152, v152
v_mul_f32 v154, 0x3d000000, v154
v_sub_f32 v154, v154, v10
s_waitcnt lgkmcnt(4)
v_mfma_f32_32x32x16_bf16 v[32:47], a[44:47], v[216:219], v[32:47]
ds_read_b128 v[208:211], v5 offset:40960
v_fmac_f32 v4, v154, v154
v_mul_f32 v4, 0x42000000, v4
v_add_f32 v11, v11, v4
v_mfma_f32_32x32x16_bf16 v[48:63], a[44:47], v[220:223], v[48:63]
ds_read_b128 v[212:215], v6 offset:40960
v_mul_f32 v11, 0x3b124925, v11
v_cvt_pk_bf16_f32 v16, v10, v10
v_lshlrev_b32 v16, 16, v16
v_mfma_f32_32x32x16_bf16 v[64:79], a[156:159], v[216:219], v[64:79]
s_add_u32 m0, s86, 38912
s_nop 0
buffer_load_dwordx4 v0, s[80:83], s42 offen lds
buffer_load_dwordx4 v1, s[80:83], s42 offen offset:1024 lds
s_add_u32 s42, s42, 14336
v_mfma_f32_32x32x16_bf16 v[80:95], a[156:159], v[220:223], v[80:95]
v_cvt_pk_bf16_f32 v11, v11, v11
v_lshlrev_b32 v11, 16, v11
v_add_f32 v11, 0x3727c5ac, v11
v_cvt_pk_bf16_f32 v11, v11, v11
s_waitcnt lgkmcnt(4)
v_mfma_f32_32x32x16_bf16 v[32:47], a[48:51], v[192:195], v[32:47]
ds_read_b128 v[216:219], v5 offset:41984
v_lshlrev_b32 v11, 16, v11
v_sqrt_f32 v11, v11
v_mfma_f32_32x32x16_bf16 v[48:63], a[48:51], v[196:199], v[48:63]
ds_read_b128 v[220:223], v6 offset:41984
s_nop 0
v_cvt_pk_bf16_f32 v11, v11, v11
v_lshlrev_b32 v11, 16, v11
v_mfma_f32_32x32x16_bf16 v[64:79], a[160:163], v[192:195], v[64:79]
v_rcp_f32 v18, v11
s_nop 0
v_mul_f32 v16, v16, v18
v_mfma_f32_32x32x16_bf16 v[80:95], a[160:163], v[196:199], v[80:95]
v_add_f32 v10, v156, v158
v_add_f32 v10, v10, v160
v_add_f32 v10, v10, v162
v_add_f32 v10, v10, v164
s_waitcnt lgkmcnt(4)
v_mfma_f32_32x32x16_bf16 v[32:47], a[52:55], v[200:203], v[32:47]
ds_read_b128 v[192:195], v5 offset:43008
v_add_f32 v10, v10, v166
v_add_f32 v10, v10, v168
v_add_f32 v10, v10, v170
v_mfma_f32_32x32x16_bf16 v[48:63], a[52:55], v[204:207], v[48:63]
ds_read_b128 v[196:199], v6 offset:43008
v_add_f32 v10, v10, v172
v_add_f32 v10, v10, v174
v_add_f32 v10, v10, v176
v_mfma_f32_32x32x16_bf16 v[64:79], a[164:167], v[200:203], v[64:79]
v_add_f32 v10, v10, v178
v_add_f32 v10, v10, v180
v_add_f32 v10, v10, v182
v_mul_f32 v10, 0x3b124925, v10
v_mfma_f32_32x32x16_bf16 v[80:95], a[164:167], v[204:207], v[80:95]
v_add_f32 v11, v157, v159
v_add_f32 v11, v11, v161
v_add_f32 v11, v11, v163
v_add_f32 v11, v11, v165
s_waitcnt lgkmcnt(4)
v_mfma_f32_32x32x16_bf16 v[32:47], a[56:59], v[208:211], v[32:47]
ds_read_b128 v[200:203], v5 offset:44032
v_add_f32 v11, v11, v167
v_add_f32 v11, v11, v169
v_add_f32 v11, v11, v171
v_mfma_f32_32x32x16_bf16 v[48:63], a[56:59], v[212:215], v[48:63]
ds_read_b128 v[204:207], v6 offset:44032
v_add_f32 v11, v11, v173
v_add_f32 v11, v11, v175
v_add_f32 v11, v11, v177
v_mfma_f32_32x32x16_bf16 v[64:79], a[168:171], v[208:211], v[64:79]
v_add_f32 v11, v11, v179
v_add_f32 v11, v11, v181
v_add_f32 v11, v11, v183
v_mov_b32 v4, 0
v_mfma_f32_32x32x16_bf16 v[80:95], a[168:171], v[212:215], v[80:95]
v_mul_f32 v156, 0x3d000000, v156
v_sub_f32 v156, v156, v10
v_fmac_f32 v4, v156, v156
v_mul_f32 v158, 0x3d000000, v158
s_waitcnt lgkmcnt(4)
v_mfma_f32_32x32x16_bf16 v[32:47], a[60:63], v[216:219], v[32:47]
ds_read_b128 v[208:211], v5 offset:45056
v_sub_f32 v158, v158, v10
v_fmac_f32 v4, v158, v158
v_mul_f32 v160, 0x3d000000, v160
v_mfma_f32_32x32x16_bf16 v[48:63], a[60:63], v[220:223], v[48:63]
ds_read_b128 v[212:215], v6 offset:45056
v_sub_f32 v160, v160, v10
v_fmac_f32 v4, v160, v160
v_mul_f32 v162, 0x3d000000, v162
v_mfma_f32_32x32x16_bf16 v[64:79], a[172:175], v[216:219], v[64:79]
v_sub_f32 v162, v162, v10
v_fmac_f32 v4, v162, v162
v_mul_f32 v164, 0x3d000000, v164
v_sub_f32 v164, v164, v10
v_mfma_f32_32x32x16_bf16 v[80:95], a[172:175], v[220:223], v[80:95]
v_fmac_f32 v4, v164, v164
v_mul_f32 v166, 0x3d000000, v166
v_sub_f32 v166, v166, v10
v_fmac_f32 v4, v166, v166
s_waitcnt lgkmcnt(4)
v_mfma_f32_32x32x16_bf16 v[32:47], a[64:67], v[192:195], v[32:47]
ds_read_b128 v[216:219], v5 offset:46080
v_mul_f32 v168, 0x3d000000, v168
v_sub_f32 v168, v168, v10
v_fmac_f32 v4, v168, v168
v_mfma_f32_32x32x16_bf16 v[48:63], a[64:67], v[196:199], v[48:63]
ds_read_b128 v[220:223], v6 offset:46080
v_mul_f32 v170, 0x3d000000, v170
v_sub_f32 v170, v170, v10
v_fmac_f32 v4, v170, v170
v_mfma_f32_32x32x16_bf16 v[64:79], a[176:179], v[192:195], v[64:79]
v_mul_f32 v172, 0x3d000000, v172
v_sub_f32 v172, v172, v10
v_fmac_f32 v4, v172, v172
v_mul_f32 v174, 0x3d000000, v174
v_mfma_f32_32x32x16_bf16 v[80:95], a[176:179], v[196:199], v[80:95]
v_sub_f32 v174, v174, v10
v_fmac_f32 v4, v174, v174
v_mul_f32 v176, 0x3d000000, v176
v_sub_f32 v176, v176, v10
s_waitcnt lgkmcnt(4)
v_mfma_f32_32x32x16_bf16 v[32:47], a[68:71], v[200:203], v[32:47]
ds_read_b128 v[192:195], v5 offset:47104
v_fmac_f32 v4, v176, v176
v_mul_f32 v178, 0x3d000000, v178
v_sub_f32 v178, v178, v10
v_mfma_f32_32x32x16_bf16 v[48:63], a[68:71], v[204:207], v[48:63]
ds_read_b128 v[196:199], v6 offset:47104
v_fmac_f32 v4, v178, v178
v_mul_f32 v180, 0x3d000000, v180
v_sub_f32 v180, v180, v10
v_mfma_f32_32x32x16_bf16 v[64:79], a[180:183], v[200:203], v[64:79]
v_fmac_f32 v4, v180, v180
v_mul_f32 v182, 0x3d000000, v182
v_sub_f32 v182, v182, v10
v_fmac_f32 v4, v182, v182
v_mfma_f32_32x32x16_bf16 v[80:95], a[180:183], v[204:207], v[80:95]
v_mul_f32 v4, 0x42000000, v4
v_add_f32 v11, v11, v4
v_mul_f32 v11, 0x3b124925, v11
v_cvt_pk_bf16_f32 v17, v10, v10
s_waitcnt lgkmcnt(4)
v_mfma_f32_32x32x16_bf16 v[32:47], a[72:75], v[208:211], v[32:47]
ds_read_b128 v[200:203], v5 offset:48128
v_lshlrev_b32 v17, 16, v17
v_cvt_pk_bf16_f32 v11, v11, v11
v_lshlrev_b32 v11, 16, v11
v_mfma_f32_32x32x16_bf16 v[48:63], a[72:75], v[212:215], v[48:63]
ds_read_b128 v[204:207], v6 offset:48128
v_add_f32 v11, 0x3727c5ac, v11
v_cvt_pk_bf16_f32 v11, v11, v11
v_lshlrev_b32 v11, 16, v11
v_mfma_f32_32x32x16_bf16 v[64:79], a[184:187], v[208:211], v[64:79]
v_sqrt_f32 v11, v11
s_nop 0
v_cvt_pk_bf16_f32 v11, v11, v11
v_mfma_f32_32x32x16_bf16 v[80:95], a[184:187], v[212:215], v[80:95]
v_lshlrev_b32 v11, 16, v11
v_rcp_f32 v19, v11
s_nop 0
s_waitcnt lgkmcnt(4)
v_mfma_f32_32x32x16_bf16 v[32:47], a[76:79], v[216:219], v[32:47]
ds_read_b128 v[208:211], v5 offset:49152
v_mul_f32 v17, v17, v19
v_mfma_f32_32x32x16_bf16 v[48:63], a[76:79], v[220:223], v[48:63]
ds_read_b128 v[212:215], v6 offset:49152
v_mfma_f32_32x32x16_bf16 v[64:79], a[188:191], v[216:219], v[64:79]
v_mfma_f32_32x32x16_bf16 v[80:95], a[188:191], v[220:223], v[80:95]
s_waitcnt lgkmcnt(4)
v_mfma_f32_32x32x16_bf16 v[32:47], a[80:83], v[192:195], v[32:47]
ds_read_b128 v[216:219], v5 offset:50176
v_mfma_f32_32x32x16_bf16 v[48:63], a[80:83], v[196:199], v[48:63]
ds_read_b128 v[220:223], v6 offset:50176
v_mfma_f32_32x32x16_bf16 v[64:79], a[192:195], v[192:195], v[64:79]
v_mfma_f32_32x32x16_bf16 v[80:95], a[192:195], v[196:199], v[80:95]
s_waitcnt lgkmcnt(4)
v_mfma_f32_32x32x16_bf16 v[32:47], a[84:87], v[200:203], v[32:47]
ds_read_b128 v[192:195], v5 offset:51200
v_mfma_f32_32x32x16_bf16 v[48:63], a[84:87], v[204:207], v[48:63]
ds_read_b128 v[196:199], v6 offset:51200
v_mfma_f32_32x32x16_bf16 v[64:79], a[196:199], v[200:203], v[64:79]
v_mfma_f32_32x32x16_bf16 v[80:95], a[196:199], v[204:207], v[80:95]
s_waitcnt lgkmcnt(4)
v_mfma_f32_32x32x16_bf16 v[32:47], a[88:91], v[208:211], v[32:47]
ds_read_b128 v[200:203], v5 offset:52224
v_mfma_f32_32x32x16_bf16 v[48:63], a[88:91], v[212:215], v[48:63]
ds_read_b128 v[204:207], v6 offset:52224
v_mfma_f32_32x32x16_bf16 v[64:79], a[200:203], v[208:211], v[64:79]
v_mfma_f32_32x32x16_bf16 v[80:95], a[200:203], v[212:215], v[80:95]
s_waitcnt lgkmcnt(4)
v_mfma_f32_32x32x16_bf16 v[32:47], a[92:95], v[216:219], v[32:47]
ds_read_b128 v[208:211], v5 offset:53248
v_mfma_f32_32x32x16_bf16 v[48:63], a[92:95], v[220:223], v[48:63]
ds_read_b128 v[212:215], v6 offset:53248
v_mfma_f32_32x32x16_bf16 v[64:79], a[204:207], v[216:219], v[64:79]
v_mfma_f32_32x32x16_bf16 v[80:95], a[204:207], v[220:223], v[80:95]
s_waitcnt lgkmcnt(4)
v_mfma_f32_32x32x16_bf16 v[32:47], a[96:99], v[192:195], v[32:47]
ds_read_b128 v[216:219], v5 offset:54272
v_mfma_f32_32x32x16_bf16 v[48:63], a[96:99], v[196:199], v[48:63]
ds_read_b128 v[220:223], v6 offset:54272
v_mfma_f32_32x32x16_bf16 v[64:79], a[208:211], v[192:195], v[64:79]
v_mfma_f32_32x32x16_bf16 v[80:95], a[208:211], v[196:199], v[80:95]
s_waitcnt lgkmcnt(4)
v_mfma_f32_32x32x16_bf16 v[32:47], a[100:103], v[200:203], v[32:47]
v_mfma_f32_32x32x16_bf16 v[48:63], a[100:103], v[204:207], v[48:63]
v_mfma_f32_32x32x16_bf16 v[64:79], a[212:215], v[200:203], v[64:79]
v_mfma_f32_32x32x16_bf16 v[80:95], a[212:215], v[204:207], v[80:95]
s_waitcnt lgkmcnt(2)
v_mfma_f32_32x32x16_bf16 v[32:47], a[104:107], v[208:211], v[32:47]
v_mfma_f32_32x32x16_bf16 v[48:63], a[104:107], v[212:215], v[48:63]
v_mfma_f32_32x32x16_bf16 v[64:79], a[216:219], v[208:211], v[64:79]
v_mfma_f32_32x32x16_bf16 v[80:95], a[216:219], v[212:215], v[80:95]
s_waitcnt lgkmcnt(0)
v_mfma_f32_32x32x16_bf16 v[32:47], a[108:111], v[216:219], v[32:47]
v_mfma_f32_32x32x16_bf16 v[48:63], a[108:111], v[220:223], v[48:63]
v_mfma_f32_32x32x16_bf16 v[64:79], a[220:223], v[216:219], v[64:79]
v_mfma_f32_32x32x16_bf16 v[80:95], a[220:223], v[220:223], v[80:95]
s_add_u32 s20, s54, 0x4100000
s_addc_u32 s21, s55, 0
s_and_b32 s21, s21, 0xffff
s_mov_b32 s22, 0x700000
s_mov_b32 s23, 0x00020000
s_mul_i32 s44, s6, 229376
s_lshl_b32 s45, s51, 11
s_add_u32 s44, s44, s45
s_add_u32 s45, s44, 114688
s_mov_b32 s50, 0xbfb8aa3b
s_mov_b32 s51, s50
v_mov_b32 v10, 1.0
v_mov_b32 v11, 1.0
s_nop 0
v_pk_mul_f32 v[128:129], v[96:97], v[16:17] op_sel:[0,0] op_sel_hi:[1,0]
v_pk_mul_f32 v[130:131], v[98:99], v[16:17] op_sel:[0,0] op_sel_hi:[1,0]
v_pk_mul_f32 v[132:133], v[100:101], v[16:17] op_sel:[0,0] op_sel_hi:[1,0]
v_pk_mul_f32 v[134:135], v[102:103], v[16:17] op_sel:[0,0] op_sel_hi:[1,0]
v_pk_mul_f32 v[136:137], v[104:105], v[16:17] op_sel:[0,0] op_sel_hi:[1,0]
v_pk_mul_f32 v[138:139], v[106:107], v[16:17] op_sel:[0,0] op_sel_hi:[1,0]
v_pk_mul_f32 v[140:141], v[108:109], v[16:17] op_sel:[0,0] op_sel_hi:[1,0]
v_pk_mul_f32 v[142:143], v[110:111], v[16:17] op_sel:[0,0] op_sel_hi:[1,0]
v_pk_fma_f32 v[32:33], v[32:33], v[18:19], v[128:129] op_sel:[0,0,0] op_sel_hi:[1,0,1] neg_lo:[0,0,1] neg_hi:[0,0,1]
v_pk_fma_f32 v[34:35], v[34:35], v[18:19], v[130:131] op_sel:[0,0,0] op_sel_hi:[1,0,1] neg_lo:[0,0,1] neg_hi:[0,0,1]
v_pk_fma_f32 v[36:37], v[36:37], v[18:19], v[132:133] op_sel:[0,0,0] op_sel_hi:[1,0,1] neg_lo:[0,0,1] neg_hi:[0,0,1]
v_pk_fma_f32 v[38:39], v[38:39], v[18:19], v[134:135] op_sel:[0,0,0] op_sel_hi:[1,0,1] neg_lo:[0,0,1] neg_hi:[0,0,1]
v_pk_fma_f32 v[40:41], v[40:41], v[18:19], v[136:137] op_sel:[0,0,0] op_sel_hi:[1,0,1] neg_lo:[0,0,1] neg_hi:[0,0,1]
v_pk_fma_f32 v[42:43], v[42:43], v[18:19], v[138:139] op_sel:[0,0,0] op_sel_hi:[1,0,1] neg_lo:[0,0,1] neg_hi:[0,0,1]
v_pk_fma_f32 v[44:45], v[44:45], v[18:19], v[140:141] op_sel:[0,0,0] op_sel_hi:[1,0,1] neg_lo:[0,0,1] neg_hi:[0,0,1]
v_pk_fma_f32 v[46:47], v[46:47], v[18:19], v[142:143] op_sel:[0,0,0] op_sel_hi:[1,0,1] neg_lo:[0,0,1] neg_hi:[0,0,1]
v_pk_mul_f32 v[128:129], v[32:33], s[50:51]
v_pk_mul_f32 v[130:131], v[34:35], s[50:51]
v_pk_mul_f32 v[132:133], v[36:37], s[50:51]
v_pk_mul_f32 v[134:135], v[38:39], s[50:51]
v_pk_mul_f32 v[136:137], v[40:41], s[50:51]
v_pk_mul_f32 v[138:139], v[42:43], s[50:51]
v_pk_mul_f32 v[140:141], v[44:45], s[50:51]
v_pk_mul_f32 v[142:143], v[46:47], s[50:51]
v_exp_f32 v128, v128
v_exp_f32 v129, v129
v_exp_f32 v130, v130
v_exp_f32 v131, v131
v_exp_f32 v132, v132
v_exp_f32 v133, v133
v_exp_f32 v134, v134
v_exp_f32 v135, v135
v_exp_f32 v136, v136
v_exp_f32 v137, v137
v_exp_f32 v138, v138
v_exp_f32 v139, v139
v_exp_f32 v140, v140
v_exp_f32 v141, v141
v_exp_f32 v142, v142
v_exp_f32 v143, v143
s_waitcnt vmcnt(22)
s_nop 0
ds_read_b64_tr_b16 a[0:1], v3 offset:16384
ds_read_b64_tr_b16 a[2:3], v3 offset:17408
ds_read_b64_tr_b16 a[112:113], v8 offset:16384
ds_read_b64_tr_b16 a[114:115], v8 offset:17408
v_pk_add_f32 v[128:129], v[128:129], v[10:11]
v_pk_add_f32 v[130:131], v[130:131], v[10:11]
v_pk_add_f32 v[132:133], v[132:133], v[10:11]
v_pk_add_f32 v[134:135], v[134:135], v[10:11]
v_pk_add_f32 v[136:137], v[136:137], v[10:11]
v_pk_add_f32 v[138:139], v[138:139], v[10:11]
v_pk_add_f32 v[140:141], v[140:141], v[10:11]
v_pk_add_f32 v[142:143], v[142:143], v[10:11]
v_rcp_f32 v128, v128
v_rcp_f32 v129, v129
v_rcp_f32 v130, v130
v_rcp_f32 v131, v131
v_rcp_f32 v132, v132
v_rcp_f32 v133, v133
v_rcp_f32 v134, v134
v_rcp_f32 v135, v135
v_rcp_f32 v136, v136
v_rcp_f32 v137, v137
v_rcp_f32 v138, v138
v_rcp_f32 v139, v139
v_rcp_f32 v140, v140
v_rcp_f32 v141, v141
v_rcp_f32 v142, v142
v_rcp_f32 v143, v143
v_pk_mul_f32 v[32:33], v[32:33], v[128:129]
v_pk_mul_f32 v[34:35], v[34:35], v[130:131]
v_pk_mul_f32 v[36:37], v[36:37], v[132:133]
v_pk_mul_f32 v[38:39], v[38:39], v[134:135]
v_pk_mul_f32 v[40:41], v[40:41], v[136:137]
v_pk_mul_f32 v[42:43], v[42:43], v[138:139]
v_pk_mul_f32 v[44:45], v[44:45], v[140:141]
v_pk_mul_f32 v[46:47], v[46:47], v[142:143]
v_cvt_pk_bf16_f32 v32, v32, v33
v_cvt_pk_bf16_f32 v33, v34, v35
v_cvt_pk_bf16_f32 v34, v36, v37
v_cvt_pk_bf16_f32 v35, v38, v39
v_cvt_pk_bf16_f32 v36, v40, v41
v_cvt_pk_bf16_f32 v37, v42, v43
v_cvt_pk_bf16_f32 v38, v44, v45
v_cvt_pk_bf16_f32 v39, v46, v47
s_waitcnt vmcnt(20)
s_nop 0
ds_read_b64_tr_b16 a[4:5], v3 offset:18432
ds_read_b64_tr_b16 a[6:7], v3 offset:19456
ds_read_b64_tr_b16 a[116:117], v8 offset:18432
ds_read_b64_tr_b16 a[118:119], v8 offset:19456
buffer_store_dwordx4 v[32:35], v5, s[20:23], s44 offen sc1
buffer_store_dwordx4 v[36:39], v5, s[20:23], s44 offen offset:1024 sc1
v_pk_mul_f32 v[128:129], v[96:97], v[16:17] op_sel:[0,1] op_sel_hi:[1,1]
v_pk_mul_f32 v[130:131], v[98:99], v[16:17] op_sel:[0,1] op_sel_hi:[1,1]
v_pk_mul_f32 v[132:133], v[100:101], v[16:17] op_sel:[0,1] op_sel_hi:[1,1]
v_pk_mul_f32 v[134:135], v[102:103], v[16:17] op_sel:[0,1] op_sel_hi:[1,1]
v_pk_mul_f32 v[136:137], v[104:105], v[16:17] op_sel:[0,1] op_sel_hi:[1,1]
v_pk_mul_f32 v[138:139], v[106:107], v[16:17] op_sel:[0,1] op_sel_hi:[1,1]
v_pk_mul_f32 v[140:141], v[108:109], v[16:17] op_sel:[0,1] op_sel_hi:[1,1]
v_pk_mul_f32 v[142:143], v[110:111], v[16:17] op_sel:[0,1] op_sel_hi:[1,1]
v_pk_fma_f32 v[48:49], v[48:49], v[18:19], v[128:129] op_sel:[0,1,0] op_sel_hi:[1,1,1] neg_lo:[0,0,1] neg_hi:[0,0,1]
v_pk_fma_f32 v[50:51], v[50:51], v[18:19], v[130:131] op_sel:[0,1,0] op_sel_hi:[1,1,1] neg_lo:[0,0,1] neg_hi:[0,0,1]
v_pk_fma_f32 v[52:53], v[52:53], v[18:19], v[132:133] op_sel:[0,1,0] op_sel_hi:[1,1,1] neg_lo:[0,0,1] neg_hi:[0,0,1]
v_pk_fma_f32 v[54:55], v[54:55], v[18:19], v[134:135] op_sel:[0,1,0] op_sel_hi:[1,1,1] neg_lo:[0,0,1] neg_hi:[0,0,1]
v_pk_fma_f32 v[56:57], v[56:57], v[18:19], v[136:137] op_sel:[0,1,0] op_sel_hi:[1,1,1] neg_lo:[0,0,1] neg_hi:[0,0,1]
v_pk_fma_f32 v[58:59], v[58:59], v[18:19], v[138:139] op_sel:[0,1,0] op_sel_hi:[1,1,1] neg_lo:[0,0,1] neg_hi:[0,0,1]
v_pk_fma_f32 v[60:61], v[60:61], v[18:19], v[140:141] op_sel:[0,1,0] op_sel_hi:[1,1,1] neg_lo:[0,0,1] neg_hi:[0,0,1]
v_pk_fma_f32 v[62:63], v[62:63], v[18:19], v[142:143] op_sel:[0,1,0] op_sel_hi:[1,1,1] neg_lo:[0,0,1] neg_hi:[0,0,1]
v_pk_mul_f32 v[128:129], v[48:49], s[50:51]
v_pk_mul_f32 v[130:131], v[50:51], s[50:51]
v_pk_mul_f32 v[132:133], v[52:53], s[50:51]
v_pk_mul_f32 v[134:135], v[54:55], s[50:51]
v_pk_mul_f32 v[136:137], v[56:57], s[50:51]
v_pk_mul_f32 v[138:139], v[58:59], s[50:51]
v_pk_mul_f32 v[140:141], v[60:61], s[50:51]
v_pk_mul_f32 v[142:143], v[62:63], s[50:51]
v_exp_f32 v128, v128
v_exp_f32 v129, v129
v_exp_f32 v130, v130
v_exp_f32 v131, v131
v_exp_f32 v132, v132
v_exp_f32 v133, v133
v_exp_f32 v134, v134
v_exp_f32 v135, v135
v_exp_f32 v136, v136
v_exp_f32 v137, v137
v_exp_f32 v138, v138
v_exp_f32 v139, v139
v_exp_f32 v140, v140
v_exp_f32 v141, v141
s_waitcnt vmcnt(20)
ds_read_b64_tr_b16 a[8:9], v3 offset:20480
ds_read_b64_tr_b16 a[10:11], v3 offset:21504
ds_read_b64_tr_b16 a[120:121], v8 offset:20480
ds_read_b64_tr_b16 a[122:123], v8 offset:21504
s_waitcnt lgkmcnt(8)
s_add_u32 m0, s86, 16384
s_nop 0
buffer_load_dwordx4 v0, s[80:83], s42 offen lds
buffer_load_dwordx4 v1, s[80:83], s42 offen offset:1024 lds
s_add_u32 s42, s42, 14336
v_exp_f32 v142, v142
v_exp_f32 v143, v143
s_nop 0
v_pk_add_f32 v[128:129], v[128:129], v[10:11]
v_pk_add_f32 v[130:131], v[130:131], v[10:11]
v_pk_add_f32 v[132:133], v[132:133], v[10:11]
v_pk_add_f32 v[134:135], v[134:135], v[10:11]
v_pk_add_f32 v[136:137], v[136:137], v[10:11]
v_pk_add_f32 v[138:139], v[138:139], v[10:11]
v_pk_add_f32 v[140:141], v[140:141], v[10:11]
v_pk_add_f32 v[142:143], v[142:143], v[10:11]
v_rcp_f32 v128, v128
v_rcp_f32 v129, v129
v_rcp_f32 v130, v130
v_rcp_f32 v131, v131
v_rcp_f32 v132, v132
v_rcp_f32 v133, v133
v_rcp_f32 v134, v134
v_rcp_f32 v135, v135
v_rcp_f32 v136, v136
v_rcp_f32 v137, v137
v_rcp_f32 v138, v138
v_rcp_f32 v139, v139
v_rcp_f32 v140, v140
v_rcp_f32 v141, v141
v_rcp_f32 v142, v142
v_rcp_f32 v143, v143
v_pk_mul_f32 v[48:49], v[48:49], v[128:129]
v_pk_mul_f32 v[50:51], v[50:51], v[130:131]
v_pk_mul_f32 v[52:53], v[52:53], v[132:133]
v_pk_mul_f32 v[54:55], v[54:55], v[134:135]
v_pk_mul_f32 v[56:57], v[56:57], v[136:137]
v_pk_mul_f32 v[58:59], v[58:59], v[138:139]
v_pk_mul_f32 v[60:61], v[60:61], v[140:141]
v_pk_mul_f32 v[62:63], v[62:63], v[142:143]
v_cvt_pk_bf16_f32 v48, v48, v49
v_cvt_pk_bf16_f32 v49, v50, v51
v_cvt_pk_bf16_f32 v50, v52, v53
v_cvt_pk_bf16_f32 v51, v54, v55
v_cvt_pk_bf16_f32 v52, v56, v57
v_cvt_pk_bf16_f32 v53, v58, v59
s_waitcnt vmcnt(20)
ds_read_b64_tr_b16 a[12:13], v3 offset:22528
ds_read_b64_tr_b16 a[14:15], v3 offset:23552
ds_read_b64_tr_b16 a[124:125], v8 offset:22528
ds_read_b64_tr_b16 a[126:127], v8 offset:23552
s_waitcnt lgkmcnt(8)
s_add_u32 m0, s86, 18432
s_nop 0
s_nop 0
buffer_load_dwordx4 v0, s[80:83], s42 offen lds
buffer_load_dwordx4 v1, s[80:83], s42 offen offset:1024 lds
s_add_u32 s42, s42, 14336
v_cvt_pk_bf16_f32 v54, v60, v61
v_cvt_pk_bf16_f32 v55, v62, v63
buffer_store_dwordx4 v[48:51], v5, s[20:23], s45 offen sc1
buffer_store_dwordx4 v[52:55], v5, s[20:23], s45 offen offset:1024 sc1
v_pk_mul_f32 v[128:129], v[112:113], v[16:17] op_sel:[0,0] op_sel_hi:[1,0]
v_pk_mul_f32 v[130:131], v[114:115], v[16:17] op_sel:[0,0] op_sel_hi:[1,0]
v_pk_mul_f32 v[132:133], v[116:117], v[16:17] op_sel:[0,0] op_sel_hi:[1,0]
v_pk_mul_f32 v[134:135], v[118:119], v[16:17] op_sel:[0,0] op_sel_hi:[1,0]
v_pk_mul_f32 v[136:137], v[120:121], v[16:17] op_sel:[0,0] op_sel_hi:[1,0]
v_pk_mul_f32 v[138:139], v[122:123], v[16:17] op_sel:[0,0] op_sel_hi:[1,0]
v_pk_mul_f32 v[140:141], v[124:125], v[16:17] op_sel:[0,0] op_sel_hi:[1,0]
v_pk_mul_f32 v[142:143], v[126:127], v[16:17] op_sel:[0,0] op_sel_hi:[1,0]
v_pk_fma_f32 v[64:65], v[64:65], v[18:19], v[128:129] op_sel:[0,0,0] op_sel_hi:[1,0,1] neg_lo:[0,0,1] neg_hi:[0,0,1]
v_pk_fma_f32 v[66:67], v[66:67], v[18:19], v[130:131] op_sel:[0,0,0] op_sel_hi:[1,0,1] neg_lo:[0,0,1] neg_hi:[0,0,1]
v_pk_fma_f32 v[68:69], v[68:69], v[18:19], v[132:133] op_sel:[0,0,0] op_sel_hi:[1,0,1] neg_lo:[0,0,1] neg_hi:[0,0,1]
v_pk_fma_f32 v[70:71], v[70:71], v[18:19], v[134:135] op_sel:[0,0,0] op_sel_hi:[1,0,1] neg_lo:[0,0,1] neg_hi:[0,0,1]
v_pk_fma_f32 v[72:73], v[72:73], v[18:19], v[136:137] op_sel:[0,0,0] op_sel_hi:[1,0,1] neg_lo:[0,0,1] neg_hi:[0,0,1]
v_pk_fma_f32 v[74:75], v[74:75], v[18:19], v[138:139] op_sel:[0,0,0] op_sel_hi:[1,0,1] neg_lo:[0,0,1] neg_hi:[0,0,1]
v_pk_fma_f32 v[76:77], v[76:77], v[18:19], v[140:141] op_sel:[0,0,0] op_sel_hi:[1,0,1] neg_lo:[0,0,1] neg_hi:[0,0,1]
v_pk_fma_f32 v[78:79], v[78:79], v[18:19], v[142:143] op_sel:[0,0,0] op_sel_hi:[1,0,1] neg_lo:[0,0,1] neg_hi:[0,0,1]
v_pk_mul_f32 v[128:129], v[64:65], s[50:51]
v_pk_mul_f32 v[130:131], v[66:67], s[50:51]
v_pk_mul_f32 v[132:133], v[68:69], s[50:51]
v_pk_mul_f32 v[134:135], v[70:71], s[50:51]
v_pk_mul_f32 v[136:137], v[72:73], s[50:51]
v_pk_mul_f32 v[138:139], v[74:75], s[50:51]
v_pk_mul_f32 v[140:141], v[76:77], s[50:51]
v_pk_mul_f32 v[142:143], v[78:79], s[50:51]
v_exp_f32 v128, v128
v_exp_f32 v129, v129
v_exp_f32 v130, v130
v_exp_f32 v131, v131
v_exp_f32 v132, v132
v_exp_f32 v133, v133
v_exp_f32 v134, v134
v_exp_f32 v135, v135
v_exp_f32 v136, v136
v_exp_f32 v137, v137
v_exp_f32 v138, v138
v_exp_f32 v139, v139
s_waitcnt vmcnt(22)
ds_read_b64_tr_b16 a[16:17], v3 offset:24576
ds_read_b64_tr_b16 a[18:19], v3 offset:25600
ds_read_b64_tr_b16 a[128:129], v8 offset:24576
ds_read_b64_tr_b16 a[130:131], v8 offset:25600
s_waitcnt lgkmcnt(8)
s_add_u32 m0, s86, 20480
s_nop 0
buffer_load_dwordx4 v0, s[80:83], s42 offen lds
buffer_load_dwordx4 v1, s[80:83], s42 offen offset:1024 lds
s_add_u32 s42, s42, 14336
v_exp_f32 v140, v140
v_exp_f32 v141, v141
v_exp_f32 v142, v142
v_exp_f32 v143, v143
s_nop 0
v_pk_add_f32 v[128:129], v[128:129], v[10:11]
v_pk_add_f32 v[130:131], v[130:131], v[10:11]
v_pk_add_f32 v[132:133], v[132:133], v[10:11]
v_pk_add_f32 v[134:135], v[134:135], v[10:11]
v_pk_add_f32 v[136:137], v[136:137], v[10:11]
v_pk_add_f32 v[138:139], v[138:139], v[10:11]
v_pk_add_f32 v[140:141], v[140:141], v[10:11]
v_pk_add_f32 v[142:143], v[142:143], v[10:11]
v_rcp_f32 v128, v128
v_rcp_f32 v129, v129
v_rcp_f32 v130, v130
v_rcp_f32 v131, v131
v_rcp_f32 v132, v132
v_rcp_f32 v133, v133
v_rcp_f32 v134, v134
v_rcp_f32 v135, v135
v_rcp_f32 v136, v136
v_rcp_f32 v137, v137
v_rcp_f32 v138, v138
v_rcp_f32 v139, v139
v_rcp_f32 v140, v140
v_rcp_f32 v141, v141
v_rcp_f32 v142, v142
v_rcp_f32 v143, v143
v_pk_mul_f32 v[64:65], v[64:65], v[128:129]
v_pk_mul_f32 v[66:67], v[66:67], v[130:131]
v_pk_mul_f32 v[68:69], v[68:69], v[132:133]
v_pk_mul_f32 v[70:71], v[70:71], v[134:135]
v_pk_mul_f32 v[72:73], v[72:73], v[136:137]
v_pk_mul_f32 v[74:75], v[74:75], v[138:139]
v_pk_mul_f32 v[76:77], v[76:77], v[140:141]
v_pk_mul_f32 v[78:79], v[78:79], v[142:143]
v_cvt_pk_bf16_f32 v64, v64, v65
v_cvt_pk_bf16_f32 v65, v66, v67
v_cvt_pk_bf16_f32 v66, v68, v69
v_cvt_pk_bf16_f32 v67, v70, v71
s_waitcnt vmcnt(22)
ds_read_b64_tr_b16 a[20:21], v3 offset:26624
ds_read_b64_tr_b16 a[22:23], v3 offset:27648
ds_read_b64_tr_b16 a[132:133], v8 offset:26624
ds_read_b64_tr_b16 a[134:135], v8 offset:27648
s_waitcnt lgkmcnt(8)
s_add_u32 m0, s86, 22528
s_nop 0
s_nop 0
buffer_load_dwordx4 v0, s[80:83], s42 offen lds
buffer_load_dwordx4 v1, s[80:83], s42 offen offset:1024 lds
s_add_u32 s42, s42, 14336
v_cvt_pk_bf16_f32 v68, v72, v73
v_cvt_pk_bf16_f32 v69, v74, v75
v_cvt_pk_bf16_f32 v70, v76, v77
v_cvt_pk_bf16_f32 v71, v78, v79
buffer_store_dwordx4 v[64:67], v5, s[20:23], s44 offen offset:2048 sc1
buffer_store_dwordx4 v[68:71], v5, s[20:23], s44 offen offset:3072 sc1
v_pk_mul_f32 v[128:129], v[112:113], v[16:17] op_sel:[0,1] op_sel_hi:[1,1]
v_pk_mul_f32 v[130:131], v[114:115], v[16:17] op_sel:[0,1] op_sel_hi:[1,1]
v_pk_mul_f32 v[132:133], v[116:117], v[16:17] op_sel:[0,1] op_sel_hi:[1,1]
v_pk_mul_f32 v[134:135], v[118:119], v[16:17] op_sel:[0,1] op_sel_hi:[1,1]
v_pk_mul_f32 v[136:137], v[120:121], v[16:17] op_sel:[0,1] op_sel_hi:[1,1]
v_pk_mul_f32 v[138:139], v[122:123], v[16:17] op_sel:[0,1] op_sel_hi:[1,1]
v_pk_mul_f32 v[140:141], v[124:125], v[16:17] op_sel:[0,1] op_sel_hi:[1,1]
v_pk_mul_f32 v[142:143], v[126:127], v[16:17] op_sel:[0,1] op_sel_hi:[1,1]
v_pk_fma_f32 v[80:81], v[80:81], v[18:19], v[128:129] op_sel:[0,1,0] op_sel_hi:[1,1,1] neg_lo:[0,0,1] neg_hi:[0,0,1]
v_pk_fma_f32 v[82:83], v[82:83], v[18:19], v[130:131] op_sel:[0,1,0] op_sel_hi:[1,1,1] neg_lo:[0,0,1] neg_hi:[0,0,1]
v_pk_fma_f32 v[84:85], v[84:85], v[18:19], v[132:133] op_sel:[0,1,0] op_sel_hi:[1,1,1] neg_lo:[0,0,1] neg_hi:[0,0,1]
v_pk_fma_f32 v[86:87], v[86:87], v[18:19], v[134:135] op_sel:[0,1,0] op_sel_hi:[1,1,1] neg_lo:[0,0,1] neg_hi:[0,0,1]
v_pk_fma_f32 v[88:89], v[88:89], v[18:19], v[136:137] op_sel:[0,1,0] op_sel_hi:[1,1,1] neg_lo:[0,0,1] neg_hi:[0,0,1]
v_pk_fma_f32 v[90:91], v[90:91], v[18:19], v[138:139] op_sel:[0,1,0] op_sel_hi:[1,1,1] neg_lo:[0,0,1] neg_hi:[0,0,1]
v_pk_fma_f32 v[92:93], v[92:93], v[18:19], v[140:141] op_sel:[0,1,0] op_sel_hi:[1,1,1] neg_lo:[0,0,1] neg_hi:[0,0,1]
v_pk_fma_f32 v[94:95], v[94:95], v[18:19], v[142:143] op_sel:[0,1,0] op_sel_hi:[1,1,1] neg_lo:[0,0,1] neg_hi:[0,0,1]
v_pk_mul_f32 v[128:129], v[80:81], s[50:51]
v_pk_mul_f32 v[130:131], v[82:83], s[50:51]
v_pk_mul_f32 v[132:133], v[84:85], s[50:51]
v_pk_mul_f32 v[134:135], v[86:87], s[50:51]
v_pk_mul_f32 v[136:137], v[88:89], s[50:51]
v_pk_mul_f32 v[138:139], v[90:91], s[50:51]
v_pk_mul_f32 v[140:141], v[92:93], s[50:51]
v_pk_mul_f32 v[142:143], v[94:95], s[50:51]
v_exp_f32 v128, v128
v_exp_f32 v129, v129
v_exp_f32 v130, v130
v_exp_f32 v131, v131
v_exp_f32 v132, v132
v_exp_f32 v133, v133
v_exp_f32 v134, v134
v_exp_f32 v135, v135
v_exp_f32 v136, v136
v_exp_f32 v137, v137
s_waitcnt vmcnt(24)
ds_read_b64_tr_b16 a[24:25], v3 offset:28672
ds_read_b64_tr_b16 a[26:27], v3 offset:29696
ds_read_b64_tr_b16 a[136:137], v8 offset:28672
ds_read_b64_tr_b16 a[138:139], v8 offset:29696
s_waitcnt lgkmcnt(8)
s_add_u32 m0, s86, 24576
s_nop 0
buffer_load_dwordx4 v0, s[80:83], s42 offen lds
buffer_load_dwordx4 v1, s[80:83], s42 offen offset:1024 lds
s_add_u32 s42, s42, 14336
v_exp_f32 v138, v138
v_exp_f32 v139, v139
v_exp_f32 v140, v140
v_exp_f32 v141, v141
v_exp_f32 v142, v142
v_exp_f32 v143, v143
s_nop 0
v_pk_add_f32 v[128:129], v[128:129], v[10:11]
v_pk_add_f32 v[130:131], v[130:131], v[10:11]
v_pk_add_f32 v[132:133], v[132:133], v[10:11]
v_pk_add_f32 v[134:135], v[134:135], v[10:11]
v_pk_add_f32 v[136:137], v[136:137], v[10:11]
v_pk_add_f32 v[138:139], v[138:139], v[10:11]
v_pk_add_f32 v[140:141], v[140:141], v[10:11]
v_pk_add_f32 v[142:143], v[142:143], v[10:11]
v_rcp_f32 v128, v128
v_rcp_f32 v129, v129
v_rcp_f32 v130, v130
v_rcp_f32 v131, v131
v_rcp_f32 v132, v132
v_rcp_f32 v133, v133
v_rcp_f32 v134, v134
v_rcp_f32 v135, v135
v_rcp_f32 v136, v136
v_rcp_f32 v137, v137
v_rcp_f32 v138, v138
v_rcp_f32 v139, v139
v_rcp_f32 v140, v140
v_rcp_f32 v141, v141
v_rcp_f32 v142, v142
v_rcp_f32 v143, v143
v_pk_mul_f32 v[80:81], v[80:81], v[128:129]
v_pk_mul_f32 v[82:83], v[82:83], v[130:131]
v_pk_mul_f32 v[84:85], v[84:85], v[132:133]
v_pk_mul_f32 v[86:87], v[86:87], v[134:135]
v_pk_mul_f32 v[88:89], v[88:89], v[136:137]
v_pk_mul_f32 v[90:91], v[90:91], v[138:139]
v_pk_mul_f32 v[92:93], v[92:93], v[140:141]
v_pk_mul_f32 v[94:95], v[94:95], v[142:143]
v_cvt_pk_bf16_f32 v80, v80, v81
v_cvt_pk_bf16_f32 v81, v82, v83
s_waitcnt vmcnt(24)
ds_read_b64_tr_b16 a[28:29], v3 offset:30720
ds_read_b64_tr_b16 a[30:31], v3 offset:31744
ds_read_b64_tr_b16 a[140:141], v8 offset:30720
ds_read_b64_tr_b16 a[142:143], v8 offset:31744
s_waitcnt lgkmcnt(8)
s_add_u32 m0, s86, 26624
s_nop 0
s_nop 0
buffer_load_dwordx4 v0, s[80:83], s42 offen lds
buffer_load_dwordx4 v1, s[80:83], s42 offen offset:1024 lds
s_add_u32 s42, s42, 14336
v_cvt_pk_bf16_f32 v82, v84, v85
v_cvt_pk_bf16_f32 v83, v86, v87
v_cvt_pk_bf16_f32 v84, v88, v89
v_cvt_pk_bf16_f32 v85, v90, v91
v_cvt_pk_bf16_f32 v86, v92, v93
v_cvt_pk_bf16_f32 v87, v94, v95
buffer_store_dwordx4 v[80:83], v5, s[20:23], s45 offen offset:2048 sc1
buffer_store_dwordx4 v[84:87], v5, s[20:23], s45 offen offset:3072 sc1
s_waitcnt vmcnt(0)
s_barrier
s_cmp_lg_u32 s3, 0
s_cbranch_scc1 SETF_18
s_mov_b64 exec, 1
buffer_store_dword v30, v29, s[88:91], s52 offen sc1
s_mov_b64 exec, -1
SETF_18:
s_waitcnt vmcnt(26)
ds_read_b64_tr_b16 a[32:33], v3 offset:32768
ds_read_b64_tr_b16 a[34:35], v3 offset:33792
ds_read_b64_tr_b16 a[144:145], v8 offset:32768
ds_read_b64_tr_b16 a[146:147], v8 offset:33792
s_waitcnt lgkmcnt(8)
s_add_u32 m0, s86, 28672
s_nop 0
buffer_load_dwordx4 v0, s[80:83], s42 offen lds
buffer_load_dwordx4 v1, s[80:83], s42 offen offset:1024 lds
s_add_u32 s42, s42, 14336
s_waitcnt vmcnt(26)
ds_read_b64_tr_b16 a[36:37], v3 offset:34816
ds_read_b64_tr_b16 a[38:39], v3 offset:35840
ds_read_b64_tr_b16 a[148:149], v8 offset:34816
ds_read_b64_tr_b16 a[150:151], v8 offset:35840
s_waitcnt lgkmcnt(8)
s_add_u32 m0, s86, 30720
s_nop 0
buffer_load_dwordx4 v0, s[80:83], s42 offen lds
buffer_load_dwordx4 v1, s[80:83], s42 offen offset:1024 lds
s_add_u32 s42, s42, 14336
s_waitcnt vmcnt(26)
ds_read_b64_tr_b16 a[40:41], v3 offset:36864
ds_read_b64_tr_b16 a[42:43], v3 offset:37888
ds_read_b64_tr_b16 a[152:153], v8 offset:36864
ds_read_b64_tr_b16 a[154:155], v8 offset:37888
s_waitcnt lgkmcnt(8)
s_add_u32 m0, s86, 32768
s_nop 0
buffer_load_dwordx4 v0, s[80:83], s42 offen lds
buffer_load_dwordx4 v1, s[80:83], s42 offen offset:1024 lds
s_add_u32 s42, s42, 14336
s_waitcnt vmcnt(26)
ds_read_b64_tr_b16 a[44:45], v3 offset:38912
ds_read_b64_tr_b16 a[46:47], v3 offset:39936
ds_read_b64_tr_b16 a[156:157], v8 offset:38912
ds_read_b64_tr_b16 a[158:159], v8 offset:39936
s_waitcnt lgkmcnt(8)
s_add_u32 m0, s86, 34816
s_nop 0
buffer_load_dwordx4 v0, s[80:83], s42 offen lds
buffer_load_dwordx4 v1, s[80:83], s42 offen offset:1024 lds
s_add_u32 s42, s42, 14336
s_waitcnt vmcnt(24)
ds_read_b64_tr_b16 a[48:49], v3 offset:16384
ds_read_b64_tr_b16 a[50:51], v3 offset:17408
ds_read_b64_tr_b16 a[160:161], v8 offset:16384
ds_read_b64_tr_b16 a[162:163], v8 offset:17408
s_waitcnt lgkmcnt(8)
s_add_u32 m0, s86, 36864
s_nop 0
buffer_load_dwordx4 v0, s[80:83], s42 offen lds
buffer_load_dwordx4 v1, s[80:83], s42 offen offset:1024 lds
s_add_u32 s42, s42, 14336
s_waitcnt vmcnt(24)
ds_read_b64_tr_b16 a[52:53], v3 offset:18432
ds_read_b64_tr_b16 a[54:55], v3 offset:19456
ds_read_b64_tr_b16 a[164:165], v8 offset:18432
ds_read_b64_tr_b16 a[166:167], v8 offset:19456
s_waitcnt lgkmcnt(8)
s_add_u32 m0, s86, 38912
s_nop 0
buffer_load_dwordx4 v0, s[80:83], s42 offen lds
buffer_load_dwordx4 v1, s[80:83], s42 offen offset:1024 lds
s_add_u32 s42, s42, 14336
s_waitcnt vmcnt(22)
ds_read_b64_tr_b16 a[56:57], v3 offset:20480
ds_read_b64_tr_b16 a[58:59], v3 offset:21504
ds_read_b64_tr_b16 a[168:169], v8 offset:20480
ds_read_b64_tr_b16 a[170:171], v8 offset:21504
s_waitcnt lgkmcnt(8)
s_add_u32 m0, s86, 16384
s_nop 0
buffer_load_dwordx4 v0, s[80:83], s42 offen lds
buffer_load_dwordx4 v1, s[80:83], s42 offen offset:1024 lds
s_add_u32 s42, s42, 14336
s_waitcnt vmcnt(22)
ds_read_b64_tr_b16 a[60:61], v3 offset:22528
ds_read_b64_tr_b16 a[62:63], v3 offset:23552
ds_read_b64_tr_b16 a[172:173], v8 offset:22528
ds_read_b64_tr_b16 a[174:175], v8 offset:23552
s_waitcnt lgkmcnt(8)
s_add_u32 m0, s86, 18432
s_nop 0
buffer_load_dwordx4 v0, s[80:83], s42 offen lds
buffer_load_dwordx4 v1, s[80:83], s42 offen offset:1024 lds
s_add_u32 s42, s42, 14336
s_waitcnt vmcnt(20)
ds_read_b64_tr_b16 a[64:65], v3 offset:24576
ds_read_b64_tr_b16 a[66:67], v3 offset:25600
ds_read_b64_tr_b16 a[176:177], v8 offset:24576
ds_read_b64_tr_b16 a[178:179], v8 offset:25600
s_waitcnt lgkmcnt(8)
s_add_u32 m0, s86, 20480
s_nop 0
buffer_load_dwordx4 v0, s[80:83], s42 offen lds
buffer_load_dwordx4 v1, s[80:83], s42 offen offset:1024 lds
s_add_u32 s42, s42, 14336
s_waitcnt vmcnt(20)
ds_read_b64_tr_b16 a[68:69], v3 offset:26624
ds_read_b64_tr_b16 a[70:71], v3 offset:27648
ds_read_b64_tr_b16 a[180:181], v8 offset:26624
ds_read_b64_tr_b16 a[182:183], v8 offset:27648
s_waitcnt lgkmcnt(8)
s_add_u32 m0, s86, 22528
s_nop 0
buffer_load_dwordx4 v0, s[80:83], s42 offen lds
buffer_load_dwordx4 v1, s[80:83], s42 offen offset:1024 lds
s_add_u32 s42, s42, 14336
s_waitcnt vmcnt(18)
ds_read_b64_tr_b16 a[72:73], v3 offset:28672
ds_read_b64_tr_b16 a[74:75], v3 offset:29696
ds_read_b64_tr_b16 a[184:185], v8 offset:28672
ds_read_b64_tr_b16 a[186:187], v8 offset:29696
s_waitcnt vmcnt(16)
ds_read_b64_tr_b16 a[76:77], v3 offset:30720
ds_read_b64_tr_b16 a[78:79], v3 offset:31744
ds_read_b64_tr_b16 a[188:189], v8 offset:30720
ds_read_b64_tr_b16 a[190:191], v8 offset:31744
s_waitcnt vmcnt(14)
ds_read_b64_tr_b16 a[80:81], v3 offset:32768
ds_read_b64_tr_b16 a[82:83], v3 offset:33792
ds_read_b64_tr_b16 a[192:193], v8 offset:32768
ds_read_b64_tr_b16 a[194:195], v8 offset:33792
s_waitcnt vmcnt(12)
ds_read_b64_tr_b16 a[84:85], v3 offset:34816
ds_read_b64_tr_b16 a[86:87], v3 offset:35840
ds_read_b64_tr_b16 a[196:197], v8 offset:34816
ds_read_b64_tr_b16 a[198:199], v8 offset:35840
s_waitcnt vmcnt(10)
ds_read_b64_tr_b16 a[88:89], v3 offset:36864
ds_read_b64_tr_b16 a[90:91], v3 offset:37888
ds_read_b64_tr_b16 a[200:201], v8 offset:36864
ds_read_b64_tr_b16 a[202:203], v8 offset:37888
s_waitcnt vmcnt(8)
ds_read_b64_tr_b16 a[92:93], v3 offset:38912
ds_read_b64_tr_b16 a[94:95], v3 offset:39936
ds_read_b64_tr_b16 a[204:205], v8 offset:38912
ds_read_b64_tr_b16 a[206:207], v8 offset:39936
s_waitcnt vmcnt(6)
ds_read_b64_tr_b16 a[96:97], v3 offset:16384
ds_read_b64_tr_b16 a[98:99], v3 offset:17408
ds_read_b64_tr_b16 a[208:209], v8 offset:16384
ds_read_b64_tr_b16 a[210:211], v8 offset:17408
s_waitcnt vmcnt(4)
ds_read_b64_tr_b16 a[100:101], v3 offset:18432
ds_read_b64_tr_b16 a[102:103], v3 offset:19456
ds_read_b64_tr_b16 a[212:213], v8 offset:18432
ds_read_b64_tr_b16 a[214:215], v8 offset:19456
s_waitcnt vmcnt(2)
ds_read_b64_tr_b16 a[104:105], v3 offset:20480
ds_read_b64_tr_b16 a[106:107], v3 offset:21504
ds_read_b64_tr_b16 a[216:217], v8 offset:20480
ds_read_b64_tr_b16 a[218:219], v8 offset:21504
s_waitcnt vmcnt(0)
ds_read_b64_tr_b16 a[108:109], v3 offset:22528
ds_read_b64_tr_b16 a[110:111], v3 offset:23552
ds_read_b64_tr_b16 a[220:221], v8 offset:22528
ds_read_b64_tr_b16 a[222:223], v8 offset:23552
v_and_b32 v10, 7, v2
v_min_u32 v10, 6, v10
v_lshlrev_b32 v10, 2, v10
s_lshl_b32 s45, s6, 5
s_add_u32 s45, s45, 6144
s_mov_b32 s87, 0
POLL_19:
buffer_load_dword v11, v10, s[88:91], s45 offen sc1
s_waitcnt vmcnt(0)
v_cmp_ne_u32 vcc, 1, v11
s_cbranch_vccz POLL_19_OK
s_sleep 1
s_add_u32 s87, s87, 1
s_cmp_lt_u32 s87, 65536
s_cbranch_scc1 POLL_19
POLL_19_OK:
s_mul_i32 s42, s6, 229376
s_mul_i32 s43, s3, 28672
s_add_u32 s42, s42, s43
v_add_u32 v6, 114688, v5
buffer_load_dwordx4 v[96:99], v5, s[20:23], s42 offen sc1
buffer_load_dwordx4 v[100:103], v6, s[20:23], s42 offen sc1
buffer_load_dwordx4 v[104:107], v5, s[20:23], s42 offen offset:1024 sc1
buffer_load_dwordx4 v[108:111], v6, s[20:23], s42 offen offset:1024 sc1
buffer_load_dwordx4 v[112:115], v5, s[20:23], s42 offen offset:2048 sc1
buffer_load_dwordx4 v[116:119], v6, s[20:23], s42 offen offset:2048 sc1
buffer_load_dwordx4 v[120:123], v5, s[20:23], s42 offen offset:3072 sc1
buffer_load_dwordx4 v[124:127], v6, s[20:23], s42 offen offset:3072 sc1
s_add_u32 s42, s42, 4096
buffer_load_dwordx4 v[128:131], v5, s[20:23], s42 offen sc1
buffer_load_dwordx4 v[132:135], v6, s[20:23], s42 offen sc1
buffer_load_dwordx4 v[136:139], v5, s[20:23], s42 offen offset:1024 sc1
buffer_load_dwordx4 v[140:143], v6, s[20:23], s42 offen offset:1024 sc1
buffer_load_dwordx4 v[144:147], v5, s[20:23], s42 offen offset:2048 sc1
buffer_load_dwordx4 v[148:151], v6, s[20:23], s42 offen offset:2048 sc1
buffer_load_dwordx4 v[152:155], v5, s[20:23], s42 offen offset:3072 sc1
buffer_load_dwordx4 v[156:159], v6, s[20:23], s42 offen offset:3072 sc1
s_add_u32 s42, s42, 4096
buffer_load_dwordx4 v[160:163], v5, s[20:23], s42 offen sc1
buffer_load_dwordx4 v[164:167], v6, s[20:23], s42 offen sc1
buffer_load_dwordx4 v[168:171], v5, s[20:23], s42 offen offset:1024 sc1
buffer_load_dwordx4 v[172:175], v6, s[20:23], s42 offen offset:1024 sc1
buffer_load_dwordx4 v[176:179], v5, s[20:23], s42 offen offset:2048 sc1
buffer_load_dwordx4 v[180:183], v6, s[20:23], s42 offen offset:2048 sc1
buffer_load_dwordx4 v[184:187], v5, s[20:23], s42 offen offset:3072 sc1
buffer_load_dwordx4 v[188:191], v6, s[20:23], s42 offen offset:3072 sc1
s_add_u32 s42, s42, 4096
buffer_load_dwordx4 v[192:195], v5, s[20:23], s42 offen sc1
buffer_load_dwordx4 v[196:199], v6, s[20:23], s42 offen sc1
buffer_load_dwordx4 v[200:203], v5, s[20:23], s42 offen offset:1024 sc1
buffer_load_dwordx4 v[204:207], v6, s[20:23], s42 offen offset:1024 sc1
s_waitcnt lgkmcnt(0)
s_waitcnt vmcnt(26)
v_mfma_f32_32x32x16_bf16 v[32:47], a[0:3], v[96:99], 0
v_mfma_f32_32x32x16_bf16 v[48:63], a[0:3], v[100:103], 0
v_mfma_f32_32x32x16_bf16 v[64:79], a[112:115], v[96:99], 0
v_mfma_f32_32x32x16_bf16 v[80:95], a[112:115], v[100:103], 0
buffer_load_dwordx4 v[96:99], v5, s[20:23], s42 offen offset:2048 sc1
buffer_load_dwordx4 v[100:103], v6, s[20:23], s42 offen offset:2048 sc1
s_waitcnt vmcnt(26)
v_mfma_f32_32x32x16_bf16 v[32:47], a[4:7], v[104:107], v[32:47]
v_mfma_f32_32x32x16_bf16 v[48:63], a[4:7], v[108:111], v[48:63]
v_mfma_f32_32x32x16_bf16 v[64:79], a[116:119], v[104:107], v[64:79]
v_mfma_f32_32x32x16_bf16 v[80:95], a[116:119], v[108:111], v[80:95]
buffer_load_dwordx4 v[104:107], v5, s[20:23], s42 offen offset:3072 sc1
buffer_load_dwordx4 v[108:111], v6, s[20:23], s42 offen offset:3072 sc1
s_add_u32 s42, s42, 4096
s_waitcnt vmcnt(26)
v_mfma_f32_32x32x16_bf16 v[32:47], a[8:11], v[112:115], v[32:47]
v_mfma_f32_32x32x16_bf16 v[48:63], a[8:11], v[116:119], v[48:63]
v_mfma_f32_32x32x16_bf16 v[64:79], a[120:123], v[112:115], v[64:79]
v_mfma_f32_32x32x16_bf16 v[80:95], a[120:123], v[116:119], v[80:95]
buffer_load_dwordx4 v[112:115], v5, s[20:23], s42 offen sc1
buffer_load_dwordx4 v[116:119], v6, s[20:23], s42 offen sc1
s_waitcnt vmcnt(26)
v_mfma_f32_32x32x16_bf16 v[32:47], a[12:15], v[120:123], v[32:47]
v_mfma_f32_32x32x16_bf16 v[48:63], a[12:15], v[124:127], v[48:63]
v_mfma_f32_32x32x16_bf16 v[64:79], a[124:127], v[120:123], v[64:79]
v_mfma_f32_32x32x16_bf16 v[80:95], a[124:127], v[124:127], v[80:95]
buffer_load_dwordx4 v[120:123], v5, s[20:23], s42 offen offset:1024 sc1
buffer_load_dwordx4 v[124:127], v6, s[20:23], s42 offen offset:1024 sc1
s_waitcnt vmcnt(26)
v_mfma_f32_32x32x16_bf16 v[32:47], a[16:19], v[128:131], v[32:47]
v_mfma_f32_32x32x16_bf16 v[48:63], a[16:19], v[132:135], v[48:63]
v_mfma_f32_32x32x16_bf16 v[64:79], a[128:131], v[128:131], v[64:79]
v_mfma_f32_32x32x16_bf16 v[80:95], a[128:131], v[132:135], v[80:95]
buffer_load_dwordx4 v[128:131], v5, s[20:23], s42 offen offset:2048 sc1
buffer_load_dwordx4 v[132:135], v6, s[20:23], s42 offen offset:2048 sc1
s_waitcnt vmcnt(26)
v_mfma_f32_32x32x16_bf16 v[32:47], a[20:23], v[136:139], v[32:47]
v_mfma_f32_32x32x16_bf16 v[48:63], a[20:23], v[140:143], v[48:63]
v_mfma_f32_32x32x16_bf16 v[64:79], a[132:135], v[136:139], v[64:79]
v_mfma_f32_32x32x16_bf16 v[80:95], a[132:135], v[140:143], v[80:95]
buffer_load_dwordx4 v[136:139], v5, s[20:23], s42 offen offset:3072 sc1
buffer_load_dwordx4 v[140:143], v6, s[20:23], s42 offen offset:3072 sc1
s_add_u32 s42, s42, 4096
s_waitcnt vmcnt(26)
v_mfma_f32_32x32x16_bf16 v[32:47], a[24:27], v[144:147], v[32:47]
v_mfma_f32_32x32x16_bf16 v[48:63], a[24:27], v[148:151], v[48:63]
v_mfma_f32_32x32x16_bf16 v[64:79], a[136:139], v[144:147], v[64:79]
v_mfma_f32_32x32x16_bf16 v[80:95], a[136:139], v[148:151], v[80:95]
buffer_load_dwordx4 v[144:147], v5, s[20:23], s42 offen sc1
buffer_load_dwordx4 v[148:151], v6, s[20:23], s42 offen sc1
s_waitcnt vmcnt(26)
v_mfma_f32_32x32x16_bf16 v[32:47], a[28:31], v[152:155], v[32:47]
v_mfma_f32_32x32x16_bf16 v[48:63], a[28:31], v[156:159], v[48:63]
v_mfma_f32_32x32x16_bf16 v[64:79], a[140:143], v[152:155], v[64:79]
v_mfma_f32_32x32x16_bf16 v[80:95], a[140:143], v[156:159], v[80:95]
buffer_load_dwordx4 v[152:155], v5, s[20:23], s42 offen offset:1024 sc1
buffer_load_dwordx4 v[156:159], v6, s[20:23], s42 offen offset:1024 sc1
s_waitcnt vmcnt(26)
v_mfma_f32_32x32x16_bf16 v[32:47], a[32:35], v[160:163], v[32:47]
v_mfma_f32_32x32x16_bf16 v[48:63], a[32:35], v[164:167], v[48:63]
v_mfma_f32_32x32x16_bf16 v[64:79], a[144:147], v[160:163], v[64:79]
v_mfma_f32_32x32x16_bf16 v[80:95], a[144:147], v[164:167], v[80:95]
buffer_load_dwordx4 v[160:163], v5, s[20:23], s42 offen offset:2048 sc1
buffer_load_dwordx4 v[164:167], v6, s[20:23], s42 offen offset:2048 sc1
s_waitcnt vmcnt(26)
v_mfma_f32_32x32x16_bf16 v[32:47], a[36:39], v[168:171], v[32:47]
v_mfma_f32_32x32x16_bf16 v[48:63], a[36:39], v[172:175], v[48:63]
v_mfma_f32_32x32x16_bf16 v[64:79], a[148:151], v[168:171], v[64:79]
v_mfma_f32_32x32x16_bf16 v[80:95], a[148:151], v[172:175], v[80:95]
buffer_load_dwordx4 v[168:171], v5, s[20:23], s42 offen offset:3072 sc1
buffer_load_dwordx4 v[172:175], v6, s[20:23], s42 offen offset:3072 sc1
s_add_u32 s42, s42, 4096
s_waitcnt vmcnt(26)
v_mfma_f32_32x32x16_bf16 v[32:47], a[40:43], v[176:179], v[32:47]
v_mfma_f32_32x32x16_bf16 v[48:63], a[40:43], v[180:183], v[48:63]
v_mfma_f32_32x32x16_bf16 v[64:79], a[152:155], v[176:179], v[64:79]
v_mfma_f32_32x32x16_bf16 v[80:95], a[152:155], v[180:183], v[80:95]
buffer_load_dwordx4 v[176:179], v5, s[20:23], s42 offen sc1
buffer_load_dwordx4 v[180:183], v6, s[20:23], s42 offen sc1
s_waitcnt vmcnt(26)
v_mfma_f32_32x32x16_bf16 v[32:47], a[44:47], v[184:187], v[32:47]
v_mfma_f32_32x32x16_bf16 v[48:63], a[44:47], v[188:191], v[48:63]
v_mfma_f32_32x32x16_bf16 v[64:79], a[156:159], v[184:187], v[64:79]
v_mfma_f32_32x32x16_bf16 v[80:95], a[156:159], v[188:191], v[80:95]
buffer_load_dwordx4 v[184:187], v5, s[20:23], s42 offen offset:1024 sc1
buffer_load_dwordx4 v[188:191], v6, s[20:23], s42 offen offset:1024 sc1
s_waitcnt vmcnt(26)
v_mfma_f32_32x32x16_bf16 v[32:47], a[48:51], v[192:195], v[32:47]
v_mfma_f32_32x32x16_bf16 v[48:63], a[48:51], v[196:199], v[48:63]
v_mfma_f32_32x32x16_bf16 v[64:79], a[160:163], v[192:195], v[64:79]
v_mfma_f32_32x32x16_bf16 v[80:95], a[160:163], v[196:199], v[80:95]
buffer_load_dwordx4 v[192:195], v5, s[20:23], s42 offen offset:2048 sc1
buffer_load_dwordx4 v[196:199], v6, s[20:23], s42 offen offset:2048 sc1
s_waitcnt vmcnt(26)
v_mfma_f32_32x32x16_bf16 v[32:47], a[52:55], v[200:203], v[32:47]
v_mfma_f32_32x32x16_bf16 v[48:63], a[52:55], v[204:207], v[48:63]
v_mfma_f32_32x32x16_bf16 v[64:79], a[164:167], v[200:203], v[64:79]
v_mfma_f32_32x32x16_bf16 v[80:95], a[164:167], v[204:207], v[80:95]
buffer_load_dwordx4 v[200:203], v5, s[20:23], s42 offen offset:3072 sc1
buffer_load_dwordx4 v[204:207], v6, s[20:23], s42 offen offset:3072 sc1
s_add_u32 s42, s42, 4096
s_waitcnt vmcnt(26)
v_mfma_f32_32x32x16_bf16 v[32:47], a[56:59], v[96:99], v[32:47]
v_mfma_f32_32x32x16_bf16 v[48:63], a[56:59], v[100:103], v[48:63]
v_mfma_f32_32x32x16_bf16 v[64:79], a[168:171], v[96:99], v[64:79]
v_mfma_f32_32x32x16_bf16 v[80:95], a[168:171], v[100:103], v[80:95]
s_waitcnt vmcnt(24)
v_mfma_f32_32x32x16_bf16 v[32:47], a[60:63], v[104:107], v[32:47]
v_mfma_f32_32x32x16_bf16 v[48:63], a[60:63], v[108:111], v[48:63]
v_mfma_f32_32x32x16_bf16 v[64:79], a[172:175], v[104:107], v[64:79]
v_mfma_f32_32x32x16_bf16 v[80:95], a[172:175], v[108:111], v[80:95]
s_waitcnt vmcnt(22)
v_mfma_f32_32x32x16_bf16 v[32:47], a[64:67], v[112:115], v[32:47]
v_mfma_f32_32x32x16_bf16 v[48:63], a[64:67], v[116:119], v[48:63]
v_mfma_f32_32x32x16_bf16 v[64:79], a[176:179], v[112:115], v[64:79]
v_mfma_f32_32x32x16_bf16 v[80:95], a[176:179], v[116:119], v[80:95]
s_waitcnt vmcnt(20)
v_mfma_f32_32x32x16_bf16 v[32:47], a[68:71], v[120:123], v[32:47]
v_mfma_f32_32x32x16_bf16 v[48:63], a[68:71], v[124:127], v[48:63]
v_mfma_f32_32x32x16_bf16 v[64:79], a[180:183], v[120:123], v[64:79]
v_mfma_f32_32x32x16_bf16 v[80:95], a[180:183], v[124:127], v[80:95]
s_waitcnt vmcnt(18)
v_mfma_f32_32x32x16_bf16 v[32:47], a[72:75], v[128:131], v[32:47]
v_mfma_f32_32x32x16_bf16 v[48:63], a[72:75], v[132:135], v[48:63]
v_mfma_f32_32x32x16_bf16 v[64:79], a[184:187], v[128:131], v[64:79]
v_mfma_f32_32x32x16_bf16 v[80:95], a[184:187], v[132:135], v[80:95]
s_waitcnt vmcnt(16)
v_mfma_f32_32x32x16_bf16 v[32:47], a[76:79], v[136:139], v[32:47]
v_mfma_f32_32x32x16_bf16 v[48:63], a[76:79], v[140:143], v[48:63]
v_mfma_f32_32x32x16_bf16 v[64:79], a[188:191], v[136:139], v[64:79]
v_mfma_f32_32x32x16_bf16 v[80:95], a[188:191], v[140:143], v[80:95]
s_waitcnt vmcnt(14)
v_mfma_f32_32x32x16_bf16 v[32:47], a[80:83], v[144:147], v[32:47]
v_mfma_f32_32x32x16_bf16 v[48:63], a[80:83], v[148:151], v[48:63]
v_mfma_f32_32x32x16_bf16 v[64:79], a[192:195], v[144:147], v[64:79]
v_mfma_f32_32x32x16_bf16 v[80:95], a[192:195], v[148:151], v[80:95]
s_waitcnt vmcnt(12)
v_mfma_f32_32x32x16_bf16 v[32:47], a[84:87], v[152:155], v[32:47]
v_mfma_f32_32x32x16_bf16 v[48:63], a[84:87], v[156:159], v[48:63]
v_mfma_f32_32x32x16_bf16 v[64:79], a[196:199], v[152:155], v[64:79]
v_mfma_f32_32x32x16_bf16 v[80:95], a[196:199], v[156:159], v[80:95]
s_waitcnt vmcnt(10)
v_mfma_f32_32x32x16_bf16 v[32:47], a[88:91], v[160:163], v[32:47]
v_mfma_f32_32x32x16_bf16 v[48:63], a[88:91], v[164:167], v[48:63]
v_mfma_f32_32x32x16_bf16 v[64:79], a[200:203], v[160:163], v[64:79]
v_mfma_f32_32x32x16_bf16 v[80:95], a[200:203], v[164:167], v[80:95]
s_waitcnt vmcnt(8)
v_mfma_f32_32x32x16_bf16 v[32:47], a[92:95], v[168:171], v[32:47]
v_mfma_f32_32x32x16_bf16 v[48:63], a[92:95], v[172:175], v[48:63]
v_mfma_f32_32x32x16_bf16 v[64:79], a[204:207], v[168:171], v[64:79]
v_mfma_f32_32x32x16_bf16 v[80:95], a[204:207], v[172:175], v[80:95]
s_waitcnt vmcnt(6)
v_mfma_f32_32x32x16_bf16 v[32:47], a[96:99], v[176:179], v[32:47]
v_mfma_f32_32x32x16_bf16 v[48:63], a[96:99], v[180:183], v[48:63]
v_mfma_f32_32x32x16_bf16 v[64:79], a[208:211], v[176:179], v[64:79]
v_mfma_f32_32x32x16_bf16 v[80:95], a[208:211], v[180:183], v[80:95]
s_waitcnt vmcnt(4)
v_mfma_f32_32x32x16_bf16 v[32:47], a[100:103], v[184:187], v[32:47]
v_mfma_f32_32x32x16_bf16 v[48:63], a[100:103], v[188:191], v[48:63]
v_mfma_f32_32x32x16_bf16 v[64:79], a[212:215], v[184:187], v[64:79]
v_mfma_f32_32x32x16_bf16 v[80:95], a[212:215], v[188:191], v[80:95]
s_waitcnt vmcnt(2)
v_mfma_f32_32x32x16_bf16 v[32:47], a[104:107], v[192:195], v[32:47]
v_mfma_f32_32x32x16_bf16 v[48:63], a[104:107], v[196:199], v[48:63]
v_mfma_f32_32x32x16_bf16 v[64:79], a[216:219], v[192:195], v[64:79]
v_mfma_f32_32x32x16_bf16 v[80:95], a[216:219], v[196:199], v[80:95]
s_waitcnt vmcnt(0)
v_mfma_f32_32x32x16_bf16 v[32:47], a[108:111], v[200:203], v[32:47]
v_mfma_f32_32x32x16_bf16 v[48:63], a[108:111], v[204:207], v[48:63]
v_mfma_f32_32x32x16_bf16 v[64:79], a[220:223], v[200:203], v[64:79]
v_mfma_f32_32x32x16_bf16 v[80:95], a[220:223], v[204:207], v[80:95]
v_add_u32 v4, s86, v5
s_nop 7
s_nop 2
ds_write_b128 v4, v[32:35]
ds_write_b128 v4, v[36:39] offset:1024
ds_write_b128 v4, v[40:43] offset:2048
ds_write_b128 v4, v[44:47] offset:3072
ds_write_b128 v4, v[48:51] offset:4096
ds_write_b128 v4, v[52:55] offset:5120
ds_write_b128 v4, v[56:59] offset:6144
ds_write_b128 v4, v[60:63] offset:7168
ds_write_b128 v4, v[64:67] offset:8192
ds_write_b128 v4, v[68:71] offset:9216
ds_write_b128 v4, v[72:75] offset:10240
ds_write_b128 v4, v[76:79] offset:11264
ds_write_b128 v4, v[80:83] offset:12288
ds_write_b128 v4, v[84:87] offset:13312
ds_write_b128 v4, v[88:91] offset:14336
ds_write_b128 v4, v[92:95] offset:15360
s_waitcnt lgkmcnt(0)
s_barrier
s_lshl_b32 s45, s3, 12
v_add_u32 v4, s45, v5
v_add_u32 v28, 81920, v4
ds_read_b128 v[32:35], v4
ds_read_b128 v[36:39], v4 offset:1024
ds_read_b128 v[40:43], v4 offset:2048
ds_read_b128 v[44:47], v4 offset:3072
ds_read_b128 v[48:51], v4 offset:40960
ds_read_b128 v[52:55], v4 offset:41984
ds_read_b128 v[56:59], v4 offset:43008
ds_read_b128 v[60:63], v4 offset:44032
ds_read_b128 v[64:67], v28
ds_read_b128 v[68:71], v28 offset:1024
ds_read_b128 v[72:75], v28 offset:2048
ds_read_b128 v[76:79], v28 offset:3072
ds_read_b128 v[80:83], v28 offset:40960
ds_read_b128 v[84:87], v28 offset:41984
ds_read_b128 v[88:91], v28 offset:43008
ds_read_b128 v[92:95], v28 offset:44032
s_waitcnt lgkmcnt(0)
s_nop 0
v_pk_add_f32 v[32:33], v[32:33], v[48:49]
v_pk_add_f32 v[64:65], v[64:65], v[80:81]
v_pk_add_f32 v[34:35], v[34:35], v[50:51]
v_pk_add_f32 v[66:67], v[66:67], v[82:83]
v_pk_add_f32 v[36:37], v[36:37], v[52:53]
v_pk_add_f32 v[68:69], v[68:69], v[84:85]
v_pk_add_f32 v[38:39], v[38:39], v[54:55]
v_pk_add_f32 v[70:71], v[70:71], v[86:87]
v_pk_add_f32 v[40:41], v[40:41], v[56:57]
v_pk_add_f32 v[72:73], v[72:73], v[88:89]
v_pk_add_f32 v[42:43], v[42:43], v[58:59]
v_pk_add_f32 v[74:75], v[74:75], v[90:91]
v_pk_add_f32 v[44:45], v[44:45], v[60:61]
v_pk_add_f32 v[76:77], v[76:77], v[92:93]
v_pk_add_f32 v[46:47], v[46:47], v[62:63]
v_pk_add_f32 v[78:79], v[78:79], v[94:95]
v_pk_add_f32 v[32:33], v[32:33], v[64:65]
v_pk_add_f32 v[34:35], v[34:35], v[66:67]
v_pk_add_f32 v[36:37], v[36:37], v[68:69]
v_pk_add_f32 v[38:39], v[38:39], v[70:71]
v_pk_add_f32 v[40:41], v[40:41], v[72:73]
v_pk_add_f32 v[42:43], v[42:43], v[74:75]
v_pk_add_f32 v[44:45], v[44:45], v[76:77]
v_pk_add_f32 v[46:47], v[46:47], v[78:79]
v_cvt_pk_bf16_f32 v48, v32, v33
v_cvt_pk_bf16_f32 v49, v34, v35
v_cvt_pk_bf16_f32 v50, v36, v37
v_cvt_pk_bf16_f32 v51, v38, v39
v_cvt_pk_bf16_f32 v52, v40, v41
v_cvt_pk_bf16_f32 v53, v42, v43
v_cvt_pk_bf16_f32 v54, v44, v45
v_cvt_pk_bf16_f32 v55, v46, v47
v_lshlrev_b32 v32, 16, v48
v_and_b32 v33, 0xffff0000, v48
v_lshlrev_b32 v64, 16, v20
v_and_b32 v65, 0xffff0000, v20
v_lshlrev_b32 v34, 16, v49
v_and_b32 v35, 0xffff0000, v49
v_lshlrev_b32 v66, 16, v21
v_and_b32 v67, 0xffff0000, v21
v_lshlrev_b32 v36, 16, v50
v_and_b32 v37, 0xffff0000, v50
v_lshlrev_b32 v68, 16, v22
v_and_b32 v69, 0xffff0000, v22
v_lshlrev_b32 v38, 16, v51
v_and_b32 v39, 0xffff0000, v51
v_lshlrev_b32 v70, 16, v23
v_and_b32 v71, 0xffff0000, v23
v_lshlrev_b32 v40, 16, v52
v_and_b32 v41, 0xffff0000, v52
v_lshlrev_b32 v72, 16, v24
v_and_b32 v73, 0xffff0000, v24
v_lshlrev_b32 v42, 16, v53
v_and_b32 v43, 0xffff0000, v53
v_lshlrev_b32 v74, 16, v25
v_and_b32 v75, 0xffff0000, v25
v_lshlrev_b32 v44, 16, v54
v_and_b32 v45, 0xffff0000, v54
v_lshlrev_b32 v76, 16, v26
v_and_b32 v77, 0xffff0000, v26
v_lshlrev_b32 v46, 16, v55
v_and_b32 v47, 0xffff0000, v55
v_lshlrev_b32 v78, 16, v27
v_and_b32 v79, 0xffff0000, v27
v_pk_add_f32 v[32:33], v[32:33], v[64:65]
v_pk_add_f32 v[34:35], v[34:35], v[66:67]
v_pk_add_f32 v[36:37], v[36:37], v[68:69]
v_pk_add_f32 v[38:39], v[38:39], v[70:71]
v_pk_add_f32 v[40:41], v[40:41], v[72:73]
v_pk_add_f32 v[42:43], v[42:43], v[74:75]
v_pk_add_f32 v[44:45], v[44:45], v[76:77]
v_pk_add_f32 v[46:47], v[46:47], v[78:79]
v_cvt_pk_bf16_f32 v12, v32, v33
v_cvt_pk_bf16_f32 v13, v34, v35
v_cvt_pk_bf16_f32 v14, v36, v37
v_cvt_pk_bf16_f32 v15, v38, v39
v_cvt_pk_bf16_f32 v16, v40, v41
v_cvt_pk_bf16_f32 v17, v42, v43
v_cvt_pk_bf16_f32 v18, v44, v45
v_cvt_pk_bf16_f32 v19, v46, v47
buffer_store_dwordx2 v[12:13], v9, s[28:31], s48 offen
buffer_store_dwordx2 v[14:15], v9, s[28:31], s48 offen offset:16
buffer_store_dwordx2 v[16:17], v9, s[28:31], s48 offen offset:32
buffer_store_dwordx2 v[18:19], v9, s[28:31], s48 offen offset:48
MEGA_FIN:
MEGA_END:
s_endpgm
.section .rodata,"a"
.p2align 6
.amdhsa_kernel mega_kernel
  .amdhsa_next_free_vgpr 512
  .amdhsa_next_free_sgpr 102
  .amdhsa_accum_offset 256
  .amdhsa_group_segment_fixed_size 0
  .amdhsa_kernarg_size 96
  .amdhsa_user_sgpr_count 2
  .amdhsa_user_sgpr_kernarg_segment_ptr 1
  .amdhsa_system_sgpr_workgroup_id_x 1
.end_amdhsa_kernel
```
